```python
import torch

def _softmax(x, axis=-1):
    return torch.softmax(x, dim=axis)
def _gelu(x):
    return torch.nn.functional.gelu(x, approximate="tanh")
def _silu(x):
    return torch.nn.functional.silu(x)
def _sigmoid(x):
    return torch.sigmoid(x)
def _layernorm(x, axis=-1, eps=1e-5):
    m = x.mean(dim=axis, keepdim=True)
    v = x.var(dim=axis, keepdim=True, unbiased=False)
    return (x - m) / torch.sqrt(v + eps)
def _scatter_add(tgt, idx, src, axis=0):
    return tgt.clone().index_add_(axis, idx, src)
def _segment_sum(src, seg, n):
    out = torch.zeros((n,) + src.shape[1:], dtype=src.dtype)
    return out.index_add_(0, seg, src)
def _pad(x, pw):
    flat = tuple(v for pair in reversed(pw) for v in pair)
    return torch.nn.functional.pad(x, flat)

kernel_name = 'interleave_layers__sliding_block__dense_activation_squared_relu__prompt'

def setup_inputs():

    _w = (lambda a: (lambda t: t.to(torch.bfloat16) if t.is_floating_point() else t)(torch.as_tensor(a)))
    def _A_setup():
        B, S, D = 1, 2048, 640
        return {
            "x": _w((lambda *s: torch.randn(*s, dtype=torch.bfloat16) * 0.05)(B, S, D)),
            "wqkv": _w((lambda *s: torch.randn(*s, dtype=torch.bfloat16) * 0.05)(D, 3 * D)),
            "wo": _w((lambda *s: torch.randn(*s, dtype=torch.bfloat16) * 0.05)(D, D)),
        }
    _A_in = _A_setup()

    def _B_setup():
        B, S, D, F = 1, 2048, 640, 1728
        return {
            "x": _w((lambda *s: torch.randn(*s, dtype=torch.bfloat16) * 0.05)(B, S, D)),
            "w1": _w((lambda *s: torch.randn(*s, dtype=torch.bfloat16) * 0.05)(D, F)),
            "b1": _w((lambda *s: torch.randn(*s, dtype=torch.bfloat16) * 0.2)(F)),
            "w2": _w((lambda *s: torch.randn(*s, dtype=torch.bfloat16) * 0.05)(F, D)),
            "b2": _w((lambda *s: torch.randn(*s, dtype=torch.bfloat16) * 0.8)(D)),
        }
    _B_in = _B_setup()

    return {
        "A_x": _A_in["x"],
        "A_wqkv": _A_in["wqkv"],
        "A_wo": _A_in["wo"],
        "B_x": _B_in["x"],
        "B_w1": _B_in["w1"],
        "B_b1": _B_in["b1"],
        "B_w2": _B_in["w2"],
        "B_b2": _B_in["b2"],
    }

def reference(A_x, A_wqkv, A_wo, B_x, B_w1, B_b1, B_w2, B_b2):
    def _A_ref(x, wqkv, wo):
        B, S, D = x.shape
        H = 32; Dh = D // H; W = 256
        qkv = (lambda x, *d: x.permute(*d))((x @ wqkv).reshape(B, S, 3, H, Dh), 2, 0, 3, 1, 4)
        q, k, v = qkv[0], qkv[1], qkv[2]
        scores = torch.einsum("bhqd,bhkd->bhqk", q, k) * (Dh ** -0.5)
        idx = torch.arange(S)
        mask = (idx[:, None] - idx[None, :] >= 0) & (idx[:, None] - idx[None, :] < W)
        scores = torch.where(mask[None, None], scores, -1e9)
        p = _softmax(scores, axis=-1)
        o = torch.einsum("bhqk,bhkd->bhqd", p, v)
        return (lambda x, *d: x.permute(*d))(o, 0, 2, 1, 3).reshape(B, S, D) @ wo

    def _B_ref(x, w1, b1, w2, b2):
        h = torch.einsum("bsd,df->bsf", x, w1) + b1
        zero = torch.zeros_like(h)
        r = torch.where(h > zero, h, zero)
        h = r * r
        out = torch.einsum("bsf,fd->bsd", h, w2) + b2
        return out

    x = A_x
    x = x + _A_ref(_layernorm(x, axis=-1), A_wqkv, A_wo)
    x = x + _B_ref(_layernorm(x, axis=-1), B_w1, B_b1, B_w2, B_b2)
    x = x + _A_ref(_layernorm(x, axis=-1), A_wqkv, A_wo)
    x = x + _B_ref(_layernorm(x, axis=-1), B_w1, B_b1, B_w2, B_b2)
    return x
```

```asm
; @launch kernel=prep_kernel grid=(504,1,1) block=(256,1,1) lds=24576
; @launch kernel=interleave_layers__sliding_block__dense_activation_squared_relu__prompt_kernel grid=(256,1,1) block=(256,1,1) lds=118784
.amdgcn_target "amdgcn-amd-amdhsa--gfx950"
.text
.globl prep_kernel
.p2align 8
.type prep_kernel,@function
prep_kernel:
s_cmp_ge_u32 s2, 504
s_cbranch_scc1 P_END
s_load_dwordx4 s[16:19], s[0:1], 0
s_load_dwordx2 s[20:21], s[0:1], 16
s_load_dwordx2 s[22:23], s[0:1], 32
s_load_dwordx2 s[24:25], s[0:1], 48
s_load_dwordx2 s[26:27], s[0:1], 80
s_and_b32 s3, s2, 7
s_mul_i32 s3, s3, 63
s_lshr_b32 s12, s2, 3
s_add_u32 s3, s3, s12
v_lshrrev_b32 v1, 6, v0
v_and_b32 v0, 63, v0
s_nop 0
v_readfirstlane_b32 s12, v1
v_lshlrev_b32 v2, 4, v0
v_lshlrev_b32 v3, 3, v0
v_lshrrev_b32 v4, 2, v0
v_and_b32 v5, 3, v0
s_mul_i32 s13, s12, 5120
v_add_u32 v3, s13, v3
s_mul_i32 s14, s12, 5
s_waitcnt lgkmcnt(0)
s_mov_b32 s8, s26
s_mov_b32 s9, s27
s_mov_b32 s10, 34201600
s_mov_b32 s11, 0x00020000
s_getpc_b64 s[40:41]
PPC:
s_lshr_b32 s42, s2, 3
s_lshl_b32 s42, s42, 2
s_add_u32 s42, s42, s12
s_lshl_b32 s42, s42, 10
s_min_u32 s42, s42, M_END-interleave_layers__sliding_block__dense_activation_squared_relu__prompt_kernel-1024
s_add_u32 s42, s42, interleave_layers__sliding_block__dense_activation_squared_relu__prompt_kernel-PPC
s_add_u32 s40, s40, s42
s_addc_u32 s41, s41, 0
v_mov_b32 v65, s41
v_add_co_u32 v64, vcc, s40, v2
v_addc_co_u32 v65, vcc, 0, v65, vcc
global_load_dwordx4 v[68:71], v[64:65], off
s_cmp_lt_u32 s3, 120
s_cbranch_scc1 P_QKV
s_cmp_lt_u32 s3, 228
s_cbranch_scc1 P_W1
s_cmp_lt_u32 s3, 268
s_cbranch_scc1 P_WO
s_cmp_lt_u32 s3, 376
s_cbranch_scc1 P_W2
s_branch P_X
P_QKV:
s_mov_b32 s4, s18
s_mov_b32 s5, s19
s_mov_b32 s6, 2457600
s_mov_b32 s7, 0x00020000
s_mul_i32 s33, s3, 4370
s_lshr_b32 s33, s33, 16
s_mul_i32 s34, s33, 15
s_sub_u32 s34, s3, s34
s_lshr_b32 s35, s34, 2
s_sub_u32 s36, s34, 12
s_cmp_lt_u32 s34, 12
s_cselect_b32 s35, s35, s36
s_add_u32 s35, s35, 1
s_cmp_eq_u32 s35, 3
s_cselect_b32 s35, 0, s35
s_mul_i32 s35, s35, 640
s_mul_i32 s36, s33, 80
s_add_u32 s35, s35, s36
s_and_b32 s36, s34, 3
s_mul_i32 s36, s36, 20
s_cmp_lt_u32 s34, 12
s_cselect_b32 s36, s36, 16
s_cselect_b32 s37, 8, 40
s_add_u32 s15, s35, s36
s_lshl_b32 s15, s15, 1
v_mul_lo_u32 v6, v5, s37
s_mov_b32 s37, 3840
v_mul_lo_u32 v7, v4, s37
v_add_u32 v6, v6, v7
s_lshl_b32 s50, s3, 6
s_add_u32 s50, s50, 7700480
s_add_u32 s30, s14, 0
s_lshr_b32 s31, s30, 1
s_mul_i32 s31, s31, 80
s_and_b32 s32, s30, 1
s_lshl_b32 s32, s32, 5
s_add_u32 s31, s31, s32
s_sub_u32 s32, s30, 16
s_mul_i32 s32, s32, 160
s_add_u32 s32, s32, 64
s_cmp_lt_u32 s30, 16
s_cselect_b32 s31, s31, s32
s_cselect_b32 s32, 16, 80
s_add_u32 s32, s32, s31
s_mul_i32 s40, s3, 20
s_add_u32 s40, s40, s30
s_lshl_b32 s40, s40, 10
s_add_u32 s40, s40, 0
s_mul_i32 s31, s31, 3840
s_mul_i32 s32, s32, 3840
s_add_u32 s31, s31, s15
s_add_u32 s32, s32, s15
buffer_load_dwordx2 v[16:17], v6, s[4:7], s31 offen
buffer_load_dwordx2 v[18:19], v6, s[4:7], s32 offen
s_add_u32 s30, s14, 1
s_lshr_b32 s31, s30, 1
s_mul_i32 s31, s31, 80
s_and_b32 s32, s30, 1
s_lshl_b32 s32, s32, 5
s_add_u32 s31, s31, s32
s_sub_u32 s32, s30, 16
s_mul_i32 s32, s32, 160
s_add_u32 s32, s32, 64
s_cmp_lt_u32 s30, 16
s_cselect_b32 s31, s31, s32
s_cselect_b32 s32, 16, 80
s_add_u32 s32, s32, s31
s_mul_i32 s41, s3, 20
s_add_u32 s41, s41, s30
s_lshl_b32 s41, s41, 10
s_add_u32 s41, s41, 0
s_mul_i32 s31, s31, 3840
s_mul_i32 s32, s32, 3840
s_add_u32 s31, s31, s15
s_add_u32 s32, s32, s15
buffer_load_dwordx2 v[20:21], v6, s[4:7], s31 offen
buffer_load_dwordx2 v[22:23], v6, s[4:7], s32 offen
s_add_u32 s30, s14, 2
s_lshr_b32 s31, s30, 1
s_mul_i32 s31, s31, 80
s_and_b32 s32, s30, 1
s_lshl_b32 s32, s32, 5
s_add_u32 s31, s31, s32
s_sub_u32 s32, s30, 16
s_mul_i32 s32, s32, 160
s_add_u32 s32, s32, 64
s_cmp_lt_u32 s30, 16
s_cselect_b32 s31, s31, s32
s_cselect_b32 s32, 16, 80
s_add_u32 s32, s32, s31
s_mul_i32 s42, s3, 20
s_add_u32 s42, s42, s30
s_lshl_b32 s42, s42, 10
s_add_u32 s42, s42, 0
s_mul_i32 s31, s31, 3840
s_mul_i32 s32, s32, 3840
s_add_u32 s31, s31, s15
s_add_u32 s32, s32, s15
buffer_load_dwordx2 v[24:25], v6, s[4:7], s31 offen
buffer_load_dwordx2 v[26:27], v6, s[4:7], s32 offen
s_add_u32 s30, s14, 3
s_lshr_b32 s31, s30, 1
s_mul_i32 s31, s31, 80
s_and_b32 s32, s30, 1
s_lshl_b32 s32, s32, 5
s_add_u32 s31, s31, s32
s_sub_u32 s32, s30, 16
s_mul_i32 s32, s32, 160
s_add_u32 s32, s32, 64
s_cmp_lt_u32 s30, 16
s_cselect_b32 s31, s31, s32
s_cselect_b32 s32, 16, 80
s_add_u32 s32, s32, s31
s_mul_i32 s43, s3, 20
s_add_u32 s43, s43, s30
s_lshl_b32 s43, s43, 10
s_add_u32 s43, s43, 0
s_mul_i32 s31, s31, 3840
s_mul_i32 s32, s32, 3840
s_add_u32 s31, s31, s15
s_add_u32 s32, s32, s15
buffer_load_dwordx2 v[28:29], v6, s[4:7], s31 offen
buffer_load_dwordx2 v[30:31], v6, s[4:7], s32 offen
s_add_u32 s30, s14, 4
s_lshr_b32 s31, s30, 1
s_mul_i32 s31, s31, 80
s_and_b32 s32, s30, 1
s_lshl_b32 s32, s32, 5
s_add_u32 s31, s31, s32
s_sub_u32 s32, s30, 16
s_mul_i32 s32, s32, 160
s_add_u32 s32, s32, 64
s_cmp_lt_u32 s30, 16
s_cselect_b32 s31, s31, s32
s_cselect_b32 s32, 16, 80
s_add_u32 s32, s32, s31
s_mul_i32 s44, s3, 20
s_add_u32 s44, s44, s30
s_lshl_b32 s44, s44, 10
s_add_u32 s44, s44, 0
s_mul_i32 s31, s31, 3840
s_mul_i32 s32, s32, 3840
s_add_u32 s31, s31, s15
s_add_u32 s32, s32, s15
buffer_load_dwordx2 v[32:33], v6, s[4:7], s31 offen
buffer_load_dwordx2 v[34:35], v6, s[4:7], s32 offen
s_waitcnt vmcnt(0)
ds_write_b64 v3, v[16:17] offset:0
ds_write_b64 v3, v[18:19] offset:512
ds_write_b64 v3, v[20:21] offset:1024
ds_write_b64 v3, v[22:23] offset:1536
ds_write_b64 v3, v[24:25] offset:2048
ds_write_b64 v3, v[26:27] offset:2560
ds_write_b64 v3, v[28:29] offset:3072
ds_write_b64 v3, v[30:31] offset:3584
ds_write_b64 v3, v[32:33] offset:4096
ds_write_b64 v3, v[34:35] offset:4608
s_waitcnt lgkmcnt(0)
ds_read_b64_tr_b16 v[16:17], v3 offset:0
ds_read_b64_tr_b16 v[18:19], v3 offset:512
ds_read_b64_tr_b16 v[20:21], v3 offset:1024
ds_read_b64_tr_b16 v[22:23], v3 offset:1536
ds_read_b64_tr_b16 v[24:25], v3 offset:2048
ds_read_b64_tr_b16 v[26:27], v3 offset:2560
ds_read_b64_tr_b16 v[28:29], v3 offset:3072
ds_read_b64_tr_b16 v[30:31], v3 offset:3584
ds_read_b64_tr_b16 v[32:33], v3 offset:4096
ds_read_b64_tr_b16 v[34:35], v3 offset:4608
s_waitcnt lgkmcnt(0)
buffer_store_dwordx4 v[16:19], v2, s[8:11], s40 offen
buffer_store_dwordx4 v[20:23], v2, s[8:11], s41 offen
buffer_store_dwordx4 v[24:27], v2, s[8:11], s42 offen
buffer_store_dwordx4 v[28:31], v2, s[8:11], s43 offen
buffer_store_dwordx4 v[32:35], v2, s[8:11], s44 offen
v_mov_b32 v8, 0x3f803f80
v_mov_b32 v9, 0x3f803f80
v_mov_b32 v10, 0x3f803f80
v_mov_b32 v11, 0x3f803f80
v_mov_b32 v12, 0
v_mov_b32 v13, 0
v_mov_b32 v14, 0
v_mov_b32 v15, 0
s_nop 1
v_mfma_f32_16x16x32_bf16 v[12:15], v[16:19], v[8:11], v[12:15]
v_mfma_f32_16x16x32_bf16 v[12:15], v[20:23], v[8:11], v[12:15]
v_mfma_f32_16x16x32_bf16 v[12:15], v[24:27], v[8:11], v[12:15]
v_mfma_f32_16x16x32_bf16 v[12:15], v[28:31], v[8:11], v[12:15]
v_mfma_f32_16x16x32_bf16 v[12:15], v[32:35], v[8:11], v[12:15]
s_lshl_b32 s13, s12, 10
v_add_u32 v6, s13, v2
s_barrier
s_nop 4
ds_write_b128 v6, v[12:15] offset:20480
s_waitcnt lgkmcnt(0)
s_barrier
s_cmp_lg_u32 s12, 0
s_cbranch_scc1 P_FIN
ds_read_b128 v[16:19], v2 offset:21504
ds_read_b128 v[20:23], v2 offset:22528
ds_read_b128 v[24:27], v2 offset:23552
s_waitcnt lgkmcnt(0)
v_add_f32 v12, v12, v16
v_add_f32 v20, v20, v24
v_add_f32 v13, v13, v17
v_add_f32 v21, v21, v25
v_add_f32 v14, v14, v18
v_add_f32 v22, v22, v26
v_add_f32 v15, v15, v19
v_add_f32 v23, v23, v27
v_add_f32 v12, v12, v20
v_add_f32 v13, v13, v21
v_add_f32 v14, v14, v22
v_add_f32 v15, v15, v23
v_lshrrev_b32 v6, 4, v0
v_lshlrev_b32 v6, 4, v6
v_and_b32 v7, 15, v0
v_cmp_eq_u32 vcc, 0, v7
s_nop 0
s_and_saveexec_b64 s[34:35], vcc
buffer_store_dwordx4 v[12:15], v6, s[8:11], s50 offen
s_branch P_FIN
P_W1:
s_mov_b32 s4, s22
s_mov_b32 s5, s23
s_mov_b32 s6, 2211840
s_mov_b32 s7, 0x00020000
s_sub_u32 s33, s3, 120
s_lshl_b32 s15, s33, 5
v_lshlrev_b32 v6, 3, v5
s_mov_b32 s37, 3456
v_mul_lo_u32 v7, v4, s37
v_add_u32 v6, v6, v7
s_lshl_b32 s50, s33, 6
s_add_u32 s50, s50, 7708672
s_lshr_b32 s34, s33, 1
s_mul_i32 s34, s34, 40
s_and_b32 s35, s33, 1
s_add_u32 s34, s34, s35
s_add_u32 s30, s14, 0
s_lshr_b32 s31, s30, 1
s_mul_i32 s31, s31, 80
s_and_b32 s32, s30, 1
s_lshl_b32 s32, s32, 5
s_add_u32 s31, s31, s32
s_sub_u32 s32, s30, 16
s_mul_i32 s32, s32, 160
s_add_u32 s32, s32, 64
s_cmp_lt_u32 s30, 16
s_cselect_b32 s31, s31, s32
s_cselect_b32 s32, 16, 80
s_add_u32 s32, s32, s31
s_lshl_b32 s40, s30, 1
s_add_u32 s40, s40, s34
s_lshl_b32 s40, s40, 10
s_add_u32 s40, s40, 3276800
s_mul_i32 s31, s31, 3456
s_mul_i32 s32, s32, 3456
s_add_u32 s31, s31, s15
s_add_u32 s32, s32, s15
buffer_load_dwordx2 v[16:17], v6, s[4:7], s31 offen
buffer_load_dwordx2 v[18:19], v6, s[4:7], s32 offen
s_add_u32 s30, s14, 1
s_lshr_b32 s31, s30, 1
s_mul_i32 s31, s31, 80
s_and_b32 s32, s30, 1
s_lshl_b32 s32, s32, 5
s_add_u32 s31, s31, s32
s_sub_u32 s32, s30, 16
s_mul_i32 s32, s32, 160
s_add_u32 s32, s32, 64
s_cmp_lt_u32 s30, 16
s_cselect_b32 s31, s31, s32
s_cselect_b32 s32, 16, 80
s_add_u32 s32, s32, s31
s_lshl_b32 s41, s30, 1
s_add_u32 s41, s41, s34
s_lshl_b32 s41, s41, 10
s_add_u32 s41, s41, 3276800
s_mul_i32 s31, s31, 3456
s_mul_i32 s32, s32, 3456
s_add_u32 s31, s31, s15
s_add_u32 s32, s32, s15
buffer_load_dwordx2 v[20:21], v6, s[4:7], s31 offen
buffer_load_dwordx2 v[22:23], v6, s[4:7], s32 offen
s_add_u32 s30, s14, 2
s_lshr_b32 s31, s30, 1
s_mul_i32 s31, s31, 80
s_and_b32 s32, s30, 1
s_lshl_b32 s32, s32, 5
s_add_u32 s31, s31, s32
s_sub_u32 s32, s30, 16
s_mul_i32 s32, s32, 160
s_add_u32 s32, s32, 64
s_cmp_lt_u32 s30, 16
s_cselect_b32 s31, s31, s32
s_cselect_b32 s32, 16, 80
s_add_u32 s32, s32, s31
s_lshl_b32 s42, s30, 1
s_add_u32 s42, s42, s34
s_lshl_b32 s42, s42, 10
s_add_u32 s42, s42, 3276800
s_mul_i32 s31, s31, 3456
s_mul_i32 s32, s32, 3456
s_add_u32 s31, s31, s15
s_add_u32 s32, s32, s15
buffer_load_dwordx2 v[24:25], v6, s[4:7], s31 offen
buffer_load_dwordx2 v[26:27], v6, s[4:7], s32 offen
s_add_u32 s30, s14, 3
s_lshr_b32 s31, s30, 1
s_mul_i32 s31, s31, 80
s_and_b32 s32, s30, 1
s_lshl_b32 s32, s32, 5
s_add_u32 s31, s31, s32
s_sub_u32 s32, s30, 16
s_mul_i32 s32, s32, 160
s_add_u32 s32, s32, 64
s_cmp_lt_u32 s30, 16
s_cselect_b32 s31, s31, s32
s_cselect_b32 s32, 16, 80
s_add_u32 s32, s32, s31
s_lshl_b32 s43, s30, 1
s_add_u32 s43, s43, s34
s_lshl_b32 s43, s43, 10
s_add_u32 s43, s43, 3276800
s_mul_i32 s31, s31, 3456
s_mul_i32 s32, s32, 3456
s_add_u32 s31, s31, s15
s_add_u32 s32, s32, s15
buffer_load_dwordx2 v[28:29], v6, s[4:7], s31 offen
buffer_load_dwordx2 v[30:31], v6, s[4:7], s32 offen
s_add_u32 s30, s14, 4
s_lshr_b32 s31, s30, 1
s_mul_i32 s31, s31, 80
s_and_b32 s32, s30, 1
s_lshl_b32 s32, s32, 5
s_add_u32 s31, s31, s32
s_sub_u32 s32, s30, 16
s_mul_i32 s32, s32, 160
s_add_u32 s32, s32, 64
s_cmp_lt_u32 s30, 16
s_cselect_b32 s31, s31, s32
s_cselect_b32 s32, 16, 80
s_add_u32 s32, s32, s31
s_lshl_b32 s44, s30, 1
s_add_u32 s44, s44, s34
s_lshl_b32 s44, s44, 10
s_add_u32 s44, s44, 3276800
s_mul_i32 s31, s31, 3456
s_mul_i32 s32, s32, 3456
s_add_u32 s31, s31, s15
s_add_u32 s32, s32, s15
buffer_load_dwordx2 v[32:33], v6, s[4:7], s31 offen
buffer_load_dwordx2 v[34:35], v6, s[4:7], s32 offen
s_waitcnt vmcnt(0)
ds_write_b64 v3, v[16:17] offset:0
ds_write_b64 v3, v[18:19] offset:512
ds_write_b64 v3, v[20:21] offset:1024
ds_write_b64 v3, v[22:23] offset:1536
ds_write_b64 v3, v[24:25] offset:2048
ds_write_b64 v3, v[26:27] offset:2560
ds_write_b64 v3, v[28:29] offset:3072
ds_write_b64 v3, v[30:31] offset:3584
ds_write_b64 v3, v[32:33] offset:4096
ds_write_b64 v3, v[34:35] offset:4608
s_waitcnt lgkmcnt(0)
ds_read_b64_tr_b16 v[16:17], v3 offset:0
ds_read_b64_tr_b16 v[18:19], v3 offset:512
ds_read_b64_tr_b16 v[20:21], v3 offset:1024
ds_read_b64_tr_b16 v[22:23], v3 offset:1536
ds_read_b64_tr_b16 v[24:25], v3 offset:2048
ds_read_b64_tr_b16 v[26:27], v3 offset:2560
ds_read_b64_tr_b16 v[28:29], v3 offset:3072
ds_read_b64_tr_b16 v[30:31], v3 offset:3584
ds_read_b64_tr_b16 v[32:33], v3 offset:4096
ds_read_b64_tr_b16 v[34:35], v3 offset:4608
s_waitcnt lgkmcnt(0)
buffer_store_dwordx4 v[16:19], v2, s[8:11], s40 offen
buffer_store_dwordx4 v[20:23], v2, s[8:11], s41 offen
buffer_store_dwordx4 v[24:27], v2, s[8:11], s42 offen
buffer_store_dwordx4 v[28:31], v2, s[8:11], s43 offen
buffer_store_dwordx4 v[32:35], v2, s[8:11], s44 offen
v_mov_b32 v8, 0x3f803f80
v_mov_b32 v9, 0x3f803f80
v_mov_b32 v10, 0x3f803f80
v_mov_b32 v11, 0x3f803f80
v_mov_b32 v12, 0
v_mov_b32 v13, 0
v_mov_b32 v14, 0
v_mov_b32 v15, 0
s_nop 1
v_mfma_f32_16x16x32_bf16 v[12:15], v[16:19], v[8:11], v[12:15]
v_mfma_f32_16x16x32_bf16 v[12:15], v[20:23], v[8:11], v[12:15]
v_mfma_f32_16x16x32_bf16 v[12:15], v[24:27], v[8:11], v[12:15]
v_mfma_f32_16x16x32_bf16 v[12:15], v[28:31], v[8:11], v[12:15]
v_mfma_f32_16x16x32_bf16 v[12:15], v[32:35], v[8:11], v[12:15]
s_lshl_b32 s13, s12, 10
v_add_u32 v6, s13, v2
s_barrier
s_nop 4
ds_write_b128 v6, v[12:15] offset:20480
s_waitcnt lgkmcnt(0)
s_barrier
s_cmp_lg_u32 s12, 0
s_cbranch_scc1 P_FIN
ds_read_b128 v[16:19], v2 offset:21504
ds_read_b128 v[20:23], v2 offset:22528
ds_read_b128 v[24:27], v2 offset:23552
s_waitcnt lgkmcnt(0)
v_add_f32 v12, v12, v16
v_add_f32 v20, v20, v24
v_add_f32 v13, v13, v17
v_add_f32 v21, v21, v25
v_add_f32 v14, v14, v18
v_add_f32 v22, v22, v26
v_add_f32 v15, v15, v19
v_add_f32 v23, v23, v27
v_add_f32 v12, v12, v20
v_add_f32 v13, v13, v21
v_add_f32 v14, v14, v22
v_add_f32 v15, v15, v23
v_lshrrev_b32 v6, 4, v0
v_lshlrev_b32 v6, 4, v6
v_and_b32 v7, 15, v0
v_cmp_eq_u32 vcc, 0, v7
s_nop 0
s_and_saveexec_b64 s[34:35], vcc
buffer_store_dwordx4 v[12:15], v6, s[8:11], s50 offen
s_branch P_FIN
P_WO:
s_mov_b32 s4, s20
s_mov_b32 s5, s21
s_mov_b32 s6, 819200
s_mov_b32 s7, 0x00020000
s_sub_u32 s33, s3, 228
s_lshl_b32 s15, s33, 5
s_mul_i32 s34, s33, 13108
s_lshr_b32 s34, s34, 16
s_mul_i32 s35, s34, 5
s_sub_u32 s35, s33, s35
s_mul_i32 s34, s34, 100
s_add_u32 s34, s34, s35
v_lshlrev_b32 v6, 3, v5
s_mov_b32 s37, 1280
v_mul_lo_u32 v7, v4, s37
v_add_u32 v7, v6, v7
v_lshrrev_b32 v8, 2, v4
v_mul_u32_u24 v8, 20, v8
v_and_b32 v9, 3, v4
v_add_u32 v8, v8, v9
v_mul_lo_u32 v8, v8, s37
v_add_u32 v8, v6, v8
s_add_u32 s30, s14, 0
s_lshr_b32 s31, s30, 1
s_mul_i32 s31, s31, 80
s_and_b32 s32, s30, 1
s_mul_i32 s32, s32, 40
s_add_u32 s31, s31, s32
s_sub_u32 s36, s30, 16
s_mul_i32 s32, s36, 160
s_add_u32 s32, s32, 16
s_lshr_b32 s38, s30, 2
s_and_b32 s39, s30, 3
s_cmp_lt_u32 s30, 16
s_cselect_b32 s31, s31, s32
s_cselect_b32 s32, 20, 80
s_cselect_b32 s38, s38, s36
s_cselect_b32 s39, s39, 4
s_cselect_b64 s[52:53], -1, 0
s_add_u32 s32, s32, s31
s_mul_i32 s38, s38, 5
s_add_u32 s38, s38, s39
s_mul_i32 s38, s38, 5
s_add_u32 s38, s38, s34
s_lshl_b32 s38, s38, 10
s_add_u32 s40, s38, 2457600
v_cndmask_b32 v40, v8, v7, s[52:53]
s_mul_i32 s31, s31, 1280
s_mul_i32 s32, s32, 1280
s_add_u32 s31, s31, s15
s_add_u32 s32, s32, s15
buffer_load_dwordx2 v[16:17], v40, s[4:7], s31 offen
buffer_load_dwordx2 v[18:19], v40, s[4:7], s32 offen
s_add_u32 s30, s14, 1
s_lshr_b32 s31, s30, 1
s_mul_i32 s31, s31, 80
s_and_b32 s32, s30, 1
s_mul_i32 s32, s32, 40
s_add_u32 s31, s31, s32
s_sub_u32 s36, s30, 16
s_mul_i32 s32, s36, 160
s_add_u32 s32, s32, 16
s_lshr_b32 s38, s30, 2
s_and_b32 s39, s30, 3
s_cmp_lt_u32 s30, 16
s_cselect_b32 s31, s31, s32
s_cselect_b32 s32, 20, 80
s_cselect_b32 s38, s38, s36
s_cselect_b32 s39, s39, 4
s_cselect_b64 s[52:53], -1, 0
s_add_u32 s32, s32, s31
s_mul_i32 s38, s38, 5
s_add_u32 s38, s38, s39
s_mul_i32 s38, s38, 5
s_add_u32 s38, s38, s34
s_lshl_b32 s38, s38, 10
s_add_u32 s41, s38, 2457600
v_cndmask_b32 v41, v8, v7, s[52:53]
s_mul_i32 s31, s31, 1280
s_mul_i32 s32, s32, 1280
s_add_u32 s31, s31, s15
s_add_u32 s32, s32, s15
buffer_load_dwordx2 v[20:21], v41, s[4:7], s31 offen
buffer_load_dwordx2 v[22:23], v41, s[4:7], s32 offen
s_add_u32 s30, s14, 2
s_lshr_b32 s31, s30, 1
s_mul_i32 s31, s31, 80
s_and_b32 s32, s30, 1
s_mul_i32 s32, s32, 40
s_add_u32 s31, s31, s32
s_sub_u32 s36, s30, 16
s_mul_i32 s32, s36, 160
s_add_u32 s32, s32, 16
s_lshr_b32 s38, s30, 2
s_and_b32 s39, s30, 3
s_cmp_lt_u32 s30, 16
s_cselect_b32 s31, s31, s32
s_cselect_b32 s32, 20, 80
s_cselect_b32 s38, s38, s36
s_cselect_b32 s39, s39, 4
s_cselect_b64 s[52:53], -1, 0
s_add_u32 s32, s32, s31
s_mul_i32 s38, s38, 5
s_add_u32 s38, s38, s39
s_mul_i32 s38, s38, 5
s_add_u32 s38, s38, s34
s_lshl_b32 s38, s38, 10
s_add_u32 s42, s38, 2457600
v_cndmask_b32 v42, v8, v7, s[52:53]
s_mul_i32 s31, s31, 1280
s_mul_i32 s32, s32, 1280
s_add_u32 s31, s31, s15
s_add_u32 s32, s32, s15
buffer_load_dwordx2 v[24:25], v42, s[4:7], s31 offen
buffer_load_dwordx2 v[26:27], v42, s[4:7], s32 offen
s_add_u32 s30, s14, 3
s_lshr_b32 s31, s30, 1
s_mul_i32 s31, s31, 80
s_and_b32 s32, s30, 1
s_mul_i32 s32, s32, 40
s_add_u32 s31, s31, s32
s_sub_u32 s36, s30, 16
s_mul_i32 s32, s36, 160
s_add_u32 s32, s32, 16
s_lshr_b32 s38, s30, 2
s_and_b32 s39, s30, 3
s_cmp_lt_u32 s30, 16
s_cselect_b32 s31, s31, s32
s_cselect_b32 s32, 20, 80
s_cselect_b32 s38, s38, s36
s_cselect_b32 s39, s39, 4
s_cselect_b64 s[52:53], -1, 0
s_add_u32 s32, s32, s31
s_mul_i32 s38, s38, 5
s_add_u32 s38, s38, s39
s_mul_i32 s38, s38, 5
s_add_u32 s38, s38, s34
s_lshl_b32 s38, s38, 10
s_add_u32 s43, s38, 2457600
v_cndmask_b32 v43, v8, v7, s[52:53]
s_mul_i32 s31, s31, 1280
s_mul_i32 s32, s32, 1280
s_add_u32 s31, s31, s15
s_add_u32 s32, s32, s15
buffer_load_dwordx2 v[28:29], v43, s[4:7], s31 offen
buffer_load_dwordx2 v[30:31], v43, s[4:7], s32 offen
s_add_u32 s30, s14, 4
s_lshr_b32 s31, s30, 1
s_mul_i32 s31, s31, 80
s_and_b32 s32, s30, 1
s_mul_i32 s32, s32, 40
s_add_u32 s31, s31, s32
s_sub_u32 s36, s30, 16
s_mul_i32 s32, s36, 160
s_add_u32 s32, s32, 16
s_lshr_b32 s38, s30, 2
s_and_b32 s39, s30, 3
s_cmp_lt_u32 s30, 16
s_cselect_b32 s31, s31, s32
s_cselect_b32 s32, 20, 80
s_cselect_b32 s38, s38, s36
s_cselect_b32 s39, s39, 4
s_cselect_b64 s[52:53], -1, 0
s_add_u32 s32, s32, s31
s_mul_i32 s38, s38, 5
s_add_u32 s38, s38, s39
s_mul_i32 s38, s38, 5
s_add_u32 s38, s38, s34
s_lshl_b32 s38, s38, 10
s_add_u32 s44, s38, 2457600
v_cndmask_b32 v44, v8, v7, s[52:53]
s_mul_i32 s31, s31, 1280
s_mul_i32 s32, s32, 1280
s_add_u32 s31, s31, s15
s_add_u32 s32, s32, s15
buffer_load_dwordx2 v[32:33], v44, s[4:7], s31 offen
buffer_load_dwordx2 v[34:35], v44, s[4:7], s32 offen
s_waitcnt vmcnt(0)
ds_write_b64 v3, v[16:17] offset:0
ds_write_b64 v3, v[18:19] offset:512
ds_write_b64 v3, v[20:21] offset:1024
ds_write_b64 v3, v[22:23] offset:1536
ds_write_b64 v3, v[24:25] offset:2048
ds_write_b64 v3, v[26:27] offset:2560
ds_write_b64 v3, v[28:29] offset:3072
ds_write_b64 v3, v[30:31] offset:3584
ds_write_b64 v3, v[32:33] offset:4096
ds_write_b64 v3, v[34:35] offset:4608
s_waitcnt lgkmcnt(0)
ds_read_b64_tr_b16 v[16:17], v3 offset:0
ds_read_b64_tr_b16 v[18:19], v3 offset:512
ds_read_b64_tr_b16 v[20:21], v3 offset:1024
ds_read_b64_tr_b16 v[22:23], v3 offset:1536
ds_read_b64_tr_b16 v[24:25], v3 offset:2048
ds_read_b64_tr_b16 v[26:27], v3 offset:2560
ds_read_b64_tr_b16 v[28:29], v3 offset:3072
ds_read_b64_tr_b16 v[30:31], v3 offset:3584
ds_read_b64_tr_b16 v[32:33], v3 offset:4096
ds_read_b64_tr_b16 v[34:35], v3 offset:4608
s_waitcnt lgkmcnt(0)
buffer_store_dwordx4 v[16:19], v2, s[8:11], s40 offen
buffer_store_dwordx4 v[20:23], v2, s[8:11], s41 offen
buffer_store_dwordx4 v[24:27], v2, s[8:11], s42 offen
buffer_store_dwordx4 v[28:31], v2, s[8:11], s43 offen
buffer_store_dwordx4 v[32:35], v2, s[8:11], s44 offen
s_branch P_FIN
P_W2:
s_mov_b32 s4, s24
s_mov_b32 s5, s25
s_mov_b32 s6, 2211840
s_mov_b32 s7, 0x00020000
s_sub_u32 s33, s3, 268
s_mul_i32 s33, s33, 20
s_add_u32 s33, s33, s14
v_lshlrev_b32 v6, 3, v5
s_mov_b32 s37, 1280
v_mul_lo_u32 v7, v4, s37
v_add_u32 v6, v6, v7
s_add_u32 s30, s33, 0
s_mul_i32 s34, s30, 1214
s_lshr_b32 s34, s34, 16
s_mul_i32 s35, s34, 54
s_sub_u32 s35, s30, s35
s_lshl_b32 s15, s34, 5
s_mul_i32 s36, s34, 13108
s_lshr_b32 s36, s36, 16
s_mul_i32 s38, s36, 5
s_sub_u32 s38, s34, s38
s_mul_i32 s36, s36, 54
s_add_u32 s36, s36, s35
s_mul_i32 s36, s36, 5
s_add_u32 s36, s36, s38
s_lshl_b32 s36, s36, 10
s_add_u32 s40, s36, 5488640
s_lshl_b32 s31, s35, 5
s_add_u32 s32, s31, 16
s_mul_i32 s31, s31, 1280
s_mul_i32 s32, s32, 1280
s_add_u32 s31, s31, s15
s_add_u32 s32, s32, s15
buffer_load_dwordx2 v[16:17], v6, s[4:7], s31 offen
buffer_load_dwordx2 v[18:19], v6, s[4:7], s32 offen
s_add_u32 s30, s33, 1
s_mul_i32 s34, s30, 1214
s_lshr_b32 s34, s34, 16
s_mul_i32 s35, s34, 54
s_sub_u32 s35, s30, s35
s_lshl_b32 s15, s34, 5
s_mul_i32 s36, s34, 13108
s_lshr_b32 s36, s36, 16
s_mul_i32 s38, s36, 5
s_sub_u32 s38, s34, s38
s_mul_i32 s36, s36, 54
s_add_u32 s36, s36, s35
s_mul_i32 s36, s36, 5
s_add_u32 s36, s36, s38
s_lshl_b32 s36, s36, 10
s_add_u32 s41, s36, 5488640
s_lshl_b32 s31, s35, 5
s_add_u32 s32, s31, 16
s_mul_i32 s31, s31, 1280
s_mul_i32 s32, s32, 1280
s_add_u32 s31, s31, s15
s_add_u32 s32, s32, s15
buffer_load_dwordx2 v[20:21], v6, s[4:7], s31 offen
buffer_load_dwordx2 v[22:23], v6, s[4:7], s32 offen
s_add_u32 s30, s33, 2
s_mul_i32 s34, s30, 1214
s_lshr_b32 s34, s34, 16
s_mul_i32 s35, s34, 54
s_sub_u32 s35, s30, s35
s_lshl_b32 s15, s34, 5
s_mul_i32 s36, s34, 13108
s_lshr_b32 s36, s36, 16
s_mul_i32 s38, s36, 5
s_sub_u32 s38, s34, s38
s_mul_i32 s36, s36, 54
s_add_u32 s36, s36, s35
s_mul_i32 s36, s36, 5
s_add_u32 s36, s36, s38
s_lshl_b32 s36, s36, 10
s_add_u32 s42, s36, 5488640
s_lshl_b32 s31, s35, 5
s_add_u32 s32, s31, 16
s_mul_i32 s31, s31, 1280
s_mul_i32 s32, s32, 1280
s_add_u32 s31, s31, s15
s_add_u32 s32, s32, s15
buffer_load_dwordx2 v[24:25], v6, s[4:7], s31 offen
buffer_load_dwordx2 v[26:27], v6, s[4:7], s32 offen
s_add_u32 s30, s33, 3
s_mul_i32 s34, s30, 1214
s_lshr_b32 s34, s34, 16
s_mul_i32 s35, s34, 54
s_sub_u32 s35, s30, s35
s_lshl_b32 s15, s34, 5
s_mul_i32 s36, s34, 13108
s_lshr_b32 s36, s36, 16
s_mul_i32 s38, s36, 5
s_sub_u32 s38, s34, s38
s_mul_i32 s36, s36, 54
s_add_u32 s36, s36, s35
s_mul_i32 s36, s36, 5
s_add_u32 s36, s36, s38
s_lshl_b32 s36, s36, 10
s_add_u32 s43, s36, 5488640
s_lshl_b32 s31, s35, 5
s_add_u32 s32, s31, 16
s_mul_i32 s31, s31, 1280
s_mul_i32 s32, s32, 1280
s_add_u32 s31, s31, s15
s_add_u32 s32, s32, s15
buffer_load_dwordx2 v[28:29], v6, s[4:7], s31 offen
buffer_load_dwordx2 v[30:31], v6, s[4:7], s32 offen
s_add_u32 s30, s33, 4
s_mul_i32 s34, s30, 1214
s_lshr_b32 s34, s34, 16
s_mul_i32 s35, s34, 54
s_sub_u32 s35, s30, s35
s_lshl_b32 s15, s34, 5
s_mul_i32 s36, s34, 13108
s_lshr_b32 s36, s36, 16
s_mul_i32 s38, s36, 5
s_sub_u32 s38, s34, s38
s_mul_i32 s36, s36, 54
s_add_u32 s36, s36, s35
s_mul_i32 s36, s36, 5
s_add_u32 s36, s36, s38
s_lshl_b32 s36, s36, 10
s_add_u32 s44, s36, 5488640
s_lshl_b32 s31, s35, 5
s_add_u32 s32, s31, 16
s_mul_i32 s31, s31, 1280
s_mul_i32 s32, s32, 1280
s_add_u32 s31, s31, s15
s_add_u32 s32, s32, s15
buffer_load_dwordx2 v[32:33], v6, s[4:7], s31 offen
buffer_load_dwordx2 v[34:35], v6, s[4:7], s32 offen
s_waitcnt vmcnt(0)
ds_write_b64 v3, v[16:17] offset:0
ds_write_b64 v3, v[18:19] offset:512
ds_write_b64 v3, v[20:21] offset:1024
ds_write_b64 v3, v[22:23] offset:1536
ds_write_b64 v3, v[24:25] offset:2048
ds_write_b64 v3, v[26:27] offset:2560
ds_write_b64 v3, v[28:29] offset:3072
ds_write_b64 v3, v[30:31] offset:3584
ds_write_b64 v3, v[32:33] offset:4096
ds_write_b64 v3, v[34:35] offset:4608
s_waitcnt lgkmcnt(0)
ds_read_b64_tr_b16 v[16:17], v3 offset:0
ds_read_b64_tr_b16 v[18:19], v3 offset:512
ds_read_b64_tr_b16 v[20:21], v3 offset:1024
ds_read_b64_tr_b16 v[22:23], v3 offset:1536
ds_read_b64_tr_b16 v[24:25], v3 offset:2048
ds_read_b64_tr_b16 v[26:27], v3 offset:2560
ds_read_b64_tr_b16 v[28:29], v3 offset:3072
ds_read_b64_tr_b16 v[30:31], v3 offset:3584
ds_read_b64_tr_b16 v[32:33], v3 offset:4096
ds_read_b64_tr_b16 v[34:35], v3 offset:4608
s_waitcnt lgkmcnt(0)
buffer_store_dwordx4 v[16:19], v2, s[8:11], s40 offen
buffer_store_dwordx4 v[20:23], v2, s[8:11], s41 offen
buffer_store_dwordx4 v[24:27], v2, s[8:11], s42 offen
buffer_store_dwordx4 v[28:31], v2, s[8:11], s43 offen
buffer_store_dwordx4 v[32:35], v2, s[8:11], s44 offen
s_branch P_FIN
P_X:
s_mov_b32 s4, s16
s_mov_b32 s5, s17
s_mov_b32 s6, 2621440
s_mov_b32 s7, 0x00020000
s_sub_u32 s33, s3, 376
v_and_b32 v7, 15, v0
v_mul_u32_u24 v6, 0x500, v7
v_lshrrev_b32 v8, 4, v0
v_lshlrev_b32 v8, 3, v8
v_add_u32 v6, v6, v8
s_mul_i32 s34, s33, 20480
s_add_u32 s30, s14, 0
s_lshr_b32 s31, s30, 1
s_mul_i32 s31, s31, 80
s_and_b32 s32, s30, 1
s_lshl_b32 s32, s32, 5
s_add_u32 s31, s31, s32
s_sub_u32 s32, s30, 16
s_mul_i32 s32, s32, 160
s_add_u32 s32, s32, 64
s_cmp_lt_u32 s30, 16
s_cselect_b32 s31, s31, s32
s_cselect_b32 s32, 16, 80
s_add_u32 s32, s32, s31
s_lshl_b32 s31, s31, 1
s_lshl_b32 s32, s32, 1
s_add_u32 s31, s31, s34
s_add_u32 s32, s32, s34
s_mul_i32 s40, s33, 20
s_add_u32 s40, s40, s30
s_lshl_b32 s40, s40, 10
s_add_u32 s40, s40, 7725056
s_cmp_lt_u32 s30, 16
s_cselect_b32 s45, 8, 512
buffer_load_dwordx2 v[16:17], v6, s[4:7], s31 offen
buffer_load_dwordx2 v[18:19], v6, s[4:7], s32 offen
s_add_u32 s30, s14, 1
s_lshr_b32 s31, s30, 1
s_mul_i32 s31, s31, 80
s_and_b32 s32, s30, 1
s_lshl_b32 s32, s32, 5
s_add_u32 s31, s31, s32
s_sub_u32 s32, s30, 16
s_mul_i32 s32, s32, 160
s_add_u32 s32, s32, 64
s_cmp_lt_u32 s30, 16
s_cselect_b32 s31, s31, s32
s_cselect_b32 s32, 16, 80
s_add_u32 s32, s32, s31
s_lshl_b32 s31, s31, 1
s_lshl_b32 s32, s32, 1
s_add_u32 s31, s31, s34
s_add_u32 s32, s32, s34
s_mul_i32 s41, s33, 20
s_add_u32 s41, s41, s30
s_lshl_b32 s41, s41, 10
s_add_u32 s41, s41, 7725056
s_cmp_lt_u32 s30, 16
s_cselect_b32 s46, 8, 512
buffer_load_dwordx2 v[20:21], v6, s[4:7], s31 offen
buffer_load_dwordx2 v[22:23], v6, s[4:7], s32 offen
s_add_u32 s30, s14, 2
s_lshr_b32 s31, s30, 1
s_mul_i32 s31, s31, 80
s_and_b32 s32, s30, 1
s_lshl_b32 s32, s32, 5
s_add_u32 s31, s31, s32
s_sub_u32 s32, s30, 16
s_mul_i32 s32, s32, 160
s_add_u32 s32, s32, 64
s_cmp_lt_u32 s30, 16
s_cselect_b32 s31, s31, s32
s_cselect_b32 s32, 16, 80
s_add_u32 s32, s32, s31
s_lshl_b32 s31, s31, 1
s_lshl_b32 s32, s32, 1
s_add_u32 s31, s31, s34
s_add_u32 s32, s32, s34
s_mul_i32 s42, s33, 20
s_add_u32 s42, s42, s30
s_lshl_b32 s42, s42, 10
s_add_u32 s42, s42, 7725056
s_cmp_lt_u32 s30, 16
s_cselect_b32 s47, 8, 512
buffer_load_dwordx2 v[24:25], v6, s[4:7], s31 offen
buffer_load_dwordx2 v[26:27], v6, s[4:7], s32 offen
s_add_u32 s30, s14, 3
s_lshr_b32 s31, s30, 1
s_mul_i32 s31, s31, 80
s_and_b32 s32, s30, 1
s_lshl_b32 s32, s32, 5
s_add_u32 s31, s31, s32
s_sub_u32 s32, s30, 16
s_mul_i32 s32, s32, 160
s_add_u32 s32, s32, 64
s_cmp_lt_u32 s30, 16
s_cselect_b32 s31, s31, s32
s_cselect_b32 s32, 16, 80
s_add_u32 s32, s32, s31
s_lshl_b32 s31, s31, 1
s_lshl_b32 s32, s32, 1
s_add_u32 s31, s31, s34
s_add_u32 s32, s32, s34
s_mul_i32 s43, s33, 20
s_add_u32 s43, s43, s30
s_lshl_b32 s43, s43, 10
s_add_u32 s43, s43, 7725056
s_cmp_lt_u32 s30, 16
s_cselect_b32 s48, 8, 512
buffer_load_dwordx2 v[28:29], v6, s[4:7], s31 offen
buffer_load_dwordx2 v[30:31], v6, s[4:7], s32 offen
s_add_u32 s30, s14, 4
s_lshr_b32 s31, s30, 1
s_mul_i32 s31, s31, 80
s_and_b32 s32, s30, 1
s_lshl_b32 s32, s32, 5
s_add_u32 s31, s31, s32
s_sub_u32 s32, s30, 16
s_mul_i32 s32, s32, 160
s_add_u32 s32, s32, 64
s_cmp_lt_u32 s30, 16
s_cselect_b32 s31, s31, s32
s_cselect_b32 s32, 16, 80
s_add_u32 s32, s32, s31
s_lshl_b32 s31, s31, 1
s_lshl_b32 s32, s32, 1
s_add_u32 s31, s31, s34
s_add_u32 s32, s32, s34
s_mul_i32 s44, s33, 20
s_add_u32 s44, s44, s30
s_lshl_b32 s44, s44, 10
s_add_u32 s44, s44, 7725056
s_cmp_lt_u32 s30, 16
s_cselect_b32 s49, 8, 512
buffer_load_dwordx2 v[32:33], v6, s[4:7], s31 offen
buffer_load_dwordx2 v[34:35], v6, s[4:7], s32 offen
s_waitcnt vmcnt(0)
v_lshlrev_b32 v9, 3, v0
s_cmp_eq_u32 s45, 8
s_cselect_b64 s[52:53], -1, 0
v_cndmask_b32 v10, v9, v2, s[52:53]
v_add_u32 v11, s45, v10
buffer_store_dwordx2 v[16:17], v10, s[8:11], s40 offen
buffer_store_dwordx2 v[18:19], v11, s[8:11], s40 offen
s_cmp_eq_u32 s46, 8
s_cselect_b64 s[52:53], -1, 0
v_cndmask_b32 v10, v9, v2, s[52:53]
v_add_u32 v11, s46, v10
buffer_store_dwordx2 v[20:21], v10, s[8:11], s41 offen
buffer_store_dwordx2 v[22:23], v11, s[8:11], s41 offen
s_cmp_eq_u32 s47, 8
s_cselect_b64 s[52:53], -1, 0
v_cndmask_b32 v10, v9, v2, s[52:53]
v_add_u32 v11, s47, v10
buffer_store_dwordx2 v[24:25], v10, s[8:11], s42 offen
buffer_store_dwordx2 v[26:27], v11, s[8:11], s42 offen
s_cmp_eq_u32 s48, 8
s_cselect_b64 s[52:53], -1, 0
v_cndmask_b32 v10, v9, v2, s[52:53]
v_add_u32 v11, s48, v10
buffer_store_dwordx2 v[28:29], v10, s[8:11], s43 offen
buffer_store_dwordx2 v[30:31], v11, s[8:11], s43 offen
s_cmp_eq_u32 s49, 8
s_cselect_b64 s[52:53], -1, 0
v_cndmask_b32 v10, v9, v2, s[52:53]
v_add_u32 v11, s49, v10
buffer_store_dwordx2 v[32:33], v10, s[8:11], s44 offen
buffer_store_dwordx2 v[34:35], v11, s[8:11], s44 offen
v_mov_b32 v12, 0
v_mov_b32 v13, 0
v_mov_b32 v14, 0
v_mov_b32 v15, 0
v_mov_b32 v8, 0x3f803f80
v_dot2_f32_bf16 v12, v16, v8, v12
s_nop 2
v_dot2_f32_bf16 v13, v16, v16, v13
s_nop 2
v_dot2_f32_bf16 v12, v17, v8, v12
s_nop 2
v_dot2_f32_bf16 v13, v17, v17, v13
s_nop 2
v_dot2_f32_bf16 v12, v18, v8, v12
s_nop 2
v_dot2_f32_bf16 v13, v18, v18, v13
s_nop 2
v_dot2_f32_bf16 v12, v19, v8, v12
s_nop 2
v_dot2_f32_bf16 v13, v19, v19, v13
s_nop 2
v_dot2_f32_bf16 v12, v20, v8, v12
s_nop 2
v_dot2_f32_bf16 v13, v20, v20, v13
s_nop 2
v_dot2_f32_bf16 v12, v21, v8, v12
s_nop 2
v_dot2_f32_bf16 v13, v21, v21, v13
s_nop 2
v_dot2_f32_bf16 v12, v22, v8, v12
s_nop 2
v_dot2_f32_bf16 v13, v22, v22, v13
s_nop 2
v_dot2_f32_bf16 v12, v23, v8, v12
s_nop 2
v_dot2_f32_bf16 v13, v23, v23, v13
s_nop 2
v_dot2_f32_bf16 v12, v24, v8, v12
s_nop 2
v_dot2_f32_bf16 v13, v24, v24, v13
s_nop 2
v_dot2_f32_bf16 v12, v25, v8, v12
s_nop 2
v_dot2_f32_bf16 v13, v25, v25, v13
s_nop 2
v_dot2_f32_bf16 v12, v26, v8, v12
s_nop 2
v_dot2_f32_bf16 v13, v26, v26, v13
s_nop 2
v_dot2_f32_bf16 v12, v27, v8, v12
s_nop 2
v_dot2_f32_bf16 v13, v27, v27, v13
s_nop 2
v_dot2_f32_bf16 v12, v28, v8, v12
s_nop 2
v_dot2_f32_bf16 v13, v28, v28, v13
s_nop 2
v_dot2_f32_bf16 v12, v29, v8, v12
s_nop 2
v_dot2_f32_bf16 v13, v29, v29, v13
s_nop 2
v_dot2_f32_bf16 v12, v30, v8, v12
s_nop 2
v_dot2_f32_bf16 v13, v30, v30, v13
s_nop 2
v_dot2_f32_bf16 v12, v31, v8, v12
s_nop 2
v_dot2_f32_bf16 v13, v31, v31, v13
s_nop 2
v_dot2_f32_bf16 v12, v32, v8, v12
s_nop 2
v_dot2_f32_bf16 v13, v32, v32, v13
s_nop 2
v_dot2_f32_bf16 v12, v33, v8, v12
s_nop 2
v_dot2_f32_bf16 v13, v33, v33, v13
s_nop 2
v_dot2_f32_bf16 v12, v34, v8, v12
s_nop 2
v_dot2_f32_bf16 v13, v34, v34, v13
s_nop 2
v_dot2_f32_bf16 v12, v35, v8, v12
s_nop 2
v_dot2_f32_bf16 v13, v35, v35, v13
s_nop 2
v_mov_b32 v36, v12
v_mov_b32 v37, v13
s_nop 1
v_permlane32_swap_b32 v12, v36
v_permlane32_swap_b32 v13, v37
s_nop 1
v_add_f32 v12, v12, v36
v_add_f32 v13, v13, v37
v_mov_b32 v36, v12
v_mov_b32 v37, v13
s_nop 1
v_permlane16_swap_b32 v12, v36
v_permlane16_swap_b32 v13, v37
s_nop 1
v_add_f32 v12, v12, v36
v_add_f32 v13, v13, v37
s_lshr_b32 s34, s33, 2
s_lshl_b32 s34, s34, 3
s_lshl_b32 s35, s12, 1
s_add_u32 s34, s34, s35
s_lshl_b32 s34, s34, 9
s_and_b32 s35, s33, 3
s_lshl_b32 s35, s35, 7
s_add_u32 s34, s34, s35
s_add_u32 s34, s34, 12967936
v_mov_b32 v14, 0
v_mov_b32 v15, 0
v_cmp_gt_u32 vcc, 16, v0
s_nop 0
s_and_saveexec_b64 s[36:37], vcc
buffer_store_dwordx2 v[12:13], v9, s[8:11], s34 offen
buffer_store_dwordx2 v[14:15], v9, s[8:11], s34 offen offset:512
s_mov_b64 exec, s[36:37]
s_cmp_lt_u32 s33, 40
s_cbranch_scc0 P_FIN
s_cmp_eq_u32 s12, 0
s_cbranch_scc0 P_FIN
s_lshl_b32 s34, s33, 7
s_add_u32 s34, s34, 7716864
v_lshlrev_b32 v9, 2, v0
v_cmp_gt_u32 vcc, 32, v0
s_nop 0
s_and_saveexec_b64 s[36:37], vcc
buffer_store_dword v14, v9, s[8:11], s34 offen
P_FIN:
s_waitcnt vmcnt(0)
P_END:
s_endpgm
.globl interleave_layers__sliding_block__dense_activation_squared_relu__prompt_kernel
.p2align 8
.type interleave_layers__sliding_block__dense_activation_squared_relu__prompt_kernel,@function
interleave_layers__sliding_block__dense_activation_squared_relu__prompt_kernel:
s_cmp_ge_u32 s2, 256
s_cbranch_scc1 M_END
s_load_dwordx2 s[24:25], s[0:1], 40
s_load_dwordx2 s[26:27], s[0:1], 56
s_load_dwordx2 s[28:29], s[0:1], 64
s_load_dwordx2 s[30:31], s[0:1], 80
v_lshrrev_b32 v1, 6, v0
v_and_b32 v0, 63, v0
s_nop 0
v_readfirstlane_b32 s22, v1
v_lshlrev_b32 v1, 4, v0
v_lshlrev_b32 v2, 3, v0
s_and_b32 s20, s2, 7
s_lshl_b32 s20, s20, 2
s_lshr_b32 s21, s2, 6
s_add_u32 s20, s20, s21
s_lshr_b32 s21, s2, 3
s_and_b32 s21, s21, 7
s_waitcnt lgkmcnt(0)
s_mov_b32 s4, s30
s_mov_b32 s5, s31
s_mov_b32 s6, 34201600
s_mov_b32 s7, 0x00020000
s_mov_b32 s8, s28
s_mov_b32 s9, s29
s_mov_b32 s10, 2621440
s_mov_b32 s11, 0x00020000
s_mov_b32 s12, s24
s_mov_b32 s13, s25
s_mov_b32 s14, 3456
s_mov_b32 s15, 0x00020000
s_mov_b32 s16, s26
s_mov_b32 s17, s27
s_mov_b32 s18, 1280
s_mov_b32 s19, 0x00020000
s_mov_b32 s72, 0
s_getreg_b32 s73, hwreg(HW_REG_XCC_ID, 0, 4)
s_add_u32 s73, s73, 1
s_lshl_b32 s24, s20, 5
s_lshl_b32 s25, s21, 2
s_add_u32 s24, s24, s25
s_add_u32 s24, s24, 7720960
v_mov_b32 v3, s73
s_mov_b64 exec, 1
buffer_store_dword v3, off, s[4:7], s24 sc1
s_mov_b64 exec, -1
s_lshl_b32 s24, s20, 7
s_add_u32 s24, s24, 7716864
s_lshl_b32 s25, s21, 4
s_lshl_b32 s26, s22, 2
s_add_u32 s25, s25, s26
s_add_u32 s23, s24, s25
v_and_b32 v236, 31, v0
v_lshlrev_b32 v236, 2, v236
v_add_u32 v236, s24, v236
v_lshrrev_b32 v3, 2, v0
v_cmp_gt_u32 vcc, 20, v0
s_nop 1
v_cndmask_b32 v3, 0, v3, vcc
v_sub_u32 v237, s20, v3
v_cmp_gt_i32 vcc, 0, v237
v_mov_b32 v3, s20
s_nop 0
v_cndmask_b32 v237, v237, v3, vcc
v_lshlrev_b32 v237, 7, v237
v_and_b32 v3, 3, v0
v_lshlrev_b32 v3, 2, v3
v_add_u32 v237, v237, v3
s_lshl_b32 s25, s21, 4
s_add_u32 s25, s25, 7716864
v_add_u32 v237, s25, v237
v_add_u32 v238, 61440, v1
v_add_u32 v239, 61440, v2
v_lshrrev_b32 v240, 4, v0
v_and_b32 v241, 15, v0
s_mul_i32 s60, s20, 8
s_add_u32 s60, s60, s21
s_mov_b32 s68, s21
s_lshl_b32 s61, s20, 2
s_add_u32 s62, s61, s22
s_mul_i32 s24, s62, 20480
s_add_u32 s24, s24, 7725056
s_lshl_b32 s25, s21, 11
s_add_u32 s25, s25, s24
s_lshr_b32 s26, s21, 1
s_lshl_b32 s26, s26, 10
s_and_b32 s27, s21, 1
s_lshl_b32 s27, s27, 9
s_add_u32 s26, s26, s27
s_add_u32 s26, s26, 16384
s_add_u32 s26, s26, s24
s_getpc_b64 s[34:35]
LPC1:
s_lshr_b32 s36, s2, 3
s_lshl_b32 s36, s36, 2
s_add_u32 s36, s36, s22
s_lshl_b32 s36, s36, 10
s_min_u32 s36, s36, M_END-LPC1-1024
s_add_u32 s34, s34, s36
s_addc_u32 s35, s35, 0
v_mov_b32 v37, s35
v_add_co_u32 v36, vcc, s34, v1
v_addc_co_u32 v37, vcc, 0, v37, vcc
global_load_dwordx4 v[40:43], v[36:37], off
v_lshlrev_b32 v44, 19, v0
s_mov_b64 exec, 31
buffer_load_dword v45, v44, s[8:11], 0 offen
s_mov_b64 exec, 1
buffer_load_dword v45, off, s[12:15], 0
buffer_load_dword v45, off, s[16:19], 0
s_mov_b64 exec, -1
buffer_load_dwordx4 v[24:27], v1, s[4:7], s25 offen
buffer_load_dwordx4 v[28:31], v1, s[4:7], s25 offen offset:1024
buffer_load_dwordx2 v[32:33], v2, s[4:7], s26 offen
s_waitcnt vmcnt(0)
v_lshlrev_b32 v4, 16, v24
v_and_b32 v5, 0xffff0000, v24
v_lshlrev_b32 v6, 16, v25
v_and_b32 v7, 0xffff0000, v25
v_lshlrev_b32 v8, 16, v26
v_and_b32 v9, 0xffff0000, v26
v_lshlrev_b32 v10, 16, v27
v_and_b32 v11, 0xffff0000, v27
v_lshlrev_b32 v12, 16, v28
v_and_b32 v13, 0xffff0000, v28
v_lshlrev_b32 v14, 16, v29
v_and_b32 v15, 0xffff0000, v29
v_lshlrev_b32 v16, 16, v30
v_and_b32 v17, 0xffff0000, v30
v_lshlrev_b32 v18, 16, v31
v_and_b32 v19, 0xffff0000, v31
v_lshlrev_b32 v20, 16, v32
v_and_b32 v21, 0xffff0000, v32
v_lshlrev_b32 v22, 16, v33
v_and_b32 v23, 0xffff0000, v33
s_mul_i32 s24, s68, 307200
s_add_u32 s24, s24, 0
s_mul_i32 s25, s22, 20480
s_add_u32 s40, s24, s25
s_add_u32 s41, s40, 81920
s_add_u32 s42, s40, 163840
s_add_u32 s43, s40, 245760
s_cmp_eq_u32 s22, 0
s_cbranch_scc1 FK3
s_cmp_eq_u32 s22, 1
s_cbranch_scc1 FK4
s_cmp_eq_u32 s22, 2
s_cbranch_scc1 FK5
s_branch FK6
FK3:
s_mul_i32 s24, s21, 960
s_lshl_b32 s25, s22, 6
s_add_u32 s24, s24, s25
s_add_u32 s24, s24, 7700480
v_lshlrev_b32 v3, 4, v240
v_lshlrev_b32 v192, 2, v241
buffer_load_dwordx4 v[176:179], v3, s[4:7], s24 offen
buffer_load_dwordx4 v[180:183], v3, s[4:7], s24 offen offset:512
buffer_load_dword v188, v192, s[4:7], s24 offen offset:256
buffer_load_dwordx4 v[184:187], v3, s[4:7], s24 offen offset:768
s_lshl_b32 s26, s60, 9
s_and_b32 s26, s26, 0xfffff000
s_lshl_b32 s27, s22, 7
s_add_u32 s26, s26, s27
s_add_u32 s26, s26, 12967936
v_lshrrev_b32 v24, 3, v0
v_lshlrev_b32 v24, 9, v24
v_and_b32 v25, 7, v0
v_lshlrev_b32 v25, 4, v25
v_add_u32 v24, v24, v25
buffer_load_dwordx4 v[28:31], v24, s[4:7], s26 offen
s_mul_i32 s69, s62, 20480
s_add_u32 s69, s69, 7725056
s_mul_i32 s70, s22, 20480
s_mov_b32 m0, s70
s_nop 0
buffer_load_dwordx4 v1, s[4:7], s69 offen offset:0 sc1 lds
buffer_load_dwordx4 a[0:3], v1, s[4:7], s40 offen
buffer_load_dwordx4 a[4:7], v1, s[4:7], s41 offen
s_mov_b32 m0, s70
s_nop 0
buffer_load_dwordx4 v1, s[4:7], s69 offen offset:1024 sc1 lds
buffer_load_dwordx4 a[8:11], v1, s[4:7], s43 offen
buffer_load_dwordx4 a[12:15], v1, s[4:7], s40 offen offset:1024
s_mov_b32 m0, s70
s_nop 0
buffer_load_dwordx4 v1, s[4:7], s69 offen offset:2048 sc1 lds
buffer_load_dwordx4 a[16:19], v1, s[4:7], s41 offen offset:1024
buffer_load_dwordx4 a[20:23], v1, s[4:7], s43 offen offset:1024
s_mov_b32 m0, s70
s_nop 0
buffer_load_dwordx4 v1, s[4:7], s69 offen offset:3072 sc1 lds
buffer_load_dwordx4 a[24:27], v1, s[4:7], s40 offen offset:2048
buffer_load_dwordx4 a[28:31], v1, s[4:7], s41 offen offset:2048
s_add_u32 s69, s69, 4096
s_add_u32 s70, s70, 4096
s_mov_b32 m0, s70
s_nop 0
buffer_load_dwordx4 v1, s[4:7], s69 offen offset:0 sc1 lds
buffer_load_dwordx4 a[32:35], v1, s[4:7], s43 offen offset:2048
buffer_load_dwordx4 a[36:39], v1, s[4:7], s40 offen offset:3072
s_mov_b32 m0, s70
s_nop 0
buffer_load_dwordx4 v1, s[4:7], s69 offen offset:1024 sc1 lds
buffer_load_dwordx4 a[40:43], v1, s[4:7], s41 offen offset:3072
buffer_load_dwordx4 a[44:47], v1, s[4:7], s43 offen offset:3072
s_mov_b32 m0, s70
s_nop 0
buffer_load_dwordx4 v1, s[4:7], s69 offen offset:2048 sc1 lds
s_add_u32 s40, s40, 4096
buffer_load_dwordx4 a[48:51], v1, s[4:7], s40 offen
s_add_u32 s41, s41, 4096
buffer_load_dwordx4 a[52:55], v1, s[4:7], s41 offen
s_mov_b32 m0, s70
s_nop 0
buffer_load_dwordx4 v1, s[4:7], s69 offen offset:3072 sc1 lds
s_add_u32 s43, s43, 4096
buffer_load_dwordx4 a[56:59], v1, s[4:7], s43 offen
buffer_load_dwordx4 a[60:63], v1, s[4:7], s40 offen offset:1024
s_add_u32 s69, s69, 4096
s_add_u32 s70, s70, 4096
s_mov_b32 m0, s70
s_nop 0
buffer_load_dwordx4 v1, s[4:7], s69 offen offset:0 sc1 lds
buffer_load_dwordx4 a[64:67], v1, s[4:7], s41 offen offset:1024
buffer_load_dwordx4 a[68:71], v1, s[4:7], s43 offen offset:1024
s_mov_b32 m0, s70
s_nop 0
buffer_load_dwordx4 v1, s[4:7], s69 offen offset:1024 sc1 lds
buffer_load_dwordx4 a[72:75], v1, s[4:7], s40 offen offset:2048
buffer_load_dwordx4 a[76:79], v1, s[4:7], s41 offen offset:2048
s_waitcnt vmcnt(30)
v_mov_b32 v32, v28
v_mov_b32 v33, v29
v_mov_b32 v34, v30
v_mov_b32 v35, v31
v_permlane32_swap_b32 v28, v32
v_permlane32_swap_b32 v29, v33
v_permlane32_swap_b32 v30, v34
v_permlane32_swap_b32 v31, v35
v_add_f32 v28, v28, v32
v_add_f32 v29, v29, v33
v_add_f32 v30, v30, v34
v_add_f32 v31, v31, v35
v_mov_b32 v32, v28
v_mov_b32 v33, v29
v_mov_b32 v34, v30
v_mov_b32 v35, v31
v_permlane16_swap_b32 v28, v32
v_permlane16_swap_b32 v29, v33
v_permlane16_swap_b32 v30, v34
v_permlane16_swap_b32 v31, v35
v_add_f32 v28, v28, v32
v_add_f32 v29, v29, v33
v_add_f32 v30, v30, v34
v_add_f32 v31, v31, v35
v_add_f32_dpp v28, v28, v28 row_ror:8 row_mask:0xf bank_mask:0xf
v_add_f32_dpp v29, v29, v29 row_ror:8 row_mask:0xf bank_mask:0xf
v_add_f32_dpp v30, v30, v30 row_ror:8 row_mask:0xf bank_mask:0xf
v_add_f32_dpp v31, v31, v31 row_ror:8 row_mask:0xf bank_mask:0xf
s_mov_b32 s26, 0xbacccccd
s_mov_b32 s27, 0x3acccccd
v_mul_f32 v32, s26, v28
v_mul_f32 v33, s26, v30
v_mul_f32 v34, s27, v29
v_mul_f32 v35, s27, v31
v_fma_f32 v34, -v32, v32, v34
v_fma_f32 v35, -v33, v33, v35
v_max_f32 v34, 0, v34
v_max_f32 v35, 0, v35
v_add_f32 v34, 0x3727c5ac, v34
v_add_f32 v35, 0x3727c5ac, v35
v_rsq_f32 v34, v34
v_rsq_f32 v35, v35
v_and_b32 v24, 7, v0
v_lshlrev_b32 v24, 3, v24
s_lshl_b32 s26, s22, 6
s_add_u32 s26, s26, 102400
v_add_u32 v24, s26, v24
s_mov_b64 exec, 0xff
ds_write_b64 v24, v[32:33]
ds_write_b64 v24, v[34:35] offset:256
s_mov_b64 exec, -1
s_waitcnt vmcnt(17)
s_waitcnt lgkmcnt(0)
s_barrier
ds_read_b128 v[24:27], v1 offset:0
ds_read_b128 v[28:31], v1 offset:20480
ds_read_b128 v[32:35], v1 offset:40960
ds_read_b128 v[36:39], v238 offset:0
s_waitcnt lgkmcnt(3)
v_mfma_f32_16x16x32_bf16 v[56:59], a[0:3], v[24:27], 0
ds_read_b128 v[40:43], v1 offset:1024
s_waitcnt lgkmcnt(3)
v_mfma_f32_16x16x32_bf16 v[60:63], a[0:3], v[28:31], 0
ds_read_b128 v[44:47], v1 offset:21504
s_waitcnt lgkmcnt(3)
v_mfma_f32_16x16x32_bf16 v[64:67], a[0:3], v[32:35], 0
ds_read_b128 v[48:51], v1 offset:41984
s_waitcnt lgkmcnt(3)
v_mfma_f32_16x16x32_bf16 v[68:71], a[0:3], v[36:39], 0
ds_read_b128 v[52:55], v238 offset:1024
v_mfma_f32_16x16x32_bf16 v[72:75], v[24:27], a[4:7], 0
s_mov_b32 m0, s70
s_nop 0
buffer_load_dwordx4 v1, s[4:7], s69 offen offset:2048 sc1 lds
v_mfma_f32_16x16x32_bf16 v[76:79], v[28:31], a[4:7], 0
buffer_load_dwordx4 a[80:83], v1, s[4:7], s43 offen offset:2048
v_mfma_f32_16x16x32_bf16 v[80:83], v[32:35], a[4:7], 0
buffer_load_dwordx4 a[84:87], v1, s[4:7], s40 offen offset:3072
v_mfma_f32_16x16x32_bf16 v[84:87], v[36:39], a[4:7], 0
buffer_load_dwordx4 a[88:91], v1, s[4:7], s41 offen offset:3072
v_mfma_f32_16x16x32_bf16 v[88:91], a[8:11], v[24:27], 0
v_mfma_f32_16x16x32_bf16 v[92:95], a[8:11], v[28:31], 0
v_mfma_f32_16x16x32_bf16 v[96:99], a[8:11], v[32:35], 0
v_mfma_f32_16x16x32_bf16 v[100:103], a[8:11], v[36:39], 0
s_waitcnt lgkmcnt(3)
v_mfma_f32_16x16x32_bf16 v[56:59], a[12:15], v[40:43], v[56:59]
ds_read_b128 v[24:27], v1 offset:2048
s_waitcnt lgkmcnt(3)
v_mfma_f32_16x16x32_bf16 v[60:63], a[12:15], v[44:47], v[60:63]
ds_read_b128 v[28:31], v1 offset:22528
s_waitcnt lgkmcnt(3)
v_mfma_f32_16x16x32_bf16 v[64:67], a[12:15], v[48:51], v[64:67]
ds_read_b128 v[32:35], v1 offset:43008
s_waitcnt lgkmcnt(3)
v_mfma_f32_16x16x32_bf16 v[68:71], a[12:15], v[52:55], v[68:71]
ds_read_b128 v[36:39], v238 offset:2048
v_mfma_f32_16x16x32_bf16 v[72:75], v[40:43], a[16:19], v[72:75]
s_mov_b32 m0, s70
s_nop 0
buffer_load_dwordx4 v1, s[4:7], s69 offen offset:3072 sc1 lds
v_mfma_f32_16x16x32_bf16 v[76:79], v[44:47], a[16:19], v[76:79]
buffer_load_dwordx4 a[92:95], v1, s[4:7], s43 offen offset:3072
v_mfma_f32_16x16x32_bf16 v[80:83], v[48:51], a[16:19], v[80:83]
s_add_u32 s40, s40, 4096
buffer_load_dwordx4 a[96:99], v1, s[4:7], s40 offen
v_mfma_f32_16x16x32_bf16 v[84:87], v[52:55], a[16:19], v[84:87]
s_add_u32 s41, s41, 4096
buffer_load_dwordx4 a[100:103], v1, s[4:7], s41 offen
v_mfma_f32_16x16x32_bf16 v[88:91], a[20:23], v[40:43], v[88:91]
v_mfma_f32_16x16x32_bf16 v[92:95], a[20:23], v[44:47], v[92:95]
v_mfma_f32_16x16x32_bf16 v[96:99], a[20:23], v[48:51], v[96:99]
v_mfma_f32_16x16x32_bf16 v[100:103], a[20:23], v[52:55], v[100:103]
s_waitcnt lgkmcnt(3)
v_mfma_f32_16x16x32_bf16 v[56:59], a[24:27], v[24:27], v[56:59]
ds_read_b128 v[40:43], v1 offset:3072
s_waitcnt lgkmcnt(3)
v_mfma_f32_16x16x32_bf16 v[60:63], a[24:27], v[28:31], v[60:63]
ds_read_b128 v[44:47], v1 offset:23552
s_waitcnt lgkmcnt(3)
v_mfma_f32_16x16x32_bf16 v[64:67], a[24:27], v[32:35], v[64:67]
ds_read_b128 v[48:51], v1 offset:44032
s_waitcnt lgkmcnt(3)
v_mfma_f32_16x16x32_bf16 v[68:71], a[24:27], v[36:39], v[68:71]
ds_read_b128 v[52:55], v238 offset:3072
v_mfma_f32_16x16x32_bf16 v[72:75], v[24:27], a[28:31], v[72:75]
s_add_u32 s69, s69, 4096
s_add_u32 s70, s70, 4096
s_mov_b32 m0, s70
s_nop 0
buffer_load_dwordx4 v1, s[4:7], s69 offen offset:0 sc1 lds
v_mfma_f32_16x16x32_bf16 v[76:79], v[28:31], a[28:31], v[76:79]
s_add_u32 s43, s43, 4096
buffer_load_dwordx4 a[104:107], v1, s[4:7], s43 offen
v_mfma_f32_16x16x32_bf16 v[80:83], v[32:35], a[28:31], v[80:83]
buffer_load_dwordx4 a[108:111], v1, s[4:7], s40 offen offset:1024
v_mfma_f32_16x16x32_bf16 v[84:87], v[36:39], a[28:31], v[84:87]
buffer_load_dwordx4 a[112:115], v1, s[4:7], s41 offen offset:1024
s_waitcnt vmcnt(28)
v_mfma_f32_16x16x32_bf16 v[88:91], a[32:35], v[24:27], v[88:91]
v_mfma_f32_16x16x32_bf16 v[92:95], a[32:35], v[28:31], v[92:95]
v_mfma_f32_16x16x32_bf16 v[96:99], a[32:35], v[32:35], v[96:99]
v_mfma_f32_16x16x32_bf16 v[100:103], a[32:35], v[36:39], v[100:103]
s_waitcnt vmcnt(27)
s_waitcnt lgkmcnt(3)
v_mfma_f32_16x16x32_bf16 v[56:59], a[36:39], v[40:43], v[56:59]
ds_read_b128 v[24:27], v1 offset:4096
s_waitcnt lgkmcnt(3)
v_mfma_f32_16x16x32_bf16 v[60:63], a[36:39], v[44:47], v[60:63]
ds_read_b128 v[28:31], v1 offset:24576
s_waitcnt lgkmcnt(3)
v_mfma_f32_16x16x32_bf16 v[64:67], a[36:39], v[48:51], v[64:67]
ds_read_b128 v[32:35], v1 offset:45056
s_waitcnt lgkmcnt(3)
v_mfma_f32_16x16x32_bf16 v[68:71], a[36:39], v[52:55], v[68:71]
ds_read_b128 v[36:39], v238 offset:4096
s_waitcnt vmcnt(25)
v_mfma_f32_16x16x32_bf16 v[72:75], v[40:43], a[40:43], v[72:75]
s_mov_b32 m0, s70
s_nop 0
buffer_load_dwordx4 v1, s[4:7], s69 offen offset:1024 sc1 lds
v_mfma_f32_16x16x32_bf16 v[76:79], v[44:47], a[40:43], v[76:79]
buffer_load_dwordx4 a[116:119], v1, s[4:7], s43 offen offset:1024
v_mfma_f32_16x16x32_bf16 v[80:83], v[48:51], a[40:43], v[80:83]
buffer_load_dwordx4 a[120:123], v1, s[4:7], s40 offen offset:2048
v_mfma_f32_16x16x32_bf16 v[84:87], v[52:55], a[40:43], v[84:87]
buffer_load_dwordx4 a[124:127], v1, s[4:7], s41 offen offset:2048
s_waitcnt vmcnt(28)
v_mfma_f32_16x16x32_bf16 v[88:91], a[44:47], v[40:43], v[88:91]
v_mfma_f32_16x16x32_bf16 v[92:95], a[44:47], v[44:47], v[92:95]
v_mfma_f32_16x16x32_bf16 v[96:99], a[44:47], v[48:51], v[96:99]
v_mfma_f32_16x16x32_bf16 v[100:103], a[44:47], v[52:55], v[100:103]
s_waitcnt vmcnt(18)
s_barrier
s_waitcnt lgkmcnt(3)
v_mfma_f32_16x16x32_bf16 v[56:59], a[48:51], v[24:27], v[56:59]
ds_read_b128 v[40:43], v1 offset:5120
s_waitcnt lgkmcnt(3)
v_mfma_f32_16x16x32_bf16 v[60:63], a[48:51], v[28:31], v[60:63]
ds_read_b128 v[44:47], v1 offset:25600
s_waitcnt lgkmcnt(3)
v_mfma_f32_16x16x32_bf16 v[64:67], a[48:51], v[32:35], v[64:67]
ds_read_b128 v[48:51], v1 offset:46080
s_waitcnt lgkmcnt(3)
v_mfma_f32_16x16x32_bf16 v[68:71], a[48:51], v[36:39], v[68:71]
ds_read_b128 v[52:55], v238 offset:5120
v_mfma_f32_16x16x32_bf16 v[72:75], v[24:27], a[52:55], v[72:75]
s_mov_b32 m0, s70
s_nop 0
buffer_load_dwordx4 v1, s[4:7], s69 offen offset:2048 sc1 lds
v_mfma_f32_16x16x32_bf16 v[76:79], v[28:31], a[52:55], v[76:79]
buffer_load_dwordx4 a[128:131], v1, s[4:7], s43 offen offset:2048
v_mfma_f32_16x16x32_bf16 v[80:83], v[32:35], a[52:55], v[80:83]
buffer_load_dwordx4 a[132:135], v1, s[4:7], s40 offen offset:3072
v_mfma_f32_16x16x32_bf16 v[84:87], v[36:39], a[52:55], v[84:87]
buffer_load_dwordx4 a[136:139], v1, s[4:7], s41 offen offset:3072
v_mfma_f32_16x16x32_bf16 v[88:91], a[56:59], v[24:27], v[88:91]
v_mfma_f32_16x16x32_bf16 v[92:95], a[56:59], v[28:31], v[92:95]
v_mfma_f32_16x16x32_bf16 v[96:99], a[56:59], v[32:35], v[96:99]
v_mfma_f32_16x16x32_bf16 v[100:103], a[56:59], v[36:39], v[100:103]
s_waitcnt lgkmcnt(3)
v_mfma_f32_16x16x32_bf16 v[56:59], a[60:63], v[40:43], v[56:59]
ds_read_b128 v[24:27], v1 offset:6144
s_waitcnt lgkmcnt(3)
v_mfma_f32_16x16x32_bf16 v[60:63], a[60:63], v[44:47], v[60:63]
ds_read_b128 v[28:31], v1 offset:26624
s_waitcnt lgkmcnt(3)
v_mfma_f32_16x16x32_bf16 v[64:67], a[60:63], v[48:51], v[64:67]
ds_read_b128 v[32:35], v1 offset:47104
s_waitcnt lgkmcnt(3)
v_mfma_f32_16x16x32_bf16 v[68:71], a[60:63], v[52:55], v[68:71]
ds_read_b128 v[36:39], v238 offset:6144
v_mfma_f32_16x16x32_bf16 v[72:75], v[40:43], a[64:67], v[72:75]
s_mov_b32 m0, s70
s_nop 0
buffer_load_dwordx4 v1, s[4:7], s69 offen offset:3072 sc1 lds
v_mfma_f32_16x16x32_bf16 v[76:79], v[44:47], a[64:67], v[76:79]
buffer_load_dwordx4 a[140:143], v1, s[4:7], s43 offen offset:3072
v_mfma_f32_16x16x32_bf16 v[80:83], v[48:51], a[64:67], v[80:83]
s_add_u32 s40, s40, 4096
buffer_load_dwordx4 a[144:147], v1, s[4:7], s40 offen
v_mfma_f32_16x16x32_bf16 v[84:87], v[52:55], a[64:67], v[84:87]
s_add_u32 s41, s41, 4096
buffer_load_dwordx4 a[148:151], v1, s[4:7], s41 offen
v_mfma_f32_16x16x32_bf16 v[88:91], a[68:71], v[40:43], v[88:91]
v_mfma_f32_16x16x32_bf16 v[92:95], a[68:71], v[44:47], v[92:95]
v_mfma_f32_16x16x32_bf16 v[96:99], a[68:71], v[48:51], v[96:99]
v_mfma_f32_16x16x32_bf16 v[100:103], a[68:71], v[52:55], v[100:103]
s_waitcnt vmcnt(25)
s_waitcnt lgkmcnt(3)
v_mfma_f32_16x16x32_bf16 v[56:59], a[72:75], v[24:27], v[56:59]
ds_read_b128 v[40:43], v1 offset:7168
s_waitcnt lgkmcnt(3)
v_mfma_f32_16x16x32_bf16 v[60:63], a[72:75], v[28:31], v[60:63]
ds_read_b128 v[44:47], v1 offset:27648
s_waitcnt lgkmcnt(3)
v_mfma_f32_16x16x32_bf16 v[64:67], a[72:75], v[32:35], v[64:67]
ds_read_b128 v[48:51], v1 offset:48128
s_waitcnt lgkmcnt(3)
v_mfma_f32_16x16x32_bf16 v[68:71], a[72:75], v[36:39], v[68:71]
ds_read_b128 v[52:55], v238 offset:7168
s_waitcnt vmcnt(24)
v_mfma_f32_16x16x32_bf16 v[72:75], v[24:27], a[76:79], v[72:75]
s_add_u32 s69, s69, 4096
s_add_u32 s70, s70, 4096
s_mov_b32 m0, s70
s_nop 0
buffer_load_dwordx4 v1, s[4:7], s69 offen offset:0 sc1 lds
v_mfma_f32_16x16x32_bf16 v[76:79], v[28:31], a[76:79], v[76:79]
s_add_u32 s43, s43, 4096
buffer_load_dwordx4 a[152:155], v1, s[4:7], s43 offen
v_mfma_f32_16x16x32_bf16 v[80:83], v[32:35], a[76:79], v[80:83]
buffer_load_dwordx4 a[156:159], v1, s[4:7], s40 offen offset:1024
v_mfma_f32_16x16x32_bf16 v[84:87], v[36:39], a[76:79], v[84:87]
buffer_load_dwordx4 a[160:163], v1, s[4:7], s41 offen offset:1024
s_waitcnt vmcnt(26)
v_mfma_f32_16x16x32_bf16 v[88:91], a[80:83], v[24:27], v[88:91]
v_mfma_f32_16x16x32_bf16 v[92:95], a[80:83], v[28:31], v[92:95]
v_mfma_f32_16x16x32_bf16 v[96:99], a[80:83], v[32:35], v[96:99]
v_mfma_f32_16x16x32_bf16 v[100:103], a[80:83], v[36:39], v[100:103]
s_waitcnt vmcnt(25)
s_waitcnt lgkmcnt(3)
v_mfma_f32_16x16x32_bf16 v[56:59], a[84:87], v[40:43], v[56:59]
ds_read_b128 v[24:27], v1 offset:8192
s_waitcnt lgkmcnt(3)
v_mfma_f32_16x16x32_bf16 v[60:63], a[84:87], v[44:47], v[60:63]
ds_read_b128 v[28:31], v1 offset:28672
s_waitcnt lgkmcnt(3)
v_mfma_f32_16x16x32_bf16 v[64:67], a[84:87], v[48:51], v[64:67]
ds_read_b128 v[32:35], v1 offset:49152
s_waitcnt lgkmcnt(3)
v_mfma_f32_16x16x32_bf16 v[68:71], a[84:87], v[52:55], v[68:71]
ds_read_b128 v[36:39], v238 offset:8192
s_waitcnt vmcnt(24)
v_mfma_f32_16x16x32_bf16 v[72:75], v[40:43], a[88:91], v[72:75]
s_mov_b32 m0, s70
s_nop 0
buffer_load_dwordx4 v1, s[4:7], s69 offen offset:1024 sc1 lds
v_mfma_f32_16x16x32_bf16 v[76:79], v[44:47], a[88:91], v[76:79]
buffer_load_dwordx4 a[164:167], v1, s[4:7], s43 offen offset:1024
v_mfma_f32_16x16x32_bf16 v[80:83], v[48:51], a[88:91], v[80:83]
buffer_load_dwordx4 a[168:171], v1, s[4:7], s40 offen offset:2048
v_mfma_f32_16x16x32_bf16 v[84:87], v[52:55], a[88:91], v[84:87]
buffer_load_dwordx4 a[172:175], v1, s[4:7], s41 offen offset:2048
s_waitcnt vmcnt(26)
v_mfma_f32_16x16x32_bf16 v[88:91], a[92:95], v[40:43], v[88:91]
v_mfma_f32_16x16x32_bf16 v[92:95], a[92:95], v[44:47], v[92:95]
v_mfma_f32_16x16x32_bf16 v[96:99], a[92:95], v[48:51], v[96:99]
v_mfma_f32_16x16x32_bf16 v[100:103], a[92:95], v[52:55], v[100:103]
s_waitcnt vmcnt(25)
s_waitcnt lgkmcnt(3)
v_mfma_f32_16x16x32_bf16 v[56:59], a[96:99], v[24:27], v[56:59]
ds_read_b128 v[40:43], v1 offset:9216
s_waitcnt lgkmcnt(3)
v_mfma_f32_16x16x32_bf16 v[60:63], a[96:99], v[28:31], v[60:63]
ds_read_b128 v[44:47], v1 offset:29696
s_waitcnt lgkmcnt(3)
v_mfma_f32_16x16x32_bf16 v[64:67], a[96:99], v[32:35], v[64:67]
ds_read_b128 v[48:51], v1 offset:50176
s_waitcnt lgkmcnt(3)
v_mfma_f32_16x16x32_bf16 v[68:71], a[96:99], v[36:39], v[68:71]
ds_read_b128 v[52:55], v238 offset:9216
s_waitcnt vmcnt(24)
v_mfma_f32_16x16x32_bf16 v[72:75], v[24:27], a[100:103], v[72:75]
s_mov_b32 m0, s70
s_nop 0
buffer_load_dwordx4 v1, s[4:7], s69 offen offset:2048 sc1 lds
v_mfma_f32_16x16x32_bf16 v[76:79], v[28:31], a[100:103], v[76:79]
buffer_load_dwordx4 a[176:179], v1, s[4:7], s43 offen offset:2048
v_mfma_f32_16x16x32_bf16 v[80:83], v[32:35], a[100:103], v[80:83]
buffer_load_dwordx4 a[180:183], v1, s[4:7], s40 offen offset:3072
v_mfma_f32_16x16x32_bf16 v[84:87], v[36:39], a[100:103], v[84:87]
buffer_load_dwordx4 a[184:187], v1, s[4:7], s41 offen offset:3072
s_waitcnt vmcnt(26)
v_mfma_f32_16x16x32_bf16 v[88:91], a[104:107], v[24:27], v[88:91]
v_mfma_f32_16x16x32_bf16 v[92:95], a[104:107], v[28:31], v[92:95]
v_mfma_f32_16x16x32_bf16 v[96:99], a[104:107], v[32:35], v[96:99]
v_mfma_f32_16x16x32_bf16 v[100:103], a[104:107], v[36:39], v[100:103]
s_waitcnt vmcnt(19)
s_barrier
s_waitcnt lgkmcnt(3)
v_mfma_f32_16x16x32_bf16 v[56:59], a[108:111], v[40:43], v[56:59]
ds_read_b128 v[24:27], v1 offset:10240
s_waitcnt lgkmcnt(3)
v_mfma_f32_16x16x32_bf16 v[60:63], a[108:111], v[44:47], v[60:63]
ds_read_b128 v[28:31], v1 offset:30720
s_waitcnt lgkmcnt(3)
v_mfma_f32_16x16x32_bf16 v[64:67], a[108:111], v[48:51], v[64:67]
ds_read_b128 v[32:35], v1 offset:51200
s_waitcnt lgkmcnt(3)
v_mfma_f32_16x16x32_bf16 v[68:71], a[108:111], v[52:55], v[68:71]
ds_read_b128 v[36:39], v238 offset:10240
v_mfma_f32_16x16x32_bf16 v[72:75], v[40:43], a[112:115], v[72:75]
s_mov_b32 m0, s70
s_nop 0
buffer_load_dwordx4 v1, s[4:7], s69 offen offset:3072 sc1 lds
v_mfma_f32_16x16x32_bf16 v[76:79], v[44:47], a[112:115], v[76:79]
buffer_load_dwordx4 a[188:191], v1, s[4:7], s43 offen offset:3072
v_mfma_f32_16x16x32_bf16 v[80:83], v[48:51], a[112:115], v[80:83]
s_add_u32 s40, s40, 4096
buffer_load_dwordx4 a[192:195], v1, s[4:7], s40 offen
v_mfma_f32_16x16x32_bf16 v[84:87], v[52:55], a[112:115], v[84:87]
s_add_u32 s41, s41, 4096
buffer_load_dwordx4 a[196:199], v1, s[4:7], s41 offen
v_mfma_f32_16x16x32_bf16 v[88:91], a[116:119], v[40:43], v[88:91]
v_mfma_f32_16x16x32_bf16 v[92:95], a[116:119], v[44:47], v[92:95]
v_mfma_f32_16x16x32_bf16 v[96:99], a[116:119], v[48:51], v[96:99]
v_mfma_f32_16x16x32_bf16 v[100:103], a[116:119], v[52:55], v[100:103]
s_waitcnt lgkmcnt(3)
v_mfma_f32_16x16x32_bf16 v[56:59], a[120:123], v[24:27], v[56:59]
ds_read_b128 v[40:43], v1 offset:11264
s_waitcnt lgkmcnt(3)
v_mfma_f32_16x16x32_bf16 v[60:63], a[120:123], v[28:31], v[60:63]
ds_read_b128 v[44:47], v1 offset:31744
s_waitcnt lgkmcnt(3)
v_mfma_f32_16x16x32_bf16 v[64:67], a[120:123], v[32:35], v[64:67]
ds_read_b128 v[48:51], v1 offset:52224
s_waitcnt lgkmcnt(3)
v_mfma_f32_16x16x32_bf16 v[68:71], a[120:123], v[36:39], v[68:71]
ds_read_b128 v[52:55], v238 offset:11264
v_mfma_f32_16x16x32_bf16 v[72:75], v[24:27], a[124:127], v[72:75]
v_mfma_f32_16x16x32_bf16 v[76:79], v[28:31], a[124:127], v[76:79]
s_add_u32 s43, s43, 4096
buffer_load_dwordx4 a[200:203], v1, s[4:7], s43 offen
v_mfma_f32_16x16x32_bf16 v[80:83], v[32:35], a[124:127], v[80:83]
buffer_load_dwordx4 a[204:207], v1, s[4:7], s40 offen offset:1024
v_mfma_f32_16x16x32_bf16 v[84:87], v[36:39], a[124:127], v[84:87]
buffer_load_dwordx4 a[208:211], v1, s[4:7], s41 offen offset:1024
s_waitcnt vmcnt(25)
v_mfma_f32_16x16x32_bf16 v[88:91], a[128:131], v[24:27], v[88:91]
v_mfma_f32_16x16x32_bf16 v[92:95], a[128:131], v[28:31], v[92:95]
v_mfma_f32_16x16x32_bf16 v[96:99], a[128:131], v[32:35], v[96:99]
v_mfma_f32_16x16x32_bf16 v[100:103], a[128:131], v[36:39], v[100:103]
s_waitcnt vmcnt(24)
s_waitcnt lgkmcnt(3)
v_mfma_f32_16x16x32_bf16 v[56:59], a[132:135], v[40:43], v[56:59]
ds_read_b128 v[24:27], v1 offset:12288
s_waitcnt lgkmcnt(3)
v_mfma_f32_16x16x32_bf16 v[60:63], a[132:135], v[44:47], v[60:63]
ds_read_b128 v[28:31], v1 offset:32768
s_waitcnt lgkmcnt(3)
v_mfma_f32_16x16x32_bf16 v[64:67], a[132:135], v[48:51], v[64:67]
ds_read_b128 v[32:35], v1 offset:53248
s_waitcnt lgkmcnt(3)
v_mfma_f32_16x16x32_bf16 v[68:71], a[132:135], v[52:55], v[68:71]
ds_read_b128 v[36:39], v238 offset:12288
s_waitcnt vmcnt(23)
v_mfma_f32_16x16x32_bf16 v[72:75], v[40:43], a[136:139], v[72:75]
v_mfma_f32_16x16x32_bf16 v[76:79], v[44:47], a[136:139], v[76:79]
buffer_load_dwordx4 a[212:215], v1, s[4:7], s43 offen offset:1024
v_mfma_f32_16x16x32_bf16 v[80:83], v[48:51], a[136:139], v[80:83]
buffer_load_dwordx4 a[216:219], v1, s[4:7], s40 offen offset:2048
v_mfma_f32_16x16x32_bf16 v[84:87], v[52:55], a[136:139], v[84:87]
buffer_load_dwordx4 a[220:223], v1, s[4:7], s41 offen offset:2048
s_waitcnt vmcnt(24)
v_mfma_f32_16x16x32_bf16 v[88:91], a[140:143], v[40:43], v[88:91]
v_mfma_f32_16x16x32_bf16 v[92:95], a[140:143], v[44:47], v[92:95]
v_mfma_f32_16x16x32_bf16 v[96:99], a[140:143], v[48:51], v[96:99]
v_mfma_f32_16x16x32_bf16 v[100:103], a[140:143], v[52:55], v[100:103]
s_waitcnt vmcnt(23)
s_waitcnt lgkmcnt(3)
v_mfma_f32_16x16x32_bf16 v[56:59], a[144:147], v[24:27], v[56:59]
ds_read_b128 v[40:43], v1 offset:13312
s_waitcnt lgkmcnt(3)
v_mfma_f32_16x16x32_bf16 v[60:63], a[144:147], v[28:31], v[60:63]
ds_read_b128 v[44:47], v1 offset:33792
s_waitcnt lgkmcnt(3)
v_mfma_f32_16x16x32_bf16 v[64:67], a[144:147], v[32:35], v[64:67]
ds_read_b128 v[48:51], v1 offset:54272
s_waitcnt lgkmcnt(3)
v_mfma_f32_16x16x32_bf16 v[68:71], a[144:147], v[36:39], v[68:71]
ds_read_b128 v[52:55], v238 offset:13312
s_waitcnt vmcnt(22)
v_mfma_f32_16x16x32_bf16 v[72:75], v[24:27], a[148:151], v[72:75]
v_mfma_f32_16x16x32_bf16 v[76:79], v[28:31], a[148:151], v[76:79]
buffer_load_dwordx4 a[224:227], v1, s[4:7], s43 offen offset:2048
v_mfma_f32_16x16x32_bf16 v[80:83], v[32:35], a[148:151], v[80:83]
buffer_load_dwordx4 a[228:231], v1, s[4:7], s40 offen offset:3072
v_mfma_f32_16x16x32_bf16 v[84:87], v[36:39], a[148:151], v[84:87]
buffer_load_dwordx4 a[232:235], v1, s[4:7], s41 offen offset:3072
s_waitcnt vmcnt(23)
v_mfma_f32_16x16x32_bf16 v[88:91], a[152:155], v[24:27], v[88:91]
v_mfma_f32_16x16x32_bf16 v[92:95], a[152:155], v[28:31], v[92:95]
v_mfma_f32_16x16x32_bf16 v[96:99], a[152:155], v[32:35], v[96:99]
v_mfma_f32_16x16x32_bf16 v[100:103], a[152:155], v[36:39], v[100:103]
s_waitcnt vmcnt(22)
s_waitcnt lgkmcnt(3)
v_mfma_f32_16x16x32_bf16 v[56:59], a[156:159], v[40:43], v[56:59]
ds_read_b128 v[24:27], v1 offset:14336
s_waitcnt lgkmcnt(3)
v_mfma_f32_16x16x32_bf16 v[60:63], a[156:159], v[44:47], v[60:63]
ds_read_b128 v[28:31], v1 offset:34816
s_waitcnt lgkmcnt(3)
v_mfma_f32_16x16x32_bf16 v[64:67], a[156:159], v[48:51], v[64:67]
ds_read_b128 v[32:35], v1 offset:55296
s_waitcnt lgkmcnt(3)
v_mfma_f32_16x16x32_bf16 v[68:71], a[156:159], v[52:55], v[68:71]
ds_read_b128 v[36:39], v238 offset:14336
s_waitcnt vmcnt(21)
v_mfma_f32_16x16x32_bf16 v[72:75], v[40:43], a[160:163], v[72:75]
v_mfma_f32_16x16x32_bf16 v[76:79], v[44:47], a[160:163], v[76:79]
buffer_load_dwordx4 a[236:239], v1, s[4:7], s43 offen offset:3072
v_mfma_f32_16x16x32_bf16 v[80:83], v[48:51], a[160:163], v[80:83]
buffer_load_dwordx4 a[240:243], v1, s[4:7], s42 offen
v_mfma_f32_16x16x32_bf16 v[84:87], v[52:55], a[160:163], v[84:87]
buffer_load_dwordx4 a[244:247], v1, s[4:7], s42 offen offset:1024
s_waitcnt vmcnt(22)
v_mfma_f32_16x16x32_bf16 v[88:91], a[164:167], v[40:43], v[88:91]
v_mfma_f32_16x16x32_bf16 v[92:95], a[164:167], v[44:47], v[92:95]
v_mfma_f32_16x16x32_bf16 v[96:99], a[164:167], v[48:51], v[96:99]
v_mfma_f32_16x16x32_bf16 v[100:103], a[164:167], v[52:55], v[100:103]
s_waitcnt vmcnt(15)
s_barrier
s_waitcnt lgkmcnt(3)
v_mfma_f32_16x16x32_bf16 v[56:59], a[168:171], v[24:27], v[56:59]
ds_read_b128 v[40:43], v1 offset:15360
s_waitcnt lgkmcnt(3)
v_mfma_f32_16x16x32_bf16 v[60:63], a[168:171], v[28:31], v[60:63]
ds_read_b128 v[44:47], v1 offset:35840
s_waitcnt lgkmcnt(3)
v_mfma_f32_16x16x32_bf16 v[64:67], a[168:171], v[32:35], v[64:67]
ds_read_b128 v[48:51], v1 offset:56320
s_waitcnt lgkmcnt(3)
v_mfma_f32_16x16x32_bf16 v[68:71], a[168:171], v[36:39], v[68:71]
ds_read_b128 v[52:55], v238 offset:15360
v_mfma_f32_16x16x32_bf16 v[72:75], v[24:27], a[172:175], v[72:75]
v_mfma_f32_16x16x32_bf16 v[76:79], v[28:31], a[172:175], v[76:79]
buffer_load_dwordx4 a[248:251], v1, s[4:7], s42 offen offset:2048
v_mfma_f32_16x16x32_bf16 v[80:83], v[32:35], a[172:175], v[80:83]
buffer_load_dwordx4 a[252:255], v1, s[4:7], s42 offen offset:3072
v_mfma_f32_16x16x32_bf16 v[84:87], v[36:39], a[172:175], v[84:87]
s_add_u32 s42, s42, 4096
buffer_load_dwordx4 a[0:3], v1, s[4:7], s42 offen
v_mfma_f32_16x16x32_bf16 v[88:91], a[176:179], v[24:27], v[88:91]
v_mfma_f32_16x16x32_bf16 v[92:95], a[176:179], v[28:31], v[92:95]
v_mfma_f32_16x16x32_bf16 v[96:99], a[176:179], v[32:35], v[96:99]
v_mfma_f32_16x16x32_bf16 v[100:103], a[176:179], v[36:39], v[100:103]
s_waitcnt lgkmcnt(3)
v_mfma_f32_16x16x32_bf16 v[56:59], a[180:183], v[40:43], v[56:59]
ds_read_b64 v[24:25], v2 offset:16384
ds_read_b64 v[26:27], v2 offset:16896
s_waitcnt lgkmcnt(4)
v_mfma_f32_16x16x32_bf16 v[60:63], a[180:183], v[44:47], v[60:63]
ds_read_b64 v[28:29], v2 offset:36864
ds_read_b64 v[30:31], v2 offset:37376
s_waitcnt lgkmcnt(5)
v_mfma_f32_16x16x32_bf16 v[64:67], a[180:183], v[48:51], v[64:67]
ds_read_b64 v[32:33], v2 offset:57344
ds_read_b64 v[34:35], v2 offset:57856
s_waitcnt lgkmcnt(6)
v_mfma_f32_16x16x32_bf16 v[68:71], a[180:183], v[52:55], v[68:71]
ds_read_b64 v[36:37], v239 offset:16384
ds_read_b64 v[38:39], v239 offset:16896
v_mfma_f32_16x16x32_bf16 v[72:75], v[40:43], a[184:187], v[72:75]
v_mfma_f32_16x16x32_bf16 v[76:79], v[44:47], a[184:187], v[76:79]
buffer_load_dwordx4 a[4:7], v1, s[4:7], s42 offen offset:1024
v_mfma_f32_16x16x32_bf16 v[80:83], v[48:51], a[184:187], v[80:83]
buffer_load_dwordx4 a[8:11], v1, s[4:7], s42 offen offset:2048
v_mfma_f32_16x16x32_bf16 v[84:87], v[52:55], a[184:187], v[84:87]
buffer_load_dwordx4 a[12:15], v1, s[4:7], s42 offen offset:3072
s_waitcnt vmcnt(20)
v_mfma_f32_16x16x32_bf16 v[88:91], a[188:191], v[40:43], v[88:91]
v_mfma_f32_16x16x32_bf16 v[92:95], a[188:191], v[44:47], v[92:95]
v_mfma_f32_16x16x32_bf16 v[96:99], a[188:191], v[48:51], v[96:99]
v_mfma_f32_16x16x32_bf16 v[100:103], a[188:191], v[52:55], v[100:103]
s_waitcnt vmcnt(19)
s_waitcnt lgkmcnt(6)
v_mfma_f32_16x16x32_bf16 v[56:59], a[192:195], v[24:27], v[56:59]
ds_read_b64 v[40:41], v2 offset:17408
ds_read_b64 v[42:43], v2 offset:17920
s_waitcnt lgkmcnt(6)
v_mfma_f32_16x16x32_bf16 v[60:63], a[192:195], v[28:31], v[60:63]
ds_read_b64 v[44:45], v2 offset:37888
ds_read_b64 v[46:47], v2 offset:38400
s_waitcnt lgkmcnt(6)
v_mfma_f32_16x16x32_bf16 v[64:67], a[192:195], v[32:35], v[64:67]
ds_read_b64 v[48:49], v2 offset:58368
ds_read_b64 v[50:51], v2 offset:58880
s_waitcnt lgkmcnt(6)
v_mfma_f32_16x16x32_bf16 v[68:71], a[192:195], v[36:39], v[68:71]
ds_read_b64 v[52:53], v239 offset:17408
ds_read_b64 v[54:55], v239 offset:17920
s_waitcnt vmcnt(18)
v_mfma_f32_16x16x32_bf16 v[72:75], v[24:27], a[196:199], v[72:75]
v_mfma_f32_16x16x32_bf16 v[76:79], v[28:31], a[196:199], v[76:79]
s_add_u32 s42, s42, 4096
buffer_load_dwordx4 a[16:19], v1, s[4:7], s42 offen
v_mfma_f32_16x16x32_bf16 v[80:83], v[32:35], a[196:199], v[80:83]
buffer_load_dwordx4 a[20:23], v1, s[4:7], s42 offen offset:1024
v_mfma_f32_16x16x32_bf16 v[84:87], v[36:39], a[196:199], v[84:87]
buffer_load_dwordx4 a[24:27], v1, s[4:7], s42 offen offset:2048
s_waitcnt vmcnt(20)
v_mfma_f32_16x16x32_bf16 v[88:91], a[200:203], v[24:27], v[88:91]
v_mfma_f32_16x16x32_bf16 v[92:95], a[200:203], v[28:31], v[92:95]
v_mfma_f32_16x16x32_bf16 v[96:99], a[200:203], v[32:35], v[96:99]
v_mfma_f32_16x16x32_bf16 v[100:103], a[200:203], v[36:39], v[100:103]
s_waitcnt vmcnt(19)
s_waitcnt lgkmcnt(6)
v_mfma_f32_16x16x32_bf16 v[56:59], a[204:207], v[40:43], v[56:59]
ds_read_b64 v[24:25], v2 offset:18432
ds_read_b64 v[26:27], v2 offset:18944
s_waitcnt lgkmcnt(6)
v_mfma_f32_16x16x32_bf16 v[60:63], a[204:207], v[44:47], v[60:63]
ds_read_b64 v[28:29], v2 offset:38912
ds_read_b64 v[30:31], v2 offset:39424
s_waitcnt lgkmcnt(6)
v_mfma_f32_16x16x32_bf16 v[64:67], a[204:207], v[48:51], v[64:67]
ds_read_b64 v[32:33], v2 offset:59392
ds_read_b64 v[34:35], v2 offset:59904
s_waitcnt lgkmcnt(6)
v_mfma_f32_16x16x32_bf16 v[68:71], a[204:207], v[52:55], v[68:71]
ds_read_b64 v[36:37], v239 offset:18432
ds_read_b64 v[38:39], v239 offset:18944
s_waitcnt vmcnt(18)
v_mfma_f32_16x16x32_bf16 v[72:75], v[40:43], a[208:211], v[72:75]
v_mfma_f32_16x16x32_bf16 v[76:79], v[44:47], a[208:211], v[76:79]
buffer_load_dwordx4 a[28:31], v1, s[4:7], s42 offen offset:3072
v_mfma_f32_16x16x32_bf16 v[80:83], v[48:51], a[208:211], v[80:83]
s_add_u32 s42, s42, 4096
buffer_load_dwordx4 a[32:35], v1, s[4:7], s42 offen
v_mfma_f32_16x16x32_bf16 v[84:87], v[52:55], a[208:211], v[84:87]
buffer_load_dwordx4 a[36:39], v1, s[4:7], s42 offen offset:1024
s_waitcnt vmcnt(20)
v_mfma_f32_16x16x32_bf16 v[88:91], a[212:215], v[40:43], v[88:91]
v_mfma_f32_16x16x32_bf16 v[92:95], a[212:215], v[44:47], v[92:95]
v_mfma_f32_16x16x32_bf16 v[96:99], a[212:215], v[48:51], v[96:99]
v_mfma_f32_16x16x32_bf16 v[100:103], a[212:215], v[52:55], v[100:103]
s_waitcnt vmcnt(19)
s_waitcnt lgkmcnt(6)
v_mfma_f32_16x16x32_bf16 v[56:59], a[216:219], v[24:27], v[56:59]
ds_read_b64 v[40:41], v2 offset:19456
ds_read_b64 v[42:43], v2 offset:19968
s_waitcnt lgkmcnt(6)
v_mfma_f32_16x16x32_bf16 v[60:63], a[216:219], v[28:31], v[60:63]
ds_read_b64 v[44:45], v2 offset:39936
ds_read_b64 v[46:47], v2 offset:40448
s_waitcnt lgkmcnt(6)
v_mfma_f32_16x16x32_bf16 v[64:67], a[216:219], v[32:35], v[64:67]
ds_read_b64 v[48:49], v2 offset:60416
ds_read_b64 v[50:51], v2 offset:60928
s_waitcnt lgkmcnt(6)
v_mfma_f32_16x16x32_bf16 v[68:71], a[216:219], v[36:39], v[68:71]
ds_read_b64 v[52:53], v239 offset:19456
ds_read_b64 v[54:55], v239 offset:19968
s_waitcnt vmcnt(18)
v_mfma_f32_16x16x32_bf16 v[72:75], v[24:27], a[220:223], v[72:75]
v_mfma_f32_16x16x32_bf16 v[76:79], v[28:31], a[220:223], v[76:79]
buffer_load_dwordx4 a[40:43], v1, s[4:7], s42 offen offset:2048
v_mfma_f32_16x16x32_bf16 v[80:83], v[32:35], a[220:223], v[80:83]
buffer_load_dwordx4 a[44:47], v1, s[4:7], s42 offen offset:3072
v_mfma_f32_16x16x32_bf16 v[84:87], v[36:39], a[220:223], v[84:87]
s_add_u32 s42, s42, 4096
buffer_load_dwordx4 a[48:51], v1, s[4:7], s42 offen
s_waitcnt vmcnt(20)
v_mfma_f32_16x16x32_bf16 v[88:91], a[224:227], v[24:27], v[88:91]
v_mfma_f32_16x16x32_bf16 v[92:95], a[224:227], v[28:31], v[92:95]
v_mfma_f32_16x16x32_bf16 v[96:99], a[224:227], v[32:35], v[96:99]
v_mfma_f32_16x16x32_bf16 v[100:103], a[224:227], v[36:39], v[100:103]
s_waitcnt vmcnt(19)
s_waitcnt lgkmcnt(6)
v_mfma_f32_16x16x32_bf16 v[56:59], a[228:231], v[40:43], v[56:59]
s_waitcnt lgkmcnt(4)
v_mfma_f32_16x16x32_bf16 v[60:63], a[228:231], v[44:47], v[60:63]
buffer_load_dwordx4 a[52:55], v1, s[4:7], s42 offen offset:1024
s_waitcnt lgkmcnt(2)
v_mfma_f32_16x16x32_bf16 v[64:67], a[228:231], v[48:51], v[64:67]
buffer_load_dwordx4 a[56:59], v1, s[4:7], s42 offen offset:2048
s_waitcnt lgkmcnt(0)
v_mfma_f32_16x16x32_bf16 v[68:71], a[228:231], v[52:55], v[68:71]
buffer_load_dwordx4 a[60:63], v1, s[4:7], s42 offen offset:3072
s_waitcnt vmcnt(21)
v_mfma_f32_16x16x32_bf16 v[72:75], v[40:43], a[232:235], v[72:75]
v_mfma_f32_16x16x32_bf16 v[76:79], v[44:47], a[232:235], v[76:79]
v_mfma_f32_16x16x32_bf16 v[80:83], v[48:51], a[232:235], v[80:83]
v_mfma_f32_16x16x32_bf16 v[84:87], v[52:55], a[232:235], v[84:87]
s_waitcnt vmcnt(20)
v_mfma_f32_16x16x32_bf16 v[88:91], a[236:239], v[40:43], v[88:91]
v_mfma_f32_16x16x32_bf16 v[92:95], a[236:239], v[44:47], v[92:95]
v_mfma_f32_16x16x32_bf16 v[96:99], a[236:239], v[48:51], v[96:99]
v_mfma_f32_16x16x32_bf16 v[100:103], a[236:239], v[52:55], v[100:103]
v_lshlrev_b32 v3, 2, v241
v_add_u32 v3, 102400, v3
ds_read_b32 v136, v3 offset:0
ds_read_b32 v140, v3 offset:256
ds_read_b32 v137, v3 offset:64
ds_read_b32 v141, v3 offset:320
ds_read_b32 v138, v3 offset:128
ds_read_b32 v142, v3 offset:384
ds_read_b32 v139, v3 offset:192
ds_read_b32 v143, v3 offset:448
v_lshlrev_b32 v3, 4, v240
v_add_u32 v3, 102400, v3
ds_read_b128 v[144:147], v3 offset:0
ds_read_b128 v[160:163], v3 offset:256
ds_read_b128 v[148:151], v3 offset:64
ds_read_b128 v[164:167], v3 offset:320
ds_read_b128 v[152:155], v3 offset:128
ds_read_b128 v[168:171], v3 offset:384
ds_read_b128 v[156:159], v3 offset:192
ds_read_b128 v[172:175], v3 offset:448
s_waitcnt lgkmcnt(0)
s_lshl_b32 s24, s60, 14
s_add_u32 s24, s24, 13492224
s_lshl_b32 s25, s22, 12
s_add_u32 s25, s25, s24
s_mul_i32 s26, s60, 10240
s_add_u32 s26, s26, 21880832
s_lshl_b32 s27, s22, 11
s_add_u32 s27, s27, s26
s_add_u32 s26, s26, 8192
v_pk_fma_f32 v[88:89], v[184:185], v[136:137], v[88:89] op_sel:[0,0,0] op_sel_hi:[1,0,1]
v_pk_fma_f32 v[90:91], v[186:187], v[136:137], v[90:91] op_sel:[0,0,0] op_sel_hi:[1,0,1]
v_pk_mul_f32 v[88:89], v[88:89], v[140:141] op_sel:[0,0] op_sel_hi:[1,0]
v_pk_mul_f32 v[90:91], v[90:91], v[140:141] op_sel:[0,0] op_sel_hi:[1,0]
v_cvt_pk_bf16_f32 v40, v88, v89
v_cvt_pk_bf16_f32 v41, v90, v91
ds_write_b64 v239, v[40:41] offset:44032
v_pk_fma_f32 v[92:93], v[184:185], v[136:137], v[92:93] op_sel:[0,1,0] op_sel_hi:[1,1,1]
v_pk_fma_f32 v[94:95], v[186:187], v[136:137], v[94:95] op_sel:[0,1,0] op_sel_hi:[1,1,1]
v_pk_mul_f32 v[92:93], v[92:93], v[140:141] op_sel:[0,1] op_sel_hi:[1,1]
v_pk_mul_f32 v[94:95], v[94:95], v[140:141] op_sel:[0,1] op_sel_hi:[1,1]
v_cvt_pk_bf16_f32 v42, v92, v93
v_cvt_pk_bf16_f32 v43, v94, v95
ds_write_b64 v239, v[42:43] offset:44544
v_pk_fma_f32 v[96:97], v[184:185], v[138:139], v[96:97] op_sel:[0,0,0] op_sel_hi:[1,0,1]
v_pk_fma_f32 v[98:99], v[186:187], v[138:139], v[98:99] op_sel:[0,0,0] op_sel_hi:[1,0,1]
v_pk_mul_f32 v[96:97], v[96:97], v[142:143] op_sel:[0,0] op_sel_hi:[1,0]
v_pk_mul_f32 v[98:99], v[98:99], v[142:143] op_sel:[0,0] op_sel_hi:[1,0]
v_cvt_pk_bf16_f32 v44, v96, v97
v_cvt_pk_bf16_f32 v45, v98, v99
ds_write_b64 v239, v[44:45] offset:45056
v_pk_fma_f32 v[100:101], v[184:185], v[138:139], v[100:101] op_sel:[0,1,0] op_sel_hi:[1,1,1]
v_pk_fma_f32 v[102:103], v[186:187], v[138:139], v[102:103] op_sel:[0,1,0] op_sel_hi:[1,1,1]
v_pk_mul_f32 v[100:101], v[100:101], v[142:143] op_sel:[0,1] op_sel_hi:[1,1]
v_pk_mul_f32 v[102:103], v[102:103], v[142:143] op_sel:[0,1] op_sel_hi:[1,1]
v_cvt_pk_bf16_f32 v46, v100, v101
v_cvt_pk_bf16_f32 v47, v102, v103
ds_write_b64 v239, v[46:47] offset:45568
v_pk_fma_f32 v[72:73], v[144:145], v[188:189], v[72:73] op_sel:[0,0,0] op_sel_hi:[1,0,1]
v_pk_fma_f32 v[74:75], v[146:147], v[188:189], v[74:75] op_sel:[0,0,0] op_sel_hi:[1,0,1]
v_pk_mul_f32 v[72:73], v[72:73], v[160:161]
v_pk_mul_f32 v[74:75], v[74:75], v[162:163]
v_cvt_pk_bf16_f32 v48, v72, v73
v_cvt_pk_bf16_f32 v49, v74, v75
v_pk_fma_f32 v[76:77], v[148:149], v[188:189], v[76:77] op_sel:[0,0,0] op_sel_hi:[1,0,1]
v_pk_fma_f32 v[78:79], v[150:151], v[188:189], v[78:79] op_sel:[0,0,0] op_sel_hi:[1,0,1]
v_pk_mul_f32 v[76:77], v[76:77], v[164:165]
v_pk_mul_f32 v[78:79], v[78:79], v[166:167]
v_cvt_pk_bf16_f32 v50, v76, v77
v_cvt_pk_bf16_f32 v51, v78, v79
buffer_store_dwordx4 v[48:51], v1, s[4:7], s27 offen offset:0 sc1
v_pk_fma_f32 v[80:81], v[152:153], v[188:189], v[80:81] op_sel:[0,0,0] op_sel_hi:[1,0,1]
v_pk_fma_f32 v[82:83], v[154:155], v[188:189], v[82:83] op_sel:[0,0,0] op_sel_hi:[1,0,1]
v_pk_mul_f32 v[80:81], v[80:81], v[168:169]
v_pk_mul_f32 v[82:83], v[82:83], v[170:171]
v_cvt_pk_bf16_f32 v52, v80, v81
v_cvt_pk_bf16_f32 v53, v82, v83
v_pk_fma_f32 v[84:85], v[156:157], v[188:189], v[84:85] op_sel:[0,0,0] op_sel_hi:[1,0,1]
v_pk_fma_f32 v[86:87], v[158:159], v[188:189], v[86:87] op_sel:[0,0,0] op_sel_hi:[1,0,1]
v_pk_mul_f32 v[84:85], v[84:85], v[172:173]
v_pk_mul_f32 v[86:87], v[86:87], v[174:175]
v_cvt_pk_bf16_f32 v54, v84, v85
v_cvt_pk_bf16_f32 v55, v86, v87
buffer_store_dwordx4 v[52:55], v1, s[4:7], s27 offen offset:1024 sc1
v_pk_fma_f32 v[56:57], v[176:177], v[136:137], v[56:57] op_sel:[0,0,0] op_sel_hi:[1,0,1]
v_pk_fma_f32 v[58:59], v[178:179], v[136:137], v[58:59] op_sel:[0,0,0] op_sel_hi:[1,0,1]
v_pk_mul_f32 v[56:57], v[56:57], v[140:141] op_sel:[0,0] op_sel_hi:[1,0]
v_pk_mul_f32 v[58:59], v[58:59], v[140:141] op_sel:[0,0] op_sel_hi:[1,0]
v_cvt_pk_bf16_f32 v24, v56, v57
v_cvt_pk_bf16_f32 v25, v58, v59
v_pk_fma_f32 v[60:61], v[176:177], v[136:137], v[60:61] op_sel:[0,1,0] op_sel_hi:[1,1,1]
v_pk_fma_f32 v[62:63], v[178:179], v[136:137], v[62:63] op_sel:[0,1,0] op_sel_hi:[1,1,1]
v_pk_mul_f32 v[60:61], v[60:61], v[140:141] op_sel:[0,1] op_sel_hi:[1,1]
v_pk_mul_f32 v[62:63], v[62:63], v[140:141] op_sel:[0,1] op_sel_hi:[1,1]
v_cvt_pk_bf16_f32 v28, v60, v61
v_cvt_pk_bf16_f32 v29, v62, v63
v_pk_fma_f32 v[64:65], v[176:177], v[138:139], v[64:65] op_sel:[0,0,0] op_sel_hi:[1,0,1]
v_pk_fma_f32 v[66:67], v[178:179], v[138:139], v[66:67] op_sel:[0,0,0] op_sel_hi:[1,0,1]
v_pk_mul_f32 v[64:65], v[64:65], v[142:143] op_sel:[0,0] op_sel_hi:[1,0]
v_pk_mul_f32 v[66:67], v[66:67], v[142:143] op_sel:[0,0] op_sel_hi:[1,0]
v_cvt_pk_bf16_f32 v32, v64, v65
v_cvt_pk_bf16_f32 v33, v66, v67
v_pk_fma_f32 v[68:69], v[176:177], v[138:139], v[68:69] op_sel:[0,1,0] op_sel_hi:[1,1,1]
v_pk_fma_f32 v[70:71], v[178:179], v[138:139], v[70:71] op_sel:[0,1,0] op_sel_hi:[1,1,1]
v_pk_mul_f32 v[68:69], v[68:69], v[142:143] op_sel:[0,1] op_sel_hi:[1,1]
v_pk_mul_f32 v[70:71], v[70:71], v[142:143] op_sel:[0,1] op_sel_hi:[1,1]
v_cvt_pk_bf16_f32 v36, v68, v69
v_cvt_pk_bf16_f32 v37, v70, v71
s_waitcnt lgkmcnt(0)
s_barrier
ds_read_b64 v[26:27], v239 offset:44032
ds_read_b64 v[30:31], v239 offset:44544
ds_read_b64 v[34:35], v239 offset:45056
ds_read_b64 v[38:39], v239 offset:45568
ds_read_b64 v[202:203], v239 offset:41984
ds_read_b64 v[206:207], v239 offset:42496
ds_read_b64 v[210:211], v239 offset:43008
ds_read_b64 v[214:215], v239 offset:43520
s_waitcnt lgkmcnt(7)
buffer_store_dwordx4 v[24:27], v1, s[4:7], s25 offen offset:0 sc1
s_waitcnt lgkmcnt(6)
buffer_store_dwordx4 v[28:31], v1, s[4:7], s25 offen offset:1024 sc1
s_waitcnt lgkmcnt(5)
buffer_store_dwordx4 v[32:35], v1, s[4:7], s25 offen offset:2048 sc1
s_waitcnt lgkmcnt(4)
buffer_store_dwordx4 v[36:39], v1, s[4:7], s25 offen offset:3072 sc1
s_waitcnt lgkmcnt(0)
v_cmp_eq_u32 vcc, s22, v240
s_nop 1
v_cndmask_b32 v202, 0, v202, vcc
v_cndmask_b32 v203, 0, v203, vcc
v_cndmask_b32 v206, 0, v206, vcc
v_cndmask_b32 v207, 0, v207, vcc
v_cndmask_b32 v210, 0, v210, vcc
v_cndmask_b32 v211, 0, v211, vcc
v_cndmask_b32 v214, 0, v214, vcc
v_cndmask_b32 v215, 0, v215, vcc
s_waitcnt vmcnt(0)
v_mov_b32 v3, 1
s_mov_b64 exec, 1
buffer_store_dword v3, off, s[4:7], s23 sc1
s_mov_b64 exec, -1
ds_read_b128 v[24:27], v1 offset:0
ds_read_b128 v[28:31], v1 offset:20480
ds_read_b128 v[32:35], v1 offset:40960
ds_read_b128 v[36:39], v238 offset:0
s_waitcnt lgkmcnt(3)
v_mfma_f32_16x16x32_bf16 v[104:107], a[240:243], v[24:27], 0
ds_read_b128 v[40:43], v1 offset:1024
ds_read_b128 v[44:47], v1 offset:21504
s_waitcnt lgkmcnt(4)
v_mfma_f32_16x16x32_bf16 v[108:111], a[240:243], v[28:31], 0
ds_read_b128 v[48:51], v1 offset:41984
ds_read_b128 v[52:55], v238 offset:1024
s_waitcnt lgkmcnt(5)
v_mfma_f32_16x16x32_bf16 v[112:115], a[240:243], v[32:35], 0
s_waitcnt lgkmcnt(4)
v_mfma_f32_16x16x32_bf16 v[116:119], a[240:243], v[36:39], 0
s_waitcnt lgkmcnt(3)
v_mfma_f32_16x16x32_bf16 v[104:107], a[244:247], v[40:43], v[104:107]
ds_read_b128 v[24:27], v1 offset:2048
ds_read_b128 v[28:31], v1 offset:22528
s_waitcnt lgkmcnt(4)
v_mfma_f32_16x16x32_bf16 v[108:111], a[244:247], v[44:47], v[108:111]
ds_read_b128 v[32:35], v1 offset:43008
ds_read_b128 v[36:39], v238 offset:2048
s_waitcnt lgkmcnt(5)
v_mfma_f32_16x16x32_bf16 v[112:115], a[244:247], v[48:51], v[112:115]
s_waitcnt lgkmcnt(4)
v_mfma_f32_16x16x32_bf16 v[116:119], a[244:247], v[52:55], v[116:119]
s_waitcnt lgkmcnt(3)
v_mfma_f32_16x16x32_bf16 v[104:107], a[248:251], v[24:27], v[104:107]
ds_read_b128 v[40:43], v1 offset:3072
ds_read_b128 v[44:47], v1 offset:23552
s_waitcnt lgkmcnt(4)
v_mfma_f32_16x16x32_bf16 v[108:111], a[248:251], v[28:31], v[108:111]
ds_read_b128 v[48:51], v1 offset:44032
ds_read_b128 v[52:55], v238 offset:3072
s_waitcnt lgkmcnt(5)
v_mfma_f32_16x16x32_bf16 v[112:115], a[248:251], v[32:35], v[112:115]
s_waitcnt lgkmcnt(4)
v_mfma_f32_16x16x32_bf16 v[116:119], a[248:251], v[36:39], v[116:119]
s_waitcnt lgkmcnt(3)
v_mfma_f32_16x16x32_bf16 v[104:107], a[252:255], v[40:43], v[104:107]
ds_read_b128 v[24:27], v1 offset:4096
ds_read_b128 v[28:31], v1 offset:24576
s_waitcnt lgkmcnt(4)
v_mfma_f32_16x16x32_bf16 v[108:111], a[252:255], v[44:47], v[108:111]
ds_read_b128 v[32:35], v1 offset:45056
ds_read_b128 v[36:39], v238 offset:4096
s_waitcnt lgkmcnt(5)
v_mfma_f32_16x16x32_bf16 v[112:115], a[252:255], v[48:51], v[112:115]
s_waitcnt lgkmcnt(4)
v_mfma_f32_16x16x32_bf16 v[116:119], a[252:255], v[52:55], v[116:119]
s_waitcnt lgkmcnt(3)
v_mfma_f32_16x16x32_bf16 v[104:107], a[0:3], v[24:27], v[104:107]
ds_read_b128 v[40:43], v1 offset:5120
ds_read_b128 v[44:47], v1 offset:25600
s_waitcnt lgkmcnt(4)
v_mfma_f32_16x16x32_bf16 v[108:111], a[0:3], v[28:31], v[108:111]
ds_read_b128 v[48:51], v1 offset:46080
ds_read_b128 v[52:55], v238 offset:5120
s_waitcnt lgkmcnt(5)
v_mfma_f32_16x16x32_bf16 v[112:115], a[0:3], v[32:35], v[112:115]
s_waitcnt lgkmcnt(4)
v_mfma_f32_16x16x32_bf16 v[116:119], a[0:3], v[36:39], v[116:119]
s_waitcnt lgkmcnt(3)
v_mfma_f32_16x16x32_bf16 v[104:107], a[4:7], v[40:43], v[104:107]
ds_read_b128 v[24:27], v1 offset:6144
ds_read_b128 v[28:31], v1 offset:26624
s_waitcnt lgkmcnt(4)
v_mfma_f32_16x16x32_bf16 v[108:111], a[4:7], v[44:47], v[108:111]
ds_read_b128 v[32:35], v1 offset:47104
ds_read_b128 v[36:39], v238 offset:6144
s_waitcnt lgkmcnt(5)
v_mfma_f32_16x16x32_bf16 v[112:115], a[4:7], v[48:51], v[112:115]
s_waitcnt lgkmcnt(4)
v_mfma_f32_16x16x32_bf16 v[116:119], a[4:7], v[52:55], v[116:119]
s_waitcnt lgkmcnt(3)
v_mfma_f32_16x16x32_bf16 v[104:107], a[8:11], v[24:27], v[104:107]
ds_read_b128 v[40:43], v1 offset:7168
ds_read_b128 v[44:47], v1 offset:27648
s_waitcnt lgkmcnt(4)
v_mfma_f32_16x16x32_bf16 v[108:111], a[8:11], v[28:31], v[108:111]
ds_read_b128 v[48:51], v1 offset:48128
ds_read_b128 v[52:55], v238 offset:7168
s_waitcnt lgkmcnt(5)
v_mfma_f32_16x16x32_bf16 v[112:115], a[8:11], v[32:35], v[112:115]
s_waitcnt lgkmcnt(4)
v_mfma_f32_16x16x32_bf16 v[116:119], a[8:11], v[36:39], v[116:119]
s_waitcnt lgkmcnt(3)
v_mfma_f32_16x16x32_bf16 v[104:107], a[12:15], v[40:43], v[104:107]
ds_read_b128 v[24:27], v1 offset:8192
ds_read_b128 v[28:31], v1 offset:28672
s_waitcnt lgkmcnt(4)
v_mfma_f32_16x16x32_bf16 v[108:111], a[12:15], v[44:47], v[108:111]
ds_read_b128 v[32:35], v1 offset:49152
ds_read_b128 v[36:39], v238 offset:8192
s_waitcnt lgkmcnt(5)
v_mfma_f32_16x16x32_bf16 v[112:115], a[12:15], v[48:51], v[112:115]
s_waitcnt lgkmcnt(4)
v_mfma_f32_16x16x32_bf16 v[116:119], a[12:15], v[52:55], v[116:119]
s_waitcnt lgkmcnt(3)
v_mfma_f32_16x16x32_bf16 v[104:107], a[16:19], v[24:27], v[104:107]
ds_read_b128 v[40:43], v1 offset:9216
ds_read_b128 v[44:47], v1 offset:29696
s_waitcnt lgkmcnt(4)
v_mfma_f32_16x16x32_bf16 v[108:111], a[16:19], v[28:31], v[108:111]
ds_read_b128 v[48:51], v1 offset:50176
ds_read_b128 v[52:55], v238 offset:9216
s_waitcnt lgkmcnt(5)
v_mfma_f32_16x16x32_bf16 v[112:115], a[16:19], v[32:35], v[112:115]
s_waitcnt lgkmcnt(4)
v_mfma_f32_16x16x32_bf16 v[116:119], a[16:19], v[36:39], v[116:119]
s_waitcnt lgkmcnt(3)
v_mfma_f32_16x16x32_bf16 v[104:107], a[20:23], v[40:43], v[104:107]
ds_read_b128 v[24:27], v1 offset:10240
ds_read_b128 v[28:31], v1 offset:30720
s_waitcnt lgkmcnt(4)
v_mfma_f32_16x16x32_bf16 v[108:111], a[20:23], v[44:47], v[108:111]
ds_read_b128 v[32:35], v1 offset:51200
ds_read_b128 v[36:39], v238 offset:10240
s_waitcnt lgkmcnt(5)
v_mfma_f32_16x16x32_bf16 v[112:115], a[20:23], v[48:51], v[112:115]
s_waitcnt lgkmcnt(4)
v_mfma_f32_16x16x32_bf16 v[116:119], a[20:23], v[52:55], v[116:119]
s_waitcnt lgkmcnt(3)
v_mfma_f32_16x16x32_bf16 v[104:107], a[24:27], v[24:27], v[104:107]
ds_read_b128 v[40:43], v1 offset:11264
ds_read_b128 v[44:47], v1 offset:31744
s_waitcnt lgkmcnt(4)
v_mfma_f32_16x16x32_bf16 v[108:111], a[24:27], v[28:31], v[108:111]
ds_read_b128 v[48:51], v1 offset:52224
ds_read_b128 v[52:55], v238 offset:11264
s_waitcnt lgkmcnt(5)
v_mfma_f32_16x16x32_bf16 v[112:115], a[24:27], v[32:35], v[112:115]
s_waitcnt lgkmcnt(4)
v_mfma_f32_16x16x32_bf16 v[116:119], a[24:27], v[36:39], v[116:119]
s_waitcnt lgkmcnt(3)
v_mfma_f32_16x16x32_bf16 v[104:107], a[28:31], v[40:43], v[104:107]
ds_read_b128 v[24:27], v1 offset:12288
ds_read_b128 v[28:31], v1 offset:32768
s_waitcnt lgkmcnt(4)
v_mfma_f32_16x16x32_bf16 v[108:111], a[28:31], v[44:47], v[108:111]
ds_read_b128 v[32:35], v1 offset:53248
ds_read_b128 v[36:39], v238 offset:12288
s_waitcnt lgkmcnt(5)
v_mfma_f32_16x16x32_bf16 v[112:115], a[28:31], v[48:51], v[112:115]
s_waitcnt lgkmcnt(4)
v_mfma_f32_16x16x32_bf16 v[116:119], a[28:31], v[52:55], v[116:119]
s_waitcnt lgkmcnt(3)
v_mfma_f32_16x16x32_bf16 v[104:107], a[32:35], v[24:27], v[104:107]
ds_read_b128 v[40:43], v1 offset:13312
ds_read_b128 v[44:47], v1 offset:33792
s_waitcnt lgkmcnt(4)
v_mfma_f32_16x16x32_bf16 v[108:111], a[32:35], v[28:31], v[108:111]
ds_read_b128 v[48:51], v1 offset:54272
ds_read_b128 v[52:55], v238 offset:13312
s_waitcnt lgkmcnt(5)
v_mfma_f32_16x16x32_bf16 v[112:115], a[32:35], v[32:35], v[112:115]
s_waitcnt lgkmcnt(4)
v_mfma_f32_16x16x32_bf16 v[116:119], a[32:35], v[36:39], v[116:119]
s_waitcnt lgkmcnt(3)
v_mfma_f32_16x16x32_bf16 v[104:107], a[36:39], v[40:43], v[104:107]
ds_read_b128 v[24:27], v1 offset:14336
ds_read_b128 v[28:31], v1 offset:34816
s_waitcnt lgkmcnt(4)
v_mfma_f32_16x16x32_bf16 v[108:111], a[36:39], v[44:47], v[108:111]
ds_read_b128 v[32:35], v1 offset:55296
ds_read_b128 v[36:39], v238 offset:14336
s_waitcnt lgkmcnt(5)
v_mfma_f32_16x16x32_bf16 v[112:115], a[36:39], v[48:51], v[112:115]
s_waitcnt lgkmcnt(4)
v_mfma_f32_16x16x32_bf16 v[116:119], a[36:39], v[52:55], v[116:119]
s_waitcnt lgkmcnt(3)
v_mfma_f32_16x16x32_bf16 v[104:107], a[40:43], v[24:27], v[104:107]
ds_read_b128 v[40:43], v1 offset:15360
ds_read_b128 v[44:47], v1 offset:35840
s_waitcnt lgkmcnt(4)
v_mfma_f32_16x16x32_bf16 v[108:111], a[40:43], v[28:31], v[108:111]
ds_read_b128 v[48:51], v1 offset:56320
ds_read_b128 v[52:55], v238 offset:15360
s_waitcnt lgkmcnt(5)
v_mfma_f32_16x16x32_bf16 v[112:115], a[40:43], v[32:35], v[112:115]
s_waitcnt lgkmcnt(4)
v_mfma_f32_16x16x32_bf16 v[116:119], a[40:43], v[36:39], v[116:119]
s_waitcnt lgkmcnt(3)
v_mfma_f32_16x16x32_bf16 v[104:107], a[44:47], v[40:43], v[104:107]
ds_read_b64 v[24:25], v2 offset:16384
ds_read_b64 v[26:27], v2 offset:16896
ds_read_b64 v[28:29], v2 offset:36864
ds_read_b64 v[30:31], v2 offset:37376
s_waitcnt lgkmcnt(6)
v_mfma_f32_16x16x32_bf16 v[108:111], a[44:47], v[44:47], v[108:111]
ds_read_b64 v[32:33], v2 offset:57344
ds_read_b64 v[34:35], v2 offset:57856
ds_read_b64 v[36:37], v239 offset:16384
ds_read_b64 v[38:39], v239 offset:16896
s_waitcnt lgkmcnt(9)
v_mfma_f32_16x16x32_bf16 v[112:115], a[44:47], v[48:51], v[112:115]
s_waitcnt lgkmcnt(8)
v_mfma_f32_16x16x32_bf16 v[116:119], a[44:47], v[52:55], v[116:119]
s_waitcnt lgkmcnt(6)
v_mfma_f32_16x16x32_bf16 v[104:107], a[48:51], v[24:27], v[104:107]
ds_read_b64 v[40:41], v2 offset:17408
ds_read_b64 v[42:43], v2 offset:17920
ds_read_b64 v[44:45], v2 offset:37888
ds_read_b64 v[46:47], v2 offset:38400
s_waitcnt lgkmcnt(8)
v_mfma_f32_16x16x32_bf16 v[108:111], a[48:51], v[28:31], v[108:111]
ds_read_b64 v[48:49], v2 offset:58368
ds_read_b64 v[50:51], v2 offset:58880
ds_read_b64 v[52:53], v239 offset:17408
ds_read_b64 v[54:55], v239 offset:17920
s_waitcnt lgkmcnt(10)
v_mfma_f32_16x16x32_bf16 v[112:115], a[48:51], v[32:35], v[112:115]
s_waitcnt lgkmcnt(8)
v_mfma_f32_16x16x32_bf16 v[116:119], a[48:51], v[36:39], v[116:119]
s_waitcnt lgkmcnt(6)
v_mfma_f32_16x16x32_bf16 v[104:107], a[52:55], v[40:43], v[104:107]
ds_read_b64 v[24:25], v2 offset:18432
ds_read_b64 v[26:27], v2 offset:18944
ds_read_b64 v[28:29], v2 offset:38912
ds_read_b64 v[30:31], v2 offset:39424
s_waitcnt lgkmcnt(8)
v_mfma_f32_16x16x32_bf16 v[108:111], a[52:55], v[44:47], v[108:111]
ds_read_b64 v[32:33], v2 offset:59392
ds_read_b64 v[34:35], v2 offset:59904
ds_read_b64 v[36:37], v239 offset:18432
ds_read_b64 v[38:39], v239 offset:18944
s_waitcnt lgkmcnt(10)
v_mfma_f32_16x16x32_bf16 v[112:115], a[52:55], v[48:51], v[112:115]
s_waitcnt lgkmcnt(8)
v_mfma_f32_16x16x32_bf16 v[116:119], a[52:55], v[52:55], v[116:119]
s_waitcnt lgkmcnt(6)
v_mfma_f32_16x16x32_bf16 v[104:107], a[56:59], v[24:27], v[104:107]
ds_read_b64 v[40:41], v2 offset:19456
ds_read_b64 v[42:43], v2 offset:19968
ds_read_b64 v[44:45], v2 offset:39936
ds_read_b64 v[46:47], v2 offset:40448
s_waitcnt lgkmcnt(8)
v_mfma_f32_16x16x32_bf16 v[108:111], a[56:59], v[28:31], v[108:111]
ds_read_b64 v[48:49], v2 offset:60416
ds_read_b64 v[50:51], v2 offset:60928
ds_read_b64 v[52:53], v239 offset:19456
ds_read_b64 v[54:55], v239 offset:19968
s_waitcnt lgkmcnt(10)
v_mfma_f32_16x16x32_bf16 v[112:115], a[56:59], v[32:35], v[112:115]
s_waitcnt lgkmcnt(8)
v_mfma_f32_16x16x32_bf16 v[116:119], a[56:59], v[36:39], v[116:119]
s_waitcnt lgkmcnt(6)
v_mfma_f32_16x16x32_bf16 v[104:107], a[60:63], v[40:43], v[104:107]
s_waitcnt lgkmcnt(4)
v_mfma_f32_16x16x32_bf16 v[108:111], a[60:63], v[44:47], v[108:111]
s_waitcnt lgkmcnt(2)
v_mfma_f32_16x16x32_bf16 v[112:115], a[60:63], v[48:51], v[112:115]
s_waitcnt lgkmcnt(0)
v_mfma_f32_16x16x32_bf16 v[116:119], a[60:63], v[52:55], v[116:119]
s_mov_b32 s24, 0x3ea52b5c
v_mul_f32 v140, s24, v140
v_mul_f32 v141, s24, v141
v_mul_f32 v142, s24, v142
v_mul_f32 v143, s24, v143
v_pk_fma_f32 v[104:105], v[180:181], v[136:137], v[104:105] op_sel:[0,0,0] op_sel_hi:[1,0,1]
v_pk_fma_f32 v[106:107], v[182:183], v[136:137], v[106:107] op_sel:[0,0,0] op_sel_hi:[1,0,1]
v_pk_mul_f32 v[104:105], v[104:105], v[140:141] op_sel:[0,0] op_sel_hi:[1,0]
v_pk_mul_f32 v[106:107], v[106:107], v[140:141] op_sel:[0,0] op_sel_hi:[1,0]
v_cvt_pk_bf16_f32 v200, v104, v105
v_cvt_pk_bf16_f32 v201, v106, v107
v_pk_fma_f32 v[108:109], v[180:181], v[136:137], v[108:109] op_sel:[0,1,0] op_sel_hi:[1,1,1]
v_pk_fma_f32 v[110:111], v[182:183], v[136:137], v[110:111] op_sel:[0,1,0] op_sel_hi:[1,1,1]
v_pk_mul_f32 v[108:109], v[108:109], v[140:141] op_sel:[0,1] op_sel_hi:[1,1]
v_pk_mul_f32 v[110:111], v[110:111], v[140:141] op_sel:[0,1] op_sel_hi:[1,1]
v_cvt_pk_bf16_f32 v204, v108, v109
v_cvt_pk_bf16_f32 v205, v110, v111
v_pk_fma_f32 v[112:113], v[180:181], v[138:139], v[112:113] op_sel:[0,0,0] op_sel_hi:[1,0,1]
v_pk_fma_f32 v[114:115], v[182:183], v[138:139], v[114:115] op_sel:[0,0,0] op_sel_hi:[1,0,1]
v_pk_mul_f32 v[112:113], v[112:113], v[142:143] op_sel:[0,0] op_sel_hi:[1,0]
v_pk_mul_f32 v[114:115], v[114:115], v[142:143] op_sel:[0,0] op_sel_hi:[1,0]
v_cvt_pk_bf16_f32 v208, v112, v113
v_cvt_pk_bf16_f32 v209, v114, v115
v_pk_fma_f32 v[116:117], v[180:181], v[138:139], v[116:117] op_sel:[0,1,0] op_sel_hi:[1,1,1]
v_pk_fma_f32 v[118:119], v[182:183], v[138:139], v[118:119] op_sel:[0,1,0] op_sel_hi:[1,1,1]
v_pk_mul_f32 v[116:117], v[116:117], v[142:143] op_sel:[0,1] op_sel_hi:[1,1]
v_pk_mul_f32 v[118:119], v[118:119], v[142:143] op_sel:[0,1] op_sel_hi:[1,1]
v_cvt_pk_bf16_f32 v212, v116, v117
v_cvt_pk_bf16_f32 v213, v118, v119
s_nop 7
s_branch FE2
FK4:
s_mul_i32 s24, s21, 960
s_lshl_b32 s25, s22, 6
s_add_u32 s24, s24, s25
s_add_u32 s24, s24, 7700480
v_lshlrev_b32 v3, 4, v240
v_lshlrev_b32 v192, 2, v241
buffer_load_dwordx4 v[176:179], v3, s[4:7], s24 offen
buffer_load_dwordx4 v[180:183], v3, s[4:7], s24 offen offset:512
buffer_load_dword v188, v192, s[4:7], s24 offen offset:256
buffer_load_dword v184, v192, s[4:7], s24 offen offset:768
s_lshl_b32 s26, s60, 9
s_and_b32 s26, s26, 0xfffff000
s_lshl_b32 s27, s22, 7
s_add_u32 s26, s26, s27
s_add_u32 s26, s26, 12967936
v_lshrrev_b32 v24, 3, v0
v_lshlrev_b32 v24, 9, v24
v_and_b32 v25, 7, v0
v_lshlrev_b32 v25, 4, v25
v_add_u32 v24, v24, v25
buffer_load_dwordx4 v[28:31], v24, s[4:7], s26 offen
s_mul_i32 s69, s62, 20480
s_add_u32 s69, s69, 7725056
s_mul_i32 s70, s22, 20480
s_mov_b32 m0, s70
s_nop 0
buffer_load_dwordx4 v1, s[4:7], s69 offen offset:0 sc1 lds
buffer_load_dwordx4 a[0:3], v1, s[4:7], s40 offen
buffer_load_dwordx4 a[4:7], v1, s[4:7], s41 offen
s_mov_b32 m0, s70
s_nop 0
buffer_load_dwordx4 v1, s[4:7], s69 offen offset:1024 sc1 lds
buffer_load_dwordx4 a[8:11], v1, s[4:7], s43 offen
buffer_load_dwordx4 a[12:15], v1, s[4:7], s40 offen offset:1024
s_mov_b32 m0, s70
s_nop 0
buffer_load_dwordx4 v1, s[4:7], s69 offen offset:2048 sc1 lds
buffer_load_dwordx4 a[16:19], v1, s[4:7], s41 offen offset:1024
buffer_load_dwordx4 a[20:23], v1, s[4:7], s43 offen offset:1024
s_mov_b32 m0, s70
s_nop 0
buffer_load_dwordx4 v1, s[4:7], s69 offen offset:3072 sc1 lds
buffer_load_dwordx4 a[24:27], v1, s[4:7], s40 offen offset:2048
buffer_load_dwordx4 a[28:31], v1, s[4:7], s41 offen offset:2048
s_add_u32 s69, s69, 4096
s_add_u32 s70, s70, 4096
s_mov_b32 m0, s70
s_nop 0
buffer_load_dwordx4 v1, s[4:7], s69 offen offset:0 sc1 lds
buffer_load_dwordx4 a[32:35], v1, s[4:7], s43 offen offset:2048
buffer_load_dwordx4 a[36:39], v1, s[4:7], s40 offen offset:3072
s_mov_b32 m0, s70
s_nop 0
buffer_load_dwordx4 v1, s[4:7], s69 offen offset:1024 sc1 lds
buffer_load_dwordx4 a[40:43], v1, s[4:7], s41 offen offset:3072
buffer_load_dwordx4 a[44:47], v1, s[4:7], s43 offen offset:3072
s_mov_b32 m0, s70
s_nop 0
buffer_load_dwordx4 v1, s[4:7], s69 offen offset:2048 sc1 lds
s_add_u32 s40, s40, 4096
buffer_load_dwordx4 a[48:51], v1, s[4:7], s40 offen
s_add_u32 s41, s41, 4096
buffer_load_dwordx4 a[52:55], v1, s[4:7], s41 offen
s_mov_b32 m0, s70
s_nop 0
buffer_load_dwordx4 v1, s[4:7], s69 offen offset:3072 sc1 lds
s_add_u32 s43, s43, 4096
buffer_load_dwordx4 a[56:59], v1, s[4:7], s43 offen
buffer_load_dwordx4 a[60:63], v1, s[4:7], s40 offen offset:1024
s_add_u32 s69, s69, 4096
s_add_u32 s70, s70, 4096
s_mov_b32 m0, s70
s_nop 0
buffer_load_dwordx4 v1, s[4:7], s69 offen offset:0 sc1 lds
buffer_load_dwordx4 a[64:67], v1, s[4:7], s41 offen offset:1024
buffer_load_dwordx4 a[68:71], v1, s[4:7], s43 offen offset:1024
s_mov_b32 m0, s70
s_nop 0
buffer_load_dwordx4 v1, s[4:7], s69 offen offset:1024 sc1 lds
buffer_load_dwordx4 a[72:75], v1, s[4:7], s40 offen offset:2048
buffer_load_dwordx4 a[76:79], v1, s[4:7], s41 offen offset:2048
s_waitcnt vmcnt(30)
v_mov_b32 v32, v28
v_mov_b32 v33, v29
v_mov_b32 v34, v30
v_mov_b32 v35, v31
v_permlane32_swap_b32 v28, v32
v_permlane32_swap_b32 v29, v33
v_permlane32_swap_b32 v30, v34
v_permlane32_swap_b32 v31, v35
v_add_f32 v28, v28, v32
v_add_f32 v29, v29, v33
v_add_f32 v30, v30, v34
v_add_f32 v31, v31, v35
v_mov_b32 v32, v28
v_mov_b32 v33, v29
v_mov_b32 v34, v30
v_mov_b32 v35, v31
v_permlane16_swap_b32 v28, v32
v_permlane16_swap_b32 v29, v33
v_permlane16_swap_b32 v30, v34
v_permlane16_swap_b32 v31, v35
v_add_f32 v28, v28, v32
v_add_f32 v29, v29, v33
v_add_f32 v30, v30, v34
v_add_f32 v31, v31, v35
v_add_f32_dpp v28, v28, v28 row_ror:8 row_mask:0xf bank_mask:0xf
v_add_f32_dpp v29, v29, v29 row_ror:8 row_mask:0xf bank_mask:0xf
v_add_f32_dpp v30, v30, v30 row_ror:8 row_mask:0xf bank_mask:0xf
v_add_f32_dpp v31, v31, v31 row_ror:8 row_mask:0xf bank_mask:0xf
s_mov_b32 s26, 0xbacccccd
s_mov_b32 s27, 0x3acccccd
v_mul_f32 v32, s26, v28
v_mul_f32 v33, s26, v30
v_mul_f32 v34, s27, v29
v_mul_f32 v35, s27, v31
v_fma_f32 v34, -v32, v32, v34
v_fma_f32 v35, -v33, v33, v35
v_max_f32 v34, 0, v34
v_max_f32 v35, 0, v35
v_add_f32 v34, 0x3727c5ac, v34
v_add_f32 v35, 0x3727c5ac, v35
v_rsq_f32 v34, v34
v_rsq_f32 v35, v35
v_and_b32 v24, 7, v0
v_lshlrev_b32 v24, 3, v24
s_lshl_b32 s26, s22, 6
s_add_u32 s26, s26, 102400
v_add_u32 v24, s26, v24
s_mov_b64 exec, 0xff
ds_write_b64 v24, v[32:33]
ds_write_b64 v24, v[34:35] offset:256
s_mov_b64 exec, -1
s_waitcnt vmcnt(17)
s_waitcnt lgkmcnt(0)
s_barrier
ds_read_b128 v[24:27], v1 offset:0
ds_read_b128 v[28:31], v1 offset:20480
ds_read_b128 v[32:35], v1 offset:40960
ds_read_b128 v[36:39], v238 offset:0
s_waitcnt lgkmcnt(3)
v_mfma_f32_16x16x32_bf16 v[56:59], a[0:3], v[24:27], 0
ds_read_b128 v[40:43], v1 offset:1024
s_waitcnt lgkmcnt(3)
v_mfma_f32_16x16x32_bf16 v[60:63], a[0:3], v[28:31], 0
ds_read_b128 v[44:47], v1 offset:21504
s_waitcnt lgkmcnt(3)
v_mfma_f32_16x16x32_bf16 v[64:67], a[0:3], v[32:35], 0
ds_read_b128 v[48:51], v1 offset:41984
s_waitcnt lgkmcnt(3)
v_mfma_f32_16x16x32_bf16 v[68:71], a[0:3], v[36:39], 0
ds_read_b128 v[52:55], v238 offset:1024
v_mfma_f32_16x16x32_bf16 v[72:75], v[24:27], a[4:7], 0
s_mov_b32 m0, s70
s_nop 0
buffer_load_dwordx4 v1, s[4:7], s69 offen offset:2048 sc1 lds
v_mfma_f32_16x16x32_bf16 v[76:79], v[28:31], a[4:7], 0
buffer_load_dwordx4 a[80:83], v1, s[4:7], s43 offen offset:2048
v_mfma_f32_16x16x32_bf16 v[80:83], v[32:35], a[4:7], 0
buffer_load_dwordx4 a[84:87], v1, s[4:7], s40 offen offset:3072
v_mfma_f32_16x16x32_bf16 v[84:87], v[36:39], a[4:7], 0
buffer_load_dwordx4 a[88:91], v1, s[4:7], s41 offen offset:3072
v_mfma_f32_16x16x32_bf16 v[88:91], v[24:27], a[8:11], 0
v_mfma_f32_16x16x32_bf16 v[92:95], v[28:31], a[8:11], 0
v_mfma_f32_16x16x32_bf16 v[96:99], v[32:35], a[8:11], 0
v_mfma_f32_16x16x32_bf16 v[100:103], v[36:39], a[8:11], 0
s_waitcnt lgkmcnt(3)
v_mfma_f32_16x16x32_bf16 v[56:59], a[12:15], v[40:43], v[56:59]
ds_read_b128 v[24:27], v1 offset:2048
s_waitcnt lgkmcnt(3)
v_mfma_f32_16x16x32_bf16 v[60:63], a[12:15], v[44:47], v[60:63]
ds_read_b128 v[28:31], v1 offset:22528
s_waitcnt lgkmcnt(3)
v_mfma_f32_16x16x32_bf16 v[64:67], a[12:15], v[48:51], v[64:67]
ds_read_b128 v[32:35], v1 offset:43008
s_waitcnt lgkmcnt(3)
v_mfma_f32_16x16x32_bf16 v[68:71], a[12:15], v[52:55], v[68:71]
ds_read_b128 v[36:39], v238 offset:2048
v_mfma_f32_16x16x32_bf16 v[72:75], v[40:43], a[16:19], v[72:75]
s_mov_b32 m0, s70
s_nop 0
buffer_load_dwordx4 v1, s[4:7], s69 offen offset:3072 sc1 lds
v_mfma_f32_16x16x32_bf16 v[76:79], v[44:47], a[16:19], v[76:79]
buffer_load_dwordx4 a[92:95], v1, s[4:7], s43 offen offset:3072
v_mfma_f32_16x16x32_bf16 v[80:83], v[48:51], a[16:19], v[80:83]
s_add_u32 s40, s40, 4096
buffer_load_dwordx4 a[96:99], v1, s[4:7], s40 offen
v_mfma_f32_16x16x32_bf16 v[84:87], v[52:55], a[16:19], v[84:87]
s_add_u32 s41, s41, 4096
buffer_load_dwordx4 a[100:103], v1, s[4:7], s41 offen
v_mfma_f32_16x16x32_bf16 v[88:91], v[40:43], a[20:23], v[88:91]
v_mfma_f32_16x16x32_bf16 v[92:95], v[44:47], a[20:23], v[92:95]
v_mfma_f32_16x16x32_bf16 v[96:99], v[48:51], a[20:23], v[96:99]
v_mfma_f32_16x16x32_bf16 v[100:103], v[52:55], a[20:23], v[100:103]
s_waitcnt lgkmcnt(3)
v_mfma_f32_16x16x32_bf16 v[56:59], a[24:27], v[24:27], v[56:59]
ds_read_b128 v[40:43], v1 offset:3072
s_waitcnt lgkmcnt(3)
v_mfma_f32_16x16x32_bf16 v[60:63], a[24:27], v[28:31], v[60:63]
ds_read_b128 v[44:47], v1 offset:23552
s_waitcnt lgkmcnt(3)
v_mfma_f32_16x16x32_bf16 v[64:67], a[24:27], v[32:35], v[64:67]
ds_read_b128 v[48:51], v1 offset:44032
s_waitcnt lgkmcnt(3)
v_mfma_f32_16x16x32_bf16 v[68:71], a[24:27], v[36:39], v[68:71]
ds_read_b128 v[52:55], v238 offset:3072
v_mfma_f32_16x16x32_bf16 v[72:75], v[24:27], a[28:31], v[72:75]
s_add_u32 s69, s69, 4096
s_add_u32 s70, s70, 4096
s_mov_b32 m0, s70
s_nop 0
buffer_load_dwordx4 v1, s[4:7], s69 offen offset:0 sc1 lds
v_mfma_f32_16x16x32_bf16 v[76:79], v[28:31], a[28:31], v[76:79]
s_add_u32 s43, s43, 4096
buffer_load_dwordx4 a[104:107], v1, s[4:7], s43 offen
v_mfma_f32_16x16x32_bf16 v[80:83], v[32:35], a[28:31], v[80:83]
buffer_load_dwordx4 a[108:111], v1, s[4:7], s40 offen offset:1024
v_mfma_f32_16x16x32_bf16 v[84:87], v[36:39], a[28:31], v[84:87]
buffer_load_dwordx4 a[112:115], v1, s[4:7], s41 offen offset:1024
s_waitcnt vmcnt(28)
v_mfma_f32_16x16x32_bf16 v[88:91], v[24:27], a[32:35], v[88:91]
v_mfma_f32_16x16x32_bf16 v[92:95], v[28:31], a[32:35], v[92:95]
v_mfma_f32_16x16x32_bf16 v[96:99], v[32:35], a[32:35], v[96:99]
v_mfma_f32_16x16x32_bf16 v[100:103], v[36:39], a[32:35], v[100:103]
s_waitcnt vmcnt(27)
s_waitcnt lgkmcnt(3)
v_mfma_f32_16x16x32_bf16 v[56:59], a[36:39], v[40:43], v[56:59]
ds_read_b128 v[24:27], v1 offset:4096
s_waitcnt lgkmcnt(3)
v_mfma_f32_16x16x32_bf16 v[60:63], a[36:39], v[44:47], v[60:63]
ds_read_b128 v[28:31], v1 offset:24576
s_waitcnt lgkmcnt(3)
v_mfma_f32_16x16x32_bf16 v[64:67], a[36:39], v[48:51], v[64:67]
ds_read_b128 v[32:35], v1 offset:45056
s_waitcnt lgkmcnt(3)
v_mfma_f32_16x16x32_bf16 v[68:71], a[36:39], v[52:55], v[68:71]
ds_read_b128 v[36:39], v238 offset:4096
s_waitcnt vmcnt(25)
v_mfma_f32_16x16x32_bf16 v[72:75], v[40:43], a[40:43], v[72:75]
s_mov_b32 m0, s70
s_nop 0
buffer_load_dwordx4 v1, s[4:7], s69 offen offset:1024 sc1 lds
v_mfma_f32_16x16x32_bf16 v[76:79], v[44:47], a[40:43], v[76:79]
buffer_load_dwordx4 a[116:119], v1, s[4:7], s43 offen offset:1024
v_mfma_f32_16x16x32_bf16 v[80:83], v[48:51], a[40:43], v[80:83]
buffer_load_dwordx4 a[120:123], v1, s[4:7], s40 offen offset:2048
v_mfma_f32_16x16x32_bf16 v[84:87], v[52:55], a[40:43], v[84:87]
buffer_load_dwordx4 a[124:127], v1, s[4:7], s41 offen offset:2048
s_waitcnt vmcnt(28)
v_mfma_f32_16x16x32_bf16 v[88:91], v[40:43], a[44:47], v[88:91]
v_mfma_f32_16x16x32_bf16 v[92:95], v[44:47], a[44:47], v[92:95]
v_mfma_f32_16x16x32_bf16 v[96:99], v[48:51], a[44:47], v[96:99]
v_mfma_f32_16x16x32_bf16 v[100:103], v[52:55], a[44:47], v[100:103]
s_waitcnt vmcnt(18)
s_barrier
s_waitcnt lgkmcnt(3)
v_mfma_f32_16x16x32_bf16 v[56:59], a[48:51], v[24:27], v[56:59]
ds_read_b128 v[40:43], v1 offset:5120
s_waitcnt lgkmcnt(3)
v_mfma_f32_16x16x32_bf16 v[60:63], a[48:51], v[28:31], v[60:63]
ds_read_b128 v[44:47], v1 offset:25600
s_waitcnt lgkmcnt(3)
v_mfma_f32_16x16x32_bf16 v[64:67], a[48:51], v[32:35], v[64:67]
ds_read_b128 v[48:51], v1 offset:46080
s_waitcnt lgkmcnt(3)
v_mfma_f32_16x16x32_bf16 v[68:71], a[48:51], v[36:39], v[68:71]
ds_read_b128 v[52:55], v238 offset:5120
v_mfma_f32_16x16x32_bf16 v[72:75], v[24:27], a[52:55], v[72:75]
s_mov_b32 m0, s70
s_nop 0
buffer_load_dwordx4 v1, s[4:7], s69 offen offset:2048 sc1 lds
v_mfma_f32_16x16x32_bf16 v[76:79], v[28:31], a[52:55], v[76:79]
buffer_load_dwordx4 a[128:131], v1, s[4:7], s43 offen offset:2048
v_mfma_f32_16x16x32_bf16 v[80:83], v[32:35], a[52:55], v[80:83]
buffer_load_dwordx4 a[132:135], v1, s[4:7], s40 offen offset:3072
v_mfma_f32_16x16x32_bf16 v[84:87], v[36:39], a[52:55], v[84:87]
buffer_load_dwordx4 a[136:139], v1, s[4:7], s41 offen offset:3072
v_mfma_f32_16x16x32_bf16 v[88:91], v[24:27], a[56:59], v[88:91]
v_mfma_f32_16x16x32_bf16 v[92:95], v[28:31], a[56:59], v[92:95]
v_mfma_f32_16x16x32_bf16 v[96:99], v[32:35], a[56:59], v[96:99]
v_mfma_f32_16x16x32_bf16 v[100:103], v[36:39], a[56:59], v[100:103]
s_waitcnt lgkmcnt(3)
v_mfma_f32_16x16x32_bf16 v[56:59], a[60:63], v[40:43], v[56:59]
ds_read_b128 v[24:27], v1 offset:6144
s_waitcnt lgkmcnt(3)
v_mfma_f32_16x16x32_bf16 v[60:63], a[60:63], v[44:47], v[60:63]
ds_read_b128 v[28:31], v1 offset:26624
s_waitcnt lgkmcnt(3)
v_mfma_f32_16x16x32_bf16 v[64:67], a[60:63], v[48:51], v[64:67]
ds_read_b128 v[32:35], v1 offset:47104
s_waitcnt lgkmcnt(3)
v_mfma_f32_16x16x32_bf16 v[68:71], a[60:63], v[52:55], v[68:71]
ds_read_b128 v[36:39], v238 offset:6144
v_mfma_f32_16x16x32_bf16 v[72:75], v[40:43], a[64:67], v[72:75]
s_mov_b32 m0, s70
s_nop 0
buffer_load_dwordx4 v1, s[4:7], s69 offen offset:3072 sc1 lds
v_mfma_f32_16x16x32_bf16 v[76:79], v[44:47], a[64:67], v[76:79]
buffer_load_dwordx4 a[140:143], v1, s[4:7], s43 offen offset:3072
v_mfma_f32_16x16x32_bf16 v[80:83], v[48:51], a[64:67], v[80:83]
s_add_u32 s40, s40, 4096
buffer_load_dwordx4 a[144:147], v1, s[4:7], s40 offen
v_mfma_f32_16x16x32_bf16 v[84:87], v[52:55], a[64:67], v[84:87]
s_add_u32 s41, s41, 4096
buffer_load_dwordx4 a[148:151], v1, s[4:7], s41 offen
v_mfma_f32_16x16x32_bf16 v[88:91], v[40:43], a[68:71], v[88:91]
v_mfma_f32_16x16x32_bf16 v[92:95], v[44:47], a[68:71], v[92:95]
v_mfma_f32_16x16x32_bf16 v[96:99], v[48:51], a[68:71], v[96:99]
v_mfma_f32_16x16x32_bf16 v[100:103], v[52:55], a[68:71], v[100:103]
s_waitcnt vmcnt(25)
s_waitcnt lgkmcnt(3)
v_mfma_f32_16x16x32_bf16 v[56:59], a[72:75], v[24:27], v[56:59]
ds_read_b128 v[40:43], v1 offset:7168
s_waitcnt lgkmcnt(3)
v_mfma_f32_16x16x32_bf16 v[60:63], a[72:75], v[28:31], v[60:63]
ds_read_b128 v[44:47], v1 offset:27648
s_waitcnt lgkmcnt(3)
v_mfma_f32_16x16x32_bf16 v[64:67], a[72:75], v[32:35], v[64:67]
ds_read_b128 v[48:51], v1 offset:48128
s_waitcnt lgkmcnt(3)
v_mfma_f32_16x16x32_bf16 v[68:71], a[72:75], v[36:39], v[68:71]
ds_read_b128 v[52:55], v238 offset:7168
s_waitcnt vmcnt(24)
v_mfma_f32_16x16x32_bf16 v[72:75], v[24:27], a[76:79], v[72:75]
s_add_u32 s69, s69, 4096
s_add_u32 s70, s70, 4096
s_mov_b32 m0, s70
s_nop 0
buffer_load_dwordx4 v1, s[4:7], s69 offen offset:0 sc1 lds
v_mfma_f32_16x16x32_bf16 v[76:79], v[28:31], a[76:79], v[76:79]
s_add_u32 s43, s43, 4096
buffer_load_dwordx4 a[152:155], v1, s[4:7], s43 offen
v_mfma_f32_16x16x32_bf16 v[80:83], v[32:35], a[76:79], v[80:83]
buffer_load_dwordx4 a[156:159], v1, s[4:7], s40 offen offset:1024
v_mfma_f32_16x16x32_bf16 v[84:87], v[36:39], a[76:79], v[84:87]
buffer_load_dwordx4 a[160:163], v1, s[4:7], s41 offen offset:1024
s_waitcnt vmcnt(26)
v_mfma_f32_16x16x32_bf16 v[88:91], v[24:27], a[80:83], v[88:91]
v_mfma_f32_16x16x32_bf16 v[92:95], v[28:31], a[80:83], v[92:95]
v_mfma_f32_16x16x32_bf16 v[96:99], v[32:35], a[80:83], v[96:99]
v_mfma_f32_16x16x32_bf16 v[100:103], v[36:39], a[80:83], v[100:103]
s_waitcnt vmcnt(25)
s_waitcnt lgkmcnt(3)
v_mfma_f32_16x16x32_bf16 v[56:59], a[84:87], v[40:43], v[56:59]
ds_read_b128 v[24:27], v1 offset:8192
s_waitcnt lgkmcnt(3)
v_mfma_f32_16x16x32_bf16 v[60:63], a[84:87], v[44:47], v[60:63]
ds_read_b128 v[28:31], v1 offset:28672
s_waitcnt lgkmcnt(3)
v_mfma_f32_16x16x32_bf16 v[64:67], a[84:87], v[48:51], v[64:67]
ds_read_b128 v[32:35], v1 offset:49152
s_waitcnt lgkmcnt(3)
v_mfma_f32_16x16x32_bf16 v[68:71], a[84:87], v[52:55], v[68:71]
ds_read_b128 v[36:39], v238 offset:8192
s_waitcnt vmcnt(24)
v_mfma_f32_16x16x32_bf16 v[72:75], v[40:43], a[88:91], v[72:75]
s_mov_b32 m0, s70
s_nop 0
buffer_load_dwordx4 v1, s[4:7], s69 offen offset:1024 sc1 lds
v_mfma_f32_16x16x32_bf16 v[76:79], v[44:47], a[88:91], v[76:79]
buffer_load_dwordx4 a[164:167], v1, s[4:7], s43 offen offset:1024
v_mfma_f32_16x16x32_bf16 v[80:83], v[48:51], a[88:91], v[80:83]
buffer_load_dwordx4 a[168:171], v1, s[4:7], s40 offen offset:2048
v_mfma_f32_16x16x32_bf16 v[84:87], v[52:55], a[88:91], v[84:87]
buffer_load_dwordx4 a[172:175], v1, s[4:7], s41 offen offset:2048
s_waitcnt vmcnt(26)
v_mfma_f32_16x16x32_bf16 v[88:91], v[40:43], a[92:95], v[88:91]
v_mfma_f32_16x16x32_bf16 v[92:95], v[44:47], a[92:95], v[92:95]
v_mfma_f32_16x16x32_bf16 v[96:99], v[48:51], a[92:95], v[96:99]
v_mfma_f32_16x16x32_bf16 v[100:103], v[52:55], a[92:95], v[100:103]
s_waitcnt vmcnt(25)
s_waitcnt lgkmcnt(3)
v_mfma_f32_16x16x32_bf16 v[56:59], a[96:99], v[24:27], v[56:59]
ds_read_b128 v[40:43], v1 offset:9216
s_waitcnt lgkmcnt(3)
v_mfma_f32_16x16x32_bf16 v[60:63], a[96:99], v[28:31], v[60:63]
ds_read_b128 v[44:47], v1 offset:29696
s_waitcnt lgkmcnt(3)
v_mfma_f32_16x16x32_bf16 v[64:67], a[96:99], v[32:35], v[64:67]
ds_read_b128 v[48:51], v1 offset:50176
s_waitcnt lgkmcnt(3)
v_mfma_f32_16x16x32_bf16 v[68:71], a[96:99], v[36:39], v[68:71]
ds_read_b128 v[52:55], v238 offset:9216
s_waitcnt vmcnt(24)
v_mfma_f32_16x16x32_bf16 v[72:75], v[24:27], a[100:103], v[72:75]
s_mov_b32 m0, s70
s_nop 0
buffer_load_dwordx4 v1, s[4:7], s69 offen offset:2048 sc1 lds
v_mfma_f32_16x16x32_bf16 v[76:79], v[28:31], a[100:103], v[76:79]
buffer_load_dwordx4 a[176:179], v1, s[4:7], s43 offen offset:2048
v_mfma_f32_16x16x32_bf16 v[80:83], v[32:35], a[100:103], v[80:83]
buffer_load_dwordx4 a[180:183], v1, s[4:7], s40 offen offset:3072
v_mfma_f32_16x16x32_bf16 v[84:87], v[36:39], a[100:103], v[84:87]
buffer_load_dwordx4 a[184:187], v1, s[4:7], s41 offen offset:3072
s_waitcnt vmcnt(26)
v_mfma_f32_16x16x32_bf16 v[88:91], v[24:27], a[104:107], v[88:91]
v_mfma_f32_16x16x32_bf16 v[92:95], v[28:31], a[104:107], v[92:95]
v_mfma_f32_16x16x32_bf16 v[96:99], v[32:35], a[104:107], v[96:99]
v_mfma_f32_16x16x32_bf16 v[100:103], v[36:39], a[104:107], v[100:103]
s_waitcnt vmcnt(19)
s_barrier
s_waitcnt lgkmcnt(3)
v_mfma_f32_16x16x32_bf16 v[56:59], a[108:111], v[40:43], v[56:59]
ds_read_b128 v[24:27], v1 offset:10240
s_waitcnt lgkmcnt(3)
v_mfma_f32_16x16x32_bf16 v[60:63], a[108:111], v[44:47], v[60:63]
ds_read_b128 v[28:31], v1 offset:30720
s_waitcnt lgkmcnt(3)
v_mfma_f32_16x16x32_bf16 v[64:67], a[108:111], v[48:51], v[64:67]
ds_read_b128 v[32:35], v1 offset:51200
s_waitcnt lgkmcnt(3)
v_mfma_f32_16x16x32_bf16 v[68:71], a[108:111], v[52:55], v[68:71]
ds_read_b128 v[36:39], v238 offset:10240
v_mfma_f32_16x16x32_bf16 v[72:75], v[40:43], a[112:115], v[72:75]
s_mov_b32 m0, s70
s_nop 0
buffer_load_dwordx4 v1, s[4:7], s69 offen offset:3072 sc1 lds
v_mfma_f32_16x16x32_bf16 v[76:79], v[44:47], a[112:115], v[76:79]
buffer_load_dwordx4 a[188:191], v1, s[4:7], s43 offen offset:3072
v_mfma_f32_16x16x32_bf16 v[80:83], v[48:51], a[112:115], v[80:83]
s_add_u32 s40, s40, 4096
buffer_load_dwordx4 a[192:195], v1, s[4:7], s40 offen
v_mfma_f32_16x16x32_bf16 v[84:87], v[52:55], a[112:115], v[84:87]
s_add_u32 s41, s41, 4096
buffer_load_dwordx4 a[196:199], v1, s[4:7], s41 offen
v_mfma_f32_16x16x32_bf16 v[88:91], v[40:43], a[116:119], v[88:91]
v_mfma_f32_16x16x32_bf16 v[92:95], v[44:47], a[116:119], v[92:95]
v_mfma_f32_16x16x32_bf16 v[96:99], v[48:51], a[116:119], v[96:99]
v_mfma_f32_16x16x32_bf16 v[100:103], v[52:55], a[116:119], v[100:103]
s_waitcnt lgkmcnt(3)
v_mfma_f32_16x16x32_bf16 v[56:59], a[120:123], v[24:27], v[56:59]
ds_read_b128 v[40:43], v1 offset:11264
s_waitcnt lgkmcnt(3)
v_mfma_f32_16x16x32_bf16 v[60:63], a[120:123], v[28:31], v[60:63]
ds_read_b128 v[44:47], v1 offset:31744
s_waitcnt lgkmcnt(3)
v_mfma_f32_16x16x32_bf16 v[64:67], a[120:123], v[32:35], v[64:67]
ds_read_b128 v[48:51], v1 offset:52224
s_waitcnt lgkmcnt(3)
v_mfma_f32_16x16x32_bf16 v[68:71], a[120:123], v[36:39], v[68:71]
ds_read_b128 v[52:55], v238 offset:11264
v_mfma_f32_16x16x32_bf16 v[72:75], v[24:27], a[124:127], v[72:75]
v_mfma_f32_16x16x32_bf16 v[76:79], v[28:31], a[124:127], v[76:79]
s_add_u32 s43, s43, 4096
buffer_load_dwordx4 a[200:203], v1, s[4:7], s43 offen
v_mfma_f32_16x16x32_bf16 v[80:83], v[32:35], a[124:127], v[80:83]
buffer_load_dwordx4 a[204:207], v1, s[4:7], s40 offen offset:1024
v_mfma_f32_16x16x32_bf16 v[84:87], v[36:39], a[124:127], v[84:87]
buffer_load_dwordx4 a[208:211], v1, s[4:7], s41 offen offset:1024
s_waitcnt vmcnt(25)
v_mfma_f32_16x16x32_bf16 v[88:91], v[24:27], a[128:131], v[88:91]
v_mfma_f32_16x16x32_bf16 v[92:95], v[28:31], a[128:131], v[92:95]
v_mfma_f32_16x16x32_bf16 v[96:99], v[32:35], a[128:131], v[96:99]
v_mfma_f32_16x16x32_bf16 v[100:103], v[36:39], a[128:131], v[100:103]
s_waitcnt vmcnt(24)
s_waitcnt lgkmcnt(3)
v_mfma_f32_16x16x32_bf16 v[56:59], a[132:135], v[40:43], v[56:59]
ds_read_b128 v[24:27], v1 offset:12288
s_waitcnt lgkmcnt(3)
v_mfma_f32_16x16x32_bf16 v[60:63], a[132:135], v[44:47], v[60:63]
ds_read_b128 v[28:31], v1 offset:32768
s_waitcnt lgkmcnt(3)
v_mfma_f32_16x16x32_bf16 v[64:67], a[132:135], v[48:51], v[64:67]
ds_read_b128 v[32:35], v1 offset:53248
s_waitcnt lgkmcnt(3)
v_mfma_f32_16x16x32_bf16 v[68:71], a[132:135], v[52:55], v[68:71]
ds_read_b128 v[36:39], v238 offset:12288
s_waitcnt vmcnt(23)
v_mfma_f32_16x16x32_bf16 v[72:75], v[40:43], a[136:139], v[72:75]
v_mfma_f32_16x16x32_bf16 v[76:79], v[44:47], a[136:139], v[76:79]
buffer_load_dwordx4 a[212:215], v1, s[4:7], s43 offen offset:1024
v_mfma_f32_16x16x32_bf16 v[80:83], v[48:51], a[136:139], v[80:83]
buffer_load_dwordx4 a[216:219], v1, s[4:7], s40 offen offset:2048
v_mfma_f32_16x16x32_bf16 v[84:87], v[52:55], a[136:139], v[84:87]
buffer_load_dwordx4 a[220:223], v1, s[4:7], s41 offen offset:2048
s_waitcnt vmcnt(24)
v_mfma_f32_16x16x32_bf16 v[88:91], v[40:43], a[140:143], v[88:91]
v_mfma_f32_16x16x32_bf16 v[92:95], v[44:47], a[140:143], v[92:95]
v_mfma_f32_16x16x32_bf16 v[96:99], v[48:51], a[140:143], v[96:99]
v_mfma_f32_16x16x32_bf16 v[100:103], v[52:55], a[140:143], v[100:103]
s_waitcnt vmcnt(23)
s_waitcnt lgkmcnt(3)
v_mfma_f32_16x16x32_bf16 v[56:59], a[144:147], v[24:27], v[56:59]
ds_read_b128 v[40:43], v1 offset:13312
s_waitcnt lgkmcnt(3)
v_mfma_f32_16x16x32_bf16 v[60:63], a[144:147], v[28:31], v[60:63]
ds_read_b128 v[44:47], v1 offset:33792
s_waitcnt lgkmcnt(3)
v_mfma_f32_16x16x32_bf16 v[64:67], a[144:147], v[32:35], v[64:67]
ds_read_b128 v[48:51], v1 offset:54272
s_waitcnt lgkmcnt(3)
v_mfma_f32_16x16x32_bf16 v[68:71], a[144:147], v[36:39], v[68:71]
ds_read_b128 v[52:55], v238 offset:13312
s_waitcnt vmcnt(22)
v_mfma_f32_16x16x32_bf16 v[72:75], v[24:27], a[148:151], v[72:75]
v_mfma_f32_16x16x32_bf16 v[76:79], v[28:31], a[148:151], v[76:79]
buffer_load_dwordx4 a[224:227], v1, s[4:7], s43 offen offset:2048
v_mfma_f32_16x16x32_bf16 v[80:83], v[32:35], a[148:151], v[80:83]
buffer_load_dwordx4 a[228:231], v1, s[4:7], s40 offen offset:3072
v_mfma_f32_16x16x32_bf16 v[84:87], v[36:39], a[148:151], v[84:87]
buffer_load_dwordx4 a[232:235], v1, s[4:7], s41 offen offset:3072
s_waitcnt vmcnt(23)
v_mfma_f32_16x16x32_bf16 v[88:91], v[24:27], a[152:155], v[88:91]
v_mfma_f32_16x16x32_bf16 v[92:95], v[28:31], a[152:155], v[92:95]
v_mfma_f32_16x16x32_bf16 v[96:99], v[32:35], a[152:155], v[96:99]
v_mfma_f32_16x16x32_bf16 v[100:103], v[36:39], a[152:155], v[100:103]
s_waitcnt vmcnt(22)
s_waitcnt lgkmcnt(3)
v_mfma_f32_16x16x32_bf16 v[56:59], a[156:159], v[40:43], v[56:59]
ds_read_b128 v[24:27], v1 offset:14336
s_waitcnt lgkmcnt(3)
v_mfma_f32_16x16x32_bf16 v[60:63], a[156:159], v[44:47], v[60:63]
ds_read_b128 v[28:31], v1 offset:34816
s_waitcnt lgkmcnt(3)
v_mfma_f32_16x16x32_bf16 v[64:67], a[156:159], v[48:51], v[64:67]
ds_read_b128 v[32:35], v1 offset:55296
s_waitcnt lgkmcnt(3)
v_mfma_f32_16x16x32_bf16 v[68:71], a[156:159], v[52:55], v[68:71]
ds_read_b128 v[36:39], v238 offset:14336
s_waitcnt vmcnt(21)
v_mfma_f32_16x16x32_bf16 v[72:75], v[40:43], a[160:163], v[72:75]
v_mfma_f32_16x16x32_bf16 v[76:79], v[44:47], a[160:163], v[76:79]
buffer_load_dwordx4 a[236:239], v1, s[4:7], s43 offen offset:3072
v_mfma_f32_16x16x32_bf16 v[80:83], v[48:51], a[160:163], v[80:83]
buffer_load_dwordx4 a[240:243], v1, s[4:7], s42 offen
v_mfma_f32_16x16x32_bf16 v[84:87], v[52:55], a[160:163], v[84:87]
buffer_load_dwordx4 a[244:247], v1, s[4:7], s42 offen offset:1024
s_waitcnt vmcnt(22)
v_mfma_f32_16x16x32_bf16 v[88:91], v[40:43], a[164:167], v[88:91]
v_mfma_f32_16x16x32_bf16 v[92:95], v[44:47], a[164:167], v[92:95]
v_mfma_f32_16x16x32_bf16 v[96:99], v[48:51], a[164:167], v[96:99]
v_mfma_f32_16x16x32_bf16 v[100:103], v[52:55], a[164:167], v[100:103]
s_waitcnt vmcnt(15)
s_barrier
s_waitcnt lgkmcnt(3)
v_mfma_f32_16x16x32_bf16 v[56:59], a[168:171], v[24:27], v[56:59]
ds_read_b128 v[40:43], v1 offset:15360
s_waitcnt lgkmcnt(3)
v_mfma_f32_16x16x32_bf16 v[60:63], a[168:171], v[28:31], v[60:63]
ds_read_b128 v[44:47], v1 offset:35840
s_waitcnt lgkmcnt(3)
v_mfma_f32_16x16x32_bf16 v[64:67], a[168:171], v[32:35], v[64:67]
ds_read_b128 v[48:51], v1 offset:56320
s_waitcnt lgkmcnt(3)
v_mfma_f32_16x16x32_bf16 v[68:71], a[168:171], v[36:39], v[68:71]
ds_read_b128 v[52:55], v238 offset:15360
v_mfma_f32_16x16x32_bf16 v[72:75], v[24:27], a[172:175], v[72:75]
v_mfma_f32_16x16x32_bf16 v[76:79], v[28:31], a[172:175], v[76:79]
buffer_load_dwordx4 a[248:251], v1, s[4:7], s42 offen offset:2048
v_mfma_f32_16x16x32_bf16 v[80:83], v[32:35], a[172:175], v[80:83]
buffer_load_dwordx4 a[252:255], v1, s[4:7], s42 offen offset:3072
v_mfma_f32_16x16x32_bf16 v[84:87], v[36:39], a[172:175], v[84:87]
s_add_u32 s42, s42, 4096
buffer_load_dwordx4 a[0:3], v1, s[4:7], s42 offen
v_mfma_f32_16x16x32_bf16 v[88:91], v[24:27], a[176:179], v[88:91]
v_mfma_f32_16x16x32_bf16 v[92:95], v[28:31], a[176:179], v[92:95]
v_mfma_f32_16x16x32_bf16 v[96:99], v[32:35], a[176:179], v[96:99]
v_mfma_f32_16x16x32_bf16 v[100:103], v[36:39], a[176:179], v[100:103]
s_waitcnt lgkmcnt(3)
v_mfma_f32_16x16x32_bf16 v[56:59], a[180:183], v[40:43], v[56:59]
ds_read_b64 v[24:25], v2 offset:16384
ds_read_b64 v[26:27], v2 offset:16896
s_waitcnt lgkmcnt(4)
v_mfma_f32_16x16x32_bf16 v[60:63], a[180:183], v[44:47], v[60:63]
ds_read_b64 v[28:29], v2 offset:36864
ds_read_b64 v[30:31], v2 offset:37376
s_waitcnt lgkmcnt(5)
v_mfma_f32_16x16x32_bf16 v[64:67], a[180:183], v[48:51], v[64:67]
ds_read_b64 v[32:33], v2 offset:57344
ds_read_b64 v[34:35], v2 offset:57856
s_waitcnt lgkmcnt(6)
v_mfma_f32_16x16x32_bf16 v[68:71], a[180:183], v[52:55], v[68:71]
ds_read_b64 v[36:37], v239 offset:16384
ds_read_b64 v[38:39], v239 offset:16896
v_mfma_f32_16x16x32_bf16 v[72:75], v[40:43], a[184:187], v[72:75]
v_mfma_f32_16x16x32_bf16 v[76:79], v[44:47], a[184:187], v[76:79]
buffer_load_dwordx4 a[4:7], v1, s[4:7], s42 offen offset:1024
v_mfma_f32_16x16x32_bf16 v[80:83], v[48:51], a[184:187], v[80:83]
buffer_load_dwordx4 a[8:11], v1, s[4:7], s42 offen offset:2048
v_mfma_f32_16x16x32_bf16 v[84:87], v[52:55], a[184:187], v[84:87]
buffer_load_dwordx4 a[12:15], v1, s[4:7], s42 offen offset:3072
s_waitcnt vmcnt(20)
v_mfma_f32_16x16x32_bf16 v[88:91], v[40:43], a[188:191], v[88:91]
v_mfma_f32_16x16x32_bf16 v[92:95], v[44:47], a[188:191], v[92:95]
v_mfma_f32_16x16x32_bf16 v[96:99], v[48:51], a[188:191], v[96:99]
v_mfma_f32_16x16x32_bf16 v[100:103], v[52:55], a[188:191], v[100:103]
s_waitcnt vmcnt(19)
s_waitcnt lgkmcnt(6)
v_mfma_f32_16x16x32_bf16 v[56:59], a[192:195], v[24:27], v[56:59]
ds_read_b64 v[40:41], v2 offset:17408
ds_read_b64 v[42:43], v2 offset:17920
s_waitcnt lgkmcnt(6)
v_mfma_f32_16x16x32_bf16 v[60:63], a[192:195], v[28:31], v[60:63]
ds_read_b64 v[44:45], v2 offset:37888
ds_read_b64 v[46:47], v2 offset:38400
s_waitcnt lgkmcnt(6)
v_mfma_f32_16x16x32_bf16 v[64:67], a[192:195], v[32:35], v[64:67]
ds_read_b64 v[48:49], v2 offset:58368
ds_read_b64 v[50:51], v2 offset:58880
s_waitcnt lgkmcnt(6)
v_mfma_f32_16x16x32_bf16 v[68:71], a[192:195], v[36:39], v[68:71]
ds_read_b64 v[52:53], v239 offset:17408
ds_read_b64 v[54:55], v239 offset:17920
s_waitcnt vmcnt(18)
v_mfma_f32_16x16x32_bf16 v[72:75], v[24:27], a[196:199], v[72:75]
v_mfma_f32_16x16x32_bf16 v[76:79], v[28:31], a[196:199], v[76:79]
s_add_u32 s42, s42, 4096
buffer_load_dwordx4 a[16:19], v1, s[4:7], s42 offen
v_mfma_f32_16x16x32_bf16 v[80:83], v[32:35], a[196:199], v[80:83]
buffer_load_dwordx4 a[20:23], v1, s[4:7], s42 offen offset:1024
v_mfma_f32_16x16x32_bf16 v[84:87], v[36:39], a[196:199], v[84:87]
buffer_load_dwordx4 a[24:27], v1, s[4:7], s42 offen offset:2048
s_waitcnt vmcnt(20)
v_mfma_f32_16x16x32_bf16 v[88:91], v[24:27], a[200:203], v[88:91]
v_mfma_f32_16x16x32_bf16 v[92:95], v[28:31], a[200:203], v[92:95]
v_mfma_f32_16x16x32_bf16 v[96:99], v[32:35], a[200:203], v[96:99]
v_mfma_f32_16x16x32_bf16 v[100:103], v[36:39], a[200:203], v[100:103]
s_waitcnt vmcnt(19)
s_waitcnt lgkmcnt(6)
v_mfma_f32_16x16x32_bf16 v[56:59], a[204:207], v[40:43], v[56:59]
ds_read_b64 v[24:25], v2 offset:18432
ds_read_b64 v[26:27], v2 offset:18944
s_waitcnt lgkmcnt(6)
v_mfma_f32_16x16x32_bf16 v[60:63], a[204:207], v[44:47], v[60:63]
ds_read_b64 v[28:29], v2 offset:38912
ds_read_b64 v[30:31], v2 offset:39424
s_waitcnt lgkmcnt(6)
v_mfma_f32_16x16x32_bf16 v[64:67], a[204:207], v[48:51], v[64:67]
ds_read_b64 v[32:33], v2 offset:59392
ds_read_b64 v[34:35], v2 offset:59904
s_waitcnt lgkmcnt(6)
v_mfma_f32_16x16x32_bf16 v[68:71], a[204:207], v[52:55], v[68:71]
ds_read_b64 v[36:37], v239 offset:18432
ds_read_b64 v[38:39], v239 offset:18944
s_waitcnt vmcnt(18)
v_mfma_f32_16x16x32_bf16 v[72:75], v[40:43], a[208:211], v[72:75]
v_mfma_f32_16x16x32_bf16 v[76:79], v[44:47], a[208:211], v[76:79]
buffer_load_dwordx4 a[28:31], v1, s[4:7], s42 offen offset:3072
v_mfma_f32_16x16x32_bf16 v[80:83], v[48:51], a[208:211], v[80:83]
s_add_u32 s42, s42, 4096
buffer_load_dwordx4 a[32:35], v1, s[4:7], s42 offen
v_mfma_f32_16x16x32_bf16 v[84:87], v[52:55], a[208:211], v[84:87]
buffer_load_dwordx4 a[36:39], v1, s[4:7], s42 offen offset:1024
s_waitcnt vmcnt(20)
v_mfma_f32_16x16x32_bf16 v[88:91], v[40:43], a[212:215], v[88:91]
v_mfma_f32_16x16x32_bf16 v[92:95], v[44:47], a[212:215], v[92:95]
v_mfma_f32_16x16x32_bf16 v[96:99], v[48:51], a[212:215], v[96:99]
v_mfma_f32_16x16x32_bf16 v[100:103], v[52:55], a[212:215], v[100:103]
s_waitcnt vmcnt(19)
s_waitcnt lgkmcnt(6)
v_mfma_f32_16x16x32_bf16 v[56:59], a[216:219], v[24:27], v[56:59]
ds_read_b64 v[40:41], v2 offset:19456
ds_read_b64 v[42:43], v2 offset:19968
s_waitcnt lgkmcnt(6)
v_mfma_f32_16x16x32_bf16 v[60:63], a[216:219], v[28:31], v[60:63]
ds_read_b64 v[44:45], v2 offset:39936
ds_read_b64 v[46:47], v2 offset:40448
s_waitcnt lgkmcnt(6)
v_mfma_f32_16x16x32_bf16 v[64:67], a[216:219], v[32:35], v[64:67]
ds_read_b64 v[48:49], v2 offset:60416
ds_read_b64 v[50:51], v2 offset:60928
s_waitcnt lgkmcnt(6)
v_mfma_f32_16x16x32_bf16 v[68:71], a[216:219], v[36:39], v[68:71]
ds_read_b64 v[52:53], v239 offset:19456
ds_read_b64 v[54:55], v239 offset:19968
s_waitcnt vmcnt(18)
v_mfma_f32_16x16x32_bf16 v[72:75], v[24:27], a[220:223], v[72:75]
v_mfma_f32_16x16x32_bf16 v[76:79], v[28:31], a[220:223], v[76:79]
buffer_load_dwordx4 a[40:43], v1, s[4:7], s42 offen offset:2048
v_mfma_f32_16x16x32_bf16 v[80:83], v[32:35], a[220:223], v[80:83]
buffer_load_dwordx4 a[44:47], v1, s[4:7], s42 offen offset:3072
v_mfma_f32_16x16x32_bf16 v[84:87], v[36:39], a[220:223], v[84:87]
s_add_u32 s42, s42, 4096
buffer_load_dwordx4 a[48:51], v1, s[4:7], s42 offen
s_waitcnt vmcnt(20)
v_mfma_f32_16x16x32_bf16 v[88:91], v[24:27], a[224:227], v[88:91]
v_mfma_f32_16x16x32_bf16 v[92:95], v[28:31], a[224:227], v[92:95]
v_mfma_f32_16x16x32_bf16 v[96:99], v[32:35], a[224:227], v[96:99]
v_mfma_f32_16x16x32_bf16 v[100:103], v[36:39], a[224:227], v[100:103]
s_waitcnt vmcnt(19)
s_waitcnt lgkmcnt(6)
v_mfma_f32_16x16x32_bf16 v[56:59], a[228:231], v[40:43], v[56:59]
s_waitcnt lgkmcnt(4)
v_mfma_f32_16x16x32_bf16 v[60:63], a[228:231], v[44:47], v[60:63]
buffer_load_dwordx4 a[52:55], v1, s[4:7], s42 offen offset:1024
s_waitcnt lgkmcnt(2)
v_mfma_f32_16x16x32_bf16 v[64:67], a[228:231], v[48:51], v[64:67]
buffer_load_dwordx4 a[56:59], v1, s[4:7], s42 offen offset:2048
s_waitcnt lgkmcnt(0)
v_mfma_f32_16x16x32_bf16 v[68:71], a[228:231], v[52:55], v[68:71]
buffer_load_dwordx4 a[60:63], v1, s[4:7], s42 offen offset:3072
s_waitcnt vmcnt(21)
v_mfma_f32_16x16x32_bf16 v[72:75], v[40:43], a[232:235], v[72:75]
v_mfma_f32_16x16x32_bf16 v[76:79], v[44:47], a[232:235], v[76:79]
v_mfma_f32_16x16x32_bf16 v[80:83], v[48:51], a[232:235], v[80:83]
v_mfma_f32_16x16x32_bf16 v[84:87], v[52:55], a[232:235], v[84:87]
s_waitcnt vmcnt(20)
v_mfma_f32_16x16x32_bf16 v[88:91], v[40:43], a[236:239], v[88:91]
v_mfma_f32_16x16x32_bf16 v[92:95], v[44:47], a[236:239], v[92:95]
v_mfma_f32_16x16x32_bf16 v[96:99], v[48:51], a[236:239], v[96:99]
v_mfma_f32_16x16x32_bf16 v[100:103], v[52:55], a[236:239], v[100:103]
v_lshlrev_b32 v3, 2, v241
v_add_u32 v3, 102400, v3
ds_read_b32 v136, v3 offset:0
ds_read_b32 v140, v3 offset:256
ds_read_b32 v137, v3 offset:64
ds_read_b32 v141, v3 offset:320
ds_read_b32 v138, v3 offset:128
ds_read_b32 v142, v3 offset:384
ds_read_b32 v139, v3 offset:192
ds_read_b32 v143, v3 offset:448
v_lshlrev_b32 v3, 4, v240
v_add_u32 v3, 102400, v3
ds_read_b128 v[144:147], v3 offset:0
ds_read_b128 v[160:163], v3 offset:256
ds_read_b128 v[148:151], v3 offset:64
ds_read_b128 v[164:167], v3 offset:320
ds_read_b128 v[152:155], v3 offset:128
ds_read_b128 v[168:171], v3 offset:384
ds_read_b128 v[156:159], v3 offset:192
ds_read_b128 v[172:175], v3 offset:448
s_waitcnt lgkmcnt(0)
s_lshl_b32 s24, s60, 14
s_add_u32 s24, s24, 13492224
s_lshl_b32 s25, s22, 12
s_add_u32 s25, s25, s24
s_mul_i32 s26, s60, 10240
s_add_u32 s26, s26, 21880832
s_lshl_b32 s27, s22, 11
s_add_u32 s27, s27, s26
s_add_u32 s26, s26, 8192
v_pk_fma_f32 v[72:73], v[144:145], v[188:189], v[72:73] op_sel:[0,0,0] op_sel_hi:[1,0,1]
v_pk_fma_f32 v[74:75], v[146:147], v[188:189], v[74:75] op_sel:[0,0,0] op_sel_hi:[1,0,1]
v_pk_mul_f32 v[72:73], v[72:73], v[160:161]
v_pk_mul_f32 v[74:75], v[74:75], v[162:163]
v_cvt_pk_bf16_f32 v48, v72, v73
v_cvt_pk_bf16_f32 v49, v74, v75
v_pk_fma_f32 v[76:77], v[148:149], v[188:189], v[76:77] op_sel:[0,0,0] op_sel_hi:[1,0,1]
v_pk_fma_f32 v[78:79], v[150:151], v[188:189], v[78:79] op_sel:[0,0,0] op_sel_hi:[1,0,1]
v_pk_mul_f32 v[76:77], v[76:77], v[164:165]
v_pk_mul_f32 v[78:79], v[78:79], v[166:167]
v_cvt_pk_bf16_f32 v50, v76, v77
v_cvt_pk_bf16_f32 v51, v78, v79
buffer_store_dwordx4 v[48:51], v1, s[4:7], s27 offen offset:0 sc1
v_pk_fma_f32 v[80:81], v[152:153], v[188:189], v[80:81] op_sel:[0,0,0] op_sel_hi:[1,0,1]
v_pk_fma_f32 v[82:83], v[154:155], v[188:189], v[82:83] op_sel:[0,0,0] op_sel_hi:[1,0,1]
v_pk_mul_f32 v[80:81], v[80:81], v[168:169]
v_pk_mul_f32 v[82:83], v[82:83], v[170:171]
v_cvt_pk_bf16_f32 v52, v80, v81
v_cvt_pk_bf16_f32 v53, v82, v83
v_pk_fma_f32 v[84:85], v[156:157], v[188:189], v[84:85] op_sel:[0,0,0] op_sel_hi:[1,0,1]
v_pk_fma_f32 v[86:87], v[158:159], v[188:189], v[86:87] op_sel:[0,0,0] op_sel_hi:[1,0,1]
v_pk_mul_f32 v[84:85], v[84:85], v[172:173]
v_pk_mul_f32 v[86:87], v[86:87], v[174:175]
v_cvt_pk_bf16_f32 v54, v84, v85
v_cvt_pk_bf16_f32 v55, v86, v87
buffer_store_dwordx4 v[52:55], v1, s[4:7], s27 offen offset:1024 sc1
v_pk_fma_f32 v[88:89], v[144:145], v[184:185], v[88:89] op_sel:[0,0,0] op_sel_hi:[1,0,1]
v_pk_fma_f32 v[90:91], v[146:147], v[184:185], v[90:91] op_sel:[0,0,0] op_sel_hi:[1,0,1]
v_pk_mul_f32 v[88:89], v[88:89], v[160:161]
v_pk_mul_f32 v[90:91], v[90:91], v[162:163]
v_cvt_pk_bf16_f32 v40, v88, v89
v_cvt_pk_bf16_f32 v41, v90, v91
v_pk_fma_f32 v[92:93], v[148:149], v[184:185], v[92:93] op_sel:[0,0,0] op_sel_hi:[1,0,1]
v_pk_fma_f32 v[94:95], v[150:151], v[184:185], v[94:95] op_sel:[0,0,0] op_sel_hi:[1,0,1]
v_pk_mul_f32 v[92:93], v[92:93], v[164:165]
v_pk_mul_f32 v[94:95], v[94:95], v[166:167]
v_cvt_pk_bf16_f32 v42, v92, v93
v_cvt_pk_bf16_f32 v43, v94, v95
buffer_store_dwordx4 v[40:43], v1, s[4:7], s26 offen offset:0 sc1
v_pk_fma_f32 v[96:97], v[152:153], v[184:185], v[96:97] op_sel:[0,0,0] op_sel_hi:[1,0,1]
v_pk_fma_f32 v[98:99], v[154:155], v[184:185], v[98:99] op_sel:[0,0,0] op_sel_hi:[1,0,1]
v_pk_mul_f32 v[96:97], v[96:97], v[168:169]
v_pk_mul_f32 v[98:99], v[98:99], v[170:171]
v_cvt_pk_bf16_f32 v44, v96, v97
v_cvt_pk_bf16_f32 v45, v98, v99
v_pk_fma_f32 v[100:101], v[156:157], v[184:185], v[100:101] op_sel:[0,0,0] op_sel_hi:[1,0,1]
v_pk_fma_f32 v[102:103], v[158:159], v[184:185], v[102:103] op_sel:[0,0,0] op_sel_hi:[1,0,1]
v_pk_mul_f32 v[100:101], v[100:101], v[172:173]
v_pk_mul_f32 v[102:103], v[102:103], v[174:175]
v_cvt_pk_bf16_f32 v46, v100, v101
v_cvt_pk_bf16_f32 v47, v102, v103
buffer_store_dwordx4 v[44:47], v1, s[4:7], s26 offen offset:1024 sc1
v_pk_fma_f32 v[56:57], v[176:177], v[136:137], v[56:57] op_sel:[0,0,0] op_sel_hi:[1,0,1]
v_pk_fma_f32 v[58:59], v[178:179], v[136:137], v[58:59] op_sel:[0,0,0] op_sel_hi:[1,0,1]
v_pk_mul_f32 v[56:57], v[56:57], v[140:141] op_sel:[0,0] op_sel_hi:[1,0]
v_pk_mul_f32 v[58:59], v[58:59], v[140:141] op_sel:[0,0] op_sel_hi:[1,0]
v_cvt_pk_bf16_f32 v24, v56, v57
v_cvt_pk_bf16_f32 v25, v58, v59
v_pk_fma_f32 v[60:61], v[176:177], v[136:137], v[60:61] op_sel:[0,1,0] op_sel_hi:[1,1,1]
v_pk_fma_f32 v[62:63], v[178:179], v[136:137], v[62:63] op_sel:[0,1,0] op_sel_hi:[1,1,1]
v_pk_mul_f32 v[60:61], v[60:61], v[140:141] op_sel:[0,1] op_sel_hi:[1,1]
v_pk_mul_f32 v[62:63], v[62:63], v[140:141] op_sel:[0,1] op_sel_hi:[1,1]
v_cvt_pk_bf16_f32 v28, v60, v61
v_cvt_pk_bf16_f32 v29, v62, v63
v_pk_fma_f32 v[64:65], v[176:177], v[138:139], v[64:65] op_sel:[0,0,0] op_sel_hi:[1,0,1]
v_pk_fma_f32 v[66:67], v[178:179], v[138:139], v[66:67] op_sel:[0,0,0] op_sel_hi:[1,0,1]
v_pk_mul_f32 v[64:65], v[64:65], v[142:143] op_sel:[0,0] op_sel_hi:[1,0]
v_pk_mul_f32 v[66:67], v[66:67], v[142:143] op_sel:[0,0] op_sel_hi:[1,0]
v_cvt_pk_bf16_f32 v32, v64, v65
v_cvt_pk_bf16_f32 v33, v66, v67
v_pk_fma_f32 v[68:69], v[176:177], v[138:139], v[68:69] op_sel:[0,1,0] op_sel_hi:[1,1,1]
v_pk_fma_f32 v[70:71], v[178:179], v[138:139], v[70:71] op_sel:[0,1,0] op_sel_hi:[1,1,1]
v_pk_mul_f32 v[68:69], v[68:69], v[142:143] op_sel:[0,1] op_sel_hi:[1,1]
v_pk_mul_f32 v[70:71], v[70:71], v[142:143] op_sel:[0,1] op_sel_hi:[1,1]
v_cvt_pk_bf16_f32 v36, v68, v69
v_cvt_pk_bf16_f32 v37, v70, v71
s_waitcnt lgkmcnt(0)
s_barrier
ds_read_b64 v[26:27], v239 offset:44032
ds_read_b64 v[30:31], v239 offset:44544
ds_read_b64 v[34:35], v239 offset:45056
ds_read_b64 v[38:39], v239 offset:45568
ds_read_b64 v[202:203], v239 offset:41984
ds_read_b64 v[206:207], v239 offset:42496
ds_read_b64 v[210:211], v239 offset:43008
ds_read_b64 v[214:215], v239 offset:43520
s_waitcnt lgkmcnt(7)
buffer_store_dwordx4 v[24:27], v1, s[4:7], s25 offen offset:0 sc1
s_waitcnt lgkmcnt(6)
buffer_store_dwordx4 v[28:31], v1, s[4:7], s25 offen offset:1024 sc1
s_waitcnt lgkmcnt(5)
buffer_store_dwordx4 v[32:35], v1, s[4:7], s25 offen offset:2048 sc1
s_waitcnt lgkmcnt(4)
buffer_store_dwordx4 v[36:39], v1, s[4:7], s25 offen offset:3072 sc1
s_waitcnt lgkmcnt(0)
v_cmp_eq_u32 vcc, s22, v240
s_nop 1
v_cndmask_b32 v202, 0, v202, vcc
v_cndmask_b32 v203, 0, v203, vcc
v_cndmask_b32 v206, 0, v206, vcc
v_cndmask_b32 v207, 0, v207, vcc
v_cndmask_b32 v210, 0, v210, vcc
v_cndmask_b32 v211, 0, v211, vcc
v_cndmask_b32 v214, 0, v214, vcc
v_cndmask_b32 v215, 0, v215, vcc
s_waitcnt vmcnt(0)
v_mov_b32 v3, 1
s_mov_b64 exec, 1
buffer_store_dword v3, off, s[4:7], s23 sc1
s_mov_b64 exec, -1
ds_read_b128 v[24:27], v1 offset:0
ds_read_b128 v[28:31], v1 offset:20480
ds_read_b128 v[32:35], v1 offset:40960
ds_read_b128 v[36:39], v238 offset:0
s_waitcnt lgkmcnt(3)
v_mfma_f32_16x16x32_bf16 v[104:107], a[240:243], v[24:27], 0
ds_read_b128 v[40:43], v1 offset:1024
ds_read_b128 v[44:47], v1 offset:21504
s_waitcnt lgkmcnt(4)
v_mfma_f32_16x16x32_bf16 v[108:111], a[240:243], v[28:31], 0
ds_read_b128 v[48:51], v1 offset:41984
ds_read_b128 v[52:55], v238 offset:1024
s_waitcnt lgkmcnt(5)
v_mfma_f32_16x16x32_bf16 v[112:115], a[240:243], v[32:35], 0
s_waitcnt lgkmcnt(4)
v_mfma_f32_16x16x32_bf16 v[116:119], a[240:243], v[36:39], 0
s_waitcnt lgkmcnt(3)
v_mfma_f32_16x16x32_bf16 v[104:107], a[244:247], v[40:43], v[104:107]
ds_read_b128 v[24:27], v1 offset:2048
ds_read_b128 v[28:31], v1 offset:22528
s_waitcnt lgkmcnt(4)
v_mfma_f32_16x16x32_bf16 v[108:111], a[244:247], v[44:47], v[108:111]
ds_read_b128 v[32:35], v1 offset:43008
ds_read_b128 v[36:39], v238 offset:2048
s_waitcnt lgkmcnt(5)
v_mfma_f32_16x16x32_bf16 v[112:115], a[244:247], v[48:51], v[112:115]
s_waitcnt lgkmcnt(4)
v_mfma_f32_16x16x32_bf16 v[116:119], a[244:247], v[52:55], v[116:119]
s_waitcnt lgkmcnt(3)
v_mfma_f32_16x16x32_bf16 v[104:107], a[248:251], v[24:27], v[104:107]
ds_read_b128 v[40:43], v1 offset:3072
ds_read_b128 v[44:47], v1 offset:23552
s_waitcnt lgkmcnt(4)
v_mfma_f32_16x16x32_bf16 v[108:111], a[248:251], v[28:31], v[108:111]
ds_read_b128 v[48:51], v1 offset:44032
ds_read_b128 v[52:55], v238 offset:3072
s_waitcnt lgkmcnt(5)
v_mfma_f32_16x16x32_bf16 v[112:115], a[248:251], v[32:35], v[112:115]
s_waitcnt lgkmcnt(4)
v_mfma_f32_16x16x32_bf16 v[116:119], a[248:251], v[36:39], v[116:119]
s_waitcnt lgkmcnt(3)
v_mfma_f32_16x16x32_bf16 v[104:107], a[252:255], v[40:43], v[104:107]
ds_read_b128 v[24:27], v1 offset:4096
ds_read_b128 v[28:31], v1 offset:24576
s_waitcnt lgkmcnt(4)
v_mfma_f32_16x16x32_bf16 v[108:111], a[252:255], v[44:47], v[108:111]
ds_read_b128 v[32:35], v1 offset:45056
ds_read_b128 v[36:39], v238 offset:4096
s_waitcnt lgkmcnt(5)
v_mfma_f32_16x16x32_bf16 v[112:115], a[252:255], v[48:51], v[112:115]
s_waitcnt lgkmcnt(4)
v_mfma_f32_16x16x32_bf16 v[116:119], a[252:255], v[52:55], v[116:119]
s_waitcnt lgkmcnt(3)
v_mfma_f32_16x16x32_bf16 v[104:107], a[0:3], v[24:27], v[104:107]
ds_read_b128 v[40:43], v1 offset:5120
ds_read_b128 v[44:47], v1 offset:25600
s_waitcnt lgkmcnt(4)
v_mfma_f32_16x16x32_bf16 v[108:111], a[0:3], v[28:31], v[108:111]
ds_read_b128 v[48:51], v1 offset:46080
ds_read_b128 v[52:55], v238 offset:5120
s_waitcnt lgkmcnt(5)
v_mfma_f32_16x16x32_bf16 v[112:115], a[0:3], v[32:35], v[112:115]
s_waitcnt lgkmcnt(4)
v_mfma_f32_16x16x32_bf16 v[116:119], a[0:3], v[36:39], v[116:119]
s_waitcnt lgkmcnt(3)
v_mfma_f32_16x16x32_bf16 v[104:107], a[4:7], v[40:43], v[104:107]
ds_read_b128 v[24:27], v1 offset:6144
ds_read_b128 v[28:31], v1 offset:26624
s_waitcnt lgkmcnt(4)
v_mfma_f32_16x16x32_bf16 v[108:111], a[4:7], v[44:47], v[108:111]
ds_read_b128 v[32:35], v1 offset:47104
ds_read_b128 v[36:39], v238 offset:6144
s_waitcnt lgkmcnt(5)
v_mfma_f32_16x16x32_bf16 v[112:115], a[4:7], v[48:51], v[112:115]
s_waitcnt lgkmcnt(4)
v_mfma_f32_16x16x32_bf16 v[116:119], a[4:7], v[52:55], v[116:119]
s_waitcnt lgkmcnt(3)
v_mfma_f32_16x16x32_bf16 v[104:107], a[8:11], v[24:27], v[104:107]
ds_read_b128 v[40:43], v1 offset:7168
ds_read_b128 v[44:47], v1 offset:27648
s_waitcnt lgkmcnt(4)
v_mfma_f32_16x16x32_bf16 v[108:111], a[8:11], v[28:31], v[108:111]
ds_read_b128 v[48:51], v1 offset:48128
ds_read_b128 v[52:55], v238 offset:7168
s_waitcnt lgkmcnt(5)
v_mfma_f32_16x16x32_bf16 v[112:115], a[8:11], v[32:35], v[112:115]
s_waitcnt lgkmcnt(4)
v_mfma_f32_16x16x32_bf16 v[116:119], a[8:11], v[36:39], v[116:119]
s_waitcnt lgkmcnt(3)
v_mfma_f32_16x16x32_bf16 v[104:107], a[12:15], v[40:43], v[104:107]
ds_read_b128 v[24:27], v1 offset:8192
ds_read_b128 v[28:31], v1 offset:28672
s_waitcnt lgkmcnt(4)
v_mfma_f32_16x16x32_bf16 v[108:111], a[12:15], v[44:47], v[108:111]
ds_read_b128 v[32:35], v1 offset:49152
ds_read_b128 v[36:39], v238 offset:8192
s_waitcnt lgkmcnt(5)
v_mfma_f32_16x16x32_bf16 v[112:115], a[12:15], v[48:51], v[112:115]
s_waitcnt lgkmcnt(4)
v_mfma_f32_16x16x32_bf16 v[116:119], a[12:15], v[52:55], v[116:119]
s_waitcnt lgkmcnt(3)
v_mfma_f32_16x16x32_bf16 v[104:107], a[16:19], v[24:27], v[104:107]
ds_read_b128 v[40:43], v1 offset:9216
ds_read_b128 v[44:47], v1 offset:29696
s_waitcnt lgkmcnt(4)
v_mfma_f32_16x16x32_bf16 v[108:111], a[16:19], v[28:31], v[108:111]
ds_read_b128 v[48:51], v1 offset:50176
ds_read_b128 v[52:55], v238 offset:9216
s_waitcnt lgkmcnt(5)
v_mfma_f32_16x16x32_bf16 v[112:115], a[16:19], v[32:35], v[112:115]
s_waitcnt lgkmcnt(4)
v_mfma_f32_16x16x32_bf16 v[116:119], a[16:19], v[36:39], v[116:119]
s_waitcnt lgkmcnt(3)
v_mfma_f32_16x16x32_bf16 v[104:107], a[20:23], v[40:43], v[104:107]
ds_read_b128 v[24:27], v1 offset:10240
ds_read_b128 v[28:31], v1 offset:30720
s_waitcnt lgkmcnt(4)
v_mfma_f32_16x16x32_bf16 v[108:111], a[20:23], v[44:47], v[108:111]
ds_read_b128 v[32:35], v1 offset:51200
ds_read_b128 v[36:39], v238 offset:10240
s_waitcnt lgkmcnt(5)
v_mfma_f32_16x16x32_bf16 v[112:115], a[20:23], v[48:51], v[112:115]
s_waitcnt lgkmcnt(4)
v_mfma_f32_16x16x32_bf16 v[116:119], a[20:23], v[52:55], v[116:119]
s_waitcnt lgkmcnt(3)
v_mfma_f32_16x16x32_bf16 v[104:107], a[24:27], v[24:27], v[104:107]
ds_read_b128 v[40:43], v1 offset:11264
ds_read_b128 v[44:47], v1 offset:31744
s_waitcnt lgkmcnt(4)
v_mfma_f32_16x16x32_bf16 v[108:111], a[24:27], v[28:31], v[108:111]
ds_read_b128 v[48:51], v1 offset:52224
ds_read_b128 v[52:55], v238 offset:11264
s_waitcnt lgkmcnt(5)
v_mfma_f32_16x16x32_bf16 v[112:115], a[24:27], v[32:35], v[112:115]
s_waitcnt lgkmcnt(4)
v_mfma_f32_16x16x32_bf16 v[116:119], a[24:27], v[36:39], v[116:119]
s_waitcnt lgkmcnt(3)
v_mfma_f32_16x16x32_bf16 v[104:107], a[28:31], v[40:43], v[104:107]
ds_read_b128 v[24:27], v1 offset:12288
ds_read_b128 v[28:31], v1 offset:32768
s_waitcnt lgkmcnt(4)
v_mfma_f32_16x16x32_bf16 v[108:111], a[28:31], v[44:47], v[108:111]
ds_read_b128 v[32:35], v1 offset:53248
ds_read_b128 v[36:39], v238 offset:12288
s_waitcnt lgkmcnt(5)
v_mfma_f32_16x16x32_bf16 v[112:115], a[28:31], v[48:51], v[112:115]
s_waitcnt lgkmcnt(4)
v_mfma_f32_16x16x32_bf16 v[116:119], a[28:31], v[52:55], v[116:119]
s_waitcnt lgkmcnt(3)
v_mfma_f32_16x16x32_bf16 v[104:107], a[32:35], v[24:27], v[104:107]
ds_read_b128 v[40:43], v1 offset:13312
ds_read_b128 v[44:47], v1 offset:33792
s_waitcnt lgkmcnt(4)
v_mfma_f32_16x16x32_bf16 v[108:111], a[32:35], v[28:31], v[108:111]
ds_read_b128 v[48:51], v1 offset:54272
ds_read_b128 v[52:55], v238 offset:13312
s_waitcnt lgkmcnt(5)
v_mfma_f32_16x16x32_bf16 v[112:115], a[32:35], v[32:35], v[112:115]
s_waitcnt lgkmcnt(4)
v_mfma_f32_16x16x32_bf16 v[116:119], a[32:35], v[36:39], v[116:119]
s_waitcnt lgkmcnt(3)
v_mfma_f32_16x16x32_bf16 v[104:107], a[36:39], v[40:43], v[104:107]
ds_read_b128 v[24:27], v1 offset:14336
ds_read_b128 v[28:31], v1 offset:34816
s_waitcnt lgkmcnt(4)
v_mfma_f32_16x16x32_bf16 v[108:111], a[36:39], v[44:47], v[108:111]
ds_read_b128 v[32:35], v1 offset:55296
ds_read_b128 v[36:39], v238 offset:14336
s_waitcnt lgkmcnt(5)
v_mfma_f32_16x16x32_bf16 v[112:115], a[36:39], v[48:51], v[112:115]
s_waitcnt lgkmcnt(4)
v_mfma_f32_16x16x32_bf16 v[116:119], a[36:39], v[52:55], v[116:119]
s_waitcnt lgkmcnt(3)
v_mfma_f32_16x16x32_bf16 v[104:107], a[40:43], v[24:27], v[104:107]
ds_read_b128 v[40:43], v1 offset:15360
ds_read_b128 v[44:47], v1 offset:35840
s_waitcnt lgkmcnt(4)
v_mfma_f32_16x16x32_bf16 v[108:111], a[40:43], v[28:31], v[108:111]
ds_read_b128 v[48:51], v1 offset:56320
ds_read_b128 v[52:55], v238 offset:15360
s_waitcnt lgkmcnt(5)
v_mfma_f32_16x16x32_bf16 v[112:115], a[40:43], v[32:35], v[112:115]
s_waitcnt lgkmcnt(4)
v_mfma_f32_16x16x32_bf16 v[116:119], a[40:43], v[36:39], v[116:119]
s_waitcnt lgkmcnt(3)
v_mfma_f32_16x16x32_bf16 v[104:107], a[44:47], v[40:43], v[104:107]
ds_read_b64 v[24:25], v2 offset:16384
ds_read_b64 v[26:27], v2 offset:16896
ds_read_b64 v[28:29], v2 offset:36864
ds_read_b64 v[30:31], v2 offset:37376
s_waitcnt lgkmcnt(6)
v_mfma_f32_16x16x32_bf16 v[108:111], a[44:47], v[44:47], v[108:111]
ds_read_b64 v[32:33], v2 offset:57344
ds_read_b64 v[34:35], v2 offset:57856
ds_read_b64 v[36:37], v239 offset:16384
ds_read_b64 v[38:39], v239 offset:16896
s_waitcnt lgkmcnt(9)
v_mfma_f32_16x16x32_bf16 v[112:115], a[44:47], v[48:51], v[112:115]
s_waitcnt lgkmcnt(8)
v_mfma_f32_16x16x32_bf16 v[116:119], a[44:47], v[52:55], v[116:119]
s_waitcnt lgkmcnt(6)
v_mfma_f32_16x16x32_bf16 v[104:107], a[48:51], v[24:27], v[104:107]
ds_read_b64 v[40:41], v2 offset:17408
ds_read_b64 v[42:43], v2 offset:17920
ds_read_b64 v[44:45], v2 offset:37888
ds_read_b64 v[46:47], v2 offset:38400
s_waitcnt lgkmcnt(8)
v_mfma_f32_16x16x32_bf16 v[108:111], a[48:51], v[28:31], v[108:111]
ds_read_b64 v[48:49], v2 offset:58368
ds_read_b64 v[50:51], v2 offset:58880
ds_read_b64 v[52:53], v239 offset:17408
ds_read_b64 v[54:55], v239 offset:17920
s_waitcnt lgkmcnt(10)
v_mfma_f32_16x16x32_bf16 v[112:115], a[48:51], v[32:35], v[112:115]
s_waitcnt lgkmcnt(8)
v_mfma_f32_16x16x32_bf16 v[116:119], a[48:51], v[36:39], v[116:119]
s_waitcnt lgkmcnt(6)
v_mfma_f32_16x16x32_bf16 v[104:107], a[52:55], v[40:43], v[104:107]
ds_read_b64 v[24:25], v2 offset:18432
ds_read_b64 v[26:27], v2 offset:18944
ds_read_b64 v[28:29], v2 offset:38912
ds_read_b64 v[30:31], v2 offset:39424
s_waitcnt lgkmcnt(8)
v_mfma_f32_16x16x32_bf16 v[108:111], a[52:55], v[44:47], v[108:111]
ds_read_b64 v[32:33], v2 offset:59392
ds_read_b64 v[34:35], v2 offset:59904
ds_read_b64 v[36:37], v239 offset:18432
ds_read_b64 v[38:39], v239 offset:18944
s_waitcnt lgkmcnt(10)
v_mfma_f32_16x16x32_bf16 v[112:115], a[52:55], v[48:51], v[112:115]
s_waitcnt lgkmcnt(8)
v_mfma_f32_16x16x32_bf16 v[116:119], a[52:55], v[52:55], v[116:119]
s_waitcnt lgkmcnt(6)
v_mfma_f32_16x16x32_bf16 v[104:107], a[56:59], v[24:27], v[104:107]
ds_read_b64 v[40:41], v2 offset:19456
ds_read_b64 v[42:43], v2 offset:19968
ds_read_b64 v[44:45], v2 offset:39936
ds_read_b64 v[46:47], v2 offset:40448
s_waitcnt lgkmcnt(8)
v_mfma_f32_16x16x32_bf16 v[108:111], a[56:59], v[28:31], v[108:111]
ds_read_b64 v[48:49], v2 offset:60416
ds_read_b64 v[50:51], v2 offset:60928
ds_read_b64 v[52:53], v239 offset:19456
ds_read_b64 v[54:55], v239 offset:19968
s_waitcnt lgkmcnt(10)
v_mfma_f32_16x16x32_bf16 v[112:115], a[56:59], v[32:35], v[112:115]
s_waitcnt lgkmcnt(8)
v_mfma_f32_16x16x32_bf16 v[116:119], a[56:59], v[36:39], v[116:119]
s_waitcnt lgkmcnt(6)
v_mfma_f32_16x16x32_bf16 v[104:107], a[60:63], v[40:43], v[104:107]
s_waitcnt lgkmcnt(4)
v_mfma_f32_16x16x32_bf16 v[108:111], a[60:63], v[44:47], v[108:111]
s_waitcnt lgkmcnt(2)
v_mfma_f32_16x16x32_bf16 v[112:115], a[60:63], v[48:51], v[112:115]
s_waitcnt lgkmcnt(0)
v_mfma_f32_16x16x32_bf16 v[116:119], a[60:63], v[52:55], v[116:119]
s_mov_b32 s24, 0x3ea52b5c
v_mul_f32 v140, s24, v140
v_mul_f32 v141, s24, v141
v_mul_f32 v142, s24, v142
v_mul_f32 v143, s24, v143
v_pk_fma_f32 v[104:105], v[180:181], v[136:137], v[104:105] op_sel:[0,0,0] op_sel_hi:[1,0,1]
v_pk_fma_f32 v[106:107], v[182:183], v[136:137], v[106:107] op_sel:[0,0,0] op_sel_hi:[1,0,1]
v_pk_mul_f32 v[104:105], v[104:105], v[140:141] op_sel:[0,0] op_sel_hi:[1,0]
v_pk_mul_f32 v[106:107], v[106:107], v[140:141] op_sel:[0,0] op_sel_hi:[1,0]
v_cvt_pk_bf16_f32 v200, v104, v105
v_cvt_pk_bf16_f32 v201, v106, v107
v_pk_fma_f32 v[108:109], v[180:181], v[136:137], v[108:109] op_sel:[0,1,0] op_sel_hi:[1,1,1]
v_pk_fma_f32 v[110:111], v[182:183], v[136:137], v[110:111] op_sel:[0,1,0] op_sel_hi:[1,1,1]
v_pk_mul_f32 v[108:109], v[108:109], v[140:141] op_sel:[0,1] op_sel_hi:[1,1]
v_pk_mul_f32 v[110:111], v[110:111], v[140:141] op_sel:[0,1] op_sel_hi:[1,1]
v_cvt_pk_bf16_f32 v204, v108, v109
v_cvt_pk_bf16_f32 v205, v110, v111
v_pk_fma_f32 v[112:113], v[180:181], v[138:139], v[112:113] op_sel:[0,0,0] op_sel_hi:[1,0,1]
v_pk_fma_f32 v[114:115], v[182:183], v[138:139], v[114:115] op_sel:[0,0,0] op_sel_hi:[1,0,1]
v_pk_mul_f32 v[112:113], v[112:113], v[142:143] op_sel:[0,0] op_sel_hi:[1,0]
v_pk_mul_f32 v[114:115], v[114:115], v[142:143] op_sel:[0,0] op_sel_hi:[1,0]
v_cvt_pk_bf16_f32 v208, v112, v113
v_cvt_pk_bf16_f32 v209, v114, v115
v_pk_fma_f32 v[116:117], v[180:181], v[138:139], v[116:117] op_sel:[0,1,0] op_sel_hi:[1,1,1]
v_pk_fma_f32 v[118:119], v[182:183], v[138:139], v[118:119] op_sel:[0,1,0] op_sel_hi:[1,1,1]
v_pk_mul_f32 v[116:117], v[116:117], v[142:143] op_sel:[0,1] op_sel_hi:[1,1]
v_pk_mul_f32 v[118:119], v[118:119], v[142:143] op_sel:[0,1] op_sel_hi:[1,1]
v_cvt_pk_bf16_f32 v212, v116, v117
v_cvt_pk_bf16_f32 v213, v118, v119
s_nop 7
s_branch FE2
FK5:
s_mul_i32 s24, s21, 960
s_lshl_b32 s25, s22, 6
s_add_u32 s24, s24, s25
s_add_u32 s24, s24, 7700480
v_lshlrev_b32 v3, 4, v240
v_lshlrev_b32 v192, 2, v241
buffer_load_dwordx4 v[176:179], v3, s[4:7], s24 offen
buffer_load_dwordx4 v[180:183], v3, s[4:7], s24 offen offset:512
buffer_load_dword v188, v192, s[4:7], s24 offen offset:256
buffer_load_dwordx4 v[184:187], v3, s[4:7], s24 offen offset:768
s_lshl_b32 s26, s60, 9
s_and_b32 s26, s26, 0xfffff000
s_lshl_b32 s27, s22, 7
s_add_u32 s26, s26, s27
s_add_u32 s26, s26, 12967936
v_lshrrev_b32 v24, 3, v0
v_lshlrev_b32 v24, 9, v24
v_and_b32 v25, 7, v0
v_lshlrev_b32 v25, 4, v25
v_add_u32 v24, v24, v25
buffer_load_dwordx4 v[28:31], v24, s[4:7], s26 offen
s_mul_i32 s69, s62, 20480
s_add_u32 s69, s69, 7725056
s_mul_i32 s70, s22, 20480
s_mov_b32 m0, s70
s_nop 0
buffer_load_dwordx4 v1, s[4:7], s69 offen offset:0 sc1 lds
buffer_load_dwordx4 a[0:3], v1, s[4:7], s40 offen
buffer_load_dwordx4 a[4:7], v1, s[4:7], s41 offen
s_mov_b32 m0, s70
s_nop 0
buffer_load_dwordx4 v1, s[4:7], s69 offen offset:1024 sc1 lds
buffer_load_dwordx4 a[8:11], v1, s[4:7], s43 offen
buffer_load_dwordx4 a[12:15], v1, s[4:7], s40 offen offset:1024
s_mov_b32 m0, s70
s_nop 0
buffer_load_dwordx4 v1, s[4:7], s69 offen offset:2048 sc1 lds
buffer_load_dwordx4 a[16:19], v1, s[4:7], s41 offen offset:1024
buffer_load_dwordx4 a[20:23], v1, s[4:7], s43 offen offset:1024
s_mov_b32 m0, s70
s_nop 0
buffer_load_dwordx4 v1, s[4:7], s69 offen offset:3072 sc1 lds
buffer_load_dwordx4 a[24:27], v1, s[4:7], s40 offen offset:2048
buffer_load_dwordx4 a[28:31], v1, s[4:7], s41 offen offset:2048
s_add_u32 s69, s69, 4096
s_add_u32 s70, s70, 4096
s_mov_b32 m0, s70
s_nop 0
buffer_load_dwordx4 v1, s[4:7], s69 offen offset:0 sc1 lds
buffer_load_dwordx4 a[32:35], v1, s[4:7], s43 offen offset:2048
buffer_load_dwordx4 a[36:39], v1, s[4:7], s40 offen offset:3072
s_mov_b32 m0, s70
s_nop 0
buffer_load_dwordx4 v1, s[4:7], s69 offen offset:1024 sc1 lds
buffer_load_dwordx4 a[40:43], v1, s[4:7], s41 offen offset:3072
buffer_load_dwordx4 a[44:47], v1, s[4:7], s43 offen offset:3072
s_mov_b32 m0, s70
s_nop 0
buffer_load_dwordx4 v1, s[4:7], s69 offen offset:2048 sc1 lds
s_add_u32 s40, s40, 4096
buffer_load_dwordx4 a[48:51], v1, s[4:7], s40 offen
s_add_u32 s41, s41, 4096
buffer_load_dwordx4 a[52:55], v1, s[4:7], s41 offen
s_mov_b32 m0, s70
s_nop 0
buffer_load_dwordx4 v1, s[4:7], s69 offen offset:3072 sc1 lds
s_add_u32 s43, s43, 4096
buffer_load_dwordx4 a[56:59], v1, s[4:7], s43 offen
buffer_load_dwordx4 a[60:63], v1, s[4:7], s40 offen offset:1024
s_add_u32 s69, s69, 4096
s_add_u32 s70, s70, 4096
s_mov_b32 m0, s70
s_nop 0
buffer_load_dwordx4 v1, s[4:7], s69 offen offset:0 sc1 lds
buffer_load_dwordx4 a[64:67], v1, s[4:7], s41 offen offset:1024
buffer_load_dwordx4 a[68:71], v1, s[4:7], s43 offen offset:1024
s_mov_b32 m0, s70
s_nop 0
buffer_load_dwordx4 v1, s[4:7], s69 offen offset:1024 sc1 lds
buffer_load_dwordx4 a[72:75], v1, s[4:7], s40 offen offset:2048
buffer_load_dwordx4 a[76:79], v1, s[4:7], s41 offen offset:2048
s_waitcnt vmcnt(30)
v_mov_b32 v32, v28
v_mov_b32 v33, v29
v_mov_b32 v34, v30
v_mov_b32 v35, v31
v_permlane32_swap_b32 v28, v32
v_permlane32_swap_b32 v29, v33
v_permlane32_swap_b32 v30, v34
v_permlane32_swap_b32 v31, v35
v_add_f32 v28, v28, v32
v_add_f32 v29, v29, v33
v_add_f32 v30, v30, v34
v_add_f32 v31, v31, v35
v_mov_b32 v32, v28
v_mov_b32 v33, v29
v_mov_b32 v34, v30
v_mov_b32 v35, v31
v_permlane16_swap_b32 v28, v32
v_permlane16_swap_b32 v29, v33
v_permlane16_swap_b32 v30, v34
v_permlane16_swap_b32 v31, v35
v_add_f32 v28, v28, v32
v_add_f32 v29, v29, v33
v_add_f32 v30, v30, v34
v_add_f32 v31, v31, v35
v_add_f32_dpp v28, v28, v28 row_ror:8 row_mask:0xf bank_mask:0xf
v_add_f32_dpp v29, v29, v29 row_ror:8 row_mask:0xf bank_mask:0xf
v_add_f32_dpp v30, v30, v30 row_ror:8 row_mask:0xf bank_mask:0xf
v_add_f32_dpp v31, v31, v31 row_ror:8 row_mask:0xf bank_mask:0xf
s_mov_b32 s26, 0xbacccccd
s_mov_b32 s27, 0x3acccccd
v_mul_f32 v32, s26, v28
v_mul_f32 v33, s26, v30
v_mul_f32 v34, s27, v29
v_mul_f32 v35, s27, v31
v_fma_f32 v34, -v32, v32, v34
v_fma_f32 v35, -v33, v33, v35
v_max_f32 v34, 0, v34
v_max_f32 v35, 0, v35
v_add_f32 v34, 0x3727c5ac, v34
v_add_f32 v35, 0x3727c5ac, v35
v_rsq_f32 v34, v34
v_rsq_f32 v35, v35
v_and_b32 v24, 7, v0
v_lshlrev_b32 v24, 3, v24
s_lshl_b32 s26, s22, 6
s_add_u32 s26, s26, 102400
v_add_u32 v24, s26, v24
s_mov_b64 exec, 0xff
ds_write_b64 v24, v[32:33]
ds_write_b64 v24, v[34:35] offset:256
s_mov_b64 exec, -1
s_waitcnt vmcnt(17)
s_waitcnt lgkmcnt(0)
s_barrier
ds_read_b128 v[24:27], v1 offset:0
ds_read_b128 v[28:31], v1 offset:20480
ds_read_b128 v[32:35], v1 offset:40960
ds_read_b128 v[36:39], v238 offset:0
s_waitcnt lgkmcnt(3)
v_mfma_f32_16x16x32_bf16 v[56:59], a[0:3], v[24:27], 0
ds_read_b128 v[40:43], v1 offset:1024
s_waitcnt lgkmcnt(3)
v_mfma_f32_16x16x32_bf16 v[60:63], a[0:3], v[28:31], 0
ds_read_b128 v[44:47], v1 offset:21504
s_waitcnt lgkmcnt(3)
v_mfma_f32_16x16x32_bf16 v[64:67], a[0:3], v[32:35], 0
ds_read_b128 v[48:51], v1 offset:41984
s_waitcnt lgkmcnt(3)
v_mfma_f32_16x16x32_bf16 v[68:71], a[0:3], v[36:39], 0
ds_read_b128 v[52:55], v238 offset:1024
v_mfma_f32_16x16x32_bf16 v[72:75], v[24:27], a[4:7], 0
s_mov_b32 m0, s70
s_nop 0
buffer_load_dwordx4 v1, s[4:7], s69 offen offset:2048 sc1 lds
v_mfma_f32_16x16x32_bf16 v[76:79], v[28:31], a[4:7], 0
buffer_load_dwordx4 a[80:83], v1, s[4:7], s43 offen offset:2048
v_mfma_f32_16x16x32_bf16 v[80:83], v[32:35], a[4:7], 0
buffer_load_dwordx4 a[84:87], v1, s[4:7], s40 offen offset:3072
v_mfma_f32_16x16x32_bf16 v[84:87], v[36:39], a[4:7], 0
buffer_load_dwordx4 a[88:91], v1, s[4:7], s41 offen offset:3072
v_mfma_f32_16x16x32_bf16 v[88:91], a[8:11], v[24:27], 0
v_mfma_f32_16x16x32_bf16 v[92:95], a[8:11], v[28:31], 0
v_mfma_f32_16x16x32_bf16 v[96:99], a[8:11], v[32:35], 0
v_mfma_f32_16x16x32_bf16 v[100:103], a[8:11], v[36:39], 0
s_waitcnt lgkmcnt(3)
v_mfma_f32_16x16x32_bf16 v[56:59], a[12:15], v[40:43], v[56:59]
ds_read_b128 v[24:27], v1 offset:2048
s_waitcnt lgkmcnt(3)
v_mfma_f32_16x16x32_bf16 v[60:63], a[12:15], v[44:47], v[60:63]
ds_read_b128 v[28:31], v1 offset:22528
s_waitcnt lgkmcnt(3)
v_mfma_f32_16x16x32_bf16 v[64:67], a[12:15], v[48:51], v[64:67]
ds_read_b128 v[32:35], v1 offset:43008
s_waitcnt lgkmcnt(3)
v_mfma_f32_16x16x32_bf16 v[68:71], a[12:15], v[52:55], v[68:71]
ds_read_b128 v[36:39], v238 offset:2048
v_mfma_f32_16x16x32_bf16 v[72:75], v[40:43], a[16:19], v[72:75]
s_mov_b32 m0, s70
s_nop 0
buffer_load_dwordx4 v1, s[4:7], s69 offen offset:3072 sc1 lds
v_mfma_f32_16x16x32_bf16 v[76:79], v[44:47], a[16:19], v[76:79]
buffer_load_dwordx4 a[92:95], v1, s[4:7], s43 offen offset:3072
v_mfma_f32_16x16x32_bf16 v[80:83], v[48:51], a[16:19], v[80:83]
s_add_u32 s40, s40, 4096
buffer_load_dwordx4 a[96:99], v1, s[4:7], s40 offen
v_mfma_f32_16x16x32_bf16 v[84:87], v[52:55], a[16:19], v[84:87]
s_add_u32 s41, s41, 4096
buffer_load_dwordx4 a[100:103], v1, s[4:7], s41 offen
v_mfma_f32_16x16x32_bf16 v[88:91], a[20:23], v[40:43], v[88:91]
v_mfma_f32_16x16x32_bf16 v[92:95], a[20:23], v[44:47], v[92:95]
v_mfma_f32_16x16x32_bf16 v[96:99], a[20:23], v[48:51], v[96:99]
v_mfma_f32_16x16x32_bf16 v[100:103], a[20:23], v[52:55], v[100:103]
s_waitcnt lgkmcnt(3)
v_mfma_f32_16x16x32_bf16 v[56:59], a[24:27], v[24:27], v[56:59]
ds_read_b128 v[40:43], v1 offset:3072
s_waitcnt lgkmcnt(3)
v_mfma_f32_16x16x32_bf16 v[60:63], a[24:27], v[28:31], v[60:63]
ds_read_b128 v[44:47], v1 offset:23552
s_waitcnt lgkmcnt(3)
v_mfma_f32_16x16x32_bf16 v[64:67], a[24:27], v[32:35], v[64:67]
ds_read_b128 v[48:51], v1 offset:44032
s_waitcnt lgkmcnt(3)
v_mfma_f32_16x16x32_bf16 v[68:71], a[24:27], v[36:39], v[68:71]
ds_read_b128 v[52:55], v238 offset:3072
v_mfma_f32_16x16x32_bf16 v[72:75], v[24:27], a[28:31], v[72:75]
s_add_u32 s69, s69, 4096
s_add_u32 s70, s70, 4096
s_mov_b32 m0, s70
s_nop 0
buffer_load_dwordx4 v1, s[4:7], s69 offen offset:0 sc1 lds
v_mfma_f32_16x16x32_bf16 v[76:79], v[28:31], a[28:31], v[76:79]
s_add_u32 s43, s43, 4096
buffer_load_dwordx4 a[104:107], v1, s[4:7], s43 offen
v_mfma_f32_16x16x32_bf16 v[80:83], v[32:35], a[28:31], v[80:83]
buffer_load_dwordx4 a[108:111], v1, s[4:7], s40 offen offset:1024
v_mfma_f32_16x16x32_bf16 v[84:87], v[36:39], a[28:31], v[84:87]
buffer_load_dwordx4 a[112:115], v1, s[4:7], s41 offen offset:1024
s_waitcnt vmcnt(28)
v_mfma_f32_16x16x32_bf16 v[88:91], a[32:35], v[24:27], v[88:91]
v_mfma_f32_16x16x32_bf16 v[92:95], a[32:35], v[28:31], v[92:95]
v_mfma_f32_16x16x32_bf16 v[96:99], a[32:35], v[32:35], v[96:99]
v_mfma_f32_16x16x32_bf16 v[100:103], a[32:35], v[36:39], v[100:103]
s_waitcnt vmcnt(27)
s_waitcnt lgkmcnt(3)
v_mfma_f32_16x16x32_bf16 v[56:59], a[36:39], v[40:43], v[56:59]
ds_read_b128 v[24:27], v1 offset:4096
s_waitcnt lgkmcnt(3)
v_mfma_f32_16x16x32_bf16 v[60:63], a[36:39], v[44:47], v[60:63]
ds_read_b128 v[28:31], v1 offset:24576
s_waitcnt lgkmcnt(3)
v_mfma_f32_16x16x32_bf16 v[64:67], a[36:39], v[48:51], v[64:67]
ds_read_b128 v[32:35], v1 offset:45056
s_waitcnt lgkmcnt(3)
v_mfma_f32_16x16x32_bf16 v[68:71], a[36:39], v[52:55], v[68:71]
ds_read_b128 v[36:39], v238 offset:4096
s_waitcnt vmcnt(25)
v_mfma_f32_16x16x32_bf16 v[72:75], v[40:43], a[40:43], v[72:75]
s_mov_b32 m0, s70
s_nop 0
buffer_load_dwordx4 v1, s[4:7], s69 offen offset:1024 sc1 lds
v_mfma_f32_16x16x32_bf16 v[76:79], v[44:47], a[40:43], v[76:79]
buffer_load_dwordx4 a[116:119], v1, s[4:7], s43 offen offset:1024
v_mfma_f32_16x16x32_bf16 v[80:83], v[48:51], a[40:43], v[80:83]
buffer_load_dwordx4 a[120:123], v1, s[4:7], s40 offen offset:2048
v_mfma_f32_16x16x32_bf16 v[84:87], v[52:55], a[40:43], v[84:87]
buffer_load_dwordx4 a[124:127], v1, s[4:7], s41 offen offset:2048
s_waitcnt vmcnt(28)
v_mfma_f32_16x16x32_bf16 v[88:91], a[44:47], v[40:43], v[88:91]
v_mfma_f32_16x16x32_bf16 v[92:95], a[44:47], v[44:47], v[92:95]
v_mfma_f32_16x16x32_bf16 v[96:99], a[44:47], v[48:51], v[96:99]
v_mfma_f32_16x16x32_bf16 v[100:103], a[44:47], v[52:55], v[100:103]
s_waitcnt vmcnt(18)
s_barrier
s_waitcnt lgkmcnt(3)
v_mfma_f32_16x16x32_bf16 v[56:59], a[48:51], v[24:27], v[56:59]
ds_read_b128 v[40:43], v1 offset:5120
s_waitcnt lgkmcnt(3)
v_mfma_f32_16x16x32_bf16 v[60:63], a[48:51], v[28:31], v[60:63]
ds_read_b128 v[44:47], v1 offset:25600
s_waitcnt lgkmcnt(3)
v_mfma_f32_16x16x32_bf16 v[64:67], a[48:51], v[32:35], v[64:67]
ds_read_b128 v[48:51], v1 offset:46080
s_waitcnt lgkmcnt(3)
v_mfma_f32_16x16x32_bf16 v[68:71], a[48:51], v[36:39], v[68:71]
ds_read_b128 v[52:55], v238 offset:5120
v_mfma_f32_16x16x32_bf16 v[72:75], v[24:27], a[52:55], v[72:75]
s_mov_b32 m0, s70
s_nop 0
buffer_load_dwordx4 v1, s[4:7], s69 offen offset:2048 sc1 lds
v_mfma_f32_16x16x32_bf16 v[76:79], v[28:31], a[52:55], v[76:79]
buffer_load_dwordx4 a[128:131], v1, s[4:7], s43 offen offset:2048
v_mfma_f32_16x16x32_bf16 v[80:83], v[32:35], a[52:55], v[80:83]
buffer_load_dwordx4 a[132:135], v1, s[4:7], s40 offen offset:3072
v_mfma_f32_16x16x32_bf16 v[84:87], v[36:39], a[52:55], v[84:87]
buffer_load_dwordx4 a[136:139], v1, s[4:7], s41 offen offset:3072
v_mfma_f32_16x16x32_bf16 v[88:91], a[56:59], v[24:27], v[88:91]
v_mfma_f32_16x16x32_bf16 v[92:95], a[56:59], v[28:31], v[92:95]
v_mfma_f32_16x16x32_bf16 v[96:99], a[56:59], v[32:35], v[96:99]
v_mfma_f32_16x16x32_bf16 v[100:103], a[56:59], v[36:39], v[100:103]
s_waitcnt lgkmcnt(3)
v_mfma_f32_16x16x32_bf16 v[56:59], a[60:63], v[40:43], v[56:59]
ds_read_b128 v[24:27], v1 offset:6144
s_waitcnt lgkmcnt(3)
v_mfma_f32_16x16x32_bf16 v[60:63], a[60:63], v[44:47], v[60:63]
ds_read_b128 v[28:31], v1 offset:26624
s_waitcnt lgkmcnt(3)
v_mfma_f32_16x16x32_bf16 v[64:67], a[60:63], v[48:51], v[64:67]
ds_read_b128 v[32:35], v1 offset:47104
s_waitcnt lgkmcnt(3)
v_mfma_f32_16x16x32_bf16 v[68:71], a[60:63], v[52:55], v[68:71]
ds_read_b128 v[36:39], v238 offset:6144
v_mfma_f32_16x16x32_bf16 v[72:75], v[40:43], a[64:67], v[72:75]
s_mov_b32 m0, s70
s_nop 0
buffer_load_dwordx4 v1, s[4:7], s69 offen offset:3072 sc1 lds
v_mfma_f32_16x16x32_bf16 v[76:79], v[44:47], a[64:67], v[76:79]
buffer_load_dwordx4 a[140:143], v1, s[4:7], s43 offen offset:3072
v_mfma_f32_16x16x32_bf16 v[80:83], v[48:51], a[64:67], v[80:83]
s_add_u32 s40, s40, 4096
buffer_load_dwordx4 a[144:147], v1, s[4:7], s40 offen
v_mfma_f32_16x16x32_bf16 v[84:87], v[52:55], a[64:67], v[84:87]
s_add_u32 s41, s41, 4096
buffer_load_dwordx4 a[148:151], v1, s[4:7], s41 offen
v_mfma_f32_16x16x32_bf16 v[88:91], a[68:71], v[40:43], v[88:91]
v_mfma_f32_16x16x32_bf16 v[92:95], a[68:71], v[44:47], v[92:95]
v_mfma_f32_16x16x32_bf16 v[96:99], a[68:71], v[48:51], v[96:99]
v_mfma_f32_16x16x32_bf16 v[100:103], a[68:71], v[52:55], v[100:103]
s_waitcnt vmcnt(25)
s_waitcnt lgkmcnt(3)
v_mfma_f32_16x16x32_bf16 v[56:59], a[72:75], v[24:27], v[56:59]
ds_read_b128 v[40:43], v1 offset:7168
s_waitcnt lgkmcnt(3)
v_mfma_f32_16x16x32_bf16 v[60:63], a[72:75], v[28:31], v[60:63]
ds_read_b128 v[44:47], v1 offset:27648
s_waitcnt lgkmcnt(3)
v_mfma_f32_16x16x32_bf16 v[64:67], a[72:75], v[32:35], v[64:67]
ds_read_b128 v[48:51], v1 offset:48128
s_waitcnt lgkmcnt(3)
v_mfma_f32_16x16x32_bf16 v[68:71], a[72:75], v[36:39], v[68:71]
ds_read_b128 v[52:55], v238 offset:7168
s_waitcnt vmcnt(24)
v_mfma_f32_16x16x32_bf16 v[72:75], v[24:27], a[76:79], v[72:75]
s_add_u32 s69, s69, 4096
s_add_u32 s70, s70, 4096
s_mov_b32 m0, s70
s_nop 0
buffer_load_dwordx4 v1, s[4:7], s69 offen offset:0 sc1 lds
v_mfma_f32_16x16x32_bf16 v[76:79], v[28:31], a[76:79], v[76:79]
s_add_u32 s43, s43, 4096
buffer_load_dwordx4 a[152:155], v1, s[4:7], s43 offen
v_mfma_f32_16x16x32_bf16 v[80:83], v[32:35], a[76:79], v[80:83]
buffer_load_dwordx4 a[156:159], v1, s[4:7], s40 offen offset:1024
v_mfma_f32_16x16x32_bf16 v[84:87], v[36:39], a[76:79], v[84:87]
buffer_load_dwordx4 a[160:163], v1, s[4:7], s41 offen offset:1024
s_waitcnt vmcnt(26)
v_mfma_f32_16x16x32_bf16 v[88:91], a[80:83], v[24:27], v[88:91]
v_mfma_f32_16x16x32_bf16 v[92:95], a[80:83], v[28:31], v[92:95]
v_mfma_f32_16x16x32_bf16 v[96:99], a[80:83], v[32:35], v[96:99]
v_mfma_f32_16x16x32_bf16 v[100:103], a[80:83], v[36:39], v[100:103]
s_waitcnt vmcnt(25)
s_waitcnt lgkmcnt(3)
v_mfma_f32_16x16x32_bf16 v[56:59], a[84:87], v[40:43], v[56:59]
ds_read_b128 v[24:27], v1 offset:8192
s_waitcnt lgkmcnt(3)
v_mfma_f32_16x16x32_bf16 v[60:63], a[84:87], v[44:47], v[60:63]
ds_read_b128 v[28:31], v1 offset:28672
s_waitcnt lgkmcnt(3)
v_mfma_f32_16x16x32_bf16 v[64:67], a[84:87], v[48:51], v[64:67]
ds_read_b128 v[32:35], v1 offset:49152
s_waitcnt lgkmcnt(3)
v_mfma_f32_16x16x32_bf16 v[68:71], a[84:87], v[52:55], v[68:71]
ds_read_b128 v[36:39], v238 offset:8192
s_waitcnt vmcnt(24)
v_mfma_f32_16x16x32_bf16 v[72:75], v[40:43], a[88:91], v[72:75]
s_mov_b32 m0, s70
s_nop 0
buffer_load_dwordx4 v1, s[4:7], s69 offen offset:1024 sc1 lds
v_mfma_f32_16x16x32_bf16 v[76:79], v[44:47], a[88:91], v[76:79]
buffer_load_dwordx4 a[164:167], v1, s[4:7], s43 offen offset:1024
v_mfma_f32_16x16x32_bf16 v[80:83], v[48:51], a[88:91], v[80:83]
buffer_load_dwordx4 a[168:171], v1, s[4:7], s40 offen offset:2048
v_mfma_f32_16x16x32_bf16 v[84:87], v[52:55], a[88:91], v[84:87]
buffer_load_dwordx4 a[172:175], v1, s[4:7], s41 offen offset:2048
s_waitcnt vmcnt(26)
v_mfma_f32_16x16x32_bf16 v[88:91], a[92:95], v[40:43], v[88:91]
v_mfma_f32_16x16x32_bf16 v[92:95], a[92:95], v[44:47], v[92:95]
v_mfma_f32_16x16x32_bf16 v[96:99], a[92:95], v[48:51], v[96:99]
v_mfma_f32_16x16x32_bf16 v[100:103], a[92:95], v[52:55], v[100:103]
s_waitcnt vmcnt(25)
s_waitcnt lgkmcnt(3)
v_mfma_f32_16x16x32_bf16 v[56:59], a[96:99], v[24:27], v[56:59]
ds_read_b128 v[40:43], v1 offset:9216
s_waitcnt lgkmcnt(3)
v_mfma_f32_16x16x32_bf16 v[60:63], a[96:99], v[28:31], v[60:63]
ds_read_b128 v[44:47], v1 offset:29696
s_waitcnt lgkmcnt(3)
v_mfma_f32_16x16x32_bf16 v[64:67], a[96:99], v[32:35], v[64:67]
ds_read_b128 v[48:51], v1 offset:50176
s_waitcnt lgkmcnt(3)
v_mfma_f32_16x16x32_bf16 v[68:71], a[96:99], v[36:39], v[68:71]
ds_read_b128 v[52:55], v238 offset:9216
s_waitcnt vmcnt(24)
v_mfma_f32_16x16x32_bf16 v[72:75], v[24:27], a[100:103], v[72:75]
s_mov_b32 m0, s70
s_nop 0
buffer_load_dwordx4 v1, s[4:7], s69 offen offset:2048 sc1 lds
v_mfma_f32_16x16x32_bf16 v[76:79], v[28:31], a[100:103], v[76:79]
buffer_load_dwordx4 a[176:179], v1, s[4:7], s43 offen offset:2048
v_mfma_f32_16x16x32_bf16 v[80:83], v[32:35], a[100:103], v[80:83]
buffer_load_dwordx4 a[180:183], v1, s[4:7], s40 offen offset:3072
v_mfma_f32_16x16x32_bf16 v[84:87], v[36:39], a[100:103], v[84:87]
buffer_load_dwordx4 a[184:187], v1, s[4:7], s41 offen offset:3072
s_waitcnt vmcnt(26)
v_mfma_f32_16x16x32_bf16 v[88:91], a[104:107], v[24:27], v[88:91]
v_mfma_f32_16x16x32_bf16 v[92:95], a[104:107], v[28:31], v[92:95]
v_mfma_f32_16x16x32_bf16 v[96:99], a[104:107], v[32:35], v[96:99]
v_mfma_f32_16x16x32_bf16 v[100:103], a[104:107], v[36:39], v[100:103]
s_waitcnt vmcnt(19)
s_barrier
s_waitcnt lgkmcnt(3)
v_mfma_f32_16x16x32_bf16 v[56:59], a[108:111], v[40:43], v[56:59]
ds_read_b128 v[24:27], v1 offset:10240
s_waitcnt lgkmcnt(3)
v_mfma_f32_16x16x32_bf16 v[60:63], a[108:111], v[44:47], v[60:63]
ds_read_b128 v[28:31], v1 offset:30720
s_waitcnt lgkmcnt(3)
v_mfma_f32_16x16x32_bf16 v[64:67], a[108:111], v[48:51], v[64:67]
ds_read_b128 v[32:35], v1 offset:51200
s_waitcnt lgkmcnt(3)
v_mfma_f32_16x16x32_bf16 v[68:71], a[108:111], v[52:55], v[68:71]
ds_read_b128 v[36:39], v238 offset:10240
v_mfma_f32_16x16x32_bf16 v[72:75], v[40:43], a[112:115], v[72:75]
s_mov_b32 m0, s70
s_nop 0
buffer_load_dwordx4 v1, s[4:7], s69 offen offset:3072 sc1 lds
v_mfma_f32_16x16x32_bf16 v[76:79], v[44:47], a[112:115], v[76:79]
buffer_load_dwordx4 a[188:191], v1, s[4:7], s43 offen offset:3072
v_mfma_f32_16x16x32_bf16 v[80:83], v[48:51], a[112:115], v[80:83]
s_add_u32 s40, s40, 4096
buffer_load_dwordx4 a[192:195], v1, s[4:7], s40 offen
v_mfma_f32_16x16x32_bf16 v[84:87], v[52:55], a[112:115], v[84:87]
s_add_u32 s41, s41, 4096
buffer_load_dwordx4 a[196:199], v1, s[4:7], s41 offen
v_mfma_f32_16x16x32_bf16 v[88:91], a[116:119], v[40:43], v[88:91]
v_mfma_f32_16x16x32_bf16 v[92:95], a[116:119], v[44:47], v[92:95]
v_mfma_f32_16x16x32_bf16 v[96:99], a[116:119], v[48:51], v[96:99]
v_mfma_f32_16x16x32_bf16 v[100:103], a[116:119], v[52:55], v[100:103]
s_waitcnt lgkmcnt(3)
v_mfma_f32_16x16x32_bf16 v[56:59], a[120:123], v[24:27], v[56:59]
ds_read_b128 v[40:43], v1 offset:11264
s_waitcnt lgkmcnt(3)
v_mfma_f32_16x16x32_bf16 v[60:63], a[120:123], v[28:31], v[60:63]
ds_read_b128 v[44:47], v1 offset:31744
s_waitcnt lgkmcnt(3)
v_mfma_f32_16x16x32_bf16 v[64:67], a[120:123], v[32:35], v[64:67]
ds_read_b128 v[48:51], v1 offset:52224
s_waitcnt lgkmcnt(3)
v_mfma_f32_16x16x32_bf16 v[68:71], a[120:123], v[36:39], v[68:71]
ds_read_b128 v[52:55], v238 offset:11264
v_mfma_f32_16x16x32_bf16 v[72:75], v[24:27], a[124:127], v[72:75]
v_mfma_f32_16x16x32_bf16 v[76:79], v[28:31], a[124:127], v[76:79]
s_add_u32 s43, s43, 4096
buffer_load_dwordx4 a[200:203], v1, s[4:7], s43 offen
v_mfma_f32_16x16x32_bf16 v[80:83], v[32:35], a[124:127], v[80:83]
buffer_load_dwordx4 a[204:207], v1, s[4:7], s40 offen offset:1024
v_mfma_f32_16x16x32_bf16 v[84:87], v[36:39], a[124:127], v[84:87]
buffer_load_dwordx4 a[208:211], v1, s[4:7], s41 offen offset:1024
s_waitcnt vmcnt(25)
v_mfma_f32_16x16x32_bf16 v[88:91], a[128:131], v[24:27], v[88:91]
v_mfma_f32_16x16x32_bf16 v[92:95], a[128:131], v[28:31], v[92:95]
v_mfma_f32_16x16x32_bf16 v[96:99], a[128:131], v[32:35], v[96:99]
v_mfma_f32_16x16x32_bf16 v[100:103], a[128:131], v[36:39], v[100:103]
s_waitcnt vmcnt(24)
s_waitcnt lgkmcnt(3)
v_mfma_f32_16x16x32_bf16 v[56:59], a[132:135], v[40:43], v[56:59]
ds_read_b128 v[24:27], v1 offset:12288
s_waitcnt lgkmcnt(3)
v_mfma_f32_16x16x32_bf16 v[60:63], a[132:135], v[44:47], v[60:63]
ds_read_b128 v[28:31], v1 offset:32768
s_waitcnt lgkmcnt(3)
v_mfma_f32_16x16x32_bf16 v[64:67], a[132:135], v[48:51], v[64:67]
ds_read_b128 v[32:35], v1 offset:53248
s_waitcnt lgkmcnt(3)
v_mfma_f32_16x16x32_bf16 v[68:71], a[132:135], v[52:55], v[68:71]
ds_read_b128 v[36:39], v238 offset:12288
s_waitcnt vmcnt(23)
v_mfma_f32_16x16x32_bf16 v[72:75], v[40:43], a[136:139], v[72:75]
v_mfma_f32_16x16x32_bf16 v[76:79], v[44:47], a[136:139], v[76:79]
buffer_load_dwordx4 a[212:215], v1, s[4:7], s43 offen offset:1024
v_mfma_f32_16x16x32_bf16 v[80:83], v[48:51], a[136:139], v[80:83]
buffer_load_dwordx4 a[216:219], v1, s[4:7], s40 offen offset:2048
v_mfma_f32_16x16x32_bf16 v[84:87], v[52:55], a[136:139], v[84:87]
buffer_load_dwordx4 a[220:223], v1, s[4:7], s41 offen offset:2048
s_waitcnt vmcnt(24)
v_mfma_f32_16x16x32_bf16 v[88:91], a[140:143], v[40:43], v[88:91]
v_mfma_f32_16x16x32_bf16 v[92:95], a[140:143], v[44:47], v[92:95]
v_mfma_f32_16x16x32_bf16 v[96:99], a[140:143], v[48:51], v[96:99]
v_mfma_f32_16x16x32_bf16 v[100:103], a[140:143], v[52:55], v[100:103]
s_waitcnt vmcnt(23)
s_waitcnt lgkmcnt(3)
v_mfma_f32_16x16x32_bf16 v[56:59], a[144:147], v[24:27], v[56:59]
ds_read_b128 v[40:43], v1 offset:13312
s_waitcnt lgkmcnt(3)
v_mfma_f32_16x16x32_bf16 v[60:63], a[144:147], v[28:31], v[60:63]
ds_read_b128 v[44:47], v1 offset:33792
s_waitcnt lgkmcnt(3)
v_mfma_f32_16x16x32_bf16 v[64:67], a[144:147], v[32:35], v[64:67]
ds_read_b128 v[48:51], v1 offset:54272
s_waitcnt lgkmcnt(3)
v_mfma_f32_16x16x32_bf16 v[68:71], a[144:147], v[36:39], v[68:71]
ds_read_b128 v[52:55], v238 offset:13312
s_waitcnt vmcnt(22)
v_mfma_f32_16x16x32_bf16 v[72:75], v[24:27], a[148:151], v[72:75]
v_mfma_f32_16x16x32_bf16 v[76:79], v[28:31], a[148:151], v[76:79]
buffer_load_dwordx4 a[224:227], v1, s[4:7], s43 offen offset:2048
v_mfma_f32_16x16x32_bf16 v[80:83], v[32:35], a[148:151], v[80:83]
buffer_load_dwordx4 a[228:231], v1, s[4:7], s40 offen offset:3072
v_mfma_f32_16x16x32_bf16 v[84:87], v[36:39], a[148:151], v[84:87]
buffer_load_dwordx4 a[232:235], v1, s[4:7], s41 offen offset:3072
s_waitcnt vmcnt(23)
v_mfma_f32_16x16x32_bf16 v[88:91], a[152:155], v[24:27], v[88:91]
v_mfma_f32_16x16x32_bf16 v[92:95], a[152:155], v[28:31], v[92:95]
v_mfma_f32_16x16x32_bf16 v[96:99], a[152:155], v[32:35], v[96:99]
v_mfma_f32_16x16x32_bf16 v[100:103], a[152:155], v[36:39], v[100:103]
s_waitcnt vmcnt(22)
s_waitcnt lgkmcnt(3)
v_mfma_f32_16x16x32_bf16 v[56:59], a[156:159], v[40:43], v[56:59]
ds_read_b128 v[24:27], v1 offset:14336
s_waitcnt lgkmcnt(3)
v_mfma_f32_16x16x32_bf16 v[60:63], a[156:159], v[44:47], v[60:63]
ds_read_b128 v[28:31], v1 offset:34816
s_waitcnt lgkmcnt(3)
v_mfma_f32_16x16x32_bf16 v[64:67], a[156:159], v[48:51], v[64:67]
ds_read_b128 v[32:35], v1 offset:55296
s_waitcnt lgkmcnt(3)
v_mfma_f32_16x16x32_bf16 v[68:71], a[156:159], v[52:55], v[68:71]
ds_read_b128 v[36:39], v238 offset:14336
s_waitcnt vmcnt(21)
v_mfma_f32_16x16x32_bf16 v[72:75], v[40:43], a[160:163], v[72:75]
v_mfma_f32_16x16x32_bf16 v[76:79], v[44:47], a[160:163], v[76:79]
buffer_load_dwordx4 a[236:239], v1, s[4:7], s43 offen offset:3072
v_mfma_f32_16x16x32_bf16 v[80:83], v[48:51], a[160:163], v[80:83]
buffer_load_dwordx4 a[240:243], v1, s[4:7], s42 offen
v_mfma_f32_16x16x32_bf16 v[84:87], v[52:55], a[160:163], v[84:87]
buffer_load_dwordx4 a[244:247], v1, s[4:7], s42 offen offset:1024
s_waitcnt vmcnt(22)
v_mfma_f32_16x16x32_bf16 v[88:91], a[164:167], v[40:43], v[88:91]
v_mfma_f32_16x16x32_bf16 v[92:95], a[164:167], v[44:47], v[92:95]
v_mfma_f32_16x16x32_bf16 v[96:99], a[164:167], v[48:51], v[96:99]
v_mfma_f32_16x16x32_bf16 v[100:103], a[164:167], v[52:55], v[100:103]
s_waitcnt vmcnt(15)
s_barrier
s_waitcnt lgkmcnt(3)
v_mfma_f32_16x16x32_bf16 v[56:59], a[168:171], v[24:27], v[56:59]
ds_read_b128 v[40:43], v1 offset:15360
s_waitcnt lgkmcnt(3)
v_mfma_f32_16x16x32_bf16 v[60:63], a[168:171], v[28:31], v[60:63]
ds_read_b128 v[44:47], v1 offset:35840
s_waitcnt lgkmcnt(3)
v_mfma_f32_16x16x32_bf16 v[64:67], a[168:171], v[32:35], v[64:67]
ds_read_b128 v[48:51], v1 offset:56320
s_waitcnt lgkmcnt(3)
v_mfma_f32_16x16x32_bf16 v[68:71], a[168:171], v[36:39], v[68:71]
ds_read_b128 v[52:55], v238 offset:15360
v_mfma_f32_16x16x32_bf16 v[72:75], v[24:27], a[172:175], v[72:75]
v_mfma_f32_16x16x32_bf16 v[76:79], v[28:31], a[172:175], v[76:79]
buffer_load_dwordx4 a[248:251], v1, s[4:7], s42 offen offset:2048
v_mfma_f32_16x16x32_bf16 v[80:83], v[32:35], a[172:175], v[80:83]
buffer_load_dwordx4 a[252:255], v1, s[4:7], s42 offen offset:3072
v_mfma_f32_16x16x32_bf16 v[84:87], v[36:39], a[172:175], v[84:87]
s_add_u32 s42, s42, 4096
buffer_load_dwordx4 a[0:3], v1, s[4:7], s42 offen
v_mfma_f32_16x16x32_bf16 v[88:91], a[176:179], v[24:27], v[88:91]
v_mfma_f32_16x16x32_bf16 v[92:95], a[176:179], v[28:31], v[92:95]
v_mfma_f32_16x16x32_bf16 v[96:99], a[176:179], v[32:35], v[96:99]
v_mfma_f32_16x16x32_bf16 v[100:103], a[176:179], v[36:39], v[100:103]
s_waitcnt lgkmcnt(3)
v_mfma_f32_16x16x32_bf16 v[56:59], a[180:183], v[40:43], v[56:59]
ds_read_b64 v[24:25], v2 offset:16384
ds_read_b64 v[26:27], v2 offset:16896
s_waitcnt lgkmcnt(4)
v_mfma_f32_16x16x32_bf16 v[60:63], a[180:183], v[44:47], v[60:63]
ds_read_b64 v[28:29], v2 offset:36864
ds_read_b64 v[30:31], v2 offset:37376
s_waitcnt lgkmcnt(5)
v_mfma_f32_16x16x32_bf16 v[64:67], a[180:183], v[48:51], v[64:67]
ds_read_b64 v[32:33], v2 offset:57344
ds_read_b64 v[34:35], v2 offset:57856
s_waitcnt lgkmcnt(6)
v_mfma_f32_16x16x32_bf16 v[68:71], a[180:183], v[52:55], v[68:71]
ds_read_b64 v[36:37], v239 offset:16384
ds_read_b64 v[38:39], v239 offset:16896
v_mfma_f32_16x16x32_bf16 v[72:75], v[40:43], a[184:187], v[72:75]
v_mfma_f32_16x16x32_bf16 v[76:79], v[44:47], a[184:187], v[76:79]
buffer_load_dwordx4 a[4:7], v1, s[4:7], s42 offen offset:1024
v_mfma_f32_16x16x32_bf16 v[80:83], v[48:51], a[184:187], v[80:83]
buffer_load_dwordx4 a[8:11], v1, s[4:7], s42 offen offset:2048
v_mfma_f32_16x16x32_bf16 v[84:87], v[52:55], a[184:187], v[84:87]
buffer_load_dwordx4 a[12:15], v1, s[4:7], s42 offen offset:3072
s_waitcnt vmcnt(20)
v_mfma_f32_16x16x32_bf16 v[88:91], a[188:191], v[40:43], v[88:91]
v_mfma_f32_16x16x32_bf16 v[92:95], a[188:191], v[44:47], v[92:95]
v_mfma_f32_16x16x32_bf16 v[96:99], a[188:191], v[48:51], v[96:99]
v_mfma_f32_16x16x32_bf16 v[100:103], a[188:191], v[52:55], v[100:103]
s_waitcnt vmcnt(19)
s_waitcnt lgkmcnt(6)
v_mfma_f32_16x16x32_bf16 v[56:59], a[192:195], v[24:27], v[56:59]
ds_read_b64 v[40:41], v2 offset:17408
ds_read_b64 v[42:43], v2 offset:17920
s_waitcnt lgkmcnt(6)
v_mfma_f32_16x16x32_bf16 v[60:63], a[192:195], v[28:31], v[60:63]
ds_read_b64 v[44:45], v2 offset:37888
ds_read_b64 v[46:47], v2 offset:38400
s_waitcnt lgkmcnt(6)
v_mfma_f32_16x16x32_bf16 v[64:67], a[192:195], v[32:35], v[64:67]
ds_read_b64 v[48:49], v2 offset:58368
ds_read_b64 v[50:51], v2 offset:58880
s_waitcnt lgkmcnt(6)
v_mfma_f32_16x16x32_bf16 v[68:71], a[192:195], v[36:39], v[68:71]
ds_read_b64 v[52:53], v239 offset:17408
ds_read_b64 v[54:55], v239 offset:17920
s_waitcnt vmcnt(18)
v_mfma_f32_16x16x32_bf16 v[72:75], v[24:27], a[196:199], v[72:75]
v_mfma_f32_16x16x32_bf16 v[76:79], v[28:31], a[196:199], v[76:79]
s_add_u32 s42, s42, 4096
buffer_load_dwordx4 a[16:19], v1, s[4:7], s42 offen
v_mfma_f32_16x16x32_bf16 v[80:83], v[32:35], a[196:199], v[80:83]
buffer_load_dwordx4 a[20:23], v1, s[4:7], s42 offen offset:1024
v_mfma_f32_16x16x32_bf16 v[84:87], v[36:39], a[196:199], v[84:87]
buffer_load_dwordx4 a[24:27], v1, s[4:7], s42 offen offset:2048
s_waitcnt vmcnt(20)
v_mfma_f32_16x16x32_bf16 v[88:91], a[200:203], v[24:27], v[88:91]
v_mfma_f32_16x16x32_bf16 v[92:95], a[200:203], v[28:31], v[92:95]
v_mfma_f32_16x16x32_bf16 v[96:99], a[200:203], v[32:35], v[96:99]
v_mfma_f32_16x16x32_bf16 v[100:103], a[200:203], v[36:39], v[100:103]
s_waitcnt vmcnt(19)
s_waitcnt lgkmcnt(6)
v_mfma_f32_16x16x32_bf16 v[56:59], a[204:207], v[40:43], v[56:59]
ds_read_b64 v[24:25], v2 offset:18432
ds_read_b64 v[26:27], v2 offset:18944
s_waitcnt lgkmcnt(6)
v_mfma_f32_16x16x32_bf16 v[60:63], a[204:207], v[44:47], v[60:63]
ds_read_b64 v[28:29], v2 offset:38912
ds_read_b64 v[30:31], v2 offset:39424
s_waitcnt lgkmcnt(6)
v_mfma_f32_16x16x32_bf16 v[64:67], a[204:207], v[48:51], v[64:67]
ds_read_b64 v[32:33], v2 offset:59392
ds_read_b64 v[34:35], v2 offset:59904
s_waitcnt lgkmcnt(6)
v_mfma_f32_16x16x32_bf16 v[68:71], a[204:207], v[52:55], v[68:71]
ds_read_b64 v[36:37], v239 offset:18432
ds_read_b64 v[38:39], v239 offset:18944
s_waitcnt vmcnt(18)
v_mfma_f32_16x16x32_bf16 v[72:75], v[40:43], a[208:211], v[72:75]
v_mfma_f32_16x16x32_bf16 v[76:79], v[44:47], a[208:211], v[76:79]
buffer_load_dwordx4 a[28:31], v1, s[4:7], s42 offen offset:3072
v_mfma_f32_16x16x32_bf16 v[80:83], v[48:51], a[208:211], v[80:83]
s_add_u32 s42, s42, 4096
buffer_load_dwordx4 a[32:35], v1, s[4:7], s42 offen
v_mfma_f32_16x16x32_bf16 v[84:87], v[52:55], a[208:211], v[84:87]
buffer_load_dwordx4 a[36:39], v1, s[4:7], s42 offen offset:1024
s_waitcnt vmcnt(20)
v_mfma_f32_16x16x32_bf16 v[88:91], a[212:215], v[40:43], v[88:91]
v_mfma_f32_16x16x32_bf16 v[92:95], a[212:215], v[44:47], v[92:95]
v_mfma_f32_16x16x32_bf16 v[96:99], a[212:215], v[48:51], v[96:99]
v_mfma_f32_16x16x32_bf16 v[100:103], a[212:215], v[52:55], v[100:103]
s_waitcnt vmcnt(19)
s_waitcnt lgkmcnt(6)
v_mfma_f32_16x16x32_bf16 v[56:59], a[216:219], v[24:27], v[56:59]
ds_read_b64 v[40:41], v2 offset:19456
ds_read_b64 v[42:43], v2 offset:19968
s_waitcnt lgkmcnt(6)
v_mfma_f32_16x16x32_bf16 v[60:63], a[216:219], v[28:31], v[60:63]
ds_read_b64 v[44:45], v2 offset:39936
ds_read_b64 v[46:47], v2 offset:40448
s_waitcnt lgkmcnt(6)
v_mfma_f32_16x16x32_bf16 v[64:67], a[216:219], v[32:35], v[64:67]
ds_read_b64 v[48:49], v2 offset:60416
ds_read_b64 v[50:51], v2 offset:60928
s_waitcnt lgkmcnt(6)
v_mfma_f32_16x16x32_bf16 v[68:71], a[216:219], v[36:39], v[68:71]
ds_read_b64 v[52:53], v239 offset:19456
ds_read_b64 v[54:55], v239 offset:19968
s_waitcnt vmcnt(18)
v_mfma_f32_16x16x32_bf16 v[72:75], v[24:27], a[220:223], v[72:75]
v_mfma_f32_16x16x32_bf16 v[76:79], v[28:31], a[220:223], v[76:79]
buffer_load_dwordx4 a[40:43], v1, s[4:7], s42 offen offset:2048
v_mfma_f32_16x16x32_bf16 v[80:83], v[32:35], a[220:223], v[80:83]
buffer_load_dwordx4 a[44:47], v1, s[4:7], s42 offen offset:3072
v_mfma_f32_16x16x32_bf16 v[84:87], v[36:39], a[220:223], v[84:87]
s_add_u32 s42, s42, 4096
buffer_load_dwordx4 a[48:51], v1, s[4:7], s42 offen
s_waitcnt vmcnt(20)
v_mfma_f32_16x16x32_bf16 v[88:91], a[224:227], v[24:27], v[88:91]
v_mfma_f32_16x16x32_bf16 v[92:95], a[224:227], v[28:31], v[92:95]
v_mfma_f32_16x16x32_bf16 v[96:99], a[224:227], v[32:35], v[96:99]
v_mfma_f32_16x16x32_bf16 v[100:103], a[224:227], v[36:39], v[100:103]
s_waitcnt vmcnt(19)
s_waitcnt lgkmcnt(6)
v_mfma_f32_16x16x32_bf16 v[56:59], a[228:231], v[40:43], v[56:59]
s_waitcnt lgkmcnt(4)
v_mfma_f32_16x16x32_bf16 v[60:63], a[228:231], v[44:47], v[60:63]
buffer_load_dwordx4 a[52:55], v1, s[4:7], s42 offen offset:1024
s_waitcnt lgkmcnt(2)
v_mfma_f32_16x16x32_bf16 v[64:67], a[228:231], v[48:51], v[64:67]
buffer_load_dwordx4 a[56:59], v1, s[4:7], s42 offen offset:2048
s_waitcnt lgkmcnt(0)
v_mfma_f32_16x16x32_bf16 v[68:71], a[228:231], v[52:55], v[68:71]
buffer_load_dwordx4 a[60:63], v1, s[4:7], s42 offen offset:3072
s_waitcnt vmcnt(21)
v_mfma_f32_16x16x32_bf16 v[72:75], v[40:43], a[232:235], v[72:75]
v_mfma_f32_16x16x32_bf16 v[76:79], v[44:47], a[232:235], v[76:79]
v_mfma_f32_16x16x32_bf16 v[80:83], v[48:51], a[232:235], v[80:83]
v_mfma_f32_16x16x32_bf16 v[84:87], v[52:55], a[232:235], v[84:87]
s_waitcnt vmcnt(20)
v_mfma_f32_16x16x32_bf16 v[88:91], a[236:239], v[40:43], v[88:91]
v_mfma_f32_16x16x32_bf16 v[92:95], a[236:239], v[44:47], v[92:95]
v_mfma_f32_16x16x32_bf16 v[96:99], a[236:239], v[48:51], v[96:99]
v_mfma_f32_16x16x32_bf16 v[100:103], a[236:239], v[52:55], v[100:103]
v_lshlrev_b32 v3, 2, v241
v_add_u32 v3, 102400, v3
ds_read_b32 v136, v3 offset:0
ds_read_b32 v140, v3 offset:256
ds_read_b32 v137, v3 offset:64
ds_read_b32 v141, v3 offset:320
ds_read_b32 v138, v3 offset:128
ds_read_b32 v142, v3 offset:384
ds_read_b32 v139, v3 offset:192
ds_read_b32 v143, v3 offset:448
v_lshlrev_b32 v3, 4, v240
v_add_u32 v3, 102400, v3
ds_read_b128 v[144:147], v3 offset:0
ds_read_b128 v[160:163], v3 offset:256
ds_read_b128 v[148:151], v3 offset:64
ds_read_b128 v[164:167], v3 offset:320
ds_read_b128 v[152:155], v3 offset:128
ds_read_b128 v[168:171], v3 offset:384
ds_read_b128 v[156:159], v3 offset:192
ds_read_b128 v[172:175], v3 offset:448
s_waitcnt lgkmcnt(0)
s_lshl_b32 s24, s60, 14
s_add_u32 s24, s24, 13492224
s_lshl_b32 s25, s22, 12
s_add_u32 s25, s25, s24
s_mul_i32 s26, s60, 10240
s_add_u32 s26, s26, 21880832
s_lshl_b32 s27, s22, 11
s_add_u32 s27, s27, s26
s_add_u32 s26, s26, 8192
v_mul_f32 v194, 0x3ea52b5c, v140
v_mul_f32 v195, 0x3ea52b5c, v141
v_mul_f32 v196, 0x3ea52b5c, v142
v_mul_f32 v197, 0x3ea52b5c, v143
v_pk_fma_f32 v[88:89], v[184:185], v[136:137], v[88:89] op_sel:[0,0,0] op_sel_hi:[1,0,1]
v_pk_fma_f32 v[90:91], v[186:187], v[136:137], v[90:91] op_sel:[0,0,0] op_sel_hi:[1,0,1]
v_pk_mul_f32 v[88:89], v[88:89], v[194:195] op_sel:[0,0] op_sel_hi:[1,0]
v_pk_mul_f32 v[90:91], v[90:91], v[194:195] op_sel:[0,0] op_sel_hi:[1,0]
v_cvt_pk_bf16_f32 v40, v88, v89
v_cvt_pk_bf16_f32 v41, v90, v91
ds_write_b64 v239, v[40:41] offset:41984
v_pk_fma_f32 v[92:93], v[184:185], v[136:137], v[92:93] op_sel:[0,1,0] op_sel_hi:[1,1,1]
v_pk_fma_f32 v[94:95], v[186:187], v[136:137], v[94:95] op_sel:[0,1,0] op_sel_hi:[1,1,1]
v_pk_mul_f32 v[92:93], v[92:93], v[194:195] op_sel:[0,1] op_sel_hi:[1,1]
v_pk_mul_f32 v[94:95], v[94:95], v[194:195] op_sel:[0,1] op_sel_hi:[1,1]
v_cvt_pk_bf16_f32 v42, v92, v93
v_cvt_pk_bf16_f32 v43, v94, v95
ds_write_b64 v239, v[42:43] offset:42496
v_pk_fma_f32 v[96:97], v[184:185], v[138:139], v[96:97] op_sel:[0,0,0] op_sel_hi:[1,0,1]
v_pk_fma_f32 v[98:99], v[186:187], v[138:139], v[98:99] op_sel:[0,0,0] op_sel_hi:[1,0,1]
v_pk_mul_f32 v[96:97], v[96:97], v[196:197] op_sel:[0,0] op_sel_hi:[1,0]
v_pk_mul_f32 v[98:99], v[98:99], v[196:197] op_sel:[0,0] op_sel_hi:[1,0]
v_cvt_pk_bf16_f32 v44, v96, v97
v_cvt_pk_bf16_f32 v45, v98, v99
ds_write_b64 v239, v[44:45] offset:43008
v_pk_fma_f32 v[100:101], v[184:185], v[138:139], v[100:101] op_sel:[0,1,0] op_sel_hi:[1,1,1]
v_pk_fma_f32 v[102:103], v[186:187], v[138:139], v[102:103] op_sel:[0,1,0] op_sel_hi:[1,1,1]
v_pk_mul_f32 v[100:101], v[100:101], v[196:197] op_sel:[0,1] op_sel_hi:[1,1]
v_pk_mul_f32 v[102:103], v[102:103], v[196:197] op_sel:[0,1] op_sel_hi:[1,1]
v_cvt_pk_bf16_f32 v46, v100, v101
v_cvt_pk_bf16_f32 v47, v102, v103
ds_write_b64 v239, v[46:47] offset:43520
v_pk_fma_f32 v[72:73], v[144:145], v[188:189], v[72:73] op_sel:[0,0,0] op_sel_hi:[1,0,1]
v_pk_fma_f32 v[74:75], v[146:147], v[188:189], v[74:75] op_sel:[0,0,0] op_sel_hi:[1,0,1]
v_pk_mul_f32 v[72:73], v[72:73], v[160:161]
v_pk_mul_f32 v[74:75], v[74:75], v[162:163]
v_cvt_pk_bf16_f32 v48, v72, v73
v_cvt_pk_bf16_f32 v49, v74, v75
v_pk_fma_f32 v[76:77], v[148:149], v[188:189], v[76:77] op_sel:[0,0,0] op_sel_hi:[1,0,1]
v_pk_fma_f32 v[78:79], v[150:151], v[188:189], v[78:79] op_sel:[0,0,0] op_sel_hi:[1,0,1]
v_pk_mul_f32 v[76:77], v[76:77], v[164:165]
v_pk_mul_f32 v[78:79], v[78:79], v[166:167]
v_cvt_pk_bf16_f32 v50, v76, v77
v_cvt_pk_bf16_f32 v51, v78, v79
buffer_store_dwordx4 v[48:51], v1, s[4:7], s27 offen offset:0 sc1
v_pk_fma_f32 v[80:81], v[152:153], v[188:189], v[80:81] op_sel:[0,0,0] op_sel_hi:[1,0,1]
v_pk_fma_f32 v[82:83], v[154:155], v[188:189], v[82:83] op_sel:[0,0,0] op_sel_hi:[1,0,1]
v_pk_mul_f32 v[80:81], v[80:81], v[168:169]
v_pk_mul_f32 v[82:83], v[82:83], v[170:171]
v_cvt_pk_bf16_f32 v52, v80, v81
v_cvt_pk_bf16_f32 v53, v82, v83
v_pk_fma_f32 v[84:85], v[156:157], v[188:189], v[84:85] op_sel:[0,0,0] op_sel_hi:[1,0,1]
v_pk_fma_f32 v[86:87], v[158:159], v[188:189], v[86:87] op_sel:[0,0,0] op_sel_hi:[1,0,1]
v_pk_mul_f32 v[84:85], v[84:85], v[172:173]
v_pk_mul_f32 v[86:87], v[86:87], v[174:175]
v_cvt_pk_bf16_f32 v54, v84, v85
v_cvt_pk_bf16_f32 v55, v86, v87
buffer_store_dwordx4 v[52:55], v1, s[4:7], s27 offen offset:1024 sc1
v_pk_fma_f32 v[56:57], v[176:177], v[136:137], v[56:57] op_sel:[0,0,0] op_sel_hi:[1,0,1]
v_pk_fma_f32 v[58:59], v[178:179], v[136:137], v[58:59] op_sel:[0,0,0] op_sel_hi:[1,0,1]
v_pk_mul_f32 v[56:57], v[56:57], v[140:141] op_sel:[0,0] op_sel_hi:[1,0]
v_pk_mul_f32 v[58:59], v[58:59], v[140:141] op_sel:[0,0] op_sel_hi:[1,0]
v_cvt_pk_bf16_f32 v24, v56, v57
v_cvt_pk_bf16_f32 v25, v58, v59
v_pk_fma_f32 v[60:61], v[176:177], v[136:137], v[60:61] op_sel:[0,1,0] op_sel_hi:[1,1,1]
v_pk_fma_f32 v[62:63], v[178:179], v[136:137], v[62:63] op_sel:[0,1,0] op_sel_hi:[1,1,1]
v_pk_mul_f32 v[60:61], v[60:61], v[140:141] op_sel:[0,1] op_sel_hi:[1,1]
v_pk_mul_f32 v[62:63], v[62:63], v[140:141] op_sel:[0,1] op_sel_hi:[1,1]
v_cvt_pk_bf16_f32 v28, v60, v61
v_cvt_pk_bf16_f32 v29, v62, v63
v_pk_fma_f32 v[64:65], v[176:177], v[138:139], v[64:65] op_sel:[0,0,0] op_sel_hi:[1,0,1]
v_pk_fma_f32 v[66:67], v[178:179], v[138:139], v[66:67] op_sel:[0,0,0] op_sel_hi:[1,0,1]
v_pk_mul_f32 v[64:65], v[64:65], v[142:143] op_sel:[0,0] op_sel_hi:[1,0]
v_pk_mul_f32 v[66:67], v[66:67], v[142:143] op_sel:[0,0] op_sel_hi:[1,0]
v_cvt_pk_bf16_f32 v32, v64, v65
v_cvt_pk_bf16_f32 v33, v66, v67
v_pk_fma_f32 v[68:69], v[176:177], v[138:139], v[68:69] op_sel:[0,1,0] op_sel_hi:[1,1,1]
v_pk_fma_f32 v[70:71], v[178:179], v[138:139], v[70:71] op_sel:[0,1,0] op_sel_hi:[1,1,1]
v_pk_mul_f32 v[68:69], v[68:69], v[142:143] op_sel:[0,1] op_sel_hi:[1,1]
v_pk_mul_f32 v[70:71], v[70:71], v[142:143] op_sel:[0,1] op_sel_hi:[1,1]
v_cvt_pk_bf16_f32 v36, v68, v69
v_cvt_pk_bf16_f32 v37, v70, v71
s_waitcnt lgkmcnt(0)
s_barrier
ds_read_b64 v[26:27], v239 offset:44032
ds_read_b64 v[30:31], v239 offset:44544
ds_read_b64 v[34:35], v239 offset:45056
ds_read_b64 v[38:39], v239 offset:45568
ds_read_b64 v[202:203], v239 offset:41984
ds_read_b64 v[206:207], v239 offset:42496
ds_read_b64 v[210:211], v239 offset:43008
ds_read_b64 v[214:215], v239 offset:43520
s_waitcnt lgkmcnt(7)
buffer_store_dwordx4 v[24:27], v1, s[4:7], s25 offen offset:0 sc1
s_waitcnt lgkmcnt(6)
buffer_store_dwordx4 v[28:31], v1, s[4:7], s25 offen offset:1024 sc1
s_waitcnt lgkmcnt(5)
buffer_store_dwordx4 v[32:35], v1, s[4:7], s25 offen offset:2048 sc1
s_waitcnt lgkmcnt(4)
buffer_store_dwordx4 v[36:39], v1, s[4:7], s25 offen offset:3072 sc1
s_waitcnt lgkmcnt(0)
v_cmp_eq_u32 vcc, s22, v240
s_nop 1
v_cndmask_b32 v202, 0, v202, vcc
v_cndmask_b32 v203, 0, v203, vcc
v_cndmask_b32 v206, 0, v206, vcc
v_cndmask_b32 v207, 0, v207, vcc
v_cndmask_b32 v210, 0, v210, vcc
v_cndmask_b32 v211, 0, v211, vcc
v_cndmask_b32 v214, 0, v214, vcc
v_cndmask_b32 v215, 0, v215, vcc
s_waitcnt vmcnt(0)
v_mov_b32 v3, 1
s_mov_b64 exec, 1
buffer_store_dword v3, off, s[4:7], s23 sc1
s_mov_b64 exec, -1
ds_read_b128 v[24:27], v1 offset:0
ds_read_b128 v[28:31], v1 offset:20480
ds_read_b128 v[32:35], v1 offset:40960
ds_read_b128 v[36:39], v238 offset:0
s_waitcnt lgkmcnt(3)
v_mfma_f32_16x16x32_bf16 v[104:107], a[240:243], v[24:27], 0
ds_read_b128 v[40:43], v1 offset:1024
ds_read_b128 v[44:47], v1 offset:21504
s_waitcnt lgkmcnt(4)
v_mfma_f32_16x16x32_bf16 v[108:111], a[240:243], v[28:31], 0
ds_read_b128 v[48:51], v1 offset:41984
ds_read_b128 v[52:55], v238 offset:1024
s_waitcnt lgkmcnt(5)
v_mfma_f32_16x16x32_bf16 v[112:115], a[240:243], v[32:35], 0
s_waitcnt lgkmcnt(4)
v_mfma_f32_16x16x32_bf16 v[116:119], a[240:243], v[36:39], 0
s_waitcnt lgkmcnt(3)
v_mfma_f32_16x16x32_bf16 v[104:107], a[244:247], v[40:43], v[104:107]
ds_read_b128 v[24:27], v1 offset:2048
ds_read_b128 v[28:31], v1 offset:22528
s_waitcnt lgkmcnt(4)
v_mfma_f32_16x16x32_bf16 v[108:111], a[244:247], v[44:47], v[108:111]
ds_read_b128 v[32:35], v1 offset:43008
ds_read_b128 v[36:39], v238 offset:2048
s_waitcnt lgkmcnt(5)
v_mfma_f32_16x16x32_bf16 v[112:115], a[244:247], v[48:51], v[112:115]
s_waitcnt lgkmcnt(4)
v_mfma_f32_16x16x32_bf16 v[116:119], a[244:247], v[52:55], v[116:119]
s_waitcnt lgkmcnt(3)
v_mfma_f32_16x16x32_bf16 v[104:107], a[248:251], v[24:27], v[104:107]
ds_read_b128 v[40:43], v1 offset:3072
ds_read_b128 v[44:47], v1 offset:23552
s_waitcnt lgkmcnt(4)
v_mfma_f32_16x16x32_bf16 v[108:111], a[248:251], v[28:31], v[108:111]
ds_read_b128 v[48:51], v1 offset:44032
ds_read_b128 v[52:55], v238 offset:3072
s_waitcnt lgkmcnt(5)
v_mfma_f32_16x16x32_bf16 v[112:115], a[248:251], v[32:35], v[112:115]
s_waitcnt lgkmcnt(4)
v_mfma_f32_16x16x32_bf16 v[116:119], a[248:251], v[36:39], v[116:119]
s_waitcnt lgkmcnt(3)
v_mfma_f32_16x16x32_bf16 v[104:107], a[252:255], v[40:43], v[104:107]
ds_read_b128 v[24:27], v1 offset:4096
ds_read_b128 v[28:31], v1 offset:24576
s_waitcnt lgkmcnt(4)
v_mfma_f32_16x16x32_bf16 v[108:111], a[252:255], v[44:47], v[108:111]
ds_read_b128 v[32:35], v1 offset:45056
ds_read_b128 v[36:39], v238 offset:4096
s_waitcnt lgkmcnt(5)
v_mfma_f32_16x16x32_bf16 v[112:115], a[252:255], v[48:51], v[112:115]
s_waitcnt lgkmcnt(4)
v_mfma_f32_16x16x32_bf16 v[116:119], a[252:255], v[52:55], v[116:119]
s_waitcnt lgkmcnt(3)
v_mfma_f32_16x16x32_bf16 v[104:107], a[0:3], v[24:27], v[104:107]
ds_read_b128 v[40:43], v1 offset:5120
ds_read_b128 v[44:47], v1 offset:25600
s_waitcnt lgkmcnt(4)
v_mfma_f32_16x16x32_bf16 v[108:111], a[0:3], v[28:31], v[108:111]
ds_read_b128 v[48:51], v1 offset:46080
ds_read_b128 v[52:55], v238 offset:5120
s_waitcnt lgkmcnt(5)
v_mfma_f32_16x16x32_bf16 v[112:115], a[0:3], v[32:35], v[112:115]
s_waitcnt lgkmcnt(4)
v_mfma_f32_16x16x32_bf16 v[116:119], a[0:3], v[36:39], v[116:119]
s_waitcnt lgkmcnt(3)
v_mfma_f32_16x16x32_bf16 v[104:107], a[4:7], v[40:43], v[104:107]
ds_read_b128 v[24:27], v1 offset:6144
ds_read_b128 v[28:31], v1 offset:26624
s_waitcnt lgkmcnt(4)
v_mfma_f32_16x16x32_bf16 v[108:111], a[4:7], v[44:47], v[108:111]
ds_read_b128 v[32:35], v1 offset:47104
ds_read_b128 v[36:39], v238 offset:6144
s_waitcnt lgkmcnt(5)
v_mfma_f32_16x16x32_bf16 v[112:115], a[4:7], v[48:51], v[112:115]
s_waitcnt lgkmcnt(4)
v_mfma_f32_16x16x32_bf16 v[116:119], a[4:7], v[52:55], v[116:119]
s_waitcnt lgkmcnt(3)
v_mfma_f32_16x16x32_bf16 v[104:107], a[8:11], v[24:27], v[104:107]
ds_read_b128 v[40:43], v1 offset:7168
ds_read_b128 v[44:47], v1 offset:27648
s_waitcnt lgkmcnt(4)
v_mfma_f32_16x16x32_bf16 v[108:111], a[8:11], v[28:31], v[108:111]
ds_read_b128 v[48:51], v1 offset:48128
ds_read_b128 v[52:55], v238 offset:7168
s_waitcnt lgkmcnt(5)
v_mfma_f32_16x16x32_bf16 v[112:115], a[8:11], v[32:35], v[112:115]
s_waitcnt lgkmcnt(4)
v_mfma_f32_16x16x32_bf16 v[116:119], a[8:11], v[36:39], v[116:119]
s_waitcnt lgkmcnt(3)
v_mfma_f32_16x16x32_bf16 v[104:107], a[12:15], v[40:43], v[104:107]
ds_read_b128 v[24:27], v1 offset:8192
ds_read_b128 v[28:31], v1 offset:28672
s_waitcnt lgkmcnt(4)
v_mfma_f32_16x16x32_bf16 v[108:111], a[12:15], v[44:47], v[108:111]
ds_read_b128 v[32:35], v1 offset:49152
ds_read_b128 v[36:39], v238 offset:8192
s_waitcnt lgkmcnt(5)
v_mfma_f32_16x16x32_bf16 v[112:115], a[12:15], v[48:51], v[112:115]
s_waitcnt lgkmcnt(4)
v_mfma_f32_16x16x32_bf16 v[116:119], a[12:15], v[52:55], v[116:119]
s_waitcnt lgkmcnt(3)
v_mfma_f32_16x16x32_bf16 v[104:107], a[16:19], v[24:27], v[104:107]
ds_read_b128 v[40:43], v1 offset:9216
ds_read_b128 v[44:47], v1 offset:29696
s_waitcnt lgkmcnt(4)
v_mfma_f32_16x16x32_bf16 v[108:111], a[16:19], v[28:31], v[108:111]
ds_read_b128 v[48:51], v1 offset:50176
ds_read_b128 v[52:55], v238 offset:9216
s_waitcnt lgkmcnt(5)
v_mfma_f32_16x16x32_bf16 v[112:115], a[16:19], v[32:35], v[112:115]
s_waitcnt lgkmcnt(4)
v_mfma_f32_16x16x32_bf16 v[116:119], a[16:19], v[36:39], v[116:119]
s_waitcnt lgkmcnt(3)
v_mfma_f32_16x16x32_bf16 v[104:107], a[20:23], v[40:43], v[104:107]
ds_read_b128 v[24:27], v1 offset:10240
ds_read_b128 v[28:31], v1 offset:30720
s_waitcnt lgkmcnt(4)
v_mfma_f32_16x16x32_bf16 v[108:111], a[20:23], v[44:47], v[108:111]
ds_read_b128 v[32:35], v1 offset:51200
ds_read_b128 v[36:39], v238 offset:10240
s_waitcnt lgkmcnt(5)
v_mfma_f32_16x16x32_bf16 v[112:115], a[20:23], v[48:51], v[112:115]
s_waitcnt lgkmcnt(4)
v_mfma_f32_16x16x32_bf16 v[116:119], a[20:23], v[52:55], v[116:119]
s_waitcnt lgkmcnt(3)
v_mfma_f32_16x16x32_bf16 v[104:107], a[24:27], v[24:27], v[104:107]
ds_read_b128 v[40:43], v1 offset:11264
ds_read_b128 v[44:47], v1 offset:31744
s_waitcnt lgkmcnt(4)
v_mfma_f32_16x16x32_bf16 v[108:111], a[24:27], v[28:31], v[108:111]
ds_read_b128 v[48:51], v1 offset:52224
ds_read_b128 v[52:55], v238 offset:11264
s_waitcnt lgkmcnt(5)
v_mfma_f32_16x16x32_bf16 v[112:115], a[24:27], v[32:35], v[112:115]
s_waitcnt lgkmcnt(4)
v_mfma_f32_16x16x32_bf16 v[116:119], a[24:27], v[36:39], v[116:119]
s_waitcnt lgkmcnt(3)
v_mfma_f32_16x16x32_bf16 v[104:107], a[28:31], v[40:43], v[104:107]
ds_read_b128 v[24:27], v1 offset:12288
ds_read_b128 v[28:31], v1 offset:32768
s_waitcnt lgkmcnt(4)
v_mfma_f32_16x16x32_bf16 v[108:111], a[28:31], v[44:47], v[108:111]
ds_read_b128 v[32:35], v1 offset:53248
ds_read_b128 v[36:39], v238 offset:12288
s_waitcnt lgkmcnt(5)
v_mfma_f32_16x16x32_bf16 v[112:115], a[28:31], v[48:51], v[112:115]
s_waitcnt lgkmcnt(4)
v_mfma_f32_16x16x32_bf16 v[116:119], a[28:31], v[52:55], v[116:119]
s_waitcnt lgkmcnt(3)
v_mfma_f32_16x16x32_bf16 v[104:107], a[32:35], v[24:27], v[104:107]
ds_read_b128 v[40:43], v1 offset:13312
ds_read_b128 v[44:47], v1 offset:33792
s_waitcnt lgkmcnt(4)
v_mfma_f32_16x16x32_bf16 v[108:111], a[32:35], v[28:31], v[108:111]
ds_read_b128 v[48:51], v1 offset:54272
ds_read_b128 v[52:55], v238 offset:13312
s_waitcnt lgkmcnt(5)
v_mfma_f32_16x16x32_bf16 v[112:115], a[32:35], v[32:35], v[112:115]
s_waitcnt lgkmcnt(4)
v_mfma_f32_16x16x32_bf16 v[116:119], a[32:35], v[36:39], v[116:119]
s_waitcnt lgkmcnt(3)
v_mfma_f32_16x16x32_bf16 v[104:107], a[36:39], v[40:43], v[104:107]
ds_read_b128 v[24:27], v1 offset:14336
ds_read_b128 v[28:31], v1 offset:34816
s_waitcnt lgkmcnt(4)
v_mfma_f32_16x16x32_bf16 v[108:111], a[36:39], v[44:47], v[108:111]
ds_read_b128 v[32:35], v1 offset:55296
ds_read_b128 v[36:39], v238 offset:14336
s_waitcnt lgkmcnt(5)
v_mfma_f32_16x16x32_bf16 v[112:115], a[36:39], v[48:51], v[112:115]
s_waitcnt lgkmcnt(4)
v_mfma_f32_16x16x32_bf16 v[116:119], a[36:39], v[52:55], v[116:119]
s_waitcnt lgkmcnt(3)
v_mfma_f32_16x16x32_bf16 v[104:107], a[40:43], v[24:27], v[104:107]
ds_read_b128 v[40:43], v1 offset:15360
ds_read_b128 v[44:47], v1 offset:35840
s_waitcnt lgkmcnt(4)
v_mfma_f32_16x16x32_bf16 v[108:111], a[40:43], v[28:31], v[108:111]
ds_read_b128 v[48:51], v1 offset:56320
ds_read_b128 v[52:55], v238 offset:15360
s_waitcnt lgkmcnt(5)
v_mfma_f32_16x16x32_bf16 v[112:115], a[40:43], v[32:35], v[112:115]
s_waitcnt lgkmcnt(4)
v_mfma_f32_16x16x32_bf16 v[116:119], a[40:43], v[36:39], v[116:119]
s_waitcnt lgkmcnt(3)
v_mfma_f32_16x16x32_bf16 v[104:107], a[44:47], v[40:43], v[104:107]
ds_read_b64 v[24:25], v2 offset:16384
ds_read_b64 v[26:27], v2 offset:16896
ds_read_b64 v[28:29], v2 offset:36864
ds_read_b64 v[30:31], v2 offset:37376
s_waitcnt lgkmcnt(6)
v_mfma_f32_16x16x32_bf16 v[108:111], a[44:47], v[44:47], v[108:111]
ds_read_b64 v[32:33], v2 offset:57344
ds_read_b64 v[34:35], v2 offset:57856
ds_read_b64 v[36:37], v239 offset:16384
ds_read_b64 v[38:39], v239 offset:16896
s_waitcnt lgkmcnt(9)
v_mfma_f32_16x16x32_bf16 v[112:115], a[44:47], v[48:51], v[112:115]
s_waitcnt lgkmcnt(8)
v_mfma_f32_16x16x32_bf16 v[116:119], a[44:47], v[52:55], v[116:119]
s_waitcnt lgkmcnt(6)
v_mfma_f32_16x16x32_bf16 v[104:107], a[48:51], v[24:27], v[104:107]
ds_read_b64 v[40:41], v2 offset:17408
ds_read_b64 v[42:43], v2 offset:17920
ds_read_b64 v[44:45], v2 offset:37888
ds_read_b64 v[46:47], v2 offset:38400
s_waitcnt lgkmcnt(8)
v_mfma_f32_16x16x32_bf16 v[108:111], a[48:51], v[28:31], v[108:111]
ds_read_b64 v[48:49], v2 offset:58368
ds_read_b64 v[50:51], v2 offset:58880
ds_read_b64 v[52:53], v239 offset:17408
ds_read_b64 v[54:55], v239 offset:17920
s_waitcnt lgkmcnt(10)
v_mfma_f32_16x16x32_bf16 v[112:115], a[48:51], v[32:35], v[112:115]
s_waitcnt lgkmcnt(8)
v_mfma_f32_16x16x32_bf16 v[116:119], a[48:51], v[36:39], v[116:119]
s_waitcnt lgkmcnt(6)
v_mfma_f32_16x16x32_bf16 v[104:107], a[52:55], v[40:43], v[104:107]
ds_read_b64 v[24:25], v2 offset:18432
ds_read_b64 v[26:27], v2 offset:18944
ds_read_b64 v[28:29], v2 offset:38912
ds_read_b64 v[30:31], v2 offset:39424
s_waitcnt lgkmcnt(8)
v_mfma_f32_16x16x32_bf16 v[108:111], a[52:55], v[44:47], v[108:111]
ds_read_b64 v[32:33], v2 offset:59392
ds_read_b64 v[34:35], v2 offset:59904
ds_read_b64 v[36:37], v239 offset:18432
ds_read_b64 v[38:39], v239 offset:18944
s_waitcnt lgkmcnt(10)
v_mfma_f32_16x16x32_bf16 v[112:115], a[52:55], v[48:51], v[112:115]
s_waitcnt lgkmcnt(8)
v_mfma_f32_16x16x32_bf16 v[116:119], a[52:55], v[52:55], v[116:119]
s_waitcnt lgkmcnt(6)
v_mfma_f32_16x16x32_bf16 v[104:107], a[56:59], v[24:27], v[104:107]
ds_read_b64 v[40:41], v2 offset:19456
ds_read_b64 v[42:43], v2 offset:19968
ds_read_b64 v[44:45], v2 offset:39936
ds_read_b64 v[46:47], v2 offset:40448
s_waitcnt lgkmcnt(8)
v_mfma_f32_16x16x32_bf16 v[108:111], a[56:59], v[28:31], v[108:111]
ds_read_b64 v[48:49], v2 offset:60416
ds_read_b64 v[50:51], v2 offset:60928
ds_read_b64 v[52:53], v239 offset:19456
ds_read_b64 v[54:55], v239 offset:19968
s_waitcnt lgkmcnt(10)
v_mfma_f32_16x16x32_bf16 v[112:115], a[56:59], v[32:35], v[112:115]
s_waitcnt lgkmcnt(8)
v_mfma_f32_16x16x32_bf16 v[116:119], a[56:59], v[36:39], v[116:119]
s_waitcnt lgkmcnt(6)
v_mfma_f32_16x16x32_bf16 v[104:107], a[60:63], v[40:43], v[104:107]
s_waitcnt lgkmcnt(4)
v_mfma_f32_16x16x32_bf16 v[108:111], a[60:63], v[44:47], v[108:111]
s_waitcnt lgkmcnt(2)
v_mfma_f32_16x16x32_bf16 v[112:115], a[60:63], v[48:51], v[112:115]
s_waitcnt lgkmcnt(0)
v_mfma_f32_16x16x32_bf16 v[116:119], a[60:63], v[52:55], v[116:119]
s_mov_b32 s24, 0x3ea52b5c
v_mul_f32 v140, s24, v140
v_mul_f32 v141, s24, v141
v_mul_f32 v142, s24, v142
v_mul_f32 v143, s24, v143
v_pk_fma_f32 v[104:105], v[180:181], v[136:137], v[104:105] op_sel:[0,0,0] op_sel_hi:[1,0,1]
v_pk_fma_f32 v[106:107], v[182:183], v[136:137], v[106:107] op_sel:[0,0,0] op_sel_hi:[1,0,1]
v_pk_mul_f32 v[104:105], v[104:105], v[140:141] op_sel:[0,0] op_sel_hi:[1,0]
v_pk_mul_f32 v[106:107], v[106:107], v[140:141] op_sel:[0,0] op_sel_hi:[1,0]
v_cvt_pk_bf16_f32 v200, v104, v105
v_cvt_pk_bf16_f32 v201, v106, v107
v_pk_fma_f32 v[108:109], v[180:181], v[136:137], v[108:109] op_sel:[0,1,0] op_sel_hi:[1,1,1]
v_pk_fma_f32 v[110:111], v[182:183], v[136:137], v[110:111] op_sel:[0,1,0] op_sel_hi:[1,1,1]
v_pk_mul_f32 v[108:109], v[108:109], v[140:141] op_sel:[0,1] op_sel_hi:[1,1]
v_pk_mul_f32 v[110:111], v[110:111], v[140:141] op_sel:[0,1] op_sel_hi:[1,1]
v_cvt_pk_bf16_f32 v204, v108, v109
v_cvt_pk_bf16_f32 v205, v110, v111
v_pk_fma_f32 v[112:113], v[180:181], v[138:139], v[112:113] op_sel:[0,0,0] op_sel_hi:[1,0,1]
v_pk_fma_f32 v[114:115], v[182:183], v[138:139], v[114:115] op_sel:[0,0,0] op_sel_hi:[1,0,1]
v_pk_mul_f32 v[112:113], v[112:113], v[142:143] op_sel:[0,0] op_sel_hi:[1,0]
v_pk_mul_f32 v[114:115], v[114:115], v[142:143] op_sel:[0,0] op_sel_hi:[1,0]
v_cvt_pk_bf16_f32 v208, v112, v113
v_cvt_pk_bf16_f32 v209, v114, v115
v_pk_fma_f32 v[116:117], v[180:181], v[138:139], v[116:117] op_sel:[0,1,0] op_sel_hi:[1,1,1]
v_pk_fma_f32 v[118:119], v[182:183], v[138:139], v[118:119] op_sel:[0,1,0] op_sel_hi:[1,1,1]
v_pk_mul_f32 v[116:117], v[116:117], v[142:143] op_sel:[0,1] op_sel_hi:[1,1]
v_pk_mul_f32 v[118:119], v[118:119], v[142:143] op_sel:[0,1] op_sel_hi:[1,1]
v_cvt_pk_bf16_f32 v212, v116, v117
v_cvt_pk_bf16_f32 v213, v118, v119
s_nop 7
s_branch FE2
FK6:
s_mul_i32 s24, s21, 960
s_lshl_b32 s25, s22, 6
s_add_u32 s24, s24, s25
s_add_u32 s24, s24, 7700480
v_lshlrev_b32 v3, 4, v240
v_lshlrev_b32 v192, 2, v241
buffer_load_dwordx4 v[176:179], v3, s[4:7], s24 offen
buffer_load_dwordx4 v[180:183], v3, s[4:7], s24 offen offset:512
buffer_load_dword v188, v192, s[4:7], s24 offen offset:256
s_lshl_b32 s26, s60, 9
s_and_b32 s26, s26, 0xfffff000
s_lshl_b32 s27, s22, 7
s_add_u32 s26, s26, s27
s_add_u32 s26, s26, 12967936
v_lshrrev_b32 v24, 3, v0
v_lshlrev_b32 v24, 9, v24
v_and_b32 v25, 7, v0
v_lshlrev_b32 v25, 4, v25
v_add_u32 v24, v24, v25
buffer_load_dwordx4 v[28:31], v24, s[4:7], s26 offen
s_mul_i32 s69, s62, 20480
s_add_u32 s69, s69, 7725056
s_mul_i32 s70, s22, 20480
s_mov_b32 m0, s70
s_nop 0
buffer_load_dwordx4 v1, s[4:7], s69 offen offset:0 sc1 lds
buffer_load_dwordx4 a[0:3], v1, s[4:7], s40 offen
buffer_load_dwordx4 a[4:7], v1, s[4:7], s41 offen
s_mov_b32 m0, s70
s_nop 0
buffer_load_dwordx4 v1, s[4:7], s69 offen offset:1024 sc1 lds
buffer_load_dwordx4 a[8:11], v1, s[4:7], s40 offen offset:1024
buffer_load_dwordx4 a[12:15], v1, s[4:7], s41 offen offset:1024
s_mov_b32 m0, s70
s_nop 0
buffer_load_dwordx4 v1, s[4:7], s69 offen offset:2048 sc1 lds
buffer_load_dwordx4 a[16:19], v1, s[4:7], s40 offen offset:2048
buffer_load_dwordx4 a[20:23], v1, s[4:7], s41 offen offset:2048
s_mov_b32 m0, s70
s_nop 0
buffer_load_dwordx4 v1, s[4:7], s69 offen offset:3072 sc1 lds
buffer_load_dwordx4 a[24:27], v1, s[4:7], s40 offen offset:3072
buffer_load_dwordx4 a[28:31], v1, s[4:7], s41 offen offset:3072
s_add_u32 s69, s69, 4096
s_add_u32 s70, s70, 4096
s_mov_b32 m0, s70
s_nop 0
buffer_load_dwordx4 v1, s[4:7], s69 offen offset:0 sc1 lds
s_add_u32 s40, s40, 4096
buffer_load_dwordx4 a[32:35], v1, s[4:7], s40 offen
s_add_u32 s41, s41, 4096
buffer_load_dwordx4 a[36:39], v1, s[4:7], s41 offen
s_mov_b32 m0, s70
s_nop 0
buffer_load_dwordx4 v1, s[4:7], s69 offen offset:1024 sc1 lds
buffer_load_dwordx4 a[40:43], v1, s[4:7], s40 offen offset:1024
buffer_load_dwordx4 a[44:47], v1, s[4:7], s41 offen offset:1024
s_mov_b32 m0, s70
s_nop 0
buffer_load_dwordx4 v1, s[4:7], s69 offen offset:2048 sc1 lds
buffer_load_dwordx4 a[48:51], v1, s[4:7], s40 offen offset:2048
buffer_load_dwordx4 a[52:55], v1, s[4:7], s41 offen offset:2048
s_mov_b32 m0, s70
s_nop 0
buffer_load_dwordx4 v1, s[4:7], s69 offen offset:3072 sc1 lds
buffer_load_dwordx4 a[56:59], v1, s[4:7], s40 offen offset:3072
buffer_load_dwordx4 a[60:63], v1, s[4:7], s41 offen offset:3072
s_add_u32 s69, s69, 4096
s_add_u32 s70, s70, 4096
s_mov_b32 m0, s70
s_nop 0
buffer_load_dwordx4 v1, s[4:7], s69 offen offset:0 sc1 lds
s_add_u32 s40, s40, 4096
buffer_load_dwordx4 a[64:67], v1, s[4:7], s40 offen
s_add_u32 s41, s41, 4096
buffer_load_dwordx4 a[68:71], v1, s[4:7], s41 offen
s_mov_b32 m0, s70
s_nop 0
buffer_load_dwordx4 v1, s[4:7], s69 offen offset:1024 sc1 lds
buffer_load_dwordx4 a[72:75], v1, s[4:7], s40 offen offset:1024
buffer_load_dwordx4 a[76:79], v1, s[4:7], s41 offen offset:1024
s_waitcnt vmcnt(30)
v_mov_b32 v32, v28
v_mov_b32 v33, v29
v_mov_b32 v34, v30
v_mov_b32 v35, v31
v_permlane32_swap_b32 v28, v32
v_permlane32_swap_b32 v29, v33
v_permlane32_swap_b32 v30, v34
v_permlane32_swap_b32 v31, v35
v_add_f32 v28, v28, v32
v_add_f32 v29, v29, v33
v_add_f32 v30, v30, v34
v_add_f32 v31, v31, v35
v_mov_b32 v32, v28
v_mov_b32 v33, v29
v_mov_b32 v34, v30
v_mov_b32 v35, v31
v_permlane16_swap_b32 v28, v32
v_permlane16_swap_b32 v29, v33
v_permlane16_swap_b32 v30, v34
v_permlane16_swap_b32 v31, v35
v_add_f32 v28, v28, v32
v_add_f32 v29, v29, v33
v_add_f32 v30, v30, v34
v_add_f32 v31, v31, v35
v_add_f32_dpp v28, v28, v28 row_ror:8 row_mask:0xf bank_mask:0xf
v_add_f32_dpp v29, v29, v29 row_ror:8 row_mask:0xf bank_mask:0xf
v_add_f32_dpp v30, v30, v30 row_ror:8 row_mask:0xf bank_mask:0xf
v_add_f32_dpp v31, v31, v31 row_ror:8 row_mask:0xf bank_mask:0xf
s_mov_b32 s26, 0xbacccccd
s_mov_b32 s27, 0x3acccccd
v_mul_f32 v32, s26, v28
v_mul_f32 v33, s26, v30
v_mul_f32 v34, s27, v29
v_mul_f32 v35, s27, v31
v_fma_f32 v34, -v32, v32, v34
v_fma_f32 v35, -v33, v33, v35
v_max_f32 v34, 0, v34
v_max_f32 v35, 0, v35
v_add_f32 v34, 0x3727c5ac, v34
v_add_f32 v35, 0x3727c5ac, v35
v_rsq_f32 v34, v34
v_rsq_f32 v35, v35
v_and_b32 v24, 7, v0
v_lshlrev_b32 v24, 3, v24
s_lshl_b32 s26, s22, 6
s_add_u32 s26, s26, 102400
v_add_u32 v24, s26, v24
s_mov_b64 exec, 0xff
ds_write_b64 v24, v[32:33]
ds_write_b64 v24, v[34:35] offset:256
s_mov_b64 exec, -1
s_waitcnt vmcnt(17)
s_waitcnt lgkmcnt(0)
s_barrier
ds_read_b128 v[24:27], v1 offset:0
ds_read_b128 v[28:31], v1 offset:20480
ds_read_b128 v[32:35], v1 offset:40960
ds_read_b128 v[36:39], v238 offset:0
s_waitcnt lgkmcnt(3)
v_mfma_f32_16x16x32_bf16 v[56:59], a[0:3], v[24:27], 0
ds_read_b128 v[40:43], v1 offset:1024
s_waitcnt lgkmcnt(3)
v_mfma_f32_16x16x32_bf16 v[60:63], a[0:3], v[28:31], 0
ds_read_b128 v[44:47], v1 offset:21504
s_waitcnt lgkmcnt(3)
v_mfma_f32_16x16x32_bf16 v[64:67], a[0:3], v[32:35], 0
ds_read_b128 v[48:51], v1 offset:41984
s_waitcnt lgkmcnt(3)
v_mfma_f32_16x16x32_bf16 v[68:71], a[0:3], v[36:39], 0
ds_read_b128 v[52:55], v238 offset:1024
v_mfma_f32_16x16x32_bf16 v[72:75], v[24:27], a[4:7], 0
s_mov_b32 m0, s70
s_nop 0
buffer_load_dwordx4 v1, s[4:7], s69 offen offset:2048 sc1 lds
v_mfma_f32_16x16x32_bf16 v[76:79], v[28:31], a[4:7], 0
buffer_load_dwordx4 a[80:83], v1, s[4:7], s40 offen offset:2048
v_mfma_f32_16x16x32_bf16 v[80:83], v[32:35], a[4:7], 0
buffer_load_dwordx4 a[84:87], v1, s[4:7], s41 offen offset:2048
v_mfma_f32_16x16x32_bf16 v[84:87], v[36:39], a[4:7], 0
s_waitcnt lgkmcnt(3)
v_mfma_f32_16x16x32_bf16 v[56:59], a[8:11], v[40:43], v[56:59]
ds_read_b128 v[24:27], v1 offset:2048
s_waitcnt lgkmcnt(3)
v_mfma_f32_16x16x32_bf16 v[60:63], a[8:11], v[44:47], v[60:63]
ds_read_b128 v[28:31], v1 offset:22528
s_waitcnt lgkmcnt(3)
v_mfma_f32_16x16x32_bf16 v[64:67], a[8:11], v[48:51], v[64:67]
ds_read_b128 v[32:35], v1 offset:43008
s_waitcnt lgkmcnt(3)
v_mfma_f32_16x16x32_bf16 v[68:71], a[8:11], v[52:55], v[68:71]
ds_read_b128 v[36:39], v238 offset:2048
v_mfma_f32_16x16x32_bf16 v[72:75], v[40:43], a[12:15], v[72:75]
s_mov_b32 m0, s70
s_nop 0
buffer_load_dwordx4 v1, s[4:7], s69 offen offset:3072 sc1 lds
v_mfma_f32_16x16x32_bf16 v[76:79], v[44:47], a[12:15], v[76:79]
buffer_load_dwordx4 a[88:91], v1, s[4:7], s40 offen offset:3072
v_mfma_f32_16x16x32_bf16 v[80:83], v[48:51], a[12:15], v[80:83]
buffer_load_dwordx4 a[92:95], v1, s[4:7], s41 offen offset:3072
v_mfma_f32_16x16x32_bf16 v[84:87], v[52:55], a[12:15], v[84:87]
s_waitcnt lgkmcnt(3)
v_mfma_f32_16x16x32_bf16 v[56:59], a[16:19], v[24:27], v[56:59]
ds_read_b128 v[40:43], v1 offset:3072
s_waitcnt lgkmcnt(3)
v_mfma_f32_16x16x32_bf16 v[60:63], a[16:19], v[28:31], v[60:63]
ds_read_b128 v[44:47], v1 offset:23552
s_waitcnt lgkmcnt(3)
v_mfma_f32_16x16x32_bf16 v[64:67], a[16:19], v[32:35], v[64:67]
ds_read_b128 v[48:51], v1 offset:44032
s_waitcnt lgkmcnt(3)
v_mfma_f32_16x16x32_bf16 v[68:71], a[16:19], v[36:39], v[68:71]
ds_read_b128 v[52:55], v238 offset:3072
v_mfma_f32_16x16x32_bf16 v[72:75], v[24:27], a[20:23], v[72:75]
s_add_u32 s69, s69, 4096
s_add_u32 s70, s70, 4096
s_mov_b32 m0, s70
s_nop 0
buffer_load_dwordx4 v1, s[4:7], s69 offen offset:0 sc1 lds
v_mfma_f32_16x16x32_bf16 v[76:79], v[28:31], a[20:23], v[76:79]
s_add_u32 s40, s40, 4096
buffer_load_dwordx4 a[96:99], v1, s[4:7], s40 offen
v_mfma_f32_16x16x32_bf16 v[80:83], v[32:35], a[20:23], v[80:83]
s_add_u32 s41, s41, 4096
buffer_load_dwordx4 a[100:103], v1, s[4:7], s41 offen
v_mfma_f32_16x16x32_bf16 v[84:87], v[36:39], a[20:23], v[84:87]
s_waitcnt lgkmcnt(3)
v_mfma_f32_16x16x32_bf16 v[56:59], a[24:27], v[40:43], v[56:59]
ds_read_b128 v[24:27], v1 offset:4096
s_waitcnt lgkmcnt(3)
v_mfma_f32_16x16x32_bf16 v[60:63], a[24:27], v[44:47], v[60:63]
ds_read_b128 v[28:31], v1 offset:24576
s_waitcnt lgkmcnt(3)
v_mfma_f32_16x16x32_bf16 v[64:67], a[24:27], v[48:51], v[64:67]
ds_read_b128 v[32:35], v1 offset:45056
s_waitcnt lgkmcnt(3)
v_mfma_f32_16x16x32_bf16 v[68:71], a[24:27], v[52:55], v[68:71]
ds_read_b128 v[36:39], v238 offset:4096
v_mfma_f32_16x16x32_bf16 v[72:75], v[40:43], a[28:31], v[72:75]
s_mov_b32 m0, s70
s_nop 0
buffer_load_dwordx4 v1, s[4:7], s69 offen offset:1024 sc1 lds
v_mfma_f32_16x16x32_bf16 v[76:79], v[44:47], a[28:31], v[76:79]
buffer_load_dwordx4 a[104:107], v1, s[4:7], s40 offen offset:1024
v_mfma_f32_16x16x32_bf16 v[80:83], v[48:51], a[28:31], v[80:83]
buffer_load_dwordx4 a[108:111], v1, s[4:7], s41 offen offset:1024
v_mfma_f32_16x16x32_bf16 v[84:87], v[52:55], a[28:31], v[84:87]
s_waitcnt vmcnt(14)
s_barrier
s_waitcnt lgkmcnt(3)
v_mfma_f32_16x16x32_bf16 v[56:59], a[32:35], v[24:27], v[56:59]
ds_read_b128 v[40:43], v1 offset:5120
s_waitcnt lgkmcnt(3)
v_mfma_f32_16x16x32_bf16 v[60:63], a[32:35], v[28:31], v[60:63]
ds_read_b128 v[44:47], v1 offset:25600
s_waitcnt lgkmcnt(3)
v_mfma_f32_16x16x32_bf16 v[64:67], a[32:35], v[32:35], v[64:67]
ds_read_b128 v[48:51], v1 offset:46080
s_waitcnt lgkmcnt(3)
v_mfma_f32_16x16x32_bf16 v[68:71], a[32:35], v[36:39], v[68:71]
ds_read_b128 v[52:55], v238 offset:5120
v_mfma_f32_16x16x32_bf16 v[72:75], v[24:27], a[36:39], v[72:75]
s_mov_b32 m0, s70
s_nop 0
buffer_load_dwordx4 v1, s[4:7], s69 offen offset:2048 sc1 lds
v_mfma_f32_16x16x32_bf16 v[76:79], v[28:31], a[36:39], v[76:79]
buffer_load_dwordx4 a[112:115], v1, s[4:7], s40 offen offset:2048
v_mfma_f32_16x16x32_bf16 v[80:83], v[32:35], a[36:39], v[80:83]
buffer_load_dwordx4 a[116:119], v1, s[4:7], s41 offen offset:2048
v_mfma_f32_16x16x32_bf16 v[84:87], v[36:39], a[36:39], v[84:87]
s_waitcnt lgkmcnt(3)
v_mfma_f32_16x16x32_bf16 v[56:59], a[40:43], v[40:43], v[56:59]
ds_read_b128 v[24:27], v1 offset:6144
s_waitcnt lgkmcnt(3)
v_mfma_f32_16x16x32_bf16 v[60:63], a[40:43], v[44:47], v[60:63]
ds_read_b128 v[28:31], v1 offset:26624
s_waitcnt lgkmcnt(3)
v_mfma_f32_16x16x32_bf16 v[64:67], a[40:43], v[48:51], v[64:67]
ds_read_b128 v[32:35], v1 offset:47104
s_waitcnt lgkmcnt(3)
v_mfma_f32_16x16x32_bf16 v[68:71], a[40:43], v[52:55], v[68:71]
ds_read_b128 v[36:39], v238 offset:6144
v_mfma_f32_16x16x32_bf16 v[72:75], v[40:43], a[44:47], v[72:75]
s_mov_b32 m0, s70
s_nop 0
buffer_load_dwordx4 v1, s[4:7], s69 offen offset:3072 sc1 lds
v_mfma_f32_16x16x32_bf16 v[76:79], v[44:47], a[44:47], v[76:79]
buffer_load_dwordx4 a[120:123], v1, s[4:7], s40 offen offset:3072
v_mfma_f32_16x16x32_bf16 v[80:83], v[48:51], a[44:47], v[80:83]
buffer_load_dwordx4 a[124:127], v1, s[4:7], s41 offen offset:3072
v_mfma_f32_16x16x32_bf16 v[84:87], v[52:55], a[44:47], v[84:87]
s_waitcnt lgkmcnt(3)
v_mfma_f32_16x16x32_bf16 v[56:59], a[48:51], v[24:27], v[56:59]
ds_read_b128 v[40:43], v1 offset:7168
s_waitcnt lgkmcnt(3)
v_mfma_f32_16x16x32_bf16 v[60:63], a[48:51], v[28:31], v[60:63]
ds_read_b128 v[44:47], v1 offset:27648
s_waitcnt lgkmcnt(3)
v_mfma_f32_16x16x32_bf16 v[64:67], a[48:51], v[32:35], v[64:67]
ds_read_b128 v[48:51], v1 offset:48128
s_waitcnt lgkmcnt(3)
v_mfma_f32_16x16x32_bf16 v[68:71], a[48:51], v[36:39], v[68:71]
ds_read_b128 v[52:55], v238 offset:7168
v_mfma_f32_16x16x32_bf16 v[72:75], v[24:27], a[52:55], v[72:75]
s_add_u32 s69, s69, 4096
s_add_u32 s70, s70, 4096
s_mov_b32 m0, s70
s_nop 0
buffer_load_dwordx4 v1, s[4:7], s69 offen offset:0 sc1 lds
v_mfma_f32_16x16x32_bf16 v[76:79], v[28:31], a[52:55], v[76:79]
s_add_u32 s40, s40, 4096
buffer_load_dwordx4 a[128:131], v1, s[4:7], s40 offen
v_mfma_f32_16x16x32_bf16 v[80:83], v[32:35], a[52:55], v[80:83]
s_add_u32 s41, s41, 4096
buffer_load_dwordx4 a[132:135], v1, s[4:7], s41 offen
v_mfma_f32_16x16x32_bf16 v[84:87], v[36:39], a[52:55], v[84:87]
s_waitcnt lgkmcnt(3)
v_mfma_f32_16x16x32_bf16 v[56:59], a[56:59], v[40:43], v[56:59]
ds_read_b128 v[24:27], v1 offset:8192
s_waitcnt lgkmcnt(3)
v_mfma_f32_16x16x32_bf16 v[60:63], a[56:59], v[44:47], v[60:63]
ds_read_b128 v[28:31], v1 offset:28672
s_waitcnt lgkmcnt(3)
v_mfma_f32_16x16x32_bf16 v[64:67], a[56:59], v[48:51], v[64:67]
ds_read_b128 v[32:35], v1 offset:49152
s_waitcnt lgkmcnt(3)
v_mfma_f32_16x16x32_bf16 v[68:71], a[56:59], v[52:55], v[68:71]
ds_read_b128 v[36:39], v238 offset:8192
v_mfma_f32_16x16x32_bf16 v[72:75], v[40:43], a[60:63], v[72:75]
s_mov_b32 m0, s70
s_nop 0
buffer_load_dwordx4 v1, s[4:7], s69 offen offset:1024 sc1 lds
v_mfma_f32_16x16x32_bf16 v[76:79], v[44:47], a[60:63], v[76:79]
buffer_load_dwordx4 a[136:139], v1, s[4:7], s40 offen offset:1024
v_mfma_f32_16x16x32_bf16 v[80:83], v[48:51], a[60:63], v[80:83]
buffer_load_dwordx4 a[140:143], v1, s[4:7], s41 offen offset:1024
v_mfma_f32_16x16x32_bf16 v[84:87], v[52:55], a[60:63], v[84:87]
s_waitcnt lgkmcnt(3)
v_mfma_f32_16x16x32_bf16 v[56:59], a[64:67], v[24:27], v[56:59]
ds_read_b128 v[40:43], v1 offset:9216
s_waitcnt lgkmcnt(3)
v_mfma_f32_16x16x32_bf16 v[60:63], a[64:67], v[28:31], v[60:63]
ds_read_b128 v[44:47], v1 offset:29696
s_waitcnt lgkmcnt(3)
v_mfma_f32_16x16x32_bf16 v[64:67], a[64:67], v[32:35], v[64:67]
ds_read_b128 v[48:51], v1 offset:50176
s_waitcnt lgkmcnt(3)
v_mfma_f32_16x16x32_bf16 v[68:71], a[64:67], v[36:39], v[68:71]
ds_read_b128 v[52:55], v238 offset:9216
v_mfma_f32_16x16x32_bf16 v[72:75], v[24:27], a[68:71], v[72:75]
s_mov_b32 m0, s70
s_nop 0
buffer_load_dwordx4 v1, s[4:7], s69 offen offset:2048 sc1 lds
v_mfma_f32_16x16x32_bf16 v[76:79], v[28:31], a[68:71], v[76:79]
buffer_load_dwordx4 a[144:147], v1, s[4:7], s40 offen offset:2048
v_mfma_f32_16x16x32_bf16 v[80:83], v[32:35], a[68:71], v[80:83]
buffer_load_dwordx4 a[148:151], v1, s[4:7], s41 offen offset:2048
v_mfma_f32_16x16x32_bf16 v[84:87], v[36:39], a[68:71], v[84:87]
s_waitcnt vmcnt(14)
s_barrier
s_waitcnt lgkmcnt(3)
v_mfma_f32_16x16x32_bf16 v[56:59], a[72:75], v[40:43], v[56:59]
ds_read_b128 v[24:27], v1 offset:10240
s_waitcnt lgkmcnt(3)
v_mfma_f32_16x16x32_bf16 v[60:63], a[72:75], v[44:47], v[60:63]
ds_read_b128 v[28:31], v1 offset:30720
s_waitcnt lgkmcnt(3)
v_mfma_f32_16x16x32_bf16 v[64:67], a[72:75], v[48:51], v[64:67]
ds_read_b128 v[32:35], v1 offset:51200
s_waitcnt lgkmcnt(3)
v_mfma_f32_16x16x32_bf16 v[68:71], a[72:75], v[52:55], v[68:71]
ds_read_b128 v[36:39], v238 offset:10240
v_mfma_f32_16x16x32_bf16 v[72:75], v[40:43], a[76:79], v[72:75]
s_mov_b32 m0, s70
s_nop 0
buffer_load_dwordx4 v1, s[4:7], s69 offen offset:3072 sc1 lds
v_mfma_f32_16x16x32_bf16 v[76:79], v[44:47], a[76:79], v[76:79]
buffer_load_dwordx4 a[152:155], v1, s[4:7], s40 offen offset:3072
v_mfma_f32_16x16x32_bf16 v[80:83], v[48:51], a[76:79], v[80:83]
buffer_load_dwordx4 a[156:159], v1, s[4:7], s41 offen offset:3072
v_mfma_f32_16x16x32_bf16 v[84:87], v[52:55], a[76:79], v[84:87]
s_waitcnt lgkmcnt(3)
v_mfma_f32_16x16x32_bf16 v[56:59], a[80:83], v[24:27], v[56:59]
ds_read_b128 v[40:43], v1 offset:11264
s_waitcnt lgkmcnt(3)
v_mfma_f32_16x16x32_bf16 v[60:63], a[80:83], v[28:31], v[60:63]
ds_read_b128 v[44:47], v1 offset:31744
s_waitcnt lgkmcnt(3)
v_mfma_f32_16x16x32_bf16 v[64:67], a[80:83], v[32:35], v[64:67]
ds_read_b128 v[48:51], v1 offset:52224
s_waitcnt lgkmcnt(3)
v_mfma_f32_16x16x32_bf16 v[68:71], a[80:83], v[36:39], v[68:71]
ds_read_b128 v[52:55], v238 offset:11264
v_mfma_f32_16x16x32_bf16 v[72:75], v[24:27], a[84:87], v[72:75]
v_mfma_f32_16x16x32_bf16 v[76:79], v[28:31], a[84:87], v[76:79]
buffer_load_dwordx4 a[160:163], v1, s[4:7], s42 offen
v_mfma_f32_16x16x32_bf16 v[80:83], v[32:35], a[84:87], v[80:83]
buffer_load_dwordx4 a[164:167], v1, s[4:7], s42 offen offset:1024
v_mfma_f32_16x16x32_bf16 v[84:87], v[36:39], a[84:87], v[84:87]
s_waitcnt lgkmcnt(3)
v_mfma_f32_16x16x32_bf16 v[56:59], a[88:91], v[40:43], v[56:59]
ds_read_b128 v[24:27], v1 offset:12288
s_waitcnt lgkmcnt(3)
v_mfma_f32_16x16x32_bf16 v[60:63], a[88:91], v[44:47], v[60:63]
ds_read_b128 v[28:31], v1 offset:32768
s_waitcnt lgkmcnt(3)
v_mfma_f32_16x16x32_bf16 v[64:67], a[88:91], v[48:51], v[64:67]
ds_read_b128 v[32:35], v1 offset:53248
s_waitcnt lgkmcnt(3)
v_mfma_f32_16x16x32_bf16 v[68:71], a[88:91], v[52:55], v[68:71]
ds_read_b128 v[36:39], v238 offset:12288
v_mfma_f32_16x16x32_bf16 v[72:75], v[40:43], a[92:95], v[72:75]
v_mfma_f32_16x16x32_bf16 v[76:79], v[44:47], a[92:95], v[76:79]
buffer_load_dwordx4 a[168:171], v1, s[4:7], s42 offen offset:2048
v_mfma_f32_16x16x32_bf16 v[80:83], v[48:51], a[92:95], v[80:83]
buffer_load_dwordx4 a[172:175], v1, s[4:7], s42 offen offset:3072
v_mfma_f32_16x16x32_bf16 v[84:87], v[52:55], a[92:95], v[84:87]
s_waitcnt lgkmcnt(3)
v_mfma_f32_16x16x32_bf16 v[56:59], a[96:99], v[24:27], v[56:59]
ds_read_b128 v[40:43], v1 offset:13312
s_waitcnt lgkmcnt(3)
v_mfma_f32_16x16x32_bf16 v[60:63], a[96:99], v[28:31], v[60:63]
ds_read_b128 v[44:47], v1 offset:33792
s_waitcnt lgkmcnt(3)
v_mfma_f32_16x16x32_bf16 v[64:67], a[96:99], v[32:35], v[64:67]
ds_read_b128 v[48:51], v1 offset:54272
s_waitcnt lgkmcnt(3)
v_mfma_f32_16x16x32_bf16 v[68:71], a[96:99], v[36:39], v[68:71]
ds_read_b128 v[52:55], v238 offset:13312
v_mfma_f32_16x16x32_bf16 v[72:75], v[24:27], a[100:103], v[72:75]
v_mfma_f32_16x16x32_bf16 v[76:79], v[28:31], a[100:103], v[76:79]
s_add_u32 s42, s42, 4096
buffer_load_dwordx4 a[176:179], v1, s[4:7], s42 offen
v_mfma_f32_16x16x32_bf16 v[80:83], v[32:35], a[100:103], v[80:83]
buffer_load_dwordx4 a[180:183], v1, s[4:7], s42 offen offset:1024
v_mfma_f32_16x16x32_bf16 v[84:87], v[36:39], a[100:103], v[84:87]
s_waitcnt lgkmcnt(3)
v_mfma_f32_16x16x32_bf16 v[56:59], a[104:107], v[40:43], v[56:59]
ds_read_b128 v[24:27], v1 offset:14336
s_waitcnt lgkmcnt(3)
v_mfma_f32_16x16x32_bf16 v[60:63], a[104:107], v[44:47], v[60:63]
ds_read_b128 v[28:31], v1 offset:34816
s_waitcnt lgkmcnt(3)
v_mfma_f32_16x16x32_bf16 v[64:67], a[104:107], v[48:51], v[64:67]
ds_read_b128 v[32:35], v1 offset:55296
s_waitcnt lgkmcnt(3)
v_mfma_f32_16x16x32_bf16 v[68:71], a[104:107], v[52:55], v[68:71]
ds_read_b128 v[36:39], v238 offset:14336
v_mfma_f32_16x16x32_bf16 v[72:75], v[40:43], a[108:111], v[72:75]
v_mfma_f32_16x16x32_bf16 v[76:79], v[44:47], a[108:111], v[76:79]
buffer_load_dwordx4 a[184:187], v1, s[4:7], s42 offen offset:2048
v_mfma_f32_16x16x32_bf16 v[80:83], v[48:51], a[108:111], v[80:83]
buffer_load_dwordx4 a[188:191], v1, s[4:7], s42 offen offset:3072
v_mfma_f32_16x16x32_bf16 v[84:87], v[52:55], a[108:111], v[84:87]
s_waitcnt vmcnt(10)
s_barrier
s_waitcnt lgkmcnt(3)
v_mfma_f32_16x16x32_bf16 v[56:59], a[112:115], v[24:27], v[56:59]
ds_read_b128 v[40:43], v1 offset:15360
s_waitcnt lgkmcnt(3)
v_mfma_f32_16x16x32_bf16 v[60:63], a[112:115], v[28:31], v[60:63]
ds_read_b128 v[44:47], v1 offset:35840
s_waitcnt lgkmcnt(3)
v_mfma_f32_16x16x32_bf16 v[64:67], a[112:115], v[32:35], v[64:67]
ds_read_b128 v[48:51], v1 offset:56320
s_waitcnt lgkmcnt(3)
v_mfma_f32_16x16x32_bf16 v[68:71], a[112:115], v[36:39], v[68:71]
ds_read_b128 v[52:55], v238 offset:15360
v_mfma_f32_16x16x32_bf16 v[72:75], v[24:27], a[116:119], v[72:75]
v_mfma_f32_16x16x32_bf16 v[76:79], v[28:31], a[116:119], v[76:79]
s_add_u32 s42, s42, 4096
buffer_load_dwordx4 a[192:195], v1, s[4:7], s42 offen
v_mfma_f32_16x16x32_bf16 v[80:83], v[32:35], a[116:119], v[80:83]
buffer_load_dwordx4 a[196:199], v1, s[4:7], s42 offen offset:1024
v_mfma_f32_16x16x32_bf16 v[84:87], v[36:39], a[116:119], v[84:87]
s_waitcnt lgkmcnt(3)
v_mfma_f32_16x16x32_bf16 v[56:59], a[120:123], v[40:43], v[56:59]
ds_read_b64 v[24:25], v2 offset:16384
ds_read_b64 v[26:27], v2 offset:16896
s_waitcnt lgkmcnt(4)
v_mfma_f32_16x16x32_bf16 v[60:63], a[120:123], v[44:47], v[60:63]
ds_read_b64 v[28:29], v2 offset:36864
ds_read_b64 v[30:31], v2 offset:37376
s_waitcnt lgkmcnt(5)
v_mfma_f32_16x16x32_bf16 v[64:67], a[120:123], v[48:51], v[64:67]
ds_read_b64 v[32:33], v2 offset:57344
ds_read_b64 v[34:35], v2 offset:57856
s_waitcnt lgkmcnt(6)
v_mfma_f32_16x16x32_bf16 v[68:71], a[120:123], v[52:55], v[68:71]
ds_read_b64 v[36:37], v239 offset:16384
ds_read_b64 v[38:39], v239 offset:16896
v_mfma_f32_16x16x32_bf16 v[72:75], v[40:43], a[124:127], v[72:75]
v_mfma_f32_16x16x32_bf16 v[76:79], v[44:47], a[124:127], v[76:79]
buffer_load_dwordx4 a[200:203], v1, s[4:7], s42 offen offset:2048
v_mfma_f32_16x16x32_bf16 v[80:83], v[48:51], a[124:127], v[80:83]
buffer_load_dwordx4 a[204:207], v1, s[4:7], s42 offen offset:3072
v_mfma_f32_16x16x32_bf16 v[84:87], v[52:55], a[124:127], v[84:87]
s_waitcnt lgkmcnt(6)
v_mfma_f32_16x16x32_bf16 v[56:59], a[128:131], v[24:27], v[56:59]
ds_read_b64 v[40:41], v2 offset:17408
ds_read_b64 v[42:43], v2 offset:17920
s_waitcnt lgkmcnt(6)
v_mfma_f32_16x16x32_bf16 v[60:63], a[128:131], v[28:31], v[60:63]
ds_read_b64 v[44:45], v2 offset:37888
ds_read_b64 v[46:47], v2 offset:38400
s_waitcnt lgkmcnt(6)
v_mfma_f32_16x16x32_bf16 v[64:67], a[128:131], v[32:35], v[64:67]
ds_read_b64 v[48:49], v2 offset:58368
ds_read_b64 v[50:51], v2 offset:58880
s_waitcnt lgkmcnt(6)
v_mfma_f32_16x16x32_bf16 v[68:71], a[128:131], v[36:39], v[68:71]
ds_read_b64 v[52:53], v239 offset:17408
ds_read_b64 v[54:55], v239 offset:17920
v_mfma_f32_16x16x32_bf16 v[72:75], v[24:27], a[132:135], v[72:75]
v_mfma_f32_16x16x32_bf16 v[76:79], v[28:31], a[132:135], v[76:79]
s_add_u32 s42, s42, 4096
buffer_load_dwordx4 a[208:211], v1, s[4:7], s42 offen
v_mfma_f32_16x16x32_bf16 v[80:83], v[32:35], a[132:135], v[80:83]
buffer_load_dwordx4 a[212:215], v1, s[4:7], s42 offen offset:1024
v_mfma_f32_16x16x32_bf16 v[84:87], v[36:39], a[132:135], v[84:87]
s_waitcnt lgkmcnt(6)
v_mfma_f32_16x16x32_bf16 v[56:59], a[136:139], v[40:43], v[56:59]
ds_read_b64 v[24:25], v2 offset:18432
ds_read_b64 v[26:27], v2 offset:18944
s_waitcnt lgkmcnt(6)
v_mfma_f32_16x16x32_bf16 v[60:63], a[136:139], v[44:47], v[60:63]
ds_read_b64 v[28:29], v2 offset:38912
ds_read_b64 v[30:31], v2 offset:39424
s_waitcnt lgkmcnt(6)
v_mfma_f32_16x16x32_bf16 v[64:67], a[136:139], v[48:51], v[64:67]
ds_read_b64 v[32:33], v2 offset:59392
ds_read_b64 v[34:35], v2 offset:59904
s_waitcnt lgkmcnt(6)
v_mfma_f32_16x16x32_bf16 v[68:71], a[136:139], v[52:55], v[68:71]
ds_read_b64 v[36:37], v239 offset:18432
ds_read_b64 v[38:39], v239 offset:18944
v_mfma_f32_16x16x32_bf16 v[72:75], v[40:43], a[140:143], v[72:75]
v_mfma_f32_16x16x32_bf16 v[76:79], v[44:47], a[140:143], v[76:79]
buffer_load_dwordx4 a[216:219], v1, s[4:7], s42 offen offset:2048
v_mfma_f32_16x16x32_bf16 v[80:83], v[48:51], a[140:143], v[80:83]
buffer_load_dwordx4 a[220:223], v1, s[4:7], s42 offen offset:3072
v_mfma_f32_16x16x32_bf16 v[84:87], v[52:55], a[140:143], v[84:87]
s_waitcnt lgkmcnt(6)
v_mfma_f32_16x16x32_bf16 v[56:59], a[144:147], v[24:27], v[56:59]
ds_read_b64 v[40:41], v2 offset:19456
ds_read_b64 v[42:43], v2 offset:19968
s_waitcnt lgkmcnt(6)
v_mfma_f32_16x16x32_bf16 v[60:63], a[144:147], v[28:31], v[60:63]
ds_read_b64 v[44:45], v2 offset:39936
ds_read_b64 v[46:47], v2 offset:40448
s_waitcnt lgkmcnt(6)
v_mfma_f32_16x16x32_bf16 v[64:67], a[144:147], v[32:35], v[64:67]
ds_read_b64 v[48:49], v2 offset:60416
ds_read_b64 v[50:51], v2 offset:60928
s_waitcnt lgkmcnt(6)
v_mfma_f32_16x16x32_bf16 v[68:71], a[144:147], v[36:39], v[68:71]
ds_read_b64 v[52:53], v239 offset:19456
ds_read_b64 v[54:55], v239 offset:19968
v_mfma_f32_16x16x32_bf16 v[72:75], v[24:27], a[148:151], v[72:75]
v_mfma_f32_16x16x32_bf16 v[76:79], v[28:31], a[148:151], v[76:79]
s_add_u32 s42, s42, 4096
buffer_load_dwordx4 a[224:227], v1, s[4:7], s42 offen
v_mfma_f32_16x16x32_bf16 v[80:83], v[32:35], a[148:151], v[80:83]
buffer_load_dwordx4 a[228:231], v1, s[4:7], s42 offen offset:1024
v_mfma_f32_16x16x32_bf16 v[84:87], v[36:39], a[148:151], v[84:87]
s_waitcnt vmcnt(19)
s_waitcnt lgkmcnt(6)
v_mfma_f32_16x16x32_bf16 v[56:59], a[152:155], v[40:43], v[56:59]
s_waitcnt lgkmcnt(4)
v_mfma_f32_16x16x32_bf16 v[60:63], a[152:155], v[44:47], v[60:63]
buffer_load_dwordx4 a[232:235], v1, s[4:7], s42 offen offset:2048
s_waitcnt lgkmcnt(2)
v_mfma_f32_16x16x32_bf16 v[64:67], a[152:155], v[48:51], v[64:67]
buffer_load_dwordx4 a[236:239], v1, s[4:7], s42 offen offset:3072
s_waitcnt lgkmcnt(0)
v_mfma_f32_16x16x32_bf16 v[68:71], a[152:155], v[52:55], v[68:71]
s_waitcnt vmcnt(20)
v_mfma_f32_16x16x32_bf16 v[72:75], v[40:43], a[156:159], v[72:75]
v_mfma_f32_16x16x32_bf16 v[76:79], v[44:47], a[156:159], v[76:79]
v_mfma_f32_16x16x32_bf16 v[80:83], v[48:51], a[156:159], v[80:83]
v_mfma_f32_16x16x32_bf16 v[84:87], v[52:55], a[156:159], v[84:87]
v_lshlrev_b32 v3, 2, v241
v_add_u32 v3, 102400, v3
ds_read_b32 v136, v3 offset:0
ds_read_b32 v140, v3 offset:256
ds_read_b32 v137, v3 offset:64
ds_read_b32 v141, v3 offset:320
ds_read_b32 v138, v3 offset:128
ds_read_b32 v142, v3 offset:384
ds_read_b32 v139, v3 offset:192
ds_read_b32 v143, v3 offset:448
v_lshlrev_b32 v3, 4, v240
v_add_u32 v3, 102400, v3
ds_read_b128 v[144:147], v3 offset:0
ds_read_b128 v[160:163], v3 offset:256
ds_read_b128 v[148:151], v3 offset:64
ds_read_b128 v[164:167], v3 offset:320
ds_read_b128 v[152:155], v3 offset:128
ds_read_b128 v[168:171], v3 offset:384
ds_read_b128 v[156:159], v3 offset:192
ds_read_b128 v[172:175], v3 offset:448
s_waitcnt lgkmcnt(0)
s_lshl_b32 s24, s60, 14
s_add_u32 s24, s24, 13492224
s_lshl_b32 s25, s22, 12
s_add_u32 s25, s25, s24
s_mul_i32 s26, s60, 10240
s_add_u32 s26, s26, 21880832
s_lshl_b32 s27, s22, 11
s_add_u32 s27, s27, s26
s_add_u32 s26, s26, 8192
v_pk_fma_f32 v[72:73], v[144:145], v[188:189], v[72:73] op_sel:[0,0,0] op_sel_hi:[1,0,1]
v_pk_fma_f32 v[74:75], v[146:147], v[188:189], v[74:75] op_sel:[0,0,0] op_sel_hi:[1,0,1]
v_pk_mul_f32 v[72:73], v[72:73], v[160:161]
v_pk_mul_f32 v[74:75], v[74:75], v[162:163]
v_cvt_pk_bf16_f32 v48, v72, v73
v_cvt_pk_bf16_f32 v49, v74, v75
v_pk_fma_f32 v[76:77], v[148:149], v[188:189], v[76:77] op_sel:[0,0,0] op_sel_hi:[1,0,1]
v_pk_fma_f32 v[78:79], v[150:151], v[188:189], v[78:79] op_sel:[0,0,0] op_sel_hi:[1,0,1]
v_pk_mul_f32 v[76:77], v[76:77], v[164:165]
v_pk_mul_f32 v[78:79], v[78:79], v[166:167]
v_cvt_pk_bf16_f32 v50, v76, v77
v_cvt_pk_bf16_f32 v51, v78, v79
buffer_store_dwordx4 v[48:51], v1, s[4:7], s27 offen offset:0 sc1
v_pk_fma_f32 v[80:81], v[152:153], v[188:189], v[80:81] op_sel:[0,0,0] op_sel_hi:[1,0,1]
v_pk_fma_f32 v[82:83], v[154:155], v[188:189], v[82:83] op_sel:[0,0,0] op_sel_hi:[1,0,1]
v_pk_mul_f32 v[80:81], v[80:81], v[168:169]
v_pk_mul_f32 v[82:83], v[82:83], v[170:171]
v_cvt_pk_bf16_f32 v52, v80, v81
v_cvt_pk_bf16_f32 v53, v82, v83
v_pk_fma_f32 v[84:85], v[156:157], v[188:189], v[84:85] op_sel:[0,0,0] op_sel_hi:[1,0,1]
v_pk_fma_f32 v[86:87], v[158:159], v[188:189], v[86:87] op_sel:[0,0,0] op_sel_hi:[1,0,1]
v_pk_mul_f32 v[84:85], v[84:85], v[172:173]
v_pk_mul_f32 v[86:87], v[86:87], v[174:175]
v_cvt_pk_bf16_f32 v54, v84, v85
v_cvt_pk_bf16_f32 v55, v86, v87
buffer_store_dwordx4 v[52:55], v1, s[4:7], s27 offen offset:1024 sc1
v_pk_fma_f32 v[56:57], v[176:177], v[136:137], v[56:57] op_sel:[0,0,0] op_sel_hi:[1,0,1]
v_pk_fma_f32 v[58:59], v[178:179], v[136:137], v[58:59] op_sel:[0,0,0] op_sel_hi:[1,0,1]
v_pk_mul_f32 v[56:57], v[56:57], v[140:141] op_sel:[0,0] op_sel_hi:[1,0]
v_pk_mul_f32 v[58:59], v[58:59], v[140:141] op_sel:[0,0] op_sel_hi:[1,0]
v_cvt_pk_bf16_f32 v24, v56, v57
v_cvt_pk_bf16_f32 v25, v58, v59
v_pk_fma_f32 v[60:61], v[176:177], v[136:137], v[60:61] op_sel:[0,1,0] op_sel_hi:[1,1,1]
v_pk_fma_f32 v[62:63], v[178:179], v[136:137], v[62:63] op_sel:[0,1,0] op_sel_hi:[1,1,1]
v_pk_mul_f32 v[60:61], v[60:61], v[140:141] op_sel:[0,1] op_sel_hi:[1,1]
v_pk_mul_f32 v[62:63], v[62:63], v[140:141] op_sel:[0,1] op_sel_hi:[1,1]
v_cvt_pk_bf16_f32 v28, v60, v61
v_cvt_pk_bf16_f32 v29, v62, v63
v_pk_fma_f32 v[64:65], v[176:177], v[138:139], v[64:65] op_sel:[0,0,0] op_sel_hi:[1,0,1]
v_pk_fma_f32 v[66:67], v[178:179], v[138:139], v[66:67] op_sel:[0,0,0] op_sel_hi:[1,0,1]
v_pk_mul_f32 v[64:65], v[64:65], v[142:143] op_sel:[0,0] op_sel_hi:[1,0]
v_pk_mul_f32 v[66:67], v[66:67], v[142:143] op_sel:[0,0] op_sel_hi:[1,0]
v_cvt_pk_bf16_f32 v32, v64, v65
v_cvt_pk_bf16_f32 v33, v66, v67
v_pk_fma_f32 v[68:69], v[176:177], v[138:139], v[68:69] op_sel:[0,1,0] op_sel_hi:[1,1,1]
v_pk_fma_f32 v[70:71], v[178:179], v[138:139], v[70:71] op_sel:[0,1,0] op_sel_hi:[1,1,1]
v_pk_mul_f32 v[68:69], v[68:69], v[142:143] op_sel:[0,1] op_sel_hi:[1,1]
v_pk_mul_f32 v[70:71], v[70:71], v[142:143] op_sel:[0,1] op_sel_hi:[1,1]
v_cvt_pk_bf16_f32 v36, v68, v69
v_cvt_pk_bf16_f32 v37, v70, v71
s_waitcnt lgkmcnt(0)
s_barrier
ds_read_b64 v[26:27], v239 offset:44032
ds_read_b64 v[30:31], v239 offset:44544
ds_read_b64 v[34:35], v239 offset:45056
ds_read_b64 v[38:39], v239 offset:45568
ds_read_b64 v[202:203], v239 offset:41984
ds_read_b64 v[206:207], v239 offset:42496
ds_read_b64 v[210:211], v239 offset:43008
ds_read_b64 v[214:215], v239 offset:43520
s_waitcnt lgkmcnt(7)
buffer_store_dwordx4 v[24:27], v1, s[4:7], s25 offen offset:0 sc1
s_waitcnt lgkmcnt(6)
buffer_store_dwordx4 v[28:31], v1, s[4:7], s25 offen offset:1024 sc1
s_waitcnt lgkmcnt(5)
buffer_store_dwordx4 v[32:35], v1, s[4:7], s25 offen offset:2048 sc1
s_waitcnt lgkmcnt(4)
buffer_store_dwordx4 v[36:39], v1, s[4:7], s25 offen offset:3072 sc1
s_waitcnt lgkmcnt(0)
v_cmp_eq_u32 vcc, s22, v240
s_nop 1
v_cndmask_b32 v202, 0, v202, vcc
v_cndmask_b32 v203, 0, v203, vcc
v_cndmask_b32 v206, 0, v206, vcc
v_cndmask_b32 v207, 0, v207, vcc
v_cndmask_b32 v210, 0, v210, vcc
v_cndmask_b32 v211, 0, v211, vcc
v_cndmask_b32 v214, 0, v214, vcc
v_cndmask_b32 v215, 0, v215, vcc
s_waitcnt vmcnt(0)
v_mov_b32 v3, 1
s_mov_b64 exec, 1
buffer_store_dword v3, off, s[4:7], s23 sc1
s_mov_b64 exec, -1
ds_read_b128 v[24:27], v1 offset:0
ds_read_b128 v[28:31], v1 offset:20480
ds_read_b128 v[32:35], v1 offset:40960
ds_read_b128 v[36:39], v238 offset:0
s_waitcnt lgkmcnt(3)
v_mfma_f32_16x16x32_bf16 v[104:107], a[160:163], v[24:27], 0
ds_read_b128 v[40:43], v1 offset:1024
ds_read_b128 v[44:47], v1 offset:21504
s_waitcnt lgkmcnt(4)
v_mfma_f32_16x16x32_bf16 v[108:111], a[160:163], v[28:31], 0
ds_read_b128 v[48:51], v1 offset:41984
ds_read_b128 v[52:55], v238 offset:1024
s_waitcnt lgkmcnt(5)
v_mfma_f32_16x16x32_bf16 v[112:115], a[160:163], v[32:35], 0
s_waitcnt lgkmcnt(4)
v_mfma_f32_16x16x32_bf16 v[116:119], a[160:163], v[36:39], 0
s_waitcnt lgkmcnt(3)
v_mfma_f32_16x16x32_bf16 v[104:107], a[164:167], v[40:43], v[104:107]
ds_read_b128 v[24:27], v1 offset:2048
ds_read_b128 v[28:31], v1 offset:22528
s_waitcnt lgkmcnt(4)
v_mfma_f32_16x16x32_bf16 v[108:111], a[164:167], v[44:47], v[108:111]
ds_read_b128 v[32:35], v1 offset:43008
ds_read_b128 v[36:39], v238 offset:2048
s_waitcnt lgkmcnt(5)
v_mfma_f32_16x16x32_bf16 v[112:115], a[164:167], v[48:51], v[112:115]
s_waitcnt lgkmcnt(4)
v_mfma_f32_16x16x32_bf16 v[116:119], a[164:167], v[52:55], v[116:119]
s_waitcnt lgkmcnt(3)
v_mfma_f32_16x16x32_bf16 v[104:107], a[168:171], v[24:27], v[104:107]
ds_read_b128 v[40:43], v1 offset:3072
ds_read_b128 v[44:47], v1 offset:23552
s_waitcnt lgkmcnt(4)
v_mfma_f32_16x16x32_bf16 v[108:111], a[168:171], v[28:31], v[108:111]
ds_read_b128 v[48:51], v1 offset:44032
ds_read_b128 v[52:55], v238 offset:3072
s_waitcnt lgkmcnt(5)
v_mfma_f32_16x16x32_bf16 v[112:115], a[168:171], v[32:35], v[112:115]
s_waitcnt lgkmcnt(4)
v_mfma_f32_16x16x32_bf16 v[116:119], a[168:171], v[36:39], v[116:119]
s_waitcnt lgkmcnt(3)
v_mfma_f32_16x16x32_bf16 v[104:107], a[172:175], v[40:43], v[104:107]
ds_read_b128 v[24:27], v1 offset:4096
ds_read_b128 v[28:31], v1 offset:24576
s_waitcnt lgkmcnt(4)
v_mfma_f32_16x16x32_bf16 v[108:111], a[172:175], v[44:47], v[108:111]
ds_read_b128 v[32:35], v1 offset:45056
ds_read_b128 v[36:39], v238 offset:4096
s_waitcnt lgkmcnt(5)
v_mfma_f32_16x16x32_bf16 v[112:115], a[172:175], v[48:51], v[112:115]
s_waitcnt lgkmcnt(4)
v_mfma_f32_16x16x32_bf16 v[116:119], a[172:175], v[52:55], v[116:119]
s_waitcnt lgkmcnt(3)
v_mfma_f32_16x16x32_bf16 v[104:107], a[176:179], v[24:27], v[104:107]
ds_read_b128 v[40:43], v1 offset:5120
ds_read_b128 v[44:47], v1 offset:25600
s_waitcnt lgkmcnt(4)
v_mfma_f32_16x16x32_bf16 v[108:111], a[176:179], v[28:31], v[108:111]
ds_read_b128 v[48:51], v1 offset:46080
ds_read_b128 v[52:55], v238 offset:5120
s_waitcnt lgkmcnt(5)
v_mfma_f32_16x16x32_bf16 v[112:115], a[176:179], v[32:35], v[112:115]
s_waitcnt lgkmcnt(4)
v_mfma_f32_16x16x32_bf16 v[116:119], a[176:179], v[36:39], v[116:119]
s_waitcnt lgkmcnt(3)
v_mfma_f32_16x16x32_bf16 v[104:107], a[180:183], v[40:43], v[104:107]
ds_read_b128 v[24:27], v1 offset:6144
ds_read_b128 v[28:31], v1 offset:26624
s_waitcnt lgkmcnt(4)
v_mfma_f32_16x16x32_bf16 v[108:111], a[180:183], v[44:47], v[108:111]
ds_read_b128 v[32:35], v1 offset:47104
ds_read_b128 v[36:39], v238 offset:6144
s_waitcnt lgkmcnt(5)
v_mfma_f32_16x16x32_bf16 v[112:115], a[180:183], v[48:51], v[112:115]
s_waitcnt lgkmcnt(4)
v_mfma_f32_16x16x32_bf16 v[116:119], a[180:183], v[52:55], v[116:119]
s_waitcnt lgkmcnt(3)
v_mfma_f32_16x16x32_bf16 v[104:107], a[184:187], v[24:27], v[104:107]
ds_read_b128 v[40:43], v1 offset:7168
ds_read_b128 v[44:47], v1 offset:27648
s_waitcnt lgkmcnt(4)
v_mfma_f32_16x16x32_bf16 v[108:111], a[184:187], v[28:31], v[108:111]
ds_read_b128 v[48:51], v1 offset:48128
ds_read_b128 v[52:55], v238 offset:7168
s_waitcnt lgkmcnt(5)
v_mfma_f32_16x16x32_bf16 v[112:115], a[184:187], v[32:35], v[112:115]
s_waitcnt lgkmcnt(4)
v_mfma_f32_16x16x32_bf16 v[116:119], a[184:187], v[36:39], v[116:119]
s_waitcnt lgkmcnt(3)
v_mfma_f32_16x16x32_bf16 v[104:107], a[188:191], v[40:43], v[104:107]
ds_read_b128 v[24:27], v1 offset:8192
ds_read_b128 v[28:31], v1 offset:28672
s_waitcnt lgkmcnt(4)
v_mfma_f32_16x16x32_bf16 v[108:111], a[188:191], v[44:47], v[108:111]
ds_read_b128 v[32:35], v1 offset:49152
ds_read_b128 v[36:39], v238 offset:8192
s_waitcnt lgkmcnt(5)
v_mfma_f32_16x16x32_bf16 v[112:115], a[188:191], v[48:51], v[112:115]
s_waitcnt lgkmcnt(4)
v_mfma_f32_16x16x32_bf16 v[116:119], a[188:191], v[52:55], v[116:119]
s_waitcnt lgkmcnt(3)
v_mfma_f32_16x16x32_bf16 v[104:107], a[192:195], v[24:27], v[104:107]
ds_read_b128 v[40:43], v1 offset:9216
ds_read_b128 v[44:47], v1 offset:29696
s_waitcnt lgkmcnt(4)
v_mfma_f32_16x16x32_bf16 v[108:111], a[192:195], v[28:31], v[108:111]
ds_read_b128 v[48:51], v1 offset:50176
ds_read_b128 v[52:55], v238 offset:9216
s_waitcnt lgkmcnt(5)
v_mfma_f32_16x16x32_bf16 v[112:115], a[192:195], v[32:35], v[112:115]
s_waitcnt lgkmcnt(4)
v_mfma_f32_16x16x32_bf16 v[116:119], a[192:195], v[36:39], v[116:119]
s_waitcnt lgkmcnt(3)
v_mfma_f32_16x16x32_bf16 v[104:107], a[196:199], v[40:43], v[104:107]
ds_read_b128 v[24:27], v1 offset:10240
ds_read_b128 v[28:31], v1 offset:30720
s_waitcnt lgkmcnt(4)
v_mfma_f32_16x16x32_bf16 v[108:111], a[196:199], v[44:47], v[108:111]
ds_read_b128 v[32:35], v1 offset:51200
ds_read_b128 v[36:39], v238 offset:10240
s_waitcnt lgkmcnt(5)
v_mfma_f32_16x16x32_bf16 v[112:115], a[196:199], v[48:51], v[112:115]
s_waitcnt lgkmcnt(4)
v_mfma_f32_16x16x32_bf16 v[116:119], a[196:199], v[52:55], v[116:119]
s_waitcnt lgkmcnt(3)
v_mfma_f32_16x16x32_bf16 v[104:107], a[200:203], v[24:27], v[104:107]
ds_read_b128 v[40:43], v1 offset:11264
ds_read_b128 v[44:47], v1 offset:31744
s_waitcnt lgkmcnt(4)
v_mfma_f32_16x16x32_bf16 v[108:111], a[200:203], v[28:31], v[108:111]
ds_read_b128 v[48:51], v1 offset:52224
ds_read_b128 v[52:55], v238 offset:11264
s_waitcnt lgkmcnt(5)
v_mfma_f32_16x16x32_bf16 v[112:115], a[200:203], v[32:35], v[112:115]
s_waitcnt lgkmcnt(4)
v_mfma_f32_16x16x32_bf16 v[116:119], a[200:203], v[36:39], v[116:119]
s_waitcnt lgkmcnt(3)
v_mfma_f32_16x16x32_bf16 v[104:107], a[204:207], v[40:43], v[104:107]
ds_read_b128 v[24:27], v1 offset:12288
ds_read_b128 v[28:31], v1 offset:32768
s_waitcnt lgkmcnt(4)
v_mfma_f32_16x16x32_bf16 v[108:111], a[204:207], v[44:47], v[108:111]
ds_read_b128 v[32:35], v1 offset:53248
ds_read_b128 v[36:39], v238 offset:12288
s_waitcnt lgkmcnt(5)
v_mfma_f32_16x16x32_bf16 v[112:115], a[204:207], v[48:51], v[112:115]
s_waitcnt lgkmcnt(4)
v_mfma_f32_16x16x32_bf16 v[116:119], a[204:207], v[52:55], v[116:119]
s_waitcnt lgkmcnt(3)
v_mfma_f32_16x16x32_bf16 v[104:107], a[208:211], v[24:27], v[104:107]
ds_read_b128 v[40:43], v1 offset:13312
ds_read_b128 v[44:47], v1 offset:33792
s_waitcnt lgkmcnt(4)
v_mfma_f32_16x16x32_bf16 v[108:111], a[208:211], v[28:31], v[108:111]
ds_read_b128 v[48:51], v1 offset:54272
ds_read_b128 v[52:55], v238 offset:13312
s_waitcnt lgkmcnt(5)
v_mfma_f32_16x16x32_bf16 v[112:115], a[208:211], v[32:35], v[112:115]
s_waitcnt lgkmcnt(4)
v_mfma_f32_16x16x32_bf16 v[116:119], a[208:211], v[36:39], v[116:119]
s_waitcnt lgkmcnt(3)
v_mfma_f32_16x16x32_bf16 v[104:107], a[212:215], v[40:43], v[104:107]
ds_read_b128 v[24:27], v1 offset:14336
ds_read_b128 v[28:31], v1 offset:34816
s_waitcnt lgkmcnt(4)
v_mfma_f32_16x16x32_bf16 v[108:111], a[212:215], v[44:47], v[108:111]
ds_read_b128 v[32:35], v1 offset:55296
ds_read_b128 v[36:39], v238 offset:14336
s_waitcnt lgkmcnt(5)
v_mfma_f32_16x16x32_bf16 v[112:115], a[212:215], v[48:51], v[112:115]
s_waitcnt lgkmcnt(4)
v_mfma_f32_16x16x32_bf16 v[116:119], a[212:215], v[52:55], v[116:119]
s_waitcnt lgkmcnt(3)
v_mfma_f32_16x16x32_bf16 v[104:107], a[216:219], v[24:27], v[104:107]
ds_read_b128 v[40:43], v1 offset:15360
ds_read_b128 v[44:47], v1 offset:35840
s_waitcnt lgkmcnt(4)
v_mfma_f32_16x16x32_bf16 v[108:111], a[216:219], v[28:31], v[108:111]
ds_read_b128 v[48:51], v1 offset:56320
ds_read_b128 v[52:55], v238 offset:15360
s_waitcnt lgkmcnt(5)
v_mfma_f32_16x16x32_bf16 v[112:115], a[216:219], v[32:35], v[112:115]
s_waitcnt lgkmcnt(4)
v_mfma_f32_16x16x32_bf16 v[116:119], a[216:219], v[36:39], v[116:119]
s_waitcnt lgkmcnt(3)
v_mfma_f32_16x16x32_bf16 v[104:107], a[220:223], v[40:43], v[104:107]
ds_read_b64 v[24:25], v2 offset:16384
ds_read_b64 v[26:27], v2 offset:16896
ds_read_b64 v[28:29], v2 offset:36864
ds_read_b64 v[30:31], v2 offset:37376
s_waitcnt lgkmcnt(6)
v_mfma_f32_16x16x32_bf16 v[108:111], a[220:223], v[44:47], v[108:111]
ds_read_b64 v[32:33], v2 offset:57344
ds_read_b64 v[34:35], v2 offset:57856
ds_read_b64 v[36:37], v239 offset:16384
ds_read_b64 v[38:39], v239 offset:16896
s_waitcnt lgkmcnt(9)
v_mfma_f32_16x16x32_bf16 v[112:115], a[220:223], v[48:51], v[112:115]
s_waitcnt lgkmcnt(8)
v_mfma_f32_16x16x32_bf16 v[116:119], a[220:223], v[52:55], v[116:119]
s_waitcnt lgkmcnt(6)
v_mfma_f32_16x16x32_bf16 v[104:107], a[224:227], v[24:27], v[104:107]
ds_read_b64 v[40:41], v2 offset:17408
ds_read_b64 v[42:43], v2 offset:17920
ds_read_b64 v[44:45], v2 offset:37888
ds_read_b64 v[46:47], v2 offset:38400
s_waitcnt lgkmcnt(8)
v_mfma_f32_16x16x32_bf16 v[108:111], a[224:227], v[28:31], v[108:111]
ds_read_b64 v[48:49], v2 offset:58368
ds_read_b64 v[50:51], v2 offset:58880
ds_read_b64 v[52:53], v239 offset:17408
ds_read_b64 v[54:55], v239 offset:17920
s_waitcnt lgkmcnt(10)
v_mfma_f32_16x16x32_bf16 v[112:115], a[224:227], v[32:35], v[112:115]
s_waitcnt lgkmcnt(8)
v_mfma_f32_16x16x32_bf16 v[116:119], a[224:227], v[36:39], v[116:119]
s_waitcnt lgkmcnt(6)
v_mfma_f32_16x16x32_bf16 v[104:107], a[228:231], v[40:43], v[104:107]
ds_read_b64 v[24:25], v2 offset:18432
ds_read_b64 v[26:27], v2 offset:18944
ds_read_b64 v[28:29], v2 offset:38912
ds_read_b64 v[30:31], v2 offset:39424
s_waitcnt lgkmcnt(8)
v_mfma_f32_16x16x32_bf16 v[108:111], a[228:231], v[44:47], v[108:111]
ds_read_b64 v[32:33], v2 offset:59392
ds_read_b64 v[34:35], v2 offset:59904
ds_read_b64 v[36:37], v239 offset:18432
ds_read_b64 v[38:39], v239 offset:18944
s_waitcnt lgkmcnt(10)
v_mfma_f32_16x16x32_bf16 v[112:115], a[228:231], v[48:51], v[112:115]
s_waitcnt lgkmcnt(8)
v_mfma_f32_16x16x32_bf16 v[116:119], a[228:231], v[52:55], v[116:119]
s_waitcnt lgkmcnt(6)
v_mfma_f32_16x16x32_bf16 v[104:107], a[232:235], v[24:27], v[104:107]
ds_read_b64 v[40:41], v2 offset:19456
ds_read_b64 v[42:43], v2 offset:19968
ds_read_b64 v[44:45], v2 offset:39936
ds_read_b64 v[46:47], v2 offset:40448
s_waitcnt lgkmcnt(8)
v_mfma_f32_16x16x32_bf16 v[108:111], a[232:235], v[28:31], v[108:111]
ds_read_b64 v[48:49], v2 offset:60416
ds_read_b64 v[50:51], v2 offset:60928
ds_read_b64 v[52:53], v239 offset:19456
ds_read_b64 v[54:55], v239 offset:19968
s_waitcnt lgkmcnt(10)
v_mfma_f32_16x16x32_bf16 v[112:115], a[232:235], v[32:35], v[112:115]
s_waitcnt lgkmcnt(8)
v_mfma_f32_16x16x32_bf16 v[116:119], a[232:235], v[36:39], v[116:119]
s_waitcnt lgkmcnt(6)
v_mfma_f32_16x16x32_bf16 v[104:107], a[236:239], v[40:43], v[104:107]
s_waitcnt lgkmcnt(4)
v_mfma_f32_16x16x32_bf16 v[108:111], a[236:239], v[44:47], v[108:111]
s_waitcnt lgkmcnt(2)
v_mfma_f32_16x16x32_bf16 v[112:115], a[236:239], v[48:51], v[112:115]
s_waitcnt lgkmcnt(0)
v_mfma_f32_16x16x32_bf16 v[116:119], a[236:239], v[52:55], v[116:119]
s_mov_b32 s24, 0x3ea52b5c
v_mul_f32 v140, s24, v140
v_mul_f32 v141, s24, v141
v_mul_f32 v142, s24, v142
v_mul_f32 v143, s24, v143
v_pk_fma_f32 v[104:105], v[180:181], v[136:137], v[104:105] op_sel:[0,0,0] op_sel_hi:[1,0,1]
v_pk_fma_f32 v[106:107], v[182:183], v[136:137], v[106:107] op_sel:[0,0,0] op_sel_hi:[1,0,1]
v_pk_mul_f32 v[104:105], v[104:105], v[140:141] op_sel:[0,0] op_sel_hi:[1,0]
v_pk_mul_f32 v[106:107], v[106:107], v[140:141] op_sel:[0,0] op_sel_hi:[1,0]
v_cvt_pk_bf16_f32 v200, v104, v105
v_cvt_pk_bf16_f32 v201, v106, v107
v_pk_fma_f32 v[108:109], v[180:181], v[136:137], v[108:109] op_sel:[0,1,0] op_sel_hi:[1,1,1]
v_pk_fma_f32 v[110:111], v[182:183], v[136:137], v[110:111] op_sel:[0,1,0] op_sel_hi:[1,1,1]
v_pk_mul_f32 v[108:109], v[108:109], v[140:141] op_sel:[0,1] op_sel_hi:[1,1]
v_pk_mul_f32 v[110:111], v[110:111], v[140:141] op_sel:[0,1] op_sel_hi:[1,1]
v_cvt_pk_bf16_f32 v204, v108, v109
v_cvt_pk_bf16_f32 v205, v110, v111
v_pk_fma_f32 v[112:113], v[180:181], v[138:139], v[112:113] op_sel:[0,0,0] op_sel_hi:[1,0,1]
v_pk_fma_f32 v[114:115], v[182:183], v[138:139], v[114:115] op_sel:[0,0,0] op_sel_hi:[1,0,1]
v_pk_mul_f32 v[112:113], v[112:113], v[142:143] op_sel:[0,0] op_sel_hi:[1,0]
v_pk_mul_f32 v[114:115], v[114:115], v[142:143] op_sel:[0,0] op_sel_hi:[1,0]
v_cvt_pk_bf16_f32 v208, v112, v113
v_cvt_pk_bf16_f32 v209, v114, v115
v_pk_fma_f32 v[116:117], v[180:181], v[138:139], v[116:117] op_sel:[0,1,0] op_sel_hi:[1,1,1]
v_pk_fma_f32 v[118:119], v[182:183], v[138:139], v[118:119] op_sel:[0,1,0] op_sel_hi:[1,1,1]
v_pk_mul_f32 v[116:117], v[116:117], v[142:143] op_sel:[0,1] op_sel_hi:[1,1]
v_pk_mul_f32 v[118:119], v[118:119], v[142:143] op_sel:[0,1] op_sel_hi:[1,1]
v_cvt_pk_bf16_f32 v212, v116, v117
v_cvt_pk_bf16_f32 v213, v118, v119
s_nop 7
s_branch FE2
FE2:
s_mov_b32 s25, 0xf149f2ca
v_lshlrev_b32 v3, 2, v240
v_mov_b32 v216, s25
s_cmp_lt_u32 s20, 4
s_cselect_b32 s24, s25, 0
v_mov_b32 v184, s24
v_mov_b32 v185, s24
v_mov_b32 v186, s24
v_mov_b32 v187, s24
s_cmp_lt_u32 s20, 3
s_cselect_b32 s24, s25, 0
v_mov_b32 v188, s24
v_mov_b32 v189, s24
v_mov_b32 v190, s24
v_mov_b32 v191, s24
s_cmp_lt_u32 s20, 2
s_cselect_b32 s24, s25, 0
v_mov_b32 v192, s24
v_mov_b32 v193, s24
v_mov_b32 v194, s24
v_mov_b32 v195, s24
s_cmp_lt_u32 s20, 1
s_cselect_b32 s24, s25, 0
v_mov_b32 v196, s24
v_mov_b32 v197, s24
v_mov_b32 v198, s24
v_mov_b32 v199, s24
v_add_u32 v217, 0, v3
v_cmp_gt_u32 vcc, v217, v241
s_nop 1
v_cndmask_b32 v176, 0, v216, vcc
v_cndmask_b32 v180, v216, v184, vcc
v_add_u32 v217, 1, v3
v_cmp_gt_u32 vcc, v217, v241
s_nop 1
v_cndmask_b32 v177, 0, v216, vcc
v_cndmask_b32 v181, v216, v185, vcc
v_add_u32 v217, 2, v3
v_cmp_gt_u32 vcc, v217, v241
s_nop 1
v_cndmask_b32 v178, 0, v216, vcc
v_cndmask_b32 v182, v216, v186, vcc
v_add_u32 v217, 3, v3
v_cmp_gt_u32 vcc, v217, v241
s_nop 1
v_cndmask_b32 v179, 0, v216, vcc
v_cndmask_b32 v183, v216, v187, vcc
v_mov_b32 v136, 0x3f803f80
v_mov_b32 v137, 0x3f803f80
v_mov_b32 v138, 0x3f803f80
v_mov_b32 v139, 0x3f803f80
v_mov_b32 v140, 0x3f803f80
v_mov_b32 v141, 0x3f803f80
v_mov_b32 v142, 0x3f803f80
v_mov_b32 v143, 0x3f803f80
v_mov_b32 v144, 0x3f803f80
v_mov_b32 v145, 0x3f803f80
v_mov_b32 v146, 0x3f803f80
v_mov_b32 v147, 0x3f803f80
v_mov_b32 v148, 0x3f803f80
v_mov_b32 v149, 0x3f803f80
v_mov_b32 v150, 0x3f803f80
v_mov_b32 v151, 0x3f803f80
v_mov_b32 v152, 0x3f803f80
v_mov_b32 v153, 0x3f803f80
v_mov_b32 v154, 0x3f803f80
v_mov_b32 v155, 0x3f803f80
v_mov_b32 v156, 0x3f803f80
v_mov_b32 v157, 0x3f803f80
v_mov_b32 v158, 0x3f803f80
v_mov_b32 v159, 0x3f803f80
v_mov_b32 v160, 0x3f803f80
v_mov_b32 v161, 0x3f803f80
v_mov_b32 v162, 0x3f803f80
v_mov_b32 v163, 0x3f803f80
v_mov_b32 v164, 0x3f803f80
v_mov_b32 v165, 0x3f803f80
v_mov_b32 v166, 0x3f803f80
v_mov_b32 v167, 0x3f803f80
v_mov_b32 v168, 0x3f803f80
v_mov_b32 v169, 0x3f803f80
v_mov_b32 v170, 0x3f803f80
v_mov_b32 v171, 0x3f803f80
v_mov_b32 v172, 0x3f803f80
v_mov_b32 v173, 0x3f803f80
v_mov_b32 v174, 0x3f803f80
v_mov_b32 v175, 0x3f803f80
s_sub_u32 s24, s20, 4
s_cmp_lt_u32 s20, 4
s_cselect_b32 s24, s20, s24
s_lshl_b32 s24, s24, 3
s_add_u32 s24, s24, s21
s_lshl_b32 s25, s24, 14
s_lshl_b32 s26, s22, 12
s_add_u32 s25, s25, s26
s_add_u32 s45, s25, 13492224
s_mul_i32 s25, s24, 10240
s_add_u32 s50, s25, 21880832
s_sub_u32 s24, s20, 3
s_cmp_lt_u32 s20, 3
s_cselect_b32 s24, s20, s24
s_lshl_b32 s24, s24, 3
s_add_u32 s24, s24, s21
s_lshl_b32 s25, s24, 14
s_lshl_b32 s26, s22, 12
s_add_u32 s25, s25, s26
s_add_u32 s46, s25, 13492224
s_mul_i32 s25, s24, 10240
s_add_u32 s51, s25, 21880832
s_sub_u32 s24, s20, 2
s_cmp_lt_u32 s20, 2
s_cselect_b32 s24, s20, s24
s_lshl_b32 s24, s24, 3
s_add_u32 s24, s24, s21
s_lshl_b32 s25, s24, 14
s_lshl_b32 s26, s22, 12
s_add_u32 s25, s25, s26
s_add_u32 s47, s25, 13492224
s_mul_i32 s25, s24, 10240
s_add_u32 s52, s25, 21880832
s_sub_u32 s24, s20, 1
s_cmp_lt_u32 s20, 1
s_cselect_b32 s24, s20, s24
s_lshl_b32 s24, s24, 3
s_add_u32 s24, s24, s21
s_lshl_b32 s25, s24, 14
s_lshl_b32 s26, s22, 12
s_add_u32 s25, s25, s26
s_add_u32 s48, s25, 13492224
s_mul_i32 s25, s24, 10240
s_add_u32 s53, s25, 21880832
s_sub_u32 s24, s20, 0
s_cmp_lt_u32 s20, 0
s_cselect_b32 s24, s20, s24
s_lshl_b32 s24, s24, 3
s_add_u32 s24, s24, s21
s_lshl_b32 s25, s24, 14
s_lshl_b32 s26, s22, 12
s_add_u32 s25, s25, s26
s_add_u32 s49, s25, 13492224
s_mul_i32 s25, s24, 10240
s_add_u32 s54, s25, 21880832
s_lshl_b32 s55, s22, 11
v_add_u32 v218, s55, v1
v_add_u32 v219, 8192, v1
v_lshrrev_b32 v3, 2, v241
v_cmp_eq_u32 s[56:57], s22, v3
s_and_b32 s24, s22, 1
s_cmp_eq_u32 s24, 1
s_cselect_b64 s[58:59], -1, 0
s_lshr_b32 s24, s22, 1
s_lshl_b32 s24, s24, 10
s_and_b32 s25, s22, 1
s_lshl_b32 s25, s25, 3
s_add_u32 s24, s24, s25
v_add_u32 v229, s24, v238
s_lshl_b32 s25, s20, 5
s_add_u32 s25, s25, 7720960
v_and_b32 v217, 7, v0
v_lshlrev_b32 v217, 2, v217
v_add_u32 v217, s25, v217
s_mov_b32 s24, 30000
PL7:
buffer_load_dword v3, v237, s[4:7], 0 offen sc1
buffer_load_dword v216, v217, s[4:7], 0 offen sc1
s_waitcnt vmcnt(0)
v_cmp_eq_u32 vcc, 0, v216
s_nop 0
s_nop 0
v_cndmask_b32 v3, v3, v216, vcc
v_cmp_gt_u32 vcc, 1, v3
s_sub_u32 s24, s24, 1
s_cbranch_scc1 PD8
s_cbranch_vccnz PL7
PD8:
v_cmp_eq_u32 vcc, s73, v216
s_nop 4
s_cmp_eq_u64 vcc, -1
s_cselect_b32 s72, 1, 0
s_barrier
buffer_load_dwordx4 a[0:3], v1, s[4:7], s45 offen offset:0
buffer_load_dwordx4 a[4:7], v1, s[4:7], s45 offen offset:1024
buffer_load_dwordx4 a[8:11], v1, s[4:7], s45 offen offset:2048
buffer_load_dwordx4 a[12:15], v1, s[4:7], s45 offen offset:3072
buffer_load_dwordx4 a[16:19], v1, s[4:7], s46 offen offset:0
buffer_load_dwordx4 a[20:23], v1, s[4:7], s46 offen offset:1024
buffer_load_dwordx4 a[24:27], v1, s[4:7], s46 offen offset:2048
buffer_load_dwordx4 a[28:31], v1, s[4:7], s46 offen offset:3072
buffer_load_dwordx4 a[32:35], v1, s[4:7], s47 offen offset:0
buffer_load_dwordx4 a[36:39], v1, s[4:7], s47 offen offset:1024
buffer_load_dwordx4 a[40:43], v1, s[4:7], s47 offen offset:2048
buffer_load_dwordx4 a[44:47], v1, s[4:7], s47 offen offset:3072
buffer_load_dwordx4 a[48:51], v1, s[4:7], s48 offen offset:0
buffer_load_dwordx4 a[52:55], v1, s[4:7], s48 offen offset:1024
buffer_load_dwordx4 a[56:59], v1, s[4:7], s48 offen offset:2048
buffer_load_dwordx4 a[60:63], v1, s[4:7], s48 offen offset:3072
buffer_load_dwordx4 a[64:67], v1, s[4:7], s49 offen offset:0
s_lshl_b32 s44, s68, 2
s_add_u32 s44, s44, s22
s_mul_i32 s44, s44, 25600
s_add_u32 s44, s44, 2457600
s_mul_i32 s70, s22, 25600
s_mul_i32 s63, s21, 7
s_cmp_eq_u32 s21, 7
s_cselect_b32 s63, 48, s63
s_lshl_b32 s24, s22, 1
s_add_u32 s63, s63, s24
s_min_u32 s63, s63, 53
s_add_u32 s24, s63, 0
s_min_u32 s24, s24, 53
s_mul_i32 s24, s24, 40960
s_add_u32 s64, s24, 3276800
s_add_u32 s24, s63, 1
s_min_u32 s24, s24, 53
s_mul_i32 s24, s24, 40960
s_add_u32 s65, s24, 3276800
s_waitcnt vmcnt(16)
v_mfma_f32_16x16x32_bf16 v[24:27], a[0:3], v[200:203], v[180:183]
s_waitcnt vmcnt(15)
v_mfma_f32_16x16x32_bf16 v[28:31], a[4:7], v[200:203], v[184:187]
s_waitcnt vmcnt(14)
v_mfma_f32_16x16x32_bf16 v[32:35], a[8:11], v[200:203], v[184:187]
s_waitcnt vmcnt(13)
v_mfma_f32_16x16x32_bf16 v[36:39], a[12:15], v[200:203], v[184:187]
s_waitcnt vmcnt(12)
v_mfma_f32_16x16x32_bf16 v[40:43], a[16:19], v[200:203], v[188:191]
s_waitcnt vmcnt(11)
v_mfma_f32_16x16x32_bf16 v[44:47], a[20:23], v[200:203], v[188:191]
s_waitcnt vmcnt(10)
v_mfma_f32_16x16x32_bf16 v[48:51], a[24:27], v[200:203], v[188:191]
s_waitcnt vmcnt(9)
v_mfma_f32_16x16x32_bf16 v[52:55], a[28:31], v[200:203], v[188:191]
s_waitcnt vmcnt(8)
v_mfma_f32_16x16x32_bf16 v[56:59], a[32:35], v[200:203], v[192:195]
s_waitcnt vmcnt(7)
v_mfma_f32_16x16x32_bf16 v[60:63], a[36:39], v[200:203], v[192:195]
s_waitcnt vmcnt(6)
v_mfma_f32_16x16x32_bf16 v[64:67], a[40:43], v[200:203], v[192:195]
s_waitcnt vmcnt(5)
v_mfma_f32_16x16x32_bf16 v[68:71], a[44:47], v[200:203], v[192:195]
s_waitcnt vmcnt(4)
v_mfma_f32_16x16x32_bf16 v[72:75], a[48:51], v[200:203], v[196:199]
s_waitcnt vmcnt(3)
v_mfma_f32_16x16x32_bf16 v[76:79], a[52:55], v[200:203], v[196:199]
s_waitcnt vmcnt(2)
v_mfma_f32_16x16x32_bf16 v[80:83], a[56:59], v[200:203], v[196:199]
s_waitcnt vmcnt(1)
v_mfma_f32_16x16x32_bf16 v[84:87], a[60:63], v[200:203], v[196:199]
s_waitcnt vmcnt(0)
v_mfma_f32_16x16x32_bf16 v[88:91], a[64:67], v[200:203], v[176:179]
v_max3_f32 v226, v24, v25, v26
buffer_load_dwordx4 a[68:71], v218, s[4:7], s50 offen offset:0
v_max3_f32 v228, v27, v28, v29
v_max3_f32 v226, v226, v30, v31
v_max3_f32 v228, v228, v32, v33
v_max3_f32 v226, v226, v34, v35
v_max3_f32 v228, v228, v36, v37
buffer_load_dwordx4 a[72:75], v218, s[4:7], s50 offen offset:1024
v_max3_f32 v226, v226, v38, v39
v_max3_f32 v228, v228, v40, v41
v_max3_f32 v226, v226, v42, v43
v_max3_f32 v228, v228, v44, v45
v_max3_f32 v226, v226, v46, v47
buffer_load_dwordx4 a[76:79], v218, s[4:7], s51 offen offset:0
v_max3_f32 v228, v228, v48, v49
v_max3_f32 v226, v226, v50, v51
v_max3_f32 v228, v228, v52, v53
v_max3_f32 v226, v226, v54, v55
v_max3_f32 v228, v228, v56, v57
buffer_load_dwordx4 a[80:83], v218, s[4:7], s51 offen offset:1024
v_max3_f32 v226, v226, v58, v59
v_max3_f32 v228, v228, v60, v61
v_max3_f32 v226, v226, v62, v63
v_max3_f32 v228, v228, v64, v65
v_max3_f32 v226, v226, v66, v67
buffer_load_dwordx4 a[84:87], v218, s[4:7], s52 offen offset:0
v_max3_f32 v228, v228, v68, v69
v_max3_f32 v226, v226, v70, v71
v_max3_f32 v228, v228, v72, v73
v_max3_f32 v226, v226, v74, v75
v_max3_f32 v228, v228, v76, v77
s_mov_b64 exec, s[56:57]
buffer_load_dwordx4 v[136:139], v219, s[4:7], s50 offen offset:0
buffer_load_dwordx4 v[140:143], v219, s[4:7], s50 offen offset:1024
buffer_load_dwordx4 v[144:147], v219, s[4:7], s51 offen offset:0
buffer_load_dwordx4 v[148:151], v219, s[4:7], s51 offen offset:1024
buffer_load_dwordx4 v[152:155], v219, s[4:7], s52 offen offset:0
s_mov_b64 exec, -1
v_max3_f32 v226, v226, v78, v79
v_max3_f32 v228, v228, v80, v81
v_max3_f32 v226, v226, v82, v83
v_max3_f32 v228, v228, v84, v85
v_max3_f32 v226, v226, v86, v87
buffer_load_dwordx4 a[88:91], v218, s[4:7], s52 offen offset:1024
v_max3_f32 v228, v228, v88, v89
v_max3_f32 v226, v226, v90, v91
v_max_f32 v226, v226, v228
v_mov_b32 v227, v226
s_nop 1
v_permlane32_swap_b32 v226, v227
v_max_f32 v226, v226, v227
v_mov_b32 v227, v226
s_nop 1
v_permlane16_swap_b32 v226, v227
v_max_f32 v226, v226, v227
v_mov_b32 v227, v226
v_pk_add_f32 v[24:25], v[24:25], v[226:227] neg_lo:[0,1] neg_hi:[0,1]
v_pk_add_f32 v[26:27], v[26:27], v[226:227] neg_lo:[0,1] neg_hi:[0,1]
buffer_load_dwordx4 a[92:95], v218, s[4:7], s53 offen offset:0
v_pk_add_f32 v[28:29], v[28:29], v[226:227] neg_lo:[0,1] neg_hi:[0,1]
v_pk_add_f32 v[30:31], v[30:31], v[226:227] neg_lo:[0,1] neg_hi:[0,1]
v_pk_add_f32 v[32:33], v[32:33], v[226:227] neg_lo:[0,1] neg_hi:[0,1]
v_pk_add_f32 v[34:35], v[34:35], v[226:227] neg_lo:[0,1] neg_hi:[0,1]
v_pk_add_f32 v[36:37], v[36:37], v[226:227] neg_lo:[0,1] neg_hi:[0,1]
buffer_load_dwordx4 a[96:99], v218, s[4:7], s53 offen offset:1024
v_pk_add_f32 v[38:39], v[38:39], v[226:227] neg_lo:[0,1] neg_hi:[0,1]
v_pk_add_f32 v[40:41], v[40:41], v[226:227] neg_lo:[0,1] neg_hi:[0,1]
v_pk_add_f32 v[42:43], v[42:43], v[226:227] neg_lo:[0,1] neg_hi:[0,1]
v_pk_add_f32 v[44:45], v[44:45], v[226:227] neg_lo:[0,1] neg_hi:[0,1]
v_pk_add_f32 v[46:47], v[46:47], v[226:227] neg_lo:[0,1] neg_hi:[0,1]
buffer_load_dwordx4 a[100:103], v218, s[4:7], s54 offen offset:0
v_pk_add_f32 v[48:49], v[48:49], v[226:227] neg_lo:[0,1] neg_hi:[0,1]
v_pk_add_f32 v[50:51], v[50:51], v[226:227] neg_lo:[0,1] neg_hi:[0,1]
v_pk_add_f32 v[52:53], v[52:53], v[226:227] neg_lo:[0,1] neg_hi:[0,1]
v_pk_add_f32 v[54:55], v[54:55], v[226:227] neg_lo:[0,1] neg_hi:[0,1]
v_pk_add_f32 v[56:57], v[56:57], v[226:227] neg_lo:[0,1] neg_hi:[0,1]
s_mov_b64 exec, s[56:57]
buffer_load_dwordx4 v[156:159], v219, s[4:7], s52 offen offset:1024
buffer_load_dwordx4 v[160:163], v219, s[4:7], s53 offen offset:0
buffer_load_dwordx4 v[164:167], v219, s[4:7], s53 offen offset:1024
buffer_load_dwordx4 v[168:171], v219, s[4:7], s54 offen offset:0
buffer_load_dwordx4 v[172:175], v219, s[4:7], s54 offen offset:1024
s_mov_b64 exec, -1
v_pk_add_f32 v[58:59], v[58:59], v[226:227] neg_lo:[0,1] neg_hi:[0,1]
v_pk_add_f32 v[60:61], v[60:61], v[226:227] neg_lo:[0,1] neg_hi:[0,1]
v_pk_add_f32 v[62:63], v[62:63], v[226:227] neg_lo:[0,1] neg_hi:[0,1]
v_pk_add_f32 v[64:65], v[64:65], v[226:227] neg_lo:[0,1] neg_hi:[0,1]
v_pk_add_f32 v[66:67], v[66:67], v[226:227] neg_lo:[0,1] neg_hi:[0,1]
buffer_load_dwordx4 a[104:107], v1, s[4:7], s49 offen offset:1024
v_pk_add_f32 v[68:69], v[68:69], v[226:227] neg_lo:[0,1] neg_hi:[0,1]
v_pk_add_f32 v[70:71], v[70:71], v[226:227] neg_lo:[0,1] neg_hi:[0,1]
v_pk_add_f32 v[72:73], v[72:73], v[226:227] neg_lo:[0,1] neg_hi:[0,1]
v_pk_add_f32 v[74:75], v[74:75], v[226:227] neg_lo:[0,1] neg_hi:[0,1]
v_pk_add_f32 v[76:77], v[76:77], v[226:227] neg_lo:[0,1] neg_hi:[0,1]
buffer_load_dwordx4 a[108:111], v1, s[4:7], s49 offen offset:2048
v_pk_add_f32 v[78:79], v[78:79], v[226:227] neg_lo:[0,1] neg_hi:[0,1]
v_pk_add_f32 v[80:81], v[80:81], v[226:227] neg_lo:[0,1] neg_hi:[0,1]
v_pk_add_f32 v[82:83], v[82:83], v[226:227] neg_lo:[0,1] neg_hi:[0,1]
v_pk_add_f32 v[84:85], v[84:85], v[226:227] neg_lo:[0,1] neg_hi:[0,1]
v_pk_add_f32 v[86:87], v[86:87], v[226:227] neg_lo:[0,1] neg_hi:[0,1]
buffer_load_dwordx4 a[112:115], v1, s[4:7], s49 offen offset:3072
v_pk_add_f32 v[88:89], v[88:89], v[226:227] neg_lo:[0,1] neg_hi:[0,1]
v_pk_add_f32 v[90:91], v[90:91], v[226:227] neg_lo:[0,1] neg_hi:[0,1]
v_mov_b32 v126, 0
v_mov_b32 v127, 0
v_exp_f32 v24, v24
v_exp_f32 v25, v25
v_exp_f32 v26, v26
v_exp_f32 v27, v27
v_cvt_pk_bf16_f32 v92, v24, v25
v_cvt_pk_bf16_f32 v93, v26, v27
buffer_load_dwordx4 a[116:119], v218, s[4:7], s54 offen offset:1024
v_exp_f32 v28, v28
v_exp_f32 v29, v29
v_exp_f32 v30, v30
v_exp_f32 v31, v31
v_mfma_f32_16x16x32_bf16 v[24:27], a[4:7], v[204:207], v[180:183]
v_cvt_pk_bf16_f32 v94, v28, v29
v_cvt_pk_bf16_f32 v95, v30, v31
s_mov_b32 m0, s70
s_nop 0
buffer_load_dwordx4 v1, s[4:7], s44 offen offset:0 lds
v_exp_f32 v32, v32
v_exp_f32 v33, v33
v_exp_f32 v34, v34
v_exp_f32 v35, v35
v_mfma_f32_16x16x32_bf16 v[28:31], a[8:11], v[204:207], v[184:187]
v_cvt_pk_bf16_f32 v96, v32, v33
v_cvt_pk_bf16_f32 v97, v34, v35
s_mov_b32 m0, s70
s_nop 0
buffer_load_dwordx4 v1, s[4:7], s44 offen offset:1024 lds
v_exp_f32 v36, v36
v_exp_f32 v37, v37
v_exp_f32 v38, v38
v_exp_f32 v39, v39
v_mfma_f32_16x16x32_bf16 v[32:35], a[12:15], v[204:207], v[184:187]
v_cvt_pk_bf16_f32 v98, v36, v37
v_cvt_pk_bf16_f32 v99, v38, v39
s_mov_b32 m0, s70
s_nop 0
buffer_load_dwordx4 v1, s[4:7], s44 offen offset:2048 lds
v_exp_f32 v40, v40
v_exp_f32 v41, v41
v_exp_f32 v42, v42
v_exp_f32 v43, v43
v_mfma_f32_16x16x32_bf16 v[36:39], a[16:19], v[204:207], v[188:191]
v_cvt_pk_bf16_f32 v100, v40, v41
v_cvt_pk_bf16_f32 v101, v42, v43
s_mov_b32 m0, s70
s_nop 0
buffer_load_dwordx4 v1, s[4:7], s44 offen offset:3072 lds
v_exp_f32 v44, v44
v_exp_f32 v45, v45
v_exp_f32 v46, v46
v_exp_f32 v47, v47
v_mfma_f32_16x16x32_bf16 v[40:43], a[20:23], v[204:207], v[188:191]
v_cvt_pk_bf16_f32 v102, v44, v45
v_cvt_pk_bf16_f32 v103, v46, v47
s_add_u32 s44, s44, 4096
s_add_u32 s70, s70, 4096
s_mov_b32 m0, s70
s_nop 0
buffer_load_dwordx4 v1, s[4:7], s44 offen offset:0 lds
v_exp_f32 v48, v48
v_exp_f32 v49, v49
v_exp_f32 v50, v50
v_exp_f32 v51, v51
v_mfma_f32_16x16x32_bf16 v[44:47], a[24:27], v[204:207], v[188:191]
v_cvt_pk_bf16_f32 v104, v48, v49
v_cvt_pk_bf16_f32 v105, v50, v51
s_mov_b32 m0, s70
s_nop 0
buffer_load_dwordx4 v1, s[4:7], s44 offen offset:1024 lds
v_exp_f32 v52, v52
v_exp_f32 v53, v53
v_exp_f32 v54, v54
v_exp_f32 v55, v55
v_mfma_f32_16x16x32_bf16 v[48:51], a[28:31], v[204:207], v[188:191]
v_cvt_pk_bf16_f32 v106, v52, v53
v_cvt_pk_bf16_f32 v107, v54, v55
s_mov_b32 m0, s70
s_nop 0
buffer_load_dwordx4 v1, s[4:7], s44 offen offset:2048 lds
v_exp_f32 v56, v56
v_exp_f32 v57, v57
v_exp_f32 v58, v58
v_exp_f32 v59, v59
v_mfma_f32_16x16x32_bf16 v[52:55], a[32:35], v[204:207], v[192:195]
v_cvt_pk_bf16_f32 v108, v56, v57
v_cvt_pk_bf16_f32 v109, v58, v59
s_mov_b32 m0, s70
s_nop 0
buffer_load_dwordx4 v1, s[4:7], s44 offen offset:3072 lds
v_exp_f32 v60, v60
v_exp_f32 v61, v61
v_exp_f32 v62, v62
v_exp_f32 v63, v63
v_mfma_f32_16x16x32_bf16 v[56:59], a[36:39], v[204:207], v[192:195]
v_cvt_pk_bf16_f32 v110, v60, v61
v_cvt_pk_bf16_f32 v111, v62, v63
s_add_u32 s44, s44, 4096
s_add_u32 s70, s70, 4096
s_mov_b32 m0, s70
s_nop 0
buffer_load_dwordx4 v1, s[4:7], s44 offen offset:0 lds
v_exp_f32 v64, v64
v_exp_f32 v65, v65
v_exp_f32 v66, v66
v_exp_f32 v67, v67
v_mfma_f32_16x16x32_bf16 v[60:63], a[40:43], v[204:207], v[192:195]
v_cvt_pk_bf16_f32 v112, v64, v65
v_cvt_pk_bf16_f32 v113, v66, v67
s_mov_b32 m0, s70
s_nop 0
buffer_load_dwordx4 v1, s[4:7], s44 offen offset:1024 lds
v_exp_f32 v68, v68
v_exp_f32 v69, v69
v_exp_f32 v70, v70
v_exp_f32 v71, v71
v_mfma_f32_16x16x32_bf16 v[64:67], a[44:47], v[204:207], v[192:195]
v_cvt_pk_bf16_f32 v114, v68, v69
v_cvt_pk_bf16_f32 v115, v70, v71
s_mov_b32 m0, s70
s_nop 0
buffer_load_dwordx4 v1, s[4:7], s44 offen offset:2048 lds
v_exp_f32 v72, v72
v_exp_f32 v73, v73
v_exp_f32 v74, v74
v_exp_f32 v75, v75
v_mfma_f32_16x16x32_bf16 v[68:71], a[48:51], v[204:207], v[196:199]
v_cvt_pk_bf16_f32 v116, v72, v73
v_cvt_pk_bf16_f32 v117, v74, v75
s_mov_b32 m0, s70
s_nop 0
buffer_load_dwordx4 v1, s[4:7], s44 offen offset:3072 lds
v_exp_f32 v76, v76
v_exp_f32 v77, v77
v_exp_f32 v78, v78
v_exp_f32 v79, v79
v_mfma_f32_16x16x32_bf16 v[72:75], a[52:55], v[204:207], v[196:199]
v_cvt_pk_bf16_f32 v118, v76, v77
v_cvt_pk_bf16_f32 v119, v78, v79
s_add_u32 s44, s44, 4096
s_add_u32 s70, s70, 4096
s_mov_b32 m0, s70
s_nop 0
buffer_load_dwordx4 v1, s[4:7], s44 offen offset:0 lds
v_exp_f32 v80, v80
v_exp_f32 v81, v81
v_exp_f32 v82, v82
v_exp_f32 v83, v83
v_mfma_f32_16x16x32_bf16 v[76:79], a[56:59], v[204:207], v[196:199]
v_cvt_pk_bf16_f32 v120, v80, v81
v_cvt_pk_bf16_f32 v121, v82, v83
s_mov_b32 m0, s70
s_nop 0
buffer_load_dwordx4 v1, s[4:7], s44 offen offset:1024 lds
v_exp_f32 v84, v84
v_exp_f32 v85, v85
v_exp_f32 v86, v86
v_exp_f32 v87, v87
v_mfma_f32_16x16x32_bf16 v[80:83], a[60:63], v[204:207], v[196:199]
v_cvt_pk_bf16_f32 v122, v84, v85
v_cvt_pk_bf16_f32 v123, v86, v87
s_mov_b32 m0, s70
s_nop 0
buffer_load_dwordx4 v1, s[4:7], s44 offen offset:2048 lds
v_exp_f32 v88, v88
v_exp_f32 v89, v89
v_exp_f32 v90, v90
v_exp_f32 v91, v91
v_mfma_f32_16x16x32_bf16 v[84:87], a[64:67], v[204:207], 0
v_cvt_pk_bf16_f32 v124, v88, v89
v_cvt_pk_bf16_f32 v125, v90, v91
s_mov_b32 m0, s70
s_nop 0
buffer_load_dwordx4 v1, s[4:7], s44 offen offset:3072 lds
s_waitcnt vmcnt(19)
v_mfma_f32_16x16x32_bf16 v[88:91], a[104:107], v[204:207], v[176:179]
buffer_load_dwordx4 a[120:123], v1, s[4:7], s64 offen
buffer_load_dwordx4 a[124:127], v1, s[4:7], s64 offen offset:1024
buffer_load_dwordx4 a[128:131], v1, s[4:7], s64 offen offset:2048
v_mfma_f32_16x16x32_bf16 v[128:131], a[68:71], v[92:95], 0
v_max3_f32 v226, v24, v25, v26
v_max3_f32 v228, v27, v28, v29
v_max3_f32 v226, v226, v30, v31
v_mfma_f32_16x16x32_bf16 v[132:135], v[136:139], v[92:95], 0
v_max3_f32 v228, v228, v32, v33
v_max3_f32 v226, v226, v34, v35
v_max3_f32 v228, v228, v36, v37
v_mfma_f32_16x16x32_bf16 v[128:131], a[72:75], v[96:99], v[128:131]
v_max3_f32 v226, v226, v38, v39
v_max3_f32 v228, v228, v40, v41
v_max3_f32 v226, v226, v42, v43
v_mfma_f32_16x16x32_bf16 v[132:135], v[140:143], v[96:99], v[132:135]
v_max3_f32 v228, v228, v44, v45
v_max3_f32 v226, v226, v46, v47
v_max3_f32 v228, v228, v48, v49
v_mfma_f32_16x16x32_bf16 v[128:131], a[76:79], v[100:103], v[128:131]
v_max3_f32 v226, v226, v50, v51
v_max3_f32 v228, v228, v52, v53
v_max3_f32 v226, v226, v54, v55
v_mfma_f32_16x16x32_bf16 v[132:135], v[144:147], v[100:103], v[132:135]
v_max3_f32 v228, v228, v56, v57
v_max3_f32 v226, v226, v58, v59
v_max3_f32 v228, v228, v60, v61
v_mfma_f32_16x16x32_bf16 v[128:131], a[80:83], v[104:107], v[128:131]
v_max3_f32 v226, v226, v62, v63
v_max3_f32 v228, v228, v64, v65
v_max3_f32 v226, v226, v66, v67
v_mfma_f32_16x16x32_bf16 v[132:135], v[148:151], v[104:107], v[132:135]
v_max3_f32 v228, v228, v68, v69
v_max3_f32 v226, v226, v70, v71
v_max3_f32 v228, v228, v72, v73
v_mfma_f32_16x16x32_bf16 v[128:131], a[84:87], v[108:111], v[128:131]
v_max3_f32 v226, v226, v74, v75
v_max3_f32 v228, v228, v76, v77
v_max3_f32 v226, v226, v78, v79
v_mfma_f32_16x16x32_bf16 v[132:135], v[152:155], v[108:111], v[132:135]
v_max3_f32 v228, v228, v80, v81
v_max3_f32 v226, v226, v82, v83
v_max3_f32 v228, v228, v84, v85
v_mfma_f32_16x16x32_bf16 v[128:131], a[88:91], v[112:115], v[128:131]
v_max3_f32 v226, v226, v86, v87
v_max3_f32 v228, v228, v88, v89
v_max3_f32 v226, v226, v90, v91
v_mfma_f32_16x16x32_bf16 v[132:135], v[156:159], v[112:115], v[132:135]
v_max_f32 v226, v226, v228
v_mov_b32 v227, v226
s_nop 1
v_permlane32_swap_b32 v226, v227
v_max_f32 v226, v226, v227
v_mov_b32 v227, v226
s_nop 1
v_permlane16_swap_b32 v226, v227
v_max_f32 v226, v226, v227
v_mov_b32 v227, v226
v_pk_add_f32 v[24:25], v[24:25], v[226:227] neg_lo:[0,1] neg_hi:[0,1]
v_pk_add_f32 v[26:27], v[26:27], v[226:227] neg_lo:[0,1] neg_hi:[0,1]
v_mfma_f32_16x16x32_bf16 v[128:131], a[92:95], v[116:119], v[128:131]
v_pk_add_f32 v[28:29], v[28:29], v[226:227] neg_lo:[0,1] neg_hi:[0,1]
v_pk_add_f32 v[30:31], v[30:31], v[226:227] neg_lo:[0,1] neg_hi:[0,1]
v_pk_add_f32 v[32:33], v[32:33], v[226:227] neg_lo:[0,1] neg_hi:[0,1]
v_mfma_f32_16x16x32_bf16 v[132:135], v[160:163], v[116:119], v[132:135]
v_pk_add_f32 v[34:35], v[34:35], v[226:227] neg_lo:[0,1] neg_hi:[0,1]
v_pk_add_f32 v[36:37], v[36:37], v[226:227] neg_lo:[0,1] neg_hi:[0,1]
v_pk_add_f32 v[38:39], v[38:39], v[226:227] neg_lo:[0,1] neg_hi:[0,1]
v_mfma_f32_16x16x32_bf16 v[128:131], a[96:99], v[120:123], v[128:131]
v_pk_add_f32 v[40:41], v[40:41], v[226:227] neg_lo:[0,1] neg_hi:[0,1]
v_pk_add_f32 v[42:43], v[42:43], v[226:227] neg_lo:[0,1] neg_hi:[0,1]
v_pk_add_f32 v[44:45], v[44:45], v[226:227] neg_lo:[0,1] neg_hi:[0,1]
v_mfma_f32_16x16x32_bf16 v[132:135], v[164:167], v[120:123], v[132:135]
v_pk_add_f32 v[46:47], v[46:47], v[226:227] neg_lo:[0,1] neg_hi:[0,1]
v_pk_add_f32 v[48:49], v[48:49], v[226:227] neg_lo:[0,1] neg_hi:[0,1]
v_pk_add_f32 v[50:51], v[50:51], v[226:227] neg_lo:[0,1] neg_hi:[0,1]
v_mfma_f32_16x16x32_bf16 v[128:131], a[100:103], v[124:127], v[128:131]
v_pk_add_f32 v[52:53], v[52:53], v[226:227] neg_lo:[0,1] neg_hi:[0,1]
v_pk_add_f32 v[54:55], v[54:55], v[226:227] neg_lo:[0,1] neg_hi:[0,1]
v_pk_add_f32 v[56:57], v[56:57], v[226:227] neg_lo:[0,1] neg_hi:[0,1]
v_mfma_f32_16x16x32_bf16 v[132:135], v[168:171], v[124:127], v[132:135]
v_pk_add_f32 v[58:59], v[58:59], v[226:227] neg_lo:[0,1] neg_hi:[0,1]
v_pk_add_f32 v[60:61], v[60:61], v[226:227] neg_lo:[0,1] neg_hi:[0,1]
v_pk_add_f32 v[62:63], v[62:63], v[226:227] neg_lo:[0,1] neg_hi:[0,1]
v_pk_add_f32 v[64:65], v[64:65], v[226:227] neg_lo:[0,1] neg_hi:[0,1]
v_pk_add_f32 v[66:67], v[66:67], v[226:227] neg_lo:[0,1] neg_hi:[0,1]
v_pk_add_f32 v[68:69], v[68:69], v[226:227] neg_lo:[0,1] neg_hi:[0,1]
v_pk_add_f32 v[70:71], v[70:71], v[226:227] neg_lo:[0,1] neg_hi:[0,1]
v_pk_add_f32 v[72:73], v[72:73], v[226:227] neg_lo:[0,1] neg_hi:[0,1]
v_pk_add_f32 v[74:75], v[74:75], v[226:227] neg_lo:[0,1] neg_hi:[0,1]
v_pk_add_f32 v[76:77], v[76:77], v[226:227] neg_lo:[0,1] neg_hi:[0,1]
v_pk_add_f32 v[78:79], v[78:79], v[226:227] neg_lo:[0,1] neg_hi:[0,1]
v_pk_add_f32 v[80:81], v[80:81], v[226:227] neg_lo:[0,1] neg_hi:[0,1]
v_pk_add_f32 v[82:83], v[82:83], v[226:227] neg_lo:[0,1] neg_hi:[0,1]
v_pk_add_f32 v[84:85], v[84:85], v[226:227] neg_lo:[0,1] neg_hi:[0,1]
v_pk_add_f32 v[86:87], v[86:87], v[226:227] neg_lo:[0,1] neg_hi:[0,1]
v_pk_add_f32 v[88:89], v[88:89], v[226:227] neg_lo:[0,1] neg_hi:[0,1]
v_pk_add_f32 v[90:91], v[90:91], v[226:227] neg_lo:[0,1] neg_hi:[0,1]
v_mov_b32 v220, v132
v_mov_b32 v221, v132
s_nop 1
v_permlane16_swap_b32 v220, v221
v_cndmask_b32 v220, v221, v220, s[58:59]
v_rcp_f32 v220, v220
s_nop 0
v_mul_f32 v128, v220, v128
v_mul_f32 v129, v220, v129
v_mul_f32 v130, v220, v130
v_mul_f32 v131, v220, v131
v_mul_f32 v132, v220, v132
v_mul_f32 v133, v220, v133
v_mul_f32 v134, v220, v134
v_mul_f32 v135, v220, v135
v_cvt_pk_bf16_f32 v222, v128, v129
v_cvt_pk_bf16_f32 v223, v130, v131
v_cvt_pk_bf16_f32 v224, v132, v133
v_cvt_pk_bf16_f32 v225, v134, v135
ds_write_b64 v229, v[222:223] offset:46080
v_cmp_eq_u32 vcc, s22, v240
s_nop 0
s_mov_b64 exec, vcc
ds_write_b64 v239, v[224:225] offset:48128
s_mov_b64 exec, -1
v_mov_b32 v92, 0
v_mov_b32 v93, 0
v_exp_f32 v24, v24
v_exp_f32 v25, v25
v_exp_f32 v26, v26
v_exp_f32 v27, v27
v_cvt_pk_bf16_f32 v94, v24, v25
v_cvt_pk_bf16_f32 v95, v26, v27
s_add_u32 s44, s44, 4096
s_add_u32 s70, s70, 4096
s_mov_b32 m0, s70
s_nop 0
buffer_load_dwordx4 v1, s[4:7], s44 offen offset:0 lds
v_exp_f32 v28, v28
v_exp_f32 v29, v29
v_exp_f32 v30, v30
v_exp_f32 v31, v31
v_mfma_f32_16x16x32_bf16 v[24:27], a[8:11], v[208:211], v[180:183]
v_cvt_pk_bf16_f32 v96, v28, v29
v_cvt_pk_bf16_f32 v97, v30, v31
s_mov_b32 m0, s70
s_nop 0
buffer_load_dwordx4 v1, s[4:7], s44 offen offset:1024 lds
v_exp_f32 v32, v32
v_exp_f32 v33, v33
v_exp_f32 v34, v34
v_exp_f32 v35, v35
v_mfma_f32_16x16x32_bf16 v[28:31], a[12:15], v[208:211], v[184:187]
v_cvt_pk_bf16_f32 v98, v32, v33
v_cvt_pk_bf16_f32 v99, v34, v35
s_mov_b32 m0, s70
s_nop 0
buffer_load_dwordx4 v1, s[4:7], s44 offen offset:2048 lds
v_exp_f32 v36, v36
v_exp_f32 v37, v37
v_exp_f32 v38, v38
v_exp_f32 v39, v39
v_mfma_f32_16x16x32_bf16 v[32:35], a[16:19], v[208:211], v[188:191]
v_cvt_pk_bf16_f32 v100, v36, v37
v_cvt_pk_bf16_f32 v101, v38, v39
s_mov_b32 m0, s70
s_nop 0
buffer_load_dwordx4 v1, s[4:7], s44 offen offset:3072 lds
v_exp_f32 v40, v40
v_exp_f32 v41, v41
v_exp_f32 v42, v42
v_exp_f32 v43, v43
v_mfma_f32_16x16x32_bf16 v[36:39], a[20:23], v[208:211], v[188:191]
v_cvt_pk_bf16_f32 v102, v40, v41
v_cvt_pk_bf16_f32 v103, v42, v43
s_add_u32 s44, s44, 4096
s_add_u32 s70, s70, 4096
s_mov_b32 m0, s70
s_nop 0
buffer_load_dwordx4 v1, s[4:7], s44 offen offset:0 lds
v_exp_f32 v44, v44
v_exp_f32 v45, v45
v_exp_f32 v46, v46
v_exp_f32 v47, v47
v_mfma_f32_16x16x32_bf16 v[40:43], a[24:27], v[208:211], v[188:191]
v_cvt_pk_bf16_f32 v104, v44, v45
v_cvt_pk_bf16_f32 v105, v46, v47
s_mov_b32 m0, s70
s_nop 0
buffer_load_dwordx4 v1, s[4:7], s44 offen offset:1024 lds
v_exp_f32 v48, v48
v_exp_f32 v49, v49
v_exp_f32 v50, v50
v_exp_f32 v51, v51
v_mfma_f32_16x16x32_bf16 v[44:47], a[28:31], v[208:211], v[188:191]
v_cvt_pk_bf16_f32 v106, v48, v49
v_cvt_pk_bf16_f32 v107, v50, v51
s_mov_b32 m0, s70
s_nop 0
buffer_load_dwordx4 v1, s[4:7], s44 offen offset:2048 lds
v_exp_f32 v52, v52
v_exp_f32 v53, v53
v_exp_f32 v54, v54
v_exp_f32 v55, v55
v_mfma_f32_16x16x32_bf16 v[48:51], a[32:35], v[208:211], v[192:195]
v_cvt_pk_bf16_f32 v108, v52, v53
v_cvt_pk_bf16_f32 v109, v54, v55
s_mov_b32 m0, s70
s_nop 0
buffer_load_dwordx4 v1, s[4:7], s44 offen offset:3072 lds
v_exp_f32 v56, v56
v_exp_f32 v57, v57
v_exp_f32 v58, v58
v_exp_f32 v59, v59
v_mfma_f32_16x16x32_bf16 v[52:55], a[36:39], v[208:211], v[192:195]
v_cvt_pk_bf16_f32 v110, v56, v57
v_cvt_pk_bf16_f32 v111, v58, v59
s_add_u32 s44, s44, 4096
s_add_u32 s70, s70, 4096
s_mov_b32 m0, s70
s_nop 0
buffer_load_dwordx4 v1, s[4:7], s44 offen offset:0 lds
v_exp_f32 v60, v60
v_exp_f32 v61, v61
v_exp_f32 v62, v62
v_exp_f32 v63, v63
v_mfma_f32_16x16x32_bf16 v[56:59], a[40:43], v[208:211], v[192:195]
v_cvt_pk_bf16_f32 v112, v60, v61
v_cvt_pk_bf16_f32 v113, v62, v63
v_exp_f32 v64, v64
v_exp_f32 v65, v65
v_exp_f32 v66, v66
v_exp_f32 v67, v67
v_mfma_f32_16x16x32_bf16 v[60:63], a[44:47], v[208:211], v[192:195]
v_cvt_pk_bf16_f32 v114, v64, v65
v_cvt_pk_bf16_f32 v115, v66, v67
buffer_load_dwordx4 a[132:135], v1, s[4:7], s64 offen offset:3072
v_exp_f32 v68, v68
v_exp_f32 v69, v69
v_exp_f32 v70, v70
v_exp_f32 v71, v71
v_mfma_f32_16x16x32_bf16 v[64:67], a[48:51], v[208:211], v[196:199]
v_cvt_pk_bf16_f32 v116, v68, v69
v_cvt_pk_bf16_f32 v117, v70, v71
v_exp_f32 v72, v72
v_exp_f32 v73, v73
v_exp_f32 v74, v74
v_exp_f32 v75, v75
v_mfma_f32_16x16x32_bf16 v[68:71], a[52:55], v[208:211], v[196:199]
v_cvt_pk_bf16_f32 v118, v72, v73
v_cvt_pk_bf16_f32 v119, v74, v75
v_exp_f32 v76, v76
v_exp_f32 v77, v77
v_exp_f32 v78, v78
v_exp_f32 v79, v79
v_mfma_f32_16x16x32_bf16 v[72:75], a[56:59], v[208:211], v[196:199]
v_cvt_pk_bf16_f32 v120, v76, v77
v_cvt_pk_bf16_f32 v121, v78, v79
s_add_u32 s64, s64, 4096
buffer_load_dwordx4 a[136:139], v1, s[4:7], s64 offen
v_exp_f32 v80, v80
v_exp_f32 v81, v81
v_exp_f32 v82, v82
v_exp_f32 v83, v83
v_mfma_f32_16x16x32_bf16 v[76:79], a[60:63], v[208:211], v[196:199]
v_cvt_pk_bf16_f32 v122, v80, v81
v_cvt_pk_bf16_f32 v123, v82, v83
v_exp_f32 v84, v84
v_exp_f32 v85, v85
v_exp_f32 v86, v86
v_exp_f32 v87, v87
v_mfma_f32_16x16x32_bf16 v[80:83], a[64:67], v[208:211], 0
v_cvt_pk_bf16_f32 v124, v84, v85
v_cvt_pk_bf16_f32 v125, v86, v87
v_exp_f32 v88, v88
v_exp_f32 v89, v89
v_exp_f32 v90, v90
v_exp_f32 v91, v91
v_mfma_f32_16x16x32_bf16 v[84:87], a[104:107], v[208:211], 0
v_cvt_pk_bf16_f32 v126, v88, v89
v_cvt_pk_bf16_f32 v127, v90, v91
buffer_load_dwordx4 a[140:143], v1, s[4:7], s64 offen offset:1024
s_waitcnt vmcnt(33)
v_mfma_f32_16x16x32_bf16 v[88:91], a[108:111], v[208:211], v[176:179]
buffer_load_dwordx4 a[144:147], v1, s[4:7], s64 offen offset:2048
buffer_load_dwordx4 a[148:151], v1, s[4:7], s64 offen offset:3072
s_add_u32 s64, s64, 4096
buffer_load_dwordx4 a[152:155], v1, s[4:7], s64 offen
v_mfma_f32_16x16x32_bf16 v[128:131], a[68:71], v[92:95], 0
v_max3_f32 v226, v24, v25, v26
v_max3_f32 v228, v27, v28, v29
v_max3_f32 v226, v226, v30, v31
v_mfma_f32_16x16x32_bf16 v[132:135], v[136:139], v[92:95], 0
v_max3_f32 v228, v228, v32, v33
v_max3_f32 v226, v226, v34, v35
v_max3_f32 v228, v228, v36, v37
v_mfma_f32_16x16x32_bf16 v[128:131], a[72:75], v[96:99], v[128:131]
v_max3_f32 v226, v226, v38, v39
v_max3_f32 v228, v228, v40, v41
v_max3_f32 v226, v226, v42, v43
v_mfma_f32_16x16x32_bf16 v[132:135], v[140:143], v[96:99], v[132:135]
v_max3_f32 v228, v228, v44, v45
v_max3_f32 v226, v226, v46, v47
v_max3_f32 v228, v228, v48, v49
v_mfma_f32_16x16x32_bf16 v[128:131], a[76:79], v[100:103], v[128:131]
v_max3_f32 v226, v226, v50, v51
v_max3_f32 v228, v228, v52, v53
v_max3_f32 v226, v226, v54, v55
v_mfma_f32_16x16x32_bf16 v[132:135], v[144:147], v[100:103], v[132:135]
v_max3_f32 v228, v228, v56, v57
v_max3_f32 v226, v226, v58, v59
v_max3_f32 v228, v228, v60, v61
v_mfma_f32_16x16x32_bf16 v[128:131], a[80:83], v[104:107], v[128:131]
v_max3_f32 v226, v226, v62, v63
v_max3_f32 v228, v228, v64, v65
v_max3_f32 v226, v226, v66, v67
v_mfma_f32_16x16x32_bf16 v[132:135], v[148:151], v[104:107], v[132:135]
v_max3_f32 v228, v228, v68, v69
v_max3_f32 v226, v226, v70, v71
v_max3_f32 v228, v228, v72, v73
v_mfma_f32_16x16x32_bf16 v[128:131], a[84:87], v[108:111], v[128:131]
v_max3_f32 v226, v226, v74, v75
v_max3_f32 v228, v228, v76, v77
v_max3_f32 v226, v226, v78, v79
v_mfma_f32_16x16x32_bf16 v[132:135], v[152:155], v[108:111], v[132:135]
v_max3_f32 v228, v228, v80, v81
v_max3_f32 v226, v226, v82, v83
v_max3_f32 v228, v228, v84, v85
v_mfma_f32_16x16x32_bf16 v[128:131], a[88:91], v[112:115], v[128:131]
v_max3_f32 v226, v226, v86, v87
v_max3_f32 v228, v228, v88, v89
v_max3_f32 v226, v226, v90, v91
v_mfma_f32_16x16x32_bf16 v[132:135], v[156:159], v[112:115], v[132:135]
v_max_f32 v226, v226, v228
v_mov_b32 v227, v226
s_nop 1
v_permlane32_swap_b32 v226, v227
v_max_f32 v226, v226, v227
v_mov_b32 v227, v226
s_nop 1
v_permlane16_swap_b32 v226, v227
v_max_f32 v226, v226, v227
v_mov_b32 v227, v226
v_pk_add_f32 v[24:25], v[24:25], v[226:227] neg_lo:[0,1] neg_hi:[0,1]
v_pk_add_f32 v[26:27], v[26:27], v[226:227] neg_lo:[0,1] neg_hi:[0,1]
v_mfma_f32_16x16x32_bf16 v[128:131], a[92:95], v[116:119], v[128:131]
v_pk_add_f32 v[28:29], v[28:29], v[226:227] neg_lo:[0,1] neg_hi:[0,1]
v_pk_add_f32 v[30:31], v[30:31], v[226:227] neg_lo:[0,1] neg_hi:[0,1]
v_pk_add_f32 v[32:33], v[32:33], v[226:227] neg_lo:[0,1] neg_hi:[0,1]
v_mfma_f32_16x16x32_bf16 v[132:135], v[160:163], v[116:119], v[132:135]
v_pk_add_f32 v[34:35], v[34:35], v[226:227] neg_lo:[0,1] neg_hi:[0,1]
v_pk_add_f32 v[36:37], v[36:37], v[226:227] neg_lo:[0,1] neg_hi:[0,1]
v_pk_add_f32 v[38:39], v[38:39], v[226:227] neg_lo:[0,1] neg_hi:[0,1]
v_mfma_f32_16x16x32_bf16 v[128:131], a[96:99], v[120:123], v[128:131]
v_pk_add_f32 v[40:41], v[40:41], v[226:227] neg_lo:[0,1] neg_hi:[0,1]
v_pk_add_f32 v[42:43], v[42:43], v[226:227] neg_lo:[0,1] neg_hi:[0,1]
v_pk_add_f32 v[44:45], v[44:45], v[226:227] neg_lo:[0,1] neg_hi:[0,1]
v_mfma_f32_16x16x32_bf16 v[132:135], v[164:167], v[120:123], v[132:135]
v_pk_add_f32 v[46:47], v[46:47], v[226:227] neg_lo:[0,1] neg_hi:[0,1]
v_pk_add_f32 v[48:49], v[48:49], v[226:227] neg_lo:[0,1] neg_hi:[0,1]
v_pk_add_f32 v[50:51], v[50:51], v[226:227] neg_lo:[0,1] neg_hi:[0,1]
v_mfma_f32_16x16x32_bf16 v[128:131], a[100:103], v[124:127], v[128:131]
v_pk_add_f32 v[52:53], v[52:53], v[226:227] neg_lo:[0,1] neg_hi:[0,1]
v_pk_add_f32 v[54:55], v[54:55], v[226:227] neg_lo:[0,1] neg_hi:[0,1]
v_pk_add_f32 v[56:57], v[56:57], v[226:227] neg_lo:[0,1] neg_hi:[0,1]
v_mfma_f32_16x16x32_bf16 v[132:135], v[168:171], v[124:127], v[132:135]
v_pk_add_f32 v[58:59], v[58:59], v[226:227] neg_lo:[0,1] neg_hi:[0,1]
v_pk_add_f32 v[60:61], v[60:61], v[226:227] neg_lo:[0,1] neg_hi:[0,1]
v_pk_add_f32 v[62:63], v[62:63], v[226:227] neg_lo:[0,1] neg_hi:[0,1]
v_pk_add_f32 v[64:65], v[64:65], v[226:227] neg_lo:[0,1] neg_hi:[0,1]
v_pk_add_f32 v[66:67], v[66:67], v[226:227] neg_lo:[0,1] neg_hi:[0,1]
v_pk_add_f32 v[68:69], v[68:69], v[226:227] neg_lo:[0,1] neg_hi:[0,1]
v_pk_add_f32 v[70:71], v[70:71], v[226:227] neg_lo:[0,1] neg_hi:[0,1]
v_pk_add_f32 v[72:73], v[72:73], v[226:227] neg_lo:[0,1] neg_hi:[0,1]
v_pk_add_f32 v[74:75], v[74:75], v[226:227] neg_lo:[0,1] neg_hi:[0,1]
v_pk_add_f32 v[76:77], v[76:77], v[226:227] neg_lo:[0,1] neg_hi:[0,1]
v_pk_add_f32 v[78:79], v[78:79], v[226:227] neg_lo:[0,1] neg_hi:[0,1]
v_pk_add_f32 v[80:81], v[80:81], v[226:227] neg_lo:[0,1] neg_hi:[0,1]
v_pk_add_f32 v[82:83], v[82:83], v[226:227] neg_lo:[0,1] neg_hi:[0,1]
v_pk_add_f32 v[84:85], v[84:85], v[226:227] neg_lo:[0,1] neg_hi:[0,1]
v_pk_add_f32 v[86:87], v[86:87], v[226:227] neg_lo:[0,1] neg_hi:[0,1]
v_pk_add_f32 v[88:89], v[88:89], v[226:227] neg_lo:[0,1] neg_hi:[0,1]
v_pk_add_f32 v[90:91], v[90:91], v[226:227] neg_lo:[0,1] neg_hi:[0,1]
v_mov_b32 v220, v132
v_mov_b32 v221, v132
s_nop 1
v_permlane16_swap_b32 v220, v221
v_cndmask_b32 v220, v221, v220, s[58:59]
v_rcp_f32 v220, v220
s_nop 0
v_mul_f32 v128, v220, v128
v_mul_f32 v129, v220, v129
v_mul_f32 v130, v220, v130
v_mul_f32 v131, v220, v131
v_mul_f32 v132, v220, v132
v_mul_f32 v133, v220, v133
v_mul_f32 v134, v220, v134
v_mul_f32 v135, v220, v135
v_cvt_pk_bf16_f32 v222, v128, v129
v_cvt_pk_bf16_f32 v223, v130, v131
v_cvt_pk_bf16_f32 v224, v132, v133
v_cvt_pk_bf16_f32 v225, v134, v135
ds_write_b64 v229, v[222:223] offset:48640
v_cmp_eq_u32 vcc, s22, v240
s_nop 0
s_mov_b64 exec, vcc
ds_write_b64 v239, v[224:225] offset:50688
s_mov_b64 exec, -1
v_mov_b32 v126, 0
v_mov_b32 v127, 0
v_exp_f32 v24, v24
v_exp_f32 v25, v25
v_exp_f32 v26, v26
v_exp_f32 v27, v27
v_cvt_pk_bf16_f32 v92, v24, v25
v_cvt_pk_bf16_f32 v93, v26, v27
v_exp_f32 v28, v28
v_exp_f32 v29, v29
v_exp_f32 v30, v30
v_exp_f32 v31, v31
v_mfma_f32_16x16x32_bf16 v[24:27], a[12:15], v[212:215], v[180:183]
v_cvt_pk_bf16_f32 v94, v28, v29
v_cvt_pk_bf16_f32 v95, v30, v31
buffer_load_dwordx4 a[156:159], v1, s[4:7], s64 offen offset:1024
v_exp_f32 v32, v32
v_exp_f32 v33, v33
v_exp_f32 v34, v34
v_exp_f32 v35, v35
v_mfma_f32_16x16x32_bf16 v[28:31], a[16:19], v[212:215], v[188:191]
v_cvt_pk_bf16_f32 v96, v32, v33
v_cvt_pk_bf16_f32 v97, v34, v35
v_exp_f32 v36, v36
v_exp_f32 v37, v37
v_exp_f32 v38, v38
v_exp_f32 v39, v39
v_mfma_f32_16x16x32_bf16 v[32:35], a[20:23], v[212:215], v[188:191]
v_cvt_pk_bf16_f32 v98, v36, v37
v_cvt_pk_bf16_f32 v99, v38, v39
v_exp_f32 v40, v40
v_exp_f32 v41, v41
v_exp_f32 v42, v42
v_exp_f32 v43, v43
v_mfma_f32_16x16x32_bf16 v[36:39], a[24:27], v[212:215], v[188:191]
v_cvt_pk_bf16_f32 v100, v40, v41
v_cvt_pk_bf16_f32 v101, v42, v43
buffer_load_dwordx4 a[160:163], v1, s[4:7], s64 offen offset:2048
v_exp_f32 v44, v44
v_exp_f32 v45, v45
v_exp_f32 v46, v46
v_exp_f32 v47, v47
v_mfma_f32_16x16x32_bf16 v[40:43], a[28:31], v[212:215], v[188:191]
v_cvt_pk_bf16_f32 v102, v44, v45
v_cvt_pk_bf16_f32 v103, v46, v47
v_exp_f32 v48, v48
v_exp_f32 v49, v49
v_exp_f32 v50, v50
v_exp_f32 v51, v51
v_mfma_f32_16x16x32_bf16 v[44:47], a[32:35], v[212:215], v[192:195]
v_cvt_pk_bf16_f32 v104, v48, v49
v_cvt_pk_bf16_f32 v105, v50, v51
v_exp_f32 v52, v52
v_exp_f32 v53, v53
v_exp_f32 v54, v54
v_exp_f32 v55, v55
v_mfma_f32_16x16x32_bf16 v[48:51], a[36:39], v[212:215], v[192:195]
v_cvt_pk_bf16_f32 v106, v52, v53
v_cvt_pk_bf16_f32 v107, v54, v55
buffer_load_dwordx4 a[164:167], v1, s[4:7], s64 offen offset:3072
v_exp_f32 v56, v56
v_exp_f32 v57, v57
v_exp_f32 v58, v58
v_exp_f32 v59, v59
v_mfma_f32_16x16x32_bf16 v[52:55], a[40:43], v[212:215], v[192:195]
v_cvt_pk_bf16_f32 v108, v56, v57
v_cvt_pk_bf16_f32 v109, v58, v59
v_exp_f32 v60, v60
v_exp_f32 v61, v61
v_exp_f32 v62, v62
v_exp_f32 v63, v63
v_mfma_f32_16x16x32_bf16 v[56:59], a[44:47], v[212:215], v[192:195]
v_cvt_pk_bf16_f32 v110, v60, v61
v_cvt_pk_bf16_f32 v111, v62, v63
v_exp_f32 v64, v64
v_exp_f32 v65, v65
v_exp_f32 v66, v66
v_exp_f32 v67, v67
v_mfma_f32_16x16x32_bf16 v[60:63], a[48:51], v[212:215], v[196:199]
v_cvt_pk_bf16_f32 v112, v64, v65
v_cvt_pk_bf16_f32 v113, v66, v67
s_add_u32 s64, s64, 4096
buffer_load_dwordx4 a[168:171], v1, s[4:7], s64 offen
v_exp_f32 v68, v68
v_exp_f32 v69, v69
v_exp_f32 v70, v70
v_exp_f32 v71, v71
v_mfma_f32_16x16x32_bf16 v[64:67], a[52:55], v[212:215], v[196:199]
v_cvt_pk_bf16_f32 v114, v68, v69
v_cvt_pk_bf16_f32 v115, v70, v71
v_exp_f32 v72, v72
v_exp_f32 v73, v73
v_exp_f32 v74, v74
v_exp_f32 v75, v75
v_mfma_f32_16x16x32_bf16 v[68:71], a[56:59], v[212:215], v[196:199]
v_cvt_pk_bf16_f32 v116, v72, v73
v_cvt_pk_bf16_f32 v117, v74, v75
v_exp_f32 v76, v76
v_exp_f32 v77, v77
v_exp_f32 v78, v78
v_exp_f32 v79, v79
v_mfma_f32_16x16x32_bf16 v[72:75], a[60:63], v[212:215], v[196:199]
v_cvt_pk_bf16_f32 v118, v76, v77
v_cvt_pk_bf16_f32 v119, v78, v79
buffer_load_dwordx4 a[172:175], v1, s[4:7], s64 offen offset:1024
v_exp_f32 v80, v80
v_exp_f32 v81, v81
v_exp_f32 v82, v82
v_exp_f32 v83, v83
v_mfma_f32_16x16x32_bf16 v[76:79], a[64:67], v[212:215], 0
v_cvt_pk_bf16_f32 v120, v80, v81
v_cvt_pk_bf16_f32 v121, v82, v83
v_exp_f32 v84, v84
v_exp_f32 v85, v85
v_exp_f32 v86, v86
v_exp_f32 v87, v87
v_mfma_f32_16x16x32_bf16 v[80:83], a[104:107], v[212:215], 0
v_cvt_pk_bf16_f32 v122, v84, v85
v_cvt_pk_bf16_f32 v123, v86, v87
v_exp_f32 v88, v88
v_exp_f32 v89, v89
v_exp_f32 v90, v90
v_exp_f32 v91, v91
v_mfma_f32_16x16x32_bf16 v[84:87], a[108:111], v[212:215], 0
v_cvt_pk_bf16_f32 v124, v88, v89
v_cvt_pk_bf16_f32 v125, v90, v91
buffer_load_dwordx4 a[176:179], v1, s[4:7], s64 offen offset:2048
s_waitcnt vmcnt(41)
v_mfma_f32_16x16x32_bf16 v[88:91], a[112:115], v[212:215], v[176:179]
buffer_load_dwordx4 a[180:183], v1, s[4:7], s64 offen offset:3072
s_add_u32 s64, s64, 4096
buffer_load_dwordx4 a[184:187], v1, s[4:7], s64 offen
buffer_load_dwordx4 a[188:191], v1, s[4:7], s64 offen offset:1024
v_lshrrev_b32 v217, 3, v0
v_and_b32 v216, 3, v217
v_lshrrev_b32 v217, 2, v217
s_mov_b32 s24, 55296
v_mul_lo_u32 v216, v216, s24
v_lshlrev_b32 v217, 10, v217
v_add_u32 v217, v217, v216
v_and_b32 v216, 7, v0
v_lshlrev_b32 v216, 7, v216
v_add_u32 v217, v217, v216
s_lshl_b32 s24, s63, 10
s_mul_i32 s25, s61, 55296
s_add_u32 s24, s24, s25
s_add_u32 s24, s24, 27123712
s_cmp_lt_u32 s22, 3
s_cselect_b32 exec_hi, -1, 0
s_cmp_eq_u32 s22, 3
s_cselect_b32 s25, s21, 0
s_cmp_ge_u32 s25, 6
s_cbranch_scc1 PH9
buffer_load_dword v216, v217, s[4:7], s24 offen
PH9:
s_mov_b64 exec, -1
v_mfma_f32_16x16x32_bf16 v[128:131], a[72:75], v[92:95], 0
v_max3_f32 v226, v24, v25, v26
v_max3_f32 v228, v27, v28, v29
v_max3_f32 v226, v226, v30, v31
v_mfma_f32_16x16x32_bf16 v[132:135], v[140:143], v[92:95], 0
v_max3_f32 v228, v228, v32, v33
v_max3_f32 v226, v226, v34, v35
v_max3_f32 v228, v228, v36, v37
v_mfma_f32_16x16x32_bf16 v[128:131], a[76:79], v[96:99], v[128:131]
v_max3_f32 v226, v226, v38, v39
v_max3_f32 v228, v228, v40, v41
v_max3_f32 v226, v226, v42, v43
v_mfma_f32_16x16x32_bf16 v[132:135], v[144:147], v[96:99], v[132:135]
v_max3_f32 v228, v228, v44, v45
v_max3_f32 v226, v226, v46, v47
v_max3_f32 v228, v228, v48, v49
v_mfma_f32_16x16x32_bf16 v[128:131], a[80:83], v[100:103], v[128:131]
v_max3_f32 v226, v226, v50, v51
v_max3_f32 v228, v228, v52, v53
v_max3_f32 v226, v226, v54, v55
v_mfma_f32_16x16x32_bf16 v[132:135], v[148:151], v[100:103], v[132:135]
v_max3_f32 v228, v228, v56, v57
v_max3_f32 v226, v226, v58, v59
v_max3_f32 v228, v228, v60, v61
v_mfma_f32_16x16x32_bf16 v[128:131], a[84:87], v[104:107], v[128:131]
v_max3_f32 v226, v226, v62, v63
v_max3_f32 v228, v228, v64, v65
v_max3_f32 v226, v226, v66, v67
v_mfma_f32_16x16x32_bf16 v[132:135], v[152:155], v[104:107], v[132:135]
v_max3_f32 v228, v228, v68, v69
v_max3_f32 v226, v226, v70, v71
v_max3_f32 v228, v228, v72, v73
v_mfma_f32_16x16x32_bf16 v[128:131], a[88:91], v[108:111], v[128:131]
v_max3_f32 v226, v226, v74, v75
v_max3_f32 v228, v228, v76, v77
v_max3_f32 v226, v226, v78, v79
v_mfma_f32_16x16x32_bf16 v[132:135], v[156:159], v[108:111], v[132:135]
v_max3_f32 v228, v228, v80, v81
v_max3_f32 v226, v226, v82, v83
v_max3_f32 v228, v228, v84, v85
v_mfma_f32_16x16x32_bf16 v[128:131], a[92:95], v[112:115], v[128:131]
v_max3_f32 v226, v226, v86, v87
v_max3_f32 v228, v228, v88, v89
v_max3_f32 v226, v226, v90, v91
v_mfma_f32_16x16x32_bf16 v[132:135], v[160:163], v[112:115], v[132:135]
v_max_f32 v226, v226, v228
v_mov_b32 v227, v226
s_nop 1
v_permlane32_swap_b32 v226, v227
v_max_f32 v226, v226, v227
v_mov_b32 v227, v226
s_nop 1
v_permlane16_swap_b32 v226, v227
v_max_f32 v226, v226, v227
v_mov_b32 v227, v226
v_pk_add_f32 v[24:25], v[24:25], v[226:227] neg_lo:[0,1] neg_hi:[0,1]
v_pk_add_f32 v[26:27], v[26:27], v[226:227] neg_lo:[0,1] neg_hi:[0,1]
v_mfma_f32_16x16x32_bf16 v[128:131], a[96:99], v[116:119], v[128:131]
v_pk_add_f32 v[28:29], v[28:29], v[226:227] neg_lo:[0,1] neg_hi:[0,1]
v_pk_add_f32 v[30:31], v[30:31], v[226:227] neg_lo:[0,1] neg_hi:[0,1]
v_pk_add_f32 v[32:33], v[32:33], v[226:227] neg_lo:[0,1] neg_hi:[0,1]
v_mfma_f32_16x16x32_bf16 v[132:135], v[164:167], v[116:119], v[132:135]
v_pk_add_f32 v[34:35], v[34:35], v[226:227] neg_lo:[0,1] neg_hi:[0,1]
v_pk_add_f32 v[36:37], v[36:37], v[226:227] neg_lo:[0,1] neg_hi:[0,1]
v_pk_add_f32 v[38:39], v[38:39], v[226:227] neg_lo:[0,1] neg_hi:[0,1]
v_mfma_f32_16x16x32_bf16 v[128:131], a[100:103], v[120:123], v[128:131]
v_pk_add_f32 v[40:41], v[40:41], v[226:227] neg_lo:[0,1] neg_hi:[0,1]
v_pk_add_f32 v[42:43], v[42:43], v[226:227] neg_lo:[0,1] neg_hi:[0,1]
v_pk_add_f32 v[44:45], v[44:45], v[226:227] neg_lo:[0,1] neg_hi:[0,1]
v_mfma_f32_16x16x32_bf16 v[132:135], v[168:171], v[120:123], v[132:135]
v_pk_add_f32 v[46:47], v[46:47], v[226:227] neg_lo:[0,1] neg_hi:[0,1]
v_pk_add_f32 v[48:49], v[48:49], v[226:227] neg_lo:[0,1] neg_hi:[0,1]
v_pk_add_f32 v[50:51], v[50:51], v[226:227] neg_lo:[0,1] neg_hi:[0,1]
s_waitcnt vmcnt(43)
v_mfma_f32_16x16x32_bf16 v[128:131], a[116:119], v[124:127], v[128:131]
v_pk_add_f32 v[52:53], v[52:53], v[226:227] neg_lo:[0,1] neg_hi:[0,1]
v_pk_add_f32 v[54:55], v[54:55], v[226:227] neg_lo:[0,1] neg_hi:[0,1]
v_pk_add_f32 v[56:57], v[56:57], v[226:227] neg_lo:[0,1] neg_hi:[0,1]
v_mfma_f32_16x16x32_bf16 v[132:135], v[172:175], v[124:127], v[132:135]
v_pk_add_f32 v[58:59], v[58:59], v[226:227] neg_lo:[0,1] neg_hi:[0,1]
v_pk_add_f32 v[60:61], v[60:61], v[226:227] neg_lo:[0,1] neg_hi:[0,1]
v_pk_add_f32 v[62:63], v[62:63], v[226:227] neg_lo:[0,1] neg_hi:[0,1]
v_pk_add_f32 v[64:65], v[64:65], v[226:227] neg_lo:[0,1] neg_hi:[0,1]
v_pk_add_f32 v[66:67], v[66:67], v[226:227] neg_lo:[0,1] neg_hi:[0,1]
v_pk_add_f32 v[68:69], v[68:69], v[226:227] neg_lo:[0,1] neg_hi:[0,1]
v_pk_add_f32 v[70:71], v[70:71], v[226:227] neg_lo:[0,1] neg_hi:[0,1]
v_pk_add_f32 v[72:73], v[72:73], v[226:227] neg_lo:[0,1] neg_hi:[0,1]
v_pk_add_f32 v[74:75], v[74:75], v[226:227] neg_lo:[0,1] neg_hi:[0,1]
v_pk_add_f32 v[76:77], v[76:77], v[226:227] neg_lo:[0,1] neg_hi:[0,1]
v_pk_add_f32 v[78:79], v[78:79], v[226:227] neg_lo:[0,1] neg_hi:[0,1]
v_pk_add_f32 v[80:81], v[80:81], v[226:227] neg_lo:[0,1] neg_hi:[0,1]
v_pk_add_f32 v[82:83], v[82:83], v[226:227] neg_lo:[0,1] neg_hi:[0,1]
v_pk_add_f32 v[84:85], v[84:85], v[226:227] neg_lo:[0,1] neg_hi:[0,1]
v_pk_add_f32 v[86:87], v[86:87], v[226:227] neg_lo:[0,1] neg_hi:[0,1]
v_pk_add_f32 v[88:89], v[88:89], v[226:227] neg_lo:[0,1] neg_hi:[0,1]
v_pk_add_f32 v[90:91], v[90:91], v[226:227] neg_lo:[0,1] neg_hi:[0,1]
v_mov_b32 v220, v132
v_mov_b32 v221, v132
s_nop 1
v_permlane16_swap_b32 v220, v221
v_cndmask_b32 v220, v221, v220, s[58:59]
v_rcp_f32 v220, v220
s_nop 0
v_mul_f32 v128, v220, v128
v_mul_f32 v129, v220, v129
v_mul_f32 v130, v220, v130
v_mul_f32 v131, v220, v131
v_mul_f32 v132, v220, v132
v_mul_f32 v133, v220, v133
v_mul_f32 v134, v220, v134
v_mul_f32 v135, v220, v135
v_cvt_pk_bf16_f32 v222, v128, v129
v_cvt_pk_bf16_f32 v223, v130, v131
v_cvt_pk_bf16_f32 v224, v132, v133
v_cvt_pk_bf16_f32 v225, v134, v135
ds_write_b64 v229, v[222:223] offset:51200
v_cmp_eq_u32 vcc, s22, v240
s_nop 0
s_mov_b64 exec, vcc
ds_write_b64 v239, v[224:225] offset:53248
s_mov_b64 exec, -1
v_mov_b32 v92, 0
v_mov_b32 v93, 0
v_exp_f32 v24, v24
v_exp_f32 v25, v25
v_exp_f32 v26, v26
v_exp_f32 v27, v27
v_cvt_pk_bf16_f32 v94, v24, v25
v_cvt_pk_bf16_f32 v95, v26, v27
v_exp_f32 v28, v28
v_exp_f32 v29, v29
v_exp_f32 v30, v30
v_exp_f32 v31, v31
v_cvt_pk_bf16_f32 v96, v28, v29
v_cvt_pk_bf16_f32 v97, v30, v31
buffer_load_dwordx4 a[192:195], v1, s[4:7], s64 offen offset:2048
v_exp_f32 v32, v32
v_exp_f32 v33, v33
v_exp_f32 v34, v34
v_exp_f32 v35, v35
v_cvt_pk_bf16_f32 v98, v32, v33
v_cvt_pk_bf16_f32 v99, v34, v35
v_exp_f32 v36, v36
v_exp_f32 v37, v37
v_exp_f32 v38, v38
v_exp_f32 v39, v39
v_cvt_pk_bf16_f32 v100, v36, v37
v_cvt_pk_bf16_f32 v101, v38, v39
v_exp_f32 v40, v40
v_exp_f32 v41, v41
v_exp_f32 v42, v42
v_exp_f32 v43, v43
v_cvt_pk_bf16_f32 v102, v40, v41
v_cvt_pk_bf16_f32 v103, v42, v43
buffer_load_dwordx4 a[196:199], v1, s[4:7], s64 offen offset:3072
v_exp_f32 v44, v44
v_exp_f32 v45, v45
v_exp_f32 v46, v46
v_exp_f32 v47, v47
v_cvt_pk_bf16_f32 v104, v44, v45
v_cvt_pk_bf16_f32 v105, v46, v47
v_exp_f32 v48, v48
v_exp_f32 v49, v49
v_exp_f32 v50, v50
v_exp_f32 v51, v51
v_cvt_pk_bf16_f32 v106, v48, v49
v_cvt_pk_bf16_f32 v107, v50, v51
v_exp_f32 v52, v52
v_exp_f32 v53, v53
v_exp_f32 v54, v54
v_exp_f32 v55, v55
v_cvt_pk_bf16_f32 v108, v52, v53
v_cvt_pk_bf16_f32 v109, v54, v55
s_add_u32 s64, s64, 4096
buffer_load_dwordx4 a[200:203], v1, s[4:7], s64 offen
v_exp_f32 v56, v56
v_exp_f32 v57, v57
v_exp_f32 v58, v58
v_exp_f32 v59, v59
v_cvt_pk_bf16_f32 v110, v56, v57
v_cvt_pk_bf16_f32 v111, v58, v59
v_exp_f32 v60, v60
v_exp_f32 v61, v61
v_exp_f32 v62, v62
v_exp_f32 v63, v63
v_cvt_pk_bf16_f32 v112, v60, v61
v_cvt_pk_bf16_f32 v113, v62, v63
v_exp_f32 v64, v64
v_exp_f32 v65, v65
v_exp_f32 v66, v66
v_exp_f32 v67, v67
v_cvt_pk_bf16_f32 v114, v64, v65
v_cvt_pk_bf16_f32 v115, v66, v67
buffer_load_dwordx4 a[204:207], v1, s[4:7], s64 offen offset:1024
v_exp_f32 v68, v68
v_exp_f32 v69, v69
v_exp_f32 v70, v70
v_exp_f32 v71, v71
v_cvt_pk_bf16_f32 v116, v68, v69
v_cvt_pk_bf16_f32 v117, v70, v71
v_exp_f32 v72, v72
v_exp_f32 v73, v73
v_exp_f32 v74, v74
v_exp_f32 v75, v75
v_cvt_pk_bf16_f32 v118, v72, v73
v_cvt_pk_bf16_f32 v119, v74, v75
v_exp_f32 v76, v76
v_exp_f32 v77, v77
v_exp_f32 v78, v78
v_exp_f32 v79, v79
v_cvt_pk_bf16_f32 v120, v76, v77
v_cvt_pk_bf16_f32 v121, v78, v79
buffer_load_dwordx4 a[208:211], v1, s[4:7], s64 offen offset:2048
v_exp_f32 v80, v80
v_exp_f32 v81, v81
v_exp_f32 v82, v82
v_exp_f32 v83, v83
v_cvt_pk_bf16_f32 v122, v80, v81
v_cvt_pk_bf16_f32 v123, v82, v83
v_exp_f32 v84, v84
v_exp_f32 v85, v85
v_exp_f32 v86, v86
v_exp_f32 v87, v87
v_cvt_pk_bf16_f32 v124, v84, v85
v_cvt_pk_bf16_f32 v125, v86, v87
v_exp_f32 v88, v88
v_exp_f32 v89, v89
v_exp_f32 v90, v90
v_exp_f32 v91, v91
v_cvt_pk_bf16_f32 v126, v88, v89
v_cvt_pk_bf16_f32 v127, v90, v91
buffer_load_dwordx4 a[212:215], v1, s[4:7], s64 offen offset:3072
s_add_u32 s64, s64, 4096
buffer_load_dwordx4 a[216:219], v1, s[4:7], s64 offen
buffer_load_dwordx4 a[220:223], v1, s[4:7], s64 offen offset:1024
buffer_load_dwordx4 a[224:227], v1, s[4:7], s64 offen offset:2048
v_mfma_f32_16x16x32_bf16 v[128:131], a[72:75], v[92:95], 0
v_mfma_f32_16x16x32_bf16 v[132:135], v[140:143], v[92:95], 0
v_mfma_f32_16x16x32_bf16 v[128:131], a[76:79], v[96:99], v[128:131]
v_mfma_f32_16x16x32_bf16 v[132:135], v[144:147], v[96:99], v[132:135]
v_mfma_f32_16x16x32_bf16 v[128:131], a[80:83], v[100:103], v[128:131]
v_mfma_f32_16x16x32_bf16 v[132:135], v[148:151], v[100:103], v[132:135]
v_mfma_f32_16x16x32_bf16 v[128:131], a[84:87], v[104:107], v[128:131]
v_mfma_f32_16x16x32_bf16 v[132:135], v[152:155], v[104:107], v[132:135]
v_mfma_f32_16x16x32_bf16 v[128:131], a[88:91], v[108:111], v[128:131]
v_mfma_f32_16x16x32_bf16 v[132:135], v[156:159], v[108:111], v[132:135]
v_mfma_f32_16x16x32_bf16 v[128:131], a[92:95], v[112:115], v[128:131]
v_mfma_f32_16x16x32_bf16 v[132:135], v[160:163], v[112:115], v[132:135]
v_mfma_f32_16x16x32_bf16 v[128:131], a[96:99], v[116:119], v[128:131]
v_mfma_f32_16x16x32_bf16 v[132:135], v[164:167], v[116:119], v[132:135]
v_mfma_f32_16x16x32_bf16 v[128:131], a[100:103], v[120:123], v[128:131]
v_mfma_f32_16x16x32_bf16 v[132:135], v[168:171], v[120:123], v[132:135]
v_mfma_f32_16x16x32_bf16 v[128:131], a[116:119], v[124:127], v[128:131]
v_mfma_f32_16x16x32_bf16 v[132:135], v[172:175], v[124:127], v[132:135]
s_nop 7
v_mov_b32 v220, v132
v_mov_b32 v221, v132
s_nop 1
v_permlane16_swap_b32 v220, v221
v_cndmask_b32 v220, v221, v220, s[58:59]
v_rcp_f32 v220, v220
s_nop 0
v_mul_f32 v128, v220, v128
v_mul_f32 v129, v220, v129
v_mul_f32 v130, v220, v130
v_mul_f32 v131, v220, v131
v_mul_f32 v132, v220, v132
v_mul_f32 v133, v220, v133
v_mul_f32 v134, v220, v134
v_mul_f32 v135, v220, v135
v_cvt_pk_bf16_f32 v222, v128, v129
v_cvt_pk_bf16_f32 v223, v130, v131
v_cvt_pk_bf16_f32 v224, v132, v133
v_cvt_pk_bf16_f32 v225, v134, v135
ds_write_b64 v229, v[222:223] offset:53760
v_cmp_eq_u32 vcc, s22, v240
s_nop 0
s_mov_b64 exec, vcc
ds_write_b64 v239, v[224:225] offset:55808
s_mov_b64 exec, -1
s_mul_i32 s24, s22, 2560
v_add_u32 v3, s24, v238
v_add_u32 v229, s24, v239
s_mul_i32 s24, s62, 20480
s_add_u32 s24, s24, 10346496
s_lshl_b32 s25, s21, 11
s_add_u32 s25, s25, s24
s_lshr_b32 s26, s21, 1
s_lshl_b32 s26, s26, 10
s_and_b32 s27, s21, 1
s_lshl_b32 s27, s27, 9
s_add_u32 s26, s26, s27
s_add_u32 s26, s26, 16384
s_add_u32 s26, s26, s24
s_waitcnt vmcnt(24)
s_waitcnt lgkmcnt(0)
s_barrier
ds_read_b128 v[24:27], v3 offset:46080
ds_read_b128 v[28:31], v3 offset:47104
ds_read_b64 v[32:33], v229 offset:48128
s_waitcnt lgkmcnt(2)
s_cmp_eq_u32 s72, 0
s_cbranch_scc1 XS10
buffer_store_dwordx4 v[24:27], v1, s[4:7], s25 offen
s_branch XE11
XS10:
buffer_store_dwordx4 v[24:27], v1, s[4:7], s25 offen sc1
XE11:
s_waitcnt lgkmcnt(1)
s_cmp_eq_u32 s72, 0
s_cbranch_scc1 XS12
buffer_store_dwordx4 v[28:31], v1, s[4:7], s25 offen offset:1024
s_branch XE13
XS12:
buffer_store_dwordx4 v[28:31], v1, s[4:7], s25 offen offset:1024 sc1
XE13:
s_waitcnt lgkmcnt(0)
s_cmp_eq_u32 s72, 0
s_cbranch_scc1 XS14
buffer_store_dwordx2 v[32:33], v2, s[4:7], s26 offen
s_branch XE15
XS14:
buffer_store_dwordx2 v[32:33], v2, s[4:7], s26 offen sc1
XE15:
buffer_load_dwordx4 a[228:231], v1, s[4:7], s64 offen offset:3072
s_add_u32 s64, s64, 4096
buffer_load_dwordx4 a[232:235], v1, s[4:7], s64 offen
buffer_load_dwordx4 a[236:239], v1, s[4:7], s64 offen offset:1024
buffer_load_dwordx4 a[240:243], v1, s[4:7], s64 offen offset:2048
buffer_load_dwordx4 a[244:247], v1, s[4:7], s64 offen offset:3072
s_add_u32 s64, s64, 4096
buffer_load_dwordx4 a[248:251], v1, s[4:7], s64 offen
buffer_load_dwordx4 a[252:255], v1, s[4:7], s64 offen offset:1024
buffer_load_dwordx4 a[0:3], v1, s[4:7], s64 offen offset:2048
buffer_load_dwordx4 a[4:7], v1, s[4:7], s64 offen offset:3072
s_add_u32 s64, s64, 4096
buffer_load_dwordx4 a[8:11], v1, s[4:7], s64 offen
buffer_load_dwordx4 a[12:15], v1, s[4:7], s64 offen offset:1024
buffer_load_dwordx4 a[16:19], v1, s[4:7], s64 offen offset:2048
buffer_load_dwordx4 a[20:23], v1, s[4:7], s64 offen offset:3072
buffer_load_dwordx4 a[24:27], v1, s[4:7], s65 offen
buffer_load_dwordx4 a[28:31], v1, s[4:7], s65 offen offset:1024
buffer_load_dwordx4 a[32:35], v1, s[4:7], s65 offen offset:2048
buffer_load_dwordx4 a[36:39], v1, s[4:7], s65 offen offset:3072
s_add_u32 s65, s65, 4096
buffer_load_dwordx4 a[40:43], v1, s[4:7], s65 offen
buffer_load_dwordx4 a[44:47], v1, s[4:7], s65 offen offset:1024
buffer_load_dwordx4 a[48:51], v1, s[4:7], s65 offen offset:2048
buffer_load_dwordx4 a[52:55], v1, s[4:7], s65 offen offset:3072
s_add_u32 s65, s65, 4096
buffer_load_dwordx4 a[56:59], v1, s[4:7], s65 offen
buffer_load_dwordx4 a[60:63], v1, s[4:7], s65 offen offset:1024
buffer_load_dwordx4 a[64:67], v1, s[4:7], s65 offen offset:2048
s_waitcnt vmcnt(24)
v_mov_b32 v3, 2
s_mov_b64 exec, 1
s_cmp_eq_u32 s72, 0
s_cbranch_scc1 XS16
buffer_store_dword v3, off, s[4:7], s23
s_branch XE17
XS16:
buffer_store_dword v3, off, s[4:7], s23 sc1
XE17:
s_mov_b64 exec, -1
s_mul_i32 s45, s62, 20480
s_add_u32 s45, s45, 10346496
s_add_u32 s46, s45, 16384
s_mov_b32 s24, 30000
PL18:
buffer_load_dword v3, v236, s[4:7], 0 offen sc1
s_waitcnt vmcnt(0)
v_cmp_gt_u32 vcc, 2, v3
s_sub_u32 s24, s24, 1
s_cbranch_scc1 PD19
s_cbranch_vccnz PL18
PD19:
buffer_load_dwordx4 v[84:87], v1, s[4:7], s45 offen offset:0 sc1
buffer_load_dwordx4 v[88:91], v1, s[4:7], s45 offen offset:1024 sc1
buffer_load_dwordx4 v[92:95], v1, s[4:7], s45 offen offset:2048 sc1
buffer_load_dwordx4 v[96:99], v1, s[4:7], s45 offen offset:3072 sc1
s_add_u32 s45, s45, 4096
buffer_load_dwordx4 v[100:103], v1, s[4:7], s45 offen offset:0 sc1
buffer_load_dwordx4 v[104:107], v1, s[4:7], s45 offen offset:1024 sc1
buffer_load_dwordx4 v[108:111], v1, s[4:7], s45 offen offset:2048 sc1
buffer_load_dwordx4 v[112:115], v1, s[4:7], s45 offen offset:3072 sc1
s_add_u32 s45, s45, 4096
buffer_load_dwordx4 v[116:119], v1, s[4:7], s45 offen offset:0 sc1
buffer_load_dwordx4 v[120:123], v1, s[4:7], s45 offen offset:1024 sc1
buffer_load_dwordx4 v[124:127], v1, s[4:7], s45 offen offset:2048 sc1
buffer_load_dwordx4 v[128:131], v1, s[4:7], s45 offen offset:3072 sc1
s_add_u32 s45, s45, 4096
buffer_load_dwordx4 v[132:135], v1, s[4:7], s45 offen offset:0 sc1
buffer_load_dwordx4 v[136:139], v1, s[4:7], s45 offen offset:1024 sc1
buffer_load_dwordx4 v[140:143], v1, s[4:7], s45 offen offset:2048 sc1
buffer_load_dwordx4 v[144:147], v1, s[4:7], s45 offen offset:3072 sc1
buffer_load_dwordx2 v[148:149], v2, s[4:7], s46 offen offset:0 sc1
buffer_load_dwordx2 v[150:151], v2, s[4:7], s46 offen offset:512 sc1
buffer_load_dwordx2 v[152:153], v2, s[4:7], s46 offen offset:1024 sc1
buffer_load_dwordx2 v[154:155], v2, s[4:7], s46 offen offset:1536 sc1
buffer_load_dwordx2 v[156:157], v2, s[4:7], s46 offen offset:2048 sc1
buffer_load_dwordx2 v[158:159], v2, s[4:7], s46 offen offset:2560 sc1
buffer_load_dwordx2 v[160:161], v2, s[4:7], s46 offen offset:3072 sc1
buffer_load_dwordx2 v[162:163], v2, s[4:7], s46 offen offset:3584 sc1
ds_read_b128 v[24:27], v1 offset:0
ds_read_b128 v[28:31], v1 offset:1024
ds_read_b128 v[32:35], v1 offset:2048
ds_read_b128 v[36:39], v1 offset:3072
ds_read_b128 v[40:43], v1 offset:4096
ds_read_b128 v[44:47], v1 offset:5120
ds_read_b128 v[48:51], v1 offset:6144
ds_read_b128 v[52:55], v1 offset:7168
s_waitcnt vmcnt(23)
s_waitcnt lgkmcnt(7)
v_mfma_f32_16x16x32_bf16 v[4:7], v[24:27], v[84:87], v[4:7]
ds_read_b128 v[24:27], v1 offset:8192
s_waitcnt lgkmcnt(7)
v_mfma_f32_16x16x32_bf16 v[8:11], v[28:31], v[84:87], v[8:11]
ds_read_b128 v[28:31], v1 offset:9216
s_waitcnt lgkmcnt(7)
v_mfma_f32_16x16x32_bf16 v[12:15], v[32:35], v[84:87], v[12:15]
ds_read_b128 v[32:35], v1 offset:10240
s_waitcnt lgkmcnt(7)
v_mfma_f32_16x16x32_bf16 v[16:19], v[36:39], v[84:87], v[16:19]
ds_read_b128 v[36:39], v1 offset:11264
s_waitcnt lgkmcnt(7)
v_mfma_f32_16x16x32_bf16 v[20:23], v[40:43], v[84:87], v[20:23]
ds_read_b128 v[40:43], v1 offset:12288
s_waitcnt vmcnt(22)
s_waitcnt lgkmcnt(7)
v_mfma_f32_16x16x32_bf16 v[4:7], v[44:47], v[88:91], v[4:7]
ds_read_b128 v[44:47], v1 offset:13312
s_waitcnt lgkmcnt(7)
v_mfma_f32_16x16x32_bf16 v[8:11], v[48:51], v[88:91], v[8:11]
ds_read_b128 v[48:51], v1 offset:14336
s_waitcnt lgkmcnt(7)
v_mfma_f32_16x16x32_bf16 v[12:15], v[52:55], v[88:91], v[12:15]
ds_read_b128 v[52:55], v1 offset:15360
s_waitcnt lgkmcnt(7)
v_mfma_f32_16x16x32_bf16 v[16:19], v[24:27], v[88:91], v[16:19]
ds_read_b128 v[24:27], v1 offset:16384
s_waitcnt lgkmcnt(7)
v_mfma_f32_16x16x32_bf16 v[20:23], v[28:31], v[88:91], v[20:23]
ds_read_b128 v[28:31], v1 offset:17408
s_waitcnt vmcnt(21)
s_waitcnt lgkmcnt(7)
v_mfma_f32_16x16x32_bf16 v[4:7], v[32:35], v[92:95], v[4:7]
ds_read_b128 v[32:35], v1 offset:18432
s_waitcnt lgkmcnt(7)
v_mfma_f32_16x16x32_bf16 v[8:11], v[36:39], v[92:95], v[8:11]
ds_read_b128 v[36:39], v1 offset:19456
s_waitcnt lgkmcnt(7)
v_mfma_f32_16x16x32_bf16 v[12:15], v[40:43], v[92:95], v[12:15]
ds_read_b128 v[40:43], v1 offset:25600
s_waitcnt lgkmcnt(7)
v_mfma_f32_16x16x32_bf16 v[16:19], v[44:47], v[92:95], v[16:19]
ds_read_b128 v[44:47], v1 offset:26624
s_waitcnt lgkmcnt(7)
v_mfma_f32_16x16x32_bf16 v[20:23], v[48:51], v[92:95], v[20:23]
ds_read_b128 v[48:51], v1 offset:27648
s_waitcnt vmcnt(20)
s_waitcnt lgkmcnt(7)
v_mfma_f32_16x16x32_bf16 v[4:7], v[52:55], v[96:99], v[4:7]
ds_read_b128 v[52:55], v1 offset:28672
s_waitcnt lgkmcnt(7)
v_mfma_f32_16x16x32_bf16 v[8:11], v[24:27], v[96:99], v[8:11]
ds_read_b128 v[24:27], v1 offset:29696
s_waitcnt lgkmcnt(7)
v_mfma_f32_16x16x32_bf16 v[12:15], v[28:31], v[96:99], v[12:15]
ds_read_b128 v[28:31], v1 offset:30720
s_waitcnt lgkmcnt(7)
v_mfma_f32_16x16x32_bf16 v[16:19], v[32:35], v[96:99], v[16:19]
ds_read_b128 v[32:35], v1 offset:31744
s_waitcnt lgkmcnt(7)
v_mfma_f32_16x16x32_bf16 v[20:23], v[36:39], v[96:99], v[20:23]
ds_read_b128 v[36:39], v1 offset:32768
s_waitcnt vmcnt(19)
s_waitcnt lgkmcnt(7)
v_mfma_f32_16x16x32_bf16 v[4:7], v[40:43], v[100:103], v[4:7]
ds_read_b128 v[40:43], v1 offset:33792
s_waitcnt lgkmcnt(7)
v_mfma_f32_16x16x32_bf16 v[8:11], v[44:47], v[100:103], v[8:11]
ds_read_b128 v[44:47], v1 offset:34816
s_waitcnt lgkmcnt(7)
v_mfma_f32_16x16x32_bf16 v[12:15], v[48:51], v[100:103], v[12:15]
ds_read_b128 v[48:51], v1 offset:35840
s_waitcnt lgkmcnt(7)
v_mfma_f32_16x16x32_bf16 v[16:19], v[52:55], v[100:103], v[16:19]
ds_read_b128 v[52:55], v1 offset:36864
s_waitcnt lgkmcnt(7)
v_mfma_f32_16x16x32_bf16 v[20:23], v[24:27], v[100:103], v[20:23]
ds_read_b128 v[24:27], v1 offset:37888
s_waitcnt vmcnt(18)
s_waitcnt lgkmcnt(7)
v_mfma_f32_16x16x32_bf16 v[4:7], v[28:31], v[104:107], v[4:7]
ds_read_b128 v[28:31], v1 offset:38912
s_waitcnt lgkmcnt(7)
v_mfma_f32_16x16x32_bf16 v[8:11], v[32:35], v[104:107], v[8:11]
ds_read_b128 v[32:35], v1 offset:39936
s_waitcnt lgkmcnt(7)
v_mfma_f32_16x16x32_bf16 v[12:15], v[36:39], v[104:107], v[12:15]
ds_read_b128 v[36:39], v1 offset:40960
s_waitcnt lgkmcnt(7)
v_mfma_f32_16x16x32_bf16 v[16:19], v[40:43], v[104:107], v[16:19]
ds_read_b128 v[40:43], v1 offset:41984
s_waitcnt lgkmcnt(7)
v_mfma_f32_16x16x32_bf16 v[20:23], v[44:47], v[104:107], v[20:23]
ds_read_b128 v[44:47], v1 offset:43008
s_waitcnt vmcnt(17)
s_waitcnt lgkmcnt(7)
v_mfma_f32_16x16x32_bf16 v[4:7], v[48:51], v[108:111], v[4:7]
ds_read_b128 v[48:51], v1 offset:44032
s_waitcnt lgkmcnt(7)
v_mfma_f32_16x16x32_bf16 v[8:11], v[52:55], v[108:111], v[8:11]
ds_read_b128 v[52:55], v1 offset:45056
s_waitcnt lgkmcnt(7)
v_mfma_f32_16x16x32_bf16 v[12:15], v[24:27], v[108:111], v[12:15]
ds_read_b128 v[24:27], v1 offset:51200
s_waitcnt lgkmcnt(7)
v_mfma_f32_16x16x32_bf16 v[16:19], v[28:31], v[108:111], v[16:19]
ds_read_b128 v[28:31], v1 offset:52224
s_waitcnt lgkmcnt(7)
v_mfma_f32_16x16x32_bf16 v[20:23], v[32:35], v[108:111], v[20:23]
ds_read_b128 v[32:35], v1 offset:53248
s_waitcnt vmcnt(16)
s_waitcnt lgkmcnt(7)
v_mfma_f32_16x16x32_bf16 v[4:7], v[36:39], v[112:115], v[4:7]
ds_read_b128 v[36:39], v1 offset:54272
s_waitcnt lgkmcnt(7)
v_mfma_f32_16x16x32_bf16 v[8:11], v[40:43], v[112:115], v[8:11]
ds_read_b128 v[40:43], v1 offset:55296
s_waitcnt lgkmcnt(7)
v_mfma_f32_16x16x32_bf16 v[12:15], v[44:47], v[112:115], v[12:15]
ds_read_b128 v[44:47], v1 offset:56320
s_waitcnt lgkmcnt(7)
v_mfma_f32_16x16x32_bf16 v[16:19], v[48:51], v[112:115], v[16:19]
ds_read_b128 v[48:51], v1 offset:57344
s_waitcnt lgkmcnt(7)
v_mfma_f32_16x16x32_bf16 v[20:23], v[52:55], v[112:115], v[20:23]
ds_read_b128 v[52:55], v1 offset:58368
s_waitcnt vmcnt(15)
s_waitcnt lgkmcnt(7)
v_mfma_f32_16x16x32_bf16 v[4:7], v[24:27], v[116:119], v[4:7]
ds_read_b128 v[24:27], v1 offset:59392
s_waitcnt lgkmcnt(7)
v_mfma_f32_16x16x32_bf16 v[8:11], v[28:31], v[116:119], v[8:11]
ds_read_b128 v[28:31], v1 offset:60416
s_waitcnt lgkmcnt(7)
v_mfma_f32_16x16x32_bf16 v[12:15], v[32:35], v[116:119], v[12:15]
ds_read_b128 v[32:35], v238 offset:0
s_waitcnt lgkmcnt(7)
v_mfma_f32_16x16x32_bf16 v[16:19], v[36:39], v[116:119], v[16:19]
ds_read_b128 v[36:39], v238 offset:1024
s_waitcnt lgkmcnt(7)
v_mfma_f32_16x16x32_bf16 v[20:23], v[40:43], v[116:119], v[20:23]
ds_read_b128 v[40:43], v238 offset:2048
s_waitcnt vmcnt(14)
s_waitcnt lgkmcnt(7)
v_mfma_f32_16x16x32_bf16 v[4:7], v[44:47], v[120:123], v[4:7]
ds_read_b128 v[44:47], v238 offset:3072
s_waitcnt lgkmcnt(7)
v_mfma_f32_16x16x32_bf16 v[8:11], v[48:51], v[120:123], v[8:11]
ds_read_b128 v[48:51], v238 offset:4096
s_waitcnt lgkmcnt(7)
v_mfma_f32_16x16x32_bf16 v[12:15], v[52:55], v[120:123], v[12:15]
ds_read_b128 v[52:55], v238 offset:5120
s_waitcnt lgkmcnt(7)
v_mfma_f32_16x16x32_bf16 v[16:19], v[24:27], v[120:123], v[16:19]
ds_read_b128 v[24:27], v238 offset:6144
s_waitcnt lgkmcnt(7)
v_mfma_f32_16x16x32_bf16 v[20:23], v[28:31], v[120:123], v[20:23]
ds_read_b128 v[28:31], v238 offset:7168
s_waitcnt vmcnt(13)
s_waitcnt lgkmcnt(7)
v_mfma_f32_16x16x32_bf16 v[4:7], v[32:35], v[124:127], v[4:7]
ds_read_b128 v[32:35], v238 offset:8192
s_waitcnt lgkmcnt(7)
v_mfma_f32_16x16x32_bf16 v[8:11], v[36:39], v[124:127], v[8:11]
ds_read_b128 v[36:39], v238 offset:9216
s_waitcnt lgkmcnt(7)
v_mfma_f32_16x16x32_bf16 v[12:15], v[40:43], v[124:127], v[12:15]
ds_read_b128 v[40:43], v238 offset:15360
s_waitcnt lgkmcnt(7)
v_mfma_f32_16x16x32_bf16 v[16:19], v[44:47], v[124:127], v[16:19]
ds_read_b128 v[44:47], v238 offset:16384
s_waitcnt lgkmcnt(7)
v_mfma_f32_16x16x32_bf16 v[20:23], v[48:51], v[124:127], v[20:23]
ds_read_b128 v[48:51], v238 offset:17408
s_waitcnt vmcnt(12)
s_waitcnt lgkmcnt(7)
v_mfma_f32_16x16x32_bf16 v[4:7], v[52:55], v[128:131], v[4:7]
ds_read_b128 v[52:55], v238 offset:18432
s_waitcnt lgkmcnt(7)
v_mfma_f32_16x16x32_bf16 v[8:11], v[24:27], v[128:131], v[8:11]
ds_read_b128 v[24:27], v238 offset:19456
s_waitcnt lgkmcnt(7)
v_mfma_f32_16x16x32_bf16 v[12:15], v[28:31], v[128:131], v[12:15]
ds_read_b128 v[28:31], v238 offset:20480
s_waitcnt lgkmcnt(7)
v_mfma_f32_16x16x32_bf16 v[16:19], v[32:35], v[128:131], v[16:19]
ds_read_b128 v[32:35], v238 offset:21504
s_waitcnt lgkmcnt(7)
v_mfma_f32_16x16x32_bf16 v[20:23], v[36:39], v[128:131], v[20:23]
ds_read_b128 v[36:39], v238 offset:22528
s_waitcnt vmcnt(11)
s_waitcnt lgkmcnt(7)
v_mfma_f32_16x16x32_bf16 v[4:7], v[40:43], v[132:135], v[4:7]
ds_read_b128 v[40:43], v238 offset:23552
s_waitcnt lgkmcnt(7)
v_mfma_f32_16x16x32_bf16 v[8:11], v[44:47], v[132:135], v[8:11]
ds_read_b128 v[44:47], v238 offset:24576
s_waitcnt lgkmcnt(7)
v_mfma_f32_16x16x32_bf16 v[12:15], v[48:51], v[132:135], v[12:15]
ds_read_b128 v[48:51], v238 offset:25600
s_waitcnt lgkmcnt(7)
v_mfma_f32_16x16x32_bf16 v[16:19], v[52:55], v[132:135], v[16:19]
ds_read_b128 v[52:55], v238 offset:26624
s_waitcnt lgkmcnt(7)
v_mfma_f32_16x16x32_bf16 v[20:23], v[24:27], v[132:135], v[20:23]
ds_read_b128 v[24:27], v238 offset:27648
s_waitcnt vmcnt(10)
s_waitcnt lgkmcnt(7)
v_mfma_f32_16x16x32_bf16 v[4:7], v[28:31], v[136:139], v[4:7]
ds_read_b128 v[28:31], v238 offset:28672
s_waitcnt lgkmcnt(7)
v_mfma_f32_16x16x32_bf16 v[8:11], v[32:35], v[136:139], v[8:11]
ds_read_b128 v[32:35], v238 offset:29696
s_waitcnt lgkmcnt(7)
v_mfma_f32_16x16x32_bf16 v[12:15], v[36:39], v[136:139], v[12:15]
ds_read_b128 v[36:39], v238 offset:30720
s_waitcnt lgkmcnt(7)
v_mfma_f32_16x16x32_bf16 v[16:19], v[40:43], v[136:139], v[16:19]
ds_read_b128 v[40:43], v238 offset:31744
s_waitcnt lgkmcnt(7)
v_mfma_f32_16x16x32_bf16 v[20:23], v[44:47], v[136:139], v[20:23]
ds_read_b128 v[44:47], v238 offset:32768
s_waitcnt vmcnt(9)
s_waitcnt lgkmcnt(7)
v_mfma_f32_16x16x32_bf16 v[4:7], v[48:51], v[140:143], v[4:7]
ds_read_b128 v[48:51], v238 offset:33792
s_waitcnt lgkmcnt(7)
v_mfma_f32_16x16x32_bf16 v[8:11], v[52:55], v[140:143], v[8:11]
ds_read_b128 v[52:55], v238 offset:34816
s_waitcnt lgkmcnt(7)
v_mfma_f32_16x16x32_bf16 v[12:15], v[24:27], v[140:143], v[12:15]
ds_read_b128 v[24:27], v1 offset:20480
s_waitcnt lgkmcnt(7)
v_mfma_f32_16x16x32_bf16 v[16:19], v[28:31], v[140:143], v[16:19]
ds_read_b128 v[28:31], v1 offset:21504
s_waitcnt lgkmcnt(7)
v_mfma_f32_16x16x32_bf16 v[20:23], v[32:35], v[140:143], v[20:23]
ds_read_b128 v[32:35], v1 offset:22528
s_waitcnt vmcnt(8)
s_waitcnt lgkmcnt(7)
v_mfma_f32_16x16x32_bf16 v[4:7], v[36:39], v[144:147], v[4:7]
ds_read_b128 v[36:39], v1 offset:23552
s_waitcnt lgkmcnt(7)
v_mfma_f32_16x16x32_bf16 v[8:11], v[40:43], v[144:147], v[8:11]
ds_read_b128 v[40:43], v1 offset:24576
s_waitcnt lgkmcnt(7)
v_mfma_f32_16x16x32_bf16 v[12:15], v[44:47], v[144:147], v[12:15]
ds_read_b128 v[44:47], v1 offset:46080
s_waitcnt lgkmcnt(7)
v_mfma_f32_16x16x32_bf16 v[16:19], v[48:51], v[144:147], v[16:19]
ds_read_b128 v[48:51], v1 offset:47104
s_waitcnt lgkmcnt(7)
v_mfma_f32_16x16x32_bf16 v[20:23], v[52:55], v[144:147], v[20:23]
ds_read_b128 v[52:55], v1 offset:48128
s_waitcnt vmcnt(6)
s_waitcnt lgkmcnt(7)
v_mfma_f32_16x16x32_bf16 v[4:7], v[24:27], v[148:151], v[4:7]
ds_read_b128 v[24:27], v1 offset:49152
s_waitcnt lgkmcnt(7)
v_mfma_f32_16x16x32_bf16 v[8:11], v[28:31], v[148:151], v[8:11]
ds_read_b128 v[28:31], v1 offset:50176
s_waitcnt lgkmcnt(7)
v_mfma_f32_16x16x32_bf16 v[12:15], v[32:35], v[148:151], v[12:15]
ds_read_b128 v[32:35], v238 offset:10240
s_waitcnt lgkmcnt(7)
v_mfma_f32_16x16x32_bf16 v[16:19], v[36:39], v[148:151], v[16:19]
ds_read_b128 v[36:39], v238 offset:11264
s_waitcnt lgkmcnt(7)
v_mfma_f32_16x16x32_bf16 v[20:23], v[40:43], v[148:151], v[20:23]
ds_read_b128 v[40:43], v238 offset:12288
s_waitcnt vmcnt(4)
s_waitcnt lgkmcnt(7)
v_mfma_f32_16x16x32_bf16 v[4:7], v[44:47], v[152:155], v[4:7]
ds_read_b128 v[44:47], v238 offset:13312
s_waitcnt lgkmcnt(7)
v_mfma_f32_16x16x32_bf16 v[8:11], v[48:51], v[152:155], v[8:11]
ds_read_b128 v[48:51], v238 offset:14336
s_waitcnt lgkmcnt(7)
v_mfma_f32_16x16x32_bf16 v[12:15], v[52:55], v[152:155], v[12:15]
ds_read_b128 v[52:55], v238 offset:35840
s_waitcnt lgkmcnt(7)
v_mfma_f32_16x16x32_bf16 v[16:19], v[24:27], v[152:155], v[16:19]
ds_read_b128 v[24:27], v238 offset:36864
s_waitcnt lgkmcnt(7)
v_mfma_f32_16x16x32_bf16 v[20:23], v[28:31], v[152:155], v[20:23]
ds_read_b128 v[28:31], v238 offset:37888
s_waitcnt vmcnt(2)
s_waitcnt lgkmcnt(7)
v_mfma_f32_16x16x32_bf16 v[4:7], v[32:35], v[156:159], v[4:7]
ds_read_b128 v[32:35], v238 offset:38912
s_waitcnt lgkmcnt(7)
v_mfma_f32_16x16x32_bf16 v[8:11], v[36:39], v[156:159], v[8:11]
ds_read_b128 v[36:39], v238 offset:39936
s_waitcnt lgkmcnt(7)
v_mfma_f32_16x16x32_bf16 v[12:15], v[40:43], v[156:159], v[12:15]
s_waitcnt lgkmcnt(6)
v_mfma_f32_16x16x32_bf16 v[16:19], v[44:47], v[156:159], v[16:19]
s_waitcnt lgkmcnt(5)
v_mfma_f32_16x16x32_bf16 v[20:23], v[48:51], v[156:159], v[20:23]
s_waitcnt vmcnt(0)
s_waitcnt lgkmcnt(4)
v_mfma_f32_16x16x32_bf16 v[4:7], v[52:55], v[160:163], v[4:7]
s_waitcnt lgkmcnt(3)
v_mfma_f32_16x16x32_bf16 v[8:11], v[24:27], v[160:163], v[8:11]
s_waitcnt lgkmcnt(2)
v_mfma_f32_16x16x32_bf16 v[12:15], v[28:31], v[160:163], v[12:15]
s_waitcnt lgkmcnt(1)
v_mfma_f32_16x16x32_bf16 v[16:19], v[32:35], v[160:163], v[16:19]
s_waitcnt lgkmcnt(0)
v_mfma_f32_16x16x32_bf16 v[20:23], v[36:39], v[160:163], v[20:23]
v_cvt_pk_bf16_f32 v24, v4, v5
v_cvt_pk_bf16_f32 v25, v6, v7
v_cvt_pk_bf16_f32 v26, v8, v9
v_cvt_pk_bf16_f32 v27, v10, v11
v_cvt_pk_bf16_f32 v28, v12, v13
v_cvt_pk_bf16_f32 v29, v14, v15
v_cvt_pk_bf16_f32 v30, v16, v17
v_cvt_pk_bf16_f32 v31, v18, v19
v_cvt_pk_bf16_f32 v32, v20, v21
v_cvt_pk_bf16_f32 v33, v22, v23
s_mul_i32 s24, s62, 20480
s_add_u32 s24, s24, 7725056
s_lshl_b32 s25, s21, 11
s_add_u32 s25, s25, s24
s_lshr_b32 s26, s21, 1
s_lshl_b32 s26, s26, 10
s_and_b32 s27, s21, 1
s_lshl_b32 s27, s27, 9
s_add_u32 s26, s26, s27
s_add_u32 s26, s26, 16384
s_add_u32 s26, s26, s24
s_cmp_eq_u32 s72, 0
s_cbranch_scc1 XS20
buffer_store_dwordx4 v[24:27], v1, s[4:7], s25 offen
s_branch XE21
XS20:
buffer_store_dwordx4 v[24:27], v1, s[4:7], s25 offen sc1
XE21:
s_cmp_eq_u32 s72, 0
s_cbranch_scc1 XS22
buffer_store_dwordx4 v[28:31], v1, s[4:7], s25 offen offset:1024
s_branch XE23
XS22:
buffer_store_dwordx4 v[28:31], v1, s[4:7], s25 offen offset:1024 sc1
XE23:
s_cmp_eq_u32 s72, 0
s_cbranch_scc1 XS24
buffer_store_dwordx2 v[32:33], v2, s[4:7], s26 offen
s_branch XE25
XS24:
buffer_store_dwordx2 v[32:33], v2, s[4:7], s26 offen sc1
XE25:
v_pk_mul_f32 v[36:37], v[4:5], v[4:5]
v_pk_add_f32 v[34:35], v[4:5], v[6:7]
v_pk_fma_f32 v[36:37], v[6:7], v[6:7], v[36:37]
v_pk_add_f32 v[34:35], v[34:35], v[8:9]
v_pk_fma_f32 v[36:37], v[8:9], v[8:9], v[36:37]
v_pk_add_f32 v[34:35], v[34:35], v[10:11]
v_pk_fma_f32 v[36:37], v[10:11], v[10:11], v[36:37]
v_pk_add_f32 v[34:35], v[34:35], v[12:13]
v_pk_fma_f32 v[36:37], v[12:13], v[12:13], v[36:37]
v_pk_add_f32 v[34:35], v[34:35], v[14:15]
v_pk_fma_f32 v[36:37], v[14:15], v[14:15], v[36:37]
v_pk_add_f32 v[34:35], v[34:35], v[16:17]
v_pk_fma_f32 v[36:37], v[16:17], v[16:17], v[36:37]
v_pk_add_f32 v[34:35], v[34:35], v[18:19]
v_pk_fma_f32 v[36:37], v[18:19], v[18:19], v[36:37]
v_pk_add_f32 v[34:35], v[34:35], v[20:21]
v_pk_fma_f32 v[36:37], v[20:21], v[20:21], v[36:37]
v_pk_add_f32 v[34:35], v[34:35], v[22:23]
v_pk_fma_f32 v[36:37], v[22:23], v[22:23], v[36:37]
v_add_f32 v34, v34, v35
v_add_f32 v35, v36, v37
v_mov_b32 v36, v34
v_mov_b32 v37, v35
s_nop 0
v_permlane32_swap_b32 v34, v36
v_permlane32_swap_b32 v35, v37
v_add_f32 v34, v34, v36
v_add_f32 v35, v35, v37
v_mov_b32 v36, v34
v_mov_b32 v37, v35
s_nop 0
v_permlane16_swap_b32 v34, v36
v_permlane16_swap_b32 v35, v37
v_add_f32 v34, v34, v36
v_add_f32 v35, v35, v37
s_lshl_b32 s24, s60, 9
s_lshl_b32 s25, s22, 7
s_add_u32 s24, s24, s25
s_add_u32 s24, s24, 13099008
s_mov_b64 exec, 0xffff
s_cmp_eq_u32 s72, 0
s_cbranch_scc1 XS26
buffer_store_dwordx2 v[34:35], v2, s[4:7], s24 offen
s_branch XE27
XS26:
buffer_store_dwordx2 v[34:35], v2, s[4:7], s24 offen sc1
XE27:
s_mov_b64 exec, -1
buffer_load_dwordx4 a[104:107], v1, s[4:7], s65 offen offset:3072
s_add_u32 s65, s65, 4096
buffer_load_dwordx4 a[108:111], v1, s[4:7], s65 offen
buffer_load_dwordx4 a[112:115], v1, s[4:7], s65 offen offset:1024
buffer_load_dwordx4 a[68:71], v1, s[4:7], s65 offen offset:2048
buffer_load_dwordx4 a[72:75], v1, s[4:7], s65 offen offset:3072
s_add_u32 s65, s65, 4096
buffer_load_dwordx4 a[76:79], v1, s[4:7], s65 offen
buffer_load_dwordx4 a[80:83], v1, s[4:7], s65 offen offset:1024
buffer_load_dwordx4 a[84:87], v1, s[4:7], s65 offen offset:2048
s_waitcnt vmcnt(8)
v_mov_b32 v3, 3
s_mov_b64 exec, 1
s_cmp_eq_u32 s72, 0
s_cbranch_scc1 XS28
buffer_store_dword v3, off, s[4:7], s23
s_branch XE29
XS28:
buffer_store_dword v3, off, s[4:7], s23 sc1
XE29:
s_mov_b64 exec, -1
s_mov_b32 s24, 30000
PL30:
buffer_load_dword v3, v236, s[4:7], 0 offen sc1
s_waitcnt vmcnt(0)
v_cmp_gt_u32 vcc, 3, v3
s_sub_u32 s24, s24, 1
s_cbranch_scc1 PD31
s_cbranch_vccnz PL30
PD31:
s_mul_i32 s24, s22, 14
s_cmp_eq_u32 s22, 3
s_cselect_b32 s24, 41, s24
s_mov_b32 s67, s24
s_mul_i32 s25, s68, 54
s_add_u32 s24, s24, s25
s_mul_i32 s24, s24, 5120
s_add_u32 s66, s24, 5488640
s_add_u32 s24, s63, 0
s_min_u32 s24, s24, 53
s_lshl_b32 s25, s24, 6
s_lshl_b32 s24, s24, 7
s_add_u32 s24, s24, 7708672
v_lshlrev_b32 v3, 4, v240
v_lshlrev_b32 v228, 3, v240
buffer_load_dwordx4 v[176:179], v3, s[4:7], s24 offen offset:0
buffer_load_dwordx2 v[184:185], v228, s[12:15], s25 offen offset:0
buffer_load_dwordx4 v[180:183], v3, s[4:7], s24 offen offset:64
buffer_load_dwordx2 v[188:189], v228, s[12:15], s25 offen offset:32
s_add_u32 s24, s63, 1
s_min_u32 s24, s24, 53
s_lshl_b32 s25, s24, 6
s_lshl_b32 s24, s24, 7
s_add_u32 s24, s24, 7708672
v_lshlrev_b32 v3, 4, v240
v_lshlrev_b32 v228, 3, v240
buffer_load_dwordx4 v[192:195], v3, s[4:7], s24 offen offset:0
buffer_load_dwordx2 v[200:201], v228, s[12:15], s25 offen offset:0
buffer_load_dwordx4 v[196:199], v3, s[4:7], s24 offen offset:64
buffer_load_dwordx2 v[204:205], v228, s[12:15], s25 offen offset:32
s_lshl_b32 s26, s60, 9
s_and_b32 s26, s26, 0xfffff000
s_lshl_b32 s27, s22, 7
s_add_u32 s26, s26, s27
s_add_u32 s26, s26, 13099008
v_lshrrev_b32 v24, 3, v0
v_lshlrev_b32 v24, 9, v24
v_and_b32 v25, 7, v0
v_lshlrev_b32 v25, 4, v25
v_add_u32 v24, v24, v25
buffer_load_dwordx4 v[28:31], v24, s[4:7], s26 offen
s_mul_i32 s69, s62, 20480
s_add_u32 s69, s69, 7725056
s_mul_i32 s70, s22, 20480
s_mov_b32 m0, s70
s_nop 0
buffer_load_dwordx4 v1, s[4:7], s69 offen offset:0 sc1 lds
s_mov_b32 m0, s70
s_nop 0
buffer_load_dwordx4 v1, s[4:7], s69 offen offset:1024 sc1 lds
s_mov_b32 m0, s70
s_nop 0
buffer_load_dwordx4 v1, s[4:7], s69 offen offset:2048 sc1 lds
s_mov_b32 m0, s70
s_nop 0
buffer_load_dwordx4 v1, s[4:7], s69 offen offset:3072 sc1 lds
s_add_u32 s69, s69, 4096
s_add_u32 s70, s70, 4096
s_mov_b32 m0, s70
s_nop 0
buffer_load_dwordx4 v1, s[4:7], s69 offen offset:0 sc1 lds
s_mov_b32 m0, s70
s_nop 0
buffer_load_dwordx4 v1, s[4:7], s69 offen offset:1024 sc1 lds
s_mov_b32 m0, s70
s_nop 0
buffer_load_dwordx4 v1, s[4:7], s69 offen offset:2048 sc1 lds
s_mov_b32 m0, s70
s_nop 0
buffer_load_dwordx4 v1, s[4:7], s69 offen offset:3072 sc1 lds
s_add_u32 s69, s69, 4096
s_add_u32 s70, s70, 4096
s_mov_b32 m0, s70
s_nop 0
buffer_load_dwordx4 v1, s[4:7], s69 offen offset:0 sc1 lds
s_mov_b32 m0, s70
s_nop 0
buffer_load_dwordx4 v1, s[4:7], s69 offen offset:1024 sc1 lds
s_waitcnt vmcnt(10)
v_mov_b32 v32, v28
v_mov_b32 v33, v29
v_mov_b32 v34, v30
v_mov_b32 v35, v31
v_permlane32_swap_b32 v28, v32
v_permlane32_swap_b32 v29, v33
v_permlane32_swap_b32 v30, v34
v_permlane32_swap_b32 v31, v35
v_add_f32 v28, v28, v32
v_add_f32 v29, v29, v33
v_add_f32 v30, v30, v34
v_add_f32 v31, v31, v35
v_mov_b32 v32, v28
v_mov_b32 v33, v29
v_mov_b32 v34, v30
v_mov_b32 v35, v31
v_permlane16_swap_b32 v28, v32
v_permlane16_swap_b32 v29, v33
v_permlane16_swap_b32 v30, v34
v_permlane16_swap_b32 v31, v35
v_add_f32 v28, v28, v32
v_add_f32 v29, v29, v33
v_add_f32 v30, v30, v34
v_add_f32 v31, v31, v35
v_add_f32_dpp v28, v28, v28 row_ror:8 row_mask:0xf bank_mask:0xf
v_add_f32_dpp v29, v29, v29 row_ror:8 row_mask:0xf bank_mask:0xf
v_add_f32_dpp v30, v30, v30 row_ror:8 row_mask:0xf bank_mask:0xf
v_add_f32_dpp v31, v31, v31 row_ror:8 row_mask:0xf bank_mask:0xf
s_mov_b32 s26, 0xbacccccd
s_mov_b32 s27, 0x3acccccd
v_mul_f32 v32, s26, v28
v_mul_f32 v33, s26, v30
v_mul_f32 v34, s27, v29
v_mul_f32 v35, s27, v31
v_fma_f32 v34, -v32, v32, v34
v_fma_f32 v35, -v33, v33, v35
v_max_f32 v34, 0, v34
v_max_f32 v35, 0, v35
v_add_f32 v34, 0x3727c5ac, v34
v_add_f32 v35, 0x3727c5ac, v35
v_rsq_f32 v34, v34
v_rsq_f32 v35, v35
v_and_b32 v24, 7, v0
v_lshlrev_b32 v24, 3, v24
s_lshl_b32 s26, s22, 6
s_add_u32 s26, s26, 102400
v_add_u32 v24, s26, v24
s_mov_b64 exec, 0xff
ds_write_b64 v24, v[32:33]
ds_write_b64 v24, v[34:35] offset:256
s_mov_b64 exec, -1
s_cmp_lt_u32 s22, 3
s_cbranch_scc1 FK33
s_cmp_lt_u32 s21, 6
s_cbranch_scc1 FK34
s_branch FK35
FK33:
v_and_b32 v187, 0xffff0000, v185
v_lshlrev_b32 v186, 16, v185
v_and_b32 v185, 0xffff0000, v184
v_lshlrev_b32 v184, 16, v184
v_and_b32 v191, 0xffff0000, v189
v_lshlrev_b32 v190, 16, v189
v_and_b32 v189, 0xffff0000, v188
v_lshlrev_b32 v188, 16, v188
s_waitcnt vmcnt(5)
s_waitcnt lgkmcnt(0)
s_barrier
ds_read_b128 v[24:27], v1 offset:0
ds_read_b128 v[28:31], v1 offset:20480
ds_read_b128 v[32:35], v1 offset:40960
ds_read_b128 v[36:39], v238 offset:0
s_waitcnt lgkmcnt(3)
v_mfma_f32_16x16x32_bf16 v[56:59], a[120:123], v[24:27], 0
ds_read_b128 v[40:43], v1 offset:1024
s_waitcnt lgkmcnt(3)
v_mfma_f32_16x16x32_bf16 v[60:63], a[120:123], v[28:31], 0
ds_read_b128 v[44:47], v1 offset:21504
s_waitcnt lgkmcnt(3)
v_mfma_f32_16x16x32_bf16 v[64:67], a[120:123], v[32:35], 0
ds_read_b128 v[48:51], v1 offset:41984
s_waitcnt lgkmcnt(3)
v_mfma_f32_16x16x32_bf16 v[68:71], a[120:123], v[36:39], 0
ds_read_b128 v[52:55], v238 offset:1024
v_mfma_f32_16x16x32_bf16 v[72:75], a[124:127], v[24:27], 0
s_mov_b32 m0, s70
s_nop 0
buffer_load_dwordx4 v1, s[4:7], s69 offen offset:2048 sc1 lds
v_mfma_f32_16x16x32_bf16 v[76:79], a[124:127], v[28:31], 0
buffer_load_dwordx4 a[88:91], v1, s[4:7], s65 offen offset:3072
v_mfma_f32_16x16x32_bf16 v[80:83], a[124:127], v[32:35], 0
s_add_u32 s65, s65, 4096
buffer_load_dwordx4 a[92:95], v1, s[4:7], s65 offen
v_mfma_f32_16x16x32_bf16 v[84:87], a[124:127], v[36:39], 0
buffer_load_dwordx4 a[96:99], v1, s[4:7], s65 offen offset:1024
s_waitcnt lgkmcnt(3)
v_mfma_f32_16x16x32_bf16 v[56:59], a[128:131], v[40:43], v[56:59]
ds_read_b128 v[24:27], v1 offset:2048
s_waitcnt lgkmcnt(3)
v_mfma_f32_16x16x32_bf16 v[60:63], a[128:131], v[44:47], v[60:63]
ds_read_b128 v[28:31], v1 offset:22528
s_waitcnt lgkmcnt(3)
v_mfma_f32_16x16x32_bf16 v[64:67], a[128:131], v[48:51], v[64:67]
ds_read_b128 v[32:35], v1 offset:43008
s_waitcnt lgkmcnt(3)
v_mfma_f32_16x16x32_bf16 v[68:71], a[128:131], v[52:55], v[68:71]
ds_read_b128 v[36:39], v238 offset:2048
v_mfma_f32_16x16x32_bf16 v[72:75], a[132:135], v[40:43], v[72:75]
s_mov_b32 m0, s70
s_nop 0
buffer_load_dwordx4 v1, s[4:7], s69 offen offset:3072 sc1 lds
v_mfma_f32_16x16x32_bf16 v[76:79], a[132:135], v[44:47], v[76:79]
buffer_load_dwordx4 a[100:103], v1, s[4:7], s65 offen offset:2048
v_mfma_f32_16x16x32_bf16 v[80:83], a[132:135], v[48:51], v[80:83]
buffer_load_dwordx4 a[116:119], v1, s[4:7], s65 offen offset:3072
v_mfma_f32_16x16x32_bf16 v[84:87], a[132:135], v[52:55], v[84:87]
s_add_u32 s65, s65, 4096
buffer_load_dwordx4 a[120:123], v1, s[4:7], s65 offen
s_waitcnt lgkmcnt(3)
v_mfma_f32_16x16x32_bf16 v[56:59], a[136:139], v[24:27], v[56:59]
ds_read_b128 v[40:43], v1 offset:3072
s_waitcnt lgkmcnt(3)
v_mfma_f32_16x16x32_bf16 v[60:63], a[136:139], v[28:31], v[60:63]
ds_read_b128 v[44:47], v1 offset:23552
s_waitcnt lgkmcnt(3)
v_mfma_f32_16x16x32_bf16 v[64:67], a[136:139], v[32:35], v[64:67]
ds_read_b128 v[48:51], v1 offset:44032
s_waitcnt lgkmcnt(3)
v_mfma_f32_16x16x32_bf16 v[68:71], a[136:139], v[36:39], v[68:71]
ds_read_b128 v[52:55], v238 offset:3072
v_mfma_f32_16x16x32_bf16 v[72:75], a[140:143], v[24:27], v[72:75]
s_add_u32 s69, s69, 4096
s_add_u32 s70, s70, 4096
s_mov_b32 m0, s70
s_nop 0
buffer_load_dwordx4 v1, s[4:7], s69 offen offset:0 sc1 lds
v_mfma_f32_16x16x32_bf16 v[76:79], a[140:143], v[28:31], v[76:79]
buffer_load_dwordx4 a[124:127], v1, s[4:7], s65 offen offset:1024
v_mfma_f32_16x16x32_bf16 v[80:83], a[140:143], v[32:35], v[80:83]
buffer_load_dwordx4 a[128:131], v1, s[4:7], s65 offen offset:2048
v_mfma_f32_16x16x32_bf16 v[84:87], a[140:143], v[36:39], v[84:87]
buffer_load_dwordx4 a[132:135], v1, s[4:7], s65 offen offset:3072
s_waitcnt lgkmcnt(3)
v_mfma_f32_16x16x32_bf16 v[56:59], a[144:147], v[40:43], v[56:59]
ds_read_b128 v[24:27], v1 offset:4096
s_waitcnt lgkmcnt(3)
v_mfma_f32_16x16x32_bf16 v[60:63], a[144:147], v[44:47], v[60:63]
ds_read_b128 v[28:31], v1 offset:24576
s_waitcnt lgkmcnt(3)
v_mfma_f32_16x16x32_bf16 v[64:67], a[144:147], v[48:51], v[64:67]
ds_read_b128 v[32:35], v1 offset:45056
s_waitcnt lgkmcnt(3)
v_mfma_f32_16x16x32_bf16 v[68:71], a[144:147], v[52:55], v[68:71]
ds_read_b128 v[36:39], v238 offset:4096
v_mfma_f32_16x16x32_bf16 v[72:75], a[148:151], v[40:43], v[72:75]
s_mov_b32 m0, s70
s_nop 0
buffer_load_dwordx4 v1, s[4:7], s69 offen offset:1024 sc1 lds
v_mfma_f32_16x16x32_bf16 v[76:79], a[148:151], v[44:47], v[76:79]
s_add_u32 s65, s65, 4096
buffer_load_dwordx4 a[136:139], v1, s[4:7], s65 offen
v_mfma_f32_16x16x32_bf16 v[80:83], a[148:151], v[48:51], v[80:83]
buffer_load_dwordx4 a[140:143], v1, s[4:7], s65 offen offset:1024
v_mfma_f32_16x16x32_bf16 v[84:87], a[148:151], v[52:55], v[84:87]
buffer_load_dwordx4 a[144:147], v1, s[4:7], s65 offen offset:2048
s_waitcnt vmcnt(16)
s_barrier
s_waitcnt lgkmcnt(3)
v_mfma_f32_16x16x32_bf16 v[56:59], a[152:155], v[24:27], v[56:59]
ds_read_b128 v[40:43], v1 offset:5120
s_waitcnt lgkmcnt(3)
v_mfma_f32_16x16x32_bf16 v[60:63], a[152:155], v[28:31], v[60:63]
ds_read_b128 v[44:47], v1 offset:25600
s_waitcnt lgkmcnt(3)
v_mfma_f32_16x16x32_bf16 v[64:67], a[152:155], v[32:35], v[64:67]
ds_read_b128 v[48:51], v1 offset:46080
s_waitcnt lgkmcnt(3)
v_mfma_f32_16x16x32_bf16 v[68:71], a[152:155], v[36:39], v[68:71]
ds_read_b128 v[52:55], v238 offset:5120
v_mfma_f32_16x16x32_bf16 v[72:75], a[156:159], v[24:27], v[72:75]
s_mov_b32 m0, s70
s_nop 0
buffer_load_dwordx4 v1, s[4:7], s69 offen offset:2048 sc1 lds
v_mfma_f32_16x16x32_bf16 v[76:79], a[156:159], v[28:31], v[76:79]
buffer_load_dwordx4 a[148:151], v1, s[4:7], s65 offen offset:3072
v_mfma_f32_16x16x32_bf16 v[80:83], a[156:159], v[32:35], v[80:83]
s_add_u32 s65, s65, 4096
buffer_load_dwordx4 a[152:155], v1, s[4:7], s65 offen
v_mfma_f32_16x16x32_bf16 v[84:87], a[156:159], v[36:39], v[84:87]
buffer_load_dwordx4 a[156:159], v1, s[4:7], s65 offen offset:1024
s_waitcnt lgkmcnt(3)
v_mfma_f32_16x16x32_bf16 v[56:59], a[160:163], v[40:43], v[56:59]
ds_read_b128 v[24:27], v1 offset:6144
s_waitcnt lgkmcnt(3)
v_mfma_f32_16x16x32_bf16 v[60:63], a[160:163], v[44:47], v[60:63]
ds_read_b128 v[28:31], v1 offset:26624
s_waitcnt lgkmcnt(3)
v_mfma_f32_16x16x32_bf16 v[64:67], a[160:163], v[48:51], v[64:67]
ds_read_b128 v[32:35], v1 offset:47104
s_waitcnt lgkmcnt(3)
v_mfma_f32_16x16x32_bf16 v[68:71], a[160:163], v[52:55], v[68:71]
ds_read_b128 v[36:39], v238 offset:6144
v_mfma_f32_16x16x32_bf16 v[72:75], a[164:167], v[40:43], v[72:75]
s_mov_b32 m0, s70
s_nop 0
buffer_load_dwordx4 v1, s[4:7], s69 offen offset:3072 sc1 lds
v_mfma_f32_16x16x32_bf16 v[76:79], a[164:167], v[44:47], v[76:79]
buffer_load_dwordx4 a[160:163], v1, s[4:7], s65 offen offset:2048
v_mfma_f32_16x16x32_bf16 v[80:83], a[164:167], v[48:51], v[80:83]
v_mfma_f32_16x16x32_bf16 v[84:87], a[164:167], v[52:55], v[84:87]
buffer_load_dwordx4 a[164:167], v1, s[4:7], s65 offen offset:3072
s_waitcnt lgkmcnt(3)
v_mfma_f32_16x16x32_bf16 v[56:59], a[168:171], v[24:27], v[56:59]
ds_read_b128 v[40:43], v1 offset:7168
s_waitcnt lgkmcnt(3)
v_mfma_f32_16x16x32_bf16 v[60:63], a[168:171], v[28:31], v[60:63]
ds_read_b128 v[44:47], v1 offset:27648
s_waitcnt lgkmcnt(3)
v_mfma_f32_16x16x32_bf16 v[64:67], a[168:171], v[32:35], v[64:67]
ds_read_b128 v[48:51], v1 offset:48128
s_waitcnt lgkmcnt(3)
v_mfma_f32_16x16x32_bf16 v[68:71], a[168:171], v[36:39], v[68:71]
ds_read_b128 v[52:55], v238 offset:7168
v_mfma_f32_16x16x32_bf16 v[72:75], a[172:175], v[24:27], v[72:75]
s_add_u32 s69, s69, 4096
s_add_u32 s70, s70, 4096
s_mov_b32 m0, s70
s_nop 0
buffer_load_dwordx4 v1, s[4:7], s69 offen offset:0 sc1 lds
v_mfma_f32_16x16x32_bf16 v[76:79], a[172:175], v[28:31], v[76:79]
s_add_u32 s65, s65, 4096
buffer_load_dwordx4 a[168:171], v1, s[4:7], s65 offen
v_mfma_f32_16x16x32_bf16 v[80:83], a[172:175], v[32:35], v[80:83]
v_mfma_f32_16x16x32_bf16 v[84:87], a[172:175], v[36:39], v[84:87]
buffer_load_dwordx4 a[172:175], v1, s[4:7], s65 offen offset:1024
s_waitcnt lgkmcnt(3)
v_mfma_f32_16x16x32_bf16 v[56:59], a[176:179], v[40:43], v[56:59]
ds_read_b128 v[24:27], v1 offset:8192
s_waitcnt lgkmcnt(3)
v_mfma_f32_16x16x32_bf16 v[60:63], a[176:179], v[44:47], v[60:63]
ds_read_b128 v[28:31], v1 offset:28672
s_waitcnt lgkmcnt(3)
v_mfma_f32_16x16x32_bf16 v[64:67], a[176:179], v[48:51], v[64:67]
ds_read_b128 v[32:35], v1 offset:49152
s_waitcnt lgkmcnt(3)
v_mfma_f32_16x16x32_bf16 v[68:71], a[176:179], v[52:55], v[68:71]
ds_read_b128 v[36:39], v238 offset:8192
v_mfma_f32_16x16x32_bf16 v[72:75], a[180:183], v[40:43], v[72:75]
s_mov_b32 m0, s70
s_nop 0
buffer_load_dwordx4 v1, s[4:7], s69 offen offset:1024 sc1 lds
v_mfma_f32_16x16x32_bf16 v[76:79], a[180:183], v[44:47], v[76:79]
buffer_load_dwordx4 a[176:179], v1, s[4:7], s65 offen offset:2048
v_mfma_f32_16x16x32_bf16 v[80:83], a[180:183], v[48:51], v[80:83]
v_mfma_f32_16x16x32_bf16 v[84:87], a[180:183], v[52:55], v[84:87]
buffer_load_dwordx4 a[180:183], v1, s[4:7], s65 offen offset:3072
s_waitcnt lgkmcnt(3)
v_mfma_f32_16x16x32_bf16 v[56:59], a[184:187], v[24:27], v[56:59]
ds_read_b128 v[40:43], v1 offset:9216
s_waitcnt lgkmcnt(3)
v_mfma_f32_16x16x32_bf16 v[60:63], a[184:187], v[28:31], v[60:63]
ds_read_b128 v[44:47], v1 offset:29696
s_waitcnt lgkmcnt(3)
v_mfma_f32_16x16x32_bf16 v[64:67], a[184:187], v[32:35], v[64:67]
ds_read_b128 v[48:51], v1 offset:50176
s_waitcnt lgkmcnt(3)
v_mfma_f32_16x16x32_bf16 v[68:71], a[184:187], v[36:39], v[68:71]
ds_read_b128 v[52:55], v238 offset:9216
v_mfma_f32_16x16x32_bf16 v[72:75], a[188:191], v[24:27], v[72:75]
s_mov_b32 m0, s70
s_nop 0
buffer_load_dwordx4 v1, s[4:7], s69 offen offset:2048 sc1 lds
v_mfma_f32_16x16x32_bf16 v[76:79], a[188:191], v[28:31], v[76:79]
buffer_load_dwordx4 a[184:187], v1, s[4:7], s66 offen
v_mfma_f32_16x16x32_bf16 v[80:83], a[188:191], v[32:35], v[80:83]
v_mfma_f32_16x16x32_bf16 v[84:87], a[188:191], v[36:39], v[84:87]
buffer_load_dwordx4 a[188:191], v1, s[4:7], s66 offen offset:1024
s_waitcnt vmcnt(15)
s_barrier
s_waitcnt lgkmcnt(3)
v_mfma_f32_16x16x32_bf16 v[56:59], a[192:195], v[40:43], v[56:59]
ds_read_b128 v[24:27], v1 offset:10240
s_waitcnt lgkmcnt(3)
v_mfma_f32_16x16x32_bf16 v[60:63], a[192:195], v[44:47], v[60:63]
ds_read_b128 v[28:31], v1 offset:30720
s_waitcnt lgkmcnt(3)
v_mfma_f32_16x16x32_bf16 v[64:67], a[192:195], v[48:51], v[64:67]
ds_read_b128 v[32:35], v1 offset:51200
s_waitcnt lgkmcnt(3)
v_mfma_f32_16x16x32_bf16 v[68:71], a[192:195], v[52:55], v[68:71]
ds_read_b128 v[36:39], v238 offset:10240
v_mfma_f32_16x16x32_bf16 v[72:75], a[196:199], v[40:43], v[72:75]
s_mov_b32 m0, s70
s_nop 0
buffer_load_dwordx4 v1, s[4:7], s69 offen offset:3072 sc1 lds
v_mfma_f32_16x16x32_bf16 v[76:79], a[196:199], v[44:47], v[76:79]
buffer_load_dwordx4 a[192:195], v1, s[4:7], s66 offen offset:2048
v_mfma_f32_16x16x32_bf16 v[80:83], a[196:199], v[48:51], v[80:83]
v_mfma_f32_16x16x32_bf16 v[84:87], a[196:199], v[52:55], v[84:87]
buffer_load_dwordx4 a[196:199], v1, s[4:7], s66 offen offset:3072
s_waitcnt lgkmcnt(3)
v_mfma_f32_16x16x32_bf16 v[56:59], a[200:203], v[24:27], v[56:59]
ds_read_b128 v[40:43], v1 offset:11264
s_waitcnt lgkmcnt(3)
v_mfma_f32_16x16x32_bf16 v[60:63], a[200:203], v[28:31], v[60:63]
ds_read_b128 v[44:47], v1 offset:31744
s_waitcnt lgkmcnt(3)
v_mfma_f32_16x16x32_bf16 v[64:67], a[200:203], v[32:35], v[64:67]
ds_read_b128 v[48:51], v1 offset:52224
s_waitcnt lgkmcnt(3)
v_mfma_f32_16x16x32_bf16 v[68:71], a[200:203], v[36:39], v[68:71]
ds_read_b128 v[52:55], v238 offset:11264
v_mfma_f32_16x16x32_bf16 v[72:75], a[204:207], v[24:27], v[72:75]
v_mfma_f32_16x16x32_bf16 v[76:79], a[204:207], v[28:31], v[76:79]
s_add_u32 s66, s66, 4096
buffer_load_dwordx4 a[200:203], v1, s[4:7], s66 offen
v_mfma_f32_16x16x32_bf16 v[80:83], a[204:207], v[32:35], v[80:83]
v_mfma_f32_16x16x32_bf16 v[84:87], a[204:207], v[36:39], v[84:87]
buffer_load_dwordx4 a[204:207], v1, s[4:7], s66 offen offset:1024
s_waitcnt lgkmcnt(3)
v_mfma_f32_16x16x32_bf16 v[56:59], a[208:211], v[40:43], v[56:59]
ds_read_b128 v[24:27], v1 offset:12288
s_waitcnt lgkmcnt(3)
v_mfma_f32_16x16x32_bf16 v[60:63], a[208:211], v[44:47], v[60:63]
ds_read_b128 v[28:31], v1 offset:32768
s_waitcnt lgkmcnt(3)
v_mfma_f32_16x16x32_bf16 v[64:67], a[208:211], v[48:51], v[64:67]
ds_read_b128 v[32:35], v1 offset:53248
s_waitcnt lgkmcnt(3)
v_mfma_f32_16x16x32_bf16 v[68:71], a[208:211], v[52:55], v[68:71]
ds_read_b128 v[36:39], v238 offset:12288
v_mfma_f32_16x16x32_bf16 v[72:75], a[212:215], v[40:43], v[72:75]
v_mfma_f32_16x16x32_bf16 v[76:79], a[212:215], v[44:47], v[76:79]
buffer_load_dwordx4 a[208:211], v1, s[4:7], s66 offen offset:2048
v_mfma_f32_16x16x32_bf16 v[80:83], a[212:215], v[48:51], v[80:83]
v_mfma_f32_16x16x32_bf16 v[84:87], a[212:215], v[52:55], v[84:87]
buffer_load_dwordx4 a[212:215], v1, s[4:7], s66 offen offset:3072
s_waitcnt lgkmcnt(3)
v_mfma_f32_16x16x32_bf16 v[56:59], a[216:219], v[24:27], v[56:59]
ds_read_b128 v[40:43], v1 offset:13312
s_waitcnt lgkmcnt(3)
v_mfma_f32_16x16x32_bf16 v[60:63], a[216:219], v[28:31], v[60:63]
ds_read_b128 v[44:47], v1 offset:33792
s_waitcnt lgkmcnt(3)
v_mfma_f32_16x16x32_bf16 v[64:67], a[216:219], v[32:35], v[64:67]
ds_read_b128 v[48:51], v1 offset:54272
s_waitcnt lgkmcnt(3)
v_mfma_f32_16x16x32_bf16 v[68:71], a[216:219], v[36:39], v[68:71]
ds_read_b128 v[52:55], v238 offset:13312
v_mfma_f32_16x16x32_bf16 v[72:75], a[220:223], v[24:27], v[72:75]
v_mfma_f32_16x16x32_bf16 v[76:79], a[220:223], v[28:31], v[76:79]
s_add_u32 s66, s66, 4096
buffer_load_dwordx4 a[216:219], v1, s[4:7], s66 offen
v_mfma_f32_16x16x32_bf16 v[80:83], a[220:223], v[32:35], v[80:83]
v_mfma_f32_16x16x32_bf16 v[84:87], a[220:223], v[36:39], v[84:87]
buffer_load_dwordx4 a[220:223], v1, s[4:7], s66 offen offset:1024
s_waitcnt lgkmcnt(3)
v_mfma_f32_16x16x32_bf16 v[56:59], a[224:227], v[40:43], v[56:59]
ds_read_b128 v[24:27], v1 offset:14336
s_waitcnt lgkmcnt(3)
v_mfma_f32_16x16x32_bf16 v[60:63], a[224:227], v[44:47], v[60:63]
ds_read_b128 v[28:31], v1 offset:34816
s_waitcnt lgkmcnt(3)
v_mfma_f32_16x16x32_bf16 v[64:67], a[224:227], v[48:51], v[64:67]
ds_read_b128 v[32:35], v1 offset:55296
s_waitcnt lgkmcnt(3)
v_mfma_f32_16x16x32_bf16 v[68:71], a[224:227], v[52:55], v[68:71]
ds_read_b128 v[36:39], v238 offset:14336
v_mfma_f32_16x16x32_bf16 v[72:75], a[228:231], v[40:43], v[72:75]
v_mfma_f32_16x16x32_bf16 v[76:79], a[228:231], v[44:47], v[76:79]
buffer_load_dwordx4 a[224:227], v1, s[4:7], s66 offen offset:2048
v_mfma_f32_16x16x32_bf16 v[80:83], a[228:231], v[48:51], v[80:83]
v_mfma_f32_16x16x32_bf16 v[84:87], a[228:231], v[52:55], v[84:87]
buffer_load_dwordx4 a[228:231], v1, s[4:7], s66 offen offset:3072
s_waitcnt vmcnt(10)
s_barrier
s_waitcnt lgkmcnt(3)
v_mfma_f32_16x16x32_bf16 v[56:59], a[232:235], v[24:27], v[56:59]
ds_read_b128 v[40:43], v1 offset:15360
s_waitcnt lgkmcnt(3)
v_mfma_f32_16x16x32_bf16 v[60:63], a[232:235], v[28:31], v[60:63]
ds_read_b128 v[44:47], v1 offset:35840
s_waitcnt lgkmcnt(3)
v_mfma_f32_16x16x32_bf16 v[64:67], a[232:235], v[32:35], v[64:67]
ds_read_b128 v[48:51], v1 offset:56320
s_waitcnt lgkmcnt(3)
v_mfma_f32_16x16x32_bf16 v[68:71], a[232:235], v[36:39], v[68:71]
ds_read_b128 v[52:55], v238 offset:15360
v_mfma_f32_16x16x32_bf16 v[72:75], a[236:239], v[24:27], v[72:75]
v_mfma_f32_16x16x32_bf16 v[76:79], a[236:239], v[28:31], v[76:79]
s_add_u32 s66, s66, 4096
buffer_load_dwordx4 a[232:235], v1, s[4:7], s66 offen
v_mfma_f32_16x16x32_bf16 v[80:83], a[236:239], v[32:35], v[80:83]
v_mfma_f32_16x16x32_bf16 v[84:87], a[236:239], v[36:39], v[84:87]
buffer_load_dwordx4 a[236:239], v1, s[4:7], s66 offen offset:1024
s_waitcnt lgkmcnt(3)
v_mfma_f32_16x16x32_bf16 v[56:59], a[240:243], v[40:43], v[56:59]
ds_read_b64 v[24:25], v2 offset:16384
ds_read_b64 v[26:27], v2 offset:16896
s_waitcnt lgkmcnt(4)
v_mfma_f32_16x16x32_bf16 v[60:63], a[240:243], v[44:47], v[60:63]
ds_read_b64 v[28:29], v2 offset:36864
ds_read_b64 v[30:31], v2 offset:37376
s_waitcnt lgkmcnt(5)
v_mfma_f32_16x16x32_bf16 v[64:67], a[240:243], v[48:51], v[64:67]
ds_read_b64 v[32:33], v2 offset:57344
ds_read_b64 v[34:35], v2 offset:57856
s_waitcnt lgkmcnt(6)
v_mfma_f32_16x16x32_bf16 v[68:71], a[240:243], v[52:55], v[68:71]
ds_read_b64 v[36:37], v239 offset:16384
ds_read_b64 v[38:39], v239 offset:16896
v_mfma_f32_16x16x32_bf16 v[72:75], a[244:247], v[40:43], v[72:75]
v_mfma_f32_16x16x32_bf16 v[76:79], a[244:247], v[44:47], v[76:79]
buffer_load_dwordx4 a[240:243], v1, s[4:7], s66 offen offset:2048
v_mfma_f32_16x16x32_bf16 v[80:83], a[244:247], v[48:51], v[80:83]
v_mfma_f32_16x16x32_bf16 v[84:87], a[244:247], v[52:55], v[84:87]
buffer_load_dwordx4 a[244:247], v1, s[4:7], s66 offen offset:3072
s_waitcnt lgkmcnt(6)
v_mfma_f32_16x16x32_bf16 v[56:59], a[248:251], v[24:27], v[56:59]
ds_read_b64 v[40:41], v2 offset:17408
ds_read_b64 v[42:43], v2 offset:17920
s_waitcnt lgkmcnt(6)
v_mfma_f32_16x16x32_bf16 v[60:63], a[248:251], v[28:31], v[60:63]
ds_read_b64 v[44:45], v2 offset:37888
ds_read_b64 v[46:47], v2 offset:38400
s_waitcnt lgkmcnt(6)
v_mfma_f32_16x16x32_bf16 v[64:67], a[248:251], v[32:35], v[64:67]
ds_read_b64 v[48:49], v2 offset:58368
ds_read_b64 v[50:51], v2 offset:58880
s_waitcnt lgkmcnt(6)
v_mfma_f32_16x16x32_bf16 v[68:71], a[248:251], v[36:39], v[68:71]
ds_read_b64 v[52:53], v239 offset:17408
ds_read_b64 v[54:55], v239 offset:17920
v_mfma_f32_16x16x32_bf16 v[72:75], a[252:255], v[24:27], v[72:75]
v_mfma_f32_16x16x32_bf16 v[76:79], a[252:255], v[28:31], v[76:79]
s_add_u32 s66, s66, 4096
buffer_load_dwordx4 a[248:251], v1, s[4:7], s66 offen
v_mfma_f32_16x16x32_bf16 v[80:83], a[252:255], v[32:35], v[80:83]
v_mfma_f32_16x16x32_bf16 v[84:87], a[252:255], v[36:39], v[84:87]
buffer_load_dwordx4 a[252:255], v1, s[4:7], s66 offen offset:1024
s_waitcnt lgkmcnt(6)
v_mfma_f32_16x16x32_bf16 v[56:59], a[0:3], v[40:43], v[56:59]
ds_read_b64 v[24:25], v2 offset:18432
ds_read_b64 v[26:27], v2 offset:18944
s_waitcnt lgkmcnt(6)
v_mfma_f32_16x16x32_bf16 v[60:63], a[0:3], v[44:47], v[60:63]
ds_read_b64 v[28:29], v2 offset:38912
ds_read_b64 v[30:31], v2 offset:39424
s_waitcnt lgkmcnt(6)
v_mfma_f32_16x16x32_bf16 v[64:67], a[0:3], v[48:51], v[64:67]
ds_read_b64 v[32:33], v2 offset:59392
ds_read_b64 v[34:35], v2 offset:59904
s_waitcnt lgkmcnt(6)
v_mfma_f32_16x16x32_bf16 v[68:71], a[0:3], v[52:55], v[68:71]
ds_read_b64 v[36:37], v239 offset:18432
ds_read_b64 v[38:39], v239 offset:18944
v_mfma_f32_16x16x32_bf16 v[72:75], a[4:7], v[40:43], v[72:75]
v_mfma_f32_16x16x32_bf16 v[76:79], a[4:7], v[44:47], v[76:79]
buffer_load_dwordx4 a[0:3], v1, s[4:7], s66 offen offset:2048
v_mfma_f32_16x16x32_bf16 v[80:83], a[4:7], v[48:51], v[80:83]
v_mfma_f32_16x16x32_bf16 v[84:87], a[4:7], v[52:55], v[84:87]
buffer_load_dwordx4 a[4:7], v1, s[4:7], s66 offen offset:3072
s_waitcnt lgkmcnt(6)
v_mfma_f32_16x16x32_bf16 v[56:59], a[8:11], v[24:27], v[56:59]
ds_read_b64 v[40:41], v2 offset:19456
ds_read_b64 v[42:43], v2 offset:19968
s_waitcnt lgkmcnt(6)
v_mfma_f32_16x16x32_bf16 v[60:63], a[8:11], v[28:31], v[60:63]
ds_read_b64 v[44:45], v2 offset:39936
ds_read_b64 v[46:47], v2 offset:40448
s_waitcnt lgkmcnt(6)
v_mfma_f32_16x16x32_bf16 v[64:67], a[8:11], v[32:35], v[64:67]
ds_read_b64 v[48:49], v2 offset:60416
ds_read_b64 v[50:51], v2 offset:60928
s_waitcnt lgkmcnt(6)
v_mfma_f32_16x16x32_bf16 v[68:71], a[8:11], v[36:39], v[68:71]
ds_read_b64 v[52:53], v239 offset:19456
ds_read_b64 v[54:55], v239 offset:19968
v_mfma_f32_16x16x32_bf16 v[72:75], a[12:15], v[24:27], v[72:75]
v_mfma_f32_16x16x32_bf16 v[76:79], a[12:15], v[28:31], v[76:79]
s_add_u32 s66, s66, 4096
buffer_load_dwordx4 a[8:11], v1, s[4:7], s66 offen
v_mfma_f32_16x16x32_bf16 v[80:83], a[12:15], v[32:35], v[80:83]
v_mfma_f32_16x16x32_bf16 v[84:87], a[12:15], v[36:39], v[84:87]
buffer_load_dwordx4 a[12:15], v1, s[4:7], s66 offen offset:1024
s_waitcnt lgkmcnt(6)
v_mfma_f32_16x16x32_bf16 v[56:59], a[16:19], v[40:43], v[56:59]
s_waitcnt lgkmcnt(4)
v_mfma_f32_16x16x32_bf16 v[60:63], a[16:19], v[44:47], v[60:63]
s_waitcnt lgkmcnt(2)
v_mfma_f32_16x16x32_bf16 v[64:67], a[16:19], v[48:51], v[64:67]
s_waitcnt lgkmcnt(0)
v_mfma_f32_16x16x32_bf16 v[68:71], a[16:19], v[52:55], v[68:71]
buffer_load_dwordx4 a[16:19], v1, s[4:7], s66 offen offset:2048
v_mfma_f32_16x16x32_bf16 v[72:75], a[20:23], v[40:43], v[72:75]
v_mfma_f32_16x16x32_bf16 v[76:79], a[20:23], v[44:47], v[76:79]
v_mfma_f32_16x16x32_bf16 v[80:83], a[20:23], v[48:51], v[80:83]
v_mfma_f32_16x16x32_bf16 v[84:87], a[20:23], v[52:55], v[84:87]
v_lshlrev_b32 v3, 2, v241
v_add_u32 v3, 102400, v3
ds_read_b32 v136, v3 offset:0
ds_read_b32 v140, v3 offset:256
ds_read_b32 v137, v3 offset:64
ds_read_b32 v141, v3 offset:320
ds_read_b32 v138, v3 offset:128
ds_read_b32 v142, v3 offset:384
ds_read_b32 v139, v3 offset:192
ds_read_b32 v143, v3 offset:448
s_waitcnt lgkmcnt(0)
s_add_u32 s24, s63, 0
s_lshl_b32 s24, s24, 10
s_mul_i32 s25, s61, 55296
s_add_u32 s24, s24, s25
s_add_u32 s24, s24, 27123712
v_pk_fma_f32 v[56:57], v[176:177], v[136:137], v[56:57] op_sel:[0,0,0] op_sel_hi:[1,0,1]
v_pk_fma_f32 v[58:59], v[178:179], v[136:137], v[58:59] op_sel:[0,0,0] op_sel_hi:[1,0,1]
v_pk_fma_f32 v[56:57], v[56:57], v[140:141], v[184:185] op_sel:[0,0,0] op_sel_hi:[1,0,1]
v_pk_fma_f32 v[58:59], v[58:59], v[140:141], v[186:187] op_sel:[0,0,0] op_sel_hi:[1,0,1]
v_max_f32 v56, 0, v56
v_max_f32 v57, 0, v57
v_max_f32 v58, 0, v58
v_max_f32 v59, 0, v59
v_pk_mul_f32 v[56:57], v[56:57], v[56:57]
v_pk_mul_f32 v[58:59], v[58:59], v[58:59]
v_cvt_pk_bf16_f32 v24, v56, v57
v_cvt_pk_bf16_f32 v25, v58, v59
v_pk_fma_f32 v[72:73], v[180:181], v[136:137], v[72:73] op_sel:[0,0,0] op_sel_hi:[1,0,1]
v_pk_fma_f32 v[74:75], v[182:183], v[136:137], v[74:75] op_sel:[0,0,0] op_sel_hi:[1,0,1]
v_pk_fma_f32 v[72:73], v[72:73], v[140:141], v[188:189] op_sel:[0,0,0] op_sel_hi:[1,0,1]
v_pk_fma_f32 v[74:75], v[74:75], v[140:141], v[190:191] op_sel:[0,0,0] op_sel_hi:[1,0,1]
v_max_f32 v72, 0, v72
v_max_f32 v73, 0, v73
v_max_f32 v74, 0, v74
v_max_f32 v75, 0, v75
v_pk_mul_f32 v[72:73], v[72:73], v[72:73]
v_pk_mul_f32 v[74:75], v[74:75], v[74:75]
v_cvt_pk_bf16_f32 v26, v72, v73
v_cvt_pk_bf16_f32 v27, v74, v75
s_cmp_eq_u32 s72, 0
s_cbranch_scc1 XS36
buffer_store_dwordx4 v[24:27], v1, s[4:7], s24 offen
s_branch XE37
XS36:
buffer_store_dwordx4 v[24:27], v1, s[4:7], s24 offen sc1
XE37:
s_add_u32 s24, s24, 55296
v_pk_fma_f32 v[60:61], v[176:177], v[136:137], v[60:61] op_sel:[0,1,0] op_sel_hi:[1,1,1]
v_pk_fma_f32 v[62:63], v[178:179], v[136:137], v[62:63] op_sel:[0,1,0] op_sel_hi:[1,1,1]
v_pk_fma_f32 v[60:61], v[60:61], v[140:141], v[184:185] op_sel:[0,1,0] op_sel_hi:[1,1,1]
v_pk_fma_f32 v[62:63], v[62:63], v[140:141], v[186:187] op_sel:[0,1,0] op_sel_hi:[1,1,1]
v_max_f32 v60, 0, v60
v_max_f32 v61, 0, v61
v_max_f32 v62, 0, v62
v_max_f32 v63, 0, v63
v_pk_mul_f32 v[60:61], v[60:61], v[60:61]
v_pk_mul_f32 v[62:63], v[62:63], v[62:63]
v_cvt_pk_bf16_f32 v28, v60, v61
v_cvt_pk_bf16_f32 v29, v62, v63
v_pk_fma_f32 v[76:77], v[180:181], v[136:137], v[76:77] op_sel:[0,1,0] op_sel_hi:[1,1,1]
v_pk_fma_f32 v[78:79], v[182:183], v[136:137], v[78:79] op_sel:[0,1,0] op_sel_hi:[1,1,1]
v_pk_fma_f32 v[76:77], v[76:77], v[140:141], v[188:189] op_sel:[0,1,0] op_sel_hi:[1,1,1]
v_pk_fma_f32 v[78:79], v[78:79], v[140:141], v[190:191] op_sel:[0,1,0] op_sel_hi:[1,1,1]
v_max_f32 v76, 0, v76
v_max_f32 v77, 0, v77
v_max_f32 v78, 0, v78
v_max_f32 v79, 0, v79
v_pk_mul_f32 v[76:77], v[76:77], v[76:77]
v_pk_mul_f32 v[78:79], v[78:79], v[78:79]
v_cvt_pk_bf16_f32 v30, v76, v77
v_cvt_pk_bf16_f32 v31, v78, v79
s_cmp_eq_u32 s72, 0
s_cbranch_scc1 XS38
buffer_store_dwordx4 v[28:31], v1, s[4:7], s24 offen
s_branch XE39
XS38:
buffer_store_dwordx4 v[28:31], v1, s[4:7], s24 offen sc1
XE39:
s_add_u32 s24, s24, 55296
v_pk_fma_f32 v[64:65], v[176:177], v[138:139], v[64:65] op_sel:[0,0,0] op_sel_hi:[1,0,1]
v_pk_fma_f32 v[66:67], v[178:179], v[138:139], v[66:67] op_sel:[0,0,0] op_sel_hi:[1,0,1]
v_pk_fma_f32 v[64:65], v[64:65], v[142:143], v[184:185] op_sel:[0,0,0] op_sel_hi:[1,0,1]
v_pk_fma_f32 v[66:67], v[66:67], v[142:143], v[186:187] op_sel:[0,0,0] op_sel_hi:[1,0,1]
v_max_f32 v64, 0, v64
v_max_f32 v65, 0, v65
v_max_f32 v66, 0, v66
v_max_f32 v67, 0, v67
v_pk_mul_f32 v[64:65], v[64:65], v[64:65]
v_pk_mul_f32 v[66:67], v[66:67], v[66:67]
v_cvt_pk_bf16_f32 v32, v64, v65
v_cvt_pk_bf16_f32 v33, v66, v67
v_pk_fma_f32 v[80:81], v[180:181], v[138:139], v[80:81] op_sel:[0,0,0] op_sel_hi:[1,0,1]
v_pk_fma_f32 v[82:83], v[182:183], v[138:139], v[82:83] op_sel:[0,0,0] op_sel_hi:[1,0,1]
v_pk_fma_f32 v[80:81], v[80:81], v[142:143], v[188:189] op_sel:[0,0,0] op_sel_hi:[1,0,1]
v_pk_fma_f32 v[82:83], v[82:83], v[142:143], v[190:191] op_sel:[0,0,0] op_sel_hi:[1,0,1]
v_max_f32 v80, 0, v80
v_max_f32 v81, 0, v81
v_max_f32 v82, 0, v82
v_max_f32 v83, 0, v83
v_pk_mul_f32 v[80:81], v[80:81], v[80:81]
v_pk_mul_f32 v[82:83], v[82:83], v[82:83]
v_cvt_pk_bf16_f32 v34, v80, v81
v_cvt_pk_bf16_f32 v35, v82, v83
s_cmp_eq_u32 s72, 0
s_cbranch_scc1 XS40
buffer_store_dwordx4 v[32:35], v1, s[4:7], s24 offen
s_branch XE41
XS40:
buffer_store_dwordx4 v[32:35], v1, s[4:7], s24 offen sc1
XE41:
s_add_u32 s24, s24, 55296
v_pk_fma_f32 v[68:69], v[176:177], v[138:139], v[68:69] op_sel:[0,1,0] op_sel_hi:[1,1,1]
v_pk_fma_f32 v[70:71], v[178:179], v[138:139], v[70:71] op_sel:[0,1,0] op_sel_hi:[1,1,1]
v_pk_fma_f32 v[68:69], v[68:69], v[142:143], v[184:185] op_sel:[0,1,0] op_sel_hi:[1,1,1]
v_pk_fma_f32 v[70:71], v[70:71], v[142:143], v[186:187] op_sel:[0,1,0] op_sel_hi:[1,1,1]
v_max_f32 v68, 0, v68
v_max_f32 v69, 0, v69
v_max_f32 v70, 0, v70
v_max_f32 v71, 0, v71
v_pk_mul_f32 v[68:69], v[68:69], v[68:69]
v_pk_mul_f32 v[70:71], v[70:71], v[70:71]
v_cvt_pk_bf16_f32 v36, v68, v69
v_cvt_pk_bf16_f32 v37, v70, v71
v_pk_fma_f32 v[84:85], v[180:181], v[138:139], v[84:85] op_sel:[0,1,0] op_sel_hi:[1,1,1]
v_pk_fma_f32 v[86:87], v[182:183], v[138:139], v[86:87] op_sel:[0,1,0] op_sel_hi:[1,1,1]
v_pk_fma_f32 v[84:85], v[84:85], v[142:143], v[188:189] op_sel:[0,1,0] op_sel_hi:[1,1,1]
v_pk_fma_f32 v[86:87], v[86:87], v[142:143], v[190:191] op_sel:[0,1,0] op_sel_hi:[1,1,1]
v_max_f32 v84, 0, v84
v_max_f32 v85, 0, v85
v_max_f32 v86, 0, v86
v_max_f32 v87, 0, v87
v_pk_mul_f32 v[84:85], v[84:85], v[84:85]
v_pk_mul_f32 v[86:87], v[86:87], v[86:87]
v_cvt_pk_bf16_f32 v38, v84, v85
v_cvt_pk_bf16_f32 v39, v86, v87
s_cmp_eq_u32 s72, 0
s_cbranch_scc1 XS42
buffer_store_dwordx4 v[36:39], v1, s[4:7], s24 offen
s_branch XE43
XS42:
buffer_store_dwordx4 v[36:39], v1, s[4:7], s24 offen sc1
XE43:
v_and_b32 v203, 0xffff0000, v201
v_lshlrev_b32 v202, 16, v201
v_and_b32 v201, 0xffff0000, v200
v_lshlrev_b32 v200, 16, v200
v_and_b32 v207, 0xffff0000, v205
v_lshlrev_b32 v206, 16, v205
v_and_b32 v205, 0xffff0000, v204
v_lshlrev_b32 v204, 16, v204
ds_read_b128 v[24:27], v1 offset:0
ds_read_b128 v[28:31], v1 offset:20480
ds_read_b128 v[32:35], v1 offset:40960
ds_read_b128 v[36:39], v238 offset:0
s_waitcnt lgkmcnt(3)
v_mfma_f32_16x16x32_bf16 v[56:59], a[24:27], v[24:27], 0
ds_read_b128 v[40:43], v1 offset:1024
s_waitcnt lgkmcnt(3)
v_mfma_f32_16x16x32_bf16 v[60:63], a[24:27], v[28:31], 0
ds_read_b128 v[44:47], v1 offset:21504
s_waitcnt lgkmcnt(3)
v_mfma_f32_16x16x32_bf16 v[64:67], a[24:27], v[32:35], 0
ds_read_b128 v[48:51], v1 offset:41984
s_waitcnt lgkmcnt(3)
v_mfma_f32_16x16x32_bf16 v[68:71], a[24:27], v[36:39], 0
ds_read_b128 v[52:55], v238 offset:1024
v_mfma_f32_16x16x32_bf16 v[72:75], a[28:31], v[24:27], 0
buffer_load_dwordx4 a[20:23], v1, s[4:7], s66 offen offset:3072
v_mfma_f32_16x16x32_bf16 v[76:79], a[28:31], v[28:31], 0
s_add_u32 s66, s66, 4096
buffer_load_dwordx4 a[24:27], v1, s[4:7], s66 offen
v_mfma_f32_16x16x32_bf16 v[80:83], a[28:31], v[32:35], 0
v_mfma_f32_16x16x32_bf16 v[84:87], a[28:31], v[36:39], 0
s_waitcnt lgkmcnt(3)
v_mfma_f32_16x16x32_bf16 v[56:59], a[32:35], v[40:43], v[56:59]
ds_read_b128 v[24:27], v1 offset:2048
s_waitcnt lgkmcnt(3)
v_mfma_f32_16x16x32_bf16 v[60:63], a[32:35], v[44:47], v[60:63]
ds_read_b128 v[28:31], v1 offset:22528
s_waitcnt lgkmcnt(3)
v_mfma_f32_16x16x32_bf16 v[64:67], a[32:35], v[48:51], v[64:67]
ds_read_b128 v[32:35], v1 offset:43008
s_waitcnt lgkmcnt(3)
v_mfma_f32_16x16x32_bf16 v[68:71], a[32:35], v[52:55], v[68:71]
ds_read_b128 v[36:39], v238 offset:2048
v_mfma_f32_16x16x32_bf16 v[72:75], a[36:39], v[40:43], v[72:75]
buffer_load_dwordx4 a[28:31], v1, s[4:7], s66 offen offset:1024
v_mfma_f32_16x16x32_bf16 v[76:79], a[36:39], v[44:47], v[76:79]
buffer_load_dwordx4 a[32:35], v1, s[4:7], s66 offen offset:2048
v_mfma_f32_16x16x32_bf16 v[80:83], a[36:39], v[48:51], v[80:83]
v_mfma_f32_16x16x32_bf16 v[84:87], a[36:39], v[52:55], v[84:87]
s_waitcnt lgkmcnt(3)
v_mfma_f32_16x16x32_bf16 v[56:59], a[40:43], v[24:27], v[56:59]
ds_read_b128 v[40:43], v1 offset:3072
s_waitcnt lgkmcnt(3)
v_mfma_f32_16x16x32_bf16 v[60:63], a[40:43], v[28:31], v[60:63]
ds_read_b128 v[44:47], v1 offset:23552
s_waitcnt lgkmcnt(3)
v_mfma_f32_16x16x32_bf16 v[64:67], a[40:43], v[32:35], v[64:67]
ds_read_b128 v[48:51], v1 offset:44032
s_waitcnt lgkmcnt(3)
v_mfma_f32_16x16x32_bf16 v[68:71], a[40:43], v[36:39], v[68:71]
ds_read_b128 v[52:55], v238 offset:3072
v_mfma_f32_16x16x32_bf16 v[72:75], a[44:47], v[24:27], v[72:75]
buffer_load_dwordx4 a[36:39], v1, s[4:7], s66 offen offset:3072
v_mfma_f32_16x16x32_bf16 v[76:79], a[44:47], v[28:31], v[76:79]
s_add_u32 s66, s66, 4096
buffer_load_dwordx4 a[40:43], v1, s[4:7], s66 offen
v_mfma_f32_16x16x32_bf16 v[80:83], a[44:47], v[32:35], v[80:83]
v_mfma_f32_16x16x32_bf16 v[84:87], a[44:47], v[36:39], v[84:87]
s_waitcnt lgkmcnt(3)
v_mfma_f32_16x16x32_bf16 v[56:59], a[48:51], v[40:43], v[56:59]
ds_read_b128 v[24:27], v1 offset:4096
s_waitcnt lgkmcnt(3)
v_mfma_f32_16x16x32_bf16 v[60:63], a[48:51], v[44:47], v[60:63]
ds_read_b128 v[28:31], v1 offset:24576
s_waitcnt lgkmcnt(3)
v_mfma_f32_16x16x32_bf16 v[64:67], a[48:51], v[48:51], v[64:67]
ds_read_b128 v[32:35], v1 offset:45056
s_waitcnt lgkmcnt(3)
v_mfma_f32_16x16x32_bf16 v[68:71], a[48:51], v[52:55], v[68:71]
ds_read_b128 v[36:39], v238 offset:4096
v_mfma_f32_16x16x32_bf16 v[72:75], a[52:55], v[40:43], v[72:75]
buffer_load_dwordx4 a[44:47], v1, s[4:7], s66 offen offset:1024
v_mfma_f32_16x16x32_bf16 v[76:79], a[52:55], v[44:47], v[76:79]
buffer_load_dwordx4 a[48:51], v1, s[4:7], s66 offen offset:2048
v_mfma_f32_16x16x32_bf16 v[80:83], a[52:55], v[48:51], v[80:83]
v_mfma_f32_16x16x32_bf16 v[84:87], a[52:55], v[52:55], v[84:87]
s_waitcnt lgkmcnt(3)
v_mfma_f32_16x16x32_bf16 v[56:59], a[56:59], v[24:27], v[56:59]
ds_read_b128 v[40:43], v1 offset:5120
s_waitcnt lgkmcnt(3)
v_mfma_f32_16x16x32_bf16 v[60:63], a[56:59], v[28:31], v[60:63]
ds_read_b128 v[44:47], v1 offset:25600
s_waitcnt lgkmcnt(3)
v_mfma_f32_16x16x32_bf16 v[64:67], a[56:59], v[32:35], v[64:67]
ds_read_b128 v[48:51], v1 offset:46080
s_waitcnt lgkmcnt(3)
v_mfma_f32_16x16x32_bf16 v[68:71], a[56:59], v[36:39], v[68:71]
ds_read_b128 v[52:55], v238 offset:5120
v_mfma_f32_16x16x32_bf16 v[72:75], a[60:63], v[24:27], v[72:75]
buffer_load_dwordx4 a[52:55], v1, s[4:7], s66 offen offset:3072
v_mfma_f32_16x16x32_bf16 v[76:79], a[60:63], v[28:31], v[76:79]
s_add_u32 s66, s66, 4096
buffer_load_dwordx4 a[56:59], v1, s[4:7], s66 offen
v_mfma_f32_16x16x32_bf16 v[80:83], a[60:63], v[32:35], v[80:83]
v_mfma_f32_16x16x32_bf16 v[84:87], a[60:63], v[36:39], v[84:87]
s_waitcnt lgkmcnt(3)
v_mfma_f32_16x16x32_bf16 v[56:59], a[64:67], v[40:43], v[56:59]
ds_read_b128 v[24:27], v1 offset:6144
s_waitcnt lgkmcnt(3)
v_mfma_f32_16x16x32_bf16 v[60:63], a[64:67], v[44:47], v[60:63]
ds_read_b128 v[28:31], v1 offset:26624
s_waitcnt lgkmcnt(3)
v_mfma_f32_16x16x32_bf16 v[64:67], a[64:67], v[48:51], v[64:67]
ds_read_b128 v[32:35], v1 offset:47104
s_waitcnt lgkmcnt(3)
v_mfma_f32_16x16x32_bf16 v[68:71], a[64:67], v[52:55], v[68:71]
ds_read_b128 v[36:39], v238 offset:6144
v_mfma_f32_16x16x32_bf16 v[72:75], a[104:107], v[40:43], v[72:75]
buffer_load_dwordx4 a[60:63], v1, s[4:7], s66 offen offset:1024
v_mfma_f32_16x16x32_bf16 v[76:79], a[104:107], v[44:47], v[76:79]
buffer_load_dwordx4 a[64:67], v1, s[4:7], s66 offen offset:2048
v_mfma_f32_16x16x32_bf16 v[80:83], a[104:107], v[48:51], v[80:83]
v_mfma_f32_16x16x32_bf16 v[84:87], a[104:107], v[52:55], v[84:87]
s_waitcnt lgkmcnt(3)
v_mfma_f32_16x16x32_bf16 v[56:59], a[108:111], v[24:27], v[56:59]
ds_read_b128 v[40:43], v1 offset:7168
s_waitcnt lgkmcnt(3)
v_mfma_f32_16x16x32_bf16 v[60:63], a[108:111], v[28:31], v[60:63]
ds_read_b128 v[44:47], v1 offset:27648
s_waitcnt lgkmcnt(3)
v_mfma_f32_16x16x32_bf16 v[64:67], a[108:111], v[32:35], v[64:67]
ds_read_b128 v[48:51], v1 offset:48128
s_waitcnt lgkmcnt(3)
v_mfma_f32_16x16x32_bf16 v[68:71], a[108:111], v[36:39], v[68:71]
ds_read_b128 v[52:55], v238 offset:7168
v_mfma_f32_16x16x32_bf16 v[72:75], a[112:115], v[24:27], v[72:75]
buffer_load_dwordx4 a[104:107], v1, s[4:7], s66 offen offset:3072
v_mfma_f32_16x16x32_bf16 v[76:79], a[112:115], v[28:31], v[76:79]
s_add_u32 s66, s66, 4096
buffer_load_dwordx4 a[108:111], v1, s[4:7], s66 offen
v_mfma_f32_16x16x32_bf16 v[80:83], a[112:115], v[32:35], v[80:83]
v_mfma_f32_16x16x32_bf16 v[84:87], a[112:115], v[36:39], v[84:87]
s_waitcnt lgkmcnt(3)
v_mfma_f32_16x16x32_bf16 v[56:59], a[68:71], v[40:43], v[56:59]
ds_read_b128 v[24:27], v1 offset:8192
s_waitcnt lgkmcnt(3)
v_mfma_f32_16x16x32_bf16 v[60:63], a[68:71], v[44:47], v[60:63]
ds_read_b128 v[28:31], v1 offset:28672
s_waitcnt lgkmcnt(3)
v_mfma_f32_16x16x32_bf16 v[64:67], a[68:71], v[48:51], v[64:67]
ds_read_b128 v[32:35], v1 offset:49152
s_waitcnt lgkmcnt(3)
v_mfma_f32_16x16x32_bf16 v[68:71], a[68:71], v[52:55], v[68:71]
ds_read_b128 v[36:39], v238 offset:8192
v_mfma_f32_16x16x32_bf16 v[72:75], a[72:75], v[40:43], v[72:75]
buffer_load_dwordx4 a[112:115], v1, s[4:7], s66 offen offset:1024
v_mfma_f32_16x16x32_bf16 v[76:79], a[72:75], v[44:47], v[76:79]
buffer_load_dwordx4 a[68:71], v1, s[4:7], s66 offen offset:2048
v_mfma_f32_16x16x32_bf16 v[80:83], a[72:75], v[48:51], v[80:83]
v_mfma_f32_16x16x32_bf16 v[84:87], a[72:75], v[52:55], v[84:87]
s_waitcnt lgkmcnt(3)
v_mfma_f32_16x16x32_bf16 v[56:59], a[76:79], v[24:27], v[56:59]
ds_read_b128 v[40:43], v1 offset:9216
s_waitcnt lgkmcnt(3)
v_mfma_f32_16x16x32_bf16 v[60:63], a[76:79], v[28:31], v[60:63]
ds_read_b128 v[44:47], v1 offset:29696
s_waitcnt lgkmcnt(3)
v_mfma_f32_16x16x32_bf16 v[64:67], a[76:79], v[32:35], v[64:67]
ds_read_b128 v[48:51], v1 offset:50176
s_waitcnt lgkmcnt(3)
v_mfma_f32_16x16x32_bf16 v[68:71], a[76:79], v[36:39], v[68:71]
ds_read_b128 v[52:55], v238 offset:9216
v_mfma_f32_16x16x32_bf16 v[72:75], a[80:83], v[24:27], v[72:75]
buffer_load_dwordx4 a[72:75], v1, s[4:7], s66 offen offset:3072
v_mfma_f32_16x16x32_bf16 v[76:79], a[80:83], v[28:31], v[76:79]
s_add_u32 s66, s66, 4096
buffer_load_dwordx4 a[76:79], v1, s[4:7], s66 offen
v_mfma_f32_16x16x32_bf16 v[80:83], a[80:83], v[32:35], v[80:83]
v_mfma_f32_16x16x32_bf16 v[84:87], a[80:83], v[36:39], v[84:87]
s_waitcnt lgkmcnt(3)
v_mfma_f32_16x16x32_bf16 v[56:59], a[84:87], v[40:43], v[56:59]
ds_read_b128 v[24:27], v1 offset:10240
s_waitcnt lgkmcnt(3)
v_mfma_f32_16x16x32_bf16 v[60:63], a[84:87], v[44:47], v[60:63]
ds_read_b128 v[28:31], v1 offset:30720
s_waitcnt lgkmcnt(3)
v_mfma_f32_16x16x32_bf16 v[64:67], a[84:87], v[48:51], v[64:67]
ds_read_b128 v[32:35], v1 offset:51200
s_waitcnt lgkmcnt(3)
v_mfma_f32_16x16x32_bf16 v[68:71], a[84:87], v[52:55], v[68:71]
ds_read_b128 v[36:39], v238 offset:10240
v_mfma_f32_16x16x32_bf16 v[72:75], a[88:91], v[40:43], v[72:75]
buffer_load_dwordx4 a[80:83], v1, s[4:7], s66 offen offset:1024
v_mfma_f32_16x16x32_bf16 v[76:79], a[88:91], v[44:47], v[76:79]
buffer_load_dwordx4 a[84:87], v1, s[4:7], s66 offen offset:2048
v_mfma_f32_16x16x32_bf16 v[80:83], a[88:91], v[48:51], v[80:83]
v_mfma_f32_16x16x32_bf16 v[84:87], a[88:91], v[52:55], v[84:87]
s_waitcnt lgkmcnt(3)
v_mfma_f32_16x16x32_bf16 v[56:59], a[92:95], v[24:27], v[56:59]
ds_read_b128 v[40:43], v1 offset:11264
s_waitcnt lgkmcnt(3)
v_mfma_f32_16x16x32_bf16 v[60:63], a[92:95], v[28:31], v[60:63]
ds_read_b128 v[44:47], v1 offset:31744
s_waitcnt lgkmcnt(3)
v_mfma_f32_16x16x32_bf16 v[64:67], a[92:95], v[32:35], v[64:67]
ds_read_b128 v[48:51], v1 offset:52224
s_waitcnt lgkmcnt(3)
v_mfma_f32_16x16x32_bf16 v[68:71], a[92:95], v[36:39], v[68:71]
ds_read_b128 v[52:55], v238 offset:11264
v_mfma_f32_16x16x32_bf16 v[72:75], a[96:99], v[24:27], v[72:75]
buffer_load_dwordx4 a[88:91], v1, s[4:7], s66 offen offset:3072
v_mfma_f32_16x16x32_bf16 v[76:79], a[96:99], v[28:31], v[76:79]
s_add_u32 s66, s66, 4096
buffer_load_dwordx4 a[92:95], v1, s[4:7], s66 offen
v_mfma_f32_16x16x32_bf16 v[80:83], a[96:99], v[32:35], v[80:83]
v_mfma_f32_16x16x32_bf16 v[84:87], a[96:99], v[36:39], v[84:87]
s_waitcnt lgkmcnt(3)
v_mfma_f32_16x16x32_bf16 v[56:59], a[100:103], v[40:43], v[56:59]
ds_read_b128 v[24:27], v1 offset:12288
s_waitcnt lgkmcnt(3)
v_mfma_f32_16x16x32_bf16 v[60:63], a[100:103], v[44:47], v[60:63]
ds_read_b128 v[28:31], v1 offset:32768
s_waitcnt lgkmcnt(3)
v_mfma_f32_16x16x32_bf16 v[64:67], a[100:103], v[48:51], v[64:67]
ds_read_b128 v[32:35], v1 offset:53248
s_waitcnt lgkmcnt(3)
v_mfma_f32_16x16x32_bf16 v[68:71], a[100:103], v[52:55], v[68:71]
ds_read_b128 v[36:39], v238 offset:12288
v_mfma_f32_16x16x32_bf16 v[72:75], a[116:119], v[40:43], v[72:75]
buffer_load_dwordx4 a[96:99], v1, s[4:7], s66 offen offset:1024
v_mfma_f32_16x16x32_bf16 v[76:79], a[116:119], v[44:47], v[76:79]
buffer_load_dwordx4 a[100:103], v1, s[4:7], s66 offen offset:2048
v_mfma_f32_16x16x32_bf16 v[80:83], a[116:119], v[48:51], v[80:83]
v_mfma_f32_16x16x32_bf16 v[84:87], a[116:119], v[52:55], v[84:87]
s_waitcnt lgkmcnt(3)
v_mfma_f32_16x16x32_bf16 v[56:59], a[120:123], v[24:27], v[56:59]
ds_read_b128 v[40:43], v1 offset:13312
s_waitcnt lgkmcnt(3)
v_mfma_f32_16x16x32_bf16 v[60:63], a[120:123], v[28:31], v[60:63]
ds_read_b128 v[44:47], v1 offset:33792
s_waitcnt lgkmcnt(3)
v_mfma_f32_16x16x32_bf16 v[64:67], a[120:123], v[32:35], v[64:67]
ds_read_b128 v[48:51], v1 offset:54272
s_waitcnt lgkmcnt(3)
v_mfma_f32_16x16x32_bf16 v[68:71], a[120:123], v[36:39], v[68:71]
ds_read_b128 v[52:55], v238 offset:13312
v_mfma_f32_16x16x32_bf16 v[72:75], a[124:127], v[24:27], v[72:75]
buffer_load_dwordx4 a[116:119], v1, s[4:7], s66 offen offset:3072
v_mfma_f32_16x16x32_bf16 v[76:79], a[124:127], v[28:31], v[76:79]
v_mfma_f32_16x16x32_bf16 v[80:83], a[124:127], v[32:35], v[80:83]
v_mfma_f32_16x16x32_bf16 v[84:87], a[124:127], v[36:39], v[84:87]
s_waitcnt lgkmcnt(3)
v_mfma_f32_16x16x32_bf16 v[56:59], a[128:131], v[40:43], v[56:59]
ds_read_b128 v[24:27], v1 offset:14336
s_waitcnt lgkmcnt(3)
v_mfma_f32_16x16x32_bf16 v[60:63], a[128:131], v[44:47], v[60:63]
ds_read_b128 v[28:31], v1 offset:34816
s_waitcnt lgkmcnt(3)
v_mfma_f32_16x16x32_bf16 v[64:67], a[128:131], v[48:51], v[64:67]
ds_read_b128 v[32:35], v1 offset:55296
s_waitcnt lgkmcnt(3)
v_mfma_f32_16x16x32_bf16 v[68:71], a[128:131], v[52:55], v[68:71]
ds_read_b128 v[36:39], v238 offset:14336
v_mfma_f32_16x16x32_bf16 v[72:75], a[132:135], v[40:43], v[72:75]
v_mfma_f32_16x16x32_bf16 v[76:79], a[132:135], v[44:47], v[76:79]
v_mfma_f32_16x16x32_bf16 v[80:83], a[132:135], v[48:51], v[80:83]
v_mfma_f32_16x16x32_bf16 v[84:87], a[132:135], v[52:55], v[84:87]
s_waitcnt lgkmcnt(3)
v_mfma_f32_16x16x32_bf16 v[56:59], a[136:139], v[24:27], v[56:59]
ds_read_b128 v[40:43], v1 offset:15360
s_waitcnt lgkmcnt(3)
v_mfma_f32_16x16x32_bf16 v[60:63], a[136:139], v[28:31], v[60:63]
ds_read_b128 v[44:47], v1 offset:35840
s_waitcnt lgkmcnt(3)
v_mfma_f32_16x16x32_bf16 v[64:67], a[136:139], v[32:35], v[64:67]
ds_read_b128 v[48:51], v1 offset:56320
s_waitcnt lgkmcnt(3)
v_mfma_f32_16x16x32_bf16 v[68:71], a[136:139], v[36:39], v[68:71]
ds_read_b128 v[52:55], v238 offset:15360
v_mfma_f32_16x16x32_bf16 v[72:75], a[140:143], v[24:27], v[72:75]
v_mfma_f32_16x16x32_bf16 v[76:79], a[140:143], v[28:31], v[76:79]
v_mfma_f32_16x16x32_bf16 v[80:83], a[140:143], v[32:35], v[80:83]
v_mfma_f32_16x16x32_bf16 v[84:87], a[140:143], v[36:39], v[84:87]
s_waitcnt lgkmcnt(3)
v_mfma_f32_16x16x32_bf16 v[56:59], a[144:147], v[40:43], v[56:59]
ds_read_b64 v[24:25], v2 offset:16384
ds_read_b64 v[26:27], v2 offset:16896
s_waitcnt lgkmcnt(4)
v_mfma_f32_16x16x32_bf16 v[60:63], a[144:147], v[44:47], v[60:63]
ds_read_b64 v[28:29], v2 offset:36864
ds_read_b64 v[30:31], v2 offset:37376
s_waitcnt lgkmcnt(5)
v_mfma_f32_16x16x32_bf16 v[64:67], a[144:147], v[48:51], v[64:67]
ds_read_b64 v[32:33], v2 offset:57344
ds_read_b64 v[34:35], v2 offset:57856
s_waitcnt lgkmcnt(6)
v_mfma_f32_16x16x32_bf16 v[68:71], a[144:147], v[52:55], v[68:71]
ds_read_b64 v[36:37], v239 offset:16384
ds_read_b64 v[38:39], v239 offset:16896
v_mfma_f32_16x16x32_bf16 v[72:75], a[148:151], v[40:43], v[72:75]
v_mfma_f32_16x16x32_bf16 v[76:79], a[148:151], v[44:47], v[76:79]
v_mfma_f32_16x16x32_bf16 v[80:83], a[148:151], v[48:51], v[80:83]
v_mfma_f32_16x16x32_bf16 v[84:87], a[148:151], v[52:55], v[84:87]
s_waitcnt lgkmcnt(6)
v_mfma_f32_16x16x32_bf16 v[56:59], a[152:155], v[24:27], v[56:59]
ds_read_b64 v[40:41], v2 offset:17408
ds_read_b64 v[42:43], v2 offset:17920
s_waitcnt lgkmcnt(6)
v_mfma_f32_16x16x32_bf16 v[60:63], a[152:155], v[28:31], v[60:63]
ds_read_b64 v[44:45], v2 offset:37888
ds_read_b64 v[46:47], v2 offset:38400
s_waitcnt lgkmcnt(6)
v_mfma_f32_16x16x32_bf16 v[64:67], a[152:155], v[32:35], v[64:67]
ds_read_b64 v[48:49], v2 offset:58368
ds_read_b64 v[50:51], v2 offset:58880
s_waitcnt lgkmcnt(6)
v_mfma_f32_16x16x32_bf16 v[68:71], a[152:155], v[36:39], v[68:71]
ds_read_b64 v[52:53], v239 offset:17408
ds_read_b64 v[54:55], v239 offset:17920
v_mfma_f32_16x16x32_bf16 v[72:75], a[156:159], v[24:27], v[72:75]
v_mfma_f32_16x16x32_bf16 v[76:79], a[156:159], v[28:31], v[76:79]
v_mfma_f32_16x16x32_bf16 v[80:83], a[156:159], v[32:35], v[80:83]
v_mfma_f32_16x16x32_bf16 v[84:87], a[156:159], v[36:39], v[84:87]
s_waitcnt lgkmcnt(6)
v_mfma_f32_16x16x32_bf16 v[56:59], a[160:163], v[40:43], v[56:59]
ds_read_b64 v[24:25], v2 offset:18432
ds_read_b64 v[26:27], v2 offset:18944
s_waitcnt lgkmcnt(6)
v_mfma_f32_16x16x32_bf16 v[60:63], a[160:163], v[44:47], v[60:63]
ds_read_b64 v[28:29], v2 offset:38912
ds_read_b64 v[30:31], v2 offset:39424
s_waitcnt lgkmcnt(6)
v_mfma_f32_16x16x32_bf16 v[64:67], a[160:163], v[48:51], v[64:67]
ds_read_b64 v[32:33], v2 offset:59392
ds_read_b64 v[34:35], v2 offset:59904
s_waitcnt lgkmcnt(6)
v_mfma_f32_16x16x32_bf16 v[68:71], a[160:163], v[52:55], v[68:71]
ds_read_b64 v[36:37], v239 offset:18432
ds_read_b64 v[38:39], v239 offset:18944
v_mfma_f32_16x16x32_bf16 v[72:75], a[164:167], v[40:43], v[72:75]
v_mfma_f32_16x16x32_bf16 v[76:79], a[164:167], v[44:47], v[76:79]
v_mfma_f32_16x16x32_bf16 v[80:83], a[164:167], v[48:51], v[80:83]
v_mfma_f32_16x16x32_bf16 v[84:87], a[164:167], v[52:55], v[84:87]
s_waitcnt lgkmcnt(6)
v_mfma_f32_16x16x32_bf16 v[56:59], a[168:171], v[24:27], v[56:59]
ds_read_b64 v[40:41], v2 offset:19456
ds_read_b64 v[42:43], v2 offset:19968
s_waitcnt lgkmcnt(6)
v_mfma_f32_16x16x32_bf16 v[60:63], a[168:171], v[28:31], v[60:63]
ds_read_b64 v[44:45], v2 offset:39936
ds_read_b64 v[46:47], v2 offset:40448
s_waitcnt lgkmcnt(6)
v_mfma_f32_16x16x32_bf16 v[64:67], a[168:171], v[32:35], v[64:67]
ds_read_b64 v[48:49], v2 offset:60416
ds_read_b64 v[50:51], v2 offset:60928
s_waitcnt lgkmcnt(6)
v_mfma_f32_16x16x32_bf16 v[68:71], a[168:171], v[36:39], v[68:71]
ds_read_b64 v[52:53], v239 offset:19456
ds_read_b64 v[54:55], v239 offset:19968
v_mfma_f32_16x16x32_bf16 v[72:75], a[172:175], v[24:27], v[72:75]
v_mfma_f32_16x16x32_bf16 v[76:79], a[172:175], v[28:31], v[76:79]
v_mfma_f32_16x16x32_bf16 v[80:83], a[172:175], v[32:35], v[80:83]
v_mfma_f32_16x16x32_bf16 v[84:87], a[172:175], v[36:39], v[84:87]
s_waitcnt lgkmcnt(6)
v_mfma_f32_16x16x32_bf16 v[56:59], a[176:179], v[40:43], v[56:59]
s_waitcnt lgkmcnt(4)
v_mfma_f32_16x16x32_bf16 v[60:63], a[176:179], v[44:47], v[60:63]
s_waitcnt lgkmcnt(2)
v_mfma_f32_16x16x32_bf16 v[64:67], a[176:179], v[48:51], v[64:67]
s_waitcnt lgkmcnt(0)
v_mfma_f32_16x16x32_bf16 v[68:71], a[176:179], v[52:55], v[68:71]
v_mfma_f32_16x16x32_bf16 v[72:75], a[180:183], v[40:43], v[72:75]
v_mfma_f32_16x16x32_bf16 v[76:79], a[180:183], v[44:47], v[76:79]
v_mfma_f32_16x16x32_bf16 v[80:83], a[180:183], v[48:51], v[80:83]
v_mfma_f32_16x16x32_bf16 v[84:87], a[180:183], v[52:55], v[84:87]
s_add_u32 s24, s63, 1
s_lshl_b32 s24, s24, 10
s_mul_i32 s25, s61, 55296
s_add_u32 s24, s24, s25
s_add_u32 s24, s24, 27123712
v_pk_fma_f32 v[56:57], v[192:193], v[136:137], v[56:57] op_sel:[0,0,0] op_sel_hi:[1,0,1]
v_pk_fma_f32 v[58:59], v[194:195], v[136:137], v[58:59] op_sel:[0,0,0] op_sel_hi:[1,0,1]
v_pk_fma_f32 v[56:57], v[56:57], v[140:141], v[200:201] op_sel:[0,0,0] op_sel_hi:[1,0,1]
v_pk_fma_f32 v[58:59], v[58:59], v[140:141], v[202:203] op_sel:[0,0,0] op_sel_hi:[1,0,1]
v_max_f32 v56, 0, v56
v_max_f32 v57, 0, v57
v_max_f32 v58, 0, v58
v_max_f32 v59, 0, v59
v_pk_mul_f32 v[56:57], v[56:57], v[56:57]
v_pk_mul_f32 v[58:59], v[58:59], v[58:59]
v_cvt_pk_bf16_f32 v24, v56, v57
v_cvt_pk_bf16_f32 v25, v58, v59
v_pk_fma_f32 v[72:73], v[196:197], v[136:137], v[72:73] op_sel:[0,0,0] op_sel_hi:[1,0,1]
v_pk_fma_f32 v[74:75], v[198:199], v[136:137], v[74:75] op_sel:[0,0,0] op_sel_hi:[1,0,1]
v_pk_fma_f32 v[72:73], v[72:73], v[140:141], v[204:205] op_sel:[0,0,0] op_sel_hi:[1,0,1]
v_pk_fma_f32 v[74:75], v[74:75], v[140:141], v[206:207] op_sel:[0,0,0] op_sel_hi:[1,0,1]
v_max_f32 v72, 0, v72
v_max_f32 v73, 0, v73
v_max_f32 v74, 0, v74
v_max_f32 v75, 0, v75
v_pk_mul_f32 v[72:73], v[72:73], v[72:73]
v_pk_mul_f32 v[74:75], v[74:75], v[74:75]
v_cvt_pk_bf16_f32 v26, v72, v73
v_cvt_pk_bf16_f32 v27, v74, v75
s_cmp_eq_u32 s72, 0
s_cbranch_scc1 XS44
buffer_store_dwordx4 v[24:27], v1, s[4:7], s24 offen
s_branch XE45
XS44:
buffer_store_dwordx4 v[24:27], v1, s[4:7], s24 offen sc1
XE45:
s_add_u32 s24, s24, 55296
v_pk_fma_f32 v[60:61], v[192:193], v[136:137], v[60:61] op_sel:[0,1,0] op_sel_hi:[1,1,1]
v_pk_fma_f32 v[62:63], v[194:195], v[136:137], v[62:63] op_sel:[0,1,0] op_sel_hi:[1,1,1]
v_pk_fma_f32 v[60:61], v[60:61], v[140:141], v[200:201] op_sel:[0,1,0] op_sel_hi:[1,1,1]
v_pk_fma_f32 v[62:63], v[62:63], v[140:141], v[202:203] op_sel:[0,1,0] op_sel_hi:[1,1,1]
v_max_f32 v60, 0, v60
v_max_f32 v61, 0, v61
v_max_f32 v62, 0, v62
v_max_f32 v63, 0, v63
v_pk_mul_f32 v[60:61], v[60:61], v[60:61]
v_pk_mul_f32 v[62:63], v[62:63], v[62:63]
v_cvt_pk_bf16_f32 v28, v60, v61
v_cvt_pk_bf16_f32 v29, v62, v63
v_pk_fma_f32 v[76:77], v[196:197], v[136:137], v[76:77] op_sel:[0,1,0] op_sel_hi:[1,1,1]
v_pk_fma_f32 v[78:79], v[198:199], v[136:137], v[78:79] op_sel:[0,1,0] op_sel_hi:[1,1,1]
v_pk_fma_f32 v[76:77], v[76:77], v[140:141], v[204:205] op_sel:[0,1,0] op_sel_hi:[1,1,1]
v_pk_fma_f32 v[78:79], v[78:79], v[140:141], v[206:207] op_sel:[0,1,0] op_sel_hi:[1,1,1]
v_max_f32 v76, 0, v76
v_max_f32 v77, 0, v77
v_max_f32 v78, 0, v78
v_max_f32 v79, 0, v79
v_pk_mul_f32 v[76:77], v[76:77], v[76:77]
v_pk_mul_f32 v[78:79], v[78:79], v[78:79]
v_cvt_pk_bf16_f32 v30, v76, v77
v_cvt_pk_bf16_f32 v31, v78, v79
s_cmp_eq_u32 s72, 0
s_cbranch_scc1 XS46
buffer_store_dwordx4 v[28:31], v1, s[4:7], s24 offen
s_branch XE47
XS46:
buffer_store_dwordx4 v[28:31], v1, s[4:7], s24 offen sc1
XE47:
s_add_u32 s24, s24, 55296
v_pk_fma_f32 v[64:65], v[192:193], v[138:139], v[64:65] op_sel:[0,0,0] op_sel_hi:[1,0,1]
v_pk_fma_f32 v[66:67], v[194:195], v[138:139], v[66:67] op_sel:[0,0,0] op_sel_hi:[1,0,1]
v_pk_fma_f32 v[64:65], v[64:65], v[142:143], v[200:201] op_sel:[0,0,0] op_sel_hi:[1,0,1]
v_pk_fma_f32 v[66:67], v[66:67], v[142:143], v[202:203] op_sel:[0,0,0] op_sel_hi:[1,0,1]
v_max_f32 v64, 0, v64
v_max_f32 v65, 0, v65
v_max_f32 v66, 0, v66
v_max_f32 v67, 0, v67
v_pk_mul_f32 v[64:65], v[64:65], v[64:65]
v_pk_mul_f32 v[66:67], v[66:67], v[66:67]
v_cvt_pk_bf16_f32 v32, v64, v65
v_cvt_pk_bf16_f32 v33, v66, v67
v_pk_fma_f32 v[80:81], v[196:197], v[138:139], v[80:81] op_sel:[0,0,0] op_sel_hi:[1,0,1]
v_pk_fma_f32 v[82:83], v[198:199], v[138:139], v[82:83] op_sel:[0,0,0] op_sel_hi:[1,0,1]
v_pk_fma_f32 v[80:81], v[80:81], v[142:143], v[204:205] op_sel:[0,0,0] op_sel_hi:[1,0,1]
v_pk_fma_f32 v[82:83], v[82:83], v[142:143], v[206:207] op_sel:[0,0,0] op_sel_hi:[1,0,1]
v_max_f32 v80, 0, v80
v_max_f32 v81, 0, v81
v_max_f32 v82, 0, v82
v_max_f32 v83, 0, v83
v_pk_mul_f32 v[80:81], v[80:81], v[80:81]
v_pk_mul_f32 v[82:83], v[82:83], v[82:83]
v_cvt_pk_bf16_f32 v34, v80, v81
v_cvt_pk_bf16_f32 v35, v82, v83
s_cmp_eq_u32 s72, 0
s_cbranch_scc1 XS48
buffer_store_dwordx4 v[32:35], v1, s[4:7], s24 offen
s_branch XE49
XS48:
buffer_store_dwordx4 v[32:35], v1, s[4:7], s24 offen sc1
XE49:
s_add_u32 s24, s24, 55296
v_pk_fma_f32 v[68:69], v[192:193], v[138:139], v[68:69] op_sel:[0,1,0] op_sel_hi:[1,1,1]
v_pk_fma_f32 v[70:71], v[194:195], v[138:139], v[70:71] op_sel:[0,1,0] op_sel_hi:[1,1,1]
v_pk_fma_f32 v[68:69], v[68:69], v[142:143], v[200:201] op_sel:[0,1,0] op_sel_hi:[1,1,1]
v_pk_fma_f32 v[70:71], v[70:71], v[142:143], v[202:203] op_sel:[0,1,0] op_sel_hi:[1,1,1]
v_max_f32 v68, 0, v68
v_max_f32 v69, 0, v69
v_max_f32 v70, 0, v70
v_max_f32 v71, 0, v71
v_pk_mul_f32 v[68:69], v[68:69], v[68:69]
v_pk_mul_f32 v[70:71], v[70:71], v[70:71]
v_cvt_pk_bf16_f32 v36, v68, v69
v_cvt_pk_bf16_f32 v37, v70, v71
v_pk_fma_f32 v[84:85], v[196:197], v[138:139], v[84:85] op_sel:[0,1,0] op_sel_hi:[1,1,1]
v_pk_fma_f32 v[86:87], v[198:199], v[138:139], v[86:87] op_sel:[0,1,0] op_sel_hi:[1,1,1]
v_pk_fma_f32 v[84:85], v[84:85], v[142:143], v[204:205] op_sel:[0,1,0] op_sel_hi:[1,1,1]
v_pk_fma_f32 v[86:87], v[86:87], v[142:143], v[206:207] op_sel:[0,1,0] op_sel_hi:[1,1,1]
v_max_f32 v84, 0, v84
v_max_f32 v85, 0, v85
v_max_f32 v86, 0, v86
v_max_f32 v87, 0, v87
v_pk_mul_f32 v[84:85], v[84:85], v[84:85]
v_pk_mul_f32 v[86:87], v[86:87], v[86:87]
v_cvt_pk_bf16_f32 v38, v84, v85
v_cvt_pk_bf16_f32 v39, v86, v87
s_cmp_eq_u32 s72, 0
s_cbranch_scc1 XS50
buffer_store_dwordx4 v[36:39], v1, s[4:7], s24 offen
s_branch XE51
XS50:
buffer_store_dwordx4 v[36:39], v1, s[4:7], s24 offen sc1
XE51:
s_waitcnt vmcnt(0)
v_mov_b32 v3, 4
s_mov_b64 exec, 1
s_cmp_eq_u32 s72, 0
s_cbranch_scc1 XS52
buffer_store_dword v3, off, s[4:7], s23
s_branch XE53
XS52:
buffer_store_dword v3, off, s[4:7], s23 sc1
XE53:
s_mov_b64 exec, -1
s_nop 7
s_branch FE32
FK34:
v_and_b32 v187, 0xffff0000, v185
v_lshlrev_b32 v186, 16, v185
v_and_b32 v185, 0xffff0000, v184
v_lshlrev_b32 v184, 16, v184
v_and_b32 v191, 0xffff0000, v189
v_lshlrev_b32 v190, 16, v189
v_and_b32 v189, 0xffff0000, v188
v_lshlrev_b32 v188, 16, v188
s_waitcnt vmcnt(5)
s_waitcnt lgkmcnt(0)
s_barrier
ds_read_b128 v[24:27], v1 offset:0
ds_read_b128 v[28:31], v1 offset:20480
ds_read_b128 v[32:35], v1 offset:40960
ds_read_b128 v[36:39], v238 offset:0
s_waitcnt lgkmcnt(3)
v_mfma_f32_16x16x32_bf16 v[56:59], a[120:123], v[24:27], 0
ds_read_b128 v[40:43], v1 offset:1024
s_waitcnt lgkmcnt(3)
v_mfma_f32_16x16x32_bf16 v[60:63], a[120:123], v[28:31], 0
ds_read_b128 v[44:47], v1 offset:21504
s_waitcnt lgkmcnt(3)
v_mfma_f32_16x16x32_bf16 v[64:67], a[120:123], v[32:35], 0
ds_read_b128 v[48:51], v1 offset:41984
s_waitcnt lgkmcnt(3)
v_mfma_f32_16x16x32_bf16 v[68:71], a[120:123], v[36:39], 0
ds_read_b128 v[52:55], v238 offset:1024
v_mfma_f32_16x16x32_bf16 v[72:75], a[124:127], v[24:27], 0
s_mov_b32 m0, s70
s_nop 0
buffer_load_dwordx4 v1, s[4:7], s69 offen offset:2048 sc1 lds
v_mfma_f32_16x16x32_bf16 v[76:79], a[124:127], v[28:31], 0
v_mfma_f32_16x16x32_bf16 v[80:83], a[124:127], v[32:35], 0
v_mfma_f32_16x16x32_bf16 v[84:87], a[124:127], v[36:39], 0
s_waitcnt lgkmcnt(3)
v_mfma_f32_16x16x32_bf16 v[56:59], a[128:131], v[40:43], v[56:59]
ds_read_b128 v[24:27], v1 offset:2048
s_waitcnt lgkmcnt(3)
v_mfma_f32_16x16x32_bf16 v[60:63], a[128:131], v[44:47], v[60:63]
ds_read_b128 v[28:31], v1 offset:22528
s_waitcnt lgkmcnt(3)
v_mfma_f32_16x16x32_bf16 v[64:67], a[128:131], v[48:51], v[64:67]
ds_read_b128 v[32:35], v1 offset:43008
s_waitcnt lgkmcnt(3)
v_mfma_f32_16x16x32_bf16 v[68:71], a[128:131], v[52:55], v[68:71]
ds_read_b128 v[36:39], v238 offset:2048
v_mfma_f32_16x16x32_bf16 v[72:75], a[132:135], v[40:43], v[72:75]
s_mov_b32 m0, s70
s_nop 0
buffer_load_dwordx4 v1, s[4:7], s69 offen offset:3072 sc1 lds
v_mfma_f32_16x16x32_bf16 v[76:79], a[132:135], v[44:47], v[76:79]
v_mfma_f32_16x16x32_bf16 v[80:83], a[132:135], v[48:51], v[80:83]
v_mfma_f32_16x16x32_bf16 v[84:87], a[132:135], v[52:55], v[84:87]
s_waitcnt lgkmcnt(3)
v_mfma_f32_16x16x32_bf16 v[56:59], a[136:139], v[24:27], v[56:59]
ds_read_b128 v[40:43], v1 offset:3072
s_waitcnt lgkmcnt(3)
v_mfma_f32_16x16x32_bf16 v[60:63], a[136:139], v[28:31], v[60:63]
ds_read_b128 v[44:47], v1 offset:23552
s_waitcnt lgkmcnt(3)
v_mfma_f32_16x16x32_bf16 v[64:67], a[136:139], v[32:35], v[64:67]
ds_read_b128 v[48:51], v1 offset:44032
s_waitcnt lgkmcnt(3)
v_mfma_f32_16x16x32_bf16 v[68:71], a[136:139], v[36:39], v[68:71]
ds_read_b128 v[52:55], v238 offset:3072
v_mfma_f32_16x16x32_bf16 v[72:75], a[140:143], v[24:27], v[72:75]
s_add_u32 s69, s69, 4096
s_add_u32 s70, s70, 4096
s_mov_b32 m0, s70
s_nop 0
buffer_load_dwordx4 v1, s[4:7], s69 offen offset:0 sc1 lds
v_mfma_f32_16x16x32_bf16 v[76:79], a[140:143], v[28:31], v[76:79]
v_mfma_f32_16x16x32_bf16 v[80:83], a[140:143], v[32:35], v[80:83]
v_mfma_f32_16x16x32_bf16 v[84:87], a[140:143], v[36:39], v[84:87]
s_waitcnt lgkmcnt(3)
v_mfma_f32_16x16x32_bf16 v[56:59], a[144:147], v[40:43], v[56:59]
ds_read_b128 v[24:27], v1 offset:4096
s_waitcnt lgkmcnt(3)
v_mfma_f32_16x16x32_bf16 v[60:63], a[144:147], v[44:47], v[60:63]
ds_read_b128 v[28:31], v1 offset:24576
s_waitcnt lgkmcnt(3)
v_mfma_f32_16x16x32_bf16 v[64:67], a[144:147], v[48:51], v[64:67]
ds_read_b128 v[32:35], v1 offset:45056
s_waitcnt lgkmcnt(3)
v_mfma_f32_16x16x32_bf16 v[68:71], a[144:147], v[52:55], v[68:71]
ds_read_b128 v[36:39], v238 offset:4096
v_mfma_f32_16x16x32_bf16 v[72:75], a[148:151], v[40:43], v[72:75]
s_mov_b32 m0, s70
s_nop 0
buffer_load_dwordx4 v1, s[4:7], s69 offen offset:1024 sc1 lds
v_mfma_f32_16x16x32_bf16 v[76:79], a[148:151], v[44:47], v[76:79]
v_mfma_f32_16x16x32_bf16 v[80:83], a[148:151], v[48:51], v[80:83]
v_mfma_f32_16x16x32_bf16 v[84:87], a[148:151], v[52:55], v[84:87]
s_waitcnt vmcnt(4)
s_barrier
s_waitcnt lgkmcnt(3)
v_mfma_f32_16x16x32_bf16 v[56:59], a[152:155], v[24:27], v[56:59]
ds_read_b128 v[40:43], v1 offset:5120
s_waitcnt lgkmcnt(3)
v_mfma_f32_16x16x32_bf16 v[60:63], a[152:155], v[28:31], v[60:63]
ds_read_b128 v[44:47], v1 offset:25600
s_waitcnt lgkmcnt(3)
v_mfma_f32_16x16x32_bf16 v[64:67], a[152:155], v[32:35], v[64:67]
ds_read_b128 v[48:51], v1 offset:46080
s_waitcnt lgkmcnt(3)
v_mfma_f32_16x16x32_bf16 v[68:71], a[152:155], v[36:39], v[68:71]
ds_read_b128 v[52:55], v238 offset:5120
v_mfma_f32_16x16x32_bf16 v[72:75], a[156:159], v[24:27], v[72:75]
s_mov_b32 m0, s70
s_nop 0
buffer_load_dwordx4 v1, s[4:7], s69 offen offset:2048 sc1 lds
v_mfma_f32_16x16x32_bf16 v[76:79], a[156:159], v[28:31], v[76:79]
v_mfma_f32_16x16x32_bf16 v[80:83], a[156:159], v[32:35], v[80:83]
v_mfma_f32_16x16x32_bf16 v[84:87], a[156:159], v[36:39], v[84:87]
s_waitcnt lgkmcnt(3)
v_mfma_f32_16x16x32_bf16 v[56:59], a[160:163], v[40:43], v[56:59]
ds_read_b128 v[24:27], v1 offset:6144
s_waitcnt lgkmcnt(3)
v_mfma_f32_16x16x32_bf16 v[60:63], a[160:163], v[44:47], v[60:63]
ds_read_b128 v[28:31], v1 offset:26624
s_waitcnt lgkmcnt(3)
v_mfma_f32_16x16x32_bf16 v[64:67], a[160:163], v[48:51], v[64:67]
ds_read_b128 v[32:35], v1 offset:47104
s_waitcnt lgkmcnt(3)
v_mfma_f32_16x16x32_bf16 v[68:71], a[160:163], v[52:55], v[68:71]
ds_read_b128 v[36:39], v238 offset:6144
v_mfma_f32_16x16x32_bf16 v[72:75], a[164:167], v[40:43], v[72:75]
s_mov_b32 m0, s70
s_nop 0
buffer_load_dwordx4 v1, s[4:7], s69 offen offset:3072 sc1 lds
v_mfma_f32_16x16x32_bf16 v[76:79], a[164:167], v[44:47], v[76:79]
v_mfma_f32_16x16x32_bf16 v[80:83], a[164:167], v[48:51], v[80:83]
v_mfma_f32_16x16x32_bf16 v[84:87], a[164:167], v[52:55], v[84:87]
s_waitcnt lgkmcnt(3)
v_mfma_f32_16x16x32_bf16 v[56:59], a[168:171], v[24:27], v[56:59]
ds_read_b128 v[40:43], v1 offset:7168
s_waitcnt lgkmcnt(3)
v_mfma_f32_16x16x32_bf16 v[60:63], a[168:171], v[28:31], v[60:63]
ds_read_b128 v[44:47], v1 offset:27648
s_waitcnt lgkmcnt(3)
v_mfma_f32_16x16x32_bf16 v[64:67], a[168:171], v[32:35], v[64:67]
ds_read_b128 v[48:51], v1 offset:48128
s_waitcnt lgkmcnt(3)
v_mfma_f32_16x16x32_bf16 v[68:71], a[168:171], v[36:39], v[68:71]
ds_read_b128 v[52:55], v238 offset:7168
v_mfma_f32_16x16x32_bf16 v[72:75], a[172:175], v[24:27], v[72:75]
s_add_u32 s69, s69, 4096
s_add_u32 s70, s70, 4096
s_mov_b32 m0, s70
s_nop 0
buffer_load_dwordx4 v1, s[4:7], s69 offen offset:0 sc1 lds
v_mfma_f32_16x16x32_bf16 v[76:79], a[172:175], v[28:31], v[76:79]
v_mfma_f32_16x16x32_bf16 v[80:83], a[172:175], v[32:35], v[80:83]
v_mfma_f32_16x16x32_bf16 v[84:87], a[172:175], v[36:39], v[84:87]
s_waitcnt lgkmcnt(3)
v_mfma_f32_16x16x32_bf16 v[56:59], a[176:179], v[40:43], v[56:59]
ds_read_b128 v[24:27], v1 offset:8192
s_waitcnt lgkmcnt(3)
v_mfma_f32_16x16x32_bf16 v[60:63], a[176:179], v[44:47], v[60:63]
ds_read_b128 v[28:31], v1 offset:28672
s_waitcnt lgkmcnt(3)
v_mfma_f32_16x16x32_bf16 v[64:67], a[176:179], v[48:51], v[64:67]
ds_read_b128 v[32:35], v1 offset:49152
s_waitcnt lgkmcnt(3)
v_mfma_f32_16x16x32_bf16 v[68:71], a[176:179], v[52:55], v[68:71]
ds_read_b128 v[36:39], v238 offset:8192
v_mfma_f32_16x16x32_bf16 v[72:75], a[180:183], v[40:43], v[72:75]
s_mov_b32 m0, s70
s_nop 0
buffer_load_dwordx4 v1, s[4:7], s69 offen offset:1024 sc1 lds
v_mfma_f32_16x16x32_bf16 v[76:79], a[180:183], v[44:47], v[76:79]
v_mfma_f32_16x16x32_bf16 v[80:83], a[180:183], v[48:51], v[80:83]
v_mfma_f32_16x16x32_bf16 v[84:87], a[180:183], v[52:55], v[84:87]
s_waitcnt lgkmcnt(3)
v_mfma_f32_16x16x32_bf16 v[56:59], a[184:187], v[24:27], v[56:59]
ds_read_b128 v[40:43], v1 offset:9216
s_waitcnt lgkmcnt(3)
v_mfma_f32_16x16x32_bf16 v[60:63], a[184:187], v[28:31], v[60:63]
ds_read_b128 v[44:47], v1 offset:29696
s_waitcnt lgkmcnt(3)
v_mfma_f32_16x16x32_bf16 v[64:67], a[184:187], v[32:35], v[64:67]
ds_read_b128 v[48:51], v1 offset:50176
s_waitcnt lgkmcnt(3)
v_mfma_f32_16x16x32_bf16 v[68:71], a[184:187], v[36:39], v[68:71]
ds_read_b128 v[52:55], v238 offset:9216
v_mfma_f32_16x16x32_bf16 v[72:75], a[188:191], v[24:27], v[72:75]
s_mov_b32 m0, s70
s_nop 0
buffer_load_dwordx4 v1, s[4:7], s69 offen offset:2048 sc1 lds
v_mfma_f32_16x16x32_bf16 v[76:79], a[188:191], v[28:31], v[76:79]
buffer_load_dwordx4 a[184:187], v1, s[4:7], s66 offen
v_mfma_f32_16x16x32_bf16 v[80:83], a[188:191], v[32:35], v[80:83]
v_mfma_f32_16x16x32_bf16 v[84:87], a[188:191], v[36:39], v[84:87]
buffer_load_dwordx4 a[188:191], v1, s[4:7], s66 offen offset:1024
s_waitcnt vmcnt(6)
s_barrier
s_waitcnt lgkmcnt(3)
v_mfma_f32_16x16x32_bf16 v[56:59], a[192:195], v[40:43], v[56:59]
ds_read_b128 v[24:27], v1 offset:10240
s_waitcnt lgkmcnt(3)
v_mfma_f32_16x16x32_bf16 v[60:63], a[192:195], v[44:47], v[60:63]
ds_read_b128 v[28:31], v1 offset:30720
s_waitcnt lgkmcnt(3)
v_mfma_f32_16x16x32_bf16 v[64:67], a[192:195], v[48:51], v[64:67]
ds_read_b128 v[32:35], v1 offset:51200
s_waitcnt lgkmcnt(3)
v_mfma_f32_16x16x32_bf16 v[68:71], a[192:195], v[52:55], v[68:71]
ds_read_b128 v[36:39], v238 offset:10240
v_mfma_f32_16x16x32_bf16 v[72:75], a[196:199], v[40:43], v[72:75]
s_mov_b32 m0, s70
s_nop 0
buffer_load_dwordx4 v1, s[4:7], s69 offen offset:3072 sc1 lds
v_mfma_f32_16x16x32_bf16 v[76:79], a[196:199], v[44:47], v[76:79]
buffer_load_dwordx4 a[192:195], v1, s[4:7], s66 offen offset:2048
v_mfma_f32_16x16x32_bf16 v[80:83], a[196:199], v[48:51], v[80:83]
v_mfma_f32_16x16x32_bf16 v[84:87], a[196:199], v[52:55], v[84:87]
buffer_load_dwordx4 a[196:199], v1, s[4:7], s66 offen offset:3072
s_waitcnt lgkmcnt(3)
v_mfma_f32_16x16x32_bf16 v[56:59], a[200:203], v[24:27], v[56:59]
ds_read_b128 v[40:43], v1 offset:11264
s_waitcnt lgkmcnt(3)
v_mfma_f32_16x16x32_bf16 v[60:63], a[200:203], v[28:31], v[60:63]
ds_read_b128 v[44:47], v1 offset:31744
s_waitcnt lgkmcnt(3)
v_mfma_f32_16x16x32_bf16 v[64:67], a[200:203], v[32:35], v[64:67]
ds_read_b128 v[48:51], v1 offset:52224
s_waitcnt lgkmcnt(3)
v_mfma_f32_16x16x32_bf16 v[68:71], a[200:203], v[36:39], v[68:71]
ds_read_b128 v[52:55], v238 offset:11264
v_mfma_f32_16x16x32_bf16 v[72:75], a[204:207], v[24:27], v[72:75]
v_mfma_f32_16x16x32_bf16 v[76:79], a[204:207], v[28:31], v[76:79]
s_add_u32 s66, s66, 4096
buffer_load_dwordx4 a[200:203], v1, s[4:7], s66 offen
v_mfma_f32_16x16x32_bf16 v[80:83], a[204:207], v[32:35], v[80:83]
v_mfma_f32_16x16x32_bf16 v[84:87], a[204:207], v[36:39], v[84:87]
buffer_load_dwordx4 a[204:207], v1, s[4:7], s66 offen offset:1024
s_waitcnt lgkmcnt(3)
v_mfma_f32_16x16x32_bf16 v[56:59], a[208:211], v[40:43], v[56:59]
ds_read_b128 v[24:27], v1 offset:12288
s_waitcnt lgkmcnt(3)
v_mfma_f32_16x16x32_bf16 v[60:63], a[208:211], v[44:47], v[60:63]
ds_read_b128 v[28:31], v1 offset:32768
s_waitcnt lgkmcnt(3)
v_mfma_f32_16x16x32_bf16 v[64:67], a[208:211], v[48:51], v[64:67]
ds_read_b128 v[32:35], v1 offset:53248
s_waitcnt lgkmcnt(3)
v_mfma_f32_16x16x32_bf16 v[68:71], a[208:211], v[52:55], v[68:71]
ds_read_b128 v[36:39], v238 offset:12288
v_mfma_f32_16x16x32_bf16 v[72:75], a[212:215], v[40:43], v[72:75]
v_mfma_f32_16x16x32_bf16 v[76:79], a[212:215], v[44:47], v[76:79]
buffer_load_dwordx4 a[208:211], v1, s[4:7], s66 offen offset:2048
v_mfma_f32_16x16x32_bf16 v[80:83], a[212:215], v[48:51], v[80:83]
v_mfma_f32_16x16x32_bf16 v[84:87], a[212:215], v[52:55], v[84:87]
buffer_load_dwordx4 a[212:215], v1, s[4:7], s66 offen offset:3072
s_waitcnt lgkmcnt(3)
v_mfma_f32_16x16x32_bf16 v[56:59], a[216:219], v[24:27], v[56:59]
ds_read_b128 v[40:43], v1 offset:13312
s_waitcnt lgkmcnt(3)
v_mfma_f32_16x16x32_bf16 v[60:63], a[216:219], v[28:31], v[60:63]
ds_read_b128 v[44:47], v1 offset:33792
s_waitcnt lgkmcnt(3)
v_mfma_f32_16x16x32_bf16 v[64:67], a[216:219], v[32:35], v[64:67]
ds_read_b128 v[48:51], v1 offset:54272
s_waitcnt lgkmcnt(3)
v_mfma_f32_16x16x32_bf16 v[68:71], a[216:219], v[36:39], v[68:71]
ds_read_b128 v[52:55], v238 offset:13312
v_mfma_f32_16x16x32_bf16 v[72:75], a[220:223], v[24:27], v[72:75]
v_mfma_f32_16x16x32_bf16 v[76:79], a[220:223], v[28:31], v[76:79]
s_add_u32 s66, s66, 4096
buffer_load_dwordx4 a[216:219], v1, s[4:7], s66 offen
v_mfma_f32_16x16x32_bf16 v[80:83], a[220:223], v[32:35], v[80:83]
v_mfma_f32_16x16x32_bf16 v[84:87], a[220:223], v[36:39], v[84:87]
buffer_load_dwordx4 a[220:223], v1, s[4:7], s66 offen offset:1024
s_waitcnt lgkmcnt(3)
v_mfma_f32_16x16x32_bf16 v[56:59], a[224:227], v[40:43], v[56:59]
ds_read_b128 v[24:27], v1 offset:14336
s_waitcnt lgkmcnt(3)
v_mfma_f32_16x16x32_bf16 v[60:63], a[224:227], v[44:47], v[60:63]
ds_read_b128 v[28:31], v1 offset:34816
s_waitcnt lgkmcnt(3)
v_mfma_f32_16x16x32_bf16 v[64:67], a[224:227], v[48:51], v[64:67]
ds_read_b128 v[32:35], v1 offset:55296
s_waitcnt lgkmcnt(3)
v_mfma_f32_16x16x32_bf16 v[68:71], a[224:227], v[52:55], v[68:71]
ds_read_b128 v[36:39], v238 offset:14336
v_mfma_f32_16x16x32_bf16 v[72:75], a[228:231], v[40:43], v[72:75]
v_mfma_f32_16x16x32_bf16 v[76:79], a[228:231], v[44:47], v[76:79]
buffer_load_dwordx4 a[224:227], v1, s[4:7], s66 offen offset:2048
v_mfma_f32_16x16x32_bf16 v[80:83], a[228:231], v[48:51], v[80:83]
v_mfma_f32_16x16x32_bf16 v[84:87], a[228:231], v[52:55], v[84:87]
buffer_load_dwordx4 a[228:231], v1, s[4:7], s66 offen offset:3072
s_waitcnt vmcnt(10)
s_barrier
s_waitcnt lgkmcnt(3)
v_mfma_f32_16x16x32_bf16 v[56:59], a[232:235], v[24:27], v[56:59]
ds_read_b128 v[40:43], v1 offset:15360
s_waitcnt lgkmcnt(3)
v_mfma_f32_16x16x32_bf16 v[60:63], a[232:235], v[28:31], v[60:63]
ds_read_b128 v[44:47], v1 offset:35840
s_waitcnt lgkmcnt(3)
v_mfma_f32_16x16x32_bf16 v[64:67], a[232:235], v[32:35], v[64:67]
ds_read_b128 v[48:51], v1 offset:56320
s_waitcnt lgkmcnt(3)
v_mfma_f32_16x16x32_bf16 v[68:71], a[232:235], v[36:39], v[68:71]
ds_read_b128 v[52:55], v238 offset:15360
v_mfma_f32_16x16x32_bf16 v[72:75], a[236:239], v[24:27], v[72:75]
v_mfma_f32_16x16x32_bf16 v[76:79], a[236:239], v[28:31], v[76:79]
s_add_u32 s66, s66, 4096
buffer_load_dwordx4 a[232:235], v1, s[4:7], s66 offen
v_mfma_f32_16x16x32_bf16 v[80:83], a[236:239], v[32:35], v[80:83]
v_mfma_f32_16x16x32_bf16 v[84:87], a[236:239], v[36:39], v[84:87]
buffer_load_dwordx4 a[236:239], v1, s[4:7], s66 offen offset:1024
s_waitcnt lgkmcnt(3)
v_mfma_f32_16x16x32_bf16 v[56:59], a[240:243], v[40:43], v[56:59]
ds_read_b64 v[24:25], v2 offset:16384
ds_read_b64 v[26:27], v2 offset:16896
s_waitcnt lgkmcnt(4)
v_mfma_f32_16x16x32_bf16 v[60:63], a[240:243], v[44:47], v[60:63]
ds_read_b64 v[28:29], v2 offset:36864
ds_read_b64 v[30:31], v2 offset:37376
s_waitcnt lgkmcnt(5)
v_mfma_f32_16x16x32_bf16 v[64:67], a[240:243], v[48:51], v[64:67]
ds_read_b64 v[32:33], v2 offset:57344
ds_read_b64 v[34:35], v2 offset:57856
s_waitcnt lgkmcnt(6)
v_mfma_f32_16x16x32_bf16 v[68:71], a[240:243], v[52:55], v[68:71]
ds_read_b64 v[36:37], v239 offset:16384
ds_read_b64 v[38:39], v239 offset:16896
v_mfma_f32_16x16x32_bf16 v[72:75], a[244:247], v[40:43], v[72:75]
v_mfma_f32_16x16x32_bf16 v[76:79], a[244:247], v[44:47], v[76:79]
buffer_load_dwordx4 a[240:243], v1, s[4:7], s66 offen offset:2048
v_mfma_f32_16x16x32_bf16 v[80:83], a[244:247], v[48:51], v[80:83]
v_mfma_f32_16x16x32_bf16 v[84:87], a[244:247], v[52:55], v[84:87]
buffer_load_dwordx4 a[244:247], v1, s[4:7], s66 offen offset:3072
s_waitcnt lgkmcnt(6)
v_mfma_f32_16x16x32_bf16 v[56:59], a[248:251], v[24:27], v[56:59]
ds_read_b64 v[40:41], v2 offset:17408
ds_read_b64 v[42:43], v2 offset:17920
s_waitcnt lgkmcnt(6)
v_mfma_f32_16x16x32_bf16 v[60:63], a[248:251], v[28:31], v[60:63]
ds_read_b64 v[44:45], v2 offset:37888
ds_read_b64 v[46:47], v2 offset:38400
s_waitcnt lgkmcnt(6)
v_mfma_f32_16x16x32_bf16 v[64:67], a[248:251], v[32:35], v[64:67]
ds_read_b64 v[48:49], v2 offset:58368
ds_read_b64 v[50:51], v2 offset:58880
s_waitcnt lgkmcnt(6)
v_mfma_f32_16x16x32_bf16 v[68:71], a[248:251], v[36:39], v[68:71]
ds_read_b64 v[52:53], v239 offset:17408
ds_read_b64 v[54:55], v239 offset:17920
v_mfma_f32_16x16x32_bf16 v[72:75], a[252:255], v[24:27], v[72:75]
v_mfma_f32_16x16x32_bf16 v[76:79], a[252:255], v[28:31], v[76:79]
s_add_u32 s66, s66, 4096
buffer_load_dwordx4 a[248:251], v1, s[4:7], s66 offen
v_mfma_f32_16x16x32_bf16 v[80:83], a[252:255], v[32:35], v[80:83]
v_mfma_f32_16x16x32_bf16 v[84:87], a[252:255], v[36:39], v[84:87]
buffer_load_dwordx4 a[252:255], v1, s[4:7], s66 offen offset:1024
s_waitcnt lgkmcnt(6)
v_mfma_f32_16x16x32_bf16 v[56:59], a[0:3], v[40:43], v[56:59]
ds_read_b64 v[24:25], v2 offset:18432
ds_read_b64 v[26:27], v2 offset:18944
s_waitcnt lgkmcnt(6)
v_mfma_f32_16x16x32_bf16 v[60:63], a[0:3], v[44:47], v[60:63]
ds_read_b64 v[28:29], v2 offset:38912
ds_read_b64 v[30:31], v2 offset:39424
s_waitcnt lgkmcnt(6)
v_mfma_f32_16x16x32_bf16 v[64:67], a[0:3], v[48:51], v[64:67]
ds_read_b64 v[32:33], v2 offset:59392
ds_read_b64 v[34:35], v2 offset:59904
s_waitcnt lgkmcnt(6)
v_mfma_f32_16x16x32_bf16 v[68:71], a[0:3], v[52:55], v[68:71]
ds_read_b64 v[36:37], v239 offset:18432
ds_read_b64 v[38:39], v239 offset:18944
v_mfma_f32_16x16x32_bf16 v[72:75], a[4:7], v[40:43], v[72:75]
v_mfma_f32_16x16x32_bf16 v[76:79], a[4:7], v[44:47], v[76:79]
buffer_load_dwordx4 a[0:3], v1, s[4:7], s66 offen offset:2048
v_mfma_f32_16x16x32_bf16 v[80:83], a[4:7], v[48:51], v[80:83]
v_mfma_f32_16x16x32_bf16 v[84:87], a[4:7], v[52:55], v[84:87]
buffer_load_dwordx4 a[4:7], v1, s[4:7], s66 offen offset:3072
s_waitcnt lgkmcnt(6)
v_mfma_f32_16x16x32_bf16 v[56:59], a[8:11], v[24:27], v[56:59]
ds_read_b64 v[40:41], v2 offset:19456
ds_read_b64 v[42:43], v2 offset:19968
s_waitcnt lgkmcnt(6)
v_mfma_f32_16x16x32_bf16 v[60:63], a[8:11], v[28:31], v[60:63]
ds_read_b64 v[44:45], v2 offset:39936
ds_read_b64 v[46:47], v2 offset:40448
s_waitcnt lgkmcnt(6)
v_mfma_f32_16x16x32_bf16 v[64:67], a[8:11], v[32:35], v[64:67]
ds_read_b64 v[48:49], v2 offset:60416
ds_read_b64 v[50:51], v2 offset:60928
s_waitcnt lgkmcnt(6)
v_mfma_f32_16x16x32_bf16 v[68:71], a[8:11], v[36:39], v[68:71]
ds_read_b64 v[52:53], v239 offset:19456
ds_read_b64 v[54:55], v239 offset:19968
v_mfma_f32_16x16x32_bf16 v[72:75], a[12:15], v[24:27], v[72:75]
v_mfma_f32_16x16x32_bf16 v[76:79], a[12:15], v[28:31], v[76:79]
s_add_u32 s66, s66, 4096
buffer_load_dwordx4 a[8:11], v1, s[4:7], s66 offen
v_mfma_f32_16x16x32_bf16 v[80:83], a[12:15], v[32:35], v[80:83]
v_mfma_f32_16x16x32_bf16 v[84:87], a[12:15], v[36:39], v[84:87]
buffer_load_dwordx4 a[12:15], v1, s[4:7], s66 offen offset:1024
s_waitcnt lgkmcnt(6)
v_mfma_f32_16x16x32_bf16 v[56:59], a[16:19], v[40:43], v[56:59]
s_waitcnt lgkmcnt(4)
v_mfma_f32_16x16x32_bf16 v[60:63], a[16:19], v[44:47], v[60:63]
s_waitcnt lgkmcnt(2)
v_mfma_f32_16x16x32_bf16 v[64:67], a[16:19], v[48:51], v[64:67]
s_waitcnt lgkmcnt(0)
v_mfma_f32_16x16x32_bf16 v[68:71], a[16:19], v[52:55], v[68:71]
buffer_load_dwordx4 a[16:19], v1, s[4:7], s66 offen offset:2048
v_mfma_f32_16x16x32_bf16 v[72:75], a[20:23], v[40:43], v[72:75]
v_mfma_f32_16x16x32_bf16 v[76:79], a[20:23], v[44:47], v[76:79]
v_mfma_f32_16x16x32_bf16 v[80:83], a[20:23], v[48:51], v[80:83]
v_mfma_f32_16x16x32_bf16 v[84:87], a[20:23], v[52:55], v[84:87]
v_lshlrev_b32 v3, 2, v241
v_add_u32 v3, 102400, v3
ds_read_b32 v136, v3 offset:0
ds_read_b32 v140, v3 offset:256
ds_read_b32 v137, v3 offset:64
ds_read_b32 v141, v3 offset:320
ds_read_b32 v138, v3 offset:128
ds_read_b32 v142, v3 offset:384
ds_read_b32 v139, v3 offset:192
ds_read_b32 v143, v3 offset:448
s_waitcnt lgkmcnt(0)
s_add_u32 s24, s63, 0
s_lshl_b32 s24, s24, 10
s_mul_i32 s25, s61, 55296
s_add_u32 s24, s24, s25
s_add_u32 s24, s24, 27123712
v_pk_fma_f32 v[56:57], v[176:177], v[136:137], v[56:57] op_sel:[0,0,0] op_sel_hi:[1,0,1]
v_pk_fma_f32 v[58:59], v[178:179], v[136:137], v[58:59] op_sel:[0,0,0] op_sel_hi:[1,0,1]
v_pk_fma_f32 v[56:57], v[56:57], v[140:141], v[184:185] op_sel:[0,0,0] op_sel_hi:[1,0,1]
v_pk_fma_f32 v[58:59], v[58:59], v[140:141], v[186:187] op_sel:[0,0,0] op_sel_hi:[1,0,1]
v_max_f32 v56, 0, v56
v_max_f32 v57, 0, v57
v_max_f32 v58, 0, v58
v_max_f32 v59, 0, v59
v_pk_mul_f32 v[56:57], v[56:57], v[56:57]
v_pk_mul_f32 v[58:59], v[58:59], v[58:59]
v_cvt_pk_bf16_f32 v24, v56, v57
v_cvt_pk_bf16_f32 v25, v58, v59
v_pk_fma_f32 v[72:73], v[180:181], v[136:137], v[72:73] op_sel:[0,0,0] op_sel_hi:[1,0,1]
v_pk_fma_f32 v[74:75], v[182:183], v[136:137], v[74:75] op_sel:[0,0,0] op_sel_hi:[1,0,1]
v_pk_fma_f32 v[72:73], v[72:73], v[140:141], v[188:189] op_sel:[0,0,0] op_sel_hi:[1,0,1]
v_pk_fma_f32 v[74:75], v[74:75], v[140:141], v[190:191] op_sel:[0,0,0] op_sel_hi:[1,0,1]
v_max_f32 v72, 0, v72
v_max_f32 v73, 0, v73
v_max_f32 v74, 0, v74
v_max_f32 v75, 0, v75
v_pk_mul_f32 v[72:73], v[72:73], v[72:73]
v_pk_mul_f32 v[74:75], v[74:75], v[74:75]
v_cvt_pk_bf16_f32 v26, v72, v73
v_cvt_pk_bf16_f32 v27, v74, v75
s_cmp_eq_u32 s72, 0
s_cbranch_scc1 XS54
buffer_store_dwordx4 v[24:27], v1, s[4:7], s24 offen
s_branch XE55
XS54:
buffer_store_dwordx4 v[24:27], v1, s[4:7], s24 offen sc1
XE55:
s_add_u32 s24, s24, 55296
v_pk_fma_f32 v[60:61], v[176:177], v[136:137], v[60:61] op_sel:[0,1,0] op_sel_hi:[1,1,1]
v_pk_fma_f32 v[62:63], v[178:179], v[136:137], v[62:63] op_sel:[0,1,0] op_sel_hi:[1,1,1]
v_pk_fma_f32 v[60:61], v[60:61], v[140:141], v[184:185] op_sel:[0,1,0] op_sel_hi:[1,1,1]
v_pk_fma_f32 v[62:63], v[62:63], v[140:141], v[186:187] op_sel:[0,1,0] op_sel_hi:[1,1,1]
v_max_f32 v60, 0, v60
v_max_f32 v61, 0, v61
v_max_f32 v62, 0, v62
v_max_f32 v63, 0, v63
v_pk_mul_f32 v[60:61], v[60:61], v[60:61]
v_pk_mul_f32 v[62:63], v[62:63], v[62:63]
v_cvt_pk_bf16_f32 v28, v60, v61
v_cvt_pk_bf16_f32 v29, v62, v63
v_pk_fma_f32 v[76:77], v[180:181], v[136:137], v[76:77] op_sel:[0,1,0] op_sel_hi:[1,1,1]
v_pk_fma_f32 v[78:79], v[182:183], v[136:137], v[78:79] op_sel:[0,1,0] op_sel_hi:[1,1,1]
v_pk_fma_f32 v[76:77], v[76:77], v[140:141], v[188:189] op_sel:[0,1,0] op_sel_hi:[1,1,1]
v_pk_fma_f32 v[78:79], v[78:79], v[140:141], v[190:191] op_sel:[0,1,0] op_sel_hi:[1,1,1]
v_max_f32 v76, 0, v76
v_max_f32 v77, 0, v77
v_max_f32 v78, 0, v78
v_max_f32 v79, 0, v79
v_pk_mul_f32 v[76:77], v[76:77], v[76:77]
v_pk_mul_f32 v[78:79], v[78:79], v[78:79]
v_cvt_pk_bf16_f32 v30, v76, v77
v_cvt_pk_bf16_f32 v31, v78, v79
s_cmp_eq_u32 s72, 0
s_cbranch_scc1 XS56
buffer_store_dwordx4 v[28:31], v1, s[4:7], s24 offen
s_branch XE57
XS56:
buffer_store_dwordx4 v[28:31], v1, s[4:7], s24 offen sc1
XE57:
s_add_u32 s24, s24, 55296
v_pk_fma_f32 v[64:65], v[176:177], v[138:139], v[64:65] op_sel:[0,0,0] op_sel_hi:[1,0,1]
v_pk_fma_f32 v[66:67], v[178:179], v[138:139], v[66:67] op_sel:[0,0,0] op_sel_hi:[1,0,1]
v_pk_fma_f32 v[64:65], v[64:65], v[142:143], v[184:185] op_sel:[0,0,0] op_sel_hi:[1,0,1]
v_pk_fma_f32 v[66:67], v[66:67], v[142:143], v[186:187] op_sel:[0,0,0] op_sel_hi:[1,0,1]
v_max_f32 v64, 0, v64
v_max_f32 v65, 0, v65
v_max_f32 v66, 0, v66
v_max_f32 v67, 0, v67
v_pk_mul_f32 v[64:65], v[64:65], v[64:65]
v_pk_mul_f32 v[66:67], v[66:67], v[66:67]
v_cvt_pk_bf16_f32 v32, v64, v65
v_cvt_pk_bf16_f32 v33, v66, v67
v_pk_fma_f32 v[80:81], v[180:181], v[138:139], v[80:81] op_sel:[0,0,0] op_sel_hi:[1,0,1]
v_pk_fma_f32 v[82:83], v[182:183], v[138:139], v[82:83] op_sel:[0,0,0] op_sel_hi:[1,0,1]
v_pk_fma_f32 v[80:81], v[80:81], v[142:143], v[188:189] op_sel:[0,0,0] op_sel_hi:[1,0,1]
v_pk_fma_f32 v[82:83], v[82:83], v[142:143], v[190:191] op_sel:[0,0,0] op_sel_hi:[1,0,1]
v_max_f32 v80, 0, v80
v_max_f32 v81, 0, v81
v_max_f32 v82, 0, v82
v_max_f32 v83, 0, v83
v_pk_mul_f32 v[80:81], v[80:81], v[80:81]
v_pk_mul_f32 v[82:83], v[82:83], v[82:83]
v_cvt_pk_bf16_f32 v34, v80, v81
v_cvt_pk_bf16_f32 v35, v82, v83
s_cmp_eq_u32 s72, 0
s_cbranch_scc1 XS58
buffer_store_dwordx4 v[32:35], v1, s[4:7], s24 offen
s_branch XE59
XS58:
buffer_store_dwordx4 v[32:35], v1, s[4:7], s24 offen sc1
XE59:
s_add_u32 s24, s24, 55296
v_pk_fma_f32 v[68:69], v[176:177], v[138:139], v[68:69] op_sel:[0,1,0] op_sel_hi:[1,1,1]
v_pk_fma_f32 v[70:71], v[178:179], v[138:139], v[70:71] op_sel:[0,1,0] op_sel_hi:[1,1,1]
v_pk_fma_f32 v[68:69], v[68:69], v[142:143], v[184:185] op_sel:[0,1,0] op_sel_hi:[1,1,1]
v_pk_fma_f32 v[70:71], v[70:71], v[142:143], v[186:187] op_sel:[0,1,0] op_sel_hi:[1,1,1]
v_max_f32 v68, 0, v68
v_max_f32 v69, 0, v69
v_max_f32 v70, 0, v70
v_max_f32 v71, 0, v71
v_pk_mul_f32 v[68:69], v[68:69], v[68:69]
v_pk_mul_f32 v[70:71], v[70:71], v[70:71]
v_cvt_pk_bf16_f32 v36, v68, v69
v_cvt_pk_bf16_f32 v37, v70, v71
v_pk_fma_f32 v[84:85], v[180:181], v[138:139], v[84:85] op_sel:[0,1,0] op_sel_hi:[1,1,1]
v_pk_fma_f32 v[86:87], v[182:183], v[138:139], v[86:87] op_sel:[0,1,0] op_sel_hi:[1,1,1]
v_pk_fma_f32 v[84:85], v[84:85], v[142:143], v[188:189] op_sel:[0,1,0] op_sel_hi:[1,1,1]
v_pk_fma_f32 v[86:87], v[86:87], v[142:143], v[190:191] op_sel:[0,1,0] op_sel_hi:[1,1,1]
v_max_f32 v84, 0, v84
v_max_f32 v85, 0, v85
v_max_f32 v86, 0, v86
v_max_f32 v87, 0, v87
v_pk_mul_f32 v[84:85], v[84:85], v[84:85]
v_pk_mul_f32 v[86:87], v[86:87], v[86:87]
v_cvt_pk_bf16_f32 v38, v84, v85
v_cvt_pk_bf16_f32 v39, v86, v87
s_cmp_eq_u32 s72, 0
s_cbranch_scc1 XS60
buffer_store_dwordx4 v[36:39], v1, s[4:7], s24 offen
s_branch XE61
XS60:
buffer_store_dwordx4 v[36:39], v1, s[4:7], s24 offen sc1
XE61:
buffer_load_dwordx4 a[20:23], v1, s[4:7], s66 offen offset:3072
s_add_u32 s66, s66, 4096
buffer_load_dwordx4 a[24:27], v1, s[4:7], s66 offen
buffer_load_dwordx4 a[28:31], v1, s[4:7], s66 offen offset:1024
buffer_load_dwordx4 a[32:35], v1, s[4:7], s66 offen offset:2048
buffer_load_dwordx4 a[36:39], v1, s[4:7], s66 offen offset:3072
s_add_u32 s66, s66, 4096
buffer_load_dwordx4 a[40:43], v1, s[4:7], s66 offen
buffer_load_dwordx4 a[44:47], v1, s[4:7], s66 offen offset:1024
buffer_load_dwordx4 a[48:51], v1, s[4:7], s66 offen offset:2048
buffer_load_dwordx4 a[52:55], v1, s[4:7], s66 offen offset:3072
s_add_u32 s66, s66, 4096
buffer_load_dwordx4 a[56:59], v1, s[4:7], s66 offen
buffer_load_dwordx4 a[60:63], v1, s[4:7], s66 offen offset:1024
buffer_load_dwordx4 a[64:67], v1, s[4:7], s66 offen offset:2048
buffer_load_dwordx4 a[104:107], v1, s[4:7], s66 offen offset:3072
s_add_u32 s66, s66, 4096
buffer_load_dwordx4 a[108:111], v1, s[4:7], s66 offen
buffer_load_dwordx4 a[112:115], v1, s[4:7], s66 offen offset:1024
buffer_load_dwordx4 a[68:71], v1, s[4:7], s66 offen offset:2048
buffer_load_dwordx4 a[72:75], v1, s[4:7], s66 offen offset:3072
s_add_u32 s66, s66, 4096
buffer_load_dwordx4 a[76:79], v1, s[4:7], s66 offen
buffer_load_dwordx4 a[80:83], v1, s[4:7], s66 offen offset:1024
buffer_load_dwordx4 a[84:87], v1, s[4:7], s66 offen offset:2048
buffer_load_dwordx4 a[88:91], v1, s[4:7], s66 offen offset:3072
s_add_u32 s66, s66, 4096
buffer_load_dwordx4 a[92:95], v1, s[4:7], s66 offen
buffer_load_dwordx4 a[96:99], v1, s[4:7], s66 offen offset:1024
buffer_load_dwordx4 a[100:103], v1, s[4:7], s66 offen offset:2048
buffer_load_dwordx4 a[116:119], v1, s[4:7], s66 offen offset:3072
s_waitcnt vmcnt(25)
v_mov_b32 v3, 4
s_mov_b64 exec, 1
s_cmp_eq_u32 s72, 0
s_cbranch_scc1 XS62
buffer_store_dword v3, off, s[4:7], s23
s_branch XE63
XS62:
buffer_store_dword v3, off, s[4:7], s23 sc1
XE63:
s_mov_b64 exec, -1
s_nop 7
s_branch FE32
FK35:
s_waitcnt vmcnt(5)
s_waitcnt lgkmcnt(0)
s_barrier
s_waitcnt vmcnt(0)
s_barrier
s_mov_b32 m0, s70
s_nop 0
buffer_load_dwordx4 v1, s[4:7], s69 offen offset:2048 sc1 lds
s_mov_b32 m0, s70
s_nop 0
buffer_load_dwordx4 v1, s[4:7], s69 offen offset:3072 sc1 lds
s_add_u32 s69, s69, 4096
s_add_u32 s70, s70, 4096
s_mov_b32 m0, s70
s_nop 0
buffer_load_dwordx4 v1, s[4:7], s69 offen offset:0 sc1 lds
s_mov_b32 m0, s70
s_nop 0
buffer_load_dwordx4 v1, s[4:7], s69 offen offset:1024 sc1 lds
s_mov_b32 m0, s70
s_nop 0
buffer_load_dwordx4 v1, s[4:7], s69 offen offset:2048 sc1 lds
s_waitcnt vmcnt(0)
s_barrier
s_mov_b32 m0, s70
s_nop 0
buffer_load_dwordx4 v1, s[4:7], s69 offen offset:3072 sc1 lds
s_add_u32 s69, s69, 4096
s_add_u32 s70, s70, 4096
s_mov_b32 m0, s70
s_nop 0
buffer_load_dwordx4 v1, s[4:7], s69 offen offset:0 sc1 lds
s_mov_b32 m0, s70
s_nop 0
buffer_load_dwordx4 v1, s[4:7], s69 offen offset:1024 sc1 lds
s_mov_b32 m0, s70
s_nop 0
buffer_load_dwordx4 v1, s[4:7], s69 offen offset:2048 sc1 lds
s_mov_b32 m0, s70
s_nop 0
buffer_load_dwordx4 v1, s[4:7], s69 offen offset:3072 sc1 lds
s_waitcnt vmcnt(0)
s_barrier
buffer_load_dwordx4 a[184:187], v1, s[4:7], s66 offen
buffer_load_dwordx4 a[188:191], v1, s[4:7], s66 offen offset:1024
buffer_load_dwordx4 a[192:195], v1, s[4:7], s66 offen offset:2048
buffer_load_dwordx4 a[196:199], v1, s[4:7], s66 offen offset:3072
s_add_u32 s66, s66, 4096
buffer_load_dwordx4 a[200:203], v1, s[4:7], s66 offen
buffer_load_dwordx4 a[204:207], v1, s[4:7], s66 offen offset:1024
buffer_load_dwordx4 a[208:211], v1, s[4:7], s66 offen offset:2048
buffer_load_dwordx4 a[212:215], v1, s[4:7], s66 offen offset:3072
s_add_u32 s66, s66, 4096
buffer_load_dwordx4 a[216:219], v1, s[4:7], s66 offen
buffer_load_dwordx4 a[220:223], v1, s[4:7], s66 offen offset:1024
buffer_load_dwordx4 a[224:227], v1, s[4:7], s66 offen offset:2048
buffer_load_dwordx4 a[228:231], v1, s[4:7], s66 offen offset:3072
s_add_u32 s66, s66, 4096
buffer_load_dwordx4 a[232:235], v1, s[4:7], s66 offen
buffer_load_dwordx4 a[236:239], v1, s[4:7], s66 offen offset:1024
buffer_load_dwordx4 a[240:243], v1, s[4:7], s66 offen offset:2048
buffer_load_dwordx4 a[244:247], v1, s[4:7], s66 offen offset:3072
s_add_u32 s66, s66, 4096
buffer_load_dwordx4 a[248:251], v1, s[4:7], s66 offen
buffer_load_dwordx4 a[252:255], v1, s[4:7], s66 offen offset:1024
buffer_load_dwordx4 a[0:3], v1, s[4:7], s66 offen offset:2048
buffer_load_dwordx4 a[4:7], v1, s[4:7], s66 offen offset:3072
s_add_u32 s66, s66, 4096
buffer_load_dwordx4 a[8:11], v1, s[4:7], s66 offen
buffer_load_dwordx4 a[12:15], v1, s[4:7], s66 offen offset:1024
buffer_load_dwordx4 a[16:19], v1, s[4:7], s66 offen offset:2048
buffer_load_dwordx4 a[20:23], v1, s[4:7], s66 offen offset:3072
s_add_u32 s66, s66, 4096
buffer_load_dwordx4 a[24:27], v1, s[4:7], s66 offen
buffer_load_dwordx4 a[28:31], v1, s[4:7], s66 offen offset:1024
buffer_load_dwordx4 a[32:35], v1, s[4:7], s66 offen offset:2048
buffer_load_dwordx4 a[36:39], v1, s[4:7], s66 offen offset:3072
s_add_u32 s66, s66, 4096
buffer_load_dwordx4 a[40:43], v1, s[4:7], s66 offen
buffer_load_dwordx4 a[44:47], v1, s[4:7], s66 offen offset:1024
buffer_load_dwordx4 a[48:51], v1, s[4:7], s66 offen offset:2048
buffer_load_dwordx4 a[52:55], v1, s[4:7], s66 offen offset:3072
s_add_u32 s66, s66, 4096
buffer_load_dwordx4 a[56:59], v1, s[4:7], s66 offen
buffer_load_dwordx4 a[60:63], v1, s[4:7], s66 offen offset:1024
buffer_load_dwordx4 a[64:67], v1, s[4:7], s66 offen offset:2048
buffer_load_dwordx4 a[104:107], v1, s[4:7], s66 offen offset:3072
s_add_u32 s66, s66, 4096
buffer_load_dwordx4 a[108:111], v1, s[4:7], s66 offen
buffer_load_dwordx4 a[112:115], v1, s[4:7], s66 offen offset:1024
buffer_load_dwordx4 a[68:71], v1, s[4:7], s66 offen offset:2048
buffer_load_dwordx4 a[72:75], v1, s[4:7], s66 offen offset:3072
s_add_u32 s66, s66, 4096
buffer_load_dwordx4 a[76:79], v1, s[4:7], s66 offen
buffer_load_dwordx4 a[80:83], v1, s[4:7], s66 offen offset:1024
buffer_load_dwordx4 a[84:87], v1, s[4:7], s66 offen offset:2048
buffer_load_dwordx4 a[88:91], v1, s[4:7], s66 offen offset:3072
s_add_u32 s66, s66, 4096
buffer_load_dwordx4 a[92:95], v1, s[4:7], s66 offen
buffer_load_dwordx4 a[96:99], v1, s[4:7], s66 offen offset:1024
buffer_load_dwordx4 a[100:103], v1, s[4:7], s66 offen offset:2048
buffer_load_dwordx4 a[116:119], v1, s[4:7], s66 offen offset:3072
s_waitcnt vmcnt(48)
v_mov_b32 v3, 4
s_mov_b64 exec, 1
s_cmp_eq_u32 s72, 0
s_cbranch_scc1 XS64
buffer_store_dword v3, off, s[4:7], s23
s_branch XE65
XS64:
buffer_store_dword v3, off, s[4:7], s23 sc1
XE65:
s_mov_b64 exec, -1
s_nop 7
s_branch FE32
FE32:
s_add_u32 s24, s22, 1
s_and_b32 s24, s24, 3
s_add_u32 s24, s24, s61
s_mul_i32 s24, s24, 54
s_add_u32 s24, s24, s67
s_lshl_b32 s24, s24, 10
s_add_u32 s45, s24, 27123712
s_add_u32 s24, s22, 2
s_and_b32 s24, s24, 3
s_add_u32 s24, s24, s61
s_mul_i32 s24, s24, 54
s_add_u32 s24, s24, s67
s_lshl_b32 s24, s24, 10
s_add_u32 s46, s24, 27123712
s_add_u32 s24, s22, 3
s_and_b32 s24, s24, 3
s_add_u32 s24, s24, s61
s_mul_i32 s24, s24, 54
s_add_u32 s24, s24, s67
s_lshl_b32 s24, s24, 10
s_add_u32 s47, s24, 27123712
s_add_u32 s24, s22, 4
s_and_b32 s24, s24, 3
s_add_u32 s24, s24, s61
s_mul_i32 s24, s24, 54
s_add_u32 s24, s24, s67
s_lshl_b32 s24, s24, 10
s_add_u32 s48, s24, 27123712
s_mul_i32 s24, s21, 160
v_lshlrev_b32 v3, 3, v240
buffer_load_dwordx2 v[84:85], v3, s[16:19], s24 offen offset:0
buffer_load_dwordx2 v[86:87], v3, s[16:19], s24 offen offset:32
buffer_load_dwordx2 v[88:89], v3, s[16:19], s24 offen offset:64
buffer_load_dwordx2 v[90:91], v3, s[16:19], s24 offen offset:96
buffer_load_dwordx2 v[92:93], v3, s[16:19], s24 offen offset:128
s_waitcnt vmcnt(0)
v_lshlrev_b32 v94, 16, v84
v_and_b32 v95, 0xffff0000, v84
v_pk_add_f32 v[4:5], v[4:5], v[94:95]
v_lshlrev_b32 v94, 16, v85
v_and_b32 v95, 0xffff0000, v85
v_pk_add_f32 v[6:7], v[6:7], v[94:95]
v_lshlrev_b32 v94, 16, v86
v_and_b32 v95, 0xffff0000, v86
v_pk_add_f32 v[8:9], v[8:9], v[94:95]
v_lshlrev_b32 v94, 16, v87
v_and_b32 v95, 0xffff0000, v87
v_pk_add_f32 v[10:11], v[10:11], v[94:95]
v_lshlrev_b32 v94, 16, v88
v_and_b32 v95, 0xffff0000, v88
v_pk_add_f32 v[12:13], v[12:13], v[94:95]
v_lshlrev_b32 v94, 16, v89
v_and_b32 v95, 0xffff0000, v89
v_pk_add_f32 v[14:15], v[14:15], v[94:95]
v_lshlrev_b32 v94, 16, v90
v_and_b32 v95, 0xffff0000, v90
v_pk_add_f32 v[16:17], v[16:17], v[94:95]
v_lshlrev_b32 v94, 16, v91
v_and_b32 v95, 0xffff0000, v91
v_pk_add_f32 v[18:19], v[18:19], v[94:95]
v_lshlrev_b32 v94, 16, v92
v_and_b32 v95, 0xffff0000, v92
v_pk_add_f32 v[20:21], v[20:21], v[94:95]
v_lshlrev_b32 v94, 16, v93
v_and_b32 v95, 0xffff0000, v93
v_pk_add_f32 v[22:23], v[22:23], v[94:95]
s_mov_b32 s24, 30000
PL66:
buffer_load_dword v3, v236, s[4:7], 0 offen sc1
s_waitcnt vmcnt(0)
v_cmp_gt_u32 vcc, 4, v3
s_sub_u32 s24, s24, 1
s_cbranch_scc1 PD67
s_cbranch_vccnz PL66
PD67:
buffer_load_dwordx4 a[120:123], v1, s[4:7], s45 offen sc1
buffer_load_dwordx4 a[124:127], v1, s[4:7], s46 offen sc1
buffer_load_dwordx4 a[128:131], v1, s[4:7], s47 offen sc1
buffer_load_dwordx4 a[132:135], v1, s[4:7], s48 offen sc1
buffer_load_dwordx4 a[136:139], v1, s[4:7], s45 offen offset:1024 sc1
buffer_load_dwordx4 a[140:143], v1, s[4:7], s46 offen offset:1024 sc1
buffer_load_dwordx4 a[144:147], v1, s[4:7], s47 offen offset:1024 sc1
buffer_load_dwordx4 a[148:151], v1, s[4:7], s48 offen offset:1024 sc1
buffer_load_dwordx4 a[152:155], v1, s[4:7], s45 offen offset:2048 sc1
buffer_load_dwordx4 a[156:159], v1, s[4:7], s46 offen offset:2048 sc1
buffer_load_dwordx4 a[160:163], v1, s[4:7], s47 offen offset:2048 sc1
buffer_load_dwordx4 a[164:167], v1, s[4:7], s48 offen offset:2048 sc1
buffer_load_dwordx4 a[168:171], v1, s[4:7], s45 offen offset:3072 sc1
buffer_load_dwordx4 a[172:175], v1, s[4:7], s46 offen offset:3072 sc1
buffer_load_dwordx4 a[176:179], v1, s[4:7], s47 offen offset:3072 sc1
buffer_load_dwordx4 a[180:183], v1, s[4:7], s48 offen offset:3072 sc1
s_waitcnt vmcnt(15)
v_mfma_f32_16x16x32_bf16 v[24:27], a[184:187], a[120:123], 0
s_waitcnt vmcnt(14)
v_mfma_f32_16x16x32_bf16 v[44:47], a[184:187], a[124:127], 0
s_waitcnt vmcnt(13)
v_mfma_f32_16x16x32_bf16 v[64:67], a[184:187], a[128:131], 0
s_waitcnt vmcnt(12)
v_mfma_f32_16x16x32_bf16 v[4:7], a[184:187], a[132:135], v[4:7]
s_add_u32 s45, s45, 4096
buffer_load_dwordx4 a[184:187], v1, s[4:7], s45 offen sc1
v_mfma_f32_16x16x32_bf16 v[28:31], a[188:191], a[120:123], 0
v_mfma_f32_16x16x32_bf16 v[48:51], a[188:191], a[124:127], 0
v_mfma_f32_16x16x32_bf16 v[68:71], a[188:191], a[128:131], 0
v_mfma_f32_16x16x32_bf16 v[8:11], a[188:191], a[132:135], v[8:11]
s_add_u32 s46, s46, 4096
buffer_load_dwordx4 a[188:191], v1, s[4:7], s46 offen sc1
v_mfma_f32_16x16x32_bf16 v[32:35], a[192:195], a[120:123], 0
v_mfma_f32_16x16x32_bf16 v[52:55], a[192:195], a[124:127], 0
v_mfma_f32_16x16x32_bf16 v[72:75], a[192:195], a[128:131], 0
v_mfma_f32_16x16x32_bf16 v[12:15], a[192:195], a[132:135], v[12:15]
s_add_u32 s47, s47, 4096
buffer_load_dwordx4 a[192:195], v1, s[4:7], s47 offen sc1
v_mfma_f32_16x16x32_bf16 v[36:39], a[196:199], a[120:123], 0
v_mfma_f32_16x16x32_bf16 v[56:59], a[196:199], a[124:127], 0
v_mfma_f32_16x16x32_bf16 v[76:79], a[196:199], a[128:131], 0
v_mfma_f32_16x16x32_bf16 v[16:19], a[196:199], a[132:135], v[16:19]
s_add_u32 s48, s48, 4096
buffer_load_dwordx4 a[196:199], v1, s[4:7], s48 offen sc1
v_mfma_f32_16x16x32_bf16 v[40:43], a[200:203], a[120:123], 0
v_mfma_f32_16x16x32_bf16 v[60:63], a[200:203], a[124:127], 0
v_mfma_f32_16x16x32_bf16 v[80:83], a[200:203], a[128:131], 0
v_mfma_f32_16x16x32_bf16 v[20:23], a[200:203], a[132:135], v[20:23]
buffer_load_dwordx4 a[200:203], v1, s[4:7], s45 offen offset:1024 sc1
s_waitcnt vmcnt(16)
v_mfma_f32_16x16x32_bf16 v[24:27], a[204:207], a[136:139], v[24:27]
s_waitcnt vmcnt(15)
v_mfma_f32_16x16x32_bf16 v[44:47], a[204:207], a[140:143], v[44:47]
buffer_load_dwordx4 a[120:123], v1, s[4:7], s46 offen offset:1024 sc1
s_waitcnt vmcnt(15)
v_mfma_f32_16x16x32_bf16 v[64:67], a[204:207], a[144:147], v[64:67]
s_waitcnt vmcnt(14)
v_mfma_f32_16x16x32_bf16 v[4:7], a[204:207], a[148:151], v[4:7]
buffer_load_dwordx4 a[124:127], v1, s[4:7], s47 offen offset:1024 sc1
v_mfma_f32_16x16x32_bf16 v[28:31], a[208:211], a[136:139], v[28:31]
v_mfma_f32_16x16x32_bf16 v[48:51], a[208:211], a[140:143], v[48:51]
buffer_load_dwordx4 a[128:131], v1, s[4:7], s48 offen offset:1024 sc1
v_mfma_f32_16x16x32_bf16 v[68:71], a[208:211], a[144:147], v[68:71]
v_mfma_f32_16x16x32_bf16 v[8:11], a[208:211], a[148:151], v[8:11]
buffer_load_dwordx4 a[132:135], v1, s[4:7], s45 offen offset:2048 sc1
v_mfma_f32_16x16x32_bf16 v[32:35], a[212:215], a[136:139], v[32:35]
v_mfma_f32_16x16x32_bf16 v[52:55], a[212:215], a[140:143], v[52:55]
buffer_load_dwordx4 a[204:207], v1, s[4:7], s46 offen offset:2048 sc1
v_mfma_f32_16x16x32_bf16 v[72:75], a[212:215], a[144:147], v[72:75]
v_mfma_f32_16x16x32_bf16 v[12:15], a[212:215], a[148:151], v[12:15]
buffer_load_dwordx4 a[208:211], v1, s[4:7], s47 offen offset:2048 sc1
v_mfma_f32_16x16x32_bf16 v[36:39], a[216:219], a[136:139], v[36:39]
v_mfma_f32_16x16x32_bf16 v[56:59], a[216:219], a[140:143], v[56:59]
buffer_load_dwordx4 a[212:215], v1, s[4:7], s48 offen offset:2048 sc1
v_mfma_f32_16x16x32_bf16 v[76:79], a[216:219], a[144:147], v[76:79]
v_mfma_f32_16x16x32_bf16 v[16:19], a[216:219], a[148:151], v[16:19]
buffer_load_dwordx4 a[216:219], v1, s[4:7], s45 offen offset:3072 sc1
v_mfma_f32_16x16x32_bf16 v[40:43], a[220:223], a[136:139], v[40:43]
v_mfma_f32_16x16x32_bf16 v[60:63], a[220:223], a[140:143], v[60:63]
v_mfma_f32_16x16x32_bf16 v[80:83], a[220:223], a[144:147], v[80:83]
v_mfma_f32_16x16x32_bf16 v[20:23], a[220:223], a[148:151], v[20:23]
buffer_load_dwordx4 a[220:223], v1, s[4:7], s46 offen offset:3072 sc1
s_waitcnt vmcnt(21)
v_mfma_f32_16x16x32_bf16 v[24:27], a[224:227], a[152:155], v[24:27]
s_waitcnt vmcnt(20)
v_mfma_f32_16x16x32_bf16 v[44:47], a[224:227], a[156:159], v[44:47]
buffer_load_dwordx4 a[136:139], v1, s[4:7], s47 offen offset:3072 sc1
s_waitcnt vmcnt(20)
v_mfma_f32_16x16x32_bf16 v[64:67], a[224:227], a[160:163], v[64:67]
s_waitcnt vmcnt(19)
v_mfma_f32_16x16x32_bf16 v[4:7], a[224:227], a[164:167], v[4:7]
buffer_load_dwordx4 a[140:143], v1, s[4:7], s48 offen offset:3072 sc1
v_mfma_f32_16x16x32_bf16 v[28:31], a[228:231], a[152:155], v[28:31]
v_mfma_f32_16x16x32_bf16 v[48:51], a[228:231], a[156:159], v[48:51]
s_add_u32 s45, s45, 4096
buffer_load_dwordx4 a[144:147], v1, s[4:7], s45 offen sc1
v_mfma_f32_16x16x32_bf16 v[68:71], a[228:231], a[160:163], v[68:71]
v_mfma_f32_16x16x32_bf16 v[8:11], a[228:231], a[164:167], v[8:11]
s_add_u32 s46, s46, 4096
buffer_load_dwordx4 a[148:151], v1, s[4:7], s46 offen sc1
v_mfma_f32_16x16x32_bf16 v[32:35], a[232:235], a[152:155], v[32:35]
v_mfma_f32_16x16x32_bf16 v[52:55], a[232:235], a[156:159], v[52:55]
s_add_u32 s47, s47, 4096
buffer_load_dwordx4 a[224:227], v1, s[4:7], s47 offen sc1
v_mfma_f32_16x16x32_bf16 v[72:75], a[232:235], a[160:163], v[72:75]
v_mfma_f32_16x16x32_bf16 v[12:15], a[232:235], a[164:167], v[12:15]
s_add_u32 s48, s48, 4096
buffer_load_dwordx4 a[228:231], v1, s[4:7], s48 offen sc1
v_mfma_f32_16x16x32_bf16 v[36:39], a[236:239], a[152:155], v[36:39]
v_mfma_f32_16x16x32_bf16 v[56:59], a[236:239], a[156:159], v[56:59]
buffer_load_dwordx4 a[232:235], v1, s[4:7], s45 offen offset:1024 sc1
v_mfma_f32_16x16x32_bf16 v[76:79], a[236:239], a[160:163], v[76:79]
v_mfma_f32_16x16x32_bf16 v[16:19], a[236:239], a[164:167], v[16:19]
buffer_load_dwordx4 a[236:239], v1, s[4:7], s46 offen offset:1024 sc1
v_mfma_f32_16x16x32_bf16 v[40:43], a[240:243], a[152:155], v[40:43]
v_mfma_f32_16x16x32_bf16 v[60:63], a[240:243], a[156:159], v[60:63]
v_mfma_f32_16x16x32_bf16 v[80:83], a[240:243], a[160:163], v[80:83]
v_mfma_f32_16x16x32_bf16 v[20:23], a[240:243], a[164:167], v[20:23]
buffer_load_dwordx4 a[240:243], v1, s[4:7], s47 offen offset:1024 sc1
s_waitcnt vmcnt(26)
v_mfma_f32_16x16x32_bf16 v[24:27], a[244:247], a[168:171], v[24:27]
s_waitcnt vmcnt(25)
v_mfma_f32_16x16x32_bf16 v[44:47], a[244:247], a[172:175], v[44:47]
buffer_load_dwordx4 a[152:155], v1, s[4:7], s48 offen offset:1024 sc1
s_waitcnt vmcnt(25)
v_mfma_f32_16x16x32_bf16 v[64:67], a[244:247], a[176:179], v[64:67]
s_waitcnt vmcnt(24)
v_mfma_f32_16x16x32_bf16 v[4:7], a[244:247], a[180:183], v[4:7]
s_add_u32 s66, s66, 4096
buffer_load_dwordx4 a[156:159], v1, s[4:7], s66 offen
v_mfma_f32_16x16x32_bf16 v[28:31], a[248:251], a[168:171], v[28:31]
v_mfma_f32_16x16x32_bf16 v[48:51], a[248:251], a[172:175], v[48:51]
buffer_load_dwordx4 a[160:163], v1, s[4:7], s66 offen offset:1024
v_mfma_f32_16x16x32_bf16 v[68:71], a[248:251], a[176:179], v[68:71]
v_mfma_f32_16x16x32_bf16 v[8:11], a[248:251], a[180:183], v[8:11]
buffer_load_dwordx4 a[164:167], v1, s[4:7], s45 offen offset:2048 sc1
v_mfma_f32_16x16x32_bf16 v[32:35], a[252:255], a[168:171], v[32:35]
v_mfma_f32_16x16x32_bf16 v[52:55], a[252:255], a[172:175], v[52:55]
buffer_load_dwordx4 a[244:247], v1, s[4:7], s46 offen offset:2048 sc1
v_mfma_f32_16x16x32_bf16 v[72:75], a[252:255], a[176:179], v[72:75]
v_mfma_f32_16x16x32_bf16 v[12:15], a[252:255], a[180:183], v[12:15]
buffer_load_dwordx4 a[248:251], v1, s[4:7], s47 offen offset:2048 sc1
v_mfma_f32_16x16x32_bf16 v[36:39], a[0:3], a[168:171], v[36:39]
v_mfma_f32_16x16x32_bf16 v[56:59], a[0:3], a[172:175], v[56:59]
buffer_load_dwordx4 a[252:255], v1, s[4:7], s48 offen offset:2048 sc1
v_mfma_f32_16x16x32_bf16 v[76:79], a[0:3], a[176:179], v[76:79]
v_mfma_f32_16x16x32_bf16 v[16:19], a[0:3], a[180:183], v[16:19]
buffer_load_dwordx4 a[0:3], v1, s[4:7], s66 offen offset:2048
v_mfma_f32_16x16x32_bf16 v[40:43], a[4:7], a[168:171], v[40:43]
v_mfma_f32_16x16x32_bf16 v[60:63], a[4:7], a[172:175], v[60:63]
v_mfma_f32_16x16x32_bf16 v[80:83], a[4:7], a[176:179], v[80:83]
v_mfma_f32_16x16x32_bf16 v[20:23], a[4:7], a[180:183], v[20:23]
buffer_load_dwordx4 a[4:7], v1, s[4:7], s66 offen offset:3072
s_waitcnt vmcnt(31)
v_mfma_f32_16x16x32_bf16 v[24:27], a[8:11], a[184:187], v[24:27]
s_waitcnt vmcnt(30)
v_mfma_f32_16x16x32_bf16 v[44:47], a[8:11], a[188:191], v[44:47]
s_add_u32 s66, s66, 4096
buffer_load_dwordx4 a[168:171], v1, s[4:7], s66 offen
s_waitcnt vmcnt(30)
v_mfma_f32_16x16x32_bf16 v[64:67], a[8:11], a[192:195], v[64:67]
s_waitcnt vmcnt(29)
v_mfma_f32_16x16x32_bf16 v[4:7], a[8:11], a[196:199], v[4:7]
buffer_load_dwordx4 a[172:175], v1, s[4:7], s66 offen offset:1024
v_mfma_f32_16x16x32_bf16 v[28:31], a[12:15], a[184:187], v[28:31]
v_mfma_f32_16x16x32_bf16 v[48:51], a[12:15], a[188:191], v[48:51]
buffer_load_dwordx4 a[176:179], v1, s[4:7], s66 offen offset:2048
v_mfma_f32_16x16x32_bf16 v[68:71], a[12:15], a[192:195], v[68:71]
v_mfma_f32_16x16x32_bf16 v[8:11], a[12:15], a[196:199], v[8:11]
buffer_load_dwordx4 a[180:183], v1, s[4:7], s45 offen offset:3072 sc1
v_mfma_f32_16x16x32_bf16 v[32:35], a[16:19], a[184:187], v[32:35]
v_mfma_f32_16x16x32_bf16 v[52:55], a[16:19], a[188:191], v[52:55]
buffer_load_dwordx4 a[8:11], v1, s[4:7], s46 offen offset:3072 sc1
v_mfma_f32_16x16x32_bf16 v[72:75], a[16:19], a[192:195], v[72:75]
v_mfma_f32_16x16x32_bf16 v[12:15], a[16:19], a[196:199], v[12:15]
buffer_load_dwordx4 a[12:15], v1, s[4:7], s47 offen offset:3072 sc1
v_mfma_f32_16x16x32_bf16 v[36:39], a[20:23], a[184:187], v[36:39]
v_mfma_f32_16x16x32_bf16 v[56:59], a[20:23], a[188:191], v[56:59]
buffer_load_dwordx4 a[16:19], v1, s[4:7], s48 offen offset:3072 sc1
v_mfma_f32_16x16x32_bf16 v[76:79], a[20:23], a[192:195], v[76:79]
v_mfma_f32_16x16x32_bf16 v[16:19], a[20:23], a[196:199], v[16:19]
buffer_load_dwordx4 a[20:23], v1, s[4:7], s66 offen offset:3072
v_mfma_f32_16x16x32_bf16 v[40:43], a[24:27], a[184:187], v[40:43]
v_mfma_f32_16x16x32_bf16 v[60:63], a[24:27], a[188:191], v[60:63]
v_mfma_f32_16x16x32_bf16 v[80:83], a[24:27], a[192:195], v[80:83]
v_mfma_f32_16x16x32_bf16 v[20:23], a[24:27], a[196:199], v[20:23]
s_add_u32 s66, s66, 4096
buffer_load_dwordx4 a[24:27], v1, s[4:7], s66 offen
s_waitcnt vmcnt(36)
v_mfma_f32_16x16x32_bf16 v[24:27], a[28:31], a[200:203], v[24:27]
s_waitcnt vmcnt(35)
v_mfma_f32_16x16x32_bf16 v[44:47], a[28:31], a[120:123], v[44:47]
buffer_load_dwordx4 a[184:187], v1, s[4:7], s66 offen offset:1024
s_waitcnt vmcnt(35)
v_mfma_f32_16x16x32_bf16 v[64:67], a[28:31], a[124:127], v[64:67]
s_waitcnt vmcnt(34)
v_mfma_f32_16x16x32_bf16 v[4:7], a[28:31], a[128:131], v[4:7]
buffer_load_dwordx4 a[188:191], v1, s[4:7], s66 offen offset:2048
v_mfma_f32_16x16x32_bf16 v[28:31], a[32:35], a[200:203], v[28:31]
v_mfma_f32_16x16x32_bf16 v[48:51], a[32:35], a[120:123], v[48:51]
buffer_load_dwordx4 a[192:195], v1, s[4:7], s66 offen offset:3072
v_mfma_f32_16x16x32_bf16 v[68:71], a[32:35], a[124:127], v[68:71]
v_mfma_f32_16x16x32_bf16 v[8:11], a[32:35], a[128:131], v[8:11]
s_add_u32 s45, s45, 4096
buffer_load_dwordx4 a[196:199], v1, s[4:7], s45 offen sc1
v_mfma_f32_16x16x32_bf16 v[32:35], a[36:39], a[200:203], v[32:35]
v_mfma_f32_16x16x32_bf16 v[52:55], a[36:39], a[120:123], v[52:55]
s_add_u32 s46, s46, 4096
buffer_load_dwordx4 a[28:31], v1, s[4:7], s46 offen sc1
v_mfma_f32_16x16x32_bf16 v[72:75], a[36:39], a[124:127], v[72:75]
v_mfma_f32_16x16x32_bf16 v[12:15], a[36:39], a[128:131], v[12:15]
s_add_u32 s47, s47, 4096
buffer_load_dwordx4 a[32:35], v1, s[4:7], s47 offen sc1
v_mfma_f32_16x16x32_bf16 v[36:39], a[40:43], a[200:203], v[36:39]
v_mfma_f32_16x16x32_bf16 v[56:59], a[40:43], a[120:123], v[56:59]
s_add_u32 s48, s48, 4096
buffer_load_dwordx4 a[36:39], v1, s[4:7], s48 offen sc1
v_mfma_f32_16x16x32_bf16 v[76:79], a[40:43], a[124:127], v[76:79]
v_mfma_f32_16x16x32_bf16 v[16:19], a[40:43], a[128:131], v[16:19]
s_add_u32 s66, s66, 4096
buffer_load_dwordx4 a[40:43], v1, s[4:7], s66 offen
v_mfma_f32_16x16x32_bf16 v[40:43], a[44:47], a[200:203], v[40:43]
v_mfma_f32_16x16x32_bf16 v[60:63], a[44:47], a[120:123], v[60:63]
v_mfma_f32_16x16x32_bf16 v[80:83], a[44:47], a[124:127], v[80:83]
v_mfma_f32_16x16x32_bf16 v[20:23], a[44:47], a[128:131], v[20:23]
buffer_load_dwordx4 a[44:47], v1, s[4:7], s66 offen offset:1024
s_waitcnt vmcnt(41)
v_mfma_f32_16x16x32_bf16 v[24:27], a[48:51], a[132:135], v[24:27]
s_waitcnt vmcnt(40)
v_mfma_f32_16x16x32_bf16 v[44:47], a[48:51], a[204:207], v[44:47]
buffer_load_dwordx4 a[200:203], v1, s[4:7], s66 offen offset:2048
s_waitcnt vmcnt(40)
v_mfma_f32_16x16x32_bf16 v[64:67], a[48:51], a[208:211], v[64:67]
s_waitcnt vmcnt(39)
v_mfma_f32_16x16x32_bf16 v[4:7], a[48:51], a[212:215], v[4:7]
buffer_load_dwordx4 a[120:123], v1, s[4:7], s66 offen offset:3072
v_mfma_f32_16x16x32_bf16 v[28:31], a[52:55], a[132:135], v[28:31]
v_mfma_f32_16x16x32_bf16 v[48:51], a[52:55], a[204:207], v[48:51]
s_add_u32 s66, s66, 4096
buffer_load_dwordx4 a[124:127], v1, s[4:7], s66 offen
v_mfma_f32_16x16x32_bf16 v[68:71], a[52:55], a[208:211], v[68:71]
v_mfma_f32_16x16x32_bf16 v[8:11], a[52:55], a[212:215], v[8:11]
buffer_load_dwordx4 a[128:131], v1, s[4:7], s45 offen offset:1024 sc1
v_mfma_f32_16x16x32_bf16 v[32:35], a[56:59], a[132:135], v[32:35]
v_mfma_f32_16x16x32_bf16 v[52:55], a[56:59], a[204:207], v[52:55]
buffer_load_dwordx4 a[48:51], v1, s[4:7], s46 offen offset:1024 sc1
v_mfma_f32_16x16x32_bf16 v[72:75], a[56:59], a[208:211], v[72:75]
v_mfma_f32_16x16x32_bf16 v[12:15], a[56:59], a[212:215], v[12:15]
buffer_load_dwordx4 a[52:55], v1, s[4:7], s47 offen offset:1024 sc1
v_mfma_f32_16x16x32_bf16 v[36:39], a[60:63], a[132:135], v[36:39]
v_mfma_f32_16x16x32_bf16 v[56:59], a[60:63], a[204:207], v[56:59]
buffer_load_dwordx4 a[56:59], v1, s[4:7], s48 offen offset:1024 sc1
v_mfma_f32_16x16x32_bf16 v[76:79], a[60:63], a[208:211], v[76:79]
v_mfma_f32_16x16x32_bf16 v[16:19], a[60:63], a[212:215], v[16:19]
buffer_load_dwordx4 a[60:63], v1, s[4:7], s66 offen offset:1024
v_mfma_f32_16x16x32_bf16 v[40:43], a[64:67], a[132:135], v[40:43]
v_mfma_f32_16x16x32_bf16 v[60:63], a[64:67], a[204:207], v[60:63]
v_mfma_f32_16x16x32_bf16 v[80:83], a[64:67], a[208:211], v[80:83]
v_mfma_f32_16x16x32_bf16 v[20:23], a[64:67], a[212:215], v[20:23]
buffer_load_dwordx4 a[64:67], v1, s[4:7], s66 offen offset:2048
s_waitcnt vmcnt(46)
v_mfma_f32_16x16x32_bf16 v[24:27], a[104:107], a[216:219], v[24:27]
s_waitcnt vmcnt(45)
v_mfma_f32_16x16x32_bf16 v[44:47], a[104:107], a[220:223], v[44:47]
buffer_load_dwordx4 a[132:135], v1, s[4:7], s66 offen offset:3072
s_waitcnt vmcnt(45)
v_mfma_f32_16x16x32_bf16 v[64:67], a[104:107], a[136:139], v[64:67]
s_waitcnt vmcnt(44)
v_mfma_f32_16x16x32_bf16 v[4:7], a[104:107], a[140:143], v[4:7]
s_add_u32 s66, s66, 4096
buffer_load_dwordx4 a[204:207], v1, s[4:7], s66 offen
v_mfma_f32_16x16x32_bf16 v[28:31], a[108:111], a[216:219], v[28:31]
v_mfma_f32_16x16x32_bf16 v[48:51], a[108:111], a[220:223], v[48:51]
buffer_load_dwordx4 a[208:211], v1, s[4:7], s66 offen offset:1024
v_mfma_f32_16x16x32_bf16 v[68:71], a[108:111], a[136:139], v[68:71]
v_mfma_f32_16x16x32_bf16 v[8:11], a[108:111], a[140:143], v[8:11]
v_mfma_f32_16x16x32_bf16 v[32:35], a[112:115], a[216:219], v[32:35]
v_mfma_f32_16x16x32_bf16 v[52:55], a[112:115], a[220:223], v[52:55]
v_mfma_f32_16x16x32_bf16 v[72:75], a[112:115], a[136:139], v[72:75]
v_mfma_f32_16x16x32_bf16 v[12:15], a[112:115], a[140:143], v[12:15]
v_mfma_f32_16x16x32_bf16 v[36:39], a[68:71], a[216:219], v[36:39]
v_mfma_f32_16x16x32_bf16 v[56:59], a[68:71], a[220:223], v[56:59]
v_mfma_f32_16x16x32_bf16 v[76:79], a[68:71], a[136:139], v[76:79]
v_mfma_f32_16x16x32_bf16 v[16:19], a[68:71], a[140:143], v[16:19]
v_mfma_f32_16x16x32_bf16 v[40:43], a[72:75], a[216:219], v[40:43]
v_mfma_f32_16x16x32_bf16 v[60:63], a[72:75], a[220:223], v[60:63]
v_mfma_f32_16x16x32_bf16 v[80:83], a[72:75], a[136:139], v[80:83]
v_mfma_f32_16x16x32_bf16 v[20:23], a[72:75], a[140:143], v[20:23]
s_waitcnt vmcnt(45)
v_mfma_f32_16x16x32_bf16 v[24:27], a[76:79], a[144:147], v[24:27]
s_waitcnt vmcnt(44)
v_mfma_f32_16x16x32_bf16 v[44:47], a[76:79], a[148:151], v[44:47]
s_waitcnt vmcnt(43)
v_mfma_f32_16x16x32_bf16 v[64:67], a[76:79], a[224:227], v[64:67]
s_waitcnt vmcnt(42)
v_mfma_f32_16x16x32_bf16 v[4:7], a[76:79], a[228:231], v[4:7]
v_mfma_f32_16x16x32_bf16 v[28:31], a[80:83], a[144:147], v[28:31]
v_mfma_f32_16x16x32_bf16 v[48:51], a[80:83], a[148:151], v[48:51]
v_mfma_f32_16x16x32_bf16 v[68:71], a[80:83], a[224:227], v[68:71]
v_mfma_f32_16x16x32_bf16 v[8:11], a[80:83], a[228:231], v[8:11]
v_mfma_f32_16x16x32_bf16 v[32:35], a[84:87], a[144:147], v[32:35]
v_mfma_f32_16x16x32_bf16 v[52:55], a[84:87], a[148:151], v[52:55]
v_mfma_f32_16x16x32_bf16 v[72:75], a[84:87], a[224:227], v[72:75]
v_mfma_f32_16x16x32_bf16 v[12:15], a[84:87], a[228:231], v[12:15]
v_mfma_f32_16x16x32_bf16 v[36:39], a[88:91], a[144:147], v[36:39]
v_mfma_f32_16x16x32_bf16 v[56:59], a[88:91], a[148:151], v[56:59]
v_mfma_f32_16x16x32_bf16 v[76:79], a[88:91], a[224:227], v[76:79]
v_mfma_f32_16x16x32_bf16 v[16:19], a[88:91], a[228:231], v[16:19]
v_mfma_f32_16x16x32_bf16 v[40:43], a[92:95], a[144:147], v[40:43]
v_mfma_f32_16x16x32_bf16 v[60:63], a[92:95], a[148:151], v[60:63]
v_mfma_f32_16x16x32_bf16 v[80:83], a[92:95], a[224:227], v[80:83]
v_mfma_f32_16x16x32_bf16 v[20:23], a[92:95], a[228:231], v[20:23]
s_waitcnt vmcnt(41)
v_mfma_f32_16x16x32_bf16 v[24:27], a[96:99], a[232:235], v[24:27]
s_waitcnt vmcnt(40)
v_mfma_f32_16x16x32_bf16 v[44:47], a[96:99], a[236:239], v[44:47]
s_waitcnt vmcnt(39)
v_mfma_f32_16x16x32_bf16 v[64:67], a[96:99], a[240:243], v[64:67]
s_waitcnt vmcnt(38)
v_mfma_f32_16x16x32_bf16 v[4:7], a[96:99], a[152:155], v[4:7]
v_mfma_f32_16x16x32_bf16 v[28:31], a[100:103], a[232:235], v[28:31]
v_mfma_f32_16x16x32_bf16 v[48:51], a[100:103], a[236:239], v[48:51]
v_mfma_f32_16x16x32_bf16 v[68:71], a[100:103], a[240:243], v[68:71]
v_mfma_f32_16x16x32_bf16 v[8:11], a[100:103], a[152:155], v[8:11]
v_mfma_f32_16x16x32_bf16 v[32:35], a[116:119], a[232:235], v[32:35]
v_mfma_f32_16x16x32_bf16 v[52:55], a[116:119], a[236:239], v[52:55]
v_mfma_f32_16x16x32_bf16 v[72:75], a[116:119], a[240:243], v[72:75]
v_mfma_f32_16x16x32_bf16 v[12:15], a[116:119], a[152:155], v[12:15]
s_waitcnt vmcnt(37)
v_mfma_f32_16x16x32_bf16 v[36:39], a[156:159], a[232:235], v[36:39]
v_mfma_f32_16x16x32_bf16 v[56:59], a[156:159], a[236:239], v[56:59]
v_mfma_f32_16x16x32_bf16 v[76:79], a[156:159], a[240:243], v[76:79]
v_mfma_f32_16x16x32_bf16 v[16:19], a[156:159], a[152:155], v[16:19]
s_waitcnt vmcnt(36)
v_mfma_f32_16x16x32_bf16 v[40:43], a[160:163], a[232:235], v[40:43]
v_mfma_f32_16x16x32_bf16 v[60:63], a[160:163], a[236:239], v[60:63]
v_mfma_f32_16x16x32_bf16 v[80:83], a[160:163], a[240:243], v[80:83]
v_mfma_f32_16x16x32_bf16 v[20:23], a[160:163], a[152:155], v[20:23]
s_waitcnt vmcnt(31)
v_mfma_f32_16x16x32_bf16 v[24:27], a[0:3], a[164:167], v[24:27]
v_mfma_f32_16x16x32_bf16 v[44:47], a[0:3], a[244:247], v[44:47]
v_mfma_f32_16x16x32_bf16 v[64:67], a[0:3], a[248:251], v[64:67]
v_mfma_f32_16x16x32_bf16 v[4:7], a[0:3], a[252:255], v[4:7]
s_waitcnt vmcnt(30)
v_mfma_f32_16x16x32_bf16 v[28:31], a[4:7], a[164:167], v[28:31]
v_mfma_f32_16x16x32_bf16 v[48:51], a[4:7], a[244:247], v[48:51]
v_mfma_f32_16x16x32_bf16 v[68:71], a[4:7], a[248:251], v[68:71]
v_mfma_f32_16x16x32_bf16 v[8:11], a[4:7], a[252:255], v[8:11]
s_waitcnt vmcnt(29)
v_mfma_f32_16x16x32_bf16 v[32:35], a[168:171], a[164:167], v[32:35]
v_mfma_f32_16x16x32_bf16 v[52:55], a[168:171], a[244:247], v[52:55]
v_mfma_f32_16x16x32_bf16 v[72:75], a[168:171], a[248:251], v[72:75]
v_mfma_f32_16x16x32_bf16 v[12:15], a[168:171], a[252:255], v[12:15]
s_waitcnt vmcnt(28)
v_mfma_f32_16x16x32_bf16 v[36:39], a[172:175], a[164:167], v[36:39]
v_mfma_f32_16x16x32_bf16 v[56:59], a[172:175], a[244:247], v[56:59]
v_mfma_f32_16x16x32_bf16 v[76:79], a[172:175], a[248:251], v[76:79]
v_mfma_f32_16x16x32_bf16 v[16:19], a[172:175], a[252:255], v[16:19]
s_waitcnt vmcnt(27)
v_mfma_f32_16x16x32_bf16 v[40:43], a[176:179], a[164:167], v[40:43]
v_mfma_f32_16x16x32_bf16 v[60:63], a[176:179], a[244:247], v[60:63]
v_mfma_f32_16x16x32_bf16 v[80:83], a[176:179], a[248:251], v[80:83]
v_mfma_f32_16x16x32_bf16 v[20:23], a[176:179], a[252:255], v[20:23]
s_waitcnt vmcnt(22)
v_mfma_f32_16x16x32_bf16 v[24:27], a[20:23], a[180:183], v[24:27]
v_mfma_f32_16x16x32_bf16 v[44:47], a[20:23], a[8:11], v[44:47]
v_mfma_f32_16x16x32_bf16 v[64:67], a[20:23], a[12:15], v[64:67]
v_mfma_f32_16x16x32_bf16 v[4:7], a[20:23], a[16:19], v[4:7]
s_waitcnt vmcnt(21)
v_mfma_f32_16x16x32_bf16 v[28:31], a[24:27], a[180:183], v[28:31]
v_mfma_f32_16x16x32_bf16 v[48:51], a[24:27], a[8:11], v[48:51]
v_mfma_f32_16x16x32_bf16 v[68:71], a[24:27], a[12:15], v[68:71]
v_mfma_f32_16x16x32_bf16 v[8:11], a[24:27], a[16:19], v[8:11]
s_waitcnt vmcnt(20)
v_mfma_f32_16x16x32_bf16 v[32:35], a[184:187], a[180:183], v[32:35]
v_mfma_f32_16x16x32_bf16 v[52:55], a[184:187], a[8:11], v[52:55]
v_mfma_f32_16x16x32_bf16 v[72:75], a[184:187], a[12:15], v[72:75]
v_mfma_f32_16x16x32_bf16 v[12:15], a[184:187], a[16:19], v[12:15]
s_waitcnt vmcnt(19)
v_mfma_f32_16x16x32_bf16 v[36:39], a[188:191], a[180:183], v[36:39]
v_mfma_f32_16x16x32_bf16 v[56:59], a[188:191], a[8:11], v[56:59]
v_mfma_f32_16x16x32_bf16 v[76:79], a[188:191], a[12:15], v[76:79]
v_mfma_f32_16x16x32_bf16 v[16:19], a[188:191], a[16:19], v[16:19]
s_waitcnt vmcnt(18)
v_mfma_f32_16x16x32_bf16 v[40:43], a[192:195], a[180:183], v[40:43]
v_mfma_f32_16x16x32_bf16 v[60:63], a[192:195], a[8:11], v[60:63]
v_mfma_f32_16x16x32_bf16 v[80:83], a[192:195], a[12:15], v[80:83]
v_mfma_f32_16x16x32_bf16 v[20:23], a[192:195], a[16:19], v[20:23]
s_waitcnt vmcnt(13)
v_mfma_f32_16x16x32_bf16 v[24:27], a[40:43], a[196:199], v[24:27]
v_mfma_f32_16x16x32_bf16 v[44:47], a[40:43], a[28:31], v[44:47]
v_mfma_f32_16x16x32_bf16 v[64:67], a[40:43], a[32:35], v[64:67]
v_mfma_f32_16x16x32_bf16 v[4:7], a[40:43], a[36:39], v[4:7]
s_waitcnt vmcnt(12)
v_mfma_f32_16x16x32_bf16 v[28:31], a[44:47], a[196:199], v[28:31]
v_mfma_f32_16x16x32_bf16 v[48:51], a[44:47], a[28:31], v[48:51]
v_mfma_f32_16x16x32_bf16 v[68:71], a[44:47], a[32:35], v[68:71]
v_mfma_f32_16x16x32_bf16 v[8:11], a[44:47], a[36:39], v[8:11]
s_waitcnt vmcnt(11)
v_mfma_f32_16x16x32_bf16 v[32:35], a[200:203], a[196:199], v[32:35]
v_mfma_f32_16x16x32_bf16 v[52:55], a[200:203], a[28:31], v[52:55]
v_mfma_f32_16x16x32_bf16 v[72:75], a[200:203], a[32:35], v[72:75]
v_mfma_f32_16x16x32_bf16 v[12:15], a[200:203], a[36:39], v[12:15]
s_waitcnt vmcnt(10)
v_mfma_f32_16x16x32_bf16 v[36:39], a[120:123], a[196:199], v[36:39]
v_mfma_f32_16x16x32_bf16 v[56:59], a[120:123], a[28:31], v[56:59]
v_mfma_f32_16x16x32_bf16 v[76:79], a[120:123], a[32:35], v[76:79]
v_mfma_f32_16x16x32_bf16 v[16:19], a[120:123], a[36:39], v[16:19]
s_waitcnt vmcnt(9)
v_mfma_f32_16x16x32_bf16 v[40:43], a[124:127], a[196:199], v[40:43]
v_mfma_f32_16x16x32_bf16 v[60:63], a[124:127], a[28:31], v[60:63]
v_mfma_f32_16x16x32_bf16 v[80:83], a[124:127], a[32:35], v[80:83]
v_mfma_f32_16x16x32_bf16 v[20:23], a[124:127], a[36:39], v[20:23]
s_waitcnt vmcnt(8)
s_waitcnt vmcnt(7)
s_waitcnt vmcnt(6)
s_waitcnt vmcnt(5)
s_waitcnt vmcnt(4)
s_waitcnt vmcnt(3)
s_waitcnt vmcnt(2)
s_waitcnt vmcnt(1)
s_waitcnt vmcnt(0)
s_cmp_ge_u32 s22, 2
s_cbranch_scc1 SK68
v_mfma_f32_16x16x32_bf16 v[24:27], a[60:63], a[128:131], v[24:27]
v_mfma_f32_16x16x32_bf16 v[44:47], a[60:63], a[48:51], v[44:47]
v_mfma_f32_16x16x32_bf16 v[64:67], a[60:63], a[52:55], v[64:67]
v_mfma_f32_16x16x32_bf16 v[4:7], a[60:63], a[56:59], v[4:7]
v_mfma_f32_16x16x32_bf16 v[28:31], a[64:67], a[128:131], v[28:31]
v_mfma_f32_16x16x32_bf16 v[48:51], a[64:67], a[48:51], v[48:51]
v_mfma_f32_16x16x32_bf16 v[68:71], a[64:67], a[52:55], v[68:71]
v_mfma_f32_16x16x32_bf16 v[8:11], a[64:67], a[56:59], v[8:11]
v_mfma_f32_16x16x32_bf16 v[32:35], a[132:135], a[128:131], v[32:35]
v_mfma_f32_16x16x32_bf16 v[52:55], a[132:135], a[48:51], v[52:55]
v_mfma_f32_16x16x32_bf16 v[72:75], a[132:135], a[52:55], v[72:75]
v_mfma_f32_16x16x32_bf16 v[12:15], a[132:135], a[56:59], v[12:15]
v_mfma_f32_16x16x32_bf16 v[36:39], a[204:207], a[128:131], v[36:39]
v_mfma_f32_16x16x32_bf16 v[56:59], a[204:207], a[48:51], v[56:59]
v_mfma_f32_16x16x32_bf16 v[76:79], a[204:207], a[52:55], v[76:79]
v_mfma_f32_16x16x32_bf16 v[16:19], a[204:207], a[56:59], v[16:19]
v_mfma_f32_16x16x32_bf16 v[40:43], a[208:211], a[128:131], v[40:43]
v_mfma_f32_16x16x32_bf16 v[60:63], a[208:211], a[48:51], v[60:63]
v_mfma_f32_16x16x32_bf16 v[80:83], a[208:211], a[52:55], v[80:83]
v_mfma_f32_16x16x32_bf16 v[20:23], a[208:211], a[56:59], v[20:23]
s_nop 7
SK68:
s_mul_i32 s24, s68, 307200
s_add_u32 s24, s24, 0
s_mul_i32 s25, s22, 20480
s_add_u32 s40, s24, s25
s_add_u32 s41, s40, 81920
s_add_u32 s42, s40, 163840
s_add_u32 s43, s40, 245760
buffer_load_dwordx4 a[212:215], v1, s[4:7], s40 offen
buffer_load_dwordx4 a[104:107], v1, s[4:7], s41 offen
buffer_load_dwordx4 a[108:111], v1, s[4:7], s40 offen offset:1024
buffer_load_dwordx4 a[112:115], v1, s[4:7], s41 offen offset:1024
buffer_load_dwordx4 a[68:71], v1, s[4:7], s40 offen offset:2048
buffer_load_dwordx4 a[72:75], v1, s[4:7], s41 offen offset:2048
buffer_load_dwordx4 a[216:219], v1, s[4:7], s40 offen offset:3072
buffer_load_dwordx4 a[220:223], v1, s[4:7], s41 offen offset:3072
s_add_u32 s40, s40, 4096
buffer_load_dwordx4 a[136:139], v1, s[4:7], s40 offen
s_add_u32 s41, s41, 4096
buffer_load_dwordx4 a[140:143], v1, s[4:7], s41 offen
buffer_load_dwordx4 a[76:79], v1, s[4:7], s40 offen offset:1024
buffer_load_dwordx4 a[80:83], v1, s[4:7], s41 offen offset:1024
buffer_load_dwordx4 a[84:87], v1, s[4:7], s40 offen offset:2048
buffer_load_dwordx4 a[88:91], v1, s[4:7], s41 offen offset:2048
buffer_load_dwordx4 a[92:95], v1, s[4:7], s40 offen offset:3072
buffer_load_dwordx4 a[144:147], v1, s[4:7], s41 offen offset:3072
s_add_u32 s24, s22, 1
s_and_b32 s24, s24, 3
s_mul_i32 s24, s24, 15360
v_add_u32 v3, s24, v1
ds_write_b128 v3, v[24:27] offset:0
ds_write_b128 v3, v[28:31] offset:1024
ds_write_b128 v3, v[32:35] offset:2048
ds_write_b128 v3, v[36:39] offset:3072
ds_write_b128 v3, v[40:43] offset:4096
s_add_u32 s24, s22, 2
s_and_b32 s24, s24, 3
s_mul_i32 s24, s24, 15360
v_add_u32 v3, s24, v1
ds_write_b128 v3, v[44:47] offset:5120
ds_write_b128 v3, v[48:51] offset:6144
ds_write_b128 v3, v[52:55] offset:7168
ds_write_b128 v3, v[56:59] offset:8192
ds_write_b128 v3, v[60:63] offset:9216
s_add_u32 s24, s22, 3
s_and_b32 s24, s24, 3
s_mul_i32 s24, s24, 15360
v_add_u32 v3, s24, v1
ds_write_b128 v3, v[64:67] offset:10240
ds_write_b128 v3, v[68:71] offset:11264
ds_write_b128 v3, v[72:75] offset:12288
ds_write_b128 v3, v[76:79] offset:13312
ds_write_b128 v3, v[80:83] offset:14336
s_mul_i32 s24, s22, 15360
v_add_u32 v3, s24, v1
s_waitcnt lgkmcnt(0)
s_barrier
ds_read_b128 v[24:27], v3 offset:0
ds_read_b128 v[28:31], v3 offset:1024
ds_read_b128 v[32:35], v3 offset:2048
ds_read_b128 v[36:39], v3 offset:3072
ds_read_b128 v[40:43], v3 offset:4096
ds_read_b128 v[44:47], v3 offset:5120
ds_read_b128 v[48:51], v3 offset:6144
ds_read_b128 v[52:55], v3 offset:7168
ds_read_b128 v[56:59], v3 offset:8192
ds_read_b128 v[60:63], v3 offset:9216
ds_read_b128 v[64:67], v3 offset:10240
ds_read_b128 v[68:71], v3 offset:11264
ds_read_b128 v[72:75], v3 offset:12288
ds_read_b128 v[76:79], v3 offset:13312
ds_read_b128 v[80:83], v3 offset:14336
s_waitcnt lgkmcnt(14)
v_pk_add_f32 v[4:5], v[4:5], v[24:25]
v_pk_add_f32 v[6:7], v[6:7], v[26:27]
s_waitcnt lgkmcnt(13)
v_pk_add_f32 v[8:9], v[8:9], v[28:29]
v_pk_add_f32 v[10:11], v[10:11], v[30:31]
s_waitcnt lgkmcnt(12)
v_pk_add_f32 v[12:13], v[12:13], v[32:33]
v_pk_add_f32 v[14:15], v[14:15], v[34:35]
s_waitcnt lgkmcnt(11)
v_pk_add_f32 v[16:17], v[16:17], v[36:37]
v_pk_add_f32 v[18:19], v[18:19], v[38:39]
s_waitcnt lgkmcnt(10)
v_pk_add_f32 v[20:21], v[20:21], v[40:41]
v_pk_add_f32 v[22:23], v[22:23], v[42:43]
s_waitcnt lgkmcnt(9)
v_pk_add_f32 v[4:5], v[4:5], v[44:45]
v_pk_add_f32 v[6:7], v[6:7], v[46:47]
s_waitcnt lgkmcnt(8)
v_pk_add_f32 v[8:9], v[8:9], v[48:49]
v_pk_add_f32 v[10:11], v[10:11], v[50:51]
s_waitcnt lgkmcnt(7)
v_pk_add_f32 v[12:13], v[12:13], v[52:53]
v_pk_add_f32 v[14:15], v[14:15], v[54:55]
s_waitcnt lgkmcnt(6)
v_pk_add_f32 v[16:17], v[16:17], v[56:57]
v_pk_add_f32 v[18:19], v[18:19], v[58:59]
s_waitcnt lgkmcnt(5)
v_pk_add_f32 v[20:21], v[20:21], v[60:61]
v_pk_add_f32 v[22:23], v[22:23], v[62:63]
s_waitcnt lgkmcnt(4)
v_pk_add_f32 v[4:5], v[4:5], v[64:65]
v_pk_add_f32 v[6:7], v[6:7], v[66:67]
s_waitcnt lgkmcnt(3)
v_pk_add_f32 v[8:9], v[8:9], v[68:69]
v_pk_add_f32 v[10:11], v[10:11], v[70:71]
s_waitcnt lgkmcnt(2)
v_pk_add_f32 v[12:13], v[12:13], v[72:73]
v_pk_add_f32 v[14:15], v[14:15], v[74:75]
s_waitcnt lgkmcnt(1)
v_pk_add_f32 v[16:17], v[16:17], v[76:77]
v_pk_add_f32 v[18:19], v[18:19], v[78:79]
s_waitcnt lgkmcnt(0)
v_pk_add_f32 v[20:21], v[20:21], v[80:81]
v_pk_add_f32 v[22:23], v[22:23], v[82:83]
v_cvt_pk_bf16_f32 v24, v4, v5
v_cvt_pk_bf16_f32 v25, v6, v7
v_cvt_pk_bf16_f32 v26, v8, v9
v_cvt_pk_bf16_f32 v27, v10, v11
v_cvt_pk_bf16_f32 v28, v12, v13
v_cvt_pk_bf16_f32 v29, v14, v15
v_cvt_pk_bf16_f32 v30, v16, v17
v_cvt_pk_bf16_f32 v31, v18, v19
v_cvt_pk_bf16_f32 v32, v20, v21
v_cvt_pk_bf16_f32 v33, v22, v23
s_mul_i32 s24, s62, 20480
s_add_u32 s24, s24, 10346496
s_lshl_b32 s25, s21, 11
s_add_u32 s25, s25, s24
s_lshr_b32 s26, s21, 1
s_lshl_b32 s26, s26, 10
s_and_b32 s27, s21, 1
s_lshl_b32 s27, s27, 9
s_add_u32 s26, s26, s27
s_add_u32 s26, s26, 16384
s_add_u32 s26, s26, s24
s_cmp_eq_u32 s72, 0
s_cbranch_scc1 XS69
buffer_store_dwordx4 v[24:27], v1, s[4:7], s25 offen
s_branch XE70
XS69:
buffer_store_dwordx4 v[24:27], v1, s[4:7], s25 offen sc1
XE70:
s_cmp_eq_u32 s72, 0
s_cbranch_scc1 XS71
buffer_store_dwordx4 v[28:31], v1, s[4:7], s25 offen offset:1024
s_branch XE72
XS71:
buffer_store_dwordx4 v[28:31], v1, s[4:7], s25 offen offset:1024 sc1
XE72:
s_cmp_eq_u32 s72, 0
s_cbranch_scc1 XS73
buffer_store_dwordx2 v[32:33], v2, s[4:7], s26 offen
s_branch XE74
XS73:
buffer_store_dwordx2 v[32:33], v2, s[4:7], s26 offen sc1
XE74:
v_pk_mul_f32 v[36:37], v[4:5], v[4:5]
v_pk_add_f32 v[34:35], v[4:5], v[6:7]
v_pk_fma_f32 v[36:37], v[6:7], v[6:7], v[36:37]
v_pk_add_f32 v[34:35], v[34:35], v[8:9]
v_pk_fma_f32 v[36:37], v[8:9], v[8:9], v[36:37]
v_pk_add_f32 v[34:35], v[34:35], v[10:11]
v_pk_fma_f32 v[36:37], v[10:11], v[10:11], v[36:37]
v_pk_add_f32 v[34:35], v[34:35], v[12:13]
v_pk_fma_f32 v[36:37], v[12:13], v[12:13], v[36:37]
v_pk_add_f32 v[34:35], v[34:35], v[14:15]
v_pk_fma_f32 v[36:37], v[14:15], v[14:15], v[36:37]
v_pk_add_f32 v[34:35], v[34:35], v[16:17]
v_pk_fma_f32 v[36:37], v[16:17], v[16:17], v[36:37]
v_pk_add_f32 v[34:35], v[34:35], v[18:19]
v_pk_fma_f32 v[36:37], v[18:19], v[18:19], v[36:37]
v_pk_add_f32 v[34:35], v[34:35], v[20:21]
v_pk_fma_f32 v[36:37], v[20:21], v[20:21], v[36:37]
v_pk_add_f32 v[34:35], v[34:35], v[22:23]
v_pk_fma_f32 v[36:37], v[22:23], v[22:23], v[36:37]
v_add_f32 v34, v34, v35
v_add_f32 v35, v36, v37
v_mov_b32 v36, v34
v_mov_b32 v37, v35
s_nop 0
v_permlane32_swap_b32 v34, v36
v_permlane32_swap_b32 v35, v37
v_add_f32 v34, v34, v36
v_add_f32 v35, v35, v37
v_mov_b32 v36, v34
v_mov_b32 v37, v35
s_nop 0
v_permlane16_swap_b32 v34, v36
v_permlane16_swap_b32 v35, v37
v_add_f32 v34, v34, v36
v_add_f32 v35, v35, v37
s_lshl_b32 s24, s60, 9
s_lshl_b32 s25, s22, 7
s_add_u32 s24, s24, s25
s_add_u32 s24, s24, 13230080
s_mov_b64 exec, 0xffff
s_cmp_eq_u32 s72, 0
s_cbranch_scc1 XS75
buffer_store_dwordx2 v[34:35], v2, s[4:7], s24 offen
s_branch XE76
XS75:
buffer_store_dwordx2 v[34:35], v2, s[4:7], s24 offen sc1
XE76:
s_mov_b64 exec, -1
s_add_u32 s40, s40, 4096
buffer_load_dwordx4 a[148:151], v1, s[4:7], s40 offen
s_add_u32 s41, s41, 4096
buffer_load_dwordx4 a[224:227], v1, s[4:7], s41 offen
buffer_load_dwordx4 a[228:231], v1, s[4:7], s40 offen offset:1024
buffer_load_dwordx4 a[96:99], v1, s[4:7], s41 offen offset:1024
buffer_load_dwordx4 a[100:103], v1, s[4:7], s40 offen offset:2048
buffer_load_dwordx4 a[116:119], v1, s[4:7], s41 offen offset:2048
buffer_load_dwordx4 a[156:159], v1, s[4:7], s40 offen offset:3072
buffer_load_dwordx4 a[160:163], v1, s[4:7], s41 offen offset:3072
s_add_u32 s40, s40, 4096
buffer_load_dwordx4 a[232:235], v1, s[4:7], s40 offen
s_add_u32 s41, s41, 4096
buffer_load_dwordx4 a[236:239], v1, s[4:7], s41 offen
buffer_load_dwordx4 a[240:243], v1, s[4:7], s40 offen offset:1024
buffer_load_dwordx4 a[152:155], v1, s[4:7], s41 offen offset:1024
buffer_load_dwordx4 a[0:3], v1, s[4:7], s40 offen offset:2048
buffer_load_dwordx4 a[4:7], v1, s[4:7], s41 offen offset:2048
buffer_load_dwordx4 a[168:171], v1, s[4:7], s40 offen offset:3072
buffer_load_dwordx4 a[172:175], v1, s[4:7], s41 offen offset:3072
s_waitcnt vmcnt(16)
v_mov_b32 v3, 5
s_mov_b64 exec, 1
s_cmp_eq_u32 s72, 0
s_cbranch_scc1 XS77
buffer_store_dword v3, off, s[4:7], s23
s_branch XE78
XS77:
buffer_store_dword v3, off, s[4:7], s23 sc1
XE78:
s_mov_b64 exec, -1
s_cmp_eq_u32 s22, 0
s_cbranch_scc1 FK80
s_cmp_eq_u32 s22, 1
s_cbranch_scc1 FK81
s_cmp_eq_u32 s22, 2
s_cbranch_scc1 FK82
s_branch FK83
FK80:
s_mul_i32 s24, s21, 960
s_lshl_b32 s25, s22, 6
s_add_u32 s24, s24, s25
s_add_u32 s24, s24, 7700480
v_lshlrev_b32 v3, 4, v240
v_lshlrev_b32 v192, 2, v241
buffer_load_dwordx4 v[176:179], v3, s[4:7], s24 offen
buffer_load_dwordx4 v[180:183], v3, s[4:7], s24 offen offset:512
buffer_load_dword v188, v192, s[4:7], s24 offen offset:256
buffer_load_dwordx4 v[184:187], v3, s[4:7], s24 offen offset:768
s_mov_b32 s24, 30000
PL84:
buffer_load_dword v3, v236, s[4:7], 0 offen sc1
s_waitcnt vmcnt(0)
v_cmp_gt_u32 vcc, 5, v3
s_sub_u32 s24, s24, 1
s_cbranch_scc1 PD85
s_cbranch_vccnz PL84
PD85:
s_lshl_b32 s26, s60, 9
s_and_b32 s26, s26, 0xfffff000
s_lshl_b32 s27, s22, 7
s_add_u32 s26, s26, s27
s_add_u32 s26, s26, 13230080
v_lshrrev_b32 v24, 3, v0
v_lshlrev_b32 v24, 9, v24
v_and_b32 v25, 7, v0
v_lshlrev_b32 v25, 4, v25
v_add_u32 v24, v24, v25
buffer_load_dwordx4 v[28:31], v24, s[4:7], s26 offen
s_mul_i32 s69, s62, 20480
s_add_u32 s69, s69, 10346496
s_mul_i32 s70, s22, 20480
s_mov_b32 m0, s70
s_nop 0
buffer_load_dwordx4 v1, s[4:7], s69 offen offset:0 sc1 lds
s_mov_b32 m0, s70
s_nop 0
buffer_load_dwordx4 v1, s[4:7], s69 offen offset:1024 sc1 lds
s_mov_b32 m0, s70
s_nop 0
buffer_load_dwordx4 v1, s[4:7], s69 offen offset:2048 sc1 lds
s_mov_b32 m0, s70
s_nop 0
buffer_load_dwordx4 v1, s[4:7], s69 offen offset:3072 sc1 lds
s_add_u32 s69, s69, 4096
s_add_u32 s70, s70, 4096
s_mov_b32 m0, s70
s_nop 0
buffer_load_dwordx4 v1, s[4:7], s69 offen offset:0 sc1 lds
s_mov_b32 m0, s70
s_nop 0
buffer_load_dwordx4 v1, s[4:7], s69 offen offset:1024 sc1 lds
s_mov_b32 m0, s70
s_nop 0
buffer_load_dwordx4 v1, s[4:7], s69 offen offset:2048 sc1 lds
s_mov_b32 m0, s70
s_nop 0
buffer_load_dwordx4 v1, s[4:7], s69 offen offset:3072 sc1 lds
s_add_u32 s69, s69, 4096
s_add_u32 s70, s70, 4096
s_mov_b32 m0, s70
s_nop 0
buffer_load_dwordx4 v1, s[4:7], s69 offen offset:0 sc1 lds
s_mov_b32 m0, s70
s_nop 0
buffer_load_dwordx4 v1, s[4:7], s69 offen offset:1024 sc1 lds
s_waitcnt vmcnt(10)
v_mov_b32 v32, v28
v_mov_b32 v33, v29
v_mov_b32 v34, v30
v_mov_b32 v35, v31
v_permlane32_swap_b32 v28, v32
v_permlane32_swap_b32 v29, v33
v_permlane32_swap_b32 v30, v34
v_permlane32_swap_b32 v31, v35
v_add_f32 v28, v28, v32
v_add_f32 v29, v29, v33
v_add_f32 v30, v30, v34
v_add_f32 v31, v31, v35
v_mov_b32 v32, v28
v_mov_b32 v33, v29
v_mov_b32 v34, v30
v_mov_b32 v35, v31
v_permlane16_swap_b32 v28, v32
v_permlane16_swap_b32 v29, v33
v_permlane16_swap_b32 v30, v34
v_permlane16_swap_b32 v31, v35
v_add_f32 v28, v28, v32
v_add_f32 v29, v29, v33
v_add_f32 v30, v30, v34
v_add_f32 v31, v31, v35
v_add_f32_dpp v28, v28, v28 row_ror:8 row_mask:0xf bank_mask:0xf
v_add_f32_dpp v29, v29, v29 row_ror:8 row_mask:0xf bank_mask:0xf
v_add_f32_dpp v30, v30, v30 row_ror:8 row_mask:0xf bank_mask:0xf
v_add_f32_dpp v31, v31, v31 row_ror:8 row_mask:0xf bank_mask:0xf
s_mov_b32 s26, 0xbacccccd
s_mov_b32 s27, 0x3acccccd
v_mul_f32 v32, s26, v28
v_mul_f32 v33, s26, v30
v_mul_f32 v34, s27, v29
v_mul_f32 v35, s27, v31
v_fma_f32 v34, -v32, v32, v34
v_fma_f32 v35, -v33, v33, v35
v_max_f32 v34, 0, v34
v_max_f32 v35, 0, v35
v_add_f32 v34, 0x3727c5ac, v34
v_add_f32 v35, 0x3727c5ac, v35
v_rsq_f32 v34, v34
v_rsq_f32 v35, v35
v_and_b32 v24, 7, v0
v_lshlrev_b32 v24, 3, v24
s_lshl_b32 s26, s22, 6
s_add_u32 s26, s26, 102400
v_add_u32 v24, s26, v24
s_mov_b64 exec, 0xff
ds_write_b64 v24, v[32:33]
ds_write_b64 v24, v[34:35] offset:256
s_mov_b64 exec, -1
s_waitcnt vmcnt(5)
s_waitcnt lgkmcnt(0)
s_barrier
ds_read_b128 v[24:27], v1 offset:0
ds_read_b128 v[28:31], v1 offset:20480
ds_read_b128 v[32:35], v1 offset:40960
ds_read_b128 v[36:39], v238 offset:0
s_waitcnt lgkmcnt(3)
v_mfma_f32_16x16x32_bf16 v[56:59], a[212:215], v[24:27], 0
ds_read_b128 v[40:43], v1 offset:1024
s_waitcnt lgkmcnt(3)
v_mfma_f32_16x16x32_bf16 v[60:63], a[212:215], v[28:31], 0
ds_read_b128 v[44:47], v1 offset:21504
s_waitcnt lgkmcnt(3)
v_mfma_f32_16x16x32_bf16 v[64:67], a[212:215], v[32:35], 0
ds_read_b128 v[48:51], v1 offset:41984
s_waitcnt lgkmcnt(3)
v_mfma_f32_16x16x32_bf16 v[68:71], a[212:215], v[36:39], 0
ds_read_b128 v[52:55], v238 offset:1024
v_mfma_f32_16x16x32_bf16 v[72:75], v[24:27], a[104:107], 0
s_mov_b32 m0, s70
s_nop 0
buffer_load_dwordx4 v1, s[4:7], s69 offen offset:2048 sc1 lds
v_mfma_f32_16x16x32_bf16 v[76:79], v[28:31], a[104:107], 0
buffer_load_dwordx4 a[176:179], v1, s[4:7], s43 offen
v_mfma_f32_16x16x32_bf16 v[80:83], v[32:35], a[104:107], 0
buffer_load_dwordx4 a[164:167], v1, s[4:7], s43 offen offset:1024
v_mfma_f32_16x16x32_bf16 v[84:87], v[36:39], a[104:107], 0
buffer_load_dwordx4 a[244:247], v1, s[4:7], s43 offen offset:2048
s_waitcnt vmcnt(2)
v_mfma_f32_16x16x32_bf16 v[88:91], a[176:179], v[24:27], 0
v_mfma_f32_16x16x32_bf16 v[92:95], a[176:179], v[28:31], 0
v_mfma_f32_16x16x32_bf16 v[96:99], a[176:179], v[32:35], 0
v_mfma_f32_16x16x32_bf16 v[100:103], a[176:179], v[36:39], 0
s_waitcnt lgkmcnt(3)
v_mfma_f32_16x16x32_bf16 v[56:59], a[108:111], v[40:43], v[56:59]
ds_read_b128 v[24:27], v1 offset:2048
s_waitcnt lgkmcnt(3)
v_mfma_f32_16x16x32_bf16 v[60:63], a[108:111], v[44:47], v[60:63]
ds_read_b128 v[28:31], v1 offset:22528
s_waitcnt lgkmcnt(3)
v_mfma_f32_16x16x32_bf16 v[64:67], a[108:111], v[48:51], v[64:67]
ds_read_b128 v[32:35], v1 offset:43008
s_waitcnt lgkmcnt(3)
v_mfma_f32_16x16x32_bf16 v[68:71], a[108:111], v[52:55], v[68:71]
ds_read_b128 v[36:39], v238 offset:2048
v_mfma_f32_16x16x32_bf16 v[72:75], v[40:43], a[112:115], v[72:75]
s_mov_b32 m0, s70
s_nop 0
buffer_load_dwordx4 v1, s[4:7], s69 offen offset:3072 sc1 lds
v_mfma_f32_16x16x32_bf16 v[76:79], v[44:47], a[112:115], v[76:79]
buffer_load_dwordx4 a[248:251], v1, s[4:7], s43 offen offset:3072
v_mfma_f32_16x16x32_bf16 v[80:83], v[48:51], a[112:115], v[80:83]
s_add_u32 s43, s43, 4096
buffer_load_dwordx4 a[252:255], v1, s[4:7], s43 offen
v_mfma_f32_16x16x32_bf16 v[84:87], v[52:55], a[112:115], v[84:87]
buffer_load_dwordx4 a[20:23], v1, s[4:7], s43 offen offset:1024
s_waitcnt vmcnt(5)
v_mfma_f32_16x16x32_bf16 v[88:91], a[164:167], v[40:43], v[88:91]
v_mfma_f32_16x16x32_bf16 v[92:95], a[164:167], v[44:47], v[92:95]
v_mfma_f32_16x16x32_bf16 v[96:99], a[164:167], v[48:51], v[96:99]
v_mfma_f32_16x16x32_bf16 v[100:103], a[164:167], v[52:55], v[100:103]
s_waitcnt lgkmcnt(3)
v_mfma_f32_16x16x32_bf16 v[56:59], a[68:71], v[24:27], v[56:59]
ds_read_b128 v[40:43], v1 offset:3072
s_waitcnt lgkmcnt(3)
v_mfma_f32_16x16x32_bf16 v[60:63], a[68:71], v[28:31], v[60:63]
ds_read_b128 v[44:47], v1 offset:23552
s_waitcnt lgkmcnt(3)
v_mfma_f32_16x16x32_bf16 v[64:67], a[68:71], v[32:35], v[64:67]
ds_read_b128 v[48:51], v1 offset:44032
s_waitcnt lgkmcnt(3)
v_mfma_f32_16x16x32_bf16 v[68:71], a[68:71], v[36:39], v[68:71]
ds_read_b128 v[52:55], v238 offset:3072
v_mfma_f32_16x16x32_bf16 v[72:75], v[24:27], a[72:75], v[72:75]
s_add_u32 s69, s69, 4096
s_add_u32 s70, s70, 4096
s_mov_b32 m0, s70
s_nop 0
buffer_load_dwordx4 v1, s[4:7], s69 offen offset:0 sc1 lds
v_mfma_f32_16x16x32_bf16 v[76:79], v[28:31], a[72:75], v[76:79]
buffer_load_dwordx4 a[24:27], v1, s[4:7], s43 offen offset:2048
v_mfma_f32_16x16x32_bf16 v[80:83], v[32:35], a[72:75], v[80:83]
buffer_load_dwordx4 a[184:187], v1, s[4:7], s43 offen offset:3072
v_mfma_f32_16x16x32_bf16 v[84:87], v[36:39], a[72:75], v[84:87]
s_add_u32 s43, s43, 4096
buffer_load_dwordx4 a[188:191], v1, s[4:7], s43 offen
s_waitcnt vmcnt(8)
v_mfma_f32_16x16x32_bf16 v[88:91], a[244:247], v[24:27], v[88:91]
v_mfma_f32_16x16x32_bf16 v[92:95], a[244:247], v[28:31], v[92:95]
v_mfma_f32_16x16x32_bf16 v[96:99], a[244:247], v[32:35], v[96:99]
v_mfma_f32_16x16x32_bf16 v[100:103], a[244:247], v[36:39], v[100:103]
s_waitcnt lgkmcnt(3)
v_mfma_f32_16x16x32_bf16 v[56:59], a[216:219], v[40:43], v[56:59]
ds_read_b128 v[24:27], v1 offset:4096
s_waitcnt lgkmcnt(3)
v_mfma_f32_16x16x32_bf16 v[60:63], a[216:219], v[44:47], v[60:63]
ds_read_b128 v[28:31], v1 offset:24576
s_waitcnt lgkmcnt(3)
v_mfma_f32_16x16x32_bf16 v[64:67], a[216:219], v[48:51], v[64:67]
ds_read_b128 v[32:35], v1 offset:45056
s_waitcnt lgkmcnt(3)
v_mfma_f32_16x16x32_bf16 v[68:71], a[216:219], v[52:55], v[68:71]
ds_read_b128 v[36:39], v238 offset:4096
v_mfma_f32_16x16x32_bf16 v[72:75], v[40:43], a[220:223], v[72:75]
s_mov_b32 m0, s70
s_nop 0
buffer_load_dwordx4 v1, s[4:7], s69 offen offset:1024 sc1 lds
v_mfma_f32_16x16x32_bf16 v[76:79], v[44:47], a[220:223], v[76:79]
buffer_load_dwordx4 a[192:195], v1, s[4:7], s43 offen offset:1024
v_mfma_f32_16x16x32_bf16 v[80:83], v[48:51], a[220:223], v[80:83]
buffer_load_dwordx4 a[180:183], v1, s[4:7], s43 offen offset:2048
v_mfma_f32_16x16x32_bf16 v[84:87], v[52:55], a[220:223], v[84:87]
buffer_load_dwordx4 a[8:11], v1, s[4:7], s43 offen offset:3072
s_waitcnt vmcnt(10)
v_mfma_f32_16x16x32_bf16 v[88:91], a[248:251], v[40:43], v[88:91]
v_mfma_f32_16x16x32_bf16 v[92:95], a[248:251], v[44:47], v[92:95]
v_mfma_f32_16x16x32_bf16 v[96:99], a[248:251], v[48:51], v[96:99]
v_mfma_f32_16x16x32_bf16 v[100:103], a[248:251], v[52:55], v[100:103]
s_barrier
s_waitcnt lgkmcnt(3)
v_mfma_f32_16x16x32_bf16 v[56:59], a[136:139], v[24:27], v[56:59]
ds_read_b128 v[40:43], v1 offset:5120
s_waitcnt lgkmcnt(3)
v_mfma_f32_16x16x32_bf16 v[60:63], a[136:139], v[28:31], v[60:63]
ds_read_b128 v[44:47], v1 offset:25600
s_waitcnt lgkmcnt(3)
v_mfma_f32_16x16x32_bf16 v[64:67], a[136:139], v[32:35], v[64:67]
ds_read_b128 v[48:51], v1 offset:46080
s_waitcnt lgkmcnt(3)
v_mfma_f32_16x16x32_bf16 v[68:71], a[136:139], v[36:39], v[68:71]
ds_read_b128 v[52:55], v238 offset:5120
v_mfma_f32_16x16x32_bf16 v[72:75], v[24:27], a[140:143], v[72:75]
s_mov_b32 m0, s70
s_nop 0
buffer_load_dwordx4 v1, s[4:7], s69 offen offset:2048 sc1 lds
v_mfma_f32_16x16x32_bf16 v[76:79], v[28:31], a[140:143], v[76:79]
s_add_u32 s43, s43, 4096
buffer_load_dwordx4 a[12:15], v1, s[4:7], s43 offen
v_mfma_f32_16x16x32_bf16 v[80:83], v[32:35], a[140:143], v[80:83]
buffer_load_dwordx4 a[16:19], v1, s[4:7], s43 offen offset:1024
v_mfma_f32_16x16x32_bf16 v[84:87], v[36:39], a[140:143], v[84:87]
buffer_load_dwordx4 a[40:43], v1, s[4:7], s43 offen offset:2048
s_waitcnt vmcnt(13)
v_mfma_f32_16x16x32_bf16 v[88:91], a[252:255], v[24:27], v[88:91]
v_mfma_f32_16x16x32_bf16 v[92:95], a[252:255], v[28:31], v[92:95]
v_mfma_f32_16x16x32_bf16 v[96:99], a[252:255], v[32:35], v[96:99]
v_mfma_f32_16x16x32_bf16 v[100:103], a[252:255], v[36:39], v[100:103]
s_waitcnt lgkmcnt(3)
v_mfma_f32_16x16x32_bf16 v[56:59], a[76:79], v[40:43], v[56:59]
ds_read_b128 v[24:27], v1 offset:6144
s_waitcnt lgkmcnt(3)
v_mfma_f32_16x16x32_bf16 v[60:63], a[76:79], v[44:47], v[60:63]
ds_read_b128 v[28:31], v1 offset:26624
s_waitcnt lgkmcnt(3)
v_mfma_f32_16x16x32_bf16 v[64:67], a[76:79], v[48:51], v[64:67]
ds_read_b128 v[32:35], v1 offset:47104
s_waitcnt lgkmcnt(3)
v_mfma_f32_16x16x32_bf16 v[68:71], a[76:79], v[52:55], v[68:71]
ds_read_b128 v[36:39], v238 offset:6144
v_mfma_f32_16x16x32_bf16 v[72:75], v[40:43], a[80:83], v[72:75]
s_mov_b32 m0, s70
s_nop 0
buffer_load_dwordx4 v1, s[4:7], s69 offen offset:3072 sc1 lds
v_mfma_f32_16x16x32_bf16 v[76:79], v[44:47], a[80:83], v[76:79]
buffer_load_dwordx4 a[44:47], v1, s[4:7], s43 offen offset:3072
v_mfma_f32_16x16x32_bf16 v[80:83], v[48:51], a[80:83], v[80:83]
s_add_u32 s40, s40, 4096
buffer_load_dwordx4 a[200:203], v1, s[4:7], s40 offen
v_mfma_f32_16x16x32_bf16 v[84:87], v[52:55], a[80:83], v[84:87]
s_add_u32 s41, s41, 4096
buffer_load_dwordx4 a[120:123], v1, s[4:7], s41 offen
s_waitcnt vmcnt(16)
v_mfma_f32_16x16x32_bf16 v[88:91], a[20:23], v[40:43], v[88:91]
v_mfma_f32_16x16x32_bf16 v[92:95], a[20:23], v[44:47], v[92:95]
v_mfma_f32_16x16x32_bf16 v[96:99], a[20:23], v[48:51], v[96:99]
v_mfma_f32_16x16x32_bf16 v[100:103], a[20:23], v[52:55], v[100:103]
s_waitcnt lgkmcnt(3)
v_mfma_f32_16x16x32_bf16 v[56:59], a[84:87], v[24:27], v[56:59]
ds_read_b128 v[40:43], v1 offset:7168
s_waitcnt lgkmcnt(3)
v_mfma_f32_16x16x32_bf16 v[60:63], a[84:87], v[28:31], v[60:63]
ds_read_b128 v[44:47], v1 offset:27648
s_waitcnt lgkmcnt(3)
v_mfma_f32_16x16x32_bf16 v[64:67], a[84:87], v[32:35], v[64:67]
ds_read_b128 v[48:51], v1 offset:48128
s_waitcnt lgkmcnt(3)
v_mfma_f32_16x16x32_bf16 v[68:71], a[84:87], v[36:39], v[68:71]
ds_read_b128 v[52:55], v238 offset:7168
v_mfma_f32_16x16x32_bf16 v[72:75], v[24:27], a[88:91], v[72:75]
s_add_u32 s69, s69, 4096
s_add_u32 s70, s70, 4096
s_mov_b32 m0, s70
s_nop 0
buffer_load_dwordx4 v1, s[4:7], s69 offen offset:0 sc1 lds
v_mfma_f32_16x16x32_bf16 v[76:79], v[28:31], a[88:91], v[76:79]
s_add_u32 s43, s43, 4096
buffer_load_dwordx4 a[124:127], v1, s[4:7], s43 offen
v_mfma_f32_16x16x32_bf16 v[80:83], v[32:35], a[88:91], v[80:83]
buffer_load_dwordx4 a[196:199], v1, s[4:7], s40 offen offset:1024
v_mfma_f32_16x16x32_bf16 v[84:87], v[36:39], a[88:91], v[84:87]
buffer_load_dwordx4 a[28:31], v1, s[4:7], s41 offen offset:1024
s_waitcnt vmcnt(18)
v_mfma_f32_16x16x32_bf16 v[88:91], a[24:27], v[24:27], v[88:91]
v_mfma_f32_16x16x32_bf16 v[92:95], a[24:27], v[28:31], v[92:95]
v_mfma_f32_16x16x32_bf16 v[96:99], a[24:27], v[32:35], v[96:99]
v_mfma_f32_16x16x32_bf16 v[100:103], a[24:27], v[36:39], v[100:103]
s_waitcnt lgkmcnt(3)
v_mfma_f32_16x16x32_bf16 v[56:59], a[92:95], v[40:43], v[56:59]
ds_read_b128 v[24:27], v1 offset:8192
s_waitcnt lgkmcnt(3)
v_mfma_f32_16x16x32_bf16 v[60:63], a[92:95], v[44:47], v[60:63]
ds_read_b128 v[28:31], v1 offset:28672
s_waitcnt lgkmcnt(3)
v_mfma_f32_16x16x32_bf16 v[64:67], a[92:95], v[48:51], v[64:67]
ds_read_b128 v[32:35], v1 offset:49152
s_waitcnt lgkmcnt(3)
v_mfma_f32_16x16x32_bf16 v[68:71], a[92:95], v[52:55], v[68:71]
ds_read_b128 v[36:39], v238 offset:8192
v_mfma_f32_16x16x32_bf16 v[72:75], v[40:43], a[144:147], v[72:75]
s_mov_b32 m0, s70
s_nop 0
buffer_load_dwordx4 v1, s[4:7], s69 offen offset:1024 sc1 lds
v_mfma_f32_16x16x32_bf16 v[76:79], v[44:47], a[144:147], v[76:79]
buffer_load_dwordx4 a[32:35], v1, s[4:7], s43 offen offset:1024
v_mfma_f32_16x16x32_bf16 v[80:83], v[48:51], a[144:147], v[80:83]
buffer_load_dwordx4 a[36:39], v1, s[4:7], s40 offen offset:2048
v_mfma_f32_16x16x32_bf16 v[84:87], v[52:55], a[144:147], v[84:87]
buffer_load_dwordx4 a[60:63], v1, s[4:7], s41 offen offset:2048
s_waitcnt vmcnt(21)
v_mfma_f32_16x16x32_bf16 v[88:91], a[184:187], v[40:43], v[88:91]
v_mfma_f32_16x16x32_bf16 v[92:95], a[184:187], v[44:47], v[92:95]
v_mfma_f32_16x16x32_bf16 v[96:99], a[184:187], v[48:51], v[96:99]
v_mfma_f32_16x16x32_bf16 v[100:103], a[184:187], v[52:55], v[100:103]
s_waitcnt lgkmcnt(3)
v_mfma_f32_16x16x32_bf16 v[56:59], a[148:151], v[24:27], v[56:59]
ds_read_b128 v[40:43], v1 offset:9216
s_waitcnt lgkmcnt(3)
v_mfma_f32_16x16x32_bf16 v[60:63], a[148:151], v[28:31], v[60:63]
ds_read_b128 v[44:47], v1 offset:29696
s_waitcnt lgkmcnt(3)
v_mfma_f32_16x16x32_bf16 v[64:67], a[148:151], v[32:35], v[64:67]
ds_read_b128 v[48:51], v1 offset:50176
s_waitcnt lgkmcnt(3)
v_mfma_f32_16x16x32_bf16 v[68:71], a[148:151], v[36:39], v[68:71]
ds_read_b128 v[52:55], v238 offset:9216
v_mfma_f32_16x16x32_bf16 v[72:75], v[24:27], a[224:227], v[72:75]
s_mov_b32 m0, s70
s_nop 0
buffer_load_dwordx4 v1, s[4:7], s69 offen offset:2048 sc1 lds
v_mfma_f32_16x16x32_bf16 v[76:79], v[28:31], a[224:227], v[76:79]
buffer_load_dwordx4 a[64:67], v1, s[4:7], s43 offen offset:2048
v_mfma_f32_16x16x32_bf16 v[80:83], v[32:35], a[224:227], v[80:83]
buffer_load_dwordx4 a[132:135], v1, s[4:7], s40 offen offset:3072
v_mfma_f32_16x16x32_bf16 v[84:87], v[36:39], a[224:227], v[84:87]
buffer_load_dwordx4 a[204:207], v1, s[4:7], s41 offen offset:3072
s_waitcnt vmcnt(24)
v_mfma_f32_16x16x32_bf16 v[88:91], a[188:191], v[24:27], v[88:91]
v_mfma_f32_16x16x32_bf16 v[92:95], a[188:191], v[28:31], v[92:95]
v_mfma_f32_16x16x32_bf16 v[96:99], a[188:191], v[32:35], v[96:99]
v_mfma_f32_16x16x32_bf16 v[100:103], a[188:191], v[36:39], v[100:103]
s_waitcnt vmcnt(19)
s_barrier
s_waitcnt lgkmcnt(3)
v_mfma_f32_16x16x32_bf16 v[56:59], a[228:231], v[40:43], v[56:59]
ds_read_b128 v[24:27], v1 offset:10240
s_waitcnt lgkmcnt(3)
v_mfma_f32_16x16x32_bf16 v[60:63], a[228:231], v[44:47], v[60:63]
ds_read_b128 v[28:31], v1 offset:30720
s_waitcnt lgkmcnt(3)
v_mfma_f32_16x16x32_bf16 v[64:67], a[228:231], v[48:51], v[64:67]
ds_read_b128 v[32:35], v1 offset:51200
s_waitcnt lgkmcnt(3)
v_mfma_f32_16x16x32_bf16 v[68:71], a[228:231], v[52:55], v[68:71]
ds_read_b128 v[36:39], v238 offset:10240
v_mfma_f32_16x16x32_bf16 v[72:75], v[40:43], a[96:99], v[72:75]
s_mov_b32 m0, s70
s_nop 0
buffer_load_dwordx4 v1, s[4:7], s69 offen offset:3072 sc1 lds
v_mfma_f32_16x16x32_bf16 v[76:79], v[44:47], a[96:99], v[76:79]
buffer_load_dwordx4 a[208:211], v1, s[4:7], s43 offen offset:3072
v_mfma_f32_16x16x32_bf16 v[80:83], v[48:51], a[96:99], v[80:83]
buffer_load_dwordx4 a[128:131], v1, s[4:7], s42 offen
v_mfma_f32_16x16x32_bf16 v[84:87], v[52:55], a[96:99], v[84:87]
buffer_load_dwordx4 a[48:51], v1, s[4:7], s42 offen offset:1024
v_mfma_f32_16x16x32_bf16 v[88:91], a[192:195], v[40:43], v[88:91]
v_mfma_f32_16x16x32_bf16 v[92:95], a[192:195], v[44:47], v[92:95]
v_mfma_f32_16x16x32_bf16 v[96:99], a[192:195], v[48:51], v[96:99]
v_mfma_f32_16x16x32_bf16 v[100:103], a[192:195], v[52:55], v[100:103]
s_waitcnt lgkmcnt(3)
v_mfma_f32_16x16x32_bf16 v[56:59], a[100:103], v[24:27], v[56:59]
ds_read_b128 v[40:43], v1 offset:11264
s_waitcnt lgkmcnt(3)
v_mfma_f32_16x16x32_bf16 v[60:63], a[100:103], v[28:31], v[60:63]
ds_read_b128 v[44:47], v1 offset:31744
s_waitcnt lgkmcnt(3)
v_mfma_f32_16x16x32_bf16 v[64:67], a[100:103], v[32:35], v[64:67]
ds_read_b128 v[48:51], v1 offset:52224
s_waitcnt lgkmcnt(3)
v_mfma_f32_16x16x32_bf16 v[68:71], a[100:103], v[36:39], v[68:71]
ds_read_b128 v[52:55], v238 offset:11264
v_mfma_f32_16x16x32_bf16 v[72:75], v[24:27], a[116:119], v[72:75]
v_mfma_f32_16x16x32_bf16 v[76:79], v[28:31], a[116:119], v[76:79]
buffer_load_dwordx4 a[52:55], v1, s[4:7], s42 offen offset:2048
v_mfma_f32_16x16x32_bf16 v[80:83], v[32:35], a[116:119], v[80:83]
buffer_load_dwordx4 a[56:59], v1, s[4:7], s42 offen offset:3072
v_mfma_f32_16x16x32_bf16 v[84:87], v[36:39], a[116:119], v[84:87]
s_add_u32 s42, s42, 4096
buffer_load_dwordx4 a[212:215], v1, s[4:7], s42 offen
v_mfma_f32_16x16x32_bf16 v[88:91], a[180:183], v[24:27], v[88:91]
v_mfma_f32_16x16x32_bf16 v[92:95], a[180:183], v[28:31], v[92:95]
v_mfma_f32_16x16x32_bf16 v[96:99], a[180:183], v[32:35], v[96:99]
v_mfma_f32_16x16x32_bf16 v[100:103], a[180:183], v[36:39], v[100:103]
s_waitcnt lgkmcnt(3)
v_mfma_f32_16x16x32_bf16 v[56:59], a[156:159], v[40:43], v[56:59]
ds_read_b128 v[24:27], v1 offset:12288
s_waitcnt lgkmcnt(3)
v_mfma_f32_16x16x32_bf16 v[60:63], a[156:159], v[44:47], v[60:63]
ds_read_b128 v[28:31], v1 offset:32768
s_waitcnt lgkmcnt(3)
v_mfma_f32_16x16x32_bf16 v[64:67], a[156:159], v[48:51], v[64:67]
ds_read_b128 v[32:35], v1 offset:53248
s_waitcnt lgkmcnt(3)
v_mfma_f32_16x16x32_bf16 v[68:71], a[156:159], v[52:55], v[68:71]
ds_read_b128 v[36:39], v238 offset:12288
v_mfma_f32_16x16x32_bf16 v[72:75], v[40:43], a[160:163], v[72:75]
v_mfma_f32_16x16x32_bf16 v[76:79], v[44:47], a[160:163], v[76:79]
buffer_load_dwordx4 a[104:107], v1, s[4:7], s42 offen offset:1024
v_mfma_f32_16x16x32_bf16 v[80:83], v[48:51], a[160:163], v[80:83]
buffer_load_dwordx4 a[176:179], v1, s[4:7], s42 offen offset:2048
v_mfma_f32_16x16x32_bf16 v[84:87], v[52:55], a[160:163], v[84:87]
buffer_load_dwordx4 a[108:111], v1, s[4:7], s42 offen offset:3072
v_mfma_f32_16x16x32_bf16 v[88:91], a[8:11], v[40:43], v[88:91]
v_mfma_f32_16x16x32_bf16 v[92:95], a[8:11], v[44:47], v[92:95]
v_mfma_f32_16x16x32_bf16 v[96:99], a[8:11], v[48:51], v[96:99]
v_mfma_f32_16x16x32_bf16 v[100:103], a[8:11], v[52:55], v[100:103]
s_waitcnt lgkmcnt(3)
v_mfma_f32_16x16x32_bf16 v[56:59], a[232:235], v[24:27], v[56:59]
ds_read_b128 v[40:43], v1 offset:13312
s_waitcnt lgkmcnt(3)
v_mfma_f32_16x16x32_bf16 v[60:63], a[232:235], v[28:31], v[60:63]
ds_read_b128 v[44:47], v1 offset:33792
s_waitcnt lgkmcnt(3)
v_mfma_f32_16x16x32_bf16 v[64:67], a[232:235], v[32:35], v[64:67]
ds_read_b128 v[48:51], v1 offset:54272
s_waitcnt lgkmcnt(3)
v_mfma_f32_16x16x32_bf16 v[68:71], a[232:235], v[36:39], v[68:71]
ds_read_b128 v[52:55], v238 offset:13312
v_mfma_f32_16x16x32_bf16 v[72:75], v[24:27], a[236:239], v[72:75]
v_mfma_f32_16x16x32_bf16 v[76:79], v[28:31], a[236:239], v[76:79]
s_add_u32 s42, s42, 4096
buffer_load_dwordx4 a[112:115], v1, s[4:7], s42 offen
v_mfma_f32_16x16x32_bf16 v[80:83], v[32:35], a[236:239], v[80:83]
buffer_load_dwordx4 a[164:167], v1, s[4:7], s42 offen offset:1024
v_mfma_f32_16x16x32_bf16 v[84:87], v[36:39], a[236:239], v[84:87]
buffer_load_dwordx4 a[68:71], v1, s[4:7], s42 offen offset:2048
s_waitcnt vmcnt(31)
v_mfma_f32_16x16x32_bf16 v[88:91], a[12:15], v[24:27], v[88:91]
v_mfma_f32_16x16x32_bf16 v[92:95], a[12:15], v[28:31], v[92:95]
v_mfma_f32_16x16x32_bf16 v[96:99], a[12:15], v[32:35], v[96:99]
v_mfma_f32_16x16x32_bf16 v[100:103], a[12:15], v[36:39], v[100:103]
s_waitcnt lgkmcnt(3)
v_mfma_f32_16x16x32_bf16 v[56:59], a[240:243], v[40:43], v[56:59]
ds_read_b128 v[24:27], v1 offset:14336
s_waitcnt lgkmcnt(3)
v_mfma_f32_16x16x32_bf16 v[60:63], a[240:243], v[44:47], v[60:63]
ds_read_b128 v[28:31], v1 offset:34816
s_waitcnt lgkmcnt(3)
v_mfma_f32_16x16x32_bf16 v[64:67], a[240:243], v[48:51], v[64:67]
ds_read_b128 v[32:35], v1 offset:55296
s_waitcnt lgkmcnt(3)
v_mfma_f32_16x16x32_bf16 v[68:71], a[240:243], v[52:55], v[68:71]
ds_read_b128 v[36:39], v238 offset:14336
v_mfma_f32_16x16x32_bf16 v[72:75], v[40:43], a[152:155], v[72:75]
v_mfma_f32_16x16x32_bf16 v[76:79], v[44:47], a[152:155], v[76:79]
buffer_load_dwordx4 a[72:75], v1, s[4:7], s42 offen offset:3072
v_mfma_f32_16x16x32_bf16 v[80:83], v[48:51], a[152:155], v[80:83]
s_add_u32 s42, s42, 4096
buffer_load_dwordx4 a[244:247], v1, s[4:7], s42 offen
v_mfma_f32_16x16x32_bf16 v[84:87], v[52:55], a[152:155], v[84:87]
buffer_load_dwordx4 a[216:219], v1, s[4:7], s42 offen offset:1024
s_waitcnt vmcnt(33)
v_mfma_f32_16x16x32_bf16 v[88:91], a[16:19], v[40:43], v[88:91]
v_mfma_f32_16x16x32_bf16 v[92:95], a[16:19], v[44:47], v[92:95]
v_mfma_f32_16x16x32_bf16 v[96:99], a[16:19], v[48:51], v[96:99]
v_mfma_f32_16x16x32_bf16 v[100:103], a[16:19], v[52:55], v[100:103]
s_waitcnt vmcnt(15)
s_barrier
s_waitcnt lgkmcnt(3)
v_mfma_f32_16x16x32_bf16 v[56:59], a[0:3], v[24:27], v[56:59]
ds_read_b128 v[40:43], v1 offset:15360
s_waitcnt lgkmcnt(3)
v_mfma_f32_16x16x32_bf16 v[60:63], a[0:3], v[28:31], v[60:63]
ds_read_b128 v[44:47], v1 offset:35840
s_waitcnt lgkmcnt(3)
v_mfma_f32_16x16x32_bf16 v[64:67], a[0:3], v[32:35], v[64:67]
ds_read_b128 v[48:51], v1 offset:56320
s_waitcnt lgkmcnt(3)
v_mfma_f32_16x16x32_bf16 v[68:71], a[0:3], v[36:39], v[68:71]
ds_read_b128 v[52:55], v238 offset:15360
v_mfma_f32_16x16x32_bf16 v[72:75], v[24:27], a[4:7], v[72:75]
v_mfma_f32_16x16x32_bf16 v[76:79], v[28:31], a[4:7], v[76:79]
buffer_load_dwordx4 a[220:223], v1, s[4:7], s42 offen offset:2048
v_mfma_f32_16x16x32_bf16 v[80:83], v[32:35], a[4:7], v[80:83]
buffer_load_dwordx4 a[248:251], v1, s[4:7], s42 offen offset:3072
v_mfma_f32_16x16x32_bf16 v[84:87], v[36:39], a[4:7], v[84:87]
s_add_u32 s42, s42, 4096
buffer_load_dwordx4 a[136:139], v1, s[4:7], s42 offen
v_mfma_f32_16x16x32_bf16 v[88:91], a[40:43], v[24:27], v[88:91]
v_mfma_f32_16x16x32_bf16 v[92:95], a[40:43], v[28:31], v[92:95]
v_mfma_f32_16x16x32_bf16 v[96:99], a[40:43], v[32:35], v[96:99]
v_mfma_f32_16x16x32_bf16 v[100:103], a[40:43], v[36:39], v[100:103]
s_waitcnt lgkmcnt(3)
v_mfma_f32_16x16x32_bf16 v[56:59], a[168:171], v[40:43], v[56:59]
ds_read_b64 v[24:25], v2 offset:16384
ds_read_b64 v[26:27], v2 offset:16896
s_waitcnt lgkmcnt(4)
v_mfma_f32_16x16x32_bf16 v[60:63], a[168:171], v[44:47], v[60:63]
ds_read_b64 v[28:29], v2 offset:36864
ds_read_b64 v[30:31], v2 offset:37376
s_waitcnt lgkmcnt(5)
v_mfma_f32_16x16x32_bf16 v[64:67], a[168:171], v[48:51], v[64:67]
ds_read_b64 v[32:33], v2 offset:57344
ds_read_b64 v[34:35], v2 offset:57856
s_waitcnt lgkmcnt(6)
v_mfma_f32_16x16x32_bf16 v[68:71], a[168:171], v[52:55], v[68:71]
ds_read_b64 v[36:37], v239 offset:16384
ds_read_b64 v[38:39], v239 offset:16896
v_mfma_f32_16x16x32_bf16 v[72:75], v[40:43], a[172:175], v[72:75]
v_mfma_f32_16x16x32_bf16 v[76:79], v[44:47], a[172:175], v[76:79]
buffer_load_dwordx4 a[140:143], v1, s[4:7], s42 offen offset:1024
v_mfma_f32_16x16x32_bf16 v[80:83], v[48:51], a[172:175], v[80:83]
buffer_load_dwordx4 a[252:255], v1, s[4:7], s42 offen offset:2048
v_mfma_f32_16x16x32_bf16 v[84:87], v[52:55], a[172:175], v[84:87]
buffer_load_dwordx4 a[76:79], v1, s[4:7], s42 offen offset:3072
v_mfma_f32_16x16x32_bf16 v[88:91], a[44:47], v[40:43], v[88:91]
v_mfma_f32_16x16x32_bf16 v[92:95], a[44:47], v[44:47], v[92:95]
v_mfma_f32_16x16x32_bf16 v[96:99], a[44:47], v[48:51], v[96:99]
v_mfma_f32_16x16x32_bf16 v[100:103], a[44:47], v[52:55], v[100:103]
s_waitcnt lgkmcnt(6)
v_mfma_f32_16x16x32_bf16 v[56:59], a[200:203], v[24:27], v[56:59]
ds_read_b64 v[40:41], v2 offset:17408
ds_read_b64 v[42:43], v2 offset:17920
s_waitcnt lgkmcnt(6)
v_mfma_f32_16x16x32_bf16 v[60:63], a[200:203], v[28:31], v[60:63]
ds_read_b64 v[44:45], v2 offset:37888
ds_read_b64 v[46:47], v2 offset:38400
s_waitcnt lgkmcnt(6)
v_mfma_f32_16x16x32_bf16 v[64:67], a[200:203], v[32:35], v[64:67]
ds_read_b64 v[48:49], v2 offset:58368
ds_read_b64 v[50:51], v2 offset:58880
s_waitcnt lgkmcnt(6)
v_mfma_f32_16x16x32_bf16 v[68:71], a[200:203], v[36:39], v[68:71]
ds_read_b64 v[52:53], v239 offset:17408
ds_read_b64 v[54:55], v239 offset:17920
v_mfma_f32_16x16x32_bf16 v[72:75], v[24:27], a[120:123], v[72:75]
v_mfma_f32_16x16x32_bf16 v[76:79], v[28:31], a[120:123], v[76:79]
v_mfma_f32_16x16x32_bf16 v[80:83], v[32:35], a[120:123], v[80:83]
v_mfma_f32_16x16x32_bf16 v[84:87], v[36:39], a[120:123], v[84:87]
v_mfma_f32_16x16x32_bf16 v[88:91], a[124:127], v[24:27], v[88:91]
v_mfma_f32_16x16x32_bf16 v[92:95], a[124:127], v[28:31], v[92:95]
v_mfma_f32_16x16x32_bf16 v[96:99], a[124:127], v[32:35], v[96:99]
v_mfma_f32_16x16x32_bf16 v[100:103], a[124:127], v[36:39], v[100:103]
s_waitcnt lgkmcnt(6)
v_mfma_f32_16x16x32_bf16 v[56:59], a[196:199], v[40:43], v[56:59]
ds_read_b64 v[24:25], v2 offset:18432
ds_read_b64 v[26:27], v2 offset:18944
s_waitcnt lgkmcnt(6)
v_mfma_f32_16x16x32_bf16 v[60:63], a[196:199], v[44:47], v[60:63]
ds_read_b64 v[28:29], v2 offset:38912
ds_read_b64 v[30:31], v2 offset:39424
s_waitcnt lgkmcnt(6)
v_mfma_f32_16x16x32_bf16 v[64:67], a[196:199], v[48:51], v[64:67]
ds_read_b64 v[32:33], v2 offset:59392
ds_read_b64 v[34:35], v2 offset:59904
s_waitcnt lgkmcnt(6)
v_mfma_f32_16x16x32_bf16 v[68:71], a[196:199], v[52:55], v[68:71]
ds_read_b64 v[36:37], v239 offset:18432
ds_read_b64 v[38:39], v239 offset:18944
v_mfma_f32_16x16x32_bf16 v[72:75], v[40:43], a[28:31], v[72:75]
v_mfma_f32_16x16x32_bf16 v[76:79], v[44:47], a[28:31], v[76:79]
v_mfma_f32_16x16x32_bf16 v[80:83], v[48:51], a[28:31], v[80:83]
v_mfma_f32_16x16x32_bf16 v[84:87], v[52:55], a[28:31], v[84:87]
v_mfma_f32_16x16x32_bf16 v[88:91], a[32:35], v[40:43], v[88:91]
v_mfma_f32_16x16x32_bf16 v[92:95], a[32:35], v[44:47], v[92:95]
v_mfma_f32_16x16x32_bf16 v[96:99], a[32:35], v[48:51], v[96:99]
v_mfma_f32_16x16x32_bf16 v[100:103], a[32:35], v[52:55], v[100:103]
s_waitcnt lgkmcnt(6)
v_mfma_f32_16x16x32_bf16 v[56:59], a[36:39], v[24:27], v[56:59]
ds_read_b64 v[40:41], v2 offset:19456
ds_read_b64 v[42:43], v2 offset:19968
s_waitcnt lgkmcnt(6)
v_mfma_f32_16x16x32_bf16 v[60:63], a[36:39], v[28:31], v[60:63]
ds_read_b64 v[44:45], v2 offset:39936
ds_read_b64 v[46:47], v2 offset:40448
s_waitcnt lgkmcnt(6)
v_mfma_f32_16x16x32_bf16 v[64:67], a[36:39], v[32:35], v[64:67]
ds_read_b64 v[48:49], v2 offset:60416
ds_read_b64 v[50:51], v2 offset:60928
s_waitcnt lgkmcnt(6)
v_mfma_f32_16x16x32_bf16 v[68:71], a[36:39], v[36:39], v[68:71]
ds_read_b64 v[52:53], v239 offset:19456
ds_read_b64 v[54:55], v239 offset:19968
v_mfma_f32_16x16x32_bf16 v[72:75], v[24:27], a[60:63], v[72:75]
v_mfma_f32_16x16x32_bf16 v[76:79], v[28:31], a[60:63], v[76:79]
v_mfma_f32_16x16x32_bf16 v[80:83], v[32:35], a[60:63], v[80:83]
v_mfma_f32_16x16x32_bf16 v[84:87], v[36:39], a[60:63], v[84:87]
v_mfma_f32_16x16x32_bf16 v[88:91], a[64:67], v[24:27], v[88:91]
v_mfma_f32_16x16x32_bf16 v[92:95], a[64:67], v[28:31], v[92:95]
v_mfma_f32_16x16x32_bf16 v[96:99], a[64:67], v[32:35], v[96:99]
v_mfma_f32_16x16x32_bf16 v[100:103], a[64:67], v[36:39], v[100:103]
s_waitcnt lgkmcnt(6)
v_mfma_f32_16x16x32_bf16 v[56:59], a[132:135], v[40:43], v[56:59]
s_waitcnt lgkmcnt(4)
v_mfma_f32_16x16x32_bf16 v[60:63], a[132:135], v[44:47], v[60:63]
s_waitcnt lgkmcnt(2)
v_mfma_f32_16x16x32_bf16 v[64:67], a[132:135], v[48:51], v[64:67]
s_waitcnt lgkmcnt(0)
v_mfma_f32_16x16x32_bf16 v[68:71], a[132:135], v[52:55], v[68:71]
v_mfma_f32_16x16x32_bf16 v[72:75], v[40:43], a[204:207], v[72:75]
v_mfma_f32_16x16x32_bf16 v[76:79], v[44:47], a[204:207], v[76:79]
v_mfma_f32_16x16x32_bf16 v[80:83], v[48:51], a[204:207], v[80:83]
v_mfma_f32_16x16x32_bf16 v[84:87], v[52:55], a[204:207], v[84:87]
s_waitcnt vmcnt(20)
v_mfma_f32_16x16x32_bf16 v[88:91], a[208:211], v[40:43], v[88:91]
v_mfma_f32_16x16x32_bf16 v[92:95], a[208:211], v[44:47], v[92:95]
v_mfma_f32_16x16x32_bf16 v[96:99], a[208:211], v[48:51], v[96:99]
v_mfma_f32_16x16x32_bf16 v[100:103], a[208:211], v[52:55], v[100:103]
v_lshlrev_b32 v3, 2, v241
v_add_u32 v3, 102400, v3
ds_read_b32 v136, v3 offset:0
ds_read_b32 v140, v3 offset:256
ds_read_b32 v137, v3 offset:64
ds_read_b32 v141, v3 offset:320
ds_read_b32 v138, v3 offset:128
ds_read_b32 v142, v3 offset:384
ds_read_b32 v139, v3 offset:192
ds_read_b32 v143, v3 offset:448
v_lshlrev_b32 v3, 4, v240
v_add_u32 v3, 102400, v3
ds_read_b128 v[144:147], v3 offset:0
ds_read_b128 v[160:163], v3 offset:256
ds_read_b128 v[148:151], v3 offset:64
ds_read_b128 v[164:167], v3 offset:320
ds_read_b128 v[152:155], v3 offset:128
ds_read_b128 v[168:171], v3 offset:384
ds_read_b128 v[156:159], v3 offset:192
ds_read_b128 v[172:175], v3 offset:448
s_waitcnt lgkmcnt(0)
s_lshl_b32 s24, s60, 14
s_add_u32 s24, s24, 17686528
s_lshl_b32 s25, s22, 12
s_add_u32 s25, s25, s24
s_mul_i32 s26, s60, 10240
s_add_u32 s26, s26, 24502272
s_lshl_b32 s27, s22, 11
s_add_u32 s27, s27, s26
s_add_u32 s26, s26, 8192
v_pk_fma_f32 v[88:89], v[184:185], v[136:137], v[88:89] op_sel:[0,0,0] op_sel_hi:[1,0,1]
v_pk_fma_f32 v[90:91], v[186:187], v[136:137], v[90:91] op_sel:[0,0,0] op_sel_hi:[1,0,1]
v_pk_mul_f32 v[88:89], v[88:89], v[140:141] op_sel:[0,0] op_sel_hi:[1,0]
v_pk_mul_f32 v[90:91], v[90:91], v[140:141] op_sel:[0,0] op_sel_hi:[1,0]
v_cvt_pk_bf16_f32 v40, v88, v89
v_cvt_pk_bf16_f32 v41, v90, v91
ds_write_b64 v239, v[40:41] offset:44032
v_pk_fma_f32 v[92:93], v[184:185], v[136:137], v[92:93] op_sel:[0,1,0] op_sel_hi:[1,1,1]
v_pk_fma_f32 v[94:95], v[186:187], v[136:137], v[94:95] op_sel:[0,1,0] op_sel_hi:[1,1,1]
v_pk_mul_f32 v[92:93], v[92:93], v[140:141] op_sel:[0,1] op_sel_hi:[1,1]
v_pk_mul_f32 v[94:95], v[94:95], v[140:141] op_sel:[0,1] op_sel_hi:[1,1]
v_cvt_pk_bf16_f32 v42, v92, v93
v_cvt_pk_bf16_f32 v43, v94, v95
ds_write_b64 v239, v[42:43] offset:44544
v_pk_fma_f32 v[96:97], v[184:185], v[138:139], v[96:97] op_sel:[0,0,0] op_sel_hi:[1,0,1]
v_pk_fma_f32 v[98:99], v[186:187], v[138:139], v[98:99] op_sel:[0,0,0] op_sel_hi:[1,0,1]
v_pk_mul_f32 v[96:97], v[96:97], v[142:143] op_sel:[0,0] op_sel_hi:[1,0]
v_pk_mul_f32 v[98:99], v[98:99], v[142:143] op_sel:[0,0] op_sel_hi:[1,0]
v_cvt_pk_bf16_f32 v44, v96, v97
v_cvt_pk_bf16_f32 v45, v98, v99
ds_write_b64 v239, v[44:45] offset:45056
v_pk_fma_f32 v[100:101], v[184:185], v[138:139], v[100:101] op_sel:[0,1,0] op_sel_hi:[1,1,1]
v_pk_fma_f32 v[102:103], v[186:187], v[138:139], v[102:103] op_sel:[0,1,0] op_sel_hi:[1,1,1]
v_pk_mul_f32 v[100:101], v[100:101], v[142:143] op_sel:[0,1] op_sel_hi:[1,1]
v_pk_mul_f32 v[102:103], v[102:103], v[142:143] op_sel:[0,1] op_sel_hi:[1,1]
v_cvt_pk_bf16_f32 v46, v100, v101
v_cvt_pk_bf16_f32 v47, v102, v103
ds_write_b64 v239, v[46:47] offset:45568
v_pk_fma_f32 v[72:73], v[144:145], v[188:189], v[72:73] op_sel:[0,0,0] op_sel_hi:[1,0,1]
v_pk_fma_f32 v[74:75], v[146:147], v[188:189], v[74:75] op_sel:[0,0,0] op_sel_hi:[1,0,1]
v_pk_mul_f32 v[72:73], v[72:73], v[160:161]
v_pk_mul_f32 v[74:75], v[74:75], v[162:163]
v_cvt_pk_bf16_f32 v48, v72, v73
v_cvt_pk_bf16_f32 v49, v74, v75
v_pk_fma_f32 v[76:77], v[148:149], v[188:189], v[76:77] op_sel:[0,0,0] op_sel_hi:[1,0,1]
v_pk_fma_f32 v[78:79], v[150:151], v[188:189], v[78:79] op_sel:[0,0,0] op_sel_hi:[1,0,1]
v_pk_mul_f32 v[76:77], v[76:77], v[164:165]
v_pk_mul_f32 v[78:79], v[78:79], v[166:167]
v_cvt_pk_bf16_f32 v50, v76, v77
v_cvt_pk_bf16_f32 v51, v78, v79
buffer_store_dwordx4 v[48:51], v1, s[4:7], s27 offen offset:0 sc1
v_pk_fma_f32 v[80:81], v[152:153], v[188:189], v[80:81] op_sel:[0,0,0] op_sel_hi:[1,0,1]
v_pk_fma_f32 v[82:83], v[154:155], v[188:189], v[82:83] op_sel:[0,0,0] op_sel_hi:[1,0,1]
v_pk_mul_f32 v[80:81], v[80:81], v[168:169]
v_pk_mul_f32 v[82:83], v[82:83], v[170:171]
v_cvt_pk_bf16_f32 v52, v80, v81
v_cvt_pk_bf16_f32 v53, v82, v83
v_pk_fma_f32 v[84:85], v[156:157], v[188:189], v[84:85] op_sel:[0,0,0] op_sel_hi:[1,0,1]
v_pk_fma_f32 v[86:87], v[158:159], v[188:189], v[86:87] op_sel:[0,0,0] op_sel_hi:[1,0,1]
v_pk_mul_f32 v[84:85], v[84:85], v[172:173]
v_pk_mul_f32 v[86:87], v[86:87], v[174:175]
v_cvt_pk_bf16_f32 v54, v84, v85
v_cvt_pk_bf16_f32 v55, v86, v87
buffer_store_dwordx4 v[52:55], v1, s[4:7], s27 offen offset:1024 sc1
v_pk_fma_f32 v[56:57], v[176:177], v[136:137], v[56:57] op_sel:[0,0,0] op_sel_hi:[1,0,1]
v_pk_fma_f32 v[58:59], v[178:179], v[136:137], v[58:59] op_sel:[0,0,0] op_sel_hi:[1,0,1]
v_pk_mul_f32 v[56:57], v[56:57], v[140:141] op_sel:[0,0] op_sel_hi:[1,0]
v_pk_mul_f32 v[58:59], v[58:59], v[140:141] op_sel:[0,0] op_sel_hi:[1,0]
v_cvt_pk_bf16_f32 v24, v56, v57
v_cvt_pk_bf16_f32 v25, v58, v59
v_pk_fma_f32 v[60:61], v[176:177], v[136:137], v[60:61] op_sel:[0,1,0] op_sel_hi:[1,1,1]
v_pk_fma_f32 v[62:63], v[178:179], v[136:137], v[62:63] op_sel:[0,1,0] op_sel_hi:[1,1,1]
v_pk_mul_f32 v[60:61], v[60:61], v[140:141] op_sel:[0,1] op_sel_hi:[1,1]
v_pk_mul_f32 v[62:63], v[62:63], v[140:141] op_sel:[0,1] op_sel_hi:[1,1]
v_cvt_pk_bf16_f32 v28, v60, v61
v_cvt_pk_bf16_f32 v29, v62, v63
v_pk_fma_f32 v[64:65], v[176:177], v[138:139], v[64:65] op_sel:[0,0,0] op_sel_hi:[1,0,1]
v_pk_fma_f32 v[66:67], v[178:179], v[138:139], v[66:67] op_sel:[0,0,0] op_sel_hi:[1,0,1]
v_pk_mul_f32 v[64:65], v[64:65], v[142:143] op_sel:[0,0] op_sel_hi:[1,0]
v_pk_mul_f32 v[66:67], v[66:67], v[142:143] op_sel:[0,0] op_sel_hi:[1,0]
v_cvt_pk_bf16_f32 v32, v64, v65
v_cvt_pk_bf16_f32 v33, v66, v67
v_pk_fma_f32 v[68:69], v[176:177], v[138:139], v[68:69] op_sel:[0,1,0] op_sel_hi:[1,1,1]
v_pk_fma_f32 v[70:71], v[178:179], v[138:139], v[70:71] op_sel:[0,1,0] op_sel_hi:[1,1,1]
v_pk_mul_f32 v[68:69], v[68:69], v[142:143] op_sel:[0,1] op_sel_hi:[1,1]
v_pk_mul_f32 v[70:71], v[70:71], v[142:143] op_sel:[0,1] op_sel_hi:[1,1]
v_cvt_pk_bf16_f32 v36, v68, v69
v_cvt_pk_bf16_f32 v37, v70, v71
s_waitcnt lgkmcnt(0)
s_barrier
ds_read_b64 v[26:27], v239 offset:44032
ds_read_b64 v[30:31], v239 offset:44544
ds_read_b64 v[34:35], v239 offset:45056
ds_read_b64 v[38:39], v239 offset:45568
ds_read_b64 v[202:203], v239 offset:41984
ds_read_b64 v[206:207], v239 offset:42496
ds_read_b64 v[210:211], v239 offset:43008
ds_read_b64 v[214:215], v239 offset:43520
s_waitcnt lgkmcnt(7)
buffer_store_dwordx4 v[24:27], v1, s[4:7], s25 offen offset:0 sc1
s_waitcnt lgkmcnt(6)
buffer_store_dwordx4 v[28:31], v1, s[4:7], s25 offen offset:1024 sc1
s_waitcnt lgkmcnt(5)
buffer_store_dwordx4 v[32:35], v1, s[4:7], s25 offen offset:2048 sc1
s_waitcnt lgkmcnt(4)
buffer_store_dwordx4 v[36:39], v1, s[4:7], s25 offen offset:3072 sc1
s_waitcnt lgkmcnt(0)
v_cmp_eq_u32 vcc, s22, v240
s_nop 1
v_cndmask_b32 v202, 0, v202, vcc
v_cndmask_b32 v203, 0, v203, vcc
v_cndmask_b32 v206, 0, v206, vcc
v_cndmask_b32 v207, 0, v207, vcc
v_cndmask_b32 v210, 0, v210, vcc
v_cndmask_b32 v211, 0, v211, vcc
v_cndmask_b32 v214, 0, v214, vcc
v_cndmask_b32 v215, 0, v215, vcc
s_waitcnt vmcnt(0)
v_mov_b32 v3, 6
s_mov_b64 exec, 1
buffer_store_dword v3, off, s[4:7], s23 sc1
s_mov_b64 exec, -1
ds_read_b128 v[24:27], v1 offset:0
ds_read_b128 v[28:31], v1 offset:20480
ds_read_b128 v[32:35], v1 offset:40960
ds_read_b128 v[36:39], v238 offset:0
s_waitcnt lgkmcnt(3)
v_mfma_f32_16x16x32_bf16 v[104:107], a[128:131], v[24:27], 0
ds_read_b128 v[40:43], v1 offset:1024
ds_read_b128 v[44:47], v1 offset:21504
s_waitcnt lgkmcnt(4)
v_mfma_f32_16x16x32_bf16 v[108:111], a[128:131], v[28:31], 0
ds_read_b128 v[48:51], v1 offset:41984
ds_read_b128 v[52:55], v238 offset:1024
s_waitcnt lgkmcnt(5)
v_mfma_f32_16x16x32_bf16 v[112:115], a[128:131], v[32:35], 0
s_waitcnt lgkmcnt(4)
v_mfma_f32_16x16x32_bf16 v[116:119], a[128:131], v[36:39], 0
s_waitcnt lgkmcnt(3)
v_mfma_f32_16x16x32_bf16 v[104:107], a[48:51], v[40:43], v[104:107]
ds_read_b128 v[24:27], v1 offset:2048
ds_read_b128 v[28:31], v1 offset:22528
s_waitcnt lgkmcnt(4)
v_mfma_f32_16x16x32_bf16 v[108:111], a[48:51], v[44:47], v[108:111]
ds_read_b128 v[32:35], v1 offset:43008
ds_read_b128 v[36:39], v238 offset:2048
s_waitcnt lgkmcnt(5)
v_mfma_f32_16x16x32_bf16 v[112:115], a[48:51], v[48:51], v[112:115]
s_waitcnt lgkmcnt(4)
v_mfma_f32_16x16x32_bf16 v[116:119], a[48:51], v[52:55], v[116:119]
s_waitcnt lgkmcnt(3)
v_mfma_f32_16x16x32_bf16 v[104:107], a[52:55], v[24:27], v[104:107]
ds_read_b128 v[40:43], v1 offset:3072
ds_read_b128 v[44:47], v1 offset:23552
s_waitcnt lgkmcnt(4)
v_mfma_f32_16x16x32_bf16 v[108:111], a[52:55], v[28:31], v[108:111]
ds_read_b128 v[48:51], v1 offset:44032
ds_read_b128 v[52:55], v238 offset:3072
s_waitcnt lgkmcnt(5)
v_mfma_f32_16x16x32_bf16 v[112:115], a[52:55], v[32:35], v[112:115]
s_waitcnt lgkmcnt(4)
v_mfma_f32_16x16x32_bf16 v[116:119], a[52:55], v[36:39], v[116:119]
s_waitcnt lgkmcnt(3)
v_mfma_f32_16x16x32_bf16 v[104:107], a[56:59], v[40:43], v[104:107]
ds_read_b128 v[24:27], v1 offset:4096
ds_read_b128 v[28:31], v1 offset:24576
s_waitcnt lgkmcnt(4)
v_mfma_f32_16x16x32_bf16 v[108:111], a[56:59], v[44:47], v[108:111]
ds_read_b128 v[32:35], v1 offset:45056
ds_read_b128 v[36:39], v238 offset:4096
s_waitcnt lgkmcnt(5)
v_mfma_f32_16x16x32_bf16 v[112:115], a[56:59], v[48:51], v[112:115]
s_waitcnt lgkmcnt(4)
v_mfma_f32_16x16x32_bf16 v[116:119], a[56:59], v[52:55], v[116:119]
s_waitcnt lgkmcnt(3)
v_mfma_f32_16x16x32_bf16 v[104:107], a[212:215], v[24:27], v[104:107]
ds_read_b128 v[40:43], v1 offset:5120
ds_read_b128 v[44:47], v1 offset:25600
s_waitcnt lgkmcnt(4)
v_mfma_f32_16x16x32_bf16 v[108:111], a[212:215], v[28:31], v[108:111]
ds_read_b128 v[48:51], v1 offset:46080
ds_read_b128 v[52:55], v238 offset:5120
s_waitcnt lgkmcnt(5)
v_mfma_f32_16x16x32_bf16 v[112:115], a[212:215], v[32:35], v[112:115]
s_waitcnt lgkmcnt(4)
v_mfma_f32_16x16x32_bf16 v[116:119], a[212:215], v[36:39], v[116:119]
s_waitcnt lgkmcnt(3)
v_mfma_f32_16x16x32_bf16 v[104:107], a[104:107], v[40:43], v[104:107]
ds_read_b128 v[24:27], v1 offset:6144
ds_read_b128 v[28:31], v1 offset:26624
s_waitcnt lgkmcnt(4)
v_mfma_f32_16x16x32_bf16 v[108:111], a[104:107], v[44:47], v[108:111]
ds_read_b128 v[32:35], v1 offset:47104
ds_read_b128 v[36:39], v238 offset:6144
s_waitcnt lgkmcnt(5)
v_mfma_f32_16x16x32_bf16 v[112:115], a[104:107], v[48:51], v[112:115]
s_waitcnt lgkmcnt(4)
v_mfma_f32_16x16x32_bf16 v[116:119], a[104:107], v[52:55], v[116:119]
s_waitcnt lgkmcnt(3)
v_mfma_f32_16x16x32_bf16 v[104:107], a[176:179], v[24:27], v[104:107]
ds_read_b128 v[40:43], v1 offset:7168
ds_read_b128 v[44:47], v1 offset:27648
s_waitcnt lgkmcnt(4)
v_mfma_f32_16x16x32_bf16 v[108:111], a[176:179], v[28:31], v[108:111]
ds_read_b128 v[48:51], v1 offset:48128
ds_read_b128 v[52:55], v238 offset:7168
s_waitcnt lgkmcnt(5)
v_mfma_f32_16x16x32_bf16 v[112:115], a[176:179], v[32:35], v[112:115]
s_waitcnt lgkmcnt(4)
v_mfma_f32_16x16x32_bf16 v[116:119], a[176:179], v[36:39], v[116:119]
s_waitcnt lgkmcnt(3)
v_mfma_f32_16x16x32_bf16 v[104:107], a[108:111], v[40:43], v[104:107]
ds_read_b128 v[24:27], v1 offset:8192
ds_read_b128 v[28:31], v1 offset:28672
s_waitcnt lgkmcnt(4)
v_mfma_f32_16x16x32_bf16 v[108:111], a[108:111], v[44:47], v[108:111]
ds_read_b128 v[32:35], v1 offset:49152
ds_read_b128 v[36:39], v238 offset:8192
s_waitcnt lgkmcnt(5)
v_mfma_f32_16x16x32_bf16 v[112:115], a[108:111], v[48:51], v[112:115]
s_waitcnt lgkmcnt(4)
v_mfma_f32_16x16x32_bf16 v[116:119], a[108:111], v[52:55], v[116:119]
s_waitcnt lgkmcnt(3)
v_mfma_f32_16x16x32_bf16 v[104:107], a[112:115], v[24:27], v[104:107]
ds_read_b128 v[40:43], v1 offset:9216
ds_read_b128 v[44:47], v1 offset:29696
s_waitcnt lgkmcnt(4)
v_mfma_f32_16x16x32_bf16 v[108:111], a[112:115], v[28:31], v[108:111]
ds_read_b128 v[48:51], v1 offset:50176
ds_read_b128 v[52:55], v238 offset:9216
s_waitcnt lgkmcnt(5)
v_mfma_f32_16x16x32_bf16 v[112:115], a[112:115], v[32:35], v[112:115]
s_waitcnt lgkmcnt(4)
v_mfma_f32_16x16x32_bf16 v[116:119], a[112:115], v[36:39], v[116:119]
s_waitcnt lgkmcnt(3)
v_mfma_f32_16x16x32_bf16 v[104:107], a[164:167], v[40:43], v[104:107]
ds_read_b128 v[24:27], v1 offset:10240
ds_read_b128 v[28:31], v1 offset:30720
s_waitcnt lgkmcnt(4)
v_mfma_f32_16x16x32_bf16 v[108:111], a[164:167], v[44:47], v[108:111]
ds_read_b128 v[32:35], v1 offset:51200
ds_read_b128 v[36:39], v238 offset:10240
s_waitcnt lgkmcnt(5)
v_mfma_f32_16x16x32_bf16 v[112:115], a[164:167], v[48:51], v[112:115]
s_waitcnt lgkmcnt(4)
v_mfma_f32_16x16x32_bf16 v[116:119], a[164:167], v[52:55], v[116:119]
s_waitcnt lgkmcnt(3)
v_mfma_f32_16x16x32_bf16 v[104:107], a[68:71], v[24:27], v[104:107]
ds_read_b128 v[40:43], v1 offset:11264
ds_read_b128 v[44:47], v1 offset:31744
s_waitcnt lgkmcnt(4)
v_mfma_f32_16x16x32_bf16 v[108:111], a[68:71], v[28:31], v[108:111]
ds_read_b128 v[48:51], v1 offset:52224
ds_read_b128 v[52:55], v238 offset:11264
s_waitcnt lgkmcnt(5)
v_mfma_f32_16x16x32_bf16 v[112:115], a[68:71], v[32:35], v[112:115]
s_waitcnt lgkmcnt(4)
v_mfma_f32_16x16x32_bf16 v[116:119], a[68:71], v[36:39], v[116:119]
s_waitcnt lgkmcnt(3)
v_mfma_f32_16x16x32_bf16 v[104:107], a[72:75], v[40:43], v[104:107]
ds_read_b128 v[24:27], v1 offset:12288
ds_read_b128 v[28:31], v1 offset:32768
s_waitcnt lgkmcnt(4)
v_mfma_f32_16x16x32_bf16 v[108:111], a[72:75], v[44:47], v[108:111]
ds_read_b128 v[32:35], v1 offset:53248
ds_read_b128 v[36:39], v238 offset:12288
s_waitcnt lgkmcnt(5)
v_mfma_f32_16x16x32_bf16 v[112:115], a[72:75], v[48:51], v[112:115]
s_waitcnt lgkmcnt(4)
v_mfma_f32_16x16x32_bf16 v[116:119], a[72:75], v[52:55], v[116:119]
s_waitcnt lgkmcnt(3)
v_mfma_f32_16x16x32_bf16 v[104:107], a[244:247], v[24:27], v[104:107]
ds_read_b128 v[40:43], v1 offset:13312
ds_read_b128 v[44:47], v1 offset:33792
s_waitcnt lgkmcnt(4)
v_mfma_f32_16x16x32_bf16 v[108:111], a[244:247], v[28:31], v[108:111]
ds_read_b128 v[48:51], v1 offset:54272
ds_read_b128 v[52:55], v238 offset:13312
s_waitcnt lgkmcnt(5)
v_mfma_f32_16x16x32_bf16 v[112:115], a[244:247], v[32:35], v[112:115]
s_waitcnt lgkmcnt(4)
v_mfma_f32_16x16x32_bf16 v[116:119], a[244:247], v[36:39], v[116:119]
s_waitcnt lgkmcnt(3)
v_mfma_f32_16x16x32_bf16 v[104:107], a[216:219], v[40:43], v[104:107]
ds_read_b128 v[24:27], v1 offset:14336
ds_read_b128 v[28:31], v1 offset:34816
s_waitcnt lgkmcnt(4)
v_mfma_f32_16x16x32_bf16 v[108:111], a[216:219], v[44:47], v[108:111]
ds_read_b128 v[32:35], v1 offset:55296
ds_read_b128 v[36:39], v238 offset:14336
s_waitcnt lgkmcnt(5)
v_mfma_f32_16x16x32_bf16 v[112:115], a[216:219], v[48:51], v[112:115]
s_waitcnt lgkmcnt(4)
v_mfma_f32_16x16x32_bf16 v[116:119], a[216:219], v[52:55], v[116:119]
s_waitcnt lgkmcnt(3)
v_mfma_f32_16x16x32_bf16 v[104:107], a[220:223], v[24:27], v[104:107]
ds_read_b128 v[40:43], v1 offset:15360
ds_read_b128 v[44:47], v1 offset:35840
s_waitcnt lgkmcnt(4)
v_mfma_f32_16x16x32_bf16 v[108:111], a[220:223], v[28:31], v[108:111]
ds_read_b128 v[48:51], v1 offset:56320
ds_read_b128 v[52:55], v238 offset:15360
s_waitcnt lgkmcnt(5)
v_mfma_f32_16x16x32_bf16 v[112:115], a[220:223], v[32:35], v[112:115]
s_waitcnt lgkmcnt(4)
v_mfma_f32_16x16x32_bf16 v[116:119], a[220:223], v[36:39], v[116:119]
s_waitcnt lgkmcnt(3)
v_mfma_f32_16x16x32_bf16 v[104:107], a[248:251], v[40:43], v[104:107]
ds_read_b64 v[24:25], v2 offset:16384
ds_read_b64 v[26:27], v2 offset:16896
ds_read_b64 v[28:29], v2 offset:36864
ds_read_b64 v[30:31], v2 offset:37376
s_waitcnt lgkmcnt(6)
v_mfma_f32_16x16x32_bf16 v[108:111], a[248:251], v[44:47], v[108:111]
ds_read_b64 v[32:33], v2 offset:57344
ds_read_b64 v[34:35], v2 offset:57856
ds_read_b64 v[36:37], v239 offset:16384
ds_read_b64 v[38:39], v239 offset:16896
s_waitcnt lgkmcnt(9)
v_mfma_f32_16x16x32_bf16 v[112:115], a[248:251], v[48:51], v[112:115]
s_waitcnt lgkmcnt(8)
v_mfma_f32_16x16x32_bf16 v[116:119], a[248:251], v[52:55], v[116:119]
s_waitcnt lgkmcnt(6)
v_mfma_f32_16x16x32_bf16 v[104:107], a[136:139], v[24:27], v[104:107]
ds_read_b64 v[40:41], v2 offset:17408
ds_read_b64 v[42:43], v2 offset:17920
ds_read_b64 v[44:45], v2 offset:37888
ds_read_b64 v[46:47], v2 offset:38400
s_waitcnt lgkmcnt(8)
v_mfma_f32_16x16x32_bf16 v[108:111], a[136:139], v[28:31], v[108:111]
ds_read_b64 v[48:49], v2 offset:58368
ds_read_b64 v[50:51], v2 offset:58880
ds_read_b64 v[52:53], v239 offset:17408
ds_read_b64 v[54:55], v239 offset:17920
s_waitcnt lgkmcnt(10)
v_mfma_f32_16x16x32_bf16 v[112:115], a[136:139], v[32:35], v[112:115]
s_waitcnt lgkmcnt(8)
v_mfma_f32_16x16x32_bf16 v[116:119], a[136:139], v[36:39], v[116:119]
s_waitcnt lgkmcnt(6)
v_mfma_f32_16x16x32_bf16 v[104:107], a[140:143], v[40:43], v[104:107]
ds_read_b64 v[24:25], v2 offset:18432
ds_read_b64 v[26:27], v2 offset:18944
ds_read_b64 v[28:29], v2 offset:38912
ds_read_b64 v[30:31], v2 offset:39424
s_waitcnt lgkmcnt(8)
v_mfma_f32_16x16x32_bf16 v[108:111], a[140:143], v[44:47], v[108:111]
ds_read_b64 v[32:33], v2 offset:59392
ds_read_b64 v[34:35], v2 offset:59904
ds_read_b64 v[36:37], v239 offset:18432
ds_read_b64 v[38:39], v239 offset:18944
s_waitcnt lgkmcnt(10)
v_mfma_f32_16x16x32_bf16 v[112:115], a[140:143], v[48:51], v[112:115]
s_waitcnt lgkmcnt(8)
v_mfma_f32_16x16x32_bf16 v[116:119], a[140:143], v[52:55], v[116:119]
s_waitcnt lgkmcnt(6)
v_mfma_f32_16x16x32_bf16 v[104:107], a[252:255], v[24:27], v[104:107]
ds_read_b64 v[40:41], v2 offset:19456
ds_read_b64 v[42:43], v2 offset:19968
ds_read_b64 v[44:45], v2 offset:39936
ds_read_b64 v[46:47], v2 offset:40448
s_waitcnt lgkmcnt(8)
v_mfma_f32_16x16x32_bf16 v[108:111], a[252:255], v[28:31], v[108:111]
ds_read_b64 v[48:49], v2 offset:60416
ds_read_b64 v[50:51], v2 offset:60928
ds_read_b64 v[52:53], v239 offset:19456
ds_read_b64 v[54:55], v239 offset:19968
s_waitcnt lgkmcnt(10)
v_mfma_f32_16x16x32_bf16 v[112:115], a[252:255], v[32:35], v[112:115]
s_waitcnt lgkmcnt(8)
v_mfma_f32_16x16x32_bf16 v[116:119], a[252:255], v[36:39], v[116:119]
s_waitcnt lgkmcnt(6)
v_mfma_f32_16x16x32_bf16 v[104:107], a[76:79], v[40:43], v[104:107]
s_waitcnt lgkmcnt(4)
v_mfma_f32_16x16x32_bf16 v[108:111], a[76:79], v[44:47], v[108:111]
s_waitcnt lgkmcnt(2)
v_mfma_f32_16x16x32_bf16 v[112:115], a[76:79], v[48:51], v[112:115]
s_waitcnt lgkmcnt(0)
v_mfma_f32_16x16x32_bf16 v[116:119], a[76:79], v[52:55], v[116:119]
s_mov_b32 s24, 0x3ea52b5c
v_mul_f32 v140, s24, v140
v_mul_f32 v141, s24, v141
v_mul_f32 v142, s24, v142
v_mul_f32 v143, s24, v143
v_pk_fma_f32 v[104:105], v[180:181], v[136:137], v[104:105] op_sel:[0,0,0] op_sel_hi:[1,0,1]
v_pk_fma_f32 v[106:107], v[182:183], v[136:137], v[106:107] op_sel:[0,0,0] op_sel_hi:[1,0,1]
v_pk_mul_f32 v[104:105], v[104:105], v[140:141] op_sel:[0,0] op_sel_hi:[1,0]
v_pk_mul_f32 v[106:107], v[106:107], v[140:141] op_sel:[0,0] op_sel_hi:[1,0]
v_cvt_pk_bf16_f32 v200, v104, v105
v_cvt_pk_bf16_f32 v201, v106, v107
v_pk_fma_f32 v[108:109], v[180:181], v[136:137], v[108:109] op_sel:[0,1,0] op_sel_hi:[1,1,1]
v_pk_fma_f32 v[110:111], v[182:183], v[136:137], v[110:111] op_sel:[0,1,0] op_sel_hi:[1,1,1]
v_pk_mul_f32 v[108:109], v[108:109], v[140:141] op_sel:[0,1] op_sel_hi:[1,1]
v_pk_mul_f32 v[110:111], v[110:111], v[140:141] op_sel:[0,1] op_sel_hi:[1,1]
v_cvt_pk_bf16_f32 v204, v108, v109
v_cvt_pk_bf16_f32 v205, v110, v111
v_pk_fma_f32 v[112:113], v[180:181], v[138:139], v[112:113] op_sel:[0,0,0] op_sel_hi:[1,0,1]
v_pk_fma_f32 v[114:115], v[182:183], v[138:139], v[114:115] op_sel:[0,0,0] op_sel_hi:[1,0,1]
v_pk_mul_f32 v[112:113], v[112:113], v[142:143] op_sel:[0,0] op_sel_hi:[1,0]
v_pk_mul_f32 v[114:115], v[114:115], v[142:143] op_sel:[0,0] op_sel_hi:[1,0]
v_cvt_pk_bf16_f32 v208, v112, v113
v_cvt_pk_bf16_f32 v209, v114, v115
v_pk_fma_f32 v[116:117], v[180:181], v[138:139], v[116:117] op_sel:[0,1,0] op_sel_hi:[1,1,1]
v_pk_fma_f32 v[118:119], v[182:183], v[138:139], v[118:119] op_sel:[0,1,0] op_sel_hi:[1,1,1]
v_pk_mul_f32 v[116:117], v[116:117], v[142:143] op_sel:[0,1] op_sel_hi:[1,1]
v_pk_mul_f32 v[118:119], v[118:119], v[142:143] op_sel:[0,1] op_sel_hi:[1,1]
v_cvt_pk_bf16_f32 v212, v116, v117
v_cvt_pk_bf16_f32 v213, v118, v119
s_nop 7
s_branch FE79
FK81:
s_mul_i32 s24, s21, 960
s_lshl_b32 s25, s22, 6
s_add_u32 s24, s24, s25
s_add_u32 s24, s24, 7700480
v_lshlrev_b32 v3, 4, v240
v_lshlrev_b32 v192, 2, v241
buffer_load_dwordx4 v[176:179], v3, s[4:7], s24 offen
buffer_load_dwordx4 v[180:183], v3, s[4:7], s24 offen offset:512
buffer_load_dword v188, v192, s[4:7], s24 offen offset:256
buffer_load_dword v184, v192, s[4:7], s24 offen offset:768
s_mov_b32 s24, 30000
PL86:
buffer_load_dword v3, v236, s[4:7], 0 offen sc1
s_waitcnt vmcnt(0)
v_cmp_gt_u32 vcc, 5, v3
s_sub_u32 s24, s24, 1
s_cbranch_scc1 PD87
s_cbranch_vccnz PL86
PD87:
s_lshl_b32 s26, s60, 9
s_and_b32 s26, s26, 0xfffff000
s_lshl_b32 s27, s22, 7
s_add_u32 s26, s26, s27
s_add_u32 s26, s26, 13230080
v_lshrrev_b32 v24, 3, v0
v_lshlrev_b32 v24, 9, v24
v_and_b32 v25, 7, v0
v_lshlrev_b32 v25, 4, v25
v_add_u32 v24, v24, v25
buffer_load_dwordx4 v[28:31], v24, s[4:7], s26 offen
s_mul_i32 s69, s62, 20480
s_add_u32 s69, s69, 10346496
s_mul_i32 s70, s22, 20480
s_mov_b32 m0, s70
s_nop 0
buffer_load_dwordx4 v1, s[4:7], s69 offen offset:0 sc1 lds
s_mov_b32 m0, s70
s_nop 0
buffer_load_dwordx4 v1, s[4:7], s69 offen offset:1024 sc1 lds
s_mov_b32 m0, s70
s_nop 0
buffer_load_dwordx4 v1, s[4:7], s69 offen offset:2048 sc1 lds
s_mov_b32 m0, s70
s_nop 0
buffer_load_dwordx4 v1, s[4:7], s69 offen offset:3072 sc1 lds
s_add_u32 s69, s69, 4096
s_add_u32 s70, s70, 4096
s_mov_b32 m0, s70
s_nop 0
buffer_load_dwordx4 v1, s[4:7], s69 offen offset:0 sc1 lds
s_mov_b32 m0, s70
s_nop 0
buffer_load_dwordx4 v1, s[4:7], s69 offen offset:1024 sc1 lds
s_mov_b32 m0, s70
s_nop 0
buffer_load_dwordx4 v1, s[4:7], s69 offen offset:2048 sc1 lds
s_mov_b32 m0, s70
s_nop 0
buffer_load_dwordx4 v1, s[4:7], s69 offen offset:3072 sc1 lds
s_add_u32 s69, s69, 4096
s_add_u32 s70, s70, 4096
s_mov_b32 m0, s70
s_nop 0
buffer_load_dwordx4 v1, s[4:7], s69 offen offset:0 sc1 lds
s_mov_b32 m0, s70
s_nop 0
buffer_load_dwordx4 v1, s[4:7], s69 offen offset:1024 sc1 lds
s_waitcnt vmcnt(10)
v_mov_b32 v32, v28
v_mov_b32 v33, v29
v_mov_b32 v34, v30
v_mov_b32 v35, v31
v_permlane32_swap_b32 v28, v32
v_permlane32_swap_b32 v29, v33
v_permlane32_swap_b32 v30, v34
v_permlane32_swap_b32 v31, v35
v_add_f32 v28, v28, v32
v_add_f32 v29, v29, v33
v_add_f32 v30, v30, v34
v_add_f32 v31, v31, v35
v_mov_b32 v32, v28
v_mov_b32 v33, v29
v_mov_b32 v34, v30
v_mov_b32 v35, v31
v_permlane16_swap_b32 v28, v32
v_permlane16_swap_b32 v29, v33
v_permlane16_swap_b32 v30, v34
v_permlane16_swap_b32 v31, v35
v_add_f32 v28, v28, v32
v_add_f32 v29, v29, v33
v_add_f32 v30, v30, v34
v_add_f32 v31, v31, v35
v_add_f32_dpp v28, v28, v28 row_ror:8 row_mask:0xf bank_mask:0xf
v_add_f32_dpp v29, v29, v29 row_ror:8 row_mask:0xf bank_mask:0xf
v_add_f32_dpp v30, v30, v30 row_ror:8 row_mask:0xf bank_mask:0xf
v_add_f32_dpp v31, v31, v31 row_ror:8 row_mask:0xf bank_mask:0xf
s_mov_b32 s26, 0xbacccccd
s_mov_b32 s27, 0x3acccccd
v_mul_f32 v32, s26, v28
v_mul_f32 v33, s26, v30
v_mul_f32 v34, s27, v29
v_mul_f32 v35, s27, v31
v_fma_f32 v34, -v32, v32, v34
v_fma_f32 v35, -v33, v33, v35
v_max_f32 v34, 0, v34
v_max_f32 v35, 0, v35
v_add_f32 v34, 0x3727c5ac, v34
v_add_f32 v35, 0x3727c5ac, v35
v_rsq_f32 v34, v34
v_rsq_f32 v35, v35
v_and_b32 v24, 7, v0
v_lshlrev_b32 v24, 3, v24
s_lshl_b32 s26, s22, 6
s_add_u32 s26, s26, 102400
v_add_u32 v24, s26, v24
s_mov_b64 exec, 0xff
ds_write_b64 v24, v[32:33]
ds_write_b64 v24, v[34:35] offset:256
s_mov_b64 exec, -1
s_waitcnt vmcnt(5)
s_waitcnt lgkmcnt(0)
s_barrier
ds_read_b128 v[24:27], v1 offset:0
ds_read_b128 v[28:31], v1 offset:20480
ds_read_b128 v[32:35], v1 offset:40960
ds_read_b128 v[36:39], v238 offset:0
s_waitcnt lgkmcnt(3)
v_mfma_f32_16x16x32_bf16 v[56:59], a[212:215], v[24:27], 0
ds_read_b128 v[40:43], v1 offset:1024
s_waitcnt lgkmcnt(3)
v_mfma_f32_16x16x32_bf16 v[60:63], a[212:215], v[28:31], 0
ds_read_b128 v[44:47], v1 offset:21504
s_waitcnt lgkmcnt(3)
v_mfma_f32_16x16x32_bf16 v[64:67], a[212:215], v[32:35], 0
ds_read_b128 v[48:51], v1 offset:41984
s_waitcnt lgkmcnt(3)
v_mfma_f32_16x16x32_bf16 v[68:71], a[212:215], v[36:39], 0
ds_read_b128 v[52:55], v238 offset:1024
v_mfma_f32_16x16x32_bf16 v[72:75], v[24:27], a[104:107], 0
s_mov_b32 m0, s70
s_nop 0
buffer_load_dwordx4 v1, s[4:7], s69 offen offset:2048 sc1 lds
v_mfma_f32_16x16x32_bf16 v[76:79], v[28:31], a[104:107], 0
buffer_load_dwordx4 a[176:179], v1, s[4:7], s43 offen
v_mfma_f32_16x16x32_bf16 v[80:83], v[32:35], a[104:107], 0
buffer_load_dwordx4 a[164:167], v1, s[4:7], s43 offen offset:1024
v_mfma_f32_16x16x32_bf16 v[84:87], v[36:39], a[104:107], 0
buffer_load_dwordx4 a[244:247], v1, s[4:7], s43 offen offset:2048
s_waitcnt vmcnt(2)
v_mfma_f32_16x16x32_bf16 v[88:91], v[24:27], a[176:179], 0
v_mfma_f32_16x16x32_bf16 v[92:95], v[28:31], a[176:179], 0
v_mfma_f32_16x16x32_bf16 v[96:99], v[32:35], a[176:179], 0
v_mfma_f32_16x16x32_bf16 v[100:103], v[36:39], a[176:179], 0
s_waitcnt lgkmcnt(3)
v_mfma_f32_16x16x32_bf16 v[56:59], a[108:111], v[40:43], v[56:59]
ds_read_b128 v[24:27], v1 offset:2048
s_waitcnt lgkmcnt(3)
v_mfma_f32_16x16x32_bf16 v[60:63], a[108:111], v[44:47], v[60:63]
ds_read_b128 v[28:31], v1 offset:22528
s_waitcnt lgkmcnt(3)
v_mfma_f32_16x16x32_bf16 v[64:67], a[108:111], v[48:51], v[64:67]
ds_read_b128 v[32:35], v1 offset:43008
s_waitcnt lgkmcnt(3)
v_mfma_f32_16x16x32_bf16 v[68:71], a[108:111], v[52:55], v[68:71]
ds_read_b128 v[36:39], v238 offset:2048
v_mfma_f32_16x16x32_bf16 v[72:75], v[40:43], a[112:115], v[72:75]
s_mov_b32 m0, s70
s_nop 0
buffer_load_dwordx4 v1, s[4:7], s69 offen offset:3072 sc1 lds
v_mfma_f32_16x16x32_bf16 v[76:79], v[44:47], a[112:115], v[76:79]
buffer_load_dwordx4 a[248:251], v1, s[4:7], s43 offen offset:3072
v_mfma_f32_16x16x32_bf16 v[80:83], v[48:51], a[112:115], v[80:83]
s_add_u32 s43, s43, 4096
buffer_load_dwordx4 a[252:255], v1, s[4:7], s43 offen
v_mfma_f32_16x16x32_bf16 v[84:87], v[52:55], a[112:115], v[84:87]
buffer_load_dwordx4 a[20:23], v1, s[4:7], s43 offen offset:1024
s_waitcnt vmcnt(5)
v_mfma_f32_16x16x32_bf16 v[88:91], v[40:43], a[164:167], v[88:91]
v_mfma_f32_16x16x32_bf16 v[92:95], v[44:47], a[164:167], v[92:95]
v_mfma_f32_16x16x32_bf16 v[96:99], v[48:51], a[164:167], v[96:99]
v_mfma_f32_16x16x32_bf16 v[100:103], v[52:55], a[164:167], v[100:103]
s_waitcnt lgkmcnt(3)
v_mfma_f32_16x16x32_bf16 v[56:59], a[68:71], v[24:27], v[56:59]
ds_read_b128 v[40:43], v1 offset:3072
s_waitcnt lgkmcnt(3)
v_mfma_f32_16x16x32_bf16 v[60:63], a[68:71], v[28:31], v[60:63]
ds_read_b128 v[44:47], v1 offset:23552
s_waitcnt lgkmcnt(3)
v_mfma_f32_16x16x32_bf16 v[64:67], a[68:71], v[32:35], v[64:67]
ds_read_b128 v[48:51], v1 offset:44032
s_waitcnt lgkmcnt(3)
v_mfma_f32_16x16x32_bf16 v[68:71], a[68:71], v[36:39], v[68:71]
ds_read_b128 v[52:55], v238 offset:3072
v_mfma_f32_16x16x32_bf16 v[72:75], v[24:27], a[72:75], v[72:75]
s_add_u32 s69, s69, 4096
s_add_u32 s70, s70, 4096
s_mov_b32 m0, s70
s_nop 0
buffer_load_dwordx4 v1, s[4:7], s69 offen offset:0 sc1 lds
v_mfma_f32_16x16x32_bf16 v[76:79], v[28:31], a[72:75], v[76:79]
buffer_load_dwordx4 a[24:27], v1, s[4:7], s43 offen offset:2048
v_mfma_f32_16x16x32_bf16 v[80:83], v[32:35], a[72:75], v[80:83]
buffer_load_dwordx4 a[184:187], v1, s[4:7], s43 offen offset:3072
v_mfma_f32_16x16x32_bf16 v[84:87], v[36:39], a[72:75], v[84:87]
s_add_u32 s43, s43, 4096
buffer_load_dwordx4 a[188:191], v1, s[4:7], s43 offen
s_waitcnt vmcnt(8)
v_mfma_f32_16x16x32_bf16 v[88:91], v[24:27], a[244:247], v[88:91]
v_mfma_f32_16x16x32_bf16 v[92:95], v[28:31], a[244:247], v[92:95]
v_mfma_f32_16x16x32_bf16 v[96:99], v[32:35], a[244:247], v[96:99]
v_mfma_f32_16x16x32_bf16 v[100:103], v[36:39], a[244:247], v[100:103]
s_waitcnt lgkmcnt(3)
v_mfma_f32_16x16x32_bf16 v[56:59], a[216:219], v[40:43], v[56:59]
ds_read_b128 v[24:27], v1 offset:4096
s_waitcnt lgkmcnt(3)
v_mfma_f32_16x16x32_bf16 v[60:63], a[216:219], v[44:47], v[60:63]
ds_read_b128 v[28:31], v1 offset:24576
s_waitcnt lgkmcnt(3)
v_mfma_f32_16x16x32_bf16 v[64:67], a[216:219], v[48:51], v[64:67]
ds_read_b128 v[32:35], v1 offset:45056
s_waitcnt lgkmcnt(3)
v_mfma_f32_16x16x32_bf16 v[68:71], a[216:219], v[52:55], v[68:71]
ds_read_b128 v[36:39], v238 offset:4096
v_mfma_f32_16x16x32_bf16 v[72:75], v[40:43], a[220:223], v[72:75]
s_mov_b32 m0, s70
s_nop 0
buffer_load_dwordx4 v1, s[4:7], s69 offen offset:1024 sc1 lds
v_mfma_f32_16x16x32_bf16 v[76:79], v[44:47], a[220:223], v[76:79]
buffer_load_dwordx4 a[192:195], v1, s[4:7], s43 offen offset:1024
v_mfma_f32_16x16x32_bf16 v[80:83], v[48:51], a[220:223], v[80:83]
buffer_load_dwordx4 a[180:183], v1, s[4:7], s43 offen offset:2048
v_mfma_f32_16x16x32_bf16 v[84:87], v[52:55], a[220:223], v[84:87]
buffer_load_dwordx4 a[8:11], v1, s[4:7], s43 offen offset:3072
s_waitcnt vmcnt(10)
v_mfma_f32_16x16x32_bf16 v[88:91], v[40:43], a[248:251], v[88:91]
v_mfma_f32_16x16x32_bf16 v[92:95], v[44:47], a[248:251], v[92:95]
v_mfma_f32_16x16x32_bf16 v[96:99], v[48:51], a[248:251], v[96:99]
v_mfma_f32_16x16x32_bf16 v[100:103], v[52:55], a[248:251], v[100:103]
s_barrier
s_waitcnt lgkmcnt(3)
v_mfma_f32_16x16x32_bf16 v[56:59], a[136:139], v[24:27], v[56:59]
ds_read_b128 v[40:43], v1 offset:5120
s_waitcnt lgkmcnt(3)
v_mfma_f32_16x16x32_bf16 v[60:63], a[136:139], v[28:31], v[60:63]
ds_read_b128 v[44:47], v1 offset:25600
s_waitcnt lgkmcnt(3)
v_mfma_f32_16x16x32_bf16 v[64:67], a[136:139], v[32:35], v[64:67]
ds_read_b128 v[48:51], v1 offset:46080
s_waitcnt lgkmcnt(3)
v_mfma_f32_16x16x32_bf16 v[68:71], a[136:139], v[36:39], v[68:71]
ds_read_b128 v[52:55], v238 offset:5120
v_mfma_f32_16x16x32_bf16 v[72:75], v[24:27], a[140:143], v[72:75]
s_mov_b32 m0, s70
s_nop 0
buffer_load_dwordx4 v1, s[4:7], s69 offen offset:2048 sc1 lds
v_mfma_f32_16x16x32_bf16 v[76:79], v[28:31], a[140:143], v[76:79]
s_add_u32 s43, s43, 4096
buffer_load_dwordx4 a[12:15], v1, s[4:7], s43 offen
v_mfma_f32_16x16x32_bf16 v[80:83], v[32:35], a[140:143], v[80:83]
buffer_load_dwordx4 a[16:19], v1, s[4:7], s43 offen offset:1024
v_mfma_f32_16x16x32_bf16 v[84:87], v[36:39], a[140:143], v[84:87]
buffer_load_dwordx4 a[40:43], v1, s[4:7], s43 offen offset:2048
s_waitcnt vmcnt(13)
v_mfma_f32_16x16x32_bf16 v[88:91], v[24:27], a[252:255], v[88:91]
v_mfma_f32_16x16x32_bf16 v[92:95], v[28:31], a[252:255], v[92:95]
v_mfma_f32_16x16x32_bf16 v[96:99], v[32:35], a[252:255], v[96:99]
v_mfma_f32_16x16x32_bf16 v[100:103], v[36:39], a[252:255], v[100:103]
s_waitcnt lgkmcnt(3)
v_mfma_f32_16x16x32_bf16 v[56:59], a[76:79], v[40:43], v[56:59]
ds_read_b128 v[24:27], v1 offset:6144
s_waitcnt lgkmcnt(3)
v_mfma_f32_16x16x32_bf16 v[60:63], a[76:79], v[44:47], v[60:63]
ds_read_b128 v[28:31], v1 offset:26624
s_waitcnt lgkmcnt(3)
v_mfma_f32_16x16x32_bf16 v[64:67], a[76:79], v[48:51], v[64:67]
ds_read_b128 v[32:35], v1 offset:47104
s_waitcnt lgkmcnt(3)
v_mfma_f32_16x16x32_bf16 v[68:71], a[76:79], v[52:55], v[68:71]
ds_read_b128 v[36:39], v238 offset:6144
v_mfma_f32_16x16x32_bf16 v[72:75], v[40:43], a[80:83], v[72:75]
s_mov_b32 m0, s70
s_nop 0
buffer_load_dwordx4 v1, s[4:7], s69 offen offset:3072 sc1 lds
v_mfma_f32_16x16x32_bf16 v[76:79], v[44:47], a[80:83], v[76:79]
buffer_load_dwordx4 a[44:47], v1, s[4:7], s43 offen offset:3072
v_mfma_f32_16x16x32_bf16 v[80:83], v[48:51], a[80:83], v[80:83]
s_add_u32 s40, s40, 4096
buffer_load_dwordx4 a[200:203], v1, s[4:7], s40 offen
v_mfma_f32_16x16x32_bf16 v[84:87], v[52:55], a[80:83], v[84:87]
s_add_u32 s41, s41, 4096
buffer_load_dwordx4 a[120:123], v1, s[4:7], s41 offen
s_waitcnt vmcnt(16)
v_mfma_f32_16x16x32_bf16 v[88:91], v[40:43], a[20:23], v[88:91]
v_mfma_f32_16x16x32_bf16 v[92:95], v[44:47], a[20:23], v[92:95]
v_mfma_f32_16x16x32_bf16 v[96:99], v[48:51], a[20:23], v[96:99]
v_mfma_f32_16x16x32_bf16 v[100:103], v[52:55], a[20:23], v[100:103]
s_waitcnt lgkmcnt(3)
v_mfma_f32_16x16x32_bf16 v[56:59], a[84:87], v[24:27], v[56:59]
ds_read_b128 v[40:43], v1 offset:7168
s_waitcnt lgkmcnt(3)
v_mfma_f32_16x16x32_bf16 v[60:63], a[84:87], v[28:31], v[60:63]
ds_read_b128 v[44:47], v1 offset:27648
s_waitcnt lgkmcnt(3)
v_mfma_f32_16x16x32_bf16 v[64:67], a[84:87], v[32:35], v[64:67]
ds_read_b128 v[48:51], v1 offset:48128
s_waitcnt lgkmcnt(3)
v_mfma_f32_16x16x32_bf16 v[68:71], a[84:87], v[36:39], v[68:71]
ds_read_b128 v[52:55], v238 offset:7168
v_mfma_f32_16x16x32_bf16 v[72:75], v[24:27], a[88:91], v[72:75]
s_add_u32 s69, s69, 4096
s_add_u32 s70, s70, 4096
s_mov_b32 m0, s70
s_nop 0
buffer_load_dwordx4 v1, s[4:7], s69 offen offset:0 sc1 lds
v_mfma_f32_16x16x32_bf16 v[76:79], v[28:31], a[88:91], v[76:79]
s_add_u32 s43, s43, 4096
buffer_load_dwordx4 a[124:127], v1, s[4:7], s43 offen
v_mfma_f32_16x16x32_bf16 v[80:83], v[32:35], a[88:91], v[80:83]
buffer_load_dwordx4 a[196:199], v1, s[4:7], s40 offen offset:1024
v_mfma_f32_16x16x32_bf16 v[84:87], v[36:39], a[88:91], v[84:87]
buffer_load_dwordx4 a[28:31], v1, s[4:7], s41 offen offset:1024
s_waitcnt vmcnt(18)
v_mfma_f32_16x16x32_bf16 v[88:91], v[24:27], a[24:27], v[88:91]
v_mfma_f32_16x16x32_bf16 v[92:95], v[28:31], a[24:27], v[92:95]
v_mfma_f32_16x16x32_bf16 v[96:99], v[32:35], a[24:27], v[96:99]
v_mfma_f32_16x16x32_bf16 v[100:103], v[36:39], a[24:27], v[100:103]
s_waitcnt lgkmcnt(3)
v_mfma_f32_16x16x32_bf16 v[56:59], a[92:95], v[40:43], v[56:59]
ds_read_b128 v[24:27], v1 offset:8192
s_waitcnt lgkmcnt(3)
v_mfma_f32_16x16x32_bf16 v[60:63], a[92:95], v[44:47], v[60:63]
ds_read_b128 v[28:31], v1 offset:28672
s_waitcnt lgkmcnt(3)
v_mfma_f32_16x16x32_bf16 v[64:67], a[92:95], v[48:51], v[64:67]
ds_read_b128 v[32:35], v1 offset:49152
s_waitcnt lgkmcnt(3)
v_mfma_f32_16x16x32_bf16 v[68:71], a[92:95], v[52:55], v[68:71]
ds_read_b128 v[36:39], v238 offset:8192
v_mfma_f32_16x16x32_bf16 v[72:75], v[40:43], a[144:147], v[72:75]
s_mov_b32 m0, s70
s_nop 0
buffer_load_dwordx4 v1, s[4:7], s69 offen offset:1024 sc1 lds
v_mfma_f32_16x16x32_bf16 v[76:79], v[44:47], a[144:147], v[76:79]
buffer_load_dwordx4 a[32:35], v1, s[4:7], s43 offen offset:1024
v_mfma_f32_16x16x32_bf16 v[80:83], v[48:51], a[144:147], v[80:83]
buffer_load_dwordx4 a[36:39], v1, s[4:7], s40 offen offset:2048
v_mfma_f32_16x16x32_bf16 v[84:87], v[52:55], a[144:147], v[84:87]
buffer_load_dwordx4 a[60:63], v1, s[4:7], s41 offen offset:2048
s_waitcnt vmcnt(21)
v_mfma_f32_16x16x32_bf16 v[88:91], v[40:43], a[184:187], v[88:91]
v_mfma_f32_16x16x32_bf16 v[92:95], v[44:47], a[184:187], v[92:95]
v_mfma_f32_16x16x32_bf16 v[96:99], v[48:51], a[184:187], v[96:99]
v_mfma_f32_16x16x32_bf16 v[100:103], v[52:55], a[184:187], v[100:103]
s_waitcnt lgkmcnt(3)
v_mfma_f32_16x16x32_bf16 v[56:59], a[148:151], v[24:27], v[56:59]
ds_read_b128 v[40:43], v1 offset:9216
s_waitcnt lgkmcnt(3)
v_mfma_f32_16x16x32_bf16 v[60:63], a[148:151], v[28:31], v[60:63]
ds_read_b128 v[44:47], v1 offset:29696
s_waitcnt lgkmcnt(3)
v_mfma_f32_16x16x32_bf16 v[64:67], a[148:151], v[32:35], v[64:67]
ds_read_b128 v[48:51], v1 offset:50176
s_waitcnt lgkmcnt(3)
v_mfma_f32_16x16x32_bf16 v[68:71], a[148:151], v[36:39], v[68:71]
ds_read_b128 v[52:55], v238 offset:9216
v_mfma_f32_16x16x32_bf16 v[72:75], v[24:27], a[224:227], v[72:75]
s_mov_b32 m0, s70
s_nop 0
buffer_load_dwordx4 v1, s[4:7], s69 offen offset:2048 sc1 lds
v_mfma_f32_16x16x32_bf16 v[76:79], v[28:31], a[224:227], v[76:79]
buffer_load_dwordx4 a[64:67], v1, s[4:7], s43 offen offset:2048
v_mfma_f32_16x16x32_bf16 v[80:83], v[32:35], a[224:227], v[80:83]
buffer_load_dwordx4 a[132:135], v1, s[4:7], s40 offen offset:3072
v_mfma_f32_16x16x32_bf16 v[84:87], v[36:39], a[224:227], v[84:87]
buffer_load_dwordx4 a[204:207], v1, s[4:7], s41 offen offset:3072
s_waitcnt vmcnt(24)
v_mfma_f32_16x16x32_bf16 v[88:91], v[24:27], a[188:191], v[88:91]
v_mfma_f32_16x16x32_bf16 v[92:95], v[28:31], a[188:191], v[92:95]
v_mfma_f32_16x16x32_bf16 v[96:99], v[32:35], a[188:191], v[96:99]
v_mfma_f32_16x16x32_bf16 v[100:103], v[36:39], a[188:191], v[100:103]
s_waitcnt vmcnt(19)
s_barrier
s_waitcnt lgkmcnt(3)
v_mfma_f32_16x16x32_bf16 v[56:59], a[228:231], v[40:43], v[56:59]
ds_read_b128 v[24:27], v1 offset:10240
s_waitcnt lgkmcnt(3)
v_mfma_f32_16x16x32_bf16 v[60:63], a[228:231], v[44:47], v[60:63]
ds_read_b128 v[28:31], v1 offset:30720
s_waitcnt lgkmcnt(3)
v_mfma_f32_16x16x32_bf16 v[64:67], a[228:231], v[48:51], v[64:67]
ds_read_b128 v[32:35], v1 offset:51200
s_waitcnt lgkmcnt(3)
v_mfma_f32_16x16x32_bf16 v[68:71], a[228:231], v[52:55], v[68:71]
ds_read_b128 v[36:39], v238 offset:10240
v_mfma_f32_16x16x32_bf16 v[72:75], v[40:43], a[96:99], v[72:75]
s_mov_b32 m0, s70
s_nop 0
buffer_load_dwordx4 v1, s[4:7], s69 offen offset:3072 sc1 lds
v_mfma_f32_16x16x32_bf16 v[76:79], v[44:47], a[96:99], v[76:79]
buffer_load_dwordx4 a[208:211], v1, s[4:7], s43 offen offset:3072
v_mfma_f32_16x16x32_bf16 v[80:83], v[48:51], a[96:99], v[80:83]
buffer_load_dwordx4 a[128:131], v1, s[4:7], s42 offen
v_mfma_f32_16x16x32_bf16 v[84:87], v[52:55], a[96:99], v[84:87]
buffer_load_dwordx4 a[48:51], v1, s[4:7], s42 offen offset:1024
v_mfma_f32_16x16x32_bf16 v[88:91], v[40:43], a[192:195], v[88:91]
v_mfma_f32_16x16x32_bf16 v[92:95], v[44:47], a[192:195], v[92:95]
v_mfma_f32_16x16x32_bf16 v[96:99], v[48:51], a[192:195], v[96:99]
v_mfma_f32_16x16x32_bf16 v[100:103], v[52:55], a[192:195], v[100:103]
s_waitcnt lgkmcnt(3)
v_mfma_f32_16x16x32_bf16 v[56:59], a[100:103], v[24:27], v[56:59]
ds_read_b128 v[40:43], v1 offset:11264
s_waitcnt lgkmcnt(3)
v_mfma_f32_16x16x32_bf16 v[60:63], a[100:103], v[28:31], v[60:63]
ds_read_b128 v[44:47], v1 offset:31744
s_waitcnt lgkmcnt(3)
v_mfma_f32_16x16x32_bf16 v[64:67], a[100:103], v[32:35], v[64:67]
ds_read_b128 v[48:51], v1 offset:52224
s_waitcnt lgkmcnt(3)
v_mfma_f32_16x16x32_bf16 v[68:71], a[100:103], v[36:39], v[68:71]
ds_read_b128 v[52:55], v238 offset:11264
v_mfma_f32_16x16x32_bf16 v[72:75], v[24:27], a[116:119], v[72:75]
v_mfma_f32_16x16x32_bf16 v[76:79], v[28:31], a[116:119], v[76:79]
buffer_load_dwordx4 a[52:55], v1, s[4:7], s42 offen offset:2048
v_mfma_f32_16x16x32_bf16 v[80:83], v[32:35], a[116:119], v[80:83]
buffer_load_dwordx4 a[56:59], v1, s[4:7], s42 offen offset:3072
v_mfma_f32_16x16x32_bf16 v[84:87], v[36:39], a[116:119], v[84:87]
s_add_u32 s42, s42, 4096
buffer_load_dwordx4 a[212:215], v1, s[4:7], s42 offen
v_mfma_f32_16x16x32_bf16 v[88:91], v[24:27], a[180:183], v[88:91]
v_mfma_f32_16x16x32_bf16 v[92:95], v[28:31], a[180:183], v[92:95]
v_mfma_f32_16x16x32_bf16 v[96:99], v[32:35], a[180:183], v[96:99]
v_mfma_f32_16x16x32_bf16 v[100:103], v[36:39], a[180:183], v[100:103]
s_waitcnt lgkmcnt(3)
v_mfma_f32_16x16x32_bf16 v[56:59], a[156:159], v[40:43], v[56:59]
ds_read_b128 v[24:27], v1 offset:12288
s_waitcnt lgkmcnt(3)
v_mfma_f32_16x16x32_bf16 v[60:63], a[156:159], v[44:47], v[60:63]
ds_read_b128 v[28:31], v1 offset:32768
s_waitcnt lgkmcnt(3)
v_mfma_f32_16x16x32_bf16 v[64:67], a[156:159], v[48:51], v[64:67]
ds_read_b128 v[32:35], v1 offset:53248
s_waitcnt lgkmcnt(3)
v_mfma_f32_16x16x32_bf16 v[68:71], a[156:159], v[52:55], v[68:71]
ds_read_b128 v[36:39], v238 offset:12288
v_mfma_f32_16x16x32_bf16 v[72:75], v[40:43], a[160:163], v[72:75]
v_mfma_f32_16x16x32_bf16 v[76:79], v[44:47], a[160:163], v[76:79]
buffer_load_dwordx4 a[104:107], v1, s[4:7], s42 offen offset:1024
v_mfma_f32_16x16x32_bf16 v[80:83], v[48:51], a[160:163], v[80:83]
buffer_load_dwordx4 a[176:179], v1, s[4:7], s42 offen offset:2048
v_mfma_f32_16x16x32_bf16 v[84:87], v[52:55], a[160:163], v[84:87]
buffer_load_dwordx4 a[108:111], v1, s[4:7], s42 offen offset:3072
v_mfma_f32_16x16x32_bf16 v[88:91], v[40:43], a[8:11], v[88:91]
v_mfma_f32_16x16x32_bf16 v[92:95], v[44:47], a[8:11], v[92:95]
v_mfma_f32_16x16x32_bf16 v[96:99], v[48:51], a[8:11], v[96:99]
v_mfma_f32_16x16x32_bf16 v[100:103], v[52:55], a[8:11], v[100:103]
s_waitcnt lgkmcnt(3)
v_mfma_f32_16x16x32_bf16 v[56:59], a[232:235], v[24:27], v[56:59]
ds_read_b128 v[40:43], v1 offset:13312
s_waitcnt lgkmcnt(3)
v_mfma_f32_16x16x32_bf16 v[60:63], a[232:235], v[28:31], v[60:63]
ds_read_b128 v[44:47], v1 offset:33792
s_waitcnt lgkmcnt(3)
v_mfma_f32_16x16x32_bf16 v[64:67], a[232:235], v[32:35], v[64:67]
ds_read_b128 v[48:51], v1 offset:54272
s_waitcnt lgkmcnt(3)
v_mfma_f32_16x16x32_bf16 v[68:71], a[232:235], v[36:39], v[68:71]
ds_read_b128 v[52:55], v238 offset:13312
v_mfma_f32_16x16x32_bf16 v[72:75], v[24:27], a[236:239], v[72:75]
v_mfma_f32_16x16x32_bf16 v[76:79], v[28:31], a[236:239], v[76:79]
s_add_u32 s42, s42, 4096
buffer_load_dwordx4 a[112:115], v1, s[4:7], s42 offen
v_mfma_f32_16x16x32_bf16 v[80:83], v[32:35], a[236:239], v[80:83]
buffer_load_dwordx4 a[164:167], v1, s[4:7], s42 offen offset:1024
v_mfma_f32_16x16x32_bf16 v[84:87], v[36:39], a[236:239], v[84:87]
buffer_load_dwordx4 a[68:71], v1, s[4:7], s42 offen offset:2048
s_waitcnt vmcnt(31)
v_mfma_f32_16x16x32_bf16 v[88:91], v[24:27], a[12:15], v[88:91]
v_mfma_f32_16x16x32_bf16 v[92:95], v[28:31], a[12:15], v[92:95]
v_mfma_f32_16x16x32_bf16 v[96:99], v[32:35], a[12:15], v[96:99]
v_mfma_f32_16x16x32_bf16 v[100:103], v[36:39], a[12:15], v[100:103]
s_waitcnt lgkmcnt(3)
v_mfma_f32_16x16x32_bf16 v[56:59], a[240:243], v[40:43], v[56:59]
ds_read_b128 v[24:27], v1 offset:14336
s_waitcnt lgkmcnt(3)
v_mfma_f32_16x16x32_bf16 v[60:63], a[240:243], v[44:47], v[60:63]
ds_read_b128 v[28:31], v1 offset:34816
s_waitcnt lgkmcnt(3)
v_mfma_f32_16x16x32_bf16 v[64:67], a[240:243], v[48:51], v[64:67]
ds_read_b128 v[32:35], v1 offset:55296
s_waitcnt lgkmcnt(3)
v_mfma_f32_16x16x32_bf16 v[68:71], a[240:243], v[52:55], v[68:71]
ds_read_b128 v[36:39], v238 offset:14336
v_mfma_f32_16x16x32_bf16 v[72:75], v[40:43], a[152:155], v[72:75]
v_mfma_f32_16x16x32_bf16 v[76:79], v[44:47], a[152:155], v[76:79]
buffer_load_dwordx4 a[72:75], v1, s[4:7], s42 offen offset:3072
v_mfma_f32_16x16x32_bf16 v[80:83], v[48:51], a[152:155], v[80:83]
s_add_u32 s42, s42, 4096
buffer_load_dwordx4 a[244:247], v1, s[4:7], s42 offen
v_mfma_f32_16x16x32_bf16 v[84:87], v[52:55], a[152:155], v[84:87]
buffer_load_dwordx4 a[216:219], v1, s[4:7], s42 offen offset:1024
s_waitcnt vmcnt(33)
v_mfma_f32_16x16x32_bf16 v[88:91], v[40:43], a[16:19], v[88:91]
v_mfma_f32_16x16x32_bf16 v[92:95], v[44:47], a[16:19], v[92:95]
v_mfma_f32_16x16x32_bf16 v[96:99], v[48:51], a[16:19], v[96:99]
v_mfma_f32_16x16x32_bf16 v[100:103], v[52:55], a[16:19], v[100:103]
s_waitcnt vmcnt(15)
s_barrier
s_waitcnt lgkmcnt(3)
v_mfma_f32_16x16x32_bf16 v[56:59], a[0:3], v[24:27], v[56:59]
ds_read_b128 v[40:43], v1 offset:15360
s_waitcnt lgkmcnt(3)
v_mfma_f32_16x16x32_bf16 v[60:63], a[0:3], v[28:31], v[60:63]
ds_read_b128 v[44:47], v1 offset:35840
s_waitcnt lgkmcnt(3)
v_mfma_f32_16x16x32_bf16 v[64:67], a[0:3], v[32:35], v[64:67]
ds_read_b128 v[48:51], v1 offset:56320
s_waitcnt lgkmcnt(3)
v_mfma_f32_16x16x32_bf16 v[68:71], a[0:3], v[36:39], v[68:71]
ds_read_b128 v[52:55], v238 offset:15360
v_mfma_f32_16x16x32_bf16 v[72:75], v[24:27], a[4:7], v[72:75]
v_mfma_f32_16x16x32_bf16 v[76:79], v[28:31], a[4:7], v[76:79]
buffer_load_dwordx4 a[220:223], v1, s[4:7], s42 offen offset:2048
v_mfma_f32_16x16x32_bf16 v[80:83], v[32:35], a[4:7], v[80:83]
buffer_load_dwordx4 a[248:251], v1, s[4:7], s42 offen offset:3072
v_mfma_f32_16x16x32_bf16 v[84:87], v[36:39], a[4:7], v[84:87]
s_add_u32 s42, s42, 4096
buffer_load_dwordx4 a[136:139], v1, s[4:7], s42 offen
v_mfma_f32_16x16x32_bf16 v[88:91], v[24:27], a[40:43], v[88:91]
v_mfma_f32_16x16x32_bf16 v[92:95], v[28:31], a[40:43], v[92:95]
v_mfma_f32_16x16x32_bf16 v[96:99], v[32:35], a[40:43], v[96:99]
v_mfma_f32_16x16x32_bf16 v[100:103], v[36:39], a[40:43], v[100:103]
s_waitcnt lgkmcnt(3)
v_mfma_f32_16x16x32_bf16 v[56:59], a[168:171], v[40:43], v[56:59]
ds_read_b64 v[24:25], v2 offset:16384
ds_read_b64 v[26:27], v2 offset:16896
s_waitcnt lgkmcnt(4)
v_mfma_f32_16x16x32_bf16 v[60:63], a[168:171], v[44:47], v[60:63]
ds_read_b64 v[28:29], v2 offset:36864
ds_read_b64 v[30:31], v2 offset:37376
s_waitcnt lgkmcnt(5)
v_mfma_f32_16x16x32_bf16 v[64:67], a[168:171], v[48:51], v[64:67]
ds_read_b64 v[32:33], v2 offset:57344
ds_read_b64 v[34:35], v2 offset:57856
s_waitcnt lgkmcnt(6)
v_mfma_f32_16x16x32_bf16 v[68:71], a[168:171], v[52:55], v[68:71]
ds_read_b64 v[36:37], v239 offset:16384
ds_read_b64 v[38:39], v239 offset:16896
v_mfma_f32_16x16x32_bf16 v[72:75], v[40:43], a[172:175], v[72:75]
v_mfma_f32_16x16x32_bf16 v[76:79], v[44:47], a[172:175], v[76:79]
buffer_load_dwordx4 a[140:143], v1, s[4:7], s42 offen offset:1024
v_mfma_f32_16x16x32_bf16 v[80:83], v[48:51], a[172:175], v[80:83]
buffer_load_dwordx4 a[252:255], v1, s[4:7], s42 offen offset:2048
v_mfma_f32_16x16x32_bf16 v[84:87], v[52:55], a[172:175], v[84:87]
buffer_load_dwordx4 a[76:79], v1, s[4:7], s42 offen offset:3072
v_mfma_f32_16x16x32_bf16 v[88:91], v[40:43], a[44:47], v[88:91]
v_mfma_f32_16x16x32_bf16 v[92:95], v[44:47], a[44:47], v[92:95]
v_mfma_f32_16x16x32_bf16 v[96:99], v[48:51], a[44:47], v[96:99]
v_mfma_f32_16x16x32_bf16 v[100:103], v[52:55], a[44:47], v[100:103]
s_waitcnt lgkmcnt(6)
v_mfma_f32_16x16x32_bf16 v[56:59], a[200:203], v[24:27], v[56:59]
ds_read_b64 v[40:41], v2 offset:17408
ds_read_b64 v[42:43], v2 offset:17920
s_waitcnt lgkmcnt(6)
v_mfma_f32_16x16x32_bf16 v[60:63], a[200:203], v[28:31], v[60:63]
ds_read_b64 v[44:45], v2 offset:37888
ds_read_b64 v[46:47], v2 offset:38400
s_waitcnt lgkmcnt(6)
v_mfma_f32_16x16x32_bf16 v[64:67], a[200:203], v[32:35], v[64:67]
ds_read_b64 v[48:49], v2 offset:58368
ds_read_b64 v[50:51], v2 offset:58880
s_waitcnt lgkmcnt(6)
v_mfma_f32_16x16x32_bf16 v[68:71], a[200:203], v[36:39], v[68:71]
ds_read_b64 v[52:53], v239 offset:17408
ds_read_b64 v[54:55], v239 offset:17920
v_mfma_f32_16x16x32_bf16 v[72:75], v[24:27], a[120:123], v[72:75]
v_mfma_f32_16x16x32_bf16 v[76:79], v[28:31], a[120:123], v[76:79]
v_mfma_f32_16x16x32_bf16 v[80:83], v[32:35], a[120:123], v[80:83]
v_mfma_f32_16x16x32_bf16 v[84:87], v[36:39], a[120:123], v[84:87]
v_mfma_f32_16x16x32_bf16 v[88:91], v[24:27], a[124:127], v[88:91]
v_mfma_f32_16x16x32_bf16 v[92:95], v[28:31], a[124:127], v[92:95]
v_mfma_f32_16x16x32_bf16 v[96:99], v[32:35], a[124:127], v[96:99]
v_mfma_f32_16x16x32_bf16 v[100:103], v[36:39], a[124:127], v[100:103]
s_waitcnt lgkmcnt(6)
v_mfma_f32_16x16x32_bf16 v[56:59], a[196:199], v[40:43], v[56:59]
ds_read_b64 v[24:25], v2 offset:18432
ds_read_b64 v[26:27], v2 offset:18944
s_waitcnt lgkmcnt(6)
v_mfma_f32_16x16x32_bf16 v[60:63], a[196:199], v[44:47], v[60:63]
ds_read_b64 v[28:29], v2 offset:38912
ds_read_b64 v[30:31], v2 offset:39424
s_waitcnt lgkmcnt(6)
v_mfma_f32_16x16x32_bf16 v[64:67], a[196:199], v[48:51], v[64:67]
ds_read_b64 v[32:33], v2 offset:59392
ds_read_b64 v[34:35], v2 offset:59904
s_waitcnt lgkmcnt(6)
v_mfma_f32_16x16x32_bf16 v[68:71], a[196:199], v[52:55], v[68:71]
ds_read_b64 v[36:37], v239 offset:18432
ds_read_b64 v[38:39], v239 offset:18944
v_mfma_f32_16x16x32_bf16 v[72:75], v[40:43], a[28:31], v[72:75]
v_mfma_f32_16x16x32_bf16 v[76:79], v[44:47], a[28:31], v[76:79]
v_mfma_f32_16x16x32_bf16 v[80:83], v[48:51], a[28:31], v[80:83]
v_mfma_f32_16x16x32_bf16 v[84:87], v[52:55], a[28:31], v[84:87]
v_mfma_f32_16x16x32_bf16 v[88:91], v[40:43], a[32:35], v[88:91]
v_mfma_f32_16x16x32_bf16 v[92:95], v[44:47], a[32:35], v[92:95]
v_mfma_f32_16x16x32_bf16 v[96:99], v[48:51], a[32:35], v[96:99]
v_mfma_f32_16x16x32_bf16 v[100:103], v[52:55], a[32:35], v[100:103]
s_waitcnt lgkmcnt(6)
v_mfma_f32_16x16x32_bf16 v[56:59], a[36:39], v[24:27], v[56:59]
ds_read_b64 v[40:41], v2 offset:19456
ds_read_b64 v[42:43], v2 offset:19968
s_waitcnt lgkmcnt(6)
v_mfma_f32_16x16x32_bf16 v[60:63], a[36:39], v[28:31], v[60:63]
ds_read_b64 v[44:45], v2 offset:39936
ds_read_b64 v[46:47], v2 offset:40448
s_waitcnt lgkmcnt(6)
v_mfma_f32_16x16x32_bf16 v[64:67], a[36:39], v[32:35], v[64:67]
ds_read_b64 v[48:49], v2 offset:60416
ds_read_b64 v[50:51], v2 offset:60928
s_waitcnt lgkmcnt(6)
v_mfma_f32_16x16x32_bf16 v[68:71], a[36:39], v[36:39], v[68:71]
ds_read_b64 v[52:53], v239 offset:19456
ds_read_b64 v[54:55], v239 offset:19968
v_mfma_f32_16x16x32_bf16 v[72:75], v[24:27], a[60:63], v[72:75]
v_mfma_f32_16x16x32_bf16 v[76:79], v[28:31], a[60:63], v[76:79]
v_mfma_f32_16x16x32_bf16 v[80:83], v[32:35], a[60:63], v[80:83]
v_mfma_f32_16x16x32_bf16 v[84:87], v[36:39], a[60:63], v[84:87]
v_mfma_f32_16x16x32_bf16 v[88:91], v[24:27], a[64:67], v[88:91]
v_mfma_f32_16x16x32_bf16 v[92:95], v[28:31], a[64:67], v[92:95]
v_mfma_f32_16x16x32_bf16 v[96:99], v[32:35], a[64:67], v[96:99]
v_mfma_f32_16x16x32_bf16 v[100:103], v[36:39], a[64:67], v[100:103]
s_waitcnt lgkmcnt(6)
v_mfma_f32_16x16x32_bf16 v[56:59], a[132:135], v[40:43], v[56:59]
s_waitcnt lgkmcnt(4)
v_mfma_f32_16x16x32_bf16 v[60:63], a[132:135], v[44:47], v[60:63]
s_waitcnt lgkmcnt(2)
v_mfma_f32_16x16x32_bf16 v[64:67], a[132:135], v[48:51], v[64:67]
s_waitcnt lgkmcnt(0)
v_mfma_f32_16x16x32_bf16 v[68:71], a[132:135], v[52:55], v[68:71]
v_mfma_f32_16x16x32_bf16 v[72:75], v[40:43], a[204:207], v[72:75]
v_mfma_f32_16x16x32_bf16 v[76:79], v[44:47], a[204:207], v[76:79]
v_mfma_f32_16x16x32_bf16 v[80:83], v[48:51], a[204:207], v[80:83]
v_mfma_f32_16x16x32_bf16 v[84:87], v[52:55], a[204:207], v[84:87]
s_waitcnt vmcnt(20)
v_mfma_f32_16x16x32_bf16 v[88:91], v[40:43], a[208:211], v[88:91]
v_mfma_f32_16x16x32_bf16 v[92:95], v[44:47], a[208:211], v[92:95]
v_mfma_f32_16x16x32_bf16 v[96:99], v[48:51], a[208:211], v[96:99]
v_mfma_f32_16x16x32_bf16 v[100:103], v[52:55], a[208:211], v[100:103]
v_lshlrev_b32 v3, 2, v241
v_add_u32 v3, 102400, v3
ds_read_b32 v136, v3 offset:0
ds_read_b32 v140, v3 offset:256
ds_read_b32 v137, v3 offset:64
ds_read_b32 v141, v3 offset:320
ds_read_b32 v138, v3 offset:128
ds_read_b32 v142, v3 offset:384
ds_read_b32 v139, v3 offset:192
ds_read_b32 v143, v3 offset:448
v_lshlrev_b32 v3, 4, v240
v_add_u32 v3, 102400, v3
ds_read_b128 v[144:147], v3 offset:0
ds_read_b128 v[160:163], v3 offset:256
ds_read_b128 v[148:151], v3 offset:64
ds_read_b128 v[164:167], v3 offset:320
ds_read_b128 v[152:155], v3 offset:128
ds_read_b128 v[168:171], v3 offset:384
ds_read_b128 v[156:159], v3 offset:192
ds_read_b128 v[172:175], v3 offset:448
s_waitcnt lgkmcnt(0)
s_lshl_b32 s24, s60, 14
s_add_u32 s24, s24, 17686528
s_lshl_b32 s25, s22, 12
s_add_u32 s25, s25, s24
s_mul_i32 s26, s60, 10240
s_add_u32 s26, s26, 24502272
s_lshl_b32 s27, s22, 11
s_add_u32 s27, s27, s26
s_add_u32 s26, s26, 8192
v_pk_fma_f32 v[72:73], v[144:145], v[188:189], v[72:73] op_sel:[0,0,0] op_sel_hi:[1,0,1]
v_pk_fma_f32 v[74:75], v[146:147], v[188:189], v[74:75] op_sel:[0,0,0] op_sel_hi:[1,0,1]
v_pk_mul_f32 v[72:73], v[72:73], v[160:161]
v_pk_mul_f32 v[74:75], v[74:75], v[162:163]
v_cvt_pk_bf16_f32 v48, v72, v73
v_cvt_pk_bf16_f32 v49, v74, v75
v_pk_fma_f32 v[76:77], v[148:149], v[188:189], v[76:77] op_sel:[0,0,0] op_sel_hi:[1,0,1]
v_pk_fma_f32 v[78:79], v[150:151], v[188:189], v[78:79] op_sel:[0,0,0] op_sel_hi:[1,0,1]
v_pk_mul_f32 v[76:77], v[76:77], v[164:165]
v_pk_mul_f32 v[78:79], v[78:79], v[166:167]
v_cvt_pk_bf16_f32 v50, v76, v77
v_cvt_pk_bf16_f32 v51, v78, v79
buffer_store_dwordx4 v[48:51], v1, s[4:7], s27 offen offset:0 sc1
v_pk_fma_f32 v[80:81], v[152:153], v[188:189], v[80:81] op_sel:[0,0,0] op_sel_hi:[1,0,1]
v_pk_fma_f32 v[82:83], v[154:155], v[188:189], v[82:83] op_sel:[0,0,0] op_sel_hi:[1,0,1]
v_pk_mul_f32 v[80:81], v[80:81], v[168:169]
v_pk_mul_f32 v[82:83], v[82:83], v[170:171]
v_cvt_pk_bf16_f32 v52, v80, v81
v_cvt_pk_bf16_f32 v53, v82, v83
v_pk_fma_f32 v[84:85], v[156:157], v[188:189], v[84:85] op_sel:[0,0,0] op_sel_hi:[1,0,1]
v_pk_fma_f32 v[86:87], v[158:159], v[188:189], v[86:87] op_sel:[0,0,0] op_sel_hi:[1,0,1]
v_pk_mul_f32 v[84:85], v[84:85], v[172:173]
v_pk_mul_f32 v[86:87], v[86:87], v[174:175]
v_cvt_pk_bf16_f32 v54, v84, v85
v_cvt_pk_bf16_f32 v55, v86, v87
buffer_store_dwordx4 v[52:55], v1, s[4:7], s27 offen offset:1024 sc1
v_pk_fma_f32 v[88:89], v[144:145], v[184:185], v[88:89] op_sel:[0,0,0] op_sel_hi:[1,0,1]
v_pk_fma_f32 v[90:91], v[146:147], v[184:185], v[90:91] op_sel:[0,0,0] op_sel_hi:[1,0,1]
v_pk_mul_f32 v[88:89], v[88:89], v[160:161]
v_pk_mul_f32 v[90:91], v[90:91], v[162:163]
v_cvt_pk_bf16_f32 v40, v88, v89
v_cvt_pk_bf16_f32 v41, v90, v91
v_pk_fma_f32 v[92:93], v[148:149], v[184:185], v[92:93] op_sel:[0,0,0] op_sel_hi:[1,0,1]
v_pk_fma_f32 v[94:95], v[150:151], v[184:185], v[94:95] op_sel:[0,0,0] op_sel_hi:[1,0,1]
v_pk_mul_f32 v[92:93], v[92:93], v[164:165]
v_pk_mul_f32 v[94:95], v[94:95], v[166:167]
v_cvt_pk_bf16_f32 v42, v92, v93
v_cvt_pk_bf16_f32 v43, v94, v95
buffer_store_dwordx4 v[40:43], v1, s[4:7], s26 offen offset:0 sc1
v_pk_fma_f32 v[96:97], v[152:153], v[184:185], v[96:97] op_sel:[0,0,0] op_sel_hi:[1,0,1]
v_pk_fma_f32 v[98:99], v[154:155], v[184:185], v[98:99] op_sel:[0,0,0] op_sel_hi:[1,0,1]
v_pk_mul_f32 v[96:97], v[96:97], v[168:169]
v_pk_mul_f32 v[98:99], v[98:99], v[170:171]
v_cvt_pk_bf16_f32 v44, v96, v97
v_cvt_pk_bf16_f32 v45, v98, v99
v_pk_fma_f32 v[100:101], v[156:157], v[184:185], v[100:101] op_sel:[0,0,0] op_sel_hi:[1,0,1]
v_pk_fma_f32 v[102:103], v[158:159], v[184:185], v[102:103] op_sel:[0,0,0] op_sel_hi:[1,0,1]
v_pk_mul_f32 v[100:101], v[100:101], v[172:173]
v_pk_mul_f32 v[102:103], v[102:103], v[174:175]
v_cvt_pk_bf16_f32 v46, v100, v101
v_cvt_pk_bf16_f32 v47, v102, v103
buffer_store_dwordx4 v[44:47], v1, s[4:7], s26 offen offset:1024 sc1
v_pk_fma_f32 v[56:57], v[176:177], v[136:137], v[56:57] op_sel:[0,0,0] op_sel_hi:[1,0,1]
v_pk_fma_f32 v[58:59], v[178:179], v[136:137], v[58:59] op_sel:[0,0,0] op_sel_hi:[1,0,1]
v_pk_mul_f32 v[56:57], v[56:57], v[140:141] op_sel:[0,0] op_sel_hi:[1,0]
v_pk_mul_f32 v[58:59], v[58:59], v[140:141] op_sel:[0,0] op_sel_hi:[1,0]
v_cvt_pk_bf16_f32 v24, v56, v57
v_cvt_pk_bf16_f32 v25, v58, v59
v_pk_fma_f32 v[60:61], v[176:177], v[136:137], v[60:61] op_sel:[0,1,0] op_sel_hi:[1,1,1]
v_pk_fma_f32 v[62:63], v[178:179], v[136:137], v[62:63] op_sel:[0,1,0] op_sel_hi:[1,1,1]
v_pk_mul_f32 v[60:61], v[60:61], v[140:141] op_sel:[0,1] op_sel_hi:[1,1]
v_pk_mul_f32 v[62:63], v[62:63], v[140:141] op_sel:[0,1] op_sel_hi:[1,1]
v_cvt_pk_bf16_f32 v28, v60, v61
v_cvt_pk_bf16_f32 v29, v62, v63
v_pk_fma_f32 v[64:65], v[176:177], v[138:139], v[64:65] op_sel:[0,0,0] op_sel_hi:[1,0,1]
v_pk_fma_f32 v[66:67], v[178:179], v[138:139], v[66:67] op_sel:[0,0,0] op_sel_hi:[1,0,1]
v_pk_mul_f32 v[64:65], v[64:65], v[142:143] op_sel:[0,0] op_sel_hi:[1,0]
v_pk_mul_f32 v[66:67], v[66:67], v[142:143] op_sel:[0,0] op_sel_hi:[1,0]
v_cvt_pk_bf16_f32 v32, v64, v65
v_cvt_pk_bf16_f32 v33, v66, v67
v_pk_fma_f32 v[68:69], v[176:177], v[138:139], v[68:69] op_sel:[0,1,0] op_sel_hi:[1,1,1]
v_pk_fma_f32 v[70:71], v[178:179], v[138:139], v[70:71] op_sel:[0,1,0] op_sel_hi:[1,1,1]
v_pk_mul_f32 v[68:69], v[68:69], v[142:143] op_sel:[0,1] op_sel_hi:[1,1]
v_pk_mul_f32 v[70:71], v[70:71], v[142:143] op_sel:[0,1] op_sel_hi:[1,1]
v_cvt_pk_bf16_f32 v36, v68, v69
v_cvt_pk_bf16_f32 v37, v70, v71
s_waitcnt lgkmcnt(0)
s_barrier
ds_read_b64 v[26:27], v239 offset:44032
ds_read_b64 v[30:31], v239 offset:44544
ds_read_b64 v[34:35], v239 offset:45056
ds_read_b64 v[38:39], v239 offset:45568
ds_read_b64 v[202:203], v239 offset:41984
ds_read_b64 v[206:207], v239 offset:42496
ds_read_b64 v[210:211], v239 offset:43008
ds_read_b64 v[214:215], v239 offset:43520
s_waitcnt lgkmcnt(7)
buffer_store_dwordx4 v[24:27], v1, s[4:7], s25 offen offset:0 sc1
s_waitcnt lgkmcnt(6)
buffer_store_dwordx4 v[28:31], v1, s[4:7], s25 offen offset:1024 sc1
s_waitcnt lgkmcnt(5)
buffer_store_dwordx4 v[32:35], v1, s[4:7], s25 offen offset:2048 sc1
s_waitcnt lgkmcnt(4)
buffer_store_dwordx4 v[36:39], v1, s[4:7], s25 offen offset:3072 sc1
s_waitcnt lgkmcnt(0)
v_cmp_eq_u32 vcc, s22, v240
s_nop 1
v_cndmask_b32 v202, 0, v202, vcc
v_cndmask_b32 v203, 0, v203, vcc
v_cndmask_b32 v206, 0, v206, vcc
v_cndmask_b32 v207, 0, v207, vcc
v_cndmask_b32 v210, 0, v210, vcc
v_cndmask_b32 v211, 0, v211, vcc
v_cndmask_b32 v214, 0, v214, vcc
v_cndmask_b32 v215, 0, v215, vcc
s_waitcnt vmcnt(0)
v_mov_b32 v3, 6
s_mov_b64 exec, 1
buffer_store_dword v3, off, s[4:7], s23 sc1
s_mov_b64 exec, -1
ds_read_b128 v[24:27], v1 offset:0
ds_read_b128 v[28:31], v1 offset:20480
ds_read_b128 v[32:35], v1 offset:40960
ds_read_b128 v[36:39], v238 offset:0
s_waitcnt lgkmcnt(3)
v_mfma_f32_16x16x32_bf16 v[104:107], a[128:131], v[24:27], 0
ds_read_b128 v[40:43], v1 offset:1024
ds_read_b128 v[44:47], v1 offset:21504
s_waitcnt lgkmcnt(4)
v_mfma_f32_16x16x32_bf16 v[108:111], a[128:131], v[28:31], 0
ds_read_b128 v[48:51], v1 offset:41984
ds_read_b128 v[52:55], v238 offset:1024
s_waitcnt lgkmcnt(5)
v_mfma_f32_16x16x32_bf16 v[112:115], a[128:131], v[32:35], 0
s_waitcnt lgkmcnt(4)
v_mfma_f32_16x16x32_bf16 v[116:119], a[128:131], v[36:39], 0
s_waitcnt lgkmcnt(3)
v_mfma_f32_16x16x32_bf16 v[104:107], a[48:51], v[40:43], v[104:107]
ds_read_b128 v[24:27], v1 offset:2048
ds_read_b128 v[28:31], v1 offset:22528
s_waitcnt lgkmcnt(4)
v_mfma_f32_16x16x32_bf16 v[108:111], a[48:51], v[44:47], v[108:111]
ds_read_b128 v[32:35], v1 offset:43008
ds_read_b128 v[36:39], v238 offset:2048
s_waitcnt lgkmcnt(5)
v_mfma_f32_16x16x32_bf16 v[112:115], a[48:51], v[48:51], v[112:115]
s_waitcnt lgkmcnt(4)
v_mfma_f32_16x16x32_bf16 v[116:119], a[48:51], v[52:55], v[116:119]
s_waitcnt lgkmcnt(3)
v_mfma_f32_16x16x32_bf16 v[104:107], a[52:55], v[24:27], v[104:107]
ds_read_b128 v[40:43], v1 offset:3072
ds_read_b128 v[44:47], v1 offset:23552
s_waitcnt lgkmcnt(4)
v_mfma_f32_16x16x32_bf16 v[108:111], a[52:55], v[28:31], v[108:111]
ds_read_b128 v[48:51], v1 offset:44032
ds_read_b128 v[52:55], v238 offset:3072
s_waitcnt lgkmcnt(5)
v_mfma_f32_16x16x32_bf16 v[112:115], a[52:55], v[32:35], v[112:115]
s_waitcnt lgkmcnt(4)
v_mfma_f32_16x16x32_bf16 v[116:119], a[52:55], v[36:39], v[116:119]
s_waitcnt lgkmcnt(3)
v_mfma_f32_16x16x32_bf16 v[104:107], a[56:59], v[40:43], v[104:107]
ds_read_b128 v[24:27], v1 offset:4096
ds_read_b128 v[28:31], v1 offset:24576
s_waitcnt lgkmcnt(4)
v_mfma_f32_16x16x32_bf16 v[108:111], a[56:59], v[44:47], v[108:111]
ds_read_b128 v[32:35], v1 offset:45056
ds_read_b128 v[36:39], v238 offset:4096
s_waitcnt lgkmcnt(5)
v_mfma_f32_16x16x32_bf16 v[112:115], a[56:59], v[48:51], v[112:115]
s_waitcnt lgkmcnt(4)
v_mfma_f32_16x16x32_bf16 v[116:119], a[56:59], v[52:55], v[116:119]
s_waitcnt lgkmcnt(3)
v_mfma_f32_16x16x32_bf16 v[104:107], a[212:215], v[24:27], v[104:107]
ds_read_b128 v[40:43], v1 offset:5120
ds_read_b128 v[44:47], v1 offset:25600
s_waitcnt lgkmcnt(4)
v_mfma_f32_16x16x32_bf16 v[108:111], a[212:215], v[28:31], v[108:111]
ds_read_b128 v[48:51], v1 offset:46080
ds_read_b128 v[52:55], v238 offset:5120
s_waitcnt lgkmcnt(5)
v_mfma_f32_16x16x32_bf16 v[112:115], a[212:215], v[32:35], v[112:115]
s_waitcnt lgkmcnt(4)
v_mfma_f32_16x16x32_bf16 v[116:119], a[212:215], v[36:39], v[116:119]
s_waitcnt lgkmcnt(3)
v_mfma_f32_16x16x32_bf16 v[104:107], a[104:107], v[40:43], v[104:107]
ds_read_b128 v[24:27], v1 offset:6144
ds_read_b128 v[28:31], v1 offset:26624
s_waitcnt lgkmcnt(4)
v_mfma_f32_16x16x32_bf16 v[108:111], a[104:107], v[44:47], v[108:111]
ds_read_b128 v[32:35], v1 offset:47104
ds_read_b128 v[36:39], v238 offset:6144
s_waitcnt lgkmcnt(5)
v_mfma_f32_16x16x32_bf16 v[112:115], a[104:107], v[48:51], v[112:115]
s_waitcnt lgkmcnt(4)
v_mfma_f32_16x16x32_bf16 v[116:119], a[104:107], v[52:55], v[116:119]
s_waitcnt lgkmcnt(3)
v_mfma_f32_16x16x32_bf16 v[104:107], a[176:179], v[24:27], v[104:107]
ds_read_b128 v[40:43], v1 offset:7168
ds_read_b128 v[44:47], v1 offset:27648
s_waitcnt lgkmcnt(4)
v_mfma_f32_16x16x32_bf16 v[108:111], a[176:179], v[28:31], v[108:111]
ds_read_b128 v[48:51], v1 offset:48128
ds_read_b128 v[52:55], v238 offset:7168
s_waitcnt lgkmcnt(5)
v_mfma_f32_16x16x32_bf16 v[112:115], a[176:179], v[32:35], v[112:115]
s_waitcnt lgkmcnt(4)
v_mfma_f32_16x16x32_bf16 v[116:119], a[176:179], v[36:39], v[116:119]
s_waitcnt lgkmcnt(3)
v_mfma_f32_16x16x32_bf16 v[104:107], a[108:111], v[40:43], v[104:107]
ds_read_b128 v[24:27], v1 offset:8192
ds_read_b128 v[28:31], v1 offset:28672
s_waitcnt lgkmcnt(4)
v_mfma_f32_16x16x32_bf16 v[108:111], a[108:111], v[44:47], v[108:111]
ds_read_b128 v[32:35], v1 offset:49152
ds_read_b128 v[36:39], v238 offset:8192
s_waitcnt lgkmcnt(5)
v_mfma_f32_16x16x32_bf16 v[112:115], a[108:111], v[48:51], v[112:115]
s_waitcnt lgkmcnt(4)
v_mfma_f32_16x16x32_bf16 v[116:119], a[108:111], v[52:55], v[116:119]
s_waitcnt lgkmcnt(3)
v_mfma_f32_16x16x32_bf16 v[104:107], a[112:115], v[24:27], v[104:107]
ds_read_b128 v[40:43], v1 offset:9216
ds_read_b128 v[44:47], v1 offset:29696
s_waitcnt lgkmcnt(4)
v_mfma_f32_16x16x32_bf16 v[108:111], a[112:115], v[28:31], v[108:111]
ds_read_b128 v[48:51], v1 offset:50176
ds_read_b128 v[52:55], v238 offset:9216
s_waitcnt lgkmcnt(5)
v_mfma_f32_16x16x32_bf16 v[112:115], a[112:115], v[32:35], v[112:115]
s_waitcnt lgkmcnt(4)
v_mfma_f32_16x16x32_bf16 v[116:119], a[112:115], v[36:39], v[116:119]
s_waitcnt lgkmcnt(3)
v_mfma_f32_16x16x32_bf16 v[104:107], a[164:167], v[40:43], v[104:107]
ds_read_b128 v[24:27], v1 offset:10240
ds_read_b128 v[28:31], v1 offset:30720
s_waitcnt lgkmcnt(4)
v_mfma_f32_16x16x32_bf16 v[108:111], a[164:167], v[44:47], v[108:111]
ds_read_b128 v[32:35], v1 offset:51200
ds_read_b128 v[36:39], v238 offset:10240
s_waitcnt lgkmcnt(5)
v_mfma_f32_16x16x32_bf16 v[112:115], a[164:167], v[48:51], v[112:115]
s_waitcnt lgkmcnt(4)
v_mfma_f32_16x16x32_bf16 v[116:119], a[164:167], v[52:55], v[116:119]
s_waitcnt lgkmcnt(3)
v_mfma_f32_16x16x32_bf16 v[104:107], a[68:71], v[24:27], v[104:107]
ds_read_b128 v[40:43], v1 offset:11264
ds_read_b128 v[44:47], v1 offset:31744
s_waitcnt lgkmcnt(4)
v_mfma_f32_16x16x32_bf16 v[108:111], a[68:71], v[28:31], v[108:111]
ds_read_b128 v[48:51], v1 offset:52224
ds_read_b128 v[52:55], v238 offset:11264
s_waitcnt lgkmcnt(5)
v_mfma_f32_16x16x32_bf16 v[112:115], a[68:71], v[32:35], v[112:115]
s_waitcnt lgkmcnt(4)
v_mfma_f32_16x16x32_bf16 v[116:119], a[68:71], v[36:39], v[116:119]
s_waitcnt lgkmcnt(3)
v_mfma_f32_16x16x32_bf16 v[104:107], a[72:75], v[40:43], v[104:107]
ds_read_b128 v[24:27], v1 offset:12288
ds_read_b128 v[28:31], v1 offset:32768
s_waitcnt lgkmcnt(4)
v_mfma_f32_16x16x32_bf16 v[108:111], a[72:75], v[44:47], v[108:111]
ds_read_b128 v[32:35], v1 offset:53248
ds_read_b128 v[36:39], v238 offset:12288
s_waitcnt lgkmcnt(5)
v_mfma_f32_16x16x32_bf16 v[112:115], a[72:75], v[48:51], v[112:115]
s_waitcnt lgkmcnt(4)
v_mfma_f32_16x16x32_bf16 v[116:119], a[72:75], v[52:55], v[116:119]
s_waitcnt lgkmcnt(3)
v_mfma_f32_16x16x32_bf16 v[104:107], a[244:247], v[24:27], v[104:107]
ds_read_b128 v[40:43], v1 offset:13312
ds_read_b128 v[44:47], v1 offset:33792
s_waitcnt lgkmcnt(4)
v_mfma_f32_16x16x32_bf16 v[108:111], a[244:247], v[28:31], v[108:111]
ds_read_b128 v[48:51], v1 offset:54272
ds_read_b128 v[52:55], v238 offset:13312
s_waitcnt lgkmcnt(5)
v_mfma_f32_16x16x32_bf16 v[112:115], a[244:247], v[32:35], v[112:115]
s_waitcnt lgkmcnt(4)
v_mfma_f32_16x16x32_bf16 v[116:119], a[244:247], v[36:39], v[116:119]
s_waitcnt lgkmcnt(3)
v_mfma_f32_16x16x32_bf16 v[104:107], a[216:219], v[40:43], v[104:107]
ds_read_b128 v[24:27], v1 offset:14336
ds_read_b128 v[28:31], v1 offset:34816
s_waitcnt lgkmcnt(4)
v_mfma_f32_16x16x32_bf16 v[108:111], a[216:219], v[44:47], v[108:111]
ds_read_b128 v[32:35], v1 offset:55296
ds_read_b128 v[36:39], v238 offset:14336
s_waitcnt lgkmcnt(5)
v_mfma_f32_16x16x32_bf16 v[112:115], a[216:219], v[48:51], v[112:115]
s_waitcnt lgkmcnt(4)
v_mfma_f32_16x16x32_bf16 v[116:119], a[216:219], v[52:55], v[116:119]
s_waitcnt lgkmcnt(3)
v_mfma_f32_16x16x32_bf16 v[104:107], a[220:223], v[24:27], v[104:107]
ds_read_b128 v[40:43], v1 offset:15360
ds_read_b128 v[44:47], v1 offset:35840
s_waitcnt lgkmcnt(4)
v_mfma_f32_16x16x32_bf16 v[108:111], a[220:223], v[28:31], v[108:111]
ds_read_b128 v[48:51], v1 offset:56320
ds_read_b128 v[52:55], v238 offset:15360
s_waitcnt lgkmcnt(5)
v_mfma_f32_16x16x32_bf16 v[112:115], a[220:223], v[32:35], v[112:115]
s_waitcnt lgkmcnt(4)
v_mfma_f32_16x16x32_bf16 v[116:119], a[220:223], v[36:39], v[116:119]
s_waitcnt lgkmcnt(3)
v_mfma_f32_16x16x32_bf16 v[104:107], a[248:251], v[40:43], v[104:107]
ds_read_b64 v[24:25], v2 offset:16384
ds_read_b64 v[26:27], v2 offset:16896
ds_read_b64 v[28:29], v2 offset:36864
ds_read_b64 v[30:31], v2 offset:37376
s_waitcnt lgkmcnt(6)
v_mfma_f32_16x16x32_bf16 v[108:111], a[248:251], v[44:47], v[108:111]
ds_read_b64 v[32:33], v2 offset:57344
ds_read_b64 v[34:35], v2 offset:57856
ds_read_b64 v[36:37], v239 offset:16384
ds_read_b64 v[38:39], v239 offset:16896
s_waitcnt lgkmcnt(9)
v_mfma_f32_16x16x32_bf16 v[112:115], a[248:251], v[48:51], v[112:115]
s_waitcnt lgkmcnt(8)
v_mfma_f32_16x16x32_bf16 v[116:119], a[248:251], v[52:55], v[116:119]
s_waitcnt lgkmcnt(6)
v_mfma_f32_16x16x32_bf16 v[104:107], a[136:139], v[24:27], v[104:107]
ds_read_b64 v[40:41], v2 offset:17408
ds_read_b64 v[42:43], v2 offset:17920
ds_read_b64 v[44:45], v2 offset:37888
ds_read_b64 v[46:47], v2 offset:38400
s_waitcnt lgkmcnt(8)
v_mfma_f32_16x16x32_bf16 v[108:111], a[136:139], v[28:31], v[108:111]
ds_read_b64 v[48:49], v2 offset:58368
ds_read_b64 v[50:51], v2 offset:58880
ds_read_b64 v[52:53], v239 offset:17408
ds_read_b64 v[54:55], v239 offset:17920
s_waitcnt lgkmcnt(10)
v_mfma_f32_16x16x32_bf16 v[112:115], a[136:139], v[32:35], v[112:115]
s_waitcnt lgkmcnt(8)
v_mfma_f32_16x16x32_bf16 v[116:119], a[136:139], v[36:39], v[116:119]
s_waitcnt lgkmcnt(6)
v_mfma_f32_16x16x32_bf16 v[104:107], a[140:143], v[40:43], v[104:107]
ds_read_b64 v[24:25], v2 offset:18432
ds_read_b64 v[26:27], v2 offset:18944
ds_read_b64 v[28:29], v2 offset:38912
ds_read_b64 v[30:31], v2 offset:39424
s_waitcnt lgkmcnt(8)
v_mfma_f32_16x16x32_bf16 v[108:111], a[140:143], v[44:47], v[108:111]
ds_read_b64 v[32:33], v2 offset:59392
ds_read_b64 v[34:35], v2 offset:59904
ds_read_b64 v[36:37], v239 offset:18432
ds_read_b64 v[38:39], v239 offset:18944
s_waitcnt lgkmcnt(10)
v_mfma_f32_16x16x32_bf16 v[112:115], a[140:143], v[48:51], v[112:115]
s_waitcnt lgkmcnt(8)
v_mfma_f32_16x16x32_bf16 v[116:119], a[140:143], v[52:55], v[116:119]
s_waitcnt lgkmcnt(6)
v_mfma_f32_16x16x32_bf16 v[104:107], a[252:255], v[24:27], v[104:107]
ds_read_b64 v[40:41], v2 offset:19456
ds_read_b64 v[42:43], v2 offset:19968
ds_read_b64 v[44:45], v2 offset:39936
ds_read_b64 v[46:47], v2 offset:40448
s_waitcnt lgkmcnt(8)
v_mfma_f32_16x16x32_bf16 v[108:111], a[252:255], v[28:31], v[108:111]
ds_read_b64 v[48:49], v2 offset:60416
ds_read_b64 v[50:51], v2 offset:60928
ds_read_b64 v[52:53], v239 offset:19456
ds_read_b64 v[54:55], v239 offset:19968
s_waitcnt lgkmcnt(10)
v_mfma_f32_16x16x32_bf16 v[112:115], a[252:255], v[32:35], v[112:115]
s_waitcnt lgkmcnt(8)
v_mfma_f32_16x16x32_bf16 v[116:119], a[252:255], v[36:39], v[116:119]
s_waitcnt lgkmcnt(6)
v_mfma_f32_16x16x32_bf16 v[104:107], a[76:79], v[40:43], v[104:107]
s_waitcnt lgkmcnt(4)
v_mfma_f32_16x16x32_bf16 v[108:111], a[76:79], v[44:47], v[108:111]
s_waitcnt lgkmcnt(2)
v_mfma_f32_16x16x32_bf16 v[112:115], a[76:79], v[48:51], v[112:115]
s_waitcnt lgkmcnt(0)
v_mfma_f32_16x16x32_bf16 v[116:119], a[76:79], v[52:55], v[116:119]
s_mov_b32 s24, 0x3ea52b5c
v_mul_f32 v140, s24, v140
v_mul_f32 v141, s24, v141
v_mul_f32 v142, s24, v142
v_mul_f32 v143, s24, v143
v_pk_fma_f32 v[104:105], v[180:181], v[136:137], v[104:105] op_sel:[0,0,0] op_sel_hi:[1,0,1]
v_pk_fma_f32 v[106:107], v[182:183], v[136:137], v[106:107] op_sel:[0,0,0] op_sel_hi:[1,0,1]
v_pk_mul_f32 v[104:105], v[104:105], v[140:141] op_sel:[0,0] op_sel_hi:[1,0]
v_pk_mul_f32 v[106:107], v[106:107], v[140:141] op_sel:[0,0] op_sel_hi:[1,0]
v_cvt_pk_bf16_f32 v200, v104, v105
v_cvt_pk_bf16_f32 v201, v106, v107
v_pk_fma_f32 v[108:109], v[180:181], v[136:137], v[108:109] op_sel:[0,1,0] op_sel_hi:[1,1,1]
v_pk_fma_f32 v[110:111], v[182:183], v[136:137], v[110:111] op_sel:[0,1,0] op_sel_hi:[1,1,1]
v_pk_mul_f32 v[108:109], v[108:109], v[140:141] op_sel:[0,1] op_sel_hi:[1,1]
v_pk_mul_f32 v[110:111], v[110:111], v[140:141] op_sel:[0,1] op_sel_hi:[1,1]
v_cvt_pk_bf16_f32 v204, v108, v109
v_cvt_pk_bf16_f32 v205, v110, v111
v_pk_fma_f32 v[112:113], v[180:181], v[138:139], v[112:113] op_sel:[0,0,0] op_sel_hi:[1,0,1]
v_pk_fma_f32 v[114:115], v[182:183], v[138:139], v[114:115] op_sel:[0,0,0] op_sel_hi:[1,0,1]
v_pk_mul_f32 v[112:113], v[112:113], v[142:143] op_sel:[0,0] op_sel_hi:[1,0]
v_pk_mul_f32 v[114:115], v[114:115], v[142:143] op_sel:[0,0] op_sel_hi:[1,0]
v_cvt_pk_bf16_f32 v208, v112, v113
v_cvt_pk_bf16_f32 v209, v114, v115
v_pk_fma_f32 v[116:117], v[180:181], v[138:139], v[116:117] op_sel:[0,1,0] op_sel_hi:[1,1,1]
v_pk_fma_f32 v[118:119], v[182:183], v[138:139], v[118:119] op_sel:[0,1,0] op_sel_hi:[1,1,1]
v_pk_mul_f32 v[116:117], v[116:117], v[142:143] op_sel:[0,1] op_sel_hi:[1,1]
v_pk_mul_f32 v[118:119], v[118:119], v[142:143] op_sel:[0,1] op_sel_hi:[1,1]
v_cvt_pk_bf16_f32 v212, v116, v117
v_cvt_pk_bf16_f32 v213, v118, v119
s_nop 7
s_branch FE79
FK82:
s_mul_i32 s24, s21, 960
s_lshl_b32 s25, s22, 6
s_add_u32 s24, s24, s25
s_add_u32 s24, s24, 7700480
v_lshlrev_b32 v3, 4, v240
v_lshlrev_b32 v192, 2, v241
buffer_load_dwordx4 v[176:179], v3, s[4:7], s24 offen
buffer_load_dwordx4 v[180:183], v3, s[4:7], s24 offen offset:512
buffer_load_dword v188, v192, s[4:7], s24 offen offset:256
buffer_load_dwordx4 v[184:187], v3, s[4:7], s24 offen offset:768
s_mov_b32 s24, 30000
PL88:
buffer_load_dword v3, v236, s[4:7], 0 offen sc1
s_waitcnt vmcnt(0)
v_cmp_gt_u32 vcc, 5, v3
s_sub_u32 s24, s24, 1
s_cbranch_scc1 PD89
s_cbranch_vccnz PL88
PD89:
s_lshl_b32 s26, s60, 9
s_and_b32 s26, s26, 0xfffff000
s_lshl_b32 s27, s22, 7
s_add_u32 s26, s26, s27
s_add_u32 s26, s26, 13230080
v_lshrrev_b32 v24, 3, v0
v_lshlrev_b32 v24, 9, v24
v_and_b32 v25, 7, v0
v_lshlrev_b32 v25, 4, v25
v_add_u32 v24, v24, v25
buffer_load_dwordx4 v[28:31], v24, s[4:7], s26 offen
s_mul_i32 s69, s62, 20480
s_add_u32 s69, s69, 10346496
s_mul_i32 s70, s22, 20480
s_mov_b32 m0, s70
s_nop 0
buffer_load_dwordx4 v1, s[4:7], s69 offen offset:0 sc1 lds
s_mov_b32 m0, s70
s_nop 0
buffer_load_dwordx4 v1, s[4:7], s69 offen offset:1024 sc1 lds
s_mov_b32 m0, s70
s_nop 0
buffer_load_dwordx4 v1, s[4:7], s69 offen offset:2048 sc1 lds
s_mov_b32 m0, s70
s_nop 0
buffer_load_dwordx4 v1, s[4:7], s69 offen offset:3072 sc1 lds
s_add_u32 s69, s69, 4096
s_add_u32 s70, s70, 4096
s_mov_b32 m0, s70
s_nop 0
buffer_load_dwordx4 v1, s[4:7], s69 offen offset:0 sc1 lds
s_mov_b32 m0, s70
s_nop 0
buffer_load_dwordx4 v1, s[4:7], s69 offen offset:1024 sc1 lds
s_mov_b32 m0, s70
s_nop 0
buffer_load_dwordx4 v1, s[4:7], s69 offen offset:2048 sc1 lds
s_mov_b32 m0, s70
s_nop 0
buffer_load_dwordx4 v1, s[4:7], s69 offen offset:3072 sc1 lds
s_add_u32 s69, s69, 4096
s_add_u32 s70, s70, 4096
s_mov_b32 m0, s70
s_nop 0
buffer_load_dwordx4 v1, s[4:7], s69 offen offset:0 sc1 lds
s_mov_b32 m0, s70
s_nop 0
buffer_load_dwordx4 v1, s[4:7], s69 offen offset:1024 sc1 lds
s_waitcnt vmcnt(10)
v_mov_b32 v32, v28
v_mov_b32 v33, v29
v_mov_b32 v34, v30
v_mov_b32 v35, v31
v_permlane32_swap_b32 v28, v32
v_permlane32_swap_b32 v29, v33
v_permlane32_swap_b32 v30, v34
v_permlane32_swap_b32 v31, v35
v_add_f32 v28, v28, v32
v_add_f32 v29, v29, v33
v_add_f32 v30, v30, v34
v_add_f32 v31, v31, v35
v_mov_b32 v32, v28
v_mov_b32 v33, v29
v_mov_b32 v34, v30
v_mov_b32 v35, v31
v_permlane16_swap_b32 v28, v32
v_permlane16_swap_b32 v29, v33
v_permlane16_swap_b32 v30, v34
v_permlane16_swap_b32 v31, v35
v_add_f32 v28, v28, v32
v_add_f32 v29, v29, v33
v_add_f32 v30, v30, v34
v_add_f32 v31, v31, v35
v_add_f32_dpp v28, v28, v28 row_ror:8 row_mask:0xf bank_mask:0xf
v_add_f32_dpp v29, v29, v29 row_ror:8 row_mask:0xf bank_mask:0xf
v_add_f32_dpp v30, v30, v30 row_ror:8 row_mask:0xf bank_mask:0xf
v_add_f32_dpp v31, v31, v31 row_ror:8 row_mask:0xf bank_mask:0xf
s_mov_b32 s26, 0xbacccccd
s_mov_b32 s27, 0x3acccccd
v_mul_f32 v32, s26, v28
v_mul_f32 v33, s26, v30
v_mul_f32 v34, s27, v29
v_mul_f32 v35, s27, v31
v_fma_f32 v34, -v32, v32, v34
v_fma_f32 v35, -v33, v33, v35
v_max_f32 v34, 0, v34
v_max_f32 v35, 0, v35
v_add_f32 v34, 0x3727c5ac, v34
v_add_f32 v35, 0x3727c5ac, v35
v_rsq_f32 v34, v34
v_rsq_f32 v35, v35
v_and_b32 v24, 7, v0
v_lshlrev_b32 v24, 3, v24
s_lshl_b32 s26, s22, 6
s_add_u32 s26, s26, 102400
v_add_u32 v24, s26, v24
s_mov_b64 exec, 0xff
ds_write_b64 v24, v[32:33]
ds_write_b64 v24, v[34:35] offset:256
s_mov_b64 exec, -1
s_waitcnt vmcnt(5)
s_waitcnt lgkmcnt(0)
s_barrier
ds_read_b128 v[24:27], v1 offset:0
ds_read_b128 v[28:31], v1 offset:20480
ds_read_b128 v[32:35], v1 offset:40960
ds_read_b128 v[36:39], v238 offset:0
s_waitcnt lgkmcnt(3)
v_mfma_f32_16x16x32_bf16 v[56:59], a[212:215], v[24:27], 0
ds_read_b128 v[40:43], v1 offset:1024
s_waitcnt lgkmcnt(3)
v_mfma_f32_16x16x32_bf16 v[60:63], a[212:215], v[28:31], 0
ds_read_b128 v[44:47], v1 offset:21504
s_waitcnt lgkmcnt(3)
v_mfma_f32_16x16x32_bf16 v[64:67], a[212:215], v[32:35], 0
ds_read_b128 v[48:51], v1 offset:41984
s_waitcnt lgkmcnt(3)
v_mfma_f32_16x16x32_bf16 v[68:71], a[212:215], v[36:39], 0
ds_read_b128 v[52:55], v238 offset:1024
v_mfma_f32_16x16x32_bf16 v[72:75], v[24:27], a[104:107], 0
s_mov_b32 m0, s70
s_nop 0
buffer_load_dwordx4 v1, s[4:7], s69 offen offset:2048 sc1 lds
v_mfma_f32_16x16x32_bf16 v[76:79], v[28:31], a[104:107], 0
buffer_load_dwordx4 a[176:179], v1, s[4:7], s43 offen
v_mfma_f32_16x16x32_bf16 v[80:83], v[32:35], a[104:107], 0
buffer_load_dwordx4 a[164:167], v1, s[4:7], s43 offen offset:1024
v_mfma_f32_16x16x32_bf16 v[84:87], v[36:39], a[104:107], 0
buffer_load_dwordx4 a[244:247], v1, s[4:7], s43 offen offset:2048
s_waitcnt vmcnt(2)
v_mfma_f32_16x16x32_bf16 v[88:91], a[176:179], v[24:27], 0
v_mfma_f32_16x16x32_bf16 v[92:95], a[176:179], v[28:31], 0
v_mfma_f32_16x16x32_bf16 v[96:99], a[176:179], v[32:35], 0
v_mfma_f32_16x16x32_bf16 v[100:103], a[176:179], v[36:39], 0
s_waitcnt lgkmcnt(3)
v_mfma_f32_16x16x32_bf16 v[56:59], a[108:111], v[40:43], v[56:59]
ds_read_b128 v[24:27], v1 offset:2048
s_waitcnt lgkmcnt(3)
v_mfma_f32_16x16x32_bf16 v[60:63], a[108:111], v[44:47], v[60:63]
ds_read_b128 v[28:31], v1 offset:22528
s_waitcnt lgkmcnt(3)
v_mfma_f32_16x16x32_bf16 v[64:67], a[108:111], v[48:51], v[64:67]
ds_read_b128 v[32:35], v1 offset:43008
s_waitcnt lgkmcnt(3)
v_mfma_f32_16x16x32_bf16 v[68:71], a[108:111], v[52:55], v[68:71]
ds_read_b128 v[36:39], v238 offset:2048
v_mfma_f32_16x16x32_bf16 v[72:75], v[40:43], a[112:115], v[72:75]
s_mov_b32 m0, s70
s_nop 0
buffer_load_dwordx4 v1, s[4:7], s69 offen offset:3072 sc1 lds
v_mfma_f32_16x16x32_bf16 v[76:79], v[44:47], a[112:115], v[76:79]
buffer_load_dwordx4 a[248:251], v1, s[4:7], s43 offen offset:3072
v_mfma_f32_16x16x32_bf16 v[80:83], v[48:51], a[112:115], v[80:83]
s_add_u32 s43, s43, 4096
buffer_load_dwordx4 a[252:255], v1, s[4:7], s43 offen
v_mfma_f32_16x16x32_bf16 v[84:87], v[52:55], a[112:115], v[84:87]
buffer_load_dwordx4 a[20:23], v1, s[4:7], s43 offen offset:1024
s_waitcnt vmcnt(5)
v_mfma_f32_16x16x32_bf16 v[88:91], a[164:167], v[40:43], v[88:91]
v_mfma_f32_16x16x32_bf16 v[92:95], a[164:167], v[44:47], v[92:95]
v_mfma_f32_16x16x32_bf16 v[96:99], a[164:167], v[48:51], v[96:99]
v_mfma_f32_16x16x32_bf16 v[100:103], a[164:167], v[52:55], v[100:103]
s_waitcnt lgkmcnt(3)
v_mfma_f32_16x16x32_bf16 v[56:59], a[68:71], v[24:27], v[56:59]
ds_read_b128 v[40:43], v1 offset:3072
s_waitcnt lgkmcnt(3)
v_mfma_f32_16x16x32_bf16 v[60:63], a[68:71], v[28:31], v[60:63]
ds_read_b128 v[44:47], v1 offset:23552
s_waitcnt lgkmcnt(3)
v_mfma_f32_16x16x32_bf16 v[64:67], a[68:71], v[32:35], v[64:67]
ds_read_b128 v[48:51], v1 offset:44032
s_waitcnt lgkmcnt(3)
v_mfma_f32_16x16x32_bf16 v[68:71], a[68:71], v[36:39], v[68:71]
ds_read_b128 v[52:55], v238 offset:3072
v_mfma_f32_16x16x32_bf16 v[72:75], v[24:27], a[72:75], v[72:75]
s_add_u32 s69, s69, 4096
s_add_u32 s70, s70, 4096
s_mov_b32 m0, s70
s_nop 0
buffer_load_dwordx4 v1, s[4:7], s69 offen offset:0 sc1 lds
v_mfma_f32_16x16x32_bf16 v[76:79], v[28:31], a[72:75], v[76:79]
buffer_load_dwordx4 a[24:27], v1, s[4:7], s43 offen offset:2048
v_mfma_f32_16x16x32_bf16 v[80:83], v[32:35], a[72:75], v[80:83]
buffer_load_dwordx4 a[184:187], v1, s[4:7], s43 offen offset:3072
v_mfma_f32_16x16x32_bf16 v[84:87], v[36:39], a[72:75], v[84:87]
s_add_u32 s43, s43, 4096
buffer_load_dwordx4 a[188:191], v1, s[4:7], s43 offen
s_waitcnt vmcnt(8)
v_mfma_f32_16x16x32_bf16 v[88:91], a[244:247], v[24:27], v[88:91]
v_mfma_f32_16x16x32_bf16 v[92:95], a[244:247], v[28:31], v[92:95]
v_mfma_f32_16x16x32_bf16 v[96:99], a[244:247], v[32:35], v[96:99]
v_mfma_f32_16x16x32_bf16 v[100:103], a[244:247], v[36:39], v[100:103]
s_waitcnt lgkmcnt(3)
v_mfma_f32_16x16x32_bf16 v[56:59], a[216:219], v[40:43], v[56:59]
ds_read_b128 v[24:27], v1 offset:4096
s_waitcnt lgkmcnt(3)
v_mfma_f32_16x16x32_bf16 v[60:63], a[216:219], v[44:47], v[60:63]
ds_read_b128 v[28:31], v1 offset:24576
s_waitcnt lgkmcnt(3)
v_mfma_f32_16x16x32_bf16 v[64:67], a[216:219], v[48:51], v[64:67]
ds_read_b128 v[32:35], v1 offset:45056
s_waitcnt lgkmcnt(3)
v_mfma_f32_16x16x32_bf16 v[68:71], a[216:219], v[52:55], v[68:71]
ds_read_b128 v[36:39], v238 offset:4096
v_mfma_f32_16x16x32_bf16 v[72:75], v[40:43], a[220:223], v[72:75]
s_mov_b32 m0, s70
s_nop 0
buffer_load_dwordx4 v1, s[4:7], s69 offen offset:1024 sc1 lds
v_mfma_f32_16x16x32_bf16 v[76:79], v[44:47], a[220:223], v[76:79]
buffer_load_dwordx4 a[192:195], v1, s[4:7], s43 offen offset:1024
v_mfma_f32_16x16x32_bf16 v[80:83], v[48:51], a[220:223], v[80:83]
buffer_load_dwordx4 a[180:183], v1, s[4:7], s43 offen offset:2048
v_mfma_f32_16x16x32_bf16 v[84:87], v[52:55], a[220:223], v[84:87]
buffer_load_dwordx4 a[8:11], v1, s[4:7], s43 offen offset:3072
s_waitcnt vmcnt(10)
v_mfma_f32_16x16x32_bf16 v[88:91], a[248:251], v[40:43], v[88:91]
v_mfma_f32_16x16x32_bf16 v[92:95], a[248:251], v[44:47], v[92:95]
v_mfma_f32_16x16x32_bf16 v[96:99], a[248:251], v[48:51], v[96:99]
v_mfma_f32_16x16x32_bf16 v[100:103], a[248:251], v[52:55], v[100:103]
s_barrier
s_waitcnt lgkmcnt(3)
v_mfma_f32_16x16x32_bf16 v[56:59], a[136:139], v[24:27], v[56:59]
ds_read_b128 v[40:43], v1 offset:5120
s_waitcnt lgkmcnt(3)
v_mfma_f32_16x16x32_bf16 v[60:63], a[136:139], v[28:31], v[60:63]
ds_read_b128 v[44:47], v1 offset:25600
s_waitcnt lgkmcnt(3)
v_mfma_f32_16x16x32_bf16 v[64:67], a[136:139], v[32:35], v[64:67]
ds_read_b128 v[48:51], v1 offset:46080
s_waitcnt lgkmcnt(3)
v_mfma_f32_16x16x32_bf16 v[68:71], a[136:139], v[36:39], v[68:71]
ds_read_b128 v[52:55], v238 offset:5120
v_mfma_f32_16x16x32_bf16 v[72:75], v[24:27], a[140:143], v[72:75]
s_mov_b32 m0, s70
s_nop 0
buffer_load_dwordx4 v1, s[4:7], s69 offen offset:2048 sc1 lds
v_mfma_f32_16x16x32_bf16 v[76:79], v[28:31], a[140:143], v[76:79]
s_add_u32 s43, s43, 4096
buffer_load_dwordx4 a[12:15], v1, s[4:7], s43 offen
v_mfma_f32_16x16x32_bf16 v[80:83], v[32:35], a[140:143], v[80:83]
buffer_load_dwordx4 a[16:19], v1, s[4:7], s43 offen offset:1024
v_mfma_f32_16x16x32_bf16 v[84:87], v[36:39], a[140:143], v[84:87]
buffer_load_dwordx4 a[40:43], v1, s[4:7], s43 offen offset:2048
s_waitcnt vmcnt(13)
v_mfma_f32_16x16x32_bf16 v[88:91], a[252:255], v[24:27], v[88:91]
v_mfma_f32_16x16x32_bf16 v[92:95], a[252:255], v[28:31], v[92:95]
v_mfma_f32_16x16x32_bf16 v[96:99], a[252:255], v[32:35], v[96:99]
v_mfma_f32_16x16x32_bf16 v[100:103], a[252:255], v[36:39], v[100:103]
s_waitcnt lgkmcnt(3)
v_mfma_f32_16x16x32_bf16 v[56:59], a[76:79], v[40:43], v[56:59]
ds_read_b128 v[24:27], v1 offset:6144
s_waitcnt lgkmcnt(3)
v_mfma_f32_16x16x32_bf16 v[60:63], a[76:79], v[44:47], v[60:63]
ds_read_b128 v[28:31], v1 offset:26624
s_waitcnt lgkmcnt(3)
v_mfma_f32_16x16x32_bf16 v[64:67], a[76:79], v[48:51], v[64:67]
ds_read_b128 v[32:35], v1 offset:47104
s_waitcnt lgkmcnt(3)
v_mfma_f32_16x16x32_bf16 v[68:71], a[76:79], v[52:55], v[68:71]
ds_read_b128 v[36:39], v238 offset:6144
v_mfma_f32_16x16x32_bf16 v[72:75], v[40:43], a[80:83], v[72:75]
s_mov_b32 m0, s70
s_nop 0
buffer_load_dwordx4 v1, s[4:7], s69 offen offset:3072 sc1 lds
v_mfma_f32_16x16x32_bf16 v[76:79], v[44:47], a[80:83], v[76:79]
buffer_load_dwordx4 a[44:47], v1, s[4:7], s43 offen offset:3072
v_mfma_f32_16x16x32_bf16 v[80:83], v[48:51], a[80:83], v[80:83]
s_add_u32 s40, s40, 4096
buffer_load_dwordx4 a[200:203], v1, s[4:7], s40 offen
v_mfma_f32_16x16x32_bf16 v[84:87], v[52:55], a[80:83], v[84:87]
s_add_u32 s41, s41, 4096
buffer_load_dwordx4 a[120:123], v1, s[4:7], s41 offen
s_waitcnt vmcnt(16)
v_mfma_f32_16x16x32_bf16 v[88:91], a[20:23], v[40:43], v[88:91]
v_mfma_f32_16x16x32_bf16 v[92:95], a[20:23], v[44:47], v[92:95]
v_mfma_f32_16x16x32_bf16 v[96:99], a[20:23], v[48:51], v[96:99]
v_mfma_f32_16x16x32_bf16 v[100:103], a[20:23], v[52:55], v[100:103]
s_waitcnt lgkmcnt(3)
v_mfma_f32_16x16x32_bf16 v[56:59], a[84:87], v[24:27], v[56:59]
ds_read_b128 v[40:43], v1 offset:7168
s_waitcnt lgkmcnt(3)
v_mfma_f32_16x16x32_bf16 v[60:63], a[84:87], v[28:31], v[60:63]
ds_read_b128 v[44:47], v1 offset:27648
s_waitcnt lgkmcnt(3)
v_mfma_f32_16x16x32_bf16 v[64:67], a[84:87], v[32:35], v[64:67]
ds_read_b128 v[48:51], v1 offset:48128
s_waitcnt lgkmcnt(3)
v_mfma_f32_16x16x32_bf16 v[68:71], a[84:87], v[36:39], v[68:71]
ds_read_b128 v[52:55], v238 offset:7168
v_mfma_f32_16x16x32_bf16 v[72:75], v[24:27], a[88:91], v[72:75]
s_add_u32 s69, s69, 4096
s_add_u32 s70, s70, 4096
s_mov_b32 m0, s70
s_nop 0
buffer_load_dwordx4 v1, s[4:7], s69 offen offset:0 sc1 lds
v_mfma_f32_16x16x32_bf16 v[76:79], v[28:31], a[88:91], v[76:79]
s_add_u32 s43, s43, 4096
buffer_load_dwordx4 a[124:127], v1, s[4:7], s43 offen
v_mfma_f32_16x16x32_bf16 v[80:83], v[32:35], a[88:91], v[80:83]
buffer_load_dwordx4 a[196:199], v1, s[4:7], s40 offen offset:1024
v_mfma_f32_16x16x32_bf16 v[84:87], v[36:39], a[88:91], v[84:87]
buffer_load_dwordx4 a[28:31], v1, s[4:7], s41 offen offset:1024
s_waitcnt vmcnt(18)
v_mfma_f32_16x16x32_bf16 v[88:91], a[24:27], v[24:27], v[88:91]
v_mfma_f32_16x16x32_bf16 v[92:95], a[24:27], v[28:31], v[92:95]
v_mfma_f32_16x16x32_bf16 v[96:99], a[24:27], v[32:35], v[96:99]
v_mfma_f32_16x16x32_bf16 v[100:103], a[24:27], v[36:39], v[100:103]
s_waitcnt lgkmcnt(3)
v_mfma_f32_16x16x32_bf16 v[56:59], a[92:95], v[40:43], v[56:59]
ds_read_b128 v[24:27], v1 offset:8192
s_waitcnt lgkmcnt(3)
v_mfma_f32_16x16x32_bf16 v[60:63], a[92:95], v[44:47], v[60:63]
ds_read_b128 v[28:31], v1 offset:28672
s_waitcnt lgkmcnt(3)
v_mfma_f32_16x16x32_bf16 v[64:67], a[92:95], v[48:51], v[64:67]
ds_read_b128 v[32:35], v1 offset:49152
s_waitcnt lgkmcnt(3)
v_mfma_f32_16x16x32_bf16 v[68:71], a[92:95], v[52:55], v[68:71]
ds_read_b128 v[36:39], v238 offset:8192
v_mfma_f32_16x16x32_bf16 v[72:75], v[40:43], a[144:147], v[72:75]
s_mov_b32 m0, s70
s_nop 0
buffer_load_dwordx4 v1, s[4:7], s69 offen offset:1024 sc1 lds
v_mfma_f32_16x16x32_bf16 v[76:79], v[44:47], a[144:147], v[76:79]
buffer_load_dwordx4 a[32:35], v1, s[4:7], s43 offen offset:1024
v_mfma_f32_16x16x32_bf16 v[80:83], v[48:51], a[144:147], v[80:83]
buffer_load_dwordx4 a[36:39], v1, s[4:7], s40 offen offset:2048
v_mfma_f32_16x16x32_bf16 v[84:87], v[52:55], a[144:147], v[84:87]
buffer_load_dwordx4 a[60:63], v1, s[4:7], s41 offen offset:2048
s_waitcnt vmcnt(21)
v_mfma_f32_16x16x32_bf16 v[88:91], a[184:187], v[40:43], v[88:91]
v_mfma_f32_16x16x32_bf16 v[92:95], a[184:187], v[44:47], v[92:95]
v_mfma_f32_16x16x32_bf16 v[96:99], a[184:187], v[48:51], v[96:99]
v_mfma_f32_16x16x32_bf16 v[100:103], a[184:187], v[52:55], v[100:103]
s_waitcnt lgkmcnt(3)
v_mfma_f32_16x16x32_bf16 v[56:59], a[148:151], v[24:27], v[56:59]
ds_read_b128 v[40:43], v1 offset:9216
s_waitcnt lgkmcnt(3)
v_mfma_f32_16x16x32_bf16 v[60:63], a[148:151], v[28:31], v[60:63]
ds_read_b128 v[44:47], v1 offset:29696
s_waitcnt lgkmcnt(3)
v_mfma_f32_16x16x32_bf16 v[64:67], a[148:151], v[32:35], v[64:67]
ds_read_b128 v[48:51], v1 offset:50176
s_waitcnt lgkmcnt(3)
v_mfma_f32_16x16x32_bf16 v[68:71], a[148:151], v[36:39], v[68:71]
ds_read_b128 v[52:55], v238 offset:9216
v_mfma_f32_16x16x32_bf16 v[72:75], v[24:27], a[224:227], v[72:75]
s_mov_b32 m0, s70
s_nop 0
buffer_load_dwordx4 v1, s[4:7], s69 offen offset:2048 sc1 lds
v_mfma_f32_16x16x32_bf16 v[76:79], v[28:31], a[224:227], v[76:79]
buffer_load_dwordx4 a[64:67], v1, s[4:7], s43 offen offset:2048
v_mfma_f32_16x16x32_bf16 v[80:83], v[32:35], a[224:227], v[80:83]
buffer_load_dwordx4 a[132:135], v1, s[4:7], s40 offen offset:3072
v_mfma_f32_16x16x32_bf16 v[84:87], v[36:39], a[224:227], v[84:87]
buffer_load_dwordx4 a[204:207], v1, s[4:7], s41 offen offset:3072
s_waitcnt vmcnt(24)
v_mfma_f32_16x16x32_bf16 v[88:91], a[188:191], v[24:27], v[88:91]
v_mfma_f32_16x16x32_bf16 v[92:95], a[188:191], v[28:31], v[92:95]
v_mfma_f32_16x16x32_bf16 v[96:99], a[188:191], v[32:35], v[96:99]
v_mfma_f32_16x16x32_bf16 v[100:103], a[188:191], v[36:39], v[100:103]
s_waitcnt vmcnt(19)
s_barrier
s_waitcnt lgkmcnt(3)
v_mfma_f32_16x16x32_bf16 v[56:59], a[228:231], v[40:43], v[56:59]
ds_read_b128 v[24:27], v1 offset:10240
s_waitcnt lgkmcnt(3)
v_mfma_f32_16x16x32_bf16 v[60:63], a[228:231], v[44:47], v[60:63]
ds_read_b128 v[28:31], v1 offset:30720
s_waitcnt lgkmcnt(3)
v_mfma_f32_16x16x32_bf16 v[64:67], a[228:231], v[48:51], v[64:67]
ds_read_b128 v[32:35], v1 offset:51200
s_waitcnt lgkmcnt(3)
v_mfma_f32_16x16x32_bf16 v[68:71], a[228:231], v[52:55], v[68:71]
ds_read_b128 v[36:39], v238 offset:10240
v_mfma_f32_16x16x32_bf16 v[72:75], v[40:43], a[96:99], v[72:75]
s_mov_b32 m0, s70
s_nop 0
buffer_load_dwordx4 v1, s[4:7], s69 offen offset:3072 sc1 lds
v_mfma_f32_16x16x32_bf16 v[76:79], v[44:47], a[96:99], v[76:79]
buffer_load_dwordx4 a[208:211], v1, s[4:7], s43 offen offset:3072
v_mfma_f32_16x16x32_bf16 v[80:83], v[48:51], a[96:99], v[80:83]
buffer_load_dwordx4 a[128:131], v1, s[4:7], s42 offen
v_mfma_f32_16x16x32_bf16 v[84:87], v[52:55], a[96:99], v[84:87]
buffer_load_dwordx4 a[48:51], v1, s[4:7], s42 offen offset:1024
v_mfma_f32_16x16x32_bf16 v[88:91], a[192:195], v[40:43], v[88:91]
v_mfma_f32_16x16x32_bf16 v[92:95], a[192:195], v[44:47], v[92:95]
v_mfma_f32_16x16x32_bf16 v[96:99], a[192:195], v[48:51], v[96:99]
v_mfma_f32_16x16x32_bf16 v[100:103], a[192:195], v[52:55], v[100:103]
s_waitcnt lgkmcnt(3)
v_mfma_f32_16x16x32_bf16 v[56:59], a[100:103], v[24:27], v[56:59]
ds_read_b128 v[40:43], v1 offset:11264
s_waitcnt lgkmcnt(3)
v_mfma_f32_16x16x32_bf16 v[60:63], a[100:103], v[28:31], v[60:63]
ds_read_b128 v[44:47], v1 offset:31744
s_waitcnt lgkmcnt(3)
v_mfma_f32_16x16x32_bf16 v[64:67], a[100:103], v[32:35], v[64:67]
ds_read_b128 v[48:51], v1 offset:52224
s_waitcnt lgkmcnt(3)
v_mfma_f32_16x16x32_bf16 v[68:71], a[100:103], v[36:39], v[68:71]
ds_read_b128 v[52:55], v238 offset:11264
v_mfma_f32_16x16x32_bf16 v[72:75], v[24:27], a[116:119], v[72:75]
v_mfma_f32_16x16x32_bf16 v[76:79], v[28:31], a[116:119], v[76:79]
buffer_load_dwordx4 a[52:55], v1, s[4:7], s42 offen offset:2048
v_mfma_f32_16x16x32_bf16 v[80:83], v[32:35], a[116:119], v[80:83]
buffer_load_dwordx4 a[56:59], v1, s[4:7], s42 offen offset:3072
v_mfma_f32_16x16x32_bf16 v[84:87], v[36:39], a[116:119], v[84:87]
s_add_u32 s42, s42, 4096
buffer_load_dwordx4 a[212:215], v1, s[4:7], s42 offen
v_mfma_f32_16x16x32_bf16 v[88:91], a[180:183], v[24:27], v[88:91]
v_mfma_f32_16x16x32_bf16 v[92:95], a[180:183], v[28:31], v[92:95]
v_mfma_f32_16x16x32_bf16 v[96:99], a[180:183], v[32:35], v[96:99]
v_mfma_f32_16x16x32_bf16 v[100:103], a[180:183], v[36:39], v[100:103]
s_waitcnt lgkmcnt(3)
v_mfma_f32_16x16x32_bf16 v[56:59], a[156:159], v[40:43], v[56:59]
ds_read_b128 v[24:27], v1 offset:12288
s_waitcnt lgkmcnt(3)
v_mfma_f32_16x16x32_bf16 v[60:63], a[156:159], v[44:47], v[60:63]
ds_read_b128 v[28:31], v1 offset:32768
s_waitcnt lgkmcnt(3)
v_mfma_f32_16x16x32_bf16 v[64:67], a[156:159], v[48:51], v[64:67]
ds_read_b128 v[32:35], v1 offset:53248
s_waitcnt lgkmcnt(3)
v_mfma_f32_16x16x32_bf16 v[68:71], a[156:159], v[52:55], v[68:71]
ds_read_b128 v[36:39], v238 offset:12288
v_mfma_f32_16x16x32_bf16 v[72:75], v[40:43], a[160:163], v[72:75]
v_mfma_f32_16x16x32_bf16 v[76:79], v[44:47], a[160:163], v[76:79]
buffer_load_dwordx4 a[104:107], v1, s[4:7], s42 offen offset:1024
v_mfma_f32_16x16x32_bf16 v[80:83], v[48:51], a[160:163], v[80:83]
buffer_load_dwordx4 a[176:179], v1, s[4:7], s42 offen offset:2048
v_mfma_f32_16x16x32_bf16 v[84:87], v[52:55], a[160:163], v[84:87]
buffer_load_dwordx4 a[108:111], v1, s[4:7], s42 offen offset:3072
v_mfma_f32_16x16x32_bf16 v[88:91], a[8:11], v[40:43], v[88:91]
v_mfma_f32_16x16x32_bf16 v[92:95], a[8:11], v[44:47], v[92:95]
v_mfma_f32_16x16x32_bf16 v[96:99], a[8:11], v[48:51], v[96:99]
v_mfma_f32_16x16x32_bf16 v[100:103], a[8:11], v[52:55], v[100:103]
s_waitcnt lgkmcnt(3)
v_mfma_f32_16x16x32_bf16 v[56:59], a[232:235], v[24:27], v[56:59]
ds_read_b128 v[40:43], v1 offset:13312
s_waitcnt lgkmcnt(3)
v_mfma_f32_16x16x32_bf16 v[60:63], a[232:235], v[28:31], v[60:63]
ds_read_b128 v[44:47], v1 offset:33792
s_waitcnt lgkmcnt(3)
v_mfma_f32_16x16x32_bf16 v[64:67], a[232:235], v[32:35], v[64:67]
ds_read_b128 v[48:51], v1 offset:54272
s_waitcnt lgkmcnt(3)
v_mfma_f32_16x16x32_bf16 v[68:71], a[232:235], v[36:39], v[68:71]
ds_read_b128 v[52:55], v238 offset:13312
v_mfma_f32_16x16x32_bf16 v[72:75], v[24:27], a[236:239], v[72:75]
v_mfma_f32_16x16x32_bf16 v[76:79], v[28:31], a[236:239], v[76:79]
s_add_u32 s42, s42, 4096
buffer_load_dwordx4 a[112:115], v1, s[4:7], s42 offen
v_mfma_f32_16x16x32_bf16 v[80:83], v[32:35], a[236:239], v[80:83]
buffer_load_dwordx4 a[164:167], v1, s[4:7], s42 offen offset:1024
v_mfma_f32_16x16x32_bf16 v[84:87], v[36:39], a[236:239], v[84:87]
buffer_load_dwordx4 a[68:71], v1, s[4:7], s42 offen offset:2048
s_waitcnt vmcnt(31)
v_mfma_f32_16x16x32_bf16 v[88:91], a[12:15], v[24:27], v[88:91]
v_mfma_f32_16x16x32_bf16 v[92:95], a[12:15], v[28:31], v[92:95]
v_mfma_f32_16x16x32_bf16 v[96:99], a[12:15], v[32:35], v[96:99]
v_mfma_f32_16x16x32_bf16 v[100:103], a[12:15], v[36:39], v[100:103]
s_waitcnt lgkmcnt(3)
v_mfma_f32_16x16x32_bf16 v[56:59], a[240:243], v[40:43], v[56:59]
ds_read_b128 v[24:27], v1 offset:14336
s_waitcnt lgkmcnt(3)
v_mfma_f32_16x16x32_bf16 v[60:63], a[240:243], v[44:47], v[60:63]
ds_read_b128 v[28:31], v1 offset:34816
s_waitcnt lgkmcnt(3)
v_mfma_f32_16x16x32_bf16 v[64:67], a[240:243], v[48:51], v[64:67]
ds_read_b128 v[32:35], v1 offset:55296
s_waitcnt lgkmcnt(3)
v_mfma_f32_16x16x32_bf16 v[68:71], a[240:243], v[52:55], v[68:71]
ds_read_b128 v[36:39], v238 offset:14336
v_mfma_f32_16x16x32_bf16 v[72:75], v[40:43], a[152:155], v[72:75]
v_mfma_f32_16x16x32_bf16 v[76:79], v[44:47], a[152:155], v[76:79]
buffer_load_dwordx4 a[72:75], v1, s[4:7], s42 offen offset:3072
v_mfma_f32_16x16x32_bf16 v[80:83], v[48:51], a[152:155], v[80:83]
s_add_u32 s42, s42, 4096
buffer_load_dwordx4 a[244:247], v1, s[4:7], s42 offen
v_mfma_f32_16x16x32_bf16 v[84:87], v[52:55], a[152:155], v[84:87]
buffer_load_dwordx4 a[216:219], v1, s[4:7], s42 offen offset:1024
s_waitcnt vmcnt(33)
v_mfma_f32_16x16x32_bf16 v[88:91], a[16:19], v[40:43], v[88:91]
v_mfma_f32_16x16x32_bf16 v[92:95], a[16:19], v[44:47], v[92:95]
v_mfma_f32_16x16x32_bf16 v[96:99], a[16:19], v[48:51], v[96:99]
v_mfma_f32_16x16x32_bf16 v[100:103], a[16:19], v[52:55], v[100:103]
s_waitcnt vmcnt(15)
s_barrier
s_waitcnt lgkmcnt(3)
v_mfma_f32_16x16x32_bf16 v[56:59], a[0:3], v[24:27], v[56:59]
ds_read_b128 v[40:43], v1 offset:15360
s_waitcnt lgkmcnt(3)
v_mfma_f32_16x16x32_bf16 v[60:63], a[0:3], v[28:31], v[60:63]
ds_read_b128 v[44:47], v1 offset:35840
s_waitcnt lgkmcnt(3)
v_mfma_f32_16x16x32_bf16 v[64:67], a[0:3], v[32:35], v[64:67]
ds_read_b128 v[48:51], v1 offset:56320
s_waitcnt lgkmcnt(3)
v_mfma_f32_16x16x32_bf16 v[68:71], a[0:3], v[36:39], v[68:71]
ds_read_b128 v[52:55], v238 offset:15360
v_mfma_f32_16x16x32_bf16 v[72:75], v[24:27], a[4:7], v[72:75]
v_mfma_f32_16x16x32_bf16 v[76:79], v[28:31], a[4:7], v[76:79]
buffer_load_dwordx4 a[220:223], v1, s[4:7], s42 offen offset:2048
v_mfma_f32_16x16x32_bf16 v[80:83], v[32:35], a[4:7], v[80:83]
buffer_load_dwordx4 a[248:251], v1, s[4:7], s42 offen offset:3072
v_mfma_f32_16x16x32_bf16 v[84:87], v[36:39], a[4:7], v[84:87]
s_add_u32 s42, s42, 4096
buffer_load_dwordx4 a[136:139], v1, s[4:7], s42 offen
v_mfma_f32_16x16x32_bf16 v[88:91], a[40:43], v[24:27], v[88:91]
v_mfma_f32_16x16x32_bf16 v[92:95], a[40:43], v[28:31], v[92:95]
v_mfma_f32_16x16x32_bf16 v[96:99], a[40:43], v[32:35], v[96:99]
v_mfma_f32_16x16x32_bf16 v[100:103], a[40:43], v[36:39], v[100:103]
s_waitcnt lgkmcnt(3)
v_mfma_f32_16x16x32_bf16 v[56:59], a[168:171], v[40:43], v[56:59]
ds_read_b64 v[24:25], v2 offset:16384
ds_read_b64 v[26:27], v2 offset:16896
s_waitcnt lgkmcnt(4)
v_mfma_f32_16x16x32_bf16 v[60:63], a[168:171], v[44:47], v[60:63]
ds_read_b64 v[28:29], v2 offset:36864
ds_read_b64 v[30:31], v2 offset:37376
s_waitcnt lgkmcnt(5)
v_mfma_f32_16x16x32_bf16 v[64:67], a[168:171], v[48:51], v[64:67]
ds_read_b64 v[32:33], v2 offset:57344
ds_read_b64 v[34:35], v2 offset:57856
s_waitcnt lgkmcnt(6)
v_mfma_f32_16x16x32_bf16 v[68:71], a[168:171], v[52:55], v[68:71]
ds_read_b64 v[36:37], v239 offset:16384
ds_read_b64 v[38:39], v239 offset:16896
v_mfma_f32_16x16x32_bf16 v[72:75], v[40:43], a[172:175], v[72:75]
v_mfma_f32_16x16x32_bf16 v[76:79], v[44:47], a[172:175], v[76:79]
buffer_load_dwordx4 a[140:143], v1, s[4:7], s42 offen offset:1024
v_mfma_f32_16x16x32_bf16 v[80:83], v[48:51], a[172:175], v[80:83]
buffer_load_dwordx4 a[252:255], v1, s[4:7], s42 offen offset:2048
v_mfma_f32_16x16x32_bf16 v[84:87], v[52:55], a[172:175], v[84:87]
buffer_load_dwordx4 a[76:79], v1, s[4:7], s42 offen offset:3072
v_mfma_f32_16x16x32_bf16 v[88:91], a[44:47], v[40:43], v[88:91]
v_mfma_f32_16x16x32_bf16 v[92:95], a[44:47], v[44:47], v[92:95]
v_mfma_f32_16x16x32_bf16 v[96:99], a[44:47], v[48:51], v[96:99]
v_mfma_f32_16x16x32_bf16 v[100:103], a[44:47], v[52:55], v[100:103]
s_waitcnt lgkmcnt(6)
v_mfma_f32_16x16x32_bf16 v[56:59], a[200:203], v[24:27], v[56:59]
ds_read_b64 v[40:41], v2 offset:17408
ds_read_b64 v[42:43], v2 offset:17920
s_waitcnt lgkmcnt(6)
v_mfma_f32_16x16x32_bf16 v[60:63], a[200:203], v[28:31], v[60:63]
ds_read_b64 v[44:45], v2 offset:37888
ds_read_b64 v[46:47], v2 offset:38400
s_waitcnt lgkmcnt(6)
v_mfma_f32_16x16x32_bf16 v[64:67], a[200:203], v[32:35], v[64:67]
ds_read_b64 v[48:49], v2 offset:58368
ds_read_b64 v[50:51], v2 offset:58880
s_waitcnt lgkmcnt(6)
v_mfma_f32_16x16x32_bf16 v[68:71], a[200:203], v[36:39], v[68:71]
ds_read_b64 v[52:53], v239 offset:17408
ds_read_b64 v[54:55], v239 offset:17920
v_mfma_f32_16x16x32_bf16 v[72:75], v[24:27], a[120:123], v[72:75]
v_mfma_f32_16x16x32_bf16 v[76:79], v[28:31], a[120:123], v[76:79]
v_mfma_f32_16x16x32_bf16 v[80:83], v[32:35], a[120:123], v[80:83]
v_mfma_f32_16x16x32_bf16 v[84:87], v[36:39], a[120:123], v[84:87]
v_mfma_f32_16x16x32_bf16 v[88:91], a[124:127], v[24:27], v[88:91]
v_mfma_f32_16x16x32_bf16 v[92:95], a[124:127], v[28:31], v[92:95]
v_mfma_f32_16x16x32_bf16 v[96:99], a[124:127], v[32:35], v[96:99]
v_mfma_f32_16x16x32_bf16 v[100:103], a[124:127], v[36:39], v[100:103]
s_waitcnt lgkmcnt(6)
v_mfma_f32_16x16x32_bf16 v[56:59], a[196:199], v[40:43], v[56:59]
ds_read_b64 v[24:25], v2 offset:18432
ds_read_b64 v[26:27], v2 offset:18944
s_waitcnt lgkmcnt(6)
v_mfma_f32_16x16x32_bf16 v[60:63], a[196:199], v[44:47], v[60:63]
ds_read_b64 v[28:29], v2 offset:38912
ds_read_b64 v[30:31], v2 offset:39424
s_waitcnt lgkmcnt(6)
v_mfma_f32_16x16x32_bf16 v[64:67], a[196:199], v[48:51], v[64:67]
ds_read_b64 v[32:33], v2 offset:59392
ds_read_b64 v[34:35], v2 offset:59904
s_waitcnt lgkmcnt(6)
v_mfma_f32_16x16x32_bf16 v[68:71], a[196:199], v[52:55], v[68:71]
ds_read_b64 v[36:37], v239 offset:18432
ds_read_b64 v[38:39], v239 offset:18944
v_mfma_f32_16x16x32_bf16 v[72:75], v[40:43], a[28:31], v[72:75]
v_mfma_f32_16x16x32_bf16 v[76:79], v[44:47], a[28:31], v[76:79]
v_mfma_f32_16x16x32_bf16 v[80:83], v[48:51], a[28:31], v[80:83]
v_mfma_f32_16x16x32_bf16 v[84:87], v[52:55], a[28:31], v[84:87]
v_mfma_f32_16x16x32_bf16 v[88:91], a[32:35], v[40:43], v[88:91]
v_mfma_f32_16x16x32_bf16 v[92:95], a[32:35], v[44:47], v[92:95]
v_mfma_f32_16x16x32_bf16 v[96:99], a[32:35], v[48:51], v[96:99]
v_mfma_f32_16x16x32_bf16 v[100:103], a[32:35], v[52:55], v[100:103]
s_waitcnt lgkmcnt(6)
v_mfma_f32_16x16x32_bf16 v[56:59], a[36:39], v[24:27], v[56:59]
ds_read_b64 v[40:41], v2 offset:19456
ds_read_b64 v[42:43], v2 offset:19968
s_waitcnt lgkmcnt(6)
v_mfma_f32_16x16x32_bf16 v[60:63], a[36:39], v[28:31], v[60:63]
ds_read_b64 v[44:45], v2 offset:39936
ds_read_b64 v[46:47], v2 offset:40448
s_waitcnt lgkmcnt(6)
v_mfma_f32_16x16x32_bf16 v[64:67], a[36:39], v[32:35], v[64:67]
ds_read_b64 v[48:49], v2 offset:60416
ds_read_b64 v[50:51], v2 offset:60928
s_waitcnt lgkmcnt(6)
v_mfma_f32_16x16x32_bf16 v[68:71], a[36:39], v[36:39], v[68:71]
ds_read_b64 v[52:53], v239 offset:19456
ds_read_b64 v[54:55], v239 offset:19968
v_mfma_f32_16x16x32_bf16 v[72:75], v[24:27], a[60:63], v[72:75]
v_mfma_f32_16x16x32_bf16 v[76:79], v[28:31], a[60:63], v[76:79]
v_mfma_f32_16x16x32_bf16 v[80:83], v[32:35], a[60:63], v[80:83]
v_mfma_f32_16x16x32_bf16 v[84:87], v[36:39], a[60:63], v[84:87]
v_mfma_f32_16x16x32_bf16 v[88:91], a[64:67], v[24:27], v[88:91]
v_mfma_f32_16x16x32_bf16 v[92:95], a[64:67], v[28:31], v[92:95]
v_mfma_f32_16x16x32_bf16 v[96:99], a[64:67], v[32:35], v[96:99]
v_mfma_f32_16x16x32_bf16 v[100:103], a[64:67], v[36:39], v[100:103]
s_waitcnt lgkmcnt(6)
v_mfma_f32_16x16x32_bf16 v[56:59], a[132:135], v[40:43], v[56:59]
s_waitcnt lgkmcnt(4)
v_mfma_f32_16x16x32_bf16 v[60:63], a[132:135], v[44:47], v[60:63]
s_waitcnt lgkmcnt(2)
v_mfma_f32_16x16x32_bf16 v[64:67], a[132:135], v[48:51], v[64:67]
s_waitcnt lgkmcnt(0)
v_mfma_f32_16x16x32_bf16 v[68:71], a[132:135], v[52:55], v[68:71]
v_mfma_f32_16x16x32_bf16 v[72:75], v[40:43], a[204:207], v[72:75]
v_mfma_f32_16x16x32_bf16 v[76:79], v[44:47], a[204:207], v[76:79]
v_mfma_f32_16x16x32_bf16 v[80:83], v[48:51], a[204:207], v[80:83]
v_mfma_f32_16x16x32_bf16 v[84:87], v[52:55], a[204:207], v[84:87]
s_waitcnt vmcnt(20)
v_mfma_f32_16x16x32_bf16 v[88:91], a[208:211], v[40:43], v[88:91]
v_mfma_f32_16x16x32_bf16 v[92:95], a[208:211], v[44:47], v[92:95]
v_mfma_f32_16x16x32_bf16 v[96:99], a[208:211], v[48:51], v[96:99]
v_mfma_f32_16x16x32_bf16 v[100:103], a[208:211], v[52:55], v[100:103]
v_lshlrev_b32 v3, 2, v241
v_add_u32 v3, 102400, v3
ds_read_b32 v136, v3 offset:0
ds_read_b32 v140, v3 offset:256
ds_read_b32 v137, v3 offset:64
ds_read_b32 v141, v3 offset:320
ds_read_b32 v138, v3 offset:128
ds_read_b32 v142, v3 offset:384
ds_read_b32 v139, v3 offset:192
ds_read_b32 v143, v3 offset:448
v_lshlrev_b32 v3, 4, v240
v_add_u32 v3, 102400, v3
ds_read_b128 v[144:147], v3 offset:0
ds_read_b128 v[160:163], v3 offset:256
ds_read_b128 v[148:151], v3 offset:64
ds_read_b128 v[164:167], v3 offset:320
ds_read_b128 v[152:155], v3 offset:128
ds_read_b128 v[168:171], v3 offset:384
ds_read_b128 v[156:159], v3 offset:192
ds_read_b128 v[172:175], v3 offset:448
s_waitcnt lgkmcnt(0)
s_lshl_b32 s24, s60, 14
s_add_u32 s24, s24, 17686528
s_lshl_b32 s25, s22, 12
s_add_u32 s25, s25, s24
s_mul_i32 s26, s60, 10240
s_add_u32 s26, s26, 24502272
s_lshl_b32 s27, s22, 11
s_add_u32 s27, s27, s26
s_add_u32 s26, s26, 8192
v_mul_f32 v194, 0x3ea52b5c, v140
v_mul_f32 v195, 0x3ea52b5c, v141
v_mul_f32 v196, 0x3ea52b5c, v142
v_mul_f32 v197, 0x3ea52b5c, v143
v_pk_fma_f32 v[88:89], v[184:185], v[136:137], v[88:89] op_sel:[0,0,0] op_sel_hi:[1,0,1]
v_pk_fma_f32 v[90:91], v[186:187], v[136:137], v[90:91] op_sel:[0,0,0] op_sel_hi:[1,0,1]
v_pk_mul_f32 v[88:89], v[88:89], v[194:195] op_sel:[0,0] op_sel_hi:[1,0]
v_pk_mul_f32 v[90:91], v[90:91], v[194:195] op_sel:[0,0] op_sel_hi:[1,0]
v_cvt_pk_bf16_f32 v40, v88, v89
v_cvt_pk_bf16_f32 v41, v90, v91
ds_write_b64 v239, v[40:41] offset:41984
v_pk_fma_f32 v[92:93], v[184:185], v[136:137], v[92:93] op_sel:[0,1,0] op_sel_hi:[1,1,1]
v_pk_fma_f32 v[94:95], v[186:187], v[136:137], v[94:95] op_sel:[0,1,0] op_sel_hi:[1,1,1]
v_pk_mul_f32 v[92:93], v[92:93], v[194:195] op_sel:[0,1] op_sel_hi:[1,1]
v_pk_mul_f32 v[94:95], v[94:95], v[194:195] op_sel:[0,1] op_sel_hi:[1,1]
v_cvt_pk_bf16_f32 v42, v92, v93
v_cvt_pk_bf16_f32 v43, v94, v95
ds_write_b64 v239, v[42:43] offset:42496
v_pk_fma_f32 v[96:97], v[184:185], v[138:139], v[96:97] op_sel:[0,0,0] op_sel_hi:[1,0,1]
v_pk_fma_f32 v[98:99], v[186:187], v[138:139], v[98:99] op_sel:[0,0,0] op_sel_hi:[1,0,1]
v_pk_mul_f32 v[96:97], v[96:97], v[196:197] op_sel:[0,0] op_sel_hi:[1,0]
v_pk_mul_f32 v[98:99], v[98:99], v[196:197] op_sel:[0,0] op_sel_hi:[1,0]
v_cvt_pk_bf16_f32 v44, v96, v97
v_cvt_pk_bf16_f32 v45, v98, v99
ds_write_b64 v239, v[44:45] offset:43008
v_pk_fma_f32 v[100:101], v[184:185], v[138:139], v[100:101] op_sel:[0,1,0] op_sel_hi:[1,1,1]
v_pk_fma_f32 v[102:103], v[186:187], v[138:139], v[102:103] op_sel:[0,1,0] op_sel_hi:[1,1,1]
v_pk_mul_f32 v[100:101], v[100:101], v[196:197] op_sel:[0,1] op_sel_hi:[1,1]
v_pk_mul_f32 v[102:103], v[102:103], v[196:197] op_sel:[0,1] op_sel_hi:[1,1]
v_cvt_pk_bf16_f32 v46, v100, v101
v_cvt_pk_bf16_f32 v47, v102, v103
ds_write_b64 v239, v[46:47] offset:43520
v_pk_fma_f32 v[72:73], v[144:145], v[188:189], v[72:73] op_sel:[0,0,0] op_sel_hi:[1,0,1]
v_pk_fma_f32 v[74:75], v[146:147], v[188:189], v[74:75] op_sel:[0,0,0] op_sel_hi:[1,0,1]
v_pk_mul_f32 v[72:73], v[72:73], v[160:161]
v_pk_mul_f32 v[74:75], v[74:75], v[162:163]
v_cvt_pk_bf16_f32 v48, v72, v73
v_cvt_pk_bf16_f32 v49, v74, v75
v_pk_fma_f32 v[76:77], v[148:149], v[188:189], v[76:77] op_sel:[0,0,0] op_sel_hi:[1,0,1]
v_pk_fma_f32 v[78:79], v[150:151], v[188:189], v[78:79] op_sel:[0,0,0] op_sel_hi:[1,0,1]
v_pk_mul_f32 v[76:77], v[76:77], v[164:165]
v_pk_mul_f32 v[78:79], v[78:79], v[166:167]
v_cvt_pk_bf16_f32 v50, v76, v77
v_cvt_pk_bf16_f32 v51, v78, v79
buffer_store_dwordx4 v[48:51], v1, s[4:7], s27 offen offset:0 sc1
v_pk_fma_f32 v[80:81], v[152:153], v[188:189], v[80:81] op_sel:[0,0,0] op_sel_hi:[1,0,1]
v_pk_fma_f32 v[82:83], v[154:155], v[188:189], v[82:83] op_sel:[0,0,0] op_sel_hi:[1,0,1]
v_pk_mul_f32 v[80:81], v[80:81], v[168:169]
v_pk_mul_f32 v[82:83], v[82:83], v[170:171]
v_cvt_pk_bf16_f32 v52, v80, v81
v_cvt_pk_bf16_f32 v53, v82, v83
v_pk_fma_f32 v[84:85], v[156:157], v[188:189], v[84:85] op_sel:[0,0,0] op_sel_hi:[1,0,1]
v_pk_fma_f32 v[86:87], v[158:159], v[188:189], v[86:87] op_sel:[0,0,0] op_sel_hi:[1,0,1]
v_pk_mul_f32 v[84:85], v[84:85], v[172:173]
v_pk_mul_f32 v[86:87], v[86:87], v[174:175]
v_cvt_pk_bf16_f32 v54, v84, v85
v_cvt_pk_bf16_f32 v55, v86, v87
buffer_store_dwordx4 v[52:55], v1, s[4:7], s27 offen offset:1024 sc1
v_pk_fma_f32 v[56:57], v[176:177], v[136:137], v[56:57] op_sel:[0,0,0] op_sel_hi:[1,0,1]
v_pk_fma_f32 v[58:59], v[178:179], v[136:137], v[58:59] op_sel:[0,0,0] op_sel_hi:[1,0,1]
v_pk_mul_f32 v[56:57], v[56:57], v[140:141] op_sel:[0,0] op_sel_hi:[1,0]
v_pk_mul_f32 v[58:59], v[58:59], v[140:141] op_sel:[0,0] op_sel_hi:[1,0]
v_cvt_pk_bf16_f32 v24, v56, v57
v_cvt_pk_bf16_f32 v25, v58, v59
v_pk_fma_f32 v[60:61], v[176:177], v[136:137], v[60:61] op_sel:[0,1,0] op_sel_hi:[1,1,1]
v_pk_fma_f32 v[62:63], v[178:179], v[136:137], v[62:63] op_sel:[0,1,0] op_sel_hi:[1,1,1]
v_pk_mul_f32 v[60:61], v[60:61], v[140:141] op_sel:[0,1] op_sel_hi:[1,1]
v_pk_mul_f32 v[62:63], v[62:63], v[140:141] op_sel:[0,1] op_sel_hi:[1,1]
v_cvt_pk_bf16_f32 v28, v60, v61
v_cvt_pk_bf16_f32 v29, v62, v63
v_pk_fma_f32 v[64:65], v[176:177], v[138:139], v[64:65] op_sel:[0,0,0] op_sel_hi:[1,0,1]
v_pk_fma_f32 v[66:67], v[178:179], v[138:139], v[66:67] op_sel:[0,0,0] op_sel_hi:[1,0,1]
v_pk_mul_f32 v[64:65], v[64:65], v[142:143] op_sel:[0,0] op_sel_hi:[1,0]
v_pk_mul_f32 v[66:67], v[66:67], v[142:143] op_sel:[0,0] op_sel_hi:[1,0]
v_cvt_pk_bf16_f32 v32, v64, v65
v_cvt_pk_bf16_f32 v33, v66, v67
v_pk_fma_f32 v[68:69], v[176:177], v[138:139], v[68:69] op_sel:[0,1,0] op_sel_hi:[1,1,1]
v_pk_fma_f32 v[70:71], v[178:179], v[138:139], v[70:71] op_sel:[0,1,0] op_sel_hi:[1,1,1]
v_pk_mul_f32 v[68:69], v[68:69], v[142:143] op_sel:[0,1] op_sel_hi:[1,1]
v_pk_mul_f32 v[70:71], v[70:71], v[142:143] op_sel:[0,1] op_sel_hi:[1,1]
v_cvt_pk_bf16_f32 v36, v68, v69
v_cvt_pk_bf16_f32 v37, v70, v71
s_waitcnt lgkmcnt(0)
s_barrier
ds_read_b64 v[26:27], v239 offset:44032
ds_read_b64 v[30:31], v239 offset:44544
ds_read_b64 v[34:35], v239 offset:45056
ds_read_b64 v[38:39], v239 offset:45568
ds_read_b64 v[202:203], v239 offset:41984
ds_read_b64 v[206:207], v239 offset:42496
ds_read_b64 v[210:211], v239 offset:43008
ds_read_b64 v[214:215], v239 offset:43520
s_waitcnt lgkmcnt(7)
buffer_store_dwordx4 v[24:27], v1, s[4:7], s25 offen offset:0 sc1
s_waitcnt lgkmcnt(6)
buffer_store_dwordx4 v[28:31], v1, s[4:7], s25 offen offset:1024 sc1
s_waitcnt lgkmcnt(5)
buffer_store_dwordx4 v[32:35], v1, s[4:7], s25 offen offset:2048 sc1
s_waitcnt lgkmcnt(4)
buffer_store_dwordx4 v[36:39], v1, s[4:7], s25 offen offset:3072 sc1
s_waitcnt lgkmcnt(0)
v_cmp_eq_u32 vcc, s22, v240
s_nop 1
v_cndmask_b32 v202, 0, v202, vcc
v_cndmask_b32 v203, 0, v203, vcc
v_cndmask_b32 v206, 0, v206, vcc
v_cndmask_b32 v207, 0, v207, vcc
v_cndmask_b32 v210, 0, v210, vcc
v_cndmask_b32 v211, 0, v211, vcc
v_cndmask_b32 v214, 0, v214, vcc
v_cndmask_b32 v215, 0, v215, vcc
s_waitcnt vmcnt(0)
v_mov_b32 v3, 6
s_mov_b64 exec, 1
buffer_store_dword v3, off, s[4:7], s23 sc1
s_mov_b64 exec, -1
ds_read_b128 v[24:27], v1 offset:0
ds_read_b128 v[28:31], v1 offset:20480
ds_read_b128 v[32:35], v1 offset:40960
ds_read_b128 v[36:39], v238 offset:0
s_waitcnt lgkmcnt(3)
v_mfma_f32_16x16x32_bf16 v[104:107], a[128:131], v[24:27], 0
ds_read_b128 v[40:43], v1 offset:1024
ds_read_b128 v[44:47], v1 offset:21504
s_waitcnt lgkmcnt(4)
v_mfma_f32_16x16x32_bf16 v[108:111], a[128:131], v[28:31], 0
ds_read_b128 v[48:51], v1 offset:41984
ds_read_b128 v[52:55], v238 offset:1024
s_waitcnt lgkmcnt(5)
v_mfma_f32_16x16x32_bf16 v[112:115], a[128:131], v[32:35], 0
s_waitcnt lgkmcnt(4)
v_mfma_f32_16x16x32_bf16 v[116:119], a[128:131], v[36:39], 0
s_waitcnt lgkmcnt(3)
v_mfma_f32_16x16x32_bf16 v[104:107], a[48:51], v[40:43], v[104:107]
ds_read_b128 v[24:27], v1 offset:2048
ds_read_b128 v[28:31], v1 offset:22528
s_waitcnt lgkmcnt(4)
v_mfma_f32_16x16x32_bf16 v[108:111], a[48:51], v[44:47], v[108:111]
ds_read_b128 v[32:35], v1 offset:43008
ds_read_b128 v[36:39], v238 offset:2048
s_waitcnt lgkmcnt(5)
v_mfma_f32_16x16x32_bf16 v[112:115], a[48:51], v[48:51], v[112:115]
s_waitcnt lgkmcnt(4)
v_mfma_f32_16x16x32_bf16 v[116:119], a[48:51], v[52:55], v[116:119]
s_waitcnt lgkmcnt(3)
v_mfma_f32_16x16x32_bf16 v[104:107], a[52:55], v[24:27], v[104:107]
ds_read_b128 v[40:43], v1 offset:3072
ds_read_b128 v[44:47], v1 offset:23552
s_waitcnt lgkmcnt(4)
v_mfma_f32_16x16x32_bf16 v[108:111], a[52:55], v[28:31], v[108:111]
ds_read_b128 v[48:51], v1 offset:44032
ds_read_b128 v[52:55], v238 offset:3072
s_waitcnt lgkmcnt(5)
v_mfma_f32_16x16x32_bf16 v[112:115], a[52:55], v[32:35], v[112:115]
s_waitcnt lgkmcnt(4)
v_mfma_f32_16x16x32_bf16 v[116:119], a[52:55], v[36:39], v[116:119]
s_waitcnt lgkmcnt(3)
v_mfma_f32_16x16x32_bf16 v[104:107], a[56:59], v[40:43], v[104:107]
ds_read_b128 v[24:27], v1 offset:4096
ds_read_b128 v[28:31], v1 offset:24576
s_waitcnt lgkmcnt(4)
v_mfma_f32_16x16x32_bf16 v[108:111], a[56:59], v[44:47], v[108:111]
ds_read_b128 v[32:35], v1 offset:45056
ds_read_b128 v[36:39], v238 offset:4096
s_waitcnt lgkmcnt(5)
v_mfma_f32_16x16x32_bf16 v[112:115], a[56:59], v[48:51], v[112:115]
s_waitcnt lgkmcnt(4)
v_mfma_f32_16x16x32_bf16 v[116:119], a[56:59], v[52:55], v[116:119]
s_waitcnt lgkmcnt(3)
v_mfma_f32_16x16x32_bf16 v[104:107], a[212:215], v[24:27], v[104:107]
ds_read_b128 v[40:43], v1 offset:5120
ds_read_b128 v[44:47], v1 offset:25600
s_waitcnt lgkmcnt(4)
v_mfma_f32_16x16x32_bf16 v[108:111], a[212:215], v[28:31], v[108:111]
ds_read_b128 v[48:51], v1 offset:46080
ds_read_b128 v[52:55], v238 offset:5120
s_waitcnt lgkmcnt(5)
v_mfma_f32_16x16x32_bf16 v[112:115], a[212:215], v[32:35], v[112:115]
s_waitcnt lgkmcnt(4)
v_mfma_f32_16x16x32_bf16 v[116:119], a[212:215], v[36:39], v[116:119]
s_waitcnt lgkmcnt(3)
v_mfma_f32_16x16x32_bf16 v[104:107], a[104:107], v[40:43], v[104:107]
ds_read_b128 v[24:27], v1 offset:6144
ds_read_b128 v[28:31], v1 offset:26624
s_waitcnt lgkmcnt(4)
v_mfma_f32_16x16x32_bf16 v[108:111], a[104:107], v[44:47], v[108:111]
ds_read_b128 v[32:35], v1 offset:47104
ds_read_b128 v[36:39], v238 offset:6144
s_waitcnt lgkmcnt(5)
v_mfma_f32_16x16x32_bf16 v[112:115], a[104:107], v[48:51], v[112:115]
s_waitcnt lgkmcnt(4)
v_mfma_f32_16x16x32_bf16 v[116:119], a[104:107], v[52:55], v[116:119]
s_waitcnt lgkmcnt(3)
v_mfma_f32_16x16x32_bf16 v[104:107], a[176:179], v[24:27], v[104:107]
ds_read_b128 v[40:43], v1 offset:7168
ds_read_b128 v[44:47], v1 offset:27648
s_waitcnt lgkmcnt(4)
v_mfma_f32_16x16x32_bf16 v[108:111], a[176:179], v[28:31], v[108:111]
ds_read_b128 v[48:51], v1 offset:48128
ds_read_b128 v[52:55], v238 offset:7168
s_waitcnt lgkmcnt(5)
v_mfma_f32_16x16x32_bf16 v[112:115], a[176:179], v[32:35], v[112:115]
s_waitcnt lgkmcnt(4)
v_mfma_f32_16x16x32_bf16 v[116:119], a[176:179], v[36:39], v[116:119]
s_waitcnt lgkmcnt(3)
v_mfma_f32_16x16x32_bf16 v[104:107], a[108:111], v[40:43], v[104:107]
ds_read_b128 v[24:27], v1 offset:8192
ds_read_b128 v[28:31], v1 offset:28672
s_waitcnt lgkmcnt(4)
v_mfma_f32_16x16x32_bf16 v[108:111], a[108:111], v[44:47], v[108:111]
ds_read_b128 v[32:35], v1 offset:49152
ds_read_b128 v[36:39], v238 offset:8192
s_waitcnt lgkmcnt(5)
v_mfma_f32_16x16x32_bf16 v[112:115], a[108:111], v[48:51], v[112:115]
s_waitcnt lgkmcnt(4)
v_mfma_f32_16x16x32_bf16 v[116:119], a[108:111], v[52:55], v[116:119]
s_waitcnt lgkmcnt(3)
v_mfma_f32_16x16x32_bf16 v[104:107], a[112:115], v[24:27], v[104:107]
ds_read_b128 v[40:43], v1 offset:9216
ds_read_b128 v[44:47], v1 offset:29696
s_waitcnt lgkmcnt(4)
v_mfma_f32_16x16x32_bf16 v[108:111], a[112:115], v[28:31], v[108:111]
ds_read_b128 v[48:51], v1 offset:50176
ds_read_b128 v[52:55], v238 offset:9216
s_waitcnt lgkmcnt(5)
v_mfma_f32_16x16x32_bf16 v[112:115], a[112:115], v[32:35], v[112:115]
s_waitcnt lgkmcnt(4)
v_mfma_f32_16x16x32_bf16 v[116:119], a[112:115], v[36:39], v[116:119]
s_waitcnt lgkmcnt(3)
v_mfma_f32_16x16x32_bf16 v[104:107], a[164:167], v[40:43], v[104:107]
ds_read_b128 v[24:27], v1 offset:10240
ds_read_b128 v[28:31], v1 offset:30720
s_waitcnt lgkmcnt(4)
v_mfma_f32_16x16x32_bf16 v[108:111], a[164:167], v[44:47], v[108:111]
ds_read_b128 v[32:35], v1 offset:51200
ds_read_b128 v[36:39], v238 offset:10240
s_waitcnt lgkmcnt(5)
v_mfma_f32_16x16x32_bf16 v[112:115], a[164:167], v[48:51], v[112:115]
s_waitcnt lgkmcnt(4)
v_mfma_f32_16x16x32_bf16 v[116:119], a[164:167], v[52:55], v[116:119]
s_waitcnt lgkmcnt(3)
v_mfma_f32_16x16x32_bf16 v[104:107], a[68:71], v[24:27], v[104:107]
ds_read_b128 v[40:43], v1 offset:11264
ds_read_b128 v[44:47], v1 offset:31744
s_waitcnt lgkmcnt(4)
v_mfma_f32_16x16x32_bf16 v[108:111], a[68:71], v[28:31], v[108:111]
ds_read_b128 v[48:51], v1 offset:52224
ds_read_b128 v[52:55], v238 offset:11264
s_waitcnt lgkmcnt(5)
v_mfma_f32_16x16x32_bf16 v[112:115], a[68:71], v[32:35], v[112:115]
s_waitcnt lgkmcnt(4)
v_mfma_f32_16x16x32_bf16 v[116:119], a[68:71], v[36:39], v[116:119]
s_waitcnt lgkmcnt(3)
v_mfma_f32_16x16x32_bf16 v[104:107], a[72:75], v[40:43], v[104:107]
ds_read_b128 v[24:27], v1 offset:12288
ds_read_b128 v[28:31], v1 offset:32768
s_waitcnt lgkmcnt(4)
v_mfma_f32_16x16x32_bf16 v[108:111], a[72:75], v[44:47], v[108:111]
ds_read_b128 v[32:35], v1 offset:53248
ds_read_b128 v[36:39], v238 offset:12288
s_waitcnt lgkmcnt(5)
v_mfma_f32_16x16x32_bf16 v[112:115], a[72:75], v[48:51], v[112:115]
s_waitcnt lgkmcnt(4)
v_mfma_f32_16x16x32_bf16 v[116:119], a[72:75], v[52:55], v[116:119]
s_waitcnt lgkmcnt(3)
v_mfma_f32_16x16x32_bf16 v[104:107], a[244:247], v[24:27], v[104:107]
ds_read_b128 v[40:43], v1 offset:13312
ds_read_b128 v[44:47], v1 offset:33792
s_waitcnt lgkmcnt(4)
v_mfma_f32_16x16x32_bf16 v[108:111], a[244:247], v[28:31], v[108:111]
ds_read_b128 v[48:51], v1 offset:54272
ds_read_b128 v[52:55], v238 offset:13312
s_waitcnt lgkmcnt(5)
v_mfma_f32_16x16x32_bf16 v[112:115], a[244:247], v[32:35], v[112:115]
s_waitcnt lgkmcnt(4)
v_mfma_f32_16x16x32_bf16 v[116:119], a[244:247], v[36:39], v[116:119]
s_waitcnt lgkmcnt(3)
v_mfma_f32_16x16x32_bf16 v[104:107], a[216:219], v[40:43], v[104:107]
ds_read_b128 v[24:27], v1 offset:14336
ds_read_b128 v[28:31], v1 offset:34816
s_waitcnt lgkmcnt(4)
v_mfma_f32_16x16x32_bf16 v[108:111], a[216:219], v[44:47], v[108:111]
ds_read_b128 v[32:35], v1 offset:55296
ds_read_b128 v[36:39], v238 offset:14336
s_waitcnt lgkmcnt(5)
v_mfma_f32_16x16x32_bf16 v[112:115], a[216:219], v[48:51], v[112:115]
s_waitcnt lgkmcnt(4)
v_mfma_f32_16x16x32_bf16 v[116:119], a[216:219], v[52:55], v[116:119]
s_waitcnt lgkmcnt(3)
v_mfma_f32_16x16x32_bf16 v[104:107], a[220:223], v[24:27], v[104:107]
ds_read_b128 v[40:43], v1 offset:15360
ds_read_b128 v[44:47], v1 offset:35840
s_waitcnt lgkmcnt(4)
v_mfma_f32_16x16x32_bf16 v[108:111], a[220:223], v[28:31], v[108:111]
ds_read_b128 v[48:51], v1 offset:56320
ds_read_b128 v[52:55], v238 offset:15360
s_waitcnt lgkmcnt(5)
v_mfma_f32_16x16x32_bf16 v[112:115], a[220:223], v[32:35], v[112:115]
s_waitcnt lgkmcnt(4)
v_mfma_f32_16x16x32_bf16 v[116:119], a[220:223], v[36:39], v[116:119]
s_waitcnt lgkmcnt(3)
v_mfma_f32_16x16x32_bf16 v[104:107], a[248:251], v[40:43], v[104:107]
ds_read_b64 v[24:25], v2 offset:16384
ds_read_b64 v[26:27], v2 offset:16896
ds_read_b64 v[28:29], v2 offset:36864
ds_read_b64 v[30:31], v2 offset:37376
s_waitcnt lgkmcnt(6)
v_mfma_f32_16x16x32_bf16 v[108:111], a[248:251], v[44:47], v[108:111]
ds_read_b64 v[32:33], v2 offset:57344
ds_read_b64 v[34:35], v2 offset:57856
ds_read_b64 v[36:37], v239 offset:16384
ds_read_b64 v[38:39], v239 offset:16896
s_waitcnt lgkmcnt(9)
v_mfma_f32_16x16x32_bf16 v[112:115], a[248:251], v[48:51], v[112:115]
s_waitcnt lgkmcnt(8)
v_mfma_f32_16x16x32_bf16 v[116:119], a[248:251], v[52:55], v[116:119]
s_waitcnt lgkmcnt(6)
v_mfma_f32_16x16x32_bf16 v[104:107], a[136:139], v[24:27], v[104:107]
ds_read_b64 v[40:41], v2 offset:17408
ds_read_b64 v[42:43], v2 offset:17920
ds_read_b64 v[44:45], v2 offset:37888
ds_read_b64 v[46:47], v2 offset:38400
s_waitcnt lgkmcnt(8)
v_mfma_f32_16x16x32_bf16 v[108:111], a[136:139], v[28:31], v[108:111]
ds_read_b64 v[48:49], v2 offset:58368
ds_read_b64 v[50:51], v2 offset:58880
ds_read_b64 v[52:53], v239 offset:17408
ds_read_b64 v[54:55], v239 offset:17920
s_waitcnt lgkmcnt(10)
v_mfma_f32_16x16x32_bf16 v[112:115], a[136:139], v[32:35], v[112:115]
s_waitcnt lgkmcnt(8)
v_mfma_f32_16x16x32_bf16 v[116:119], a[136:139], v[36:39], v[116:119]
s_waitcnt lgkmcnt(6)
v_mfma_f32_16x16x32_bf16 v[104:107], a[140:143], v[40:43], v[104:107]
ds_read_b64 v[24:25], v2 offset:18432
ds_read_b64 v[26:27], v2 offset:18944
ds_read_b64 v[28:29], v2 offset:38912
ds_read_b64 v[30:31], v2 offset:39424
s_waitcnt lgkmcnt(8)
v_mfma_f32_16x16x32_bf16 v[108:111], a[140:143], v[44:47], v[108:111]
ds_read_b64 v[32:33], v2 offset:59392
ds_read_b64 v[34:35], v2 offset:59904
ds_read_b64 v[36:37], v239 offset:18432
ds_read_b64 v[38:39], v239 offset:18944
s_waitcnt lgkmcnt(10)
v_mfma_f32_16x16x32_bf16 v[112:115], a[140:143], v[48:51], v[112:115]
s_waitcnt lgkmcnt(8)
v_mfma_f32_16x16x32_bf16 v[116:119], a[140:143], v[52:55], v[116:119]
s_waitcnt lgkmcnt(6)
v_mfma_f32_16x16x32_bf16 v[104:107], a[252:255], v[24:27], v[104:107]
ds_read_b64 v[40:41], v2 offset:19456
ds_read_b64 v[42:43], v2 offset:19968
ds_read_b64 v[44:45], v2 offset:39936
ds_read_b64 v[46:47], v2 offset:40448
s_waitcnt lgkmcnt(8)
v_mfma_f32_16x16x32_bf16 v[108:111], a[252:255], v[28:31], v[108:111]
ds_read_b64 v[48:49], v2 offset:60416
ds_read_b64 v[50:51], v2 offset:60928
ds_read_b64 v[52:53], v239 offset:19456
ds_read_b64 v[54:55], v239 offset:19968
s_waitcnt lgkmcnt(10)
v_mfma_f32_16x16x32_bf16 v[112:115], a[252:255], v[32:35], v[112:115]
s_waitcnt lgkmcnt(8)
v_mfma_f32_16x16x32_bf16 v[116:119], a[252:255], v[36:39], v[116:119]
s_waitcnt lgkmcnt(6)
v_mfma_f32_16x16x32_bf16 v[104:107], a[76:79], v[40:43], v[104:107]
s_waitcnt lgkmcnt(4)
v_mfma_f32_16x16x32_bf16 v[108:111], a[76:79], v[44:47], v[108:111]
s_waitcnt lgkmcnt(2)
v_mfma_f32_16x16x32_bf16 v[112:115], a[76:79], v[48:51], v[112:115]
s_waitcnt lgkmcnt(0)
v_mfma_f32_16x16x32_bf16 v[116:119], a[76:79], v[52:55], v[116:119]
s_mov_b32 s24, 0x3ea52b5c
v_mul_f32 v140, s24, v140
v_mul_f32 v141, s24, v141
v_mul_f32 v142, s24, v142
v_mul_f32 v143, s24, v143
v_pk_fma_f32 v[104:105], v[180:181], v[136:137], v[104:105] op_sel:[0,0,0] op_sel_hi:[1,0,1]
v_pk_fma_f32 v[106:107], v[182:183], v[136:137], v[106:107] op_sel:[0,0,0] op_sel_hi:[1,0,1]
v_pk_mul_f32 v[104:105], v[104:105], v[140:141] op_sel:[0,0] op_sel_hi:[1,0]
v_pk_mul_f32 v[106:107], v[106:107], v[140:141] op_sel:[0,0] op_sel_hi:[1,0]
v_cvt_pk_bf16_f32 v200, v104, v105
v_cvt_pk_bf16_f32 v201, v106, v107
v_pk_fma_f32 v[108:109], v[180:181], v[136:137], v[108:109] op_sel:[0,1,0] op_sel_hi:[1,1,1]
v_pk_fma_f32 v[110:111], v[182:183], v[136:137], v[110:111] op_sel:[0,1,0] op_sel_hi:[1,1,1]
v_pk_mul_f32 v[108:109], v[108:109], v[140:141] op_sel:[0,1] op_sel_hi:[1,1]
v_pk_mul_f32 v[110:111], v[110:111], v[140:141] op_sel:[0,1] op_sel_hi:[1,1]
v_cvt_pk_bf16_f32 v204, v108, v109
v_cvt_pk_bf16_f32 v205, v110, v111
v_pk_fma_f32 v[112:113], v[180:181], v[138:139], v[112:113] op_sel:[0,0,0] op_sel_hi:[1,0,1]
v_pk_fma_f32 v[114:115], v[182:183], v[138:139], v[114:115] op_sel:[0,0,0] op_sel_hi:[1,0,1]
v_pk_mul_f32 v[112:113], v[112:113], v[142:143] op_sel:[0,0] op_sel_hi:[1,0]
v_pk_mul_f32 v[114:115], v[114:115], v[142:143] op_sel:[0,0] op_sel_hi:[1,0]
v_cvt_pk_bf16_f32 v208, v112, v113
v_cvt_pk_bf16_f32 v209, v114, v115
v_pk_fma_f32 v[116:117], v[180:181], v[138:139], v[116:117] op_sel:[0,1,0] op_sel_hi:[1,1,1]
v_pk_fma_f32 v[118:119], v[182:183], v[138:139], v[118:119] op_sel:[0,1,0] op_sel_hi:[1,1,1]
v_pk_mul_f32 v[116:117], v[116:117], v[142:143] op_sel:[0,1] op_sel_hi:[1,1]
v_pk_mul_f32 v[118:119], v[118:119], v[142:143] op_sel:[0,1] op_sel_hi:[1,1]
v_cvt_pk_bf16_f32 v212, v116, v117
v_cvt_pk_bf16_f32 v213, v118, v119
s_nop 7
s_branch FE79
FK83:
s_mul_i32 s24, s21, 960
s_lshl_b32 s25, s22, 6
s_add_u32 s24, s24, s25
s_add_u32 s24, s24, 7700480
v_lshlrev_b32 v3, 4, v240
v_lshlrev_b32 v192, 2, v241
buffer_load_dwordx4 v[176:179], v3, s[4:7], s24 offen
buffer_load_dwordx4 v[180:183], v3, s[4:7], s24 offen offset:512
buffer_load_dword v188, v192, s[4:7], s24 offen offset:256
s_mov_b32 s24, 30000
PL90:
buffer_load_dword v3, v236, s[4:7], 0 offen sc1
s_waitcnt vmcnt(0)
v_cmp_gt_u32 vcc, 5, v3
s_sub_u32 s24, s24, 1
s_cbranch_scc1 PD91
s_cbranch_vccnz PL90
PD91:
s_lshl_b32 s26, s60, 9
s_and_b32 s26, s26, 0xfffff000
s_lshl_b32 s27, s22, 7
s_add_u32 s26, s26, s27
s_add_u32 s26, s26, 13230080
v_lshrrev_b32 v24, 3, v0
v_lshlrev_b32 v24, 9, v24
v_and_b32 v25, 7, v0
v_lshlrev_b32 v25, 4, v25
v_add_u32 v24, v24, v25
buffer_load_dwordx4 v[28:31], v24, s[4:7], s26 offen
s_mul_i32 s69, s62, 20480
s_add_u32 s69, s69, 10346496
s_mul_i32 s70, s22, 20480
s_mov_b32 m0, s70
s_nop 0
buffer_load_dwordx4 v1, s[4:7], s69 offen offset:0 sc1 lds
s_mov_b32 m0, s70
s_nop 0
buffer_load_dwordx4 v1, s[4:7], s69 offen offset:1024 sc1 lds
s_mov_b32 m0, s70
s_nop 0
buffer_load_dwordx4 v1, s[4:7], s69 offen offset:2048 sc1 lds
s_mov_b32 m0, s70
s_nop 0
buffer_load_dwordx4 v1, s[4:7], s69 offen offset:3072 sc1 lds
s_add_u32 s69, s69, 4096
s_add_u32 s70, s70, 4096
s_mov_b32 m0, s70
s_nop 0
buffer_load_dwordx4 v1, s[4:7], s69 offen offset:0 sc1 lds
s_mov_b32 m0, s70
s_nop 0
buffer_load_dwordx4 v1, s[4:7], s69 offen offset:1024 sc1 lds
s_mov_b32 m0, s70
s_nop 0
buffer_load_dwordx4 v1, s[4:7], s69 offen offset:2048 sc1 lds
s_mov_b32 m0, s70
s_nop 0
buffer_load_dwordx4 v1, s[4:7], s69 offen offset:3072 sc1 lds
s_add_u32 s69, s69, 4096
s_add_u32 s70, s70, 4096
s_mov_b32 m0, s70
s_nop 0
buffer_load_dwordx4 v1, s[4:7], s69 offen offset:0 sc1 lds
s_mov_b32 m0, s70
s_nop 0
buffer_load_dwordx4 v1, s[4:7], s69 offen offset:1024 sc1 lds
s_waitcnt vmcnt(10)
v_mov_b32 v32, v28
v_mov_b32 v33, v29
v_mov_b32 v34, v30
v_mov_b32 v35, v31
v_permlane32_swap_b32 v28, v32
v_permlane32_swap_b32 v29, v33
v_permlane32_swap_b32 v30, v34
v_permlane32_swap_b32 v31, v35
v_add_f32 v28, v28, v32
v_add_f32 v29, v29, v33
v_add_f32 v30, v30, v34
v_add_f32 v31, v31, v35
v_mov_b32 v32, v28
v_mov_b32 v33, v29
v_mov_b32 v34, v30
v_mov_b32 v35, v31
v_permlane16_swap_b32 v28, v32
v_permlane16_swap_b32 v29, v33
v_permlane16_swap_b32 v30, v34
v_permlane16_swap_b32 v31, v35
v_add_f32 v28, v28, v32
v_add_f32 v29, v29, v33
v_add_f32 v30, v30, v34
v_add_f32 v31, v31, v35
v_add_f32_dpp v28, v28, v28 row_ror:8 row_mask:0xf bank_mask:0xf
v_add_f32_dpp v29, v29, v29 row_ror:8 row_mask:0xf bank_mask:0xf
v_add_f32_dpp v30, v30, v30 row_ror:8 row_mask:0xf bank_mask:0xf
v_add_f32_dpp v31, v31, v31 row_ror:8 row_mask:0xf bank_mask:0xf
s_mov_b32 s26, 0xbacccccd
s_mov_b32 s27, 0x3acccccd
v_mul_f32 v32, s26, v28
v_mul_f32 v33, s26, v30
v_mul_f32 v34, s27, v29
v_mul_f32 v35, s27, v31
v_fma_f32 v34, -v32, v32, v34
v_fma_f32 v35, -v33, v33, v35
v_max_f32 v34, 0, v34
v_max_f32 v35, 0, v35
v_add_f32 v34, 0x3727c5ac, v34
v_add_f32 v35, 0x3727c5ac, v35
v_rsq_f32 v34, v34
v_rsq_f32 v35, v35
v_and_b32 v24, 7, v0
v_lshlrev_b32 v24, 3, v24
s_lshl_b32 s26, s22, 6
s_add_u32 s26, s26, 102400
v_add_u32 v24, s26, v24
s_mov_b64 exec, 0xff
ds_write_b64 v24, v[32:33]
ds_write_b64 v24, v[34:35] offset:256
s_mov_b64 exec, -1
s_waitcnt vmcnt(5)
s_waitcnt lgkmcnt(0)
s_barrier
ds_read_b128 v[24:27], v1 offset:0
ds_read_b128 v[28:31], v1 offset:20480
ds_read_b128 v[32:35], v1 offset:40960
ds_read_b128 v[36:39], v238 offset:0
s_waitcnt lgkmcnt(3)
v_mfma_f32_16x16x32_bf16 v[56:59], a[212:215], v[24:27], 0
ds_read_b128 v[40:43], v1 offset:1024
s_waitcnt lgkmcnt(3)
v_mfma_f32_16x16x32_bf16 v[60:63], a[212:215], v[28:31], 0
ds_read_b128 v[44:47], v1 offset:21504
s_waitcnt lgkmcnt(3)
v_mfma_f32_16x16x32_bf16 v[64:67], a[212:215], v[32:35], 0
ds_read_b128 v[48:51], v1 offset:41984
s_waitcnt lgkmcnt(3)
v_mfma_f32_16x16x32_bf16 v[68:71], a[212:215], v[36:39], 0
ds_read_b128 v[52:55], v238 offset:1024
v_mfma_f32_16x16x32_bf16 v[72:75], v[24:27], a[104:107], 0
s_mov_b32 m0, s70
s_nop 0
buffer_load_dwordx4 v1, s[4:7], s69 offen offset:2048 sc1 lds
v_mfma_f32_16x16x32_bf16 v[76:79], v[28:31], a[104:107], 0
s_add_u32 s40, s40, 4096
buffer_load_dwordx4 a[176:179], v1, s[4:7], s40 offen
v_mfma_f32_16x16x32_bf16 v[80:83], v[32:35], a[104:107], 0
s_add_u32 s41, s41, 4096
buffer_load_dwordx4 a[164:167], v1, s[4:7], s41 offen
v_mfma_f32_16x16x32_bf16 v[84:87], v[36:39], a[104:107], 0
buffer_load_dwordx4 a[244:247], v1, s[4:7], s40 offen offset:1024
s_waitcnt lgkmcnt(3)
v_mfma_f32_16x16x32_bf16 v[56:59], a[108:111], v[40:43], v[56:59]
ds_read_b128 v[24:27], v1 offset:2048
s_waitcnt lgkmcnt(3)
v_mfma_f32_16x16x32_bf16 v[60:63], a[108:111], v[44:47], v[60:63]
ds_read_b128 v[28:31], v1 offset:22528
s_waitcnt lgkmcnt(3)
v_mfma_f32_16x16x32_bf16 v[64:67], a[108:111], v[48:51], v[64:67]
ds_read_b128 v[32:35], v1 offset:43008
s_waitcnt lgkmcnt(3)
v_mfma_f32_16x16x32_bf16 v[68:71], a[108:111], v[52:55], v[68:71]
ds_read_b128 v[36:39], v238 offset:2048
v_mfma_f32_16x16x32_bf16 v[72:75], v[40:43], a[112:115], v[72:75]
s_mov_b32 m0, s70
s_nop 0
buffer_load_dwordx4 v1, s[4:7], s69 offen offset:3072 sc1 lds
v_mfma_f32_16x16x32_bf16 v[76:79], v[44:47], a[112:115], v[76:79]
buffer_load_dwordx4 a[248:251], v1, s[4:7], s41 offen offset:1024
v_mfma_f32_16x16x32_bf16 v[80:83], v[48:51], a[112:115], v[80:83]
buffer_load_dwordx4 a[252:255], v1, s[4:7], s40 offen offset:2048
v_mfma_f32_16x16x32_bf16 v[84:87], v[52:55], a[112:115], v[84:87]
buffer_load_dwordx4 a[20:23], v1, s[4:7], s41 offen offset:2048
s_waitcnt lgkmcnt(3)
v_mfma_f32_16x16x32_bf16 v[56:59], a[68:71], v[24:27], v[56:59]
ds_read_b128 v[40:43], v1 offset:3072
s_waitcnt lgkmcnt(3)
v_mfma_f32_16x16x32_bf16 v[60:63], a[68:71], v[28:31], v[60:63]
ds_read_b128 v[44:47], v1 offset:23552
s_waitcnt lgkmcnt(3)
v_mfma_f32_16x16x32_bf16 v[64:67], a[68:71], v[32:35], v[64:67]
ds_read_b128 v[48:51], v1 offset:44032
s_waitcnt lgkmcnt(3)
v_mfma_f32_16x16x32_bf16 v[68:71], a[68:71], v[36:39], v[68:71]
ds_read_b128 v[52:55], v238 offset:3072
v_mfma_f32_16x16x32_bf16 v[72:75], v[24:27], a[72:75], v[72:75]
s_add_u32 s69, s69, 4096
s_add_u32 s70, s70, 4096
s_mov_b32 m0, s70
s_nop 0
buffer_load_dwordx4 v1, s[4:7], s69 offen offset:0 sc1 lds
v_mfma_f32_16x16x32_bf16 v[76:79], v[28:31], a[72:75], v[76:79]
buffer_load_dwordx4 a[24:27], v1, s[4:7], s40 offen offset:3072
v_mfma_f32_16x16x32_bf16 v[80:83], v[32:35], a[72:75], v[80:83]
buffer_load_dwordx4 a[184:187], v1, s[4:7], s41 offen offset:3072
v_mfma_f32_16x16x32_bf16 v[84:87], v[36:39], a[72:75], v[84:87]
buffer_load_dwordx4 a[188:191], v1, s[4:7], s42 offen
s_waitcnt lgkmcnt(3)
v_mfma_f32_16x16x32_bf16 v[56:59], a[216:219], v[40:43], v[56:59]
ds_read_b128 v[24:27], v1 offset:4096
s_waitcnt lgkmcnt(3)
v_mfma_f32_16x16x32_bf16 v[60:63], a[216:219], v[44:47], v[60:63]
ds_read_b128 v[28:31], v1 offset:24576
s_waitcnt lgkmcnt(3)
v_mfma_f32_16x16x32_bf16 v[64:67], a[216:219], v[48:51], v[64:67]
ds_read_b128 v[32:35], v1 offset:45056
s_waitcnt lgkmcnt(3)
v_mfma_f32_16x16x32_bf16 v[68:71], a[216:219], v[52:55], v[68:71]
ds_read_b128 v[36:39], v238 offset:4096
v_mfma_f32_16x16x32_bf16 v[72:75], v[40:43], a[220:223], v[72:75]
s_mov_b32 m0, s70
s_nop 0
buffer_load_dwordx4 v1, s[4:7], s69 offen offset:1024 sc1 lds
v_mfma_f32_16x16x32_bf16 v[76:79], v[44:47], a[220:223], v[76:79]
buffer_load_dwordx4 a[192:195], v1, s[4:7], s42 offen offset:1024
v_mfma_f32_16x16x32_bf16 v[80:83], v[48:51], a[220:223], v[80:83]
buffer_load_dwordx4 a[180:183], v1, s[4:7], s42 offen offset:2048
v_mfma_f32_16x16x32_bf16 v[84:87], v[52:55], a[220:223], v[84:87]
buffer_load_dwordx4 a[8:11], v1, s[4:7], s42 offen offset:3072
s_waitcnt vmcnt(16)
s_barrier
s_waitcnt lgkmcnt(3)
v_mfma_f32_16x16x32_bf16 v[56:59], a[136:139], v[24:27], v[56:59]
ds_read_b128 v[40:43], v1 offset:5120
s_waitcnt lgkmcnt(3)
v_mfma_f32_16x16x32_bf16 v[60:63], a[136:139], v[28:31], v[60:63]
ds_read_b128 v[44:47], v1 offset:25600
s_waitcnt lgkmcnt(3)
v_mfma_f32_16x16x32_bf16 v[64:67], a[136:139], v[32:35], v[64:67]
ds_read_b128 v[48:51], v1 offset:46080
s_waitcnt lgkmcnt(3)
v_mfma_f32_16x16x32_bf16 v[68:71], a[136:139], v[36:39], v[68:71]
ds_read_b128 v[52:55], v238 offset:5120
v_mfma_f32_16x16x32_bf16 v[72:75], v[24:27], a[140:143], v[72:75]
s_mov_b32 m0, s70
s_nop 0
buffer_load_dwordx4 v1, s[4:7], s69 offen offset:2048 sc1 lds
v_mfma_f32_16x16x32_bf16 v[76:79], v[28:31], a[140:143], v[76:79]
s_add_u32 s42, s42, 4096
buffer_load_dwordx4 a[12:15], v1, s[4:7], s42 offen
v_mfma_f32_16x16x32_bf16 v[80:83], v[32:35], a[140:143], v[80:83]
buffer_load_dwordx4 a[16:19], v1, s[4:7], s42 offen offset:1024
v_mfma_f32_16x16x32_bf16 v[84:87], v[36:39], a[140:143], v[84:87]
buffer_load_dwordx4 a[40:43], v1, s[4:7], s42 offen offset:2048
s_waitcnt lgkmcnt(3)
v_mfma_f32_16x16x32_bf16 v[56:59], a[76:79], v[40:43], v[56:59]
ds_read_b128 v[24:27], v1 offset:6144
s_waitcnt lgkmcnt(3)
v_mfma_f32_16x16x32_bf16 v[60:63], a[76:79], v[44:47], v[60:63]
ds_read_b128 v[28:31], v1 offset:26624
s_waitcnt lgkmcnt(3)
v_mfma_f32_16x16x32_bf16 v[64:67], a[76:79], v[48:51], v[64:67]
ds_read_b128 v[32:35], v1 offset:47104
s_waitcnt lgkmcnt(3)
v_mfma_f32_16x16x32_bf16 v[68:71], a[76:79], v[52:55], v[68:71]
ds_read_b128 v[36:39], v238 offset:6144
v_mfma_f32_16x16x32_bf16 v[72:75], v[40:43], a[80:83], v[72:75]
s_mov_b32 m0, s70
s_nop 0
buffer_load_dwordx4 v1, s[4:7], s69 offen offset:3072 sc1 lds
v_mfma_f32_16x16x32_bf16 v[76:79], v[44:47], a[80:83], v[76:79]
buffer_load_dwordx4 a[44:47], v1, s[4:7], s42 offen offset:3072
v_mfma_f32_16x16x32_bf16 v[80:83], v[48:51], a[80:83], v[80:83]
s_add_u32 s42, s42, 4096
buffer_load_dwordx4 a[200:203], v1, s[4:7], s42 offen
v_mfma_f32_16x16x32_bf16 v[84:87], v[52:55], a[80:83], v[84:87]
buffer_load_dwordx4 a[120:123], v1, s[4:7], s42 offen offset:1024
s_waitcnt lgkmcnt(3)
v_mfma_f32_16x16x32_bf16 v[56:59], a[84:87], v[24:27], v[56:59]
ds_read_b128 v[40:43], v1 offset:7168
s_waitcnt lgkmcnt(3)
v_mfma_f32_16x16x32_bf16 v[60:63], a[84:87], v[28:31], v[60:63]
ds_read_b128 v[44:47], v1 offset:27648
s_waitcnt lgkmcnt(3)
v_mfma_f32_16x16x32_bf16 v[64:67], a[84:87], v[32:35], v[64:67]
ds_read_b128 v[48:51], v1 offset:48128
s_waitcnt lgkmcnt(3)
v_mfma_f32_16x16x32_bf16 v[68:71], a[84:87], v[36:39], v[68:71]
ds_read_b128 v[52:55], v238 offset:7168
v_mfma_f32_16x16x32_bf16 v[72:75], v[24:27], a[88:91], v[72:75]
s_add_u32 s69, s69, 4096
s_add_u32 s70, s70, 4096
s_mov_b32 m0, s70
s_nop 0
buffer_load_dwordx4 v1, s[4:7], s69 offen offset:0 sc1 lds
v_mfma_f32_16x16x32_bf16 v[76:79], v[28:31], a[88:91], v[76:79]
buffer_load_dwordx4 a[124:127], v1, s[4:7], s42 offen offset:2048
v_mfma_f32_16x16x32_bf16 v[80:83], v[32:35], a[88:91], v[80:83]
buffer_load_dwordx4 a[196:199], v1, s[4:7], s42 offen offset:3072
v_mfma_f32_16x16x32_bf16 v[84:87], v[36:39], a[88:91], v[84:87]
s_add_u32 s42, s42, 4096
buffer_load_dwordx4 a[28:31], v1, s[4:7], s42 offen
s_waitcnt lgkmcnt(3)
v_mfma_f32_16x16x32_bf16 v[56:59], a[92:95], v[40:43], v[56:59]
ds_read_b128 v[24:27], v1 offset:8192
s_waitcnt lgkmcnt(3)
v_mfma_f32_16x16x32_bf16 v[60:63], a[92:95], v[44:47], v[60:63]
ds_read_b128 v[28:31], v1 offset:28672
s_waitcnt lgkmcnt(3)
v_mfma_f32_16x16x32_bf16 v[64:67], a[92:95], v[48:51], v[64:67]
ds_read_b128 v[32:35], v1 offset:49152
s_waitcnt lgkmcnt(3)
v_mfma_f32_16x16x32_bf16 v[68:71], a[92:95], v[52:55], v[68:71]
ds_read_b128 v[36:39], v238 offset:8192
v_mfma_f32_16x16x32_bf16 v[72:75], v[40:43], a[144:147], v[72:75]
s_mov_b32 m0, s70
s_nop 0
buffer_load_dwordx4 v1, s[4:7], s69 offen offset:1024 sc1 lds
v_mfma_f32_16x16x32_bf16 v[76:79], v[44:47], a[144:147], v[76:79]
buffer_load_dwordx4 a[32:35], v1, s[4:7], s42 offen offset:1024
v_mfma_f32_16x16x32_bf16 v[80:83], v[48:51], a[144:147], v[80:83]
buffer_load_dwordx4 a[36:39], v1, s[4:7], s42 offen offset:2048
v_mfma_f32_16x16x32_bf16 v[84:87], v[52:55], a[144:147], v[84:87]
buffer_load_dwordx4 a[60:63], v1, s[4:7], s42 offen offset:3072
s_waitcnt lgkmcnt(3)
v_mfma_f32_16x16x32_bf16 v[56:59], a[148:151], v[24:27], v[56:59]
ds_read_b128 v[40:43], v1 offset:9216
s_waitcnt lgkmcnt(3)
v_mfma_f32_16x16x32_bf16 v[60:63], a[148:151], v[28:31], v[60:63]
ds_read_b128 v[44:47], v1 offset:29696
s_waitcnt lgkmcnt(3)
v_mfma_f32_16x16x32_bf16 v[64:67], a[148:151], v[32:35], v[64:67]
ds_read_b128 v[48:51], v1 offset:50176
s_waitcnt lgkmcnt(3)
v_mfma_f32_16x16x32_bf16 v[68:71], a[148:151], v[36:39], v[68:71]
ds_read_b128 v[52:55], v238 offset:9216
v_mfma_f32_16x16x32_bf16 v[72:75], v[24:27], a[224:227], v[72:75]
s_mov_b32 m0, s70
s_nop 0
buffer_load_dwordx4 v1, s[4:7], s69 offen offset:2048 sc1 lds
v_mfma_f32_16x16x32_bf16 v[76:79], v[28:31], a[224:227], v[76:79]
s_add_u32 s42, s42, 4096
buffer_load_dwordx4 a[64:67], v1, s[4:7], s42 offen
v_mfma_f32_16x16x32_bf16 v[80:83], v[32:35], a[224:227], v[80:83]
buffer_load_dwordx4 a[132:135], v1, s[4:7], s42 offen offset:1024
v_mfma_f32_16x16x32_bf16 v[84:87], v[36:39], a[224:227], v[84:87]
buffer_load_dwordx4 a[204:207], v1, s[4:7], s42 offen offset:2048
s_waitcnt vmcnt(19)
s_barrier
s_waitcnt lgkmcnt(3)
v_mfma_f32_16x16x32_bf16 v[56:59], a[228:231], v[40:43], v[56:59]
ds_read_b128 v[24:27], v1 offset:10240
s_waitcnt lgkmcnt(3)
v_mfma_f32_16x16x32_bf16 v[60:63], a[228:231], v[44:47], v[60:63]
ds_read_b128 v[28:31], v1 offset:30720
s_waitcnt lgkmcnt(3)
v_mfma_f32_16x16x32_bf16 v[64:67], a[228:231], v[48:51], v[64:67]
ds_read_b128 v[32:35], v1 offset:51200
s_waitcnt lgkmcnt(3)
v_mfma_f32_16x16x32_bf16 v[68:71], a[228:231], v[52:55], v[68:71]
ds_read_b128 v[36:39], v238 offset:10240
v_mfma_f32_16x16x32_bf16 v[72:75], v[40:43], a[96:99], v[72:75]
s_mov_b32 m0, s70
s_nop 0
buffer_load_dwordx4 v1, s[4:7], s69 offen offset:3072 sc1 lds
v_mfma_f32_16x16x32_bf16 v[76:79], v[44:47], a[96:99], v[76:79]
buffer_load_dwordx4 a[208:211], v1, s[4:7], s42 offen offset:3072
v_mfma_f32_16x16x32_bf16 v[80:83], v[48:51], a[96:99], v[80:83]
v_mfma_f32_16x16x32_bf16 v[84:87], v[52:55], a[96:99], v[84:87]
s_waitcnt lgkmcnt(3)
v_mfma_f32_16x16x32_bf16 v[56:59], a[100:103], v[24:27], v[56:59]
ds_read_b128 v[40:43], v1 offset:11264
s_waitcnt lgkmcnt(3)
v_mfma_f32_16x16x32_bf16 v[60:63], a[100:103], v[28:31], v[60:63]
ds_read_b128 v[44:47], v1 offset:31744
s_waitcnt lgkmcnt(3)
v_mfma_f32_16x16x32_bf16 v[64:67], a[100:103], v[32:35], v[64:67]
ds_read_b128 v[48:51], v1 offset:52224
s_waitcnt lgkmcnt(3)
v_mfma_f32_16x16x32_bf16 v[68:71], a[100:103], v[36:39], v[68:71]
ds_read_b128 v[52:55], v238 offset:11264
v_mfma_f32_16x16x32_bf16 v[72:75], v[24:27], a[116:119], v[72:75]
v_mfma_f32_16x16x32_bf16 v[76:79], v[28:31], a[116:119], v[76:79]
v_mfma_f32_16x16x32_bf16 v[80:83], v[32:35], a[116:119], v[80:83]
v_mfma_f32_16x16x32_bf16 v[84:87], v[36:39], a[116:119], v[84:87]
s_waitcnt lgkmcnt(3)
v_mfma_f32_16x16x32_bf16 v[56:59], a[156:159], v[40:43], v[56:59]
ds_read_b128 v[24:27], v1 offset:12288
s_waitcnt lgkmcnt(3)
v_mfma_f32_16x16x32_bf16 v[60:63], a[156:159], v[44:47], v[60:63]
ds_read_b128 v[28:31], v1 offset:32768
s_waitcnt lgkmcnt(3)
v_mfma_f32_16x16x32_bf16 v[64:67], a[156:159], v[48:51], v[64:67]
ds_read_b128 v[32:35], v1 offset:53248
s_waitcnt lgkmcnt(3)
v_mfma_f32_16x16x32_bf16 v[68:71], a[156:159], v[52:55], v[68:71]
ds_read_b128 v[36:39], v238 offset:12288
v_mfma_f32_16x16x32_bf16 v[72:75], v[40:43], a[160:163], v[72:75]
v_mfma_f32_16x16x32_bf16 v[76:79], v[44:47], a[160:163], v[76:79]
v_mfma_f32_16x16x32_bf16 v[80:83], v[48:51], a[160:163], v[80:83]
v_mfma_f32_16x16x32_bf16 v[84:87], v[52:55], a[160:163], v[84:87]
s_waitcnt lgkmcnt(3)
v_mfma_f32_16x16x32_bf16 v[56:59], a[232:235], v[24:27], v[56:59]
ds_read_b128 v[40:43], v1 offset:13312
s_waitcnt lgkmcnt(3)
v_mfma_f32_16x16x32_bf16 v[60:63], a[232:235], v[28:31], v[60:63]
ds_read_b128 v[44:47], v1 offset:33792
s_waitcnt lgkmcnt(3)
v_mfma_f32_16x16x32_bf16 v[64:67], a[232:235], v[32:35], v[64:67]
ds_read_b128 v[48:51], v1 offset:54272
s_waitcnt lgkmcnt(3)
v_mfma_f32_16x16x32_bf16 v[68:71], a[232:235], v[36:39], v[68:71]
ds_read_b128 v[52:55], v238 offset:13312
v_mfma_f32_16x16x32_bf16 v[72:75], v[24:27], a[236:239], v[72:75]
v_mfma_f32_16x16x32_bf16 v[76:79], v[28:31], a[236:239], v[76:79]
v_mfma_f32_16x16x32_bf16 v[80:83], v[32:35], a[236:239], v[80:83]
v_mfma_f32_16x16x32_bf16 v[84:87], v[36:39], a[236:239], v[84:87]
s_waitcnt lgkmcnt(3)
v_mfma_f32_16x16x32_bf16 v[56:59], a[240:243], v[40:43], v[56:59]
ds_read_b128 v[24:27], v1 offset:14336
s_waitcnt lgkmcnt(3)
v_mfma_f32_16x16x32_bf16 v[60:63], a[240:243], v[44:47], v[60:63]
ds_read_b128 v[28:31], v1 offset:34816
s_waitcnt lgkmcnt(3)
v_mfma_f32_16x16x32_bf16 v[64:67], a[240:243], v[48:51], v[64:67]
ds_read_b128 v[32:35], v1 offset:55296
s_waitcnt lgkmcnt(3)
v_mfma_f32_16x16x32_bf16 v[68:71], a[240:243], v[52:55], v[68:71]
ds_read_b128 v[36:39], v238 offset:14336
v_mfma_f32_16x16x32_bf16 v[72:75], v[40:43], a[152:155], v[72:75]
v_mfma_f32_16x16x32_bf16 v[76:79], v[44:47], a[152:155], v[76:79]
v_mfma_f32_16x16x32_bf16 v[80:83], v[48:51], a[152:155], v[80:83]
v_mfma_f32_16x16x32_bf16 v[84:87], v[52:55], a[152:155], v[84:87]
s_waitcnt vmcnt(1)
s_barrier
s_waitcnt lgkmcnt(3)
v_mfma_f32_16x16x32_bf16 v[56:59], a[0:3], v[24:27], v[56:59]
ds_read_b128 v[40:43], v1 offset:15360
s_waitcnt lgkmcnt(3)
v_mfma_f32_16x16x32_bf16 v[60:63], a[0:3], v[28:31], v[60:63]
ds_read_b128 v[44:47], v1 offset:35840
s_waitcnt lgkmcnt(3)
v_mfma_f32_16x16x32_bf16 v[64:67], a[0:3], v[32:35], v[64:67]
ds_read_b128 v[48:51], v1 offset:56320
s_waitcnt lgkmcnt(3)
v_mfma_f32_16x16x32_bf16 v[68:71], a[0:3], v[36:39], v[68:71]
ds_read_b128 v[52:55], v238 offset:15360
v_mfma_f32_16x16x32_bf16 v[72:75], v[24:27], a[4:7], v[72:75]
v_mfma_f32_16x16x32_bf16 v[76:79], v[28:31], a[4:7], v[76:79]
v_mfma_f32_16x16x32_bf16 v[80:83], v[32:35], a[4:7], v[80:83]
v_mfma_f32_16x16x32_bf16 v[84:87], v[36:39], a[4:7], v[84:87]
s_waitcnt lgkmcnt(3)
v_mfma_f32_16x16x32_bf16 v[56:59], a[168:171], v[40:43], v[56:59]
ds_read_b64 v[24:25], v2 offset:16384
ds_read_b64 v[26:27], v2 offset:16896
s_waitcnt lgkmcnt(4)
v_mfma_f32_16x16x32_bf16 v[60:63], a[168:171], v[44:47], v[60:63]
ds_read_b64 v[28:29], v2 offset:36864
ds_read_b64 v[30:31], v2 offset:37376
s_waitcnt lgkmcnt(5)
v_mfma_f32_16x16x32_bf16 v[64:67], a[168:171], v[48:51], v[64:67]
ds_read_b64 v[32:33], v2 offset:57344
ds_read_b64 v[34:35], v2 offset:57856
s_waitcnt lgkmcnt(6)
v_mfma_f32_16x16x32_bf16 v[68:71], a[168:171], v[52:55], v[68:71]
ds_read_b64 v[36:37], v239 offset:16384
ds_read_b64 v[38:39], v239 offset:16896
v_mfma_f32_16x16x32_bf16 v[72:75], v[40:43], a[172:175], v[72:75]
v_mfma_f32_16x16x32_bf16 v[76:79], v[44:47], a[172:175], v[76:79]
v_mfma_f32_16x16x32_bf16 v[80:83], v[48:51], a[172:175], v[80:83]
v_mfma_f32_16x16x32_bf16 v[84:87], v[52:55], a[172:175], v[84:87]
s_waitcnt lgkmcnt(6)
v_mfma_f32_16x16x32_bf16 v[56:59], a[176:179], v[24:27], v[56:59]
ds_read_b64 v[40:41], v2 offset:17408
ds_read_b64 v[42:43], v2 offset:17920
s_waitcnt lgkmcnt(6)
v_mfma_f32_16x16x32_bf16 v[60:63], a[176:179], v[28:31], v[60:63]
ds_read_b64 v[44:45], v2 offset:37888
ds_read_b64 v[46:47], v2 offset:38400
s_waitcnt lgkmcnt(6)
v_mfma_f32_16x16x32_bf16 v[64:67], a[176:179], v[32:35], v[64:67]
ds_read_b64 v[48:49], v2 offset:58368
ds_read_b64 v[50:51], v2 offset:58880
s_waitcnt lgkmcnt(6)
v_mfma_f32_16x16x32_bf16 v[68:71], a[176:179], v[36:39], v[68:71]
ds_read_b64 v[52:53], v239 offset:17408
ds_read_b64 v[54:55], v239 offset:17920
v_mfma_f32_16x16x32_bf16 v[72:75], v[24:27], a[164:167], v[72:75]
v_mfma_f32_16x16x32_bf16 v[76:79], v[28:31], a[164:167], v[76:79]
v_mfma_f32_16x16x32_bf16 v[80:83], v[32:35], a[164:167], v[80:83]
v_mfma_f32_16x16x32_bf16 v[84:87], v[36:39], a[164:167], v[84:87]
s_waitcnt lgkmcnt(6)
v_mfma_f32_16x16x32_bf16 v[56:59], a[244:247], v[40:43], v[56:59]
ds_read_b64 v[24:25], v2 offset:18432
ds_read_b64 v[26:27], v2 offset:18944
s_waitcnt lgkmcnt(6)
v_mfma_f32_16x16x32_bf16 v[60:63], a[244:247], v[44:47], v[60:63]
ds_read_b64 v[28:29], v2 offset:38912
ds_read_b64 v[30:31], v2 offset:39424
s_waitcnt lgkmcnt(6)
v_mfma_f32_16x16x32_bf16 v[64:67], a[244:247], v[48:51], v[64:67]
ds_read_b64 v[32:33], v2 offset:59392
ds_read_b64 v[34:35], v2 offset:59904
s_waitcnt lgkmcnt(6)
v_mfma_f32_16x16x32_bf16 v[68:71], a[244:247], v[52:55], v[68:71]
ds_read_b64 v[36:37], v239 offset:18432
ds_read_b64 v[38:39], v239 offset:18944
v_mfma_f32_16x16x32_bf16 v[72:75], v[40:43], a[248:251], v[72:75]
v_mfma_f32_16x16x32_bf16 v[76:79], v[44:47], a[248:251], v[76:79]
v_mfma_f32_16x16x32_bf16 v[80:83], v[48:51], a[248:251], v[80:83]
v_mfma_f32_16x16x32_bf16 v[84:87], v[52:55], a[248:251], v[84:87]
s_waitcnt lgkmcnt(6)
v_mfma_f32_16x16x32_bf16 v[56:59], a[252:255], v[24:27], v[56:59]
ds_read_b64 v[40:41], v2 offset:19456
ds_read_b64 v[42:43], v2 offset:19968
s_waitcnt lgkmcnt(6)
v_mfma_f32_16x16x32_bf16 v[60:63], a[252:255], v[28:31], v[60:63]
ds_read_b64 v[44:45], v2 offset:39936
ds_read_b64 v[46:47], v2 offset:40448
s_waitcnt lgkmcnt(6)
v_mfma_f32_16x16x32_bf16 v[64:67], a[252:255], v[32:35], v[64:67]
ds_read_b64 v[48:49], v2 offset:60416
ds_read_b64 v[50:51], v2 offset:60928
s_waitcnt lgkmcnt(6)
v_mfma_f32_16x16x32_bf16 v[68:71], a[252:255], v[36:39], v[68:71]
ds_read_b64 v[52:53], v239 offset:19456
ds_read_b64 v[54:55], v239 offset:19968
v_mfma_f32_16x16x32_bf16 v[72:75], v[24:27], a[20:23], v[72:75]
v_mfma_f32_16x16x32_bf16 v[76:79], v[28:31], a[20:23], v[76:79]
v_mfma_f32_16x16x32_bf16 v[80:83], v[32:35], a[20:23], v[80:83]
v_mfma_f32_16x16x32_bf16 v[84:87], v[36:39], a[20:23], v[84:87]
s_waitcnt lgkmcnt(6)
v_mfma_f32_16x16x32_bf16 v[56:59], a[24:27], v[40:43], v[56:59]
s_waitcnt lgkmcnt(4)
v_mfma_f32_16x16x32_bf16 v[60:63], a[24:27], v[44:47], v[60:63]
s_waitcnt lgkmcnt(2)
v_mfma_f32_16x16x32_bf16 v[64:67], a[24:27], v[48:51], v[64:67]
s_waitcnt lgkmcnt(0)
v_mfma_f32_16x16x32_bf16 v[68:71], a[24:27], v[52:55], v[68:71]
v_mfma_f32_16x16x32_bf16 v[72:75], v[40:43], a[184:187], v[72:75]
v_mfma_f32_16x16x32_bf16 v[76:79], v[44:47], a[184:187], v[76:79]
v_mfma_f32_16x16x32_bf16 v[80:83], v[48:51], a[184:187], v[80:83]
v_mfma_f32_16x16x32_bf16 v[84:87], v[52:55], a[184:187], v[84:87]
v_lshlrev_b32 v3, 2, v241
v_add_u32 v3, 102400, v3
ds_read_b32 v136, v3 offset:0
ds_read_b32 v140, v3 offset:256
ds_read_b32 v137, v3 offset:64
ds_read_b32 v141, v3 offset:320
ds_read_b32 v138, v3 offset:128
ds_read_b32 v142, v3 offset:384
ds_read_b32 v139, v3 offset:192
ds_read_b32 v143, v3 offset:448
v_lshlrev_b32 v3, 4, v240
v_add_u32 v3, 102400, v3
ds_read_b128 v[144:147], v3 offset:0
ds_read_b128 v[160:163], v3 offset:256
ds_read_b128 v[148:151], v3 offset:64
ds_read_b128 v[164:167], v3 offset:320
ds_read_b128 v[152:155], v3 offset:128
ds_read_b128 v[168:171], v3 offset:384
ds_read_b128 v[156:159], v3 offset:192
ds_read_b128 v[172:175], v3 offset:448
s_waitcnt lgkmcnt(0)
s_lshl_b32 s24, s60, 14
s_add_u32 s24, s24, 17686528
s_lshl_b32 s25, s22, 12
s_add_u32 s25, s25, s24
s_mul_i32 s26, s60, 10240
s_add_u32 s26, s26, 24502272
s_lshl_b32 s27, s22, 11
s_add_u32 s27, s27, s26
s_add_u32 s26, s26, 8192
v_pk_fma_f32 v[72:73], v[144:145], v[188:189], v[72:73] op_sel:[0,0,0] op_sel_hi:[1,0,1]
v_pk_fma_f32 v[74:75], v[146:147], v[188:189], v[74:75] op_sel:[0,0,0] op_sel_hi:[1,0,1]
v_pk_mul_f32 v[72:73], v[72:73], v[160:161]
v_pk_mul_f32 v[74:75], v[74:75], v[162:163]
v_cvt_pk_bf16_f32 v48, v72, v73
v_cvt_pk_bf16_f32 v49, v74, v75
v_pk_fma_f32 v[76:77], v[148:149], v[188:189], v[76:77] op_sel:[0,0,0] op_sel_hi:[1,0,1]
v_pk_fma_f32 v[78:79], v[150:151], v[188:189], v[78:79] op_sel:[0,0,0] op_sel_hi:[1,0,1]
v_pk_mul_f32 v[76:77], v[76:77], v[164:165]
v_pk_mul_f32 v[78:79], v[78:79], v[166:167]
v_cvt_pk_bf16_f32 v50, v76, v77
v_cvt_pk_bf16_f32 v51, v78, v79
buffer_store_dwordx4 v[48:51], v1, s[4:7], s27 offen offset:0 sc1
v_pk_fma_f32 v[80:81], v[152:153], v[188:189], v[80:81] op_sel:[0,0,0] op_sel_hi:[1,0,1]
v_pk_fma_f32 v[82:83], v[154:155], v[188:189], v[82:83] op_sel:[0,0,0] op_sel_hi:[1,0,1]
v_pk_mul_f32 v[80:81], v[80:81], v[168:169]
v_pk_mul_f32 v[82:83], v[82:83], v[170:171]
v_cvt_pk_bf16_f32 v52, v80, v81
v_cvt_pk_bf16_f32 v53, v82, v83
v_pk_fma_f32 v[84:85], v[156:157], v[188:189], v[84:85] op_sel:[0,0,0] op_sel_hi:[1,0,1]
v_pk_fma_f32 v[86:87], v[158:159], v[188:189], v[86:87] op_sel:[0,0,0] op_sel_hi:[1,0,1]
v_pk_mul_f32 v[84:85], v[84:85], v[172:173]
v_pk_mul_f32 v[86:87], v[86:87], v[174:175]
v_cvt_pk_bf16_f32 v54, v84, v85
v_cvt_pk_bf16_f32 v55, v86, v87
buffer_store_dwordx4 v[52:55], v1, s[4:7], s27 offen offset:1024 sc1
v_pk_fma_f32 v[56:57], v[176:177], v[136:137], v[56:57] op_sel:[0,0,0] op_sel_hi:[1,0,1]
v_pk_fma_f32 v[58:59], v[178:179], v[136:137], v[58:59] op_sel:[0,0,0] op_sel_hi:[1,0,1]
v_pk_mul_f32 v[56:57], v[56:57], v[140:141] op_sel:[0,0] op_sel_hi:[1,0]
v_pk_mul_f32 v[58:59], v[58:59], v[140:141] op_sel:[0,0] op_sel_hi:[1,0]
v_cvt_pk_bf16_f32 v24, v56, v57
v_cvt_pk_bf16_f32 v25, v58, v59
v_pk_fma_f32 v[60:61], v[176:177], v[136:137], v[60:61] op_sel:[0,1,0] op_sel_hi:[1,1,1]
v_pk_fma_f32 v[62:63], v[178:179], v[136:137], v[62:63] op_sel:[0,1,0] op_sel_hi:[1,1,1]
v_pk_mul_f32 v[60:61], v[60:61], v[140:141] op_sel:[0,1] op_sel_hi:[1,1]
v_pk_mul_f32 v[62:63], v[62:63], v[140:141] op_sel:[0,1] op_sel_hi:[1,1]
v_cvt_pk_bf16_f32 v28, v60, v61
v_cvt_pk_bf16_f32 v29, v62, v63
v_pk_fma_f32 v[64:65], v[176:177], v[138:139], v[64:65] op_sel:[0,0,0] op_sel_hi:[1,0,1]
v_pk_fma_f32 v[66:67], v[178:179], v[138:139], v[66:67] op_sel:[0,0,0] op_sel_hi:[1,0,1]
v_pk_mul_f32 v[64:65], v[64:65], v[142:143] op_sel:[0,0] op_sel_hi:[1,0]
v_pk_mul_f32 v[66:67], v[66:67], v[142:143] op_sel:[0,0] op_sel_hi:[1,0]
v_cvt_pk_bf16_f32 v32, v64, v65
v_cvt_pk_bf16_f32 v33, v66, v67
v_pk_fma_f32 v[68:69], v[176:177], v[138:139], v[68:69] op_sel:[0,1,0] op_sel_hi:[1,1,1]
v_pk_fma_f32 v[70:71], v[178:179], v[138:139], v[70:71] op_sel:[0,1,0] op_sel_hi:[1,1,1]
v_pk_mul_f32 v[68:69], v[68:69], v[142:143] op_sel:[0,1] op_sel_hi:[1,1]
v_pk_mul_f32 v[70:71], v[70:71], v[142:143] op_sel:[0,1] op_sel_hi:[1,1]
v_cvt_pk_bf16_f32 v36, v68, v69
v_cvt_pk_bf16_f32 v37, v70, v71
s_waitcnt lgkmcnt(0)
s_barrier
ds_read_b64 v[26:27], v239 offset:44032
ds_read_b64 v[30:31], v239 offset:44544
ds_read_b64 v[34:35], v239 offset:45056
ds_read_b64 v[38:39], v239 offset:45568
ds_read_b64 v[202:203], v239 offset:41984
ds_read_b64 v[206:207], v239 offset:42496
ds_read_b64 v[210:211], v239 offset:43008
ds_read_b64 v[214:215], v239 offset:43520
s_waitcnt lgkmcnt(7)
buffer_store_dwordx4 v[24:27], v1, s[4:7], s25 offen offset:0 sc1
s_waitcnt lgkmcnt(6)
buffer_store_dwordx4 v[28:31], v1, s[4:7], s25 offen offset:1024 sc1
s_waitcnt lgkmcnt(5)
buffer_store_dwordx4 v[32:35], v1, s[4:7], s25 offen offset:2048 sc1
s_waitcnt lgkmcnt(4)
buffer_store_dwordx4 v[36:39], v1, s[4:7], s25 offen offset:3072 sc1
s_waitcnt lgkmcnt(0)
v_cmp_eq_u32 vcc, s22, v240
s_nop 1
v_cndmask_b32 v202, 0, v202, vcc
v_cndmask_b32 v203, 0, v203, vcc
v_cndmask_b32 v206, 0, v206, vcc
v_cndmask_b32 v207, 0, v207, vcc
v_cndmask_b32 v210, 0, v210, vcc
v_cndmask_b32 v211, 0, v211, vcc
v_cndmask_b32 v214, 0, v214, vcc
v_cndmask_b32 v215, 0, v215, vcc
s_waitcnt vmcnt(0)
v_mov_b32 v3, 6
s_mov_b64 exec, 1
buffer_store_dword v3, off, s[4:7], s23 sc1
s_mov_b64 exec, -1
ds_read_b128 v[24:27], v1 offset:0
ds_read_b128 v[28:31], v1 offset:20480
ds_read_b128 v[32:35], v1 offset:40960
ds_read_b128 v[36:39], v238 offset:0
s_waitcnt lgkmcnt(3)
v_mfma_f32_16x16x32_bf16 v[104:107], a[188:191], v[24:27], 0
ds_read_b128 v[40:43], v1 offset:1024
ds_read_b128 v[44:47], v1 offset:21504
s_waitcnt lgkmcnt(4)
v_mfma_f32_16x16x32_bf16 v[108:111], a[188:191], v[28:31], 0
ds_read_b128 v[48:51], v1 offset:41984
ds_read_b128 v[52:55], v238 offset:1024
s_waitcnt lgkmcnt(5)
v_mfma_f32_16x16x32_bf16 v[112:115], a[188:191], v[32:35], 0
s_waitcnt lgkmcnt(4)
v_mfma_f32_16x16x32_bf16 v[116:119], a[188:191], v[36:39], 0
s_waitcnt lgkmcnt(3)
v_mfma_f32_16x16x32_bf16 v[104:107], a[192:195], v[40:43], v[104:107]
ds_read_b128 v[24:27], v1 offset:2048
ds_read_b128 v[28:31], v1 offset:22528
s_waitcnt lgkmcnt(4)
v_mfma_f32_16x16x32_bf16 v[108:111], a[192:195], v[44:47], v[108:111]
ds_read_b128 v[32:35], v1 offset:43008
ds_read_b128 v[36:39], v238 offset:2048
s_waitcnt lgkmcnt(5)
v_mfma_f32_16x16x32_bf16 v[112:115], a[192:195], v[48:51], v[112:115]
s_waitcnt lgkmcnt(4)
v_mfma_f32_16x16x32_bf16 v[116:119], a[192:195], v[52:55], v[116:119]
s_waitcnt lgkmcnt(3)
v_mfma_f32_16x16x32_bf16 v[104:107], a[180:183], v[24:27], v[104:107]
ds_read_b128 v[40:43], v1 offset:3072
ds_read_b128 v[44:47], v1 offset:23552
s_waitcnt lgkmcnt(4)
v_mfma_f32_16x16x32_bf16 v[108:111], a[180:183], v[28:31], v[108:111]
ds_read_b128 v[48:51], v1 offset:44032
ds_read_b128 v[52:55], v238 offset:3072
s_waitcnt lgkmcnt(5)
v_mfma_f32_16x16x32_bf16 v[112:115], a[180:183], v[32:35], v[112:115]
s_waitcnt lgkmcnt(4)
v_mfma_f32_16x16x32_bf16 v[116:119], a[180:183], v[36:39], v[116:119]
s_waitcnt lgkmcnt(3)
v_mfma_f32_16x16x32_bf16 v[104:107], a[8:11], v[40:43], v[104:107]
ds_read_b128 v[24:27], v1 offset:4096
ds_read_b128 v[28:31], v1 offset:24576
s_waitcnt lgkmcnt(4)
v_mfma_f32_16x16x32_bf16 v[108:111], a[8:11], v[44:47], v[108:111]
ds_read_b128 v[32:35], v1 offset:45056
ds_read_b128 v[36:39], v238 offset:4096
s_waitcnt lgkmcnt(5)
v_mfma_f32_16x16x32_bf16 v[112:115], a[8:11], v[48:51], v[112:115]
s_waitcnt lgkmcnt(4)
v_mfma_f32_16x16x32_bf16 v[116:119], a[8:11], v[52:55], v[116:119]
s_waitcnt lgkmcnt(3)
v_mfma_f32_16x16x32_bf16 v[104:107], a[12:15], v[24:27], v[104:107]
ds_read_b128 v[40:43], v1 offset:5120
ds_read_b128 v[44:47], v1 offset:25600
s_waitcnt lgkmcnt(4)
v_mfma_f32_16x16x32_bf16 v[108:111], a[12:15], v[28:31], v[108:111]
ds_read_b128 v[48:51], v1 offset:46080
ds_read_b128 v[52:55], v238 offset:5120
s_waitcnt lgkmcnt(5)
v_mfma_f32_16x16x32_bf16 v[112:115], a[12:15], v[32:35], v[112:115]
s_waitcnt lgkmcnt(4)
v_mfma_f32_16x16x32_bf16 v[116:119], a[12:15], v[36:39], v[116:119]
s_waitcnt lgkmcnt(3)
v_mfma_f32_16x16x32_bf16 v[104:107], a[16:19], v[40:43], v[104:107]
ds_read_b128 v[24:27], v1 offset:6144
ds_read_b128 v[28:31], v1 offset:26624
s_waitcnt lgkmcnt(4)
v_mfma_f32_16x16x32_bf16 v[108:111], a[16:19], v[44:47], v[108:111]
ds_read_b128 v[32:35], v1 offset:47104
ds_read_b128 v[36:39], v238 offset:6144
s_waitcnt lgkmcnt(5)
v_mfma_f32_16x16x32_bf16 v[112:115], a[16:19], v[48:51], v[112:115]
s_waitcnt lgkmcnt(4)
v_mfma_f32_16x16x32_bf16 v[116:119], a[16:19], v[52:55], v[116:119]
s_waitcnt lgkmcnt(3)
v_mfma_f32_16x16x32_bf16 v[104:107], a[40:43], v[24:27], v[104:107]
ds_read_b128 v[40:43], v1 offset:7168
ds_read_b128 v[44:47], v1 offset:27648
s_waitcnt lgkmcnt(4)
v_mfma_f32_16x16x32_bf16 v[108:111], a[40:43], v[28:31], v[108:111]
ds_read_b128 v[48:51], v1 offset:48128
ds_read_b128 v[52:55], v238 offset:7168
s_waitcnt lgkmcnt(5)
v_mfma_f32_16x16x32_bf16 v[112:115], a[40:43], v[32:35], v[112:115]
s_waitcnt lgkmcnt(4)
v_mfma_f32_16x16x32_bf16 v[116:119], a[40:43], v[36:39], v[116:119]
s_waitcnt lgkmcnt(3)
v_mfma_f32_16x16x32_bf16 v[104:107], a[44:47], v[40:43], v[104:107]
ds_read_b128 v[24:27], v1 offset:8192
ds_read_b128 v[28:31], v1 offset:28672
s_waitcnt lgkmcnt(4)
v_mfma_f32_16x16x32_bf16 v[108:111], a[44:47], v[44:47], v[108:111]
ds_read_b128 v[32:35], v1 offset:49152
ds_read_b128 v[36:39], v238 offset:8192
s_waitcnt lgkmcnt(5)
v_mfma_f32_16x16x32_bf16 v[112:115], a[44:47], v[48:51], v[112:115]
s_waitcnt lgkmcnt(4)
v_mfma_f32_16x16x32_bf16 v[116:119], a[44:47], v[52:55], v[116:119]
s_waitcnt lgkmcnt(3)
v_mfma_f32_16x16x32_bf16 v[104:107], a[200:203], v[24:27], v[104:107]
ds_read_b128 v[40:43], v1 offset:9216
ds_read_b128 v[44:47], v1 offset:29696
s_waitcnt lgkmcnt(4)
v_mfma_f32_16x16x32_bf16 v[108:111], a[200:203], v[28:31], v[108:111]
ds_read_b128 v[48:51], v1 offset:50176
ds_read_b128 v[52:55], v238 offset:9216
s_waitcnt lgkmcnt(5)
v_mfma_f32_16x16x32_bf16 v[112:115], a[200:203], v[32:35], v[112:115]
s_waitcnt lgkmcnt(4)
v_mfma_f32_16x16x32_bf16 v[116:119], a[200:203], v[36:39], v[116:119]
s_waitcnt lgkmcnt(3)
v_mfma_f32_16x16x32_bf16 v[104:107], a[120:123], v[40:43], v[104:107]
ds_read_b128 v[24:27], v1 offset:10240
ds_read_b128 v[28:31], v1 offset:30720
s_waitcnt lgkmcnt(4)
v_mfma_f32_16x16x32_bf16 v[108:111], a[120:123], v[44:47], v[108:111]
ds_read_b128 v[32:35], v1 offset:51200
ds_read_b128 v[36:39], v238 offset:10240
s_waitcnt lgkmcnt(5)
v_mfma_f32_16x16x32_bf16 v[112:115], a[120:123], v[48:51], v[112:115]
s_waitcnt lgkmcnt(4)
v_mfma_f32_16x16x32_bf16 v[116:119], a[120:123], v[52:55], v[116:119]
s_waitcnt lgkmcnt(3)
v_mfma_f32_16x16x32_bf16 v[104:107], a[124:127], v[24:27], v[104:107]
ds_read_b128 v[40:43], v1 offset:11264
ds_read_b128 v[44:47], v1 offset:31744
s_waitcnt lgkmcnt(4)
v_mfma_f32_16x16x32_bf16 v[108:111], a[124:127], v[28:31], v[108:111]
ds_read_b128 v[48:51], v1 offset:52224
ds_read_b128 v[52:55], v238 offset:11264
s_waitcnt lgkmcnt(5)
v_mfma_f32_16x16x32_bf16 v[112:115], a[124:127], v[32:35], v[112:115]
s_waitcnt lgkmcnt(4)
v_mfma_f32_16x16x32_bf16 v[116:119], a[124:127], v[36:39], v[116:119]
s_waitcnt lgkmcnt(3)
v_mfma_f32_16x16x32_bf16 v[104:107], a[196:199], v[40:43], v[104:107]
ds_read_b128 v[24:27], v1 offset:12288
ds_read_b128 v[28:31], v1 offset:32768
s_waitcnt lgkmcnt(4)
v_mfma_f32_16x16x32_bf16 v[108:111], a[196:199], v[44:47], v[108:111]
ds_read_b128 v[32:35], v1 offset:53248
ds_read_b128 v[36:39], v238 offset:12288
s_waitcnt lgkmcnt(5)
v_mfma_f32_16x16x32_bf16 v[112:115], a[196:199], v[48:51], v[112:115]
s_waitcnt lgkmcnt(4)
v_mfma_f32_16x16x32_bf16 v[116:119], a[196:199], v[52:55], v[116:119]
s_waitcnt lgkmcnt(3)
v_mfma_f32_16x16x32_bf16 v[104:107], a[28:31], v[24:27], v[104:107]
ds_read_b128 v[40:43], v1 offset:13312
ds_read_b128 v[44:47], v1 offset:33792
s_waitcnt lgkmcnt(4)
v_mfma_f32_16x16x32_bf16 v[108:111], a[28:31], v[28:31], v[108:111]
ds_read_b128 v[48:51], v1 offset:54272
ds_read_b128 v[52:55], v238 offset:13312
s_waitcnt lgkmcnt(5)
v_mfma_f32_16x16x32_bf16 v[112:115], a[28:31], v[32:35], v[112:115]
s_waitcnt lgkmcnt(4)
v_mfma_f32_16x16x32_bf16 v[116:119], a[28:31], v[36:39], v[116:119]
s_waitcnt lgkmcnt(3)
v_mfma_f32_16x16x32_bf16 v[104:107], a[32:35], v[40:43], v[104:107]
ds_read_b128 v[24:27], v1 offset:14336
ds_read_b128 v[28:31], v1 offset:34816
s_waitcnt lgkmcnt(4)
v_mfma_f32_16x16x32_bf16 v[108:111], a[32:35], v[44:47], v[108:111]
ds_read_b128 v[32:35], v1 offset:55296
ds_read_b128 v[36:39], v238 offset:14336
s_waitcnt lgkmcnt(5)
v_mfma_f32_16x16x32_bf16 v[112:115], a[32:35], v[48:51], v[112:115]
s_waitcnt lgkmcnt(4)
v_mfma_f32_16x16x32_bf16 v[116:119], a[32:35], v[52:55], v[116:119]
s_waitcnt lgkmcnt(3)
v_mfma_f32_16x16x32_bf16 v[104:107], a[36:39], v[24:27], v[104:107]
ds_read_b128 v[40:43], v1 offset:15360
ds_read_b128 v[44:47], v1 offset:35840
s_waitcnt lgkmcnt(4)
v_mfma_f32_16x16x32_bf16 v[108:111], a[36:39], v[28:31], v[108:111]
ds_read_b128 v[48:51], v1 offset:56320
ds_read_b128 v[52:55], v238 offset:15360
s_waitcnt lgkmcnt(5)
v_mfma_f32_16x16x32_bf16 v[112:115], a[36:39], v[32:35], v[112:115]
s_waitcnt lgkmcnt(4)
v_mfma_f32_16x16x32_bf16 v[116:119], a[36:39], v[36:39], v[116:119]
s_waitcnt lgkmcnt(3)
v_mfma_f32_16x16x32_bf16 v[104:107], a[60:63], v[40:43], v[104:107]
ds_read_b64 v[24:25], v2 offset:16384
ds_read_b64 v[26:27], v2 offset:16896
ds_read_b64 v[28:29], v2 offset:36864
ds_read_b64 v[30:31], v2 offset:37376
s_waitcnt lgkmcnt(6)
v_mfma_f32_16x16x32_bf16 v[108:111], a[60:63], v[44:47], v[108:111]
ds_read_b64 v[32:33], v2 offset:57344
ds_read_b64 v[34:35], v2 offset:57856
ds_read_b64 v[36:37], v239 offset:16384
ds_read_b64 v[38:39], v239 offset:16896
s_waitcnt lgkmcnt(9)
v_mfma_f32_16x16x32_bf16 v[112:115], a[60:63], v[48:51], v[112:115]
s_waitcnt lgkmcnt(8)
v_mfma_f32_16x16x32_bf16 v[116:119], a[60:63], v[52:55], v[116:119]
s_waitcnt lgkmcnt(6)
v_mfma_f32_16x16x32_bf16 v[104:107], a[64:67], v[24:27], v[104:107]
ds_read_b64 v[40:41], v2 offset:17408
ds_read_b64 v[42:43], v2 offset:17920
ds_read_b64 v[44:45], v2 offset:37888
ds_read_b64 v[46:47], v2 offset:38400
s_waitcnt lgkmcnt(8)
v_mfma_f32_16x16x32_bf16 v[108:111], a[64:67], v[28:31], v[108:111]
ds_read_b64 v[48:49], v2 offset:58368
ds_read_b64 v[50:51], v2 offset:58880
ds_read_b64 v[52:53], v239 offset:17408
ds_read_b64 v[54:55], v239 offset:17920
s_waitcnt lgkmcnt(10)
v_mfma_f32_16x16x32_bf16 v[112:115], a[64:67], v[32:35], v[112:115]
s_waitcnt lgkmcnt(8)
v_mfma_f32_16x16x32_bf16 v[116:119], a[64:67], v[36:39], v[116:119]
s_waitcnt lgkmcnt(6)
v_mfma_f32_16x16x32_bf16 v[104:107], a[132:135], v[40:43], v[104:107]
ds_read_b64 v[24:25], v2 offset:18432
ds_read_b64 v[26:27], v2 offset:18944
ds_read_b64 v[28:29], v2 offset:38912
ds_read_b64 v[30:31], v2 offset:39424
s_waitcnt lgkmcnt(8)
v_mfma_f32_16x16x32_bf16 v[108:111], a[132:135], v[44:47], v[108:111]
ds_read_b64 v[32:33], v2 offset:59392
ds_read_b64 v[34:35], v2 offset:59904
ds_read_b64 v[36:37], v239 offset:18432
ds_read_b64 v[38:39], v239 offset:18944
s_waitcnt lgkmcnt(10)
v_mfma_f32_16x16x32_bf16 v[112:115], a[132:135], v[48:51], v[112:115]
s_waitcnt lgkmcnt(8)
v_mfma_f32_16x16x32_bf16 v[116:119], a[132:135], v[52:55], v[116:119]
s_waitcnt lgkmcnt(6)
v_mfma_f32_16x16x32_bf16 v[104:107], a[204:207], v[24:27], v[104:107]
ds_read_b64 v[40:41], v2 offset:19456
ds_read_b64 v[42:43], v2 offset:19968
ds_read_b64 v[44:45], v2 offset:39936
ds_read_b64 v[46:47], v2 offset:40448
s_waitcnt lgkmcnt(8)
v_mfma_f32_16x16x32_bf16 v[108:111], a[204:207], v[28:31], v[108:111]
ds_read_b64 v[48:49], v2 offset:60416
ds_read_b64 v[50:51], v2 offset:60928
ds_read_b64 v[52:53], v239 offset:19456
ds_read_b64 v[54:55], v239 offset:19968
s_waitcnt lgkmcnt(10)
v_mfma_f32_16x16x32_bf16 v[112:115], a[204:207], v[32:35], v[112:115]
s_waitcnt lgkmcnt(8)
v_mfma_f32_16x16x32_bf16 v[116:119], a[204:207], v[36:39], v[116:119]
s_waitcnt lgkmcnt(6)
v_mfma_f32_16x16x32_bf16 v[104:107], a[208:211], v[40:43], v[104:107]
s_waitcnt lgkmcnt(4)
v_mfma_f32_16x16x32_bf16 v[108:111], a[208:211], v[44:47], v[108:111]
s_waitcnt lgkmcnt(2)
v_mfma_f32_16x16x32_bf16 v[112:115], a[208:211], v[48:51], v[112:115]
s_waitcnt lgkmcnt(0)
v_mfma_f32_16x16x32_bf16 v[116:119], a[208:211], v[52:55], v[116:119]
s_mov_b32 s24, 0x3ea52b5c
v_mul_f32 v140, s24, v140
v_mul_f32 v141, s24, v141
v_mul_f32 v142, s24, v142
v_mul_f32 v143, s24, v143
v_pk_fma_f32 v[104:105], v[180:181], v[136:137], v[104:105] op_sel:[0,0,0] op_sel_hi:[1,0,1]
v_pk_fma_f32 v[106:107], v[182:183], v[136:137], v[106:107] op_sel:[0,0,0] op_sel_hi:[1,0,1]
v_pk_mul_f32 v[104:105], v[104:105], v[140:141] op_sel:[0,0] op_sel_hi:[1,0]
v_pk_mul_f32 v[106:107], v[106:107], v[140:141] op_sel:[0,0] op_sel_hi:[1,0]
v_cvt_pk_bf16_f32 v200, v104, v105
v_cvt_pk_bf16_f32 v201, v106, v107
v_pk_fma_f32 v[108:109], v[180:181], v[136:137], v[108:109] op_sel:[0,1,0] op_sel_hi:[1,1,1]
v_pk_fma_f32 v[110:111], v[182:183], v[136:137], v[110:111] op_sel:[0,1,0] op_sel_hi:[1,1,1]
v_pk_mul_f32 v[108:109], v[108:109], v[140:141] op_sel:[0,1] op_sel_hi:[1,1]
v_pk_mul_f32 v[110:111], v[110:111], v[140:141] op_sel:[0,1] op_sel_hi:[1,1]
v_cvt_pk_bf16_f32 v204, v108, v109
v_cvt_pk_bf16_f32 v205, v110, v111
v_pk_fma_f32 v[112:113], v[180:181], v[138:139], v[112:113] op_sel:[0,0,0] op_sel_hi:[1,0,1]
v_pk_fma_f32 v[114:115], v[182:183], v[138:139], v[114:115] op_sel:[0,0,0] op_sel_hi:[1,0,1]
v_pk_mul_f32 v[112:113], v[112:113], v[142:143] op_sel:[0,0] op_sel_hi:[1,0]
v_pk_mul_f32 v[114:115], v[114:115], v[142:143] op_sel:[0,0] op_sel_hi:[1,0]
v_cvt_pk_bf16_f32 v208, v112, v113
v_cvt_pk_bf16_f32 v209, v114, v115
v_pk_fma_f32 v[116:117], v[180:181], v[138:139], v[116:117] op_sel:[0,1,0] op_sel_hi:[1,1,1]
v_pk_fma_f32 v[118:119], v[182:183], v[138:139], v[118:119] op_sel:[0,1,0] op_sel_hi:[1,1,1]
v_pk_mul_f32 v[116:117], v[116:117], v[142:143] op_sel:[0,1] op_sel_hi:[1,1]
v_pk_mul_f32 v[118:119], v[118:119], v[142:143] op_sel:[0,1] op_sel_hi:[1,1]
v_cvt_pk_bf16_f32 v212, v116, v117
v_cvt_pk_bf16_f32 v213, v118, v119
s_nop 7
s_branch FE79
FE79:
s_mov_b32 s25, 0xf149f2ca
v_lshlrev_b32 v3, 2, v240
v_mov_b32 v216, s25
s_cmp_lt_u32 s20, 4
s_cselect_b32 s24, s25, 0
v_mov_b32 v184, s24
v_mov_b32 v185, s24
v_mov_b32 v186, s24
v_mov_b32 v187, s24
s_cmp_lt_u32 s20, 3
s_cselect_b32 s24, s25, 0
v_mov_b32 v188, s24
v_mov_b32 v189, s24
v_mov_b32 v190, s24
v_mov_b32 v191, s24
s_cmp_lt_u32 s20, 2
s_cselect_b32 s24, s25, 0
v_mov_b32 v192, s24
v_mov_b32 v193, s24
v_mov_b32 v194, s24
v_mov_b32 v195, s24
s_cmp_lt_u32 s20, 1
s_cselect_b32 s24, s25, 0
v_mov_b32 v196, s24
v_mov_b32 v197, s24
v_mov_b32 v198, s24
v_mov_b32 v199, s24
v_add_u32 v217, 0, v3
v_cmp_gt_u32 vcc, v217, v241
s_nop 1
v_cndmask_b32 v176, 0, v216, vcc
v_cndmask_b32 v180, v216, v184, vcc
v_add_u32 v217, 1, v3
v_cmp_gt_u32 vcc, v217, v241
s_nop 1
v_cndmask_b32 v177, 0, v216, vcc
v_cndmask_b32 v181, v216, v185, vcc
v_add_u32 v217, 2, v3
v_cmp_gt_u32 vcc, v217, v241
s_nop 1
v_cndmask_b32 v178, 0, v216, vcc
v_cndmask_b32 v182, v216, v186, vcc
v_add_u32 v217, 3, v3
v_cmp_gt_u32 vcc, v217, v241
s_nop 1
v_cndmask_b32 v179, 0, v216, vcc
v_cndmask_b32 v183, v216, v187, vcc
v_mov_b32 v136, 0x3f803f80
v_mov_b32 v137, 0x3f803f80
v_mov_b32 v138, 0x3f803f80
v_mov_b32 v139, 0x3f803f80
v_mov_b32 v140, 0x3f803f80
v_mov_b32 v141, 0x3f803f80
v_mov_b32 v142, 0x3f803f80
v_mov_b32 v143, 0x3f803f80
v_mov_b32 v144, 0x3f803f80
v_mov_b32 v145, 0x3f803f80
v_mov_b32 v146, 0x3f803f80
v_mov_b32 v147, 0x3f803f80
v_mov_b32 v148, 0x3f803f80
v_mov_b32 v149, 0x3f803f80
v_mov_b32 v150, 0x3f803f80
v_mov_b32 v151, 0x3f803f80
v_mov_b32 v152, 0x3f803f80
v_mov_b32 v153, 0x3f803f80
v_mov_b32 v154, 0x3f803f80
v_mov_b32 v155, 0x3f803f80
v_mov_b32 v156, 0x3f803f80
v_mov_b32 v157, 0x3f803f80
v_mov_b32 v158, 0x3f803f80
v_mov_b32 v159, 0x3f803f80
v_mov_b32 v160, 0x3f803f80
v_mov_b32 v161, 0x3f803f80
v_mov_b32 v162, 0x3f803f80
v_mov_b32 v163, 0x3f803f80
v_mov_b32 v164, 0x3f803f80
v_mov_b32 v165, 0x3f803f80
v_mov_b32 v166, 0x3f803f80
v_mov_b32 v167, 0x3f803f80
v_mov_b32 v168, 0x3f803f80
v_mov_b32 v169, 0x3f803f80
v_mov_b32 v170, 0x3f803f80
v_mov_b32 v171, 0x3f803f80
v_mov_b32 v172, 0x3f803f80
v_mov_b32 v173, 0x3f803f80
v_mov_b32 v174, 0x3f803f80
v_mov_b32 v175, 0x3f803f80
s_sub_u32 s24, s20, 4
s_cmp_lt_u32 s20, 4
s_cselect_b32 s24, s20, s24
s_lshl_b32 s24, s24, 3
s_add_u32 s24, s24, s21
s_lshl_b32 s25, s24, 14
s_lshl_b32 s26, s22, 12
s_add_u32 s25, s25, s26
s_add_u32 s45, s25, 17686528
s_mul_i32 s25, s24, 10240
s_add_u32 s50, s25, 24502272
s_sub_u32 s24, s20, 3
s_cmp_lt_u32 s20, 3
s_cselect_b32 s24, s20, s24
s_lshl_b32 s24, s24, 3
s_add_u32 s24, s24, s21
s_lshl_b32 s25, s24, 14
s_lshl_b32 s26, s22, 12
s_add_u32 s25, s25, s26
s_add_u32 s46, s25, 17686528
s_mul_i32 s25, s24, 10240
s_add_u32 s51, s25, 24502272
s_sub_u32 s24, s20, 2
s_cmp_lt_u32 s20, 2
s_cselect_b32 s24, s20, s24
s_lshl_b32 s24, s24, 3
s_add_u32 s24, s24, s21
s_lshl_b32 s25, s24, 14
s_lshl_b32 s26, s22, 12
s_add_u32 s25, s25, s26
s_add_u32 s47, s25, 17686528
s_mul_i32 s25, s24, 10240
s_add_u32 s52, s25, 24502272
s_sub_u32 s24, s20, 1
s_cmp_lt_u32 s20, 1
s_cselect_b32 s24, s20, s24
s_lshl_b32 s24, s24, 3
s_add_u32 s24, s24, s21
s_lshl_b32 s25, s24, 14
s_lshl_b32 s26, s22, 12
s_add_u32 s25, s25, s26
s_add_u32 s48, s25, 17686528
s_mul_i32 s25, s24, 10240
s_add_u32 s53, s25, 24502272
s_sub_u32 s24, s20, 0
s_cmp_lt_u32 s20, 0
s_cselect_b32 s24, s20, s24
s_lshl_b32 s24, s24, 3
s_add_u32 s24, s24, s21
s_lshl_b32 s25, s24, 14
s_lshl_b32 s26, s22, 12
s_add_u32 s25, s25, s26
s_add_u32 s49, s25, 17686528
s_mul_i32 s25, s24, 10240
s_add_u32 s54, s25, 24502272
s_lshl_b32 s55, s22, 11
v_add_u32 v218, s55, v1
v_add_u32 v219, 8192, v1
v_lshrrev_b32 v3, 2, v241
v_cmp_eq_u32 s[56:57], s22, v3
s_and_b32 s24, s22, 1
s_cmp_eq_u32 s24, 1
s_cselect_b64 s[58:59], -1, 0
s_lshr_b32 s24, s22, 1
s_lshl_b32 s24, s24, 10
s_and_b32 s25, s22, 1
s_lshl_b32 s25, s25, 3
s_add_u32 s24, s24, s25
v_add_u32 v229, s24, v238
s_mov_b32 s24, 30000
PL92:
buffer_load_dword v3, v237, s[4:7], 0 offen sc1
s_waitcnt vmcnt(0)
v_cmp_gt_u32 vcc, 6, v3
s_sub_u32 s24, s24, 1
s_cbranch_scc1 PD93
s_cbranch_vccnz PL92
PD93:
s_barrier
buffer_load_dwordx4 a[0:3], v1, s[4:7], s45 offen offset:0
buffer_load_dwordx4 a[4:7], v1, s[4:7], s45 offen offset:1024
buffer_load_dwordx4 a[8:11], v1, s[4:7], s45 offen offset:2048
buffer_load_dwordx4 a[12:15], v1, s[4:7], s45 offen offset:3072
buffer_load_dwordx4 a[16:19], v1, s[4:7], s46 offen offset:0
buffer_load_dwordx4 a[20:23], v1, s[4:7], s46 offen offset:1024
buffer_load_dwordx4 a[24:27], v1, s[4:7], s46 offen offset:2048
buffer_load_dwordx4 a[28:31], v1, s[4:7], s46 offen offset:3072
buffer_load_dwordx4 a[32:35], v1, s[4:7], s47 offen offset:0
buffer_load_dwordx4 a[36:39], v1, s[4:7], s47 offen offset:1024
buffer_load_dwordx4 a[40:43], v1, s[4:7], s47 offen offset:2048
buffer_load_dwordx4 a[44:47], v1, s[4:7], s47 offen offset:3072
buffer_load_dwordx4 a[48:51], v1, s[4:7], s48 offen offset:0
buffer_load_dwordx4 a[52:55], v1, s[4:7], s48 offen offset:1024
buffer_load_dwordx4 a[56:59], v1, s[4:7], s48 offen offset:2048
buffer_load_dwordx4 a[60:63], v1, s[4:7], s48 offen offset:3072
buffer_load_dwordx4 a[64:67], v1, s[4:7], s49 offen offset:0
s_lshl_b32 s44, s68, 2
s_add_u32 s44, s44, s22
s_mul_i32 s44, s44, 25600
s_add_u32 s44, s44, 2457600
s_mul_i32 s70, s22, 25600
s_mul_i32 s63, s21, 7
s_cmp_eq_u32 s21, 7
s_cselect_b32 s63, 48, s63
s_lshl_b32 s24, s22, 1
s_add_u32 s63, s63, s24
s_min_u32 s63, s63, 53
s_add_u32 s24, s63, 0
s_min_u32 s24, s24, 53
s_mul_i32 s24, s24, 40960
s_add_u32 s64, s24, 3276800
s_add_u32 s24, s63, 1
s_min_u32 s24, s24, 53
s_mul_i32 s24, s24, 40960
s_add_u32 s65, s24, 3276800
s_waitcnt vmcnt(16)
v_mfma_f32_16x16x32_bf16 v[24:27], a[0:3], v[200:203], v[180:183]
s_waitcnt vmcnt(15)
v_mfma_f32_16x16x32_bf16 v[28:31], a[4:7], v[200:203], v[184:187]
s_waitcnt vmcnt(14)
v_mfma_f32_16x16x32_bf16 v[32:35], a[8:11], v[200:203], v[184:187]
s_waitcnt vmcnt(13)
v_mfma_f32_16x16x32_bf16 v[36:39], a[12:15], v[200:203], v[184:187]
s_waitcnt vmcnt(12)
v_mfma_f32_16x16x32_bf16 v[40:43], a[16:19], v[200:203], v[188:191]
s_waitcnt vmcnt(11)
v_mfma_f32_16x16x32_bf16 v[44:47], a[20:23], v[200:203], v[188:191]
s_waitcnt vmcnt(10)
v_mfma_f32_16x16x32_bf16 v[48:51], a[24:27], v[200:203], v[188:191]
s_waitcnt vmcnt(9)
v_mfma_f32_16x16x32_bf16 v[52:55], a[28:31], v[200:203], v[188:191]
s_waitcnt vmcnt(8)
v_mfma_f32_16x16x32_bf16 v[56:59], a[32:35], v[200:203], v[192:195]
s_waitcnt vmcnt(7)
v_mfma_f32_16x16x32_bf16 v[60:63], a[36:39], v[200:203], v[192:195]
s_waitcnt vmcnt(6)
v_mfma_f32_16x16x32_bf16 v[64:67], a[40:43], v[200:203], v[192:195]
s_waitcnt vmcnt(5)
v_mfma_f32_16x16x32_bf16 v[68:71], a[44:47], v[200:203], v[192:195]
s_waitcnt vmcnt(4)
v_mfma_f32_16x16x32_bf16 v[72:75], a[48:51], v[200:203], v[196:199]
s_waitcnt vmcnt(3)
v_mfma_f32_16x16x32_bf16 v[76:79], a[52:55], v[200:203], v[196:199]
s_waitcnt vmcnt(2)
v_mfma_f32_16x16x32_bf16 v[80:83], a[56:59], v[200:203], v[196:199]
s_waitcnt vmcnt(1)
v_mfma_f32_16x16x32_bf16 v[84:87], a[60:63], v[200:203], v[196:199]
s_waitcnt vmcnt(0)
v_mfma_f32_16x16x32_bf16 v[88:91], a[64:67], v[200:203], v[176:179]
v_max3_f32 v226, v24, v25, v26
buffer_load_dwordx4 a[68:71], v218, s[4:7], s50 offen offset:0
v_max3_f32 v228, v27, v28, v29
v_max3_f32 v226, v226, v30, v31
v_max3_f32 v228, v228, v32, v33
v_max3_f32 v226, v226, v34, v35
v_max3_f32 v228, v228, v36, v37
buffer_load_dwordx4 a[72:75], v218, s[4:7], s50 offen offset:1024
v_max3_f32 v226, v226, v38, v39
v_max3_f32 v228, v228, v40, v41
v_max3_f32 v226, v226, v42, v43
v_max3_f32 v228, v228, v44, v45
v_max3_f32 v226, v226, v46, v47
buffer_load_dwordx4 a[76:79], v218, s[4:7], s51 offen offset:0
v_max3_f32 v228, v228, v48, v49
v_max3_f32 v226, v226, v50, v51
v_max3_f32 v228, v228, v52, v53
v_max3_f32 v226, v226, v54, v55
v_max3_f32 v228, v228, v56, v57
buffer_load_dwordx4 a[80:83], v218, s[4:7], s51 offen offset:1024
v_max3_f32 v226, v226, v58, v59
v_max3_f32 v228, v228, v60, v61
v_max3_f32 v226, v226, v62, v63
v_max3_f32 v228, v228, v64, v65
v_max3_f32 v226, v226, v66, v67
buffer_load_dwordx4 a[84:87], v218, s[4:7], s52 offen offset:0
v_max3_f32 v228, v228, v68, v69
v_max3_f32 v226, v226, v70, v71
v_max3_f32 v228, v228, v72, v73
v_max3_f32 v226, v226, v74, v75
v_max3_f32 v228, v228, v76, v77
s_mov_b64 exec, s[56:57]
buffer_load_dwordx4 v[136:139], v219, s[4:7], s50 offen offset:0
buffer_load_dwordx4 v[140:143], v219, s[4:7], s50 offen offset:1024
buffer_load_dwordx4 v[144:147], v219, s[4:7], s51 offen offset:0
buffer_load_dwordx4 v[148:151], v219, s[4:7], s51 offen offset:1024
buffer_load_dwordx4 v[152:155], v219, s[4:7], s52 offen offset:0
s_mov_b64 exec, -1
v_max3_f32 v226, v226, v78, v79
v_max3_f32 v228, v228, v80, v81
v_max3_f32 v226, v226, v82, v83
v_max3_f32 v228, v228, v84, v85
v_max3_f32 v226, v226, v86, v87
buffer_load_dwordx4 a[88:91], v218, s[4:7], s52 offen offset:1024
v_max3_f32 v228, v228, v88, v89
v_max3_f32 v226, v226, v90, v91
v_max_f32 v226, v226, v228
v_mov_b32 v227, v226
s_nop 1
v_permlane32_swap_b32 v226, v227
v_max_f32 v226, v226, v227
v_mov_b32 v227, v226
s_nop 1
v_permlane16_swap_b32 v226, v227
v_max_f32 v226, v226, v227
v_mov_b32 v227, v226
v_pk_add_f32 v[24:25], v[24:25], v[226:227] neg_lo:[0,1] neg_hi:[0,1]
v_pk_add_f32 v[26:27], v[26:27], v[226:227] neg_lo:[0,1] neg_hi:[0,1]
buffer_load_dwordx4 a[92:95], v218, s[4:7], s53 offen offset:0
v_pk_add_f32 v[28:29], v[28:29], v[226:227] neg_lo:[0,1] neg_hi:[0,1]
v_pk_add_f32 v[30:31], v[30:31], v[226:227] neg_lo:[0,1] neg_hi:[0,1]
v_pk_add_f32 v[32:33], v[32:33], v[226:227] neg_lo:[0,1] neg_hi:[0,1]
v_pk_add_f32 v[34:35], v[34:35], v[226:227] neg_lo:[0,1] neg_hi:[0,1]
v_pk_add_f32 v[36:37], v[36:37], v[226:227] neg_lo:[0,1] neg_hi:[0,1]
buffer_load_dwordx4 a[96:99], v218, s[4:7], s53 offen offset:1024
v_pk_add_f32 v[38:39], v[38:39], v[226:227] neg_lo:[0,1] neg_hi:[0,1]
v_pk_add_f32 v[40:41], v[40:41], v[226:227] neg_lo:[0,1] neg_hi:[0,1]
v_pk_add_f32 v[42:43], v[42:43], v[226:227] neg_lo:[0,1] neg_hi:[0,1]
v_pk_add_f32 v[44:45], v[44:45], v[226:227] neg_lo:[0,1] neg_hi:[0,1]
v_pk_add_f32 v[46:47], v[46:47], v[226:227] neg_lo:[0,1] neg_hi:[0,1]
buffer_load_dwordx4 a[100:103], v218, s[4:7], s54 offen offset:0
v_pk_add_f32 v[48:49], v[48:49], v[226:227] neg_lo:[0,1] neg_hi:[0,1]
v_pk_add_f32 v[50:51], v[50:51], v[226:227] neg_lo:[0,1] neg_hi:[0,1]
v_pk_add_f32 v[52:53], v[52:53], v[226:227] neg_lo:[0,1] neg_hi:[0,1]
v_pk_add_f32 v[54:55], v[54:55], v[226:227] neg_lo:[0,1] neg_hi:[0,1]
v_pk_add_f32 v[56:57], v[56:57], v[226:227] neg_lo:[0,1] neg_hi:[0,1]
s_mov_b64 exec, s[56:57]
buffer_load_dwordx4 v[156:159], v219, s[4:7], s52 offen offset:1024
buffer_load_dwordx4 v[160:163], v219, s[4:7], s53 offen offset:0
buffer_load_dwordx4 v[164:167], v219, s[4:7], s53 offen offset:1024
buffer_load_dwordx4 v[168:171], v219, s[4:7], s54 offen offset:0
buffer_load_dwordx4 v[172:175], v219, s[4:7], s54 offen offset:1024
s_mov_b64 exec, -1
v_pk_add_f32 v[58:59], v[58:59], v[226:227] neg_lo:[0,1] neg_hi:[0,1]
v_pk_add_f32 v[60:61], v[60:61], v[226:227] neg_lo:[0,1] neg_hi:[0,1]
v_pk_add_f32 v[62:63], v[62:63], v[226:227] neg_lo:[0,1] neg_hi:[0,1]
v_pk_add_f32 v[64:65], v[64:65], v[226:227] neg_lo:[0,1] neg_hi:[0,1]
v_pk_add_f32 v[66:67], v[66:67], v[226:227] neg_lo:[0,1] neg_hi:[0,1]
buffer_load_dwordx4 a[104:107], v1, s[4:7], s49 offen offset:1024
v_pk_add_f32 v[68:69], v[68:69], v[226:227] neg_lo:[0,1] neg_hi:[0,1]
v_pk_add_f32 v[70:71], v[70:71], v[226:227] neg_lo:[0,1] neg_hi:[0,1]
v_pk_add_f32 v[72:73], v[72:73], v[226:227] neg_lo:[0,1] neg_hi:[0,1]
v_pk_add_f32 v[74:75], v[74:75], v[226:227] neg_lo:[0,1] neg_hi:[0,1]
v_pk_add_f32 v[76:77], v[76:77], v[226:227] neg_lo:[0,1] neg_hi:[0,1]
buffer_load_dwordx4 a[108:111], v1, s[4:7], s49 offen offset:2048
v_pk_add_f32 v[78:79], v[78:79], v[226:227] neg_lo:[0,1] neg_hi:[0,1]
v_pk_add_f32 v[80:81], v[80:81], v[226:227] neg_lo:[0,1] neg_hi:[0,1]
v_pk_add_f32 v[82:83], v[82:83], v[226:227] neg_lo:[0,1] neg_hi:[0,1]
v_pk_add_f32 v[84:85], v[84:85], v[226:227] neg_lo:[0,1] neg_hi:[0,1]
v_pk_add_f32 v[86:87], v[86:87], v[226:227] neg_lo:[0,1] neg_hi:[0,1]
buffer_load_dwordx4 a[112:115], v1, s[4:7], s49 offen offset:3072
v_pk_add_f32 v[88:89], v[88:89], v[226:227] neg_lo:[0,1] neg_hi:[0,1]
v_pk_add_f32 v[90:91], v[90:91], v[226:227] neg_lo:[0,1] neg_hi:[0,1]
v_mov_b32 v126, 0
v_mov_b32 v127, 0
v_exp_f32 v24, v24
v_exp_f32 v25, v25
v_exp_f32 v26, v26
v_exp_f32 v27, v27
v_cvt_pk_bf16_f32 v92, v24, v25
v_cvt_pk_bf16_f32 v93, v26, v27
buffer_load_dwordx4 a[116:119], v218, s[4:7], s54 offen offset:1024
v_exp_f32 v28, v28
v_exp_f32 v29, v29
v_exp_f32 v30, v30
v_exp_f32 v31, v31
v_mfma_f32_16x16x32_bf16 v[24:27], a[4:7], v[204:207], v[180:183]
v_cvt_pk_bf16_f32 v94, v28, v29
v_cvt_pk_bf16_f32 v95, v30, v31
s_mov_b32 m0, s70
s_nop 0
buffer_load_dwordx4 v1, s[4:7], s44 offen offset:0 lds
v_exp_f32 v32, v32
v_exp_f32 v33, v33
v_exp_f32 v34, v34
v_exp_f32 v35, v35
v_mfma_f32_16x16x32_bf16 v[28:31], a[8:11], v[204:207], v[184:187]
v_cvt_pk_bf16_f32 v96, v32, v33
v_cvt_pk_bf16_f32 v97, v34, v35
s_mov_b32 m0, s70
s_nop 0
buffer_load_dwordx4 v1, s[4:7], s44 offen offset:1024 lds
v_exp_f32 v36, v36
v_exp_f32 v37, v37
v_exp_f32 v38, v38
v_exp_f32 v39, v39
v_mfma_f32_16x16x32_bf16 v[32:35], a[12:15], v[204:207], v[184:187]
v_cvt_pk_bf16_f32 v98, v36, v37
v_cvt_pk_bf16_f32 v99, v38, v39
s_mov_b32 m0, s70
s_nop 0
buffer_load_dwordx4 v1, s[4:7], s44 offen offset:2048 lds
v_exp_f32 v40, v40
v_exp_f32 v41, v41
v_exp_f32 v42, v42
v_exp_f32 v43, v43
v_mfma_f32_16x16x32_bf16 v[36:39], a[16:19], v[204:207], v[188:191]
v_cvt_pk_bf16_f32 v100, v40, v41
v_cvt_pk_bf16_f32 v101, v42, v43
s_mov_b32 m0, s70
s_nop 0
buffer_load_dwordx4 v1, s[4:7], s44 offen offset:3072 lds
v_exp_f32 v44, v44
v_exp_f32 v45, v45
v_exp_f32 v46, v46
v_exp_f32 v47, v47
v_mfma_f32_16x16x32_bf16 v[40:43], a[20:23], v[204:207], v[188:191]
v_cvt_pk_bf16_f32 v102, v44, v45
v_cvt_pk_bf16_f32 v103, v46, v47
s_add_u32 s44, s44, 4096
s_add_u32 s70, s70, 4096
s_mov_b32 m0, s70
s_nop 0
buffer_load_dwordx4 v1, s[4:7], s44 offen offset:0 lds
v_exp_f32 v48, v48
v_exp_f32 v49, v49
v_exp_f32 v50, v50
v_exp_f32 v51, v51
v_mfma_f32_16x16x32_bf16 v[44:47], a[24:27], v[204:207], v[188:191]
v_cvt_pk_bf16_f32 v104, v48, v49
v_cvt_pk_bf16_f32 v105, v50, v51
s_mov_b32 m0, s70
s_nop 0
buffer_load_dwordx4 v1, s[4:7], s44 offen offset:1024 lds
v_exp_f32 v52, v52
v_exp_f32 v53, v53
v_exp_f32 v54, v54
v_exp_f32 v55, v55
v_mfma_f32_16x16x32_bf16 v[48:51], a[28:31], v[204:207], v[188:191]
v_cvt_pk_bf16_f32 v106, v52, v53
v_cvt_pk_bf16_f32 v107, v54, v55
s_mov_b32 m0, s70
s_nop 0
buffer_load_dwordx4 v1, s[4:7], s44 offen offset:2048 lds
v_exp_f32 v56, v56
v_exp_f32 v57, v57
v_exp_f32 v58, v58
v_exp_f32 v59, v59
v_mfma_f32_16x16x32_bf16 v[52:55], a[32:35], v[204:207], v[192:195]
v_cvt_pk_bf16_f32 v108, v56, v57
v_cvt_pk_bf16_f32 v109, v58, v59
s_mov_b32 m0, s70
s_nop 0
buffer_load_dwordx4 v1, s[4:7], s44 offen offset:3072 lds
v_exp_f32 v60, v60
v_exp_f32 v61, v61
v_exp_f32 v62, v62
v_exp_f32 v63, v63
v_mfma_f32_16x16x32_bf16 v[56:59], a[36:39], v[204:207], v[192:195]
v_cvt_pk_bf16_f32 v110, v60, v61
v_cvt_pk_bf16_f32 v111, v62, v63
s_add_u32 s44, s44, 4096
s_add_u32 s70, s70, 4096
s_mov_b32 m0, s70
s_nop 0
buffer_load_dwordx4 v1, s[4:7], s44 offen offset:0 lds
v_exp_f32 v64, v64
v_exp_f32 v65, v65
v_exp_f32 v66, v66
v_exp_f32 v67, v67
v_mfma_f32_16x16x32_bf16 v[60:63], a[40:43], v[204:207], v[192:195]
v_cvt_pk_bf16_f32 v112, v64, v65
v_cvt_pk_bf16_f32 v113, v66, v67
s_mov_b32 m0, s70
s_nop 0
buffer_load_dwordx4 v1, s[4:7], s44 offen offset:1024 lds
v_exp_f32 v68, v68
v_exp_f32 v69, v69
v_exp_f32 v70, v70
v_exp_f32 v71, v71
v_mfma_f32_16x16x32_bf16 v[64:67], a[44:47], v[204:207], v[192:195]
v_cvt_pk_bf16_f32 v114, v68, v69
v_cvt_pk_bf16_f32 v115, v70, v71
s_mov_b32 m0, s70
s_nop 0
buffer_load_dwordx4 v1, s[4:7], s44 offen offset:2048 lds
v_exp_f32 v72, v72
v_exp_f32 v73, v73
v_exp_f32 v74, v74
v_exp_f32 v75, v75
v_mfma_f32_16x16x32_bf16 v[68:71], a[48:51], v[204:207], v[196:199]
v_cvt_pk_bf16_f32 v116, v72, v73
v_cvt_pk_bf16_f32 v117, v74, v75
s_mov_b32 m0, s70
s_nop 0
buffer_load_dwordx4 v1, s[4:7], s44 offen offset:3072 lds
v_exp_f32 v76, v76
v_exp_f32 v77, v77
v_exp_f32 v78, v78
v_exp_f32 v79, v79
v_mfma_f32_16x16x32_bf16 v[72:75], a[52:55], v[204:207], v[196:199]
v_cvt_pk_bf16_f32 v118, v76, v77
v_cvt_pk_bf16_f32 v119, v78, v79
s_add_u32 s44, s44, 4096
s_add_u32 s70, s70, 4096
s_mov_b32 m0, s70
s_nop 0
buffer_load_dwordx4 v1, s[4:7], s44 offen offset:0 lds
v_exp_f32 v80, v80
v_exp_f32 v81, v81
v_exp_f32 v82, v82
v_exp_f32 v83, v83
v_mfma_f32_16x16x32_bf16 v[76:79], a[56:59], v[204:207], v[196:199]
v_cvt_pk_bf16_f32 v120, v80, v81
v_cvt_pk_bf16_f32 v121, v82, v83
s_mov_b32 m0, s70
s_nop 0
buffer_load_dwordx4 v1, s[4:7], s44 offen offset:1024 lds
v_exp_f32 v84, v84
v_exp_f32 v85, v85
v_exp_f32 v86, v86
v_exp_f32 v87, v87
v_mfma_f32_16x16x32_bf16 v[80:83], a[60:63], v[204:207], v[196:199]
v_cvt_pk_bf16_f32 v122, v84, v85
v_cvt_pk_bf16_f32 v123, v86, v87
s_mov_b32 m0, s70
s_nop 0
buffer_load_dwordx4 v1, s[4:7], s44 offen offset:2048 lds
v_exp_f32 v88, v88
v_exp_f32 v89, v89
v_exp_f32 v90, v90
v_exp_f32 v91, v91
v_mfma_f32_16x16x32_bf16 v[84:87], a[64:67], v[204:207], 0
v_cvt_pk_bf16_f32 v124, v88, v89
v_cvt_pk_bf16_f32 v125, v90, v91
s_mov_b32 m0, s70
s_nop 0
buffer_load_dwordx4 v1, s[4:7], s44 offen offset:3072 lds
s_waitcnt vmcnt(19)
v_mfma_f32_16x16x32_bf16 v[88:91], a[104:107], v[204:207], v[176:179]
buffer_load_dwordx4 a[120:123], v1, s[4:7], s64 offen
buffer_load_dwordx4 a[124:127], v1, s[4:7], s64 offen offset:1024
buffer_load_dwordx4 a[128:131], v1, s[4:7], s64 offen offset:2048
v_mfma_f32_16x16x32_bf16 v[128:131], a[68:71], v[92:95], 0
v_max3_f32 v226, v24, v25, v26
v_max3_f32 v228, v27, v28, v29
v_max3_f32 v226, v226, v30, v31
v_mfma_f32_16x16x32_bf16 v[132:135], v[136:139], v[92:95], 0
v_max3_f32 v228, v228, v32, v33
v_max3_f32 v226, v226, v34, v35
v_max3_f32 v228, v228, v36, v37
v_mfma_f32_16x16x32_bf16 v[128:131], a[72:75], v[96:99], v[128:131]
v_max3_f32 v226, v226, v38, v39
v_max3_f32 v228, v228, v40, v41
v_max3_f32 v226, v226, v42, v43
v_mfma_f32_16x16x32_bf16 v[132:135], v[140:143], v[96:99], v[132:135]
v_max3_f32 v228, v228, v44, v45
v_max3_f32 v226, v226, v46, v47
v_max3_f32 v228, v228, v48, v49
v_mfma_f32_16x16x32_bf16 v[128:131], a[76:79], v[100:103], v[128:131]
v_max3_f32 v226, v226, v50, v51
v_max3_f32 v228, v228, v52, v53
v_max3_f32 v226, v226, v54, v55
v_mfma_f32_16x16x32_bf16 v[132:135], v[144:147], v[100:103], v[132:135]
v_max3_f32 v228, v228, v56, v57
v_max3_f32 v226, v226, v58, v59
v_max3_f32 v228, v228, v60, v61
v_mfma_f32_16x16x32_bf16 v[128:131], a[80:83], v[104:107], v[128:131]
v_max3_f32 v226, v226, v62, v63
v_max3_f32 v228, v228, v64, v65
v_max3_f32 v226, v226, v66, v67
v_mfma_f32_16x16x32_bf16 v[132:135], v[148:151], v[104:107], v[132:135]
v_max3_f32 v228, v228, v68, v69
v_max3_f32 v226, v226, v70, v71
v_max3_f32 v228, v228, v72, v73
v_mfma_f32_16x16x32_bf16 v[128:131], a[84:87], v[108:111], v[128:131]
v_max3_f32 v226, v226, v74, v75
v_max3_f32 v228, v228, v76, v77
v_max3_f32 v226, v226, v78, v79
v_mfma_f32_16x16x32_bf16 v[132:135], v[152:155], v[108:111], v[132:135]
v_max3_f32 v228, v228, v80, v81
v_max3_f32 v226, v226, v82, v83
v_max3_f32 v228, v228, v84, v85
v_mfma_f32_16x16x32_bf16 v[128:131], a[88:91], v[112:115], v[128:131]
v_max3_f32 v226, v226, v86, v87
v_max3_f32 v228, v228, v88, v89
v_max3_f32 v226, v226, v90, v91
v_mfma_f32_16x16x32_bf16 v[132:135], v[156:159], v[112:115], v[132:135]
v_max_f32 v226, v226, v228
v_mov_b32 v227, v226
s_nop 1
v_permlane32_swap_b32 v226, v227
v_max_f32 v226, v226, v227
v_mov_b32 v227, v226
s_nop 1
v_permlane16_swap_b32 v226, v227
v_max_f32 v226, v226, v227
v_mov_b32 v227, v226
v_pk_add_f32 v[24:25], v[24:25], v[226:227] neg_lo:[0,1] neg_hi:[0,1]
v_pk_add_f32 v[26:27], v[26:27], v[226:227] neg_lo:[0,1] neg_hi:[0,1]
v_mfma_f32_16x16x32_bf16 v[128:131], a[92:95], v[116:119], v[128:131]
v_pk_add_f32 v[28:29], v[28:29], v[226:227] neg_lo:[0,1] neg_hi:[0,1]
v_pk_add_f32 v[30:31], v[30:31], v[226:227] neg_lo:[0,1] neg_hi:[0,1]
v_pk_add_f32 v[32:33], v[32:33], v[226:227] neg_lo:[0,1] neg_hi:[0,1]
v_mfma_f32_16x16x32_bf16 v[132:135], v[160:163], v[116:119], v[132:135]
v_pk_add_f32 v[34:35], v[34:35], v[226:227] neg_lo:[0,1] neg_hi:[0,1]
v_pk_add_f32 v[36:37], v[36:37], v[226:227] neg_lo:[0,1] neg_hi:[0,1]
v_pk_add_f32 v[38:39], v[38:39], v[226:227] neg_lo:[0,1] neg_hi:[0,1]
v_mfma_f32_16x16x32_bf16 v[128:131], a[96:99], v[120:123], v[128:131]
v_pk_add_f32 v[40:41], v[40:41], v[226:227] neg_lo:[0,1] neg_hi:[0,1]
v_pk_add_f32 v[42:43], v[42:43], v[226:227] neg_lo:[0,1] neg_hi:[0,1]
v_pk_add_f32 v[44:45], v[44:45], v[226:227] neg_lo:[0,1] neg_hi:[0,1]
v_mfma_f32_16x16x32_bf16 v[132:135], v[164:167], v[120:123], v[132:135]
v_pk_add_f32 v[46:47], v[46:47], v[226:227] neg_lo:[0,1] neg_hi:[0,1]
v_pk_add_f32 v[48:49], v[48:49], v[226:227] neg_lo:[0,1] neg_hi:[0,1]
v_pk_add_f32 v[50:51], v[50:51], v[226:227] neg_lo:[0,1] neg_hi:[0,1]
v_mfma_f32_16x16x32_bf16 v[128:131], a[100:103], v[124:127], v[128:131]
v_pk_add_f32 v[52:53], v[52:53], v[226:227] neg_lo:[0,1] neg_hi:[0,1]
v_pk_add_f32 v[54:55], v[54:55], v[226:227] neg_lo:[0,1] neg_hi:[0,1]
v_pk_add_f32 v[56:57], v[56:57], v[226:227] neg_lo:[0,1] neg_hi:[0,1]
v_mfma_f32_16x16x32_bf16 v[132:135], v[168:171], v[124:127], v[132:135]
v_pk_add_f32 v[58:59], v[58:59], v[226:227] neg_lo:[0,1] neg_hi:[0,1]
v_pk_add_f32 v[60:61], v[60:61], v[226:227] neg_lo:[0,1] neg_hi:[0,1]
v_pk_add_f32 v[62:63], v[62:63], v[226:227] neg_lo:[0,1] neg_hi:[0,1]
v_pk_add_f32 v[64:65], v[64:65], v[226:227] neg_lo:[0,1] neg_hi:[0,1]
v_pk_add_f32 v[66:67], v[66:67], v[226:227] neg_lo:[0,1] neg_hi:[0,1]
v_pk_add_f32 v[68:69], v[68:69], v[226:227] neg_lo:[0,1] neg_hi:[0,1]
v_pk_add_f32 v[70:71], v[70:71], v[226:227] neg_lo:[0,1] neg_hi:[0,1]
v_pk_add_f32 v[72:73], v[72:73], v[226:227] neg_lo:[0,1] neg_hi:[0,1]
v_pk_add_f32 v[74:75], v[74:75], v[226:227] neg_lo:[0,1] neg_hi:[0,1]
v_pk_add_f32 v[76:77], v[76:77], v[226:227] neg_lo:[0,1] neg_hi:[0,1]
v_pk_add_f32 v[78:79], v[78:79], v[226:227] neg_lo:[0,1] neg_hi:[0,1]
v_pk_add_f32 v[80:81], v[80:81], v[226:227] neg_lo:[0,1] neg_hi:[0,1]
v_pk_add_f32 v[82:83], v[82:83], v[226:227] neg_lo:[0,1] neg_hi:[0,1]
v_pk_add_f32 v[84:85], v[84:85], v[226:227] neg_lo:[0,1] neg_hi:[0,1]
v_pk_add_f32 v[86:87], v[86:87], v[226:227] neg_lo:[0,1] neg_hi:[0,1]
v_pk_add_f32 v[88:89], v[88:89], v[226:227] neg_lo:[0,1] neg_hi:[0,1]
v_pk_add_f32 v[90:91], v[90:91], v[226:227] neg_lo:[0,1] neg_hi:[0,1]
v_mov_b32 v220, v132
v_mov_b32 v221, v132
s_nop 1
v_permlane16_swap_b32 v220, v221
v_cndmask_b32 v220, v221, v220, s[58:59]
v_rcp_f32 v220, v220
s_nop 0
v_mul_f32 v128, v220, v128
v_mul_f32 v129, v220, v129
v_mul_f32 v130, v220, v130
v_mul_f32 v131, v220, v131
v_mul_f32 v132, v220, v132
v_mul_f32 v133, v220, v133
v_mul_f32 v134, v220, v134
v_mul_f32 v135, v220, v135
v_cvt_pk_bf16_f32 v222, v128, v129
v_cvt_pk_bf16_f32 v223, v130, v131
v_cvt_pk_bf16_f32 v224, v132, v133
v_cvt_pk_bf16_f32 v225, v134, v135
ds_write_b64 v229, v[222:223] offset:46080
v_cmp_eq_u32 vcc, s22, v240
s_nop 0
s_mov_b64 exec, vcc
ds_write_b64 v239, v[224:225] offset:48128
s_mov_b64 exec, -1
v_mov_b32 v92, 0
v_mov_b32 v93, 0
v_exp_f32 v24, v24
v_exp_f32 v25, v25
v_exp_f32 v26, v26
v_exp_f32 v27, v27
v_cvt_pk_bf16_f32 v94, v24, v25
v_cvt_pk_bf16_f32 v95, v26, v27
s_add_u32 s44, s44, 4096
s_add_u32 s70, s70, 4096
s_mov_b32 m0, s70
s_nop 0
buffer_load_dwordx4 v1, s[4:7], s44 offen offset:0 lds
v_exp_f32 v28, v28
v_exp_f32 v29, v29
v_exp_f32 v30, v30
v_exp_f32 v31, v31
v_mfma_f32_16x16x32_bf16 v[24:27], a[8:11], v[208:211], v[180:183]
v_cvt_pk_bf16_f32 v96, v28, v29
v_cvt_pk_bf16_f32 v97, v30, v31
s_mov_b32 m0, s70
s_nop 0
buffer_load_dwordx4 v1, s[4:7], s44 offen offset:1024 lds
v_exp_f32 v32, v32
v_exp_f32 v33, v33
v_exp_f32 v34, v34
v_exp_f32 v35, v35
v_mfma_f32_16x16x32_bf16 v[28:31], a[12:15], v[208:211], v[184:187]
v_cvt_pk_bf16_f32 v98, v32, v33
v_cvt_pk_bf16_f32 v99, v34, v35
s_mov_b32 m0, s70
s_nop 0
buffer_load_dwordx4 v1, s[4:7], s44 offen offset:2048 lds
v_exp_f32 v36, v36
v_exp_f32 v37, v37
v_exp_f32 v38, v38
v_exp_f32 v39, v39
v_mfma_f32_16x16x32_bf16 v[32:35], a[16:19], v[208:211], v[188:191]
v_cvt_pk_bf16_f32 v100, v36, v37
v_cvt_pk_bf16_f32 v101, v38, v39
s_mov_b32 m0, s70
s_nop 0
buffer_load_dwordx4 v1, s[4:7], s44 offen offset:3072 lds
v_exp_f32 v40, v40
v_exp_f32 v41, v41
v_exp_f32 v42, v42
v_exp_f32 v43, v43
v_mfma_f32_16x16x32_bf16 v[36:39], a[20:23], v[208:211], v[188:191]
v_cvt_pk_bf16_f32 v102, v40, v41
v_cvt_pk_bf16_f32 v103, v42, v43
s_add_u32 s44, s44, 4096
s_add_u32 s70, s70, 4096
s_mov_b32 m0, s70
s_nop 0
buffer_load_dwordx4 v1, s[4:7], s44 offen offset:0 lds
v_exp_f32 v44, v44
v_exp_f32 v45, v45
v_exp_f32 v46, v46
v_exp_f32 v47, v47
v_mfma_f32_16x16x32_bf16 v[40:43], a[24:27], v[208:211], v[188:191]
v_cvt_pk_bf16_f32 v104, v44, v45
v_cvt_pk_bf16_f32 v105, v46, v47
s_mov_b32 m0, s70
s_nop 0
buffer_load_dwordx4 v1, s[4:7], s44 offen offset:1024 lds
v_exp_f32 v48, v48
v_exp_f32 v49, v49
v_exp_f32 v50, v50
v_exp_f32 v51, v51
v_mfma_f32_16x16x32_bf16 v[44:47], a[28:31], v[208:211], v[188:191]
v_cvt_pk_bf16_f32 v106, v48, v49
v_cvt_pk_bf16_f32 v107, v50, v51
s_mov_b32 m0, s70
s_nop 0
buffer_load_dwordx4 v1, s[4:7], s44 offen offset:2048 lds
v_exp_f32 v52, v52
v_exp_f32 v53, v53
v_exp_f32 v54, v54
v_exp_f32 v55, v55
v_mfma_f32_16x16x32_bf16 v[48:51], a[32:35], v[208:211], v[192:195]
v_cvt_pk_bf16_f32 v108, v52, v53
v_cvt_pk_bf16_f32 v109, v54, v55
s_mov_b32 m0, s70
s_nop 0
buffer_load_dwordx4 v1, s[4:7], s44 offen offset:3072 lds
v_exp_f32 v56, v56
v_exp_f32 v57, v57
v_exp_f32 v58, v58
v_exp_f32 v59, v59
v_mfma_f32_16x16x32_bf16 v[52:55], a[36:39], v[208:211], v[192:195]
v_cvt_pk_bf16_f32 v110, v56, v57
v_cvt_pk_bf16_f32 v111, v58, v59
s_add_u32 s44, s44, 4096
s_add_u32 s70, s70, 4096
s_mov_b32 m0, s70
s_nop 0
buffer_load_dwordx4 v1, s[4:7], s44 offen offset:0 lds
v_exp_f32 v60, v60
v_exp_f32 v61, v61
v_exp_f32 v62, v62
v_exp_f32 v63, v63
v_mfma_f32_16x16x32_bf16 v[56:59], a[40:43], v[208:211], v[192:195]
v_cvt_pk_bf16_f32 v112, v60, v61
v_cvt_pk_bf16_f32 v113, v62, v63
v_exp_f32 v64, v64
v_exp_f32 v65, v65
v_exp_f32 v66, v66
v_exp_f32 v67, v67
v_mfma_f32_16x16x32_bf16 v[60:63], a[44:47], v[208:211], v[192:195]
v_cvt_pk_bf16_f32 v114, v64, v65
v_cvt_pk_bf16_f32 v115, v66, v67
buffer_load_dwordx4 a[132:135], v1, s[4:7], s64 offen offset:3072
v_exp_f32 v68, v68
v_exp_f32 v69, v69
v_exp_f32 v70, v70
v_exp_f32 v71, v71
v_mfma_f32_16x16x32_bf16 v[64:67], a[48:51], v[208:211], v[196:199]
v_cvt_pk_bf16_f32 v116, v68, v69
v_cvt_pk_bf16_f32 v117, v70, v71
v_exp_f32 v72, v72
v_exp_f32 v73, v73
v_exp_f32 v74, v74
v_exp_f32 v75, v75
v_mfma_f32_16x16x32_bf16 v[68:71], a[52:55], v[208:211], v[196:199]
v_cvt_pk_bf16_f32 v118, v72, v73
v_cvt_pk_bf16_f32 v119, v74, v75
v_exp_f32 v76, v76
v_exp_f32 v77, v77
v_exp_f32 v78, v78
v_exp_f32 v79, v79
v_mfma_f32_16x16x32_bf16 v[72:75], a[56:59], v[208:211], v[196:199]
v_cvt_pk_bf16_f32 v120, v76, v77
v_cvt_pk_bf16_f32 v121, v78, v79
s_add_u32 s64, s64, 4096
buffer_load_dwordx4 a[136:139], v1, s[4:7], s64 offen
v_exp_f32 v80, v80
v_exp_f32 v81, v81
v_exp_f32 v82, v82
v_exp_f32 v83, v83
v_mfma_f32_16x16x32_bf16 v[76:79], a[60:63], v[208:211], v[196:199]
v_cvt_pk_bf16_f32 v122, v80, v81
v_cvt_pk_bf16_f32 v123, v82, v83
v_exp_f32 v84, v84
v_exp_f32 v85, v85
v_exp_f32 v86, v86
v_exp_f32 v87, v87
v_mfma_f32_16x16x32_bf16 v[80:83], a[64:67], v[208:211], 0
v_cvt_pk_bf16_f32 v124, v84, v85
v_cvt_pk_bf16_f32 v125, v86, v87
v_exp_f32 v88, v88
v_exp_f32 v89, v89
v_exp_f32 v90, v90
v_exp_f32 v91, v91
v_mfma_f32_16x16x32_bf16 v[84:87], a[104:107], v[208:211], 0
v_cvt_pk_bf16_f32 v126, v88, v89
v_cvt_pk_bf16_f32 v127, v90, v91
buffer_load_dwordx4 a[140:143], v1, s[4:7], s64 offen offset:1024
s_waitcnt vmcnt(33)
v_mfma_f32_16x16x32_bf16 v[88:91], a[108:111], v[208:211], v[176:179]
buffer_load_dwordx4 a[144:147], v1, s[4:7], s64 offen offset:2048
buffer_load_dwordx4 a[148:151], v1, s[4:7], s64 offen offset:3072
s_add_u32 s64, s64, 4096
buffer_load_dwordx4 a[152:155], v1, s[4:7], s64 offen
v_mfma_f32_16x16x32_bf16 v[128:131], a[68:71], v[92:95], 0
v_max3_f32 v226, v24, v25, v26
v_max3_f32 v228, v27, v28, v29
v_max3_f32 v226, v226, v30, v31
v_mfma_f32_16x16x32_bf16 v[132:135], v[136:139], v[92:95], 0
v_max3_f32 v228, v228, v32, v33
v_max3_f32 v226, v226, v34, v35
v_max3_f32 v228, v228, v36, v37
v_mfma_f32_16x16x32_bf16 v[128:131], a[72:75], v[96:99], v[128:131]
v_max3_f32 v226, v226, v38, v39
v_max3_f32 v228, v228, v40, v41
v_max3_f32 v226, v226, v42, v43
v_mfma_f32_16x16x32_bf16 v[132:135], v[140:143], v[96:99], v[132:135]
v_max3_f32 v228, v228, v44, v45
v_max3_f32 v226, v226, v46, v47
v_max3_f32 v228, v228, v48, v49
v_mfma_f32_16x16x32_bf16 v[128:131], a[76:79], v[100:103], v[128:131]
v_max3_f32 v226, v226, v50, v51
v_max3_f32 v228, v228, v52, v53
v_max3_f32 v226, v226, v54, v55
v_mfma_f32_16x16x32_bf16 v[132:135], v[144:147], v[100:103], v[132:135]
v_max3_f32 v228, v228, v56, v57
v_max3_f32 v226, v226, v58, v59
v_max3_f32 v228, v228, v60, v61
v_mfma_f32_16x16x32_bf16 v[128:131], a[80:83], v[104:107], v[128:131]
v_max3_f32 v226, v226, v62, v63
v_max3_f32 v228, v228, v64, v65
v_max3_f32 v226, v226, v66, v67
v_mfma_f32_16x16x32_bf16 v[132:135], v[148:151], v[104:107], v[132:135]
v_max3_f32 v228, v228, v68, v69
v_max3_f32 v226, v226, v70, v71
v_max3_f32 v228, v228, v72, v73
v_mfma_f32_16x16x32_bf16 v[128:131], a[84:87], v[108:111], v[128:131]
v_max3_f32 v226, v226, v74, v75
v_max3_f32 v228, v228, v76, v77
v_max3_f32 v226, v226, v78, v79
v_mfma_f32_16x16x32_bf16 v[132:135], v[152:155], v[108:111], v[132:135]
v_max3_f32 v228, v228, v80, v81
v_max3_f32 v226, v226, v82, v83
v_max3_f32 v228, v228, v84, v85
v_mfma_f32_16x16x32_bf16 v[128:131], a[88:91], v[112:115], v[128:131]
v_max3_f32 v226, v226, v86, v87
v_max3_f32 v228, v228, v88, v89
v_max3_f32 v226, v226, v90, v91
v_mfma_f32_16x16x32_bf16 v[132:135], v[156:159], v[112:115], v[132:135]
v_max_f32 v226, v226, v228
v_mov_b32 v227, v226
s_nop 1
v_permlane32_swap_b32 v226, v227
v_max_f32 v226, v226, v227
v_mov_b32 v227, v226
s_nop 1
v_permlane16_swap_b32 v226, v227
v_max_f32 v226, v226, v227
v_mov_b32 v227, v226
v_pk_add_f32 v[24:25], v[24:25], v[226:227] neg_lo:[0,1] neg_hi:[0,1]
v_pk_add_f32 v[26:27], v[26:27], v[226:227] neg_lo:[0,1] neg_hi:[0,1]
v_mfma_f32_16x16x32_bf16 v[128:131], a[92:95], v[116:119], v[128:131]
v_pk_add_f32 v[28:29], v[28:29], v[226:227] neg_lo:[0,1] neg_hi:[0,1]
v_pk_add_f32 v[30:31], v[30:31], v[226:227] neg_lo:[0,1] neg_hi:[0,1]
v_pk_add_f32 v[32:33], v[32:33], v[226:227] neg_lo:[0,1] neg_hi:[0,1]
v_mfma_f32_16x16x32_bf16 v[132:135], v[160:163], v[116:119], v[132:135]
v_pk_add_f32 v[34:35], v[34:35], v[226:227] neg_lo:[0,1] neg_hi:[0,1]
v_pk_add_f32 v[36:37], v[36:37], v[226:227] neg_lo:[0,1] neg_hi:[0,1]
v_pk_add_f32 v[38:39], v[38:39], v[226:227] neg_lo:[0,1] neg_hi:[0,1]
v_mfma_f32_16x16x32_bf16 v[128:131], a[96:99], v[120:123], v[128:131]
v_pk_add_f32 v[40:41], v[40:41], v[226:227] neg_lo:[0,1] neg_hi:[0,1]
v_pk_add_f32 v[42:43], v[42:43], v[226:227] neg_lo:[0,1] neg_hi:[0,1]
v_pk_add_f32 v[44:45], v[44:45], v[226:227] neg_lo:[0,1] neg_hi:[0,1]
v_mfma_f32_16x16x32_bf16 v[132:135], v[164:167], v[120:123], v[132:135]
v_pk_add_f32 v[46:47], v[46:47], v[226:227] neg_lo:[0,1] neg_hi:[0,1]
v_pk_add_f32 v[48:49], v[48:49], v[226:227] neg_lo:[0,1] neg_hi:[0,1]
v_pk_add_f32 v[50:51], v[50:51], v[226:227] neg_lo:[0,1] neg_hi:[0,1]
v_mfma_f32_16x16x32_bf16 v[128:131], a[100:103], v[124:127], v[128:131]
v_pk_add_f32 v[52:53], v[52:53], v[226:227] neg_lo:[0,1] neg_hi:[0,1]
v_pk_add_f32 v[54:55], v[54:55], v[226:227] neg_lo:[0,1] neg_hi:[0,1]
v_pk_add_f32 v[56:57], v[56:57], v[226:227] neg_lo:[0,1] neg_hi:[0,1]
v_mfma_f32_16x16x32_bf16 v[132:135], v[168:171], v[124:127], v[132:135]
v_pk_add_f32 v[58:59], v[58:59], v[226:227] neg_lo:[0,1] neg_hi:[0,1]
v_pk_add_f32 v[60:61], v[60:61], v[226:227] neg_lo:[0,1] neg_hi:[0,1]
v_pk_add_f32 v[62:63], v[62:63], v[226:227] neg_lo:[0,1] neg_hi:[0,1]
v_pk_add_f32 v[64:65], v[64:65], v[226:227] neg_lo:[0,1] neg_hi:[0,1]
v_pk_add_f32 v[66:67], v[66:67], v[226:227] neg_lo:[0,1] neg_hi:[0,1]
v_pk_add_f32 v[68:69], v[68:69], v[226:227] neg_lo:[0,1] neg_hi:[0,1]
v_pk_add_f32 v[70:71], v[70:71], v[226:227] neg_lo:[0,1] neg_hi:[0,1]
v_pk_add_f32 v[72:73], v[72:73], v[226:227] neg_lo:[0,1] neg_hi:[0,1]
v_pk_add_f32 v[74:75], v[74:75], v[226:227] neg_lo:[0,1] neg_hi:[0,1]
v_pk_add_f32 v[76:77], v[76:77], v[226:227] neg_lo:[0,1] neg_hi:[0,1]
v_pk_add_f32 v[78:79], v[78:79], v[226:227] neg_lo:[0,1] neg_hi:[0,1]
v_pk_add_f32 v[80:81], v[80:81], v[226:227] neg_lo:[0,1] neg_hi:[0,1]
v_pk_add_f32 v[82:83], v[82:83], v[226:227] neg_lo:[0,1] neg_hi:[0,1]
v_pk_add_f32 v[84:85], v[84:85], v[226:227] neg_lo:[0,1] neg_hi:[0,1]
v_pk_add_f32 v[86:87], v[86:87], v[226:227] neg_lo:[0,1] neg_hi:[0,1]
v_pk_add_f32 v[88:89], v[88:89], v[226:227] neg_lo:[0,1] neg_hi:[0,1]
v_pk_add_f32 v[90:91], v[90:91], v[226:227] neg_lo:[0,1] neg_hi:[0,1]
v_mov_b32 v220, v132
v_mov_b32 v221, v132
s_nop 1
v_permlane16_swap_b32 v220, v221
v_cndmask_b32 v220, v221, v220, s[58:59]
v_rcp_f32 v220, v220
s_nop 0
v_mul_f32 v128, v220, v128
v_mul_f32 v129, v220, v129
v_mul_f32 v130, v220, v130
v_mul_f32 v131, v220, v131
v_mul_f32 v132, v220, v132
v_mul_f32 v133, v220, v133
v_mul_f32 v134, v220, v134
v_mul_f32 v135, v220, v135
v_cvt_pk_bf16_f32 v222, v128, v129
v_cvt_pk_bf16_f32 v223, v130, v131
v_cvt_pk_bf16_f32 v224, v132, v133
v_cvt_pk_bf16_f32 v225, v134, v135
ds_write_b64 v229, v[222:223] offset:48640
v_cmp_eq_u32 vcc, s22, v240
s_nop 0
s_mov_b64 exec, vcc
ds_write_b64 v239, v[224:225] offset:50688
s_mov_b64 exec, -1
v_mov_b32 v126, 0
v_mov_b32 v127, 0
v_exp_f32 v24, v24
v_exp_f32 v25, v25
v_exp_f32 v26, v26
v_exp_f32 v27, v27
v_cvt_pk_bf16_f32 v92, v24, v25
v_cvt_pk_bf16_f32 v93, v26, v27
v_exp_f32 v28, v28
v_exp_f32 v29, v29
v_exp_f32 v30, v30
v_exp_f32 v31, v31
v_mfma_f32_16x16x32_bf16 v[24:27], a[12:15], v[212:215], v[180:183]
v_cvt_pk_bf16_f32 v94, v28, v29
v_cvt_pk_bf16_f32 v95, v30, v31
buffer_load_dwordx4 a[156:159], v1, s[4:7], s64 offen offset:1024
v_exp_f32 v32, v32
v_exp_f32 v33, v33
v_exp_f32 v34, v34
v_exp_f32 v35, v35
v_mfma_f32_16x16x32_bf16 v[28:31], a[16:19], v[212:215], v[188:191]
v_cvt_pk_bf16_f32 v96, v32, v33
v_cvt_pk_bf16_f32 v97, v34, v35
v_exp_f32 v36, v36
v_exp_f32 v37, v37
v_exp_f32 v38, v38
v_exp_f32 v39, v39
v_mfma_f32_16x16x32_bf16 v[32:35], a[20:23], v[212:215], v[188:191]
v_cvt_pk_bf16_f32 v98, v36, v37
v_cvt_pk_bf16_f32 v99, v38, v39
v_exp_f32 v40, v40
v_exp_f32 v41, v41
v_exp_f32 v42, v42
v_exp_f32 v43, v43
v_mfma_f32_16x16x32_bf16 v[36:39], a[24:27], v[212:215], v[188:191]
v_cvt_pk_bf16_f32 v100, v40, v41
v_cvt_pk_bf16_f32 v101, v42, v43
buffer_load_dwordx4 a[160:163], v1, s[4:7], s64 offen offset:2048
v_exp_f32 v44, v44
v_exp_f32 v45, v45
v_exp_f32 v46, v46
v_exp_f32 v47, v47
v_mfma_f32_16x16x32_bf16 v[40:43], a[28:31], v[212:215], v[188:191]
v_cvt_pk_bf16_f32 v102, v44, v45
v_cvt_pk_bf16_f32 v103, v46, v47
v_exp_f32 v48, v48
v_exp_f32 v49, v49
v_exp_f32 v50, v50
v_exp_f32 v51, v51
v_mfma_f32_16x16x32_bf16 v[44:47], a[32:35], v[212:215], v[192:195]
v_cvt_pk_bf16_f32 v104, v48, v49
v_cvt_pk_bf16_f32 v105, v50, v51
v_exp_f32 v52, v52
v_exp_f32 v53, v53
v_exp_f32 v54, v54
v_exp_f32 v55, v55
v_mfma_f32_16x16x32_bf16 v[48:51], a[36:39], v[212:215], v[192:195]
v_cvt_pk_bf16_f32 v106, v52, v53
v_cvt_pk_bf16_f32 v107, v54, v55
buffer_load_dwordx4 a[164:167], v1, s[4:7], s64 offen offset:3072
v_exp_f32 v56, v56
v_exp_f32 v57, v57
v_exp_f32 v58, v58
v_exp_f32 v59, v59
v_mfma_f32_16x16x32_bf16 v[52:55], a[40:43], v[212:215], v[192:195]
v_cvt_pk_bf16_f32 v108, v56, v57
v_cvt_pk_bf16_f32 v109, v58, v59
v_exp_f32 v60, v60
v_exp_f32 v61, v61
v_exp_f32 v62, v62
v_exp_f32 v63, v63
v_mfma_f32_16x16x32_bf16 v[56:59], a[44:47], v[212:215], v[192:195]
v_cvt_pk_bf16_f32 v110, v60, v61
v_cvt_pk_bf16_f32 v111, v62, v63
v_exp_f32 v64, v64
v_exp_f32 v65, v65
v_exp_f32 v66, v66
v_exp_f32 v67, v67
v_mfma_f32_16x16x32_bf16 v[60:63], a[48:51], v[212:215], v[196:199]
v_cvt_pk_bf16_f32 v112, v64, v65
v_cvt_pk_bf16_f32 v113, v66, v67
s_add_u32 s64, s64, 4096
buffer_load_dwordx4 a[168:171], v1, s[4:7], s64 offen
v_exp_f32 v68, v68
v_exp_f32 v69, v69
v_exp_f32 v70, v70
v_exp_f32 v71, v71
v_mfma_f32_16x16x32_bf16 v[64:67], a[52:55], v[212:215], v[196:199]
v_cvt_pk_bf16_f32 v114, v68, v69
v_cvt_pk_bf16_f32 v115, v70, v71
v_exp_f32 v72, v72
v_exp_f32 v73, v73
v_exp_f32 v74, v74
v_exp_f32 v75, v75
v_mfma_f32_16x16x32_bf16 v[68:71], a[56:59], v[212:215], v[196:199]
v_cvt_pk_bf16_f32 v116, v72, v73
v_cvt_pk_bf16_f32 v117, v74, v75
v_exp_f32 v76, v76
v_exp_f32 v77, v77
v_exp_f32 v78, v78
v_exp_f32 v79, v79
v_mfma_f32_16x16x32_bf16 v[72:75], a[60:63], v[212:215], v[196:199]
v_cvt_pk_bf16_f32 v118, v76, v77
v_cvt_pk_bf16_f32 v119, v78, v79
buffer_load_dwordx4 a[172:175], v1, s[4:7], s64 offen offset:1024
v_exp_f32 v80, v80
v_exp_f32 v81, v81
v_exp_f32 v82, v82
v_exp_f32 v83, v83
v_mfma_f32_16x16x32_bf16 v[76:79], a[64:67], v[212:215], 0
v_cvt_pk_bf16_f32 v120, v80, v81
v_cvt_pk_bf16_f32 v121, v82, v83
v_exp_f32 v84, v84
v_exp_f32 v85, v85
v_exp_f32 v86, v86
v_exp_f32 v87, v87
v_mfma_f32_16x16x32_bf16 v[80:83], a[104:107], v[212:215], 0
v_cvt_pk_bf16_f32 v122, v84, v85
v_cvt_pk_bf16_f32 v123, v86, v87
v_exp_f32 v88, v88
v_exp_f32 v89, v89
v_exp_f32 v90, v90
v_exp_f32 v91, v91
v_mfma_f32_16x16x32_bf16 v[84:87], a[108:111], v[212:215], 0
v_cvt_pk_bf16_f32 v124, v88, v89
v_cvt_pk_bf16_f32 v125, v90, v91
buffer_load_dwordx4 a[176:179], v1, s[4:7], s64 offen offset:2048
s_waitcnt vmcnt(41)
v_mfma_f32_16x16x32_bf16 v[88:91], a[112:115], v[212:215], v[176:179]
buffer_load_dwordx4 a[180:183], v1, s[4:7], s64 offen offset:3072
s_add_u32 s64, s64, 4096
buffer_load_dwordx4 a[184:187], v1, s[4:7], s64 offen
buffer_load_dwordx4 a[188:191], v1, s[4:7], s64 offen offset:1024
v_mfma_f32_16x16x32_bf16 v[128:131], a[72:75], v[92:95], 0
v_max3_f32 v226, v24, v25, v26
v_max3_f32 v228, v27, v28, v29
v_max3_f32 v226, v226, v30, v31
v_mfma_f32_16x16x32_bf16 v[132:135], v[140:143], v[92:95], 0
v_max3_f32 v228, v228, v32, v33
v_max3_f32 v226, v226, v34, v35
v_max3_f32 v228, v228, v36, v37
v_mfma_f32_16x16x32_bf16 v[128:131], a[76:79], v[96:99], v[128:131]
v_max3_f32 v226, v226, v38, v39
v_max3_f32 v228, v228, v40, v41
v_max3_f32 v226, v226, v42, v43
v_mfma_f32_16x16x32_bf16 v[132:135], v[144:147], v[96:99], v[132:135]
v_max3_f32 v228, v228, v44, v45
v_max3_f32 v226, v226, v46, v47
v_max3_f32 v228, v228, v48, v49
v_mfma_f32_16x16x32_bf16 v[128:131], a[80:83], v[100:103], v[128:131]
v_max3_f32 v226, v226, v50, v51
v_max3_f32 v228, v228, v52, v53
v_max3_f32 v226, v226, v54, v55
v_mfma_f32_16x16x32_bf16 v[132:135], v[148:151], v[100:103], v[132:135]
v_max3_f32 v228, v228, v56, v57
v_max3_f32 v226, v226, v58, v59
v_max3_f32 v228, v228, v60, v61
v_mfma_f32_16x16x32_bf16 v[128:131], a[84:87], v[104:107], v[128:131]
v_max3_f32 v226, v226, v62, v63
v_max3_f32 v228, v228, v64, v65
v_max3_f32 v226, v226, v66, v67
v_mfma_f32_16x16x32_bf16 v[132:135], v[152:155], v[104:107], v[132:135]
v_max3_f32 v228, v228, v68, v69
v_max3_f32 v226, v226, v70, v71
v_max3_f32 v228, v228, v72, v73
v_mfma_f32_16x16x32_bf16 v[128:131], a[88:91], v[108:111], v[128:131]
v_max3_f32 v226, v226, v74, v75
v_max3_f32 v228, v228, v76, v77
v_max3_f32 v226, v226, v78, v79
v_mfma_f32_16x16x32_bf16 v[132:135], v[156:159], v[108:111], v[132:135]
v_max3_f32 v228, v228, v80, v81
v_max3_f32 v226, v226, v82, v83
v_max3_f32 v228, v228, v84, v85
v_mfma_f32_16x16x32_bf16 v[128:131], a[92:95], v[112:115], v[128:131]
v_max3_f32 v226, v226, v86, v87
v_max3_f32 v228, v228, v88, v89
v_max3_f32 v226, v226, v90, v91
v_mfma_f32_16x16x32_bf16 v[132:135], v[160:163], v[112:115], v[132:135]
v_max_f32 v226, v226, v228
v_mov_b32 v227, v226
s_nop 1
v_permlane32_swap_b32 v226, v227
v_max_f32 v226, v226, v227
v_mov_b32 v227, v226
s_nop 1
v_permlane16_swap_b32 v226, v227
v_max_f32 v226, v226, v227
v_mov_b32 v227, v226
v_pk_add_f32 v[24:25], v[24:25], v[226:227] neg_lo:[0,1] neg_hi:[0,1]
v_pk_add_f32 v[26:27], v[26:27], v[226:227] neg_lo:[0,1] neg_hi:[0,1]
v_mfma_f32_16x16x32_bf16 v[128:131], a[96:99], v[116:119], v[128:131]
v_pk_add_f32 v[28:29], v[28:29], v[226:227] neg_lo:[0,1] neg_hi:[0,1]
v_pk_add_f32 v[30:31], v[30:31], v[226:227] neg_lo:[0,1] neg_hi:[0,1]
v_pk_add_f32 v[32:33], v[32:33], v[226:227] neg_lo:[0,1] neg_hi:[0,1]
v_mfma_f32_16x16x32_bf16 v[132:135], v[164:167], v[116:119], v[132:135]
v_pk_add_f32 v[34:35], v[34:35], v[226:227] neg_lo:[0,1] neg_hi:[0,1]
v_pk_add_f32 v[36:37], v[36:37], v[226:227] neg_lo:[0,1] neg_hi:[0,1]
v_pk_add_f32 v[38:39], v[38:39], v[226:227] neg_lo:[0,1] neg_hi:[0,1]
v_mfma_f32_16x16x32_bf16 v[128:131], a[100:103], v[120:123], v[128:131]
v_pk_add_f32 v[40:41], v[40:41], v[226:227] neg_lo:[0,1] neg_hi:[0,1]
v_pk_add_f32 v[42:43], v[42:43], v[226:227] neg_lo:[0,1] neg_hi:[0,1]
v_pk_add_f32 v[44:45], v[44:45], v[226:227] neg_lo:[0,1] neg_hi:[0,1]
v_mfma_f32_16x16x32_bf16 v[132:135], v[168:171], v[120:123], v[132:135]
v_pk_add_f32 v[46:47], v[46:47], v[226:227] neg_lo:[0,1] neg_hi:[0,1]
v_pk_add_f32 v[48:49], v[48:49], v[226:227] neg_lo:[0,1] neg_hi:[0,1]
v_pk_add_f32 v[50:51], v[50:51], v[226:227] neg_lo:[0,1] neg_hi:[0,1]
s_waitcnt vmcnt(43)
v_mfma_f32_16x16x32_bf16 v[128:131], a[116:119], v[124:127], v[128:131]
v_pk_add_f32 v[52:53], v[52:53], v[226:227] neg_lo:[0,1] neg_hi:[0,1]
v_pk_add_f32 v[54:55], v[54:55], v[226:227] neg_lo:[0,1] neg_hi:[0,1]
v_pk_add_f32 v[56:57], v[56:57], v[226:227] neg_lo:[0,1] neg_hi:[0,1]
v_mfma_f32_16x16x32_bf16 v[132:135], v[172:175], v[124:127], v[132:135]
v_pk_add_f32 v[58:59], v[58:59], v[226:227] neg_lo:[0,1] neg_hi:[0,1]
v_pk_add_f32 v[60:61], v[60:61], v[226:227] neg_lo:[0,1] neg_hi:[0,1]
v_pk_add_f32 v[62:63], v[62:63], v[226:227] neg_lo:[0,1] neg_hi:[0,1]
v_pk_add_f32 v[64:65], v[64:65], v[226:227] neg_lo:[0,1] neg_hi:[0,1]
v_pk_add_f32 v[66:67], v[66:67], v[226:227] neg_lo:[0,1] neg_hi:[0,1]
v_pk_add_f32 v[68:69], v[68:69], v[226:227] neg_lo:[0,1] neg_hi:[0,1]
v_pk_add_f32 v[70:71], v[70:71], v[226:227] neg_lo:[0,1] neg_hi:[0,1]
v_pk_add_f32 v[72:73], v[72:73], v[226:227] neg_lo:[0,1] neg_hi:[0,1]
v_pk_add_f32 v[74:75], v[74:75], v[226:227] neg_lo:[0,1] neg_hi:[0,1]
v_pk_add_f32 v[76:77], v[76:77], v[226:227] neg_lo:[0,1] neg_hi:[0,1]
v_pk_add_f32 v[78:79], v[78:79], v[226:227] neg_lo:[0,1] neg_hi:[0,1]
v_pk_add_f32 v[80:81], v[80:81], v[226:227] neg_lo:[0,1] neg_hi:[0,1]
v_pk_add_f32 v[82:83], v[82:83], v[226:227] neg_lo:[0,1] neg_hi:[0,1]
v_pk_add_f32 v[84:85], v[84:85], v[226:227] neg_lo:[0,1] neg_hi:[0,1]
v_pk_add_f32 v[86:87], v[86:87], v[226:227] neg_lo:[0,1] neg_hi:[0,1]
v_pk_add_f32 v[88:89], v[88:89], v[226:227] neg_lo:[0,1] neg_hi:[0,1]
v_pk_add_f32 v[90:91], v[90:91], v[226:227] neg_lo:[0,1] neg_hi:[0,1]
v_mov_b32 v220, v132
v_mov_b32 v221, v132
s_nop 1
v_permlane16_swap_b32 v220, v221
v_cndmask_b32 v220, v221, v220, s[58:59]
v_rcp_f32 v220, v220
s_nop 0
v_mul_f32 v128, v220, v128
v_mul_f32 v129, v220, v129
v_mul_f32 v130, v220, v130
v_mul_f32 v131, v220, v131
v_mul_f32 v132, v220, v132
v_mul_f32 v133, v220, v133
v_mul_f32 v134, v220, v134
v_mul_f32 v135, v220, v135
v_cvt_pk_bf16_f32 v222, v128, v129
v_cvt_pk_bf16_f32 v223, v130, v131
v_cvt_pk_bf16_f32 v224, v132, v133
v_cvt_pk_bf16_f32 v225, v134, v135
ds_write_b64 v229, v[222:223] offset:51200
v_cmp_eq_u32 vcc, s22, v240
s_nop 0
s_mov_b64 exec, vcc
ds_write_b64 v239, v[224:225] offset:53248
s_mov_b64 exec, -1
v_mov_b32 v92, 0
v_mov_b32 v93, 0
v_exp_f32 v24, v24
v_exp_f32 v25, v25
v_exp_f32 v26, v26
v_exp_f32 v27, v27
v_cvt_pk_bf16_f32 v94, v24, v25
v_cvt_pk_bf16_f32 v95, v26, v27
v_exp_f32 v28, v28
v_exp_f32 v29, v29
v_exp_f32 v30, v30
v_exp_f32 v31, v31
v_cvt_pk_bf16_f32 v96, v28, v29
v_cvt_pk_bf16_f32 v97, v30, v31
buffer_load_dwordx4 a[192:195], v1, s[4:7], s64 offen offset:2048
v_exp_f32 v32, v32
v_exp_f32 v33, v33
v_exp_f32 v34, v34
v_exp_f32 v35, v35
v_cvt_pk_bf16_f32 v98, v32, v33
v_cvt_pk_bf16_f32 v99, v34, v35
v_exp_f32 v36, v36
v_exp_f32 v37, v37
v_exp_f32 v38, v38
v_exp_f32 v39, v39
v_cvt_pk_bf16_f32 v100, v36, v37
v_cvt_pk_bf16_f32 v101, v38, v39
v_exp_f32 v40, v40
v_exp_f32 v41, v41
v_exp_f32 v42, v42
v_exp_f32 v43, v43
v_cvt_pk_bf16_f32 v102, v40, v41
v_cvt_pk_bf16_f32 v103, v42, v43
buffer_load_dwordx4 a[196:199], v1, s[4:7], s64 offen offset:3072
v_exp_f32 v44, v44
v_exp_f32 v45, v45
v_exp_f32 v46, v46
v_exp_f32 v47, v47
v_cvt_pk_bf16_f32 v104, v44, v45
v_cvt_pk_bf16_f32 v105, v46, v47
v_exp_f32 v48, v48
v_exp_f32 v49, v49
v_exp_f32 v50, v50
v_exp_f32 v51, v51
v_cvt_pk_bf16_f32 v106, v48, v49
v_cvt_pk_bf16_f32 v107, v50, v51
v_exp_f32 v52, v52
v_exp_f32 v53, v53
v_exp_f32 v54, v54
v_exp_f32 v55, v55
v_cvt_pk_bf16_f32 v108, v52, v53
v_cvt_pk_bf16_f32 v109, v54, v55
s_add_u32 s64, s64, 4096
buffer_load_dwordx4 a[200:203], v1, s[4:7], s64 offen
v_exp_f32 v56, v56
v_exp_f32 v57, v57
v_exp_f32 v58, v58
v_exp_f32 v59, v59
v_cvt_pk_bf16_f32 v110, v56, v57
v_cvt_pk_bf16_f32 v111, v58, v59
v_exp_f32 v60, v60
v_exp_f32 v61, v61
v_exp_f32 v62, v62
v_exp_f32 v63, v63
v_cvt_pk_bf16_f32 v112, v60, v61
v_cvt_pk_bf16_f32 v113, v62, v63
v_exp_f32 v64, v64
v_exp_f32 v65, v65
v_exp_f32 v66, v66
v_exp_f32 v67, v67
v_cvt_pk_bf16_f32 v114, v64, v65
v_cvt_pk_bf16_f32 v115, v66, v67
buffer_load_dwordx4 a[204:207], v1, s[4:7], s64 offen offset:1024
v_exp_f32 v68, v68
v_exp_f32 v69, v69
v_exp_f32 v70, v70
v_exp_f32 v71, v71
v_cvt_pk_bf16_f32 v116, v68, v69
v_cvt_pk_bf16_f32 v117, v70, v71
v_exp_f32 v72, v72
v_exp_f32 v73, v73
v_exp_f32 v74, v74
v_exp_f32 v75, v75
v_cvt_pk_bf16_f32 v118, v72, v73
v_cvt_pk_bf16_f32 v119, v74, v75
v_exp_f32 v76, v76
v_exp_f32 v77, v77
v_exp_f32 v78, v78
v_exp_f32 v79, v79
v_cvt_pk_bf16_f32 v120, v76, v77
v_cvt_pk_bf16_f32 v121, v78, v79
buffer_load_dwordx4 a[208:211], v1, s[4:7], s64 offen offset:2048
v_exp_f32 v80, v80
v_exp_f32 v81, v81
v_exp_f32 v82, v82
v_exp_f32 v83, v83
v_cvt_pk_bf16_f32 v122, v80, v81
v_cvt_pk_bf16_f32 v123, v82, v83
v_exp_f32 v84, v84
v_exp_f32 v85, v85
v_exp_f32 v86, v86
v_exp_f32 v87, v87
v_cvt_pk_bf16_f32 v124, v84, v85
v_cvt_pk_bf16_f32 v125, v86, v87
v_exp_f32 v88, v88
v_exp_f32 v89, v89
v_exp_f32 v90, v90
v_exp_f32 v91, v91
v_cvt_pk_bf16_f32 v126, v88, v89
v_cvt_pk_bf16_f32 v127, v90, v91
buffer_load_dwordx4 a[212:215], v1, s[4:7], s64 offen offset:3072
s_add_u32 s64, s64, 4096
buffer_load_dwordx4 a[216:219], v1, s[4:7], s64 offen
buffer_load_dwordx4 a[220:223], v1, s[4:7], s64 offen offset:1024
buffer_load_dwordx4 a[224:227], v1, s[4:7], s64 offen offset:2048
v_mfma_f32_16x16x32_bf16 v[128:131], a[72:75], v[92:95], 0
v_mfma_f32_16x16x32_bf16 v[132:135], v[140:143], v[92:95], 0
v_mfma_f32_16x16x32_bf16 v[128:131], a[76:79], v[96:99], v[128:131]
v_mfma_f32_16x16x32_bf16 v[132:135], v[144:147], v[96:99], v[132:135]
v_mfma_f32_16x16x32_bf16 v[128:131], a[80:83], v[100:103], v[128:131]
v_mfma_f32_16x16x32_bf16 v[132:135], v[148:151], v[100:103], v[132:135]
v_mfma_f32_16x16x32_bf16 v[128:131], a[84:87], v[104:107], v[128:131]
v_mfma_f32_16x16x32_bf16 v[132:135], v[152:155], v[104:107], v[132:135]
v_mfma_f32_16x16x32_bf16 v[128:131], a[88:91], v[108:111], v[128:131]
v_mfma_f32_16x16x32_bf16 v[132:135], v[156:159], v[108:111], v[132:135]
v_mfma_f32_16x16x32_bf16 v[128:131], a[92:95], v[112:115], v[128:131]
v_mfma_f32_16x16x32_bf16 v[132:135], v[160:163], v[112:115], v[132:135]
v_mfma_f32_16x16x32_bf16 v[128:131], a[96:99], v[116:119], v[128:131]
v_mfma_f32_16x16x32_bf16 v[132:135], v[164:167], v[116:119], v[132:135]
v_mfma_f32_16x16x32_bf16 v[128:131], a[100:103], v[120:123], v[128:131]
v_mfma_f32_16x16x32_bf16 v[132:135], v[168:171], v[120:123], v[132:135]
v_mfma_f32_16x16x32_bf16 v[128:131], a[116:119], v[124:127], v[128:131]
v_mfma_f32_16x16x32_bf16 v[132:135], v[172:175], v[124:127], v[132:135]
s_nop 7
v_mov_b32 v220, v132
v_mov_b32 v221, v132
s_nop 1
v_permlane16_swap_b32 v220, v221
v_cndmask_b32 v220, v221, v220, s[58:59]
v_rcp_f32 v220, v220
s_nop 0
v_mul_f32 v128, v220, v128
v_mul_f32 v129, v220, v129
v_mul_f32 v130, v220, v130
v_mul_f32 v131, v220, v131
v_mul_f32 v132, v220, v132
v_mul_f32 v133, v220, v133
v_mul_f32 v134, v220, v134
v_mul_f32 v135, v220, v135
v_cvt_pk_bf16_f32 v222, v128, v129
v_cvt_pk_bf16_f32 v223, v130, v131
v_cvt_pk_bf16_f32 v224, v132, v133
v_cvt_pk_bf16_f32 v225, v134, v135
ds_write_b64 v229, v[222:223] offset:53760
v_cmp_eq_u32 vcc, s22, v240
s_nop 0
s_mov_b64 exec, vcc
ds_write_b64 v239, v[224:225] offset:55808
s_mov_b64 exec, -1
s_mul_i32 s24, s22, 2560
v_add_u32 v3, s24, v238
v_add_u32 v229, s24, v239
s_mul_i32 s24, s62, 20480
s_add_u32 s24, s24, 7725056
s_lshl_b32 s25, s21, 11
s_add_u32 s25, s25, s24
s_lshr_b32 s26, s21, 1
s_lshl_b32 s26, s26, 10
s_and_b32 s27, s21, 1
s_lshl_b32 s27, s27, 9
s_add_u32 s26, s26, s27
s_add_u32 s26, s26, 16384
s_add_u32 s26, s26, s24
s_waitcnt vmcnt(24)
s_waitcnt lgkmcnt(0)
s_barrier
ds_read_b128 v[24:27], v3 offset:46080
ds_read_b128 v[28:31], v3 offset:47104
ds_read_b64 v[32:33], v229 offset:48128
s_waitcnt lgkmcnt(2)
s_cmp_eq_u32 s72, 0
s_cbranch_scc1 XS94
buffer_store_dwordx4 v[24:27], v1, s[4:7], s25 offen
s_branch XE95
XS94:
buffer_store_dwordx4 v[24:27], v1, s[4:7], s25 offen sc1
XE95:
s_waitcnt lgkmcnt(1)
s_cmp_eq_u32 s72, 0
s_cbranch_scc1 XS96
buffer_store_dwordx4 v[28:31], v1, s[4:7], s25 offen offset:1024
s_branch XE97
XS96:
buffer_store_dwordx4 v[28:31], v1, s[4:7], s25 offen offset:1024 sc1
XE97:
s_waitcnt lgkmcnt(0)
s_cmp_eq_u32 s72, 0
s_cbranch_scc1 XS98
buffer_store_dwordx2 v[32:33], v2, s[4:7], s26 offen
s_branch XE99
XS98:
buffer_store_dwordx2 v[32:33], v2, s[4:7], s26 offen sc1
XE99:
buffer_load_dwordx4 a[228:231], v1, s[4:7], s64 offen offset:3072
s_add_u32 s64, s64, 4096
buffer_load_dwordx4 a[232:235], v1, s[4:7], s64 offen
buffer_load_dwordx4 a[236:239], v1, s[4:7], s64 offen offset:1024
buffer_load_dwordx4 a[240:243], v1, s[4:7], s64 offen offset:2048
buffer_load_dwordx4 a[244:247], v1, s[4:7], s64 offen offset:3072
s_add_u32 s64, s64, 4096
buffer_load_dwordx4 a[248:251], v1, s[4:7], s64 offen
buffer_load_dwordx4 a[252:255], v1, s[4:7], s64 offen offset:1024
buffer_load_dwordx4 a[0:3], v1, s[4:7], s64 offen offset:2048
buffer_load_dwordx4 a[4:7], v1, s[4:7], s64 offen offset:3072
s_add_u32 s64, s64, 4096
buffer_load_dwordx4 a[8:11], v1, s[4:7], s64 offen
buffer_load_dwordx4 a[12:15], v1, s[4:7], s64 offen offset:1024
buffer_load_dwordx4 a[16:19], v1, s[4:7], s64 offen offset:2048
buffer_load_dwordx4 a[20:23], v1, s[4:7], s64 offen offset:3072
buffer_load_dwordx4 a[24:27], v1, s[4:7], s65 offen
buffer_load_dwordx4 a[28:31], v1, s[4:7], s65 offen offset:1024
buffer_load_dwordx4 a[32:35], v1, s[4:7], s65 offen offset:2048
buffer_load_dwordx4 a[36:39], v1, s[4:7], s65 offen offset:3072
s_add_u32 s65, s65, 4096
buffer_load_dwordx4 a[40:43], v1, s[4:7], s65 offen
buffer_load_dwordx4 a[44:47], v1, s[4:7], s65 offen offset:1024
buffer_load_dwordx4 a[48:51], v1, s[4:7], s65 offen offset:2048
buffer_load_dwordx4 a[52:55], v1, s[4:7], s65 offen offset:3072
s_add_u32 s65, s65, 4096
buffer_load_dwordx4 a[56:59], v1, s[4:7], s65 offen
buffer_load_dwordx4 a[60:63], v1, s[4:7], s65 offen offset:1024
buffer_load_dwordx4 a[64:67], v1, s[4:7], s65 offen offset:2048
s_waitcnt vmcnt(24)
v_mov_b32 v3, 7
s_mov_b64 exec, 1
s_cmp_eq_u32 s72, 0
s_cbranch_scc1 XS100
buffer_store_dword v3, off, s[4:7], s23
s_branch XE101
XS100:
buffer_store_dword v3, off, s[4:7], s23 sc1
XE101:
s_mov_b64 exec, -1
s_mul_i32 s45, s62, 20480
s_add_u32 s45, s45, 7725056
s_add_u32 s46, s45, 16384
s_mov_b32 s24, 30000
PL102:
buffer_load_dword v3, v236, s[4:7], 0 offen sc1
s_waitcnt vmcnt(0)
v_cmp_gt_u32 vcc, 7, v3
s_sub_u32 s24, s24, 1
s_cbranch_scc1 PD103
s_cbranch_vccnz PL102
PD103:
buffer_load_dwordx4 v[84:87], v1, s[4:7], s45 offen offset:0 sc1
buffer_load_dwordx4 v[88:91], v1, s[4:7], s45 offen offset:1024 sc1
buffer_load_dwordx4 v[92:95], v1, s[4:7], s45 offen offset:2048 sc1
buffer_load_dwordx4 v[96:99], v1, s[4:7], s45 offen offset:3072 sc1
s_add_u32 s45, s45, 4096
buffer_load_dwordx4 v[100:103], v1, s[4:7], s45 offen offset:0 sc1
buffer_load_dwordx4 v[104:107], v1, s[4:7], s45 offen offset:1024 sc1
buffer_load_dwordx4 v[108:111], v1, s[4:7], s45 offen offset:2048 sc1
buffer_load_dwordx4 v[112:115], v1, s[4:7], s45 offen offset:3072 sc1
s_add_u32 s45, s45, 4096
buffer_load_dwordx4 v[116:119], v1, s[4:7], s45 offen offset:0 sc1
buffer_load_dwordx4 v[120:123], v1, s[4:7], s45 offen offset:1024 sc1
buffer_load_dwordx4 v[124:127], v1, s[4:7], s45 offen offset:2048 sc1
buffer_load_dwordx4 v[128:131], v1, s[4:7], s45 offen offset:3072 sc1
s_add_u32 s45, s45, 4096
buffer_load_dwordx4 v[132:135], v1, s[4:7], s45 offen offset:0 sc1
buffer_load_dwordx4 v[136:139], v1, s[4:7], s45 offen offset:1024 sc1
buffer_load_dwordx4 v[140:143], v1, s[4:7], s45 offen offset:2048 sc1
buffer_load_dwordx4 v[144:147], v1, s[4:7], s45 offen offset:3072 sc1
buffer_load_dwordx2 v[148:149], v2, s[4:7], s46 offen offset:0 sc1
buffer_load_dwordx2 v[150:151], v2, s[4:7], s46 offen offset:512 sc1
buffer_load_dwordx2 v[152:153], v2, s[4:7], s46 offen offset:1024 sc1
buffer_load_dwordx2 v[154:155], v2, s[4:7], s46 offen offset:1536 sc1
buffer_load_dwordx2 v[156:157], v2, s[4:7], s46 offen offset:2048 sc1
buffer_load_dwordx2 v[158:159], v2, s[4:7], s46 offen offset:2560 sc1
buffer_load_dwordx2 v[160:161], v2, s[4:7], s46 offen offset:3072 sc1
buffer_load_dwordx2 v[162:163], v2, s[4:7], s46 offen offset:3584 sc1
ds_read_b128 v[24:27], v1 offset:0
ds_read_b128 v[28:31], v1 offset:1024
ds_read_b128 v[32:35], v1 offset:2048
ds_read_b128 v[36:39], v1 offset:3072
ds_read_b128 v[40:43], v1 offset:4096
ds_read_b128 v[44:47], v1 offset:5120
ds_read_b128 v[48:51], v1 offset:6144
ds_read_b128 v[52:55], v1 offset:7168
s_waitcnt vmcnt(23)
s_waitcnt lgkmcnt(7)
v_mfma_f32_16x16x32_bf16 v[4:7], v[24:27], v[84:87], v[4:7]
ds_read_b128 v[24:27], v1 offset:8192
s_waitcnt lgkmcnt(7)
v_mfma_f32_16x16x32_bf16 v[8:11], v[28:31], v[84:87], v[8:11]
ds_read_b128 v[28:31], v1 offset:9216
s_waitcnt lgkmcnt(7)
v_mfma_f32_16x16x32_bf16 v[12:15], v[32:35], v[84:87], v[12:15]
ds_read_b128 v[32:35], v1 offset:10240
s_waitcnt lgkmcnt(7)
v_mfma_f32_16x16x32_bf16 v[16:19], v[36:39], v[84:87], v[16:19]
ds_read_b128 v[36:39], v1 offset:11264
s_waitcnt lgkmcnt(7)
v_mfma_f32_16x16x32_bf16 v[20:23], v[40:43], v[84:87], v[20:23]
ds_read_b128 v[40:43], v1 offset:12288
s_waitcnt vmcnt(22)
s_waitcnt lgkmcnt(7)
v_mfma_f32_16x16x32_bf16 v[4:7], v[44:47], v[88:91], v[4:7]
ds_read_b128 v[44:47], v1 offset:13312
s_waitcnt lgkmcnt(7)
v_mfma_f32_16x16x32_bf16 v[8:11], v[48:51], v[88:91], v[8:11]
ds_read_b128 v[48:51], v1 offset:14336
s_waitcnt lgkmcnt(7)
v_mfma_f32_16x16x32_bf16 v[12:15], v[52:55], v[88:91], v[12:15]
ds_read_b128 v[52:55], v1 offset:15360
s_waitcnt lgkmcnt(7)
v_mfma_f32_16x16x32_bf16 v[16:19], v[24:27], v[88:91], v[16:19]
ds_read_b128 v[24:27], v1 offset:16384
s_waitcnt lgkmcnt(7)
v_mfma_f32_16x16x32_bf16 v[20:23], v[28:31], v[88:91], v[20:23]
ds_read_b128 v[28:31], v1 offset:17408
s_waitcnt vmcnt(21)
s_waitcnt lgkmcnt(7)
v_mfma_f32_16x16x32_bf16 v[4:7], v[32:35], v[92:95], v[4:7]
ds_read_b128 v[32:35], v1 offset:18432
s_waitcnt lgkmcnt(7)
v_mfma_f32_16x16x32_bf16 v[8:11], v[36:39], v[92:95], v[8:11]
ds_read_b128 v[36:39], v1 offset:19456
s_waitcnt lgkmcnt(7)
v_mfma_f32_16x16x32_bf16 v[12:15], v[40:43], v[92:95], v[12:15]
ds_read_b128 v[40:43], v1 offset:25600
s_waitcnt lgkmcnt(7)
v_mfma_f32_16x16x32_bf16 v[16:19], v[44:47], v[92:95], v[16:19]
ds_read_b128 v[44:47], v1 offset:26624
s_waitcnt lgkmcnt(7)
v_mfma_f32_16x16x32_bf16 v[20:23], v[48:51], v[92:95], v[20:23]
ds_read_b128 v[48:51], v1 offset:27648
s_waitcnt vmcnt(20)
s_waitcnt lgkmcnt(7)
v_mfma_f32_16x16x32_bf16 v[4:7], v[52:55], v[96:99], v[4:7]
ds_read_b128 v[52:55], v1 offset:28672
s_waitcnt lgkmcnt(7)
v_mfma_f32_16x16x32_bf16 v[8:11], v[24:27], v[96:99], v[8:11]
ds_read_b128 v[24:27], v1 offset:29696
s_waitcnt lgkmcnt(7)
v_mfma_f32_16x16x32_bf16 v[12:15], v[28:31], v[96:99], v[12:15]
ds_read_b128 v[28:31], v1 offset:30720
s_waitcnt lgkmcnt(7)
v_mfma_f32_16x16x32_bf16 v[16:19], v[32:35], v[96:99], v[16:19]
ds_read_b128 v[32:35], v1 offset:31744
s_waitcnt lgkmcnt(7)
v_mfma_f32_16x16x32_bf16 v[20:23], v[36:39], v[96:99], v[20:23]
ds_read_b128 v[36:39], v1 offset:32768
s_waitcnt vmcnt(19)
s_waitcnt lgkmcnt(7)
v_mfma_f32_16x16x32_bf16 v[4:7], v[40:43], v[100:103], v[4:7]
ds_read_b128 v[40:43], v1 offset:33792
s_waitcnt lgkmcnt(7)
v_mfma_f32_16x16x32_bf16 v[8:11], v[44:47], v[100:103], v[8:11]
ds_read_b128 v[44:47], v1 offset:34816
s_waitcnt lgkmcnt(7)
v_mfma_f32_16x16x32_bf16 v[12:15], v[48:51], v[100:103], v[12:15]
ds_read_b128 v[48:51], v1 offset:35840
s_waitcnt lgkmcnt(7)
v_mfma_f32_16x16x32_bf16 v[16:19], v[52:55], v[100:103], v[16:19]
ds_read_b128 v[52:55], v1 offset:36864
s_waitcnt lgkmcnt(7)
v_mfma_f32_16x16x32_bf16 v[20:23], v[24:27], v[100:103], v[20:23]
ds_read_b128 v[24:27], v1 offset:37888
s_waitcnt vmcnt(18)
s_waitcnt lgkmcnt(7)
v_mfma_f32_16x16x32_bf16 v[4:7], v[28:31], v[104:107], v[4:7]
ds_read_b128 v[28:31], v1 offset:38912
s_waitcnt lgkmcnt(7)
v_mfma_f32_16x16x32_bf16 v[8:11], v[32:35], v[104:107], v[8:11]
ds_read_b128 v[32:35], v1 offset:39936
s_waitcnt lgkmcnt(7)
v_mfma_f32_16x16x32_bf16 v[12:15], v[36:39], v[104:107], v[12:15]
ds_read_b128 v[36:39], v1 offset:40960
s_waitcnt lgkmcnt(7)
v_mfma_f32_16x16x32_bf16 v[16:19], v[40:43], v[104:107], v[16:19]
ds_read_b128 v[40:43], v1 offset:41984
s_waitcnt lgkmcnt(7)
v_mfma_f32_16x16x32_bf16 v[20:23], v[44:47], v[104:107], v[20:23]
ds_read_b128 v[44:47], v1 offset:43008
s_waitcnt vmcnt(17)
s_waitcnt lgkmcnt(7)
v_mfma_f32_16x16x32_bf16 v[4:7], v[48:51], v[108:111], v[4:7]
ds_read_b128 v[48:51], v1 offset:44032
s_waitcnt lgkmcnt(7)
v_mfma_f32_16x16x32_bf16 v[8:11], v[52:55], v[108:111], v[8:11]
ds_read_b128 v[52:55], v1 offset:45056
s_waitcnt lgkmcnt(7)
v_mfma_f32_16x16x32_bf16 v[12:15], v[24:27], v[108:111], v[12:15]
ds_read_b128 v[24:27], v1 offset:51200
s_waitcnt lgkmcnt(7)
v_mfma_f32_16x16x32_bf16 v[16:19], v[28:31], v[108:111], v[16:19]
ds_read_b128 v[28:31], v1 offset:52224
s_waitcnt lgkmcnt(7)
v_mfma_f32_16x16x32_bf16 v[20:23], v[32:35], v[108:111], v[20:23]
ds_read_b128 v[32:35], v1 offset:53248
s_waitcnt vmcnt(16)
s_waitcnt lgkmcnt(7)
v_mfma_f32_16x16x32_bf16 v[4:7], v[36:39], v[112:115], v[4:7]
ds_read_b128 v[36:39], v1 offset:54272
s_waitcnt lgkmcnt(7)
v_mfma_f32_16x16x32_bf16 v[8:11], v[40:43], v[112:115], v[8:11]
ds_read_b128 v[40:43], v1 offset:55296
s_waitcnt lgkmcnt(7)
v_mfma_f32_16x16x32_bf16 v[12:15], v[44:47], v[112:115], v[12:15]
ds_read_b128 v[44:47], v1 offset:56320
s_waitcnt lgkmcnt(7)
v_mfma_f32_16x16x32_bf16 v[16:19], v[48:51], v[112:115], v[16:19]
ds_read_b128 v[48:51], v1 offset:57344
s_waitcnt lgkmcnt(7)
v_mfma_f32_16x16x32_bf16 v[20:23], v[52:55], v[112:115], v[20:23]
ds_read_b128 v[52:55], v1 offset:58368
s_waitcnt vmcnt(15)
s_waitcnt lgkmcnt(7)
v_mfma_f32_16x16x32_bf16 v[4:7], v[24:27], v[116:119], v[4:7]
ds_read_b128 v[24:27], v1 offset:59392
s_waitcnt lgkmcnt(7)
v_mfma_f32_16x16x32_bf16 v[8:11], v[28:31], v[116:119], v[8:11]
ds_read_b128 v[28:31], v1 offset:60416
s_waitcnt lgkmcnt(7)
v_mfma_f32_16x16x32_bf16 v[12:15], v[32:35], v[116:119], v[12:15]
ds_read_b128 v[32:35], v238 offset:0
s_waitcnt lgkmcnt(7)
v_mfma_f32_16x16x32_bf16 v[16:19], v[36:39], v[116:119], v[16:19]
ds_read_b128 v[36:39], v238 offset:1024
s_waitcnt lgkmcnt(7)
v_mfma_f32_16x16x32_bf16 v[20:23], v[40:43], v[116:119], v[20:23]
ds_read_b128 v[40:43], v238 offset:2048
s_waitcnt vmcnt(14)
s_waitcnt lgkmcnt(7)
v_mfma_f32_16x16x32_bf16 v[4:7], v[44:47], v[120:123], v[4:7]
ds_read_b128 v[44:47], v238 offset:3072
s_waitcnt lgkmcnt(7)
v_mfma_f32_16x16x32_bf16 v[8:11], v[48:51], v[120:123], v[8:11]
ds_read_b128 v[48:51], v238 offset:4096
s_waitcnt lgkmcnt(7)
v_mfma_f32_16x16x32_bf16 v[12:15], v[52:55], v[120:123], v[12:15]
ds_read_b128 v[52:55], v238 offset:5120
s_waitcnt lgkmcnt(7)
v_mfma_f32_16x16x32_bf16 v[16:19], v[24:27], v[120:123], v[16:19]
ds_read_b128 v[24:27], v238 offset:6144
s_waitcnt lgkmcnt(7)
v_mfma_f32_16x16x32_bf16 v[20:23], v[28:31], v[120:123], v[20:23]
ds_read_b128 v[28:31], v238 offset:7168
s_waitcnt vmcnt(13)
s_waitcnt lgkmcnt(7)
v_mfma_f32_16x16x32_bf16 v[4:7], v[32:35], v[124:127], v[4:7]
ds_read_b128 v[32:35], v238 offset:8192
s_waitcnt lgkmcnt(7)
v_mfma_f32_16x16x32_bf16 v[8:11], v[36:39], v[124:127], v[8:11]
ds_read_b128 v[36:39], v238 offset:9216
s_waitcnt lgkmcnt(7)
v_mfma_f32_16x16x32_bf16 v[12:15], v[40:43], v[124:127], v[12:15]
ds_read_b128 v[40:43], v238 offset:15360
s_waitcnt lgkmcnt(7)
v_mfma_f32_16x16x32_bf16 v[16:19], v[44:47], v[124:127], v[16:19]
ds_read_b128 v[44:47], v238 offset:16384
s_waitcnt lgkmcnt(7)
v_mfma_f32_16x16x32_bf16 v[20:23], v[48:51], v[124:127], v[20:23]
ds_read_b128 v[48:51], v238 offset:17408
s_waitcnt vmcnt(12)
s_waitcnt lgkmcnt(7)
v_mfma_f32_16x16x32_bf16 v[4:7], v[52:55], v[128:131], v[4:7]
ds_read_b128 v[52:55], v238 offset:18432
s_waitcnt lgkmcnt(7)
v_mfma_f32_16x16x32_bf16 v[8:11], v[24:27], v[128:131], v[8:11]
ds_read_b128 v[24:27], v238 offset:19456
s_waitcnt lgkmcnt(7)
v_mfma_f32_16x16x32_bf16 v[12:15], v[28:31], v[128:131], v[12:15]
ds_read_b128 v[28:31], v238 offset:20480
s_waitcnt lgkmcnt(7)
v_mfma_f32_16x16x32_bf16 v[16:19], v[32:35], v[128:131], v[16:19]
ds_read_b128 v[32:35], v238 offset:21504
s_waitcnt lgkmcnt(7)
v_mfma_f32_16x16x32_bf16 v[20:23], v[36:39], v[128:131], v[20:23]
ds_read_b128 v[36:39], v238 offset:22528
s_waitcnt vmcnt(11)
s_waitcnt lgkmcnt(7)
v_mfma_f32_16x16x32_bf16 v[4:7], v[40:43], v[132:135], v[4:7]
ds_read_b128 v[40:43], v238 offset:23552
s_waitcnt lgkmcnt(7)
v_mfma_f32_16x16x32_bf16 v[8:11], v[44:47], v[132:135], v[8:11]
ds_read_b128 v[44:47], v238 offset:24576
s_waitcnt lgkmcnt(7)
v_mfma_f32_16x16x32_bf16 v[12:15], v[48:51], v[132:135], v[12:15]
ds_read_b128 v[48:51], v238 offset:25600
s_waitcnt lgkmcnt(7)
v_mfma_f32_16x16x32_bf16 v[16:19], v[52:55], v[132:135], v[16:19]
ds_read_b128 v[52:55], v238 offset:26624
s_waitcnt lgkmcnt(7)
v_mfma_f32_16x16x32_bf16 v[20:23], v[24:27], v[132:135], v[20:23]
ds_read_b128 v[24:27], v238 offset:27648
s_waitcnt vmcnt(10)
s_waitcnt lgkmcnt(7)
v_mfma_f32_16x16x32_bf16 v[4:7], v[28:31], v[136:139], v[4:7]
ds_read_b128 v[28:31], v238 offset:28672
s_waitcnt lgkmcnt(7)
v_mfma_f32_16x16x32_bf16 v[8:11], v[32:35], v[136:139], v[8:11]
ds_read_b128 v[32:35], v238 offset:29696
s_waitcnt lgkmcnt(7)
v_mfma_f32_16x16x32_bf16 v[12:15], v[36:39], v[136:139], v[12:15]
ds_read_b128 v[36:39], v238 offset:30720
s_waitcnt lgkmcnt(7)
v_mfma_f32_16x16x32_bf16 v[16:19], v[40:43], v[136:139], v[16:19]
ds_read_b128 v[40:43], v238 offset:31744
s_waitcnt lgkmcnt(7)
v_mfma_f32_16x16x32_bf16 v[20:23], v[44:47], v[136:139], v[20:23]
ds_read_b128 v[44:47], v238 offset:32768
s_waitcnt vmcnt(9)
s_waitcnt lgkmcnt(7)
v_mfma_f32_16x16x32_bf16 v[4:7], v[48:51], v[140:143], v[4:7]
ds_read_b128 v[48:51], v238 offset:33792
s_waitcnt lgkmcnt(7)
v_mfma_f32_16x16x32_bf16 v[8:11], v[52:55], v[140:143], v[8:11]
ds_read_b128 v[52:55], v238 offset:34816
s_waitcnt lgkmcnt(7)
v_mfma_f32_16x16x32_bf16 v[12:15], v[24:27], v[140:143], v[12:15]
ds_read_b128 v[24:27], v1 offset:20480
s_waitcnt lgkmcnt(7)
v_mfma_f32_16x16x32_bf16 v[16:19], v[28:31], v[140:143], v[16:19]
ds_read_b128 v[28:31], v1 offset:21504
s_waitcnt lgkmcnt(7)
v_mfma_f32_16x16x32_bf16 v[20:23], v[32:35], v[140:143], v[20:23]
ds_read_b128 v[32:35], v1 offset:22528
s_waitcnt vmcnt(8)
s_waitcnt lgkmcnt(7)
v_mfma_f32_16x16x32_bf16 v[4:7], v[36:39], v[144:147], v[4:7]
ds_read_b128 v[36:39], v1 offset:23552
s_waitcnt lgkmcnt(7)
v_mfma_f32_16x16x32_bf16 v[8:11], v[40:43], v[144:147], v[8:11]
ds_read_b128 v[40:43], v1 offset:24576
s_waitcnt lgkmcnt(7)
v_mfma_f32_16x16x32_bf16 v[12:15], v[44:47], v[144:147], v[12:15]
ds_read_b128 v[44:47], v1 offset:46080
s_waitcnt lgkmcnt(7)
v_mfma_f32_16x16x32_bf16 v[16:19], v[48:51], v[144:147], v[16:19]
ds_read_b128 v[48:51], v1 offset:47104
s_waitcnt lgkmcnt(7)
v_mfma_f32_16x16x32_bf16 v[20:23], v[52:55], v[144:147], v[20:23]
ds_read_b128 v[52:55], v1 offset:48128
s_waitcnt vmcnt(6)
s_waitcnt lgkmcnt(7)
v_mfma_f32_16x16x32_bf16 v[4:7], v[24:27], v[148:151], v[4:7]
ds_read_b128 v[24:27], v1 offset:49152
s_waitcnt lgkmcnt(7)
v_mfma_f32_16x16x32_bf16 v[8:11], v[28:31], v[148:151], v[8:11]
ds_read_b128 v[28:31], v1 offset:50176
s_waitcnt lgkmcnt(7)
v_mfma_f32_16x16x32_bf16 v[12:15], v[32:35], v[148:151], v[12:15]
ds_read_b128 v[32:35], v238 offset:10240
s_waitcnt lgkmcnt(7)
v_mfma_f32_16x16x32_bf16 v[16:19], v[36:39], v[148:151], v[16:19]
ds_read_b128 v[36:39], v238 offset:11264
s_waitcnt lgkmcnt(7)
v_mfma_f32_16x16x32_bf16 v[20:23], v[40:43], v[148:151], v[20:23]
ds_read_b128 v[40:43], v238 offset:12288
s_waitcnt vmcnt(4)
s_waitcnt lgkmcnt(7)
v_mfma_f32_16x16x32_bf16 v[4:7], v[44:47], v[152:155], v[4:7]
ds_read_b128 v[44:47], v238 offset:13312
s_waitcnt lgkmcnt(7)
v_mfma_f32_16x16x32_bf16 v[8:11], v[48:51], v[152:155], v[8:11]
ds_read_b128 v[48:51], v238 offset:14336
s_waitcnt lgkmcnt(7)
v_mfma_f32_16x16x32_bf16 v[12:15], v[52:55], v[152:155], v[12:15]
ds_read_b128 v[52:55], v238 offset:35840
s_waitcnt lgkmcnt(7)
v_mfma_f32_16x16x32_bf16 v[16:19], v[24:27], v[152:155], v[16:19]
ds_read_b128 v[24:27], v238 offset:36864
s_waitcnt lgkmcnt(7)
v_mfma_f32_16x16x32_bf16 v[20:23], v[28:31], v[152:155], v[20:23]
ds_read_b128 v[28:31], v238 offset:37888
s_waitcnt vmcnt(2)
s_waitcnt lgkmcnt(7)
v_mfma_f32_16x16x32_bf16 v[4:7], v[32:35], v[156:159], v[4:7]
ds_read_b128 v[32:35], v238 offset:38912
s_waitcnt lgkmcnt(7)
v_mfma_f32_16x16x32_bf16 v[8:11], v[36:39], v[156:159], v[8:11]
ds_read_b128 v[36:39], v238 offset:39936
s_waitcnt lgkmcnt(7)
v_mfma_f32_16x16x32_bf16 v[12:15], v[40:43], v[156:159], v[12:15]
s_waitcnt lgkmcnt(6)
v_mfma_f32_16x16x32_bf16 v[16:19], v[44:47], v[156:159], v[16:19]
s_waitcnt lgkmcnt(5)
v_mfma_f32_16x16x32_bf16 v[20:23], v[48:51], v[156:159], v[20:23]
s_waitcnt vmcnt(0)
s_waitcnt lgkmcnt(4)
v_mfma_f32_16x16x32_bf16 v[4:7], v[52:55], v[160:163], v[4:7]
s_waitcnt lgkmcnt(3)
v_mfma_f32_16x16x32_bf16 v[8:11], v[24:27], v[160:163], v[8:11]
s_waitcnt lgkmcnt(2)
v_mfma_f32_16x16x32_bf16 v[12:15], v[28:31], v[160:163], v[12:15]
s_waitcnt lgkmcnt(1)
v_mfma_f32_16x16x32_bf16 v[16:19], v[32:35], v[160:163], v[16:19]
s_waitcnt lgkmcnt(0)
v_mfma_f32_16x16x32_bf16 v[20:23], v[36:39], v[160:163], v[20:23]
v_cvt_pk_bf16_f32 v24, v4, v5
v_cvt_pk_bf16_f32 v25, v6, v7
v_cvt_pk_bf16_f32 v26, v8, v9
v_cvt_pk_bf16_f32 v27, v10, v11
v_cvt_pk_bf16_f32 v28, v12, v13
v_cvt_pk_bf16_f32 v29, v14, v15
v_cvt_pk_bf16_f32 v30, v16, v17
v_cvt_pk_bf16_f32 v31, v18, v19
v_cvt_pk_bf16_f32 v32, v20, v21
v_cvt_pk_bf16_f32 v33, v22, v23
s_mul_i32 s24, s62, 20480
s_add_u32 s24, s24, 10346496
s_lshl_b32 s25, s21, 11
s_add_u32 s25, s25, s24
s_lshr_b32 s26, s21, 1
s_lshl_b32 s26, s26, 10
s_and_b32 s27, s21, 1
s_lshl_b32 s27, s27, 9
s_add_u32 s26, s26, s27
s_add_u32 s26, s26, 16384
s_add_u32 s26, s26, s24
s_cmp_eq_u32 s72, 0
s_cbranch_scc1 XS104
buffer_store_dwordx4 v[24:27], v1, s[4:7], s25 offen
s_branch XE105
XS104:
buffer_store_dwordx4 v[24:27], v1, s[4:7], s25 offen sc1
XE105:
s_cmp_eq_u32 s72, 0
s_cbranch_scc1 XS106
buffer_store_dwordx4 v[28:31], v1, s[4:7], s25 offen offset:1024
s_branch XE107
XS106:
buffer_store_dwordx4 v[28:31], v1, s[4:7], s25 offen offset:1024 sc1
XE107:
s_cmp_eq_u32 s72, 0
s_cbranch_scc1 XS108
buffer_store_dwordx2 v[32:33], v2, s[4:7], s26 offen
s_branch XE109
XS108:
buffer_store_dwordx2 v[32:33], v2, s[4:7], s26 offen sc1
XE109:
v_pk_mul_f32 v[36:37], v[4:5], v[4:5]
v_pk_add_f32 v[34:35], v[4:5], v[6:7]
v_pk_fma_f32 v[36:37], v[6:7], v[6:7], v[36:37]
v_pk_add_f32 v[34:35], v[34:35], v[8:9]
v_pk_fma_f32 v[36:37], v[8:9], v[8:9], v[36:37]
v_pk_add_f32 v[34:35], v[34:35], v[10:11]
v_pk_fma_f32 v[36:37], v[10:11], v[10:11], v[36:37]
v_pk_add_f32 v[34:35], v[34:35], v[12:13]
v_pk_fma_f32 v[36:37], v[12:13], v[12:13], v[36:37]
v_pk_add_f32 v[34:35], v[34:35], v[14:15]
v_pk_fma_f32 v[36:37], v[14:15], v[14:15], v[36:37]
v_pk_add_f32 v[34:35], v[34:35], v[16:17]
v_pk_fma_f32 v[36:37], v[16:17], v[16:17], v[36:37]
v_pk_add_f32 v[34:35], v[34:35], v[18:19]
v_pk_fma_f32 v[36:37], v[18:19], v[18:19], v[36:37]
v_pk_add_f32 v[34:35], v[34:35], v[20:21]
v_pk_fma_f32 v[36:37], v[20:21], v[20:21], v[36:37]
v_pk_add_f32 v[34:35], v[34:35], v[22:23]
v_pk_fma_f32 v[36:37], v[22:23], v[22:23], v[36:37]
v_add_f32 v34, v34, v35
v_add_f32 v35, v36, v37
v_mov_b32 v36, v34
v_mov_b32 v37, v35
s_nop 0
v_permlane32_swap_b32 v34, v36
v_permlane32_swap_b32 v35, v37
v_add_f32 v34, v34, v36
v_add_f32 v35, v35, v37
v_mov_b32 v36, v34
v_mov_b32 v37, v35
s_nop 0
v_permlane16_swap_b32 v34, v36
v_permlane16_swap_b32 v35, v37
v_add_f32 v34, v34, v36
v_add_f32 v35, v35, v37
s_lshl_b32 s24, s60, 9
s_lshl_b32 s25, s22, 7
s_add_u32 s24, s24, s25
s_add_u32 s24, s24, 13361152
s_mov_b64 exec, 0xffff
s_cmp_eq_u32 s72, 0
s_cbranch_scc1 XS110
buffer_store_dwordx2 v[34:35], v2, s[4:7], s24 offen
s_branch XE111
XS110:
buffer_store_dwordx2 v[34:35], v2, s[4:7], s24 offen sc1
XE111:
s_mov_b64 exec, -1
buffer_load_dwordx4 a[104:107], v1, s[4:7], s65 offen offset:3072
s_add_u32 s65, s65, 4096
buffer_load_dwordx4 a[108:111], v1, s[4:7], s65 offen
buffer_load_dwordx4 a[112:115], v1, s[4:7], s65 offen offset:1024
buffer_load_dwordx4 a[68:71], v1, s[4:7], s65 offen offset:2048
buffer_load_dwordx4 a[72:75], v1, s[4:7], s65 offen offset:3072
s_add_u32 s65, s65, 4096
buffer_load_dwordx4 a[76:79], v1, s[4:7], s65 offen
buffer_load_dwordx4 a[80:83], v1, s[4:7], s65 offen offset:1024
buffer_load_dwordx4 a[84:87], v1, s[4:7], s65 offen offset:2048
s_waitcnt vmcnt(8)
v_mov_b32 v3, 8
s_mov_b64 exec, 1
s_cmp_eq_u32 s72, 0
s_cbranch_scc1 XS112
buffer_store_dword v3, off, s[4:7], s23
s_branch XE113
XS112:
buffer_store_dword v3, off, s[4:7], s23 sc1
XE113:
s_mov_b64 exec, -1
s_mov_b32 s24, 30000
PL114:
buffer_load_dword v3, v236, s[4:7], 0 offen sc1
s_waitcnt vmcnt(0)
v_cmp_gt_u32 vcc, 8, v3
s_sub_u32 s24, s24, 1
s_cbranch_scc1 PD115
s_cbranch_vccnz PL114
PD115:
s_mul_i32 s24, s22, 14
s_cmp_eq_u32 s22, 3
s_cselect_b32 s24, 41, s24
s_mov_b32 s67, s24
s_mul_i32 s25, s68, 54
s_add_u32 s24, s24, s25
s_mul_i32 s24, s24, 5120
s_add_u32 s66, s24, 5488640
s_add_u32 s24, s63, 0
s_min_u32 s24, s24, 53
s_lshl_b32 s25, s24, 6
s_lshl_b32 s24, s24, 7
s_add_u32 s24, s24, 7708672
v_lshlrev_b32 v3, 4, v240
v_lshlrev_b32 v228, 3, v240
buffer_load_dwordx4 v[176:179], v3, s[4:7], s24 offen offset:0
buffer_load_dwordx2 v[184:185], v228, s[12:15], s25 offen offset:0
buffer_load_dwordx4 v[180:183], v3, s[4:7], s24 offen offset:64
buffer_load_dwordx2 v[188:189], v228, s[12:15], s25 offen offset:32
s_add_u32 s24, s63, 1
s_min_u32 s24, s24, 53
s_lshl_b32 s25, s24, 6
s_lshl_b32 s24, s24, 7
s_add_u32 s24, s24, 7708672
v_lshlrev_b32 v3, 4, v240
v_lshlrev_b32 v228, 3, v240
buffer_load_dwordx4 v[192:195], v3, s[4:7], s24 offen offset:0
buffer_load_dwordx2 v[200:201], v228, s[12:15], s25 offen offset:0
buffer_load_dwordx4 v[196:199], v3, s[4:7], s24 offen offset:64
buffer_load_dwordx2 v[204:205], v228, s[12:15], s25 offen offset:32
s_lshl_b32 s26, s60, 9
s_and_b32 s26, s26, 0xfffff000
s_lshl_b32 s27, s22, 7
s_add_u32 s26, s26, s27
s_add_u32 s26, s26, 13361152
v_lshrrev_b32 v24, 3, v0
v_lshlrev_b32 v24, 9, v24
v_and_b32 v25, 7, v0
v_lshlrev_b32 v25, 4, v25
v_add_u32 v24, v24, v25
buffer_load_dwordx4 v[28:31], v24, s[4:7], s26 offen
s_mul_i32 s69, s62, 20480
s_add_u32 s69, s69, 10346496
s_mul_i32 s70, s22, 20480
s_mov_b32 m0, s70
s_nop 0
buffer_load_dwordx4 v1, s[4:7], s69 offen offset:0 sc1 lds
s_mov_b32 m0, s70
s_nop 0
buffer_load_dwordx4 v1, s[4:7], s69 offen offset:1024 sc1 lds
s_mov_b32 m0, s70
s_nop 0
buffer_load_dwordx4 v1, s[4:7], s69 offen offset:2048 sc1 lds
s_mov_b32 m0, s70
s_nop 0
buffer_load_dwordx4 v1, s[4:7], s69 offen offset:3072 sc1 lds
s_add_u32 s69, s69, 4096
s_add_u32 s70, s70, 4096
s_mov_b32 m0, s70
s_nop 0
buffer_load_dwordx4 v1, s[4:7], s69 offen offset:0 sc1 lds
s_mov_b32 m0, s70
s_nop 0
buffer_load_dwordx4 v1, s[4:7], s69 offen offset:1024 sc1 lds
s_mov_b32 m0, s70
s_nop 0
buffer_load_dwordx4 v1, s[4:7], s69 offen offset:2048 sc1 lds
s_mov_b32 m0, s70
s_nop 0
buffer_load_dwordx4 v1, s[4:7], s69 offen offset:3072 sc1 lds
s_add_u32 s69, s69, 4096
s_add_u32 s70, s70, 4096
s_mov_b32 m0, s70
s_nop 0
buffer_load_dwordx4 v1, s[4:7], s69 offen offset:0 sc1 lds
s_mov_b32 m0, s70
s_nop 0
buffer_load_dwordx4 v1, s[4:7], s69 offen offset:1024 sc1 lds
s_waitcnt vmcnt(10)
v_mov_b32 v32, v28
v_mov_b32 v33, v29
v_mov_b32 v34, v30
v_mov_b32 v35, v31
v_permlane32_swap_b32 v28, v32
v_permlane32_swap_b32 v29, v33
v_permlane32_swap_b32 v30, v34
v_permlane32_swap_b32 v31, v35
v_add_f32 v28, v28, v32
v_add_f32 v29, v29, v33
v_add_f32 v30, v30, v34
v_add_f32 v31, v31, v35
v_mov_b32 v32, v28
v_mov_b32 v33, v29
v_mov_b32 v34, v30
v_mov_b32 v35, v31
v_permlane16_swap_b32 v28, v32
v_permlane16_swap_b32 v29, v33
v_permlane16_swap_b32 v30, v34
v_permlane16_swap_b32 v31, v35
v_add_f32 v28, v28, v32
v_add_f32 v29, v29, v33
v_add_f32 v30, v30, v34
v_add_f32 v31, v31, v35
v_add_f32_dpp v28, v28, v28 row_ror:8 row_mask:0xf bank_mask:0xf
v_add_f32_dpp v29, v29, v29 row_ror:8 row_mask:0xf bank_mask:0xf
v_add_f32_dpp v30, v30, v30 row_ror:8 row_mask:0xf bank_mask:0xf
v_add_f32_dpp v31, v31, v31 row_ror:8 row_mask:0xf bank_mask:0xf
s_mov_b32 s26, 0xbacccccd
s_mov_b32 s27, 0x3acccccd
v_mul_f32 v32, s26, v28
v_mul_f32 v33, s26, v30
v_mul_f32 v34, s27, v29
v_mul_f32 v35, s27, v31
v_fma_f32 v34, -v32, v32, v34
v_fma_f32 v35, -v33, v33, v35
v_max_f32 v34, 0, v34
v_max_f32 v35, 0, v35
v_add_f32 v34, 0x3727c5ac, v34
v_add_f32 v35, 0x3727c5ac, v35
v_rsq_f32 v34, v34
v_rsq_f32 v35, v35
v_and_b32 v24, 7, v0
v_lshlrev_b32 v24, 3, v24
s_lshl_b32 s26, s22, 6
s_add_u32 s26, s26, 102400
v_add_u32 v24, s26, v24
s_mov_b64 exec, 0xff
ds_write_b64 v24, v[32:33]
ds_write_b64 v24, v[34:35] offset:256
s_mov_b64 exec, -1
s_cmp_lt_u32 s22, 3
s_cbranch_scc1 FK117
s_cmp_lt_u32 s21, 6
s_cbranch_scc1 FK118
s_branch FK119
FK117:
v_and_b32 v187, 0xffff0000, v185
v_lshlrev_b32 v186, 16, v185
v_and_b32 v185, 0xffff0000, v184
v_lshlrev_b32 v184, 16, v184
v_and_b32 v191, 0xffff0000, v189
v_lshlrev_b32 v190, 16, v189
v_and_b32 v189, 0xffff0000, v188
v_lshlrev_b32 v188, 16, v188
s_waitcnt vmcnt(5)
s_waitcnt lgkmcnt(0)
s_barrier
ds_read_b128 v[24:27], v1 offset:0
ds_read_b128 v[28:31], v1 offset:20480
ds_read_b128 v[32:35], v1 offset:40960
ds_read_b128 v[36:39], v238 offset:0
s_waitcnt lgkmcnt(3)
v_mfma_f32_16x16x32_bf16 v[56:59], a[120:123], v[24:27], 0
ds_read_b128 v[40:43], v1 offset:1024
s_waitcnt lgkmcnt(3)
v_mfma_f32_16x16x32_bf16 v[60:63], a[120:123], v[28:31], 0
ds_read_b128 v[44:47], v1 offset:21504
s_waitcnt lgkmcnt(3)
v_mfma_f32_16x16x32_bf16 v[64:67], a[120:123], v[32:35], 0
ds_read_b128 v[48:51], v1 offset:41984
s_waitcnt lgkmcnt(3)
v_mfma_f32_16x16x32_bf16 v[68:71], a[120:123], v[36:39], 0
ds_read_b128 v[52:55], v238 offset:1024
v_mfma_f32_16x16x32_bf16 v[72:75], a[124:127], v[24:27], 0
s_mov_b32 m0, s70
s_nop 0
buffer_load_dwordx4 v1, s[4:7], s69 offen offset:2048 sc1 lds
v_mfma_f32_16x16x32_bf16 v[76:79], a[124:127], v[28:31], 0
buffer_load_dwordx4 a[88:91], v1, s[4:7], s65 offen offset:3072
v_mfma_f32_16x16x32_bf16 v[80:83], a[124:127], v[32:35], 0
s_add_u32 s65, s65, 4096
buffer_load_dwordx4 a[92:95], v1, s[4:7], s65 offen
v_mfma_f32_16x16x32_bf16 v[84:87], a[124:127], v[36:39], 0
buffer_load_dwordx4 a[96:99], v1, s[4:7], s65 offen offset:1024
s_waitcnt lgkmcnt(3)
v_mfma_f32_16x16x32_bf16 v[56:59], a[128:131], v[40:43], v[56:59]
ds_read_b128 v[24:27], v1 offset:2048
s_waitcnt lgkmcnt(3)
v_mfma_f32_16x16x32_bf16 v[60:63], a[128:131], v[44:47], v[60:63]
ds_read_b128 v[28:31], v1 offset:22528
s_waitcnt lgkmcnt(3)
v_mfma_f32_16x16x32_bf16 v[64:67], a[128:131], v[48:51], v[64:67]
ds_read_b128 v[32:35], v1 offset:43008
s_waitcnt lgkmcnt(3)
v_mfma_f32_16x16x32_bf16 v[68:71], a[128:131], v[52:55], v[68:71]
ds_read_b128 v[36:39], v238 offset:2048
v_mfma_f32_16x16x32_bf16 v[72:75], a[132:135], v[40:43], v[72:75]
s_mov_b32 m0, s70
s_nop 0
buffer_load_dwordx4 v1, s[4:7], s69 offen offset:3072 sc1 lds
v_mfma_f32_16x16x32_bf16 v[76:79], a[132:135], v[44:47], v[76:79]
buffer_load_dwordx4 a[100:103], v1, s[4:7], s65 offen offset:2048
v_mfma_f32_16x16x32_bf16 v[80:83], a[132:135], v[48:51], v[80:83]
buffer_load_dwordx4 a[116:119], v1, s[4:7], s65 offen offset:3072
v_mfma_f32_16x16x32_bf16 v[84:87], a[132:135], v[52:55], v[84:87]
s_add_u32 s65, s65, 4096
buffer_load_dwordx4 a[120:123], v1, s[4:7], s65 offen
s_waitcnt lgkmcnt(3)
v_mfma_f32_16x16x32_bf16 v[56:59], a[136:139], v[24:27], v[56:59]
ds_read_b128 v[40:43], v1 offset:3072
s_waitcnt lgkmcnt(3)
v_mfma_f32_16x16x32_bf16 v[60:63], a[136:139], v[28:31], v[60:63]
ds_read_b128 v[44:47], v1 offset:23552
s_waitcnt lgkmcnt(3)
v_mfma_f32_16x16x32_bf16 v[64:67], a[136:139], v[32:35], v[64:67]
ds_read_b128 v[48:51], v1 offset:44032
s_waitcnt lgkmcnt(3)
v_mfma_f32_16x16x32_bf16 v[68:71], a[136:139], v[36:39], v[68:71]
ds_read_b128 v[52:55], v238 offset:3072
v_mfma_f32_16x16x32_bf16 v[72:75], a[140:143], v[24:27], v[72:75]
s_add_u32 s69, s69, 4096
s_add_u32 s70, s70, 4096
s_mov_b32 m0, s70
s_nop 0
buffer_load_dwordx4 v1, s[4:7], s69 offen offset:0 sc1 lds
v_mfma_f32_16x16x32_bf16 v[76:79], a[140:143], v[28:31], v[76:79]
buffer_load_dwordx4 a[124:127], v1, s[4:7], s65 offen offset:1024
v_mfma_f32_16x16x32_bf16 v[80:83], a[140:143], v[32:35], v[80:83]
buffer_load_dwordx4 a[128:131], v1, s[4:7], s65 offen offset:2048
v_mfma_f32_16x16x32_bf16 v[84:87], a[140:143], v[36:39], v[84:87]
buffer_load_dwordx4 a[132:135], v1, s[4:7], s65 offen offset:3072
s_waitcnt lgkmcnt(3)
v_mfma_f32_16x16x32_bf16 v[56:59], a[144:147], v[40:43], v[56:59]
ds_read_b128 v[24:27], v1 offset:4096
s_waitcnt lgkmcnt(3)
v_mfma_f32_16x16x32_bf16 v[60:63], a[144:147], v[44:47], v[60:63]
ds_read_b128 v[28:31], v1 offset:24576
s_waitcnt lgkmcnt(3)
v_mfma_f32_16x16x32_bf16 v[64:67], a[144:147], v[48:51], v[64:67]
ds_read_b128 v[32:35], v1 offset:45056
s_waitcnt lgkmcnt(3)
v_mfma_f32_16x16x32_bf16 v[68:71], a[144:147], v[52:55], v[68:71]
ds_read_b128 v[36:39], v238 offset:4096
v_mfma_f32_16x16x32_bf16 v[72:75], a[148:151], v[40:43], v[72:75]
s_mov_b32 m0, s70
s_nop 0
buffer_load_dwordx4 v1, s[4:7], s69 offen offset:1024 sc1 lds
v_mfma_f32_16x16x32_bf16 v[76:79], a[148:151], v[44:47], v[76:79]
s_add_u32 s65, s65, 4096
buffer_load_dwordx4 a[136:139], v1, s[4:7], s65 offen
v_mfma_f32_16x16x32_bf16 v[80:83], a[148:151], v[48:51], v[80:83]
buffer_load_dwordx4 a[140:143], v1, s[4:7], s65 offen offset:1024
v_mfma_f32_16x16x32_bf16 v[84:87], a[148:151], v[52:55], v[84:87]
buffer_load_dwordx4 a[144:147], v1, s[4:7], s65 offen offset:2048
s_waitcnt vmcnt(16)
s_barrier
s_waitcnt lgkmcnt(3)
v_mfma_f32_16x16x32_bf16 v[56:59], a[152:155], v[24:27], v[56:59]
ds_read_b128 v[40:43], v1 offset:5120
s_waitcnt lgkmcnt(3)
v_mfma_f32_16x16x32_bf16 v[60:63], a[152:155], v[28:31], v[60:63]
ds_read_b128 v[44:47], v1 offset:25600
s_waitcnt lgkmcnt(3)
v_mfma_f32_16x16x32_bf16 v[64:67], a[152:155], v[32:35], v[64:67]
ds_read_b128 v[48:51], v1 offset:46080
s_waitcnt lgkmcnt(3)
v_mfma_f32_16x16x32_bf16 v[68:71], a[152:155], v[36:39], v[68:71]
ds_read_b128 v[52:55], v238 offset:5120
v_mfma_f32_16x16x32_bf16 v[72:75], a[156:159], v[24:27], v[72:75]
s_mov_b32 m0, s70
s_nop 0
buffer_load_dwordx4 v1, s[4:7], s69 offen offset:2048 sc1 lds
v_mfma_f32_16x16x32_bf16 v[76:79], a[156:159], v[28:31], v[76:79]
buffer_load_dwordx4 a[148:151], v1, s[4:7], s65 offen offset:3072
v_mfma_f32_16x16x32_bf16 v[80:83], a[156:159], v[32:35], v[80:83]
s_add_u32 s65, s65, 4096
buffer_load_dwordx4 a[152:155], v1, s[4:7], s65 offen
v_mfma_f32_16x16x32_bf16 v[84:87], a[156:159], v[36:39], v[84:87]
buffer_load_dwordx4 a[156:159], v1, s[4:7], s65 offen offset:1024
s_waitcnt lgkmcnt(3)
v_mfma_f32_16x16x32_bf16 v[56:59], a[160:163], v[40:43], v[56:59]
ds_read_b128 v[24:27], v1 offset:6144
s_waitcnt lgkmcnt(3)
v_mfma_f32_16x16x32_bf16 v[60:63], a[160:163], v[44:47], v[60:63]
ds_read_b128 v[28:31], v1 offset:26624
s_waitcnt lgkmcnt(3)
v_mfma_f32_16x16x32_bf16 v[64:67], a[160:163], v[48:51], v[64:67]
ds_read_b128 v[32:35], v1 offset:47104
s_waitcnt lgkmcnt(3)
v_mfma_f32_16x16x32_bf16 v[68:71], a[160:163], v[52:55], v[68:71]
ds_read_b128 v[36:39], v238 offset:6144
v_mfma_f32_16x16x32_bf16 v[72:75], a[164:167], v[40:43], v[72:75]
s_mov_b32 m0, s70
s_nop 0
buffer_load_dwordx4 v1, s[4:7], s69 offen offset:3072 sc1 lds
v_mfma_f32_16x16x32_bf16 v[76:79], a[164:167], v[44:47], v[76:79]
buffer_load_dwordx4 a[160:163], v1, s[4:7], s65 offen offset:2048
v_mfma_f32_16x16x32_bf16 v[80:83], a[164:167], v[48:51], v[80:83]
v_mfma_f32_16x16x32_bf16 v[84:87], a[164:167], v[52:55], v[84:87]
buffer_load_dwordx4 a[164:167], v1, s[4:7], s65 offen offset:3072
s_waitcnt lgkmcnt(3)
v_mfma_f32_16x16x32_bf16 v[56:59], a[168:171], v[24:27], v[56:59]
ds_read_b128 v[40:43], v1 offset:7168
s_waitcnt lgkmcnt(3)
v_mfma_f32_16x16x32_bf16 v[60:63], a[168:171], v[28:31], v[60:63]
ds_read_b128 v[44:47], v1 offset:27648
s_waitcnt lgkmcnt(3)
v_mfma_f32_16x16x32_bf16 v[64:67], a[168:171], v[32:35], v[64:67]
ds_read_b128 v[48:51], v1 offset:48128
s_waitcnt lgkmcnt(3)
v_mfma_f32_16x16x32_bf16 v[68:71], a[168:171], v[36:39], v[68:71]
ds_read_b128 v[52:55], v238 offset:7168
v_mfma_f32_16x16x32_bf16 v[72:75], a[172:175], v[24:27], v[72:75]
s_add_u32 s69, s69, 4096
s_add_u32 s70, s70, 4096
s_mov_b32 m0, s70
s_nop 0
buffer_load_dwordx4 v1, s[4:7], s69 offen offset:0 sc1 lds
v_mfma_f32_16x16x32_bf16 v[76:79], a[172:175], v[28:31], v[76:79]
s_add_u32 s65, s65, 4096
buffer_load_dwordx4 a[168:171], v1, s[4:7], s65 offen
v_mfma_f32_16x16x32_bf16 v[80:83], a[172:175], v[32:35], v[80:83]
v_mfma_f32_16x16x32_bf16 v[84:87], a[172:175], v[36:39], v[84:87]
buffer_load_dwordx4 a[172:175], v1, s[4:7], s65 offen offset:1024
s_waitcnt lgkmcnt(3)
v_mfma_f32_16x16x32_bf16 v[56:59], a[176:179], v[40:43], v[56:59]
ds_read_b128 v[24:27], v1 offset:8192
s_waitcnt lgkmcnt(3)
v_mfma_f32_16x16x32_bf16 v[60:63], a[176:179], v[44:47], v[60:63]
ds_read_b128 v[28:31], v1 offset:28672
s_waitcnt lgkmcnt(3)
v_mfma_f32_16x16x32_bf16 v[64:67], a[176:179], v[48:51], v[64:67]
ds_read_b128 v[32:35], v1 offset:49152
s_waitcnt lgkmcnt(3)
v_mfma_f32_16x16x32_bf16 v[68:71], a[176:179], v[52:55], v[68:71]
ds_read_b128 v[36:39], v238 offset:8192
v_mfma_f32_16x16x32_bf16 v[72:75], a[180:183], v[40:43], v[72:75]
s_mov_b32 m0, s70
s_nop 0
buffer_load_dwordx4 v1, s[4:7], s69 offen offset:1024 sc1 lds
v_mfma_f32_16x16x32_bf16 v[76:79], a[180:183], v[44:47], v[76:79]
buffer_load_dwordx4 a[176:179], v1, s[4:7], s65 offen offset:2048
v_mfma_f32_16x16x32_bf16 v[80:83], a[180:183], v[48:51], v[80:83]
v_mfma_f32_16x16x32_bf16 v[84:87], a[180:183], v[52:55], v[84:87]
buffer_load_dwordx4 a[180:183], v1, s[4:7], s65 offen offset:3072
s_waitcnt lgkmcnt(3)
v_mfma_f32_16x16x32_bf16 v[56:59], a[184:187], v[24:27], v[56:59]
ds_read_b128 v[40:43], v1 offset:9216
s_waitcnt lgkmcnt(3)
v_mfma_f32_16x16x32_bf16 v[60:63], a[184:187], v[28:31], v[60:63]
ds_read_b128 v[44:47], v1 offset:29696
s_waitcnt lgkmcnt(3)
v_mfma_f32_16x16x32_bf16 v[64:67], a[184:187], v[32:35], v[64:67]
ds_read_b128 v[48:51], v1 offset:50176
s_waitcnt lgkmcnt(3)
v_mfma_f32_16x16x32_bf16 v[68:71], a[184:187], v[36:39], v[68:71]
ds_read_b128 v[52:55], v238 offset:9216
v_mfma_f32_16x16x32_bf16 v[72:75], a[188:191], v[24:27], v[72:75]
s_mov_b32 m0, s70
s_nop 0
buffer_load_dwordx4 v1, s[4:7], s69 offen offset:2048 sc1 lds
v_mfma_f32_16x16x32_bf16 v[76:79], a[188:191], v[28:31], v[76:79]
buffer_load_dwordx4 a[184:187], v1, s[4:7], s66 offen
v_mfma_f32_16x16x32_bf16 v[80:83], a[188:191], v[32:35], v[80:83]
v_mfma_f32_16x16x32_bf16 v[84:87], a[188:191], v[36:39], v[84:87]
buffer_load_dwordx4 a[188:191], v1, s[4:7], s66 offen offset:1024
s_waitcnt vmcnt(15)
s_barrier
s_waitcnt lgkmcnt(3)
v_mfma_f32_16x16x32_bf16 v[56:59], a[192:195], v[40:43], v[56:59]
ds_read_b128 v[24:27], v1 offset:10240
s_waitcnt lgkmcnt(3)
v_mfma_f32_16x16x32_bf16 v[60:63], a[192:195], v[44:47], v[60:63]
ds_read_b128 v[28:31], v1 offset:30720
s_waitcnt lgkmcnt(3)
v_mfma_f32_16x16x32_bf16 v[64:67], a[192:195], v[48:51], v[64:67]
ds_read_b128 v[32:35], v1 offset:51200
s_waitcnt lgkmcnt(3)
v_mfma_f32_16x16x32_bf16 v[68:71], a[192:195], v[52:55], v[68:71]
ds_read_b128 v[36:39], v238 offset:10240
v_mfma_f32_16x16x32_bf16 v[72:75], a[196:199], v[40:43], v[72:75]
s_mov_b32 m0, s70
s_nop 0
buffer_load_dwordx4 v1, s[4:7], s69 offen offset:3072 sc1 lds
v_mfma_f32_16x16x32_bf16 v[76:79], a[196:199], v[44:47], v[76:79]
buffer_load_dwordx4 a[192:195], v1, s[4:7], s66 offen offset:2048
v_mfma_f32_16x16x32_bf16 v[80:83], a[196:199], v[48:51], v[80:83]
v_mfma_f32_16x16x32_bf16 v[84:87], a[196:199], v[52:55], v[84:87]
buffer_load_dwordx4 a[196:199], v1, s[4:7], s66 offen offset:3072
s_waitcnt lgkmcnt(3)
v_mfma_f32_16x16x32_bf16 v[56:59], a[200:203], v[24:27], v[56:59]
ds_read_b128 v[40:43], v1 offset:11264
s_waitcnt lgkmcnt(3)
v_mfma_f32_16x16x32_bf16 v[60:63], a[200:203], v[28:31], v[60:63]
ds_read_b128 v[44:47], v1 offset:31744
s_waitcnt lgkmcnt(3)
v_mfma_f32_16x16x32_bf16 v[64:67], a[200:203], v[32:35], v[64:67]
ds_read_b128 v[48:51], v1 offset:52224
s_waitcnt lgkmcnt(3)
v_mfma_f32_16x16x32_bf16 v[68:71], a[200:203], v[36:39], v[68:71]
ds_read_b128 v[52:55], v238 offset:11264
v_mfma_f32_16x16x32_bf16 v[72:75], a[204:207], v[24:27], v[72:75]
v_mfma_f32_16x16x32_bf16 v[76:79], a[204:207], v[28:31], v[76:79]
s_add_u32 s66, s66, 4096
buffer_load_dwordx4 a[200:203], v1, s[4:7], s66 offen
v_mfma_f32_16x16x32_bf16 v[80:83], a[204:207], v[32:35], v[80:83]
v_mfma_f32_16x16x32_bf16 v[84:87], a[204:207], v[36:39], v[84:87]
buffer_load_dwordx4 a[204:207], v1, s[4:7], s66 offen offset:1024
s_waitcnt lgkmcnt(3)
v_mfma_f32_16x16x32_bf16 v[56:59], a[208:211], v[40:43], v[56:59]
ds_read_b128 v[24:27], v1 offset:12288
s_waitcnt lgkmcnt(3)
v_mfma_f32_16x16x32_bf16 v[60:63], a[208:211], v[44:47], v[60:63]
ds_read_b128 v[28:31], v1 offset:32768
s_waitcnt lgkmcnt(3)
v_mfma_f32_16x16x32_bf16 v[64:67], a[208:211], v[48:51], v[64:67]
ds_read_b128 v[32:35], v1 offset:53248
s_waitcnt lgkmcnt(3)
v_mfma_f32_16x16x32_bf16 v[68:71], a[208:211], v[52:55], v[68:71]
ds_read_b128 v[36:39], v238 offset:12288
v_mfma_f32_16x16x32_bf16 v[72:75], a[212:215], v[40:43], v[72:75]
v_mfma_f32_16x16x32_bf16 v[76:79], a[212:215], v[44:47], v[76:79]
buffer_load_dwordx4 a[208:211], v1, s[4:7], s66 offen offset:2048
v_mfma_f32_16x16x32_bf16 v[80:83], a[212:215], v[48:51], v[80:83]
v_mfma_f32_16x16x32_bf16 v[84:87], a[212:215], v[52:55], v[84:87]
buffer_load_dwordx4 a[212:215], v1, s[4:7], s66 offen offset:3072
s_waitcnt lgkmcnt(3)
v_mfma_f32_16x16x32_bf16 v[56:59], a[216:219], v[24:27], v[56:59]
ds_read_b128 v[40:43], v1 offset:13312
s_waitcnt lgkmcnt(3)
v_mfma_f32_16x16x32_bf16 v[60:63], a[216:219], v[28:31], v[60:63]
ds_read_b128 v[44:47], v1 offset:33792
s_waitcnt lgkmcnt(3)
v_mfma_f32_16x16x32_bf16 v[64:67], a[216:219], v[32:35], v[64:67]
ds_read_b128 v[48:51], v1 offset:54272
s_waitcnt lgkmcnt(3)
v_mfma_f32_16x16x32_bf16 v[68:71], a[216:219], v[36:39], v[68:71]
ds_read_b128 v[52:55], v238 offset:13312
v_mfma_f32_16x16x32_bf16 v[72:75], a[220:223], v[24:27], v[72:75]
v_mfma_f32_16x16x32_bf16 v[76:79], a[220:223], v[28:31], v[76:79]
s_add_u32 s66, s66, 4096
buffer_load_dwordx4 a[216:219], v1, s[4:7], s66 offen
v_mfma_f32_16x16x32_bf16 v[80:83], a[220:223], v[32:35], v[80:83]
v_mfma_f32_16x16x32_bf16 v[84:87], a[220:223], v[36:39], v[84:87]
buffer_load_dwordx4 a[220:223], v1, s[4:7], s66 offen offset:1024
s_waitcnt lgkmcnt(3)
v_mfma_f32_16x16x32_bf16 v[56:59], a[224:227], v[40:43], v[56:59]
ds_read_b128 v[24:27], v1 offset:14336
s_waitcnt lgkmcnt(3)
v_mfma_f32_16x16x32_bf16 v[60:63], a[224:227], v[44:47], v[60:63]
ds_read_b128 v[28:31], v1 offset:34816
s_waitcnt lgkmcnt(3)
v_mfma_f32_16x16x32_bf16 v[64:67], a[224:227], v[48:51], v[64:67]
ds_read_b128 v[32:35], v1 offset:55296
s_waitcnt lgkmcnt(3)
v_mfma_f32_16x16x32_bf16 v[68:71], a[224:227], v[52:55], v[68:71]
ds_read_b128 v[36:39], v238 offset:14336
v_mfma_f32_16x16x32_bf16 v[72:75], a[228:231], v[40:43], v[72:75]
v_mfma_f32_16x16x32_bf16 v[76:79], a[228:231], v[44:47], v[76:79]
buffer_load_dwordx4 a[224:227], v1, s[4:7], s66 offen offset:2048
v_mfma_f32_16x16x32_bf16 v[80:83], a[228:231], v[48:51], v[80:83]
v_mfma_f32_16x16x32_bf16 v[84:87], a[228:231], v[52:55], v[84:87]
buffer_load_dwordx4 a[228:231], v1, s[4:7], s66 offen offset:3072
s_waitcnt vmcnt(10)
s_barrier
s_waitcnt lgkmcnt(3)
v_mfma_f32_16x16x32_bf16 v[56:59], a[232:235], v[24:27], v[56:59]
ds_read_b128 v[40:43], v1 offset:15360
s_waitcnt lgkmcnt(3)
v_mfma_f32_16x16x32_bf16 v[60:63], a[232:235], v[28:31], v[60:63]
ds_read_b128 v[44:47], v1 offset:35840
s_waitcnt lgkmcnt(3)
v_mfma_f32_16x16x32_bf16 v[64:67], a[232:235], v[32:35], v[64:67]
ds_read_b128 v[48:51], v1 offset:56320
s_waitcnt lgkmcnt(3)
v_mfma_f32_16x16x32_bf16 v[68:71], a[232:235], v[36:39], v[68:71]
ds_read_b128 v[52:55], v238 offset:15360
v_mfma_f32_16x16x32_bf16 v[72:75], a[236:239], v[24:27], v[72:75]
v_mfma_f32_16x16x32_bf16 v[76:79], a[236:239], v[28:31], v[76:79]
s_add_u32 s66, s66, 4096
buffer_load_dwordx4 a[232:235], v1, s[4:7], s66 offen
v_mfma_f32_16x16x32_bf16 v[80:83], a[236:239], v[32:35], v[80:83]
v_mfma_f32_16x16x32_bf16 v[84:87], a[236:239], v[36:39], v[84:87]
buffer_load_dwordx4 a[236:239], v1, s[4:7], s66 offen offset:1024
s_waitcnt lgkmcnt(3)
v_mfma_f32_16x16x32_bf16 v[56:59], a[240:243], v[40:43], v[56:59]
ds_read_b64 v[24:25], v2 offset:16384
ds_read_b64 v[26:27], v2 offset:16896
s_waitcnt lgkmcnt(4)
v_mfma_f32_16x16x32_bf16 v[60:63], a[240:243], v[44:47], v[60:63]
ds_read_b64 v[28:29], v2 offset:36864
ds_read_b64 v[30:31], v2 offset:37376
s_waitcnt lgkmcnt(5)
v_mfma_f32_16x16x32_bf16 v[64:67], a[240:243], v[48:51], v[64:67]
ds_read_b64 v[32:33], v2 offset:57344
ds_read_b64 v[34:35], v2 offset:57856
s_waitcnt lgkmcnt(6)
v_mfma_f32_16x16x32_bf16 v[68:71], a[240:243], v[52:55], v[68:71]
ds_read_b64 v[36:37], v239 offset:16384
ds_read_b64 v[38:39], v239 offset:16896
v_mfma_f32_16x16x32_bf16 v[72:75], a[244:247], v[40:43], v[72:75]
v_mfma_f32_16x16x32_bf16 v[76:79], a[244:247], v[44:47], v[76:79]
buffer_load_dwordx4 a[240:243], v1, s[4:7], s66 offen offset:2048
v_mfma_f32_16x16x32_bf16 v[80:83], a[244:247], v[48:51], v[80:83]
v_mfma_f32_16x16x32_bf16 v[84:87], a[244:247], v[52:55], v[84:87]
buffer_load_dwordx4 a[244:247], v1, s[4:7], s66 offen offset:3072
s_waitcnt lgkmcnt(6)
v_mfma_f32_16x16x32_bf16 v[56:59], a[248:251], v[24:27], v[56:59]
ds_read_b64 v[40:41], v2 offset:17408
ds_read_b64 v[42:43], v2 offset:17920
s_waitcnt lgkmcnt(6)
v_mfma_f32_16x16x32_bf16 v[60:63], a[248:251], v[28:31], v[60:63]
ds_read_b64 v[44:45], v2 offset:37888
ds_read_b64 v[46:47], v2 offset:38400
s_waitcnt lgkmcnt(6)
v_mfma_f32_16x16x32_bf16 v[64:67], a[248:251], v[32:35], v[64:67]
ds_read_b64 v[48:49], v2 offset:58368
ds_read_b64 v[50:51], v2 offset:58880
s_waitcnt lgkmcnt(6)
v_mfma_f32_16x16x32_bf16 v[68:71], a[248:251], v[36:39], v[68:71]
ds_read_b64 v[52:53], v239 offset:17408
ds_read_b64 v[54:55], v239 offset:17920
v_mfma_f32_16x16x32_bf16 v[72:75], a[252:255], v[24:27], v[72:75]
v_mfma_f32_16x16x32_bf16 v[76:79], a[252:255], v[28:31], v[76:79]
s_add_u32 s66, s66, 4096
buffer_load_dwordx4 a[248:251], v1, s[4:7], s66 offen
v_mfma_f32_16x16x32_bf16 v[80:83], a[252:255], v[32:35], v[80:83]
v_mfma_f32_16x16x32_bf16 v[84:87], a[252:255], v[36:39], v[84:87]
buffer_load_dwordx4 a[252:255], v1, s[4:7], s66 offen offset:1024
s_waitcnt lgkmcnt(6)
v_mfma_f32_16x16x32_bf16 v[56:59], a[0:3], v[40:43], v[56:59]
ds_read_b64 v[24:25], v2 offset:18432
ds_read_b64 v[26:27], v2 offset:18944
s_waitcnt lgkmcnt(6)
v_mfma_f32_16x16x32_bf16 v[60:63], a[0:3], v[44:47], v[60:63]
ds_read_b64 v[28:29], v2 offset:38912
ds_read_b64 v[30:31], v2 offset:39424
s_waitcnt lgkmcnt(6)
v_mfma_f32_16x16x32_bf16 v[64:67], a[0:3], v[48:51], v[64:67]
ds_read_b64 v[32:33], v2 offset:59392
ds_read_b64 v[34:35], v2 offset:59904
s_waitcnt lgkmcnt(6)
v_mfma_f32_16x16x32_bf16 v[68:71], a[0:3], v[52:55], v[68:71]
ds_read_b64 v[36:37], v239 offset:18432
ds_read_b64 v[38:39], v239 offset:18944
v_mfma_f32_16x16x32_bf16 v[72:75], a[4:7], v[40:43], v[72:75]
v_mfma_f32_16x16x32_bf16 v[76:79], a[4:7], v[44:47], v[76:79]
buffer_load_dwordx4 a[0:3], v1, s[4:7], s66 offen offset:2048
v_mfma_f32_16x16x32_bf16 v[80:83], a[4:7], v[48:51], v[80:83]
v_mfma_f32_16x16x32_bf16 v[84:87], a[4:7], v[52:55], v[84:87]
buffer_load_dwordx4 a[4:7], v1, s[4:7], s66 offen offset:3072
s_waitcnt lgkmcnt(6)
v_mfma_f32_16x16x32_bf16 v[56:59], a[8:11], v[24:27], v[56:59]
ds_read_b64 v[40:41], v2 offset:19456
ds_read_b64 v[42:43], v2 offset:19968
s_waitcnt lgkmcnt(6)
v_mfma_f32_16x16x32_bf16 v[60:63], a[8:11], v[28:31], v[60:63]
ds_read_b64 v[44:45], v2 offset:39936
ds_read_b64 v[46:47], v2 offset:40448
s_waitcnt lgkmcnt(6)
v_mfma_f32_16x16x32_bf16 v[64:67], a[8:11], v[32:35], v[64:67]
ds_read_b64 v[48:49], v2 offset:60416
ds_read_b64 v[50:51], v2 offset:60928
s_waitcnt lgkmcnt(6)
v_mfma_f32_16x16x32_bf16 v[68:71], a[8:11], v[36:39], v[68:71]
ds_read_b64 v[52:53], v239 offset:19456
ds_read_b64 v[54:55], v239 offset:19968
v_mfma_f32_16x16x32_bf16 v[72:75], a[12:15], v[24:27], v[72:75]
v_mfma_f32_16x16x32_bf16 v[76:79], a[12:15], v[28:31], v[76:79]
s_add_u32 s66, s66, 4096
buffer_load_dwordx4 a[8:11], v1, s[4:7], s66 offen
v_mfma_f32_16x16x32_bf16 v[80:83], a[12:15], v[32:35], v[80:83]
v_mfma_f32_16x16x32_bf16 v[84:87], a[12:15], v[36:39], v[84:87]
buffer_load_dwordx4 a[12:15], v1, s[4:7], s66 offen offset:1024
s_waitcnt lgkmcnt(6)
v_mfma_f32_16x16x32_bf16 v[56:59], a[16:19], v[40:43], v[56:59]
s_waitcnt lgkmcnt(4)
v_mfma_f32_16x16x32_bf16 v[60:63], a[16:19], v[44:47], v[60:63]
s_waitcnt lgkmcnt(2)
v_mfma_f32_16x16x32_bf16 v[64:67], a[16:19], v[48:51], v[64:67]
s_waitcnt lgkmcnt(0)
v_mfma_f32_16x16x32_bf16 v[68:71], a[16:19], v[52:55], v[68:71]
buffer_load_dwordx4 a[16:19], v1, s[4:7], s66 offen offset:2048
v_mfma_f32_16x16x32_bf16 v[72:75], a[20:23], v[40:43], v[72:75]
v_mfma_f32_16x16x32_bf16 v[76:79], a[20:23], v[44:47], v[76:79]
v_mfma_f32_16x16x32_bf16 v[80:83], a[20:23], v[48:51], v[80:83]
v_mfma_f32_16x16x32_bf16 v[84:87], a[20:23], v[52:55], v[84:87]
v_lshlrev_b32 v3, 2, v241
v_add_u32 v3, 102400, v3
ds_read_b32 v136, v3 offset:0
ds_read_b32 v140, v3 offset:256
ds_read_b32 v137, v3 offset:64
ds_read_b32 v141, v3 offset:320
ds_read_b32 v138, v3 offset:128
ds_read_b32 v142, v3 offset:384
ds_read_b32 v139, v3 offset:192
ds_read_b32 v143, v3 offset:448
s_waitcnt lgkmcnt(0)
s_add_u32 s24, s63, 0
s_lshl_b32 s24, s24, 10
s_mul_i32 s25, s61, 55296
s_add_u32 s24, s24, s25
s_add_u32 s24, s24, 27123712
v_pk_fma_f32 v[56:57], v[176:177], v[136:137], v[56:57] op_sel:[0,0,0] op_sel_hi:[1,0,1]
v_pk_fma_f32 v[58:59], v[178:179], v[136:137], v[58:59] op_sel:[0,0,0] op_sel_hi:[1,0,1]
v_pk_fma_f32 v[56:57], v[56:57], v[140:141], v[184:185] op_sel:[0,0,0] op_sel_hi:[1,0,1]
v_pk_fma_f32 v[58:59], v[58:59], v[140:141], v[186:187] op_sel:[0,0,0] op_sel_hi:[1,0,1]
v_max_f32 v56, 0, v56
v_max_f32 v57, 0, v57
v_max_f32 v58, 0, v58
v_max_f32 v59, 0, v59
v_pk_mul_f32 v[56:57], v[56:57], v[56:57]
v_pk_mul_f32 v[58:59], v[58:59], v[58:59]
v_cvt_pk_bf16_f32 v24, v56, v57
v_cvt_pk_bf16_f32 v25, v58, v59
v_pk_fma_f32 v[72:73], v[180:181], v[136:137], v[72:73] op_sel:[0,0,0] op_sel_hi:[1,0,1]
v_pk_fma_f32 v[74:75], v[182:183], v[136:137], v[74:75] op_sel:[0,0,0] op_sel_hi:[1,0,1]
v_pk_fma_f32 v[72:73], v[72:73], v[140:141], v[188:189] op_sel:[0,0,0] op_sel_hi:[1,0,1]
v_pk_fma_f32 v[74:75], v[74:75], v[140:141], v[190:191] op_sel:[0,0,0] op_sel_hi:[1,0,1]
v_max_f32 v72, 0, v72
v_max_f32 v73, 0, v73
v_max_f32 v74, 0, v74
v_max_f32 v75, 0, v75
v_pk_mul_f32 v[72:73], v[72:73], v[72:73]
v_pk_mul_f32 v[74:75], v[74:75], v[74:75]
v_cvt_pk_bf16_f32 v26, v72, v73
v_cvt_pk_bf16_f32 v27, v74, v75
s_cmp_eq_u32 s72, 0
s_cbranch_scc1 XS120
buffer_store_dwordx4 v[24:27], v1, s[4:7], s24 offen
s_branch XE121
XS120:
buffer_store_dwordx4 v[24:27], v1, s[4:7], s24 offen sc1
XE121:
s_add_u32 s24, s24, 55296
v_pk_fma_f32 v[60:61], v[176:177], v[136:137], v[60:61] op_sel:[0,1,0] op_sel_hi:[1,1,1]
v_pk_fma_f32 v[62:63], v[178:179], v[136:137], v[62:63] op_sel:[0,1,0] op_sel_hi:[1,1,1]
v_pk_fma_f32 v[60:61], v[60:61], v[140:141], v[184:185] op_sel:[0,1,0] op_sel_hi:[1,1,1]
v_pk_fma_f32 v[62:63], v[62:63], v[140:141], v[186:187] op_sel:[0,1,0] op_sel_hi:[1,1,1]
v_max_f32 v60, 0, v60
v_max_f32 v61, 0, v61
v_max_f32 v62, 0, v62
v_max_f32 v63, 0, v63
v_pk_mul_f32 v[60:61], v[60:61], v[60:61]
v_pk_mul_f32 v[62:63], v[62:63], v[62:63]
v_cvt_pk_bf16_f32 v28, v60, v61
v_cvt_pk_bf16_f32 v29, v62, v63
v_pk_fma_f32 v[76:77], v[180:181], v[136:137], v[76:77] op_sel:[0,1,0] op_sel_hi:[1,1,1]
v_pk_fma_f32 v[78:79], v[182:183], v[136:137], v[78:79] op_sel:[0,1,0] op_sel_hi:[1,1,1]
v_pk_fma_f32 v[76:77], v[76:77], v[140:141], v[188:189] op_sel:[0,1,0] op_sel_hi:[1,1,1]
v_pk_fma_f32 v[78:79], v[78:79], v[140:141], v[190:191] op_sel:[0,1,0] op_sel_hi:[1,1,1]
v_max_f32 v76, 0, v76
v_max_f32 v77, 0, v77
v_max_f32 v78, 0, v78
v_max_f32 v79, 0, v79
v_pk_mul_f32 v[76:77], v[76:77], v[76:77]
v_pk_mul_f32 v[78:79], v[78:79], v[78:79]
v_cvt_pk_bf16_f32 v30, v76, v77
v_cvt_pk_bf16_f32 v31, v78, v79
s_cmp_eq_u32 s72, 0
s_cbranch_scc1 XS122
buffer_store_dwordx4 v[28:31], v1, s[4:7], s24 offen
s_branch XE123
XS122:
buffer_store_dwordx4 v[28:31], v1, s[4:7], s24 offen sc1
XE123:
s_add_u32 s24, s24, 55296
v_pk_fma_f32 v[64:65], v[176:177], v[138:139], v[64:65] op_sel:[0,0,0] op_sel_hi:[1,0,1]
v_pk_fma_f32 v[66:67], v[178:179], v[138:139], v[66:67] op_sel:[0,0,0] op_sel_hi:[1,0,1]
v_pk_fma_f32 v[64:65], v[64:65], v[142:143], v[184:185] op_sel:[0,0,0] op_sel_hi:[1,0,1]
v_pk_fma_f32 v[66:67], v[66:67], v[142:143], v[186:187] op_sel:[0,0,0] op_sel_hi:[1,0,1]
v_max_f32 v64, 0, v64
v_max_f32 v65, 0, v65
v_max_f32 v66, 0, v66
v_max_f32 v67, 0, v67
v_pk_mul_f32 v[64:65], v[64:65], v[64:65]
v_pk_mul_f32 v[66:67], v[66:67], v[66:67]
v_cvt_pk_bf16_f32 v32, v64, v65
v_cvt_pk_bf16_f32 v33, v66, v67
v_pk_fma_f32 v[80:81], v[180:181], v[138:139], v[80:81] op_sel:[0,0,0] op_sel_hi:[1,0,1]
v_pk_fma_f32 v[82:83], v[182:183], v[138:139], v[82:83] op_sel:[0,0,0] op_sel_hi:[1,0,1]
v_pk_fma_f32 v[80:81], v[80:81], v[142:143], v[188:189] op_sel:[0,0,0] op_sel_hi:[1,0,1]
v_pk_fma_f32 v[82:83], v[82:83], v[142:143], v[190:191] op_sel:[0,0,0] op_sel_hi:[1,0,1]
v_max_f32 v80, 0, v80
v_max_f32 v81, 0, v81
v_max_f32 v82, 0, v82
v_max_f32 v83, 0, v83
v_pk_mul_f32 v[80:81], v[80:81], v[80:81]
v_pk_mul_f32 v[82:83], v[82:83], v[82:83]
v_cvt_pk_bf16_f32 v34, v80, v81
v_cvt_pk_bf16_f32 v35, v82, v83
s_cmp_eq_u32 s72, 0
s_cbranch_scc1 XS124
buffer_store_dwordx4 v[32:35], v1, s[4:7], s24 offen
s_branch XE125
XS124:
buffer_store_dwordx4 v[32:35], v1, s[4:7], s24 offen sc1
XE125:
s_add_u32 s24, s24, 55296
v_pk_fma_f32 v[68:69], v[176:177], v[138:139], v[68:69] op_sel:[0,1,0] op_sel_hi:[1,1,1]
v_pk_fma_f32 v[70:71], v[178:179], v[138:139], v[70:71] op_sel:[0,1,0] op_sel_hi:[1,1,1]
v_pk_fma_f32 v[68:69], v[68:69], v[142:143], v[184:185] op_sel:[0,1,0] op_sel_hi:[1,1,1]
v_pk_fma_f32 v[70:71], v[70:71], v[142:143], v[186:187] op_sel:[0,1,0] op_sel_hi:[1,1,1]
v_max_f32 v68, 0, v68
v_max_f32 v69, 0, v69
v_max_f32 v70, 0, v70
v_max_f32 v71, 0, v71
v_pk_mul_f32 v[68:69], v[68:69], v[68:69]
v_pk_mul_f32 v[70:71], v[70:71], v[70:71]
v_cvt_pk_bf16_f32 v36, v68, v69
v_cvt_pk_bf16_f32 v37, v70, v71
v_pk_fma_f32 v[84:85], v[180:181], v[138:139], v[84:85] op_sel:[0,1,0] op_sel_hi:[1,1,1]
v_pk_fma_f32 v[86:87], v[182:183], v[138:139], v[86:87] op_sel:[0,1,0] op_sel_hi:[1,1,1]
v_pk_fma_f32 v[84:85], v[84:85], v[142:143], v[188:189] op_sel:[0,1,0] op_sel_hi:[1,1,1]
v_pk_fma_f32 v[86:87], v[86:87], v[142:143], v[190:191] op_sel:[0,1,0] op_sel_hi:[1,1,1]
v_max_f32 v84, 0, v84
v_max_f32 v85, 0, v85
v_max_f32 v86, 0, v86
v_max_f32 v87, 0, v87
v_pk_mul_f32 v[84:85], v[84:85], v[84:85]
v_pk_mul_f32 v[86:87], v[86:87], v[86:87]
v_cvt_pk_bf16_f32 v38, v84, v85
v_cvt_pk_bf16_f32 v39, v86, v87
s_cmp_eq_u32 s72, 0
s_cbranch_scc1 XS126
buffer_store_dwordx4 v[36:39], v1, s[4:7], s24 offen
s_branch XE127
XS126:
buffer_store_dwordx4 v[36:39], v1, s[4:7], s24 offen sc1
XE127:
v_and_b32 v203, 0xffff0000, v201
v_lshlrev_b32 v202, 16, v201
v_and_b32 v201, 0xffff0000, v200
v_lshlrev_b32 v200, 16, v200
v_and_b32 v207, 0xffff0000, v205
v_lshlrev_b32 v206, 16, v205
v_and_b32 v205, 0xffff0000, v204
v_lshlrev_b32 v204, 16, v204
ds_read_b128 v[24:27], v1 offset:0
ds_read_b128 v[28:31], v1 offset:20480
ds_read_b128 v[32:35], v1 offset:40960
ds_read_b128 v[36:39], v238 offset:0
s_waitcnt lgkmcnt(3)
v_mfma_f32_16x16x32_bf16 v[56:59], a[24:27], v[24:27], 0
ds_read_b128 v[40:43], v1 offset:1024
s_waitcnt lgkmcnt(3)
v_mfma_f32_16x16x32_bf16 v[60:63], a[24:27], v[28:31], 0
ds_read_b128 v[44:47], v1 offset:21504
s_waitcnt lgkmcnt(3)
v_mfma_f32_16x16x32_bf16 v[64:67], a[24:27], v[32:35], 0
ds_read_b128 v[48:51], v1 offset:41984
s_waitcnt lgkmcnt(3)
v_mfma_f32_16x16x32_bf16 v[68:71], a[24:27], v[36:39], 0
ds_read_b128 v[52:55], v238 offset:1024
v_mfma_f32_16x16x32_bf16 v[72:75], a[28:31], v[24:27], 0
buffer_load_dwordx4 a[20:23], v1, s[4:7], s66 offen offset:3072
v_mfma_f32_16x16x32_bf16 v[76:79], a[28:31], v[28:31], 0
s_add_u32 s66, s66, 4096
buffer_load_dwordx4 a[24:27], v1, s[4:7], s66 offen
v_mfma_f32_16x16x32_bf16 v[80:83], a[28:31], v[32:35], 0
v_mfma_f32_16x16x32_bf16 v[84:87], a[28:31], v[36:39], 0
s_waitcnt lgkmcnt(3)
v_mfma_f32_16x16x32_bf16 v[56:59], a[32:35], v[40:43], v[56:59]
ds_read_b128 v[24:27], v1 offset:2048
s_waitcnt lgkmcnt(3)
v_mfma_f32_16x16x32_bf16 v[60:63], a[32:35], v[44:47], v[60:63]
ds_read_b128 v[28:31], v1 offset:22528
s_waitcnt lgkmcnt(3)
v_mfma_f32_16x16x32_bf16 v[64:67], a[32:35], v[48:51], v[64:67]
ds_read_b128 v[32:35], v1 offset:43008
s_waitcnt lgkmcnt(3)
v_mfma_f32_16x16x32_bf16 v[68:71], a[32:35], v[52:55], v[68:71]
ds_read_b128 v[36:39], v238 offset:2048
v_mfma_f32_16x16x32_bf16 v[72:75], a[36:39], v[40:43], v[72:75]
buffer_load_dwordx4 a[28:31], v1, s[4:7], s66 offen offset:1024
v_mfma_f32_16x16x32_bf16 v[76:79], a[36:39], v[44:47], v[76:79]
buffer_load_dwordx4 a[32:35], v1, s[4:7], s66 offen offset:2048
v_mfma_f32_16x16x32_bf16 v[80:83], a[36:39], v[48:51], v[80:83]
v_mfma_f32_16x16x32_bf16 v[84:87], a[36:39], v[52:55], v[84:87]
s_waitcnt lgkmcnt(3)
v_mfma_f32_16x16x32_bf16 v[56:59], a[40:43], v[24:27], v[56:59]
ds_read_b128 v[40:43], v1 offset:3072
s_waitcnt lgkmcnt(3)
v_mfma_f32_16x16x32_bf16 v[60:63], a[40:43], v[28:31], v[60:63]
ds_read_b128 v[44:47], v1 offset:23552
s_waitcnt lgkmcnt(3)
v_mfma_f32_16x16x32_bf16 v[64:67], a[40:43], v[32:35], v[64:67]
ds_read_b128 v[48:51], v1 offset:44032
s_waitcnt lgkmcnt(3)
v_mfma_f32_16x16x32_bf16 v[68:71], a[40:43], v[36:39], v[68:71]
ds_read_b128 v[52:55], v238 offset:3072
v_mfma_f32_16x16x32_bf16 v[72:75], a[44:47], v[24:27], v[72:75]
buffer_load_dwordx4 a[36:39], v1, s[4:7], s66 offen offset:3072
v_mfma_f32_16x16x32_bf16 v[76:79], a[44:47], v[28:31], v[76:79]
s_add_u32 s66, s66, 4096
buffer_load_dwordx4 a[40:43], v1, s[4:7], s66 offen
v_mfma_f32_16x16x32_bf16 v[80:83], a[44:47], v[32:35], v[80:83]
v_mfma_f32_16x16x32_bf16 v[84:87], a[44:47], v[36:39], v[84:87]
s_waitcnt lgkmcnt(3)
v_mfma_f32_16x16x32_bf16 v[56:59], a[48:51], v[40:43], v[56:59]
ds_read_b128 v[24:27], v1 offset:4096
s_waitcnt lgkmcnt(3)
v_mfma_f32_16x16x32_bf16 v[60:63], a[48:51], v[44:47], v[60:63]
ds_read_b128 v[28:31], v1 offset:24576
s_waitcnt lgkmcnt(3)
v_mfma_f32_16x16x32_bf16 v[64:67], a[48:51], v[48:51], v[64:67]
ds_read_b128 v[32:35], v1 offset:45056
s_waitcnt lgkmcnt(3)
v_mfma_f32_16x16x32_bf16 v[68:71], a[48:51], v[52:55], v[68:71]
ds_read_b128 v[36:39], v238 offset:4096
v_mfma_f32_16x16x32_bf16 v[72:75], a[52:55], v[40:43], v[72:75]
buffer_load_dwordx4 a[44:47], v1, s[4:7], s66 offen offset:1024
v_mfma_f32_16x16x32_bf16 v[76:79], a[52:55], v[44:47], v[76:79]
buffer_load_dwordx4 a[48:51], v1, s[4:7], s66 offen offset:2048
v_mfma_f32_16x16x32_bf16 v[80:83], a[52:55], v[48:51], v[80:83]
v_mfma_f32_16x16x32_bf16 v[84:87], a[52:55], v[52:55], v[84:87]
s_waitcnt lgkmcnt(3)
v_mfma_f32_16x16x32_bf16 v[56:59], a[56:59], v[24:27], v[56:59]
ds_read_b128 v[40:43], v1 offset:5120
s_waitcnt lgkmcnt(3)
v_mfma_f32_16x16x32_bf16 v[60:63], a[56:59], v[28:31], v[60:63]
ds_read_b128 v[44:47], v1 offset:25600
s_waitcnt lgkmcnt(3)
v_mfma_f32_16x16x32_bf16 v[64:67], a[56:59], v[32:35], v[64:67]
ds_read_b128 v[48:51], v1 offset:46080
s_waitcnt lgkmcnt(3)
v_mfma_f32_16x16x32_bf16 v[68:71], a[56:59], v[36:39], v[68:71]
ds_read_b128 v[52:55], v238 offset:5120
v_mfma_f32_16x16x32_bf16 v[72:75], a[60:63], v[24:27], v[72:75]
buffer_load_dwordx4 a[52:55], v1, s[4:7], s66 offen offset:3072
v_mfma_f32_16x16x32_bf16 v[76:79], a[60:63], v[28:31], v[76:79]
s_add_u32 s66, s66, 4096
buffer_load_dwordx4 a[56:59], v1, s[4:7], s66 offen
v_mfma_f32_16x16x32_bf16 v[80:83], a[60:63], v[32:35], v[80:83]
v_mfma_f32_16x16x32_bf16 v[84:87], a[60:63], v[36:39], v[84:87]
s_waitcnt lgkmcnt(3)
v_mfma_f32_16x16x32_bf16 v[56:59], a[64:67], v[40:43], v[56:59]
ds_read_b128 v[24:27], v1 offset:6144
s_waitcnt lgkmcnt(3)
v_mfma_f32_16x16x32_bf16 v[60:63], a[64:67], v[44:47], v[60:63]
ds_read_b128 v[28:31], v1 offset:26624
s_waitcnt lgkmcnt(3)
v_mfma_f32_16x16x32_bf16 v[64:67], a[64:67], v[48:51], v[64:67]
ds_read_b128 v[32:35], v1 offset:47104
s_waitcnt lgkmcnt(3)
v_mfma_f32_16x16x32_bf16 v[68:71], a[64:67], v[52:55], v[68:71]
ds_read_b128 v[36:39], v238 offset:6144
v_mfma_f32_16x16x32_bf16 v[72:75], a[104:107], v[40:43], v[72:75]
buffer_load_dwordx4 a[60:63], v1, s[4:7], s66 offen offset:1024
v_mfma_f32_16x16x32_bf16 v[76:79], a[104:107], v[44:47], v[76:79]
buffer_load_dwordx4 a[64:67], v1, s[4:7], s66 offen offset:2048
v_mfma_f32_16x16x32_bf16 v[80:83], a[104:107], v[48:51], v[80:83]
v_mfma_f32_16x16x32_bf16 v[84:87], a[104:107], v[52:55], v[84:87]
s_waitcnt lgkmcnt(3)
v_mfma_f32_16x16x32_bf16 v[56:59], a[108:111], v[24:27], v[56:59]
ds_read_b128 v[40:43], v1 offset:7168
s_waitcnt lgkmcnt(3)
v_mfma_f32_16x16x32_bf16 v[60:63], a[108:111], v[28:31], v[60:63]
ds_read_b128 v[44:47], v1 offset:27648
s_waitcnt lgkmcnt(3)
v_mfma_f32_16x16x32_bf16 v[64:67], a[108:111], v[32:35], v[64:67]
ds_read_b128 v[48:51], v1 offset:48128
s_waitcnt lgkmcnt(3)
v_mfma_f32_16x16x32_bf16 v[68:71], a[108:111], v[36:39], v[68:71]
ds_read_b128 v[52:55], v238 offset:7168
v_mfma_f32_16x16x32_bf16 v[72:75], a[112:115], v[24:27], v[72:75]
buffer_load_dwordx4 a[104:107], v1, s[4:7], s66 offen offset:3072
v_mfma_f32_16x16x32_bf16 v[76:79], a[112:115], v[28:31], v[76:79]
s_add_u32 s66, s66, 4096
buffer_load_dwordx4 a[108:111], v1, s[4:7], s66 offen
v_mfma_f32_16x16x32_bf16 v[80:83], a[112:115], v[32:35], v[80:83]
v_mfma_f32_16x16x32_bf16 v[84:87], a[112:115], v[36:39], v[84:87]
s_waitcnt lgkmcnt(3)
v_mfma_f32_16x16x32_bf16 v[56:59], a[68:71], v[40:43], v[56:59]
ds_read_b128 v[24:27], v1 offset:8192
s_waitcnt lgkmcnt(3)
v_mfma_f32_16x16x32_bf16 v[60:63], a[68:71], v[44:47], v[60:63]
ds_read_b128 v[28:31], v1 offset:28672
s_waitcnt lgkmcnt(3)
v_mfma_f32_16x16x32_bf16 v[64:67], a[68:71], v[48:51], v[64:67]
ds_read_b128 v[32:35], v1 offset:49152
s_waitcnt lgkmcnt(3)
v_mfma_f32_16x16x32_bf16 v[68:71], a[68:71], v[52:55], v[68:71]
ds_read_b128 v[36:39], v238 offset:8192
v_mfma_f32_16x16x32_bf16 v[72:75], a[72:75], v[40:43], v[72:75]
buffer_load_dwordx4 a[112:115], v1, s[4:7], s66 offen offset:1024
v_mfma_f32_16x16x32_bf16 v[76:79], a[72:75], v[44:47], v[76:79]
buffer_load_dwordx4 a[68:71], v1, s[4:7], s66 offen offset:2048
v_mfma_f32_16x16x32_bf16 v[80:83], a[72:75], v[48:51], v[80:83]
v_mfma_f32_16x16x32_bf16 v[84:87], a[72:75], v[52:55], v[84:87]
s_waitcnt lgkmcnt(3)
v_mfma_f32_16x16x32_bf16 v[56:59], a[76:79], v[24:27], v[56:59]
ds_read_b128 v[40:43], v1 offset:9216
s_waitcnt lgkmcnt(3)
v_mfma_f32_16x16x32_bf16 v[60:63], a[76:79], v[28:31], v[60:63]
ds_read_b128 v[44:47], v1 offset:29696
s_waitcnt lgkmcnt(3)
v_mfma_f32_16x16x32_bf16 v[64:67], a[76:79], v[32:35], v[64:67]
ds_read_b128 v[48:51], v1 offset:50176
s_waitcnt lgkmcnt(3)
v_mfma_f32_16x16x32_bf16 v[68:71], a[76:79], v[36:39], v[68:71]
ds_read_b128 v[52:55], v238 offset:9216
v_mfma_f32_16x16x32_bf16 v[72:75], a[80:83], v[24:27], v[72:75]
buffer_load_dwordx4 a[72:75], v1, s[4:7], s66 offen offset:3072
v_mfma_f32_16x16x32_bf16 v[76:79], a[80:83], v[28:31], v[76:79]
s_add_u32 s66, s66, 4096
buffer_load_dwordx4 a[76:79], v1, s[4:7], s66 offen
v_mfma_f32_16x16x32_bf16 v[80:83], a[80:83], v[32:35], v[80:83]
v_mfma_f32_16x16x32_bf16 v[84:87], a[80:83], v[36:39], v[84:87]
s_waitcnt lgkmcnt(3)
v_mfma_f32_16x16x32_bf16 v[56:59], a[84:87], v[40:43], v[56:59]
ds_read_b128 v[24:27], v1 offset:10240
s_waitcnt lgkmcnt(3)
v_mfma_f32_16x16x32_bf16 v[60:63], a[84:87], v[44:47], v[60:63]
ds_read_b128 v[28:31], v1 offset:30720
s_waitcnt lgkmcnt(3)
v_mfma_f32_16x16x32_bf16 v[64:67], a[84:87], v[48:51], v[64:67]
ds_read_b128 v[32:35], v1 offset:51200
s_waitcnt lgkmcnt(3)
v_mfma_f32_16x16x32_bf16 v[68:71], a[84:87], v[52:55], v[68:71]
ds_read_b128 v[36:39], v238 offset:10240
v_mfma_f32_16x16x32_bf16 v[72:75], a[88:91], v[40:43], v[72:75]
buffer_load_dwordx4 a[80:83], v1, s[4:7], s66 offen offset:1024
v_mfma_f32_16x16x32_bf16 v[76:79], a[88:91], v[44:47], v[76:79]
buffer_load_dwordx4 a[84:87], v1, s[4:7], s66 offen offset:2048
v_mfma_f32_16x16x32_bf16 v[80:83], a[88:91], v[48:51], v[80:83]
v_mfma_f32_16x16x32_bf16 v[84:87], a[88:91], v[52:55], v[84:87]
s_waitcnt lgkmcnt(3)
v_mfma_f32_16x16x32_bf16 v[56:59], a[92:95], v[24:27], v[56:59]
ds_read_b128 v[40:43], v1 offset:11264
s_waitcnt lgkmcnt(3)
v_mfma_f32_16x16x32_bf16 v[60:63], a[92:95], v[28:31], v[60:63]
ds_read_b128 v[44:47], v1 offset:31744
s_waitcnt lgkmcnt(3)
v_mfma_f32_16x16x32_bf16 v[64:67], a[92:95], v[32:35], v[64:67]
ds_read_b128 v[48:51], v1 offset:52224
s_waitcnt lgkmcnt(3)
v_mfma_f32_16x16x32_bf16 v[68:71], a[92:95], v[36:39], v[68:71]
ds_read_b128 v[52:55], v238 offset:11264
v_mfma_f32_16x16x32_bf16 v[72:75], a[96:99], v[24:27], v[72:75]
buffer_load_dwordx4 a[88:91], v1, s[4:7], s66 offen offset:3072
v_mfma_f32_16x16x32_bf16 v[76:79], a[96:99], v[28:31], v[76:79]
s_add_u32 s66, s66, 4096
buffer_load_dwordx4 a[92:95], v1, s[4:7], s66 offen
v_mfma_f32_16x16x32_bf16 v[80:83], a[96:99], v[32:35], v[80:83]
v_mfma_f32_16x16x32_bf16 v[84:87], a[96:99], v[36:39], v[84:87]
s_waitcnt lgkmcnt(3)
v_mfma_f32_16x16x32_bf16 v[56:59], a[100:103], v[40:43], v[56:59]
ds_read_b128 v[24:27], v1 offset:12288
s_waitcnt lgkmcnt(3)
v_mfma_f32_16x16x32_bf16 v[60:63], a[100:103], v[44:47], v[60:63]
ds_read_b128 v[28:31], v1 offset:32768
s_waitcnt lgkmcnt(3)
v_mfma_f32_16x16x32_bf16 v[64:67], a[100:103], v[48:51], v[64:67]
ds_read_b128 v[32:35], v1 offset:53248
s_waitcnt lgkmcnt(3)
v_mfma_f32_16x16x32_bf16 v[68:71], a[100:103], v[52:55], v[68:71]
ds_read_b128 v[36:39], v238 offset:12288
v_mfma_f32_16x16x32_bf16 v[72:75], a[116:119], v[40:43], v[72:75]
buffer_load_dwordx4 a[96:99], v1, s[4:7], s66 offen offset:1024
v_mfma_f32_16x16x32_bf16 v[76:79], a[116:119], v[44:47], v[76:79]
buffer_load_dwordx4 a[100:103], v1, s[4:7], s66 offen offset:2048
v_mfma_f32_16x16x32_bf16 v[80:83], a[116:119], v[48:51], v[80:83]
v_mfma_f32_16x16x32_bf16 v[84:87], a[116:119], v[52:55], v[84:87]
s_waitcnt lgkmcnt(3)
v_mfma_f32_16x16x32_bf16 v[56:59], a[120:123], v[24:27], v[56:59]
ds_read_b128 v[40:43], v1 offset:13312
s_waitcnt lgkmcnt(3)
v_mfma_f32_16x16x32_bf16 v[60:63], a[120:123], v[28:31], v[60:63]
ds_read_b128 v[44:47], v1 offset:33792
s_waitcnt lgkmcnt(3)
v_mfma_f32_16x16x32_bf16 v[64:67], a[120:123], v[32:35], v[64:67]
ds_read_b128 v[48:51], v1 offset:54272
s_waitcnt lgkmcnt(3)
v_mfma_f32_16x16x32_bf16 v[68:71], a[120:123], v[36:39], v[68:71]
ds_read_b128 v[52:55], v238 offset:13312
v_mfma_f32_16x16x32_bf16 v[72:75], a[124:127], v[24:27], v[72:75]
buffer_load_dwordx4 a[116:119], v1, s[4:7], s66 offen offset:3072
v_mfma_f32_16x16x32_bf16 v[76:79], a[124:127], v[28:31], v[76:79]
v_mfma_f32_16x16x32_bf16 v[80:83], a[124:127], v[32:35], v[80:83]
v_mfma_f32_16x16x32_bf16 v[84:87], a[124:127], v[36:39], v[84:87]
s_waitcnt lgkmcnt(3)
v_mfma_f32_16x16x32_bf16 v[56:59], a[128:131], v[40:43], v[56:59]
ds_read_b128 v[24:27], v1 offset:14336
s_waitcnt lgkmcnt(3)
v_mfma_f32_16x16x32_bf16 v[60:63], a[128:131], v[44:47], v[60:63]
ds_read_b128 v[28:31], v1 offset:34816
s_waitcnt lgkmcnt(3)
v_mfma_f32_16x16x32_bf16 v[64:67], a[128:131], v[48:51], v[64:67]
ds_read_b128 v[32:35], v1 offset:55296
s_waitcnt lgkmcnt(3)
v_mfma_f32_16x16x32_bf16 v[68:71], a[128:131], v[52:55], v[68:71]
ds_read_b128 v[36:39], v238 offset:14336
v_mfma_f32_16x16x32_bf16 v[72:75], a[132:135], v[40:43], v[72:75]
v_mfma_f32_16x16x32_bf16 v[76:79], a[132:135], v[44:47], v[76:79]
v_mfma_f32_16x16x32_bf16 v[80:83], a[132:135], v[48:51], v[80:83]
v_mfma_f32_16x16x32_bf16 v[84:87], a[132:135], v[52:55], v[84:87]
s_waitcnt lgkmcnt(3)
v_mfma_f32_16x16x32_bf16 v[56:59], a[136:139], v[24:27], v[56:59]
ds_read_b128 v[40:43], v1 offset:15360
s_waitcnt lgkmcnt(3)
v_mfma_f32_16x16x32_bf16 v[60:63], a[136:139], v[28:31], v[60:63]
ds_read_b128 v[44:47], v1 offset:35840
s_waitcnt lgkmcnt(3)
v_mfma_f32_16x16x32_bf16 v[64:67], a[136:139], v[32:35], v[64:67]
ds_read_b128 v[48:51], v1 offset:56320
s_waitcnt lgkmcnt(3)
v_mfma_f32_16x16x32_bf16 v[68:71], a[136:139], v[36:39], v[68:71]
ds_read_b128 v[52:55], v238 offset:15360
v_mfma_f32_16x16x32_bf16 v[72:75], a[140:143], v[24:27], v[72:75]
v_mfma_f32_16x16x32_bf16 v[76:79], a[140:143], v[28:31], v[76:79]
v_mfma_f32_16x16x32_bf16 v[80:83], a[140:143], v[32:35], v[80:83]
v_mfma_f32_16x16x32_bf16 v[84:87], a[140:143], v[36:39], v[84:87]
s_waitcnt lgkmcnt(3)
v_mfma_f32_16x16x32_bf16 v[56:59], a[144:147], v[40:43], v[56:59]
ds_read_b64 v[24:25], v2 offset:16384
ds_read_b64 v[26:27], v2 offset:16896
s_waitcnt lgkmcnt(4)
v_mfma_f32_16x16x32_bf16 v[60:63], a[144:147], v[44:47], v[60:63]
ds_read_b64 v[28:29], v2 offset:36864
ds_read_b64 v[30:31], v2 offset:37376
s_waitcnt lgkmcnt(5)
v_mfma_f32_16x16x32_bf16 v[64:67], a[144:147], v[48:51], v[64:67]
ds_read_b64 v[32:33], v2 offset:57344
ds_read_b64 v[34:35], v2 offset:57856
s_waitcnt lgkmcnt(6)
v_mfma_f32_16x16x32_bf16 v[68:71], a[144:147], v[52:55], v[68:71]
ds_read_b64 v[36:37], v239 offset:16384
ds_read_b64 v[38:39], v239 offset:16896
v_mfma_f32_16x16x32_bf16 v[72:75], a[148:151], v[40:43], v[72:75]
v_mfma_f32_16x16x32_bf16 v[76:79], a[148:151], v[44:47], v[76:79]
v_mfma_f32_16x16x32_bf16 v[80:83], a[148:151], v[48:51], v[80:83]
v_mfma_f32_16x16x32_bf16 v[84:87], a[148:151], v[52:55], v[84:87]
s_waitcnt lgkmcnt(6)
v_mfma_f32_16x16x32_bf16 v[56:59], a[152:155], v[24:27], v[56:59]
ds_read_b64 v[40:41], v2 offset:17408
ds_read_b64 v[42:43], v2 offset:17920
s_waitcnt lgkmcnt(6)
v_mfma_f32_16x16x32_bf16 v[60:63], a[152:155], v[28:31], v[60:63]
ds_read_b64 v[44:45], v2 offset:37888
ds_read_b64 v[46:47], v2 offset:38400
s_waitcnt lgkmcnt(6)
v_mfma_f32_16x16x32_bf16 v[64:67], a[152:155], v[32:35], v[64:67]
ds_read_b64 v[48:49], v2 offset:58368
ds_read_b64 v[50:51], v2 offset:58880
s_waitcnt lgkmcnt(6)
v_mfma_f32_16x16x32_bf16 v[68:71], a[152:155], v[36:39], v[68:71]
ds_read_b64 v[52:53], v239 offset:17408
ds_read_b64 v[54:55], v239 offset:17920
v_mfma_f32_16x16x32_bf16 v[72:75], a[156:159], v[24:27], v[72:75]
v_mfma_f32_16x16x32_bf16 v[76:79], a[156:159], v[28:31], v[76:79]
v_mfma_f32_16x16x32_bf16 v[80:83], a[156:159], v[32:35], v[80:83]
v_mfma_f32_16x16x32_bf16 v[84:87], a[156:159], v[36:39], v[84:87]
s_waitcnt lgkmcnt(6)
v_mfma_f32_16x16x32_bf16 v[56:59], a[160:163], v[40:43], v[56:59]
ds_read_b64 v[24:25], v2 offset:18432
ds_read_b64 v[26:27], v2 offset:18944
s_waitcnt lgkmcnt(6)
v_mfma_f32_16x16x32_bf16 v[60:63], a[160:163], v[44:47], v[60:63]
ds_read_b64 v[28:29], v2 offset:38912
ds_read_b64 v[30:31], v2 offset:39424
s_waitcnt lgkmcnt(6)
v_mfma_f32_16x16x32_bf16 v[64:67], a[160:163], v[48:51], v[64:67]
ds_read_b64 v[32:33], v2 offset:59392
ds_read_b64 v[34:35], v2 offset:59904
s_waitcnt lgkmcnt(6)
v_mfma_f32_16x16x32_bf16 v[68:71], a[160:163], v[52:55], v[68:71]
ds_read_b64 v[36:37], v239 offset:18432
ds_read_b64 v[38:39], v239 offset:18944
v_mfma_f32_16x16x32_bf16 v[72:75], a[164:167], v[40:43], v[72:75]
v_mfma_f32_16x16x32_bf16 v[76:79], a[164:167], v[44:47], v[76:79]
v_mfma_f32_16x16x32_bf16 v[80:83], a[164:167], v[48:51], v[80:83]
v_mfma_f32_16x16x32_bf16 v[84:87], a[164:167], v[52:55], v[84:87]
s_waitcnt lgkmcnt(6)
v_mfma_f32_16x16x32_bf16 v[56:59], a[168:171], v[24:27], v[56:59]
ds_read_b64 v[40:41], v2 offset:19456
ds_read_b64 v[42:43], v2 offset:19968
s_waitcnt lgkmcnt(6)
v_mfma_f32_16x16x32_bf16 v[60:63], a[168:171], v[28:31], v[60:63]
ds_read_b64 v[44:45], v2 offset:39936
ds_read_b64 v[46:47], v2 offset:40448
s_waitcnt lgkmcnt(6)
v_mfma_f32_16x16x32_bf16 v[64:67], a[168:171], v[32:35], v[64:67]
ds_read_b64 v[48:49], v2 offset:60416
ds_read_b64 v[50:51], v2 offset:60928
s_waitcnt lgkmcnt(6)
v_mfma_f32_16x16x32_bf16 v[68:71], a[168:171], v[36:39], v[68:71]
ds_read_b64 v[52:53], v239 offset:19456
ds_read_b64 v[54:55], v239 offset:19968
v_mfma_f32_16x16x32_bf16 v[72:75], a[172:175], v[24:27], v[72:75]
v_mfma_f32_16x16x32_bf16 v[76:79], a[172:175], v[28:31], v[76:79]
v_mfma_f32_16x16x32_bf16 v[80:83], a[172:175], v[32:35], v[80:83]
v_mfma_f32_16x16x32_bf16 v[84:87], a[172:175], v[36:39], v[84:87]
s_waitcnt lgkmcnt(6)
v_mfma_f32_16x16x32_bf16 v[56:59], a[176:179], v[40:43], v[56:59]
s_waitcnt lgkmcnt(4)
v_mfma_f32_16x16x32_bf16 v[60:63], a[176:179], v[44:47], v[60:63]
s_waitcnt lgkmcnt(2)
v_mfma_f32_16x16x32_bf16 v[64:67], a[176:179], v[48:51], v[64:67]
s_waitcnt lgkmcnt(0)
v_mfma_f32_16x16x32_bf16 v[68:71], a[176:179], v[52:55], v[68:71]
v_mfma_f32_16x16x32_bf16 v[72:75], a[180:183], v[40:43], v[72:75]
v_mfma_f32_16x16x32_bf16 v[76:79], a[180:183], v[44:47], v[76:79]
v_mfma_f32_16x16x32_bf16 v[80:83], a[180:183], v[48:51], v[80:83]
v_mfma_f32_16x16x32_bf16 v[84:87], a[180:183], v[52:55], v[84:87]
s_add_u32 s24, s63, 1
s_lshl_b32 s24, s24, 10
s_mul_i32 s25, s61, 55296
s_add_u32 s24, s24, s25
s_add_u32 s24, s24, 27123712
v_pk_fma_f32 v[56:57], v[192:193], v[136:137], v[56:57] op_sel:[0,0,0] op_sel_hi:[1,0,1]
v_pk_fma_f32 v[58:59], v[194:195], v[136:137], v[58:59] op_sel:[0,0,0] op_sel_hi:[1,0,1]
v_pk_fma_f32 v[56:57], v[56:57], v[140:141], v[200:201] op_sel:[0,0,0] op_sel_hi:[1,0,1]
v_pk_fma_f32 v[58:59], v[58:59], v[140:141], v[202:203] op_sel:[0,0,0] op_sel_hi:[1,0,1]
v_max_f32 v56, 0, v56
v_max_f32 v57, 0, v57
v_max_f32 v58, 0, v58
v_max_f32 v59, 0, v59
v_pk_mul_f32 v[56:57], v[56:57], v[56:57]
v_pk_mul_f32 v[58:59], v[58:59], v[58:59]
v_cvt_pk_bf16_f32 v24, v56, v57
v_cvt_pk_bf16_f32 v25, v58, v59
v_pk_fma_f32 v[72:73], v[196:197], v[136:137], v[72:73] op_sel:[0,0,0] op_sel_hi:[1,0,1]
v_pk_fma_f32 v[74:75], v[198:199], v[136:137], v[74:75] op_sel:[0,0,0] op_sel_hi:[1,0,1]
v_pk_fma_f32 v[72:73], v[72:73], v[140:141], v[204:205] op_sel:[0,0,0] op_sel_hi:[1,0,1]
v_pk_fma_f32 v[74:75], v[74:75], v[140:141], v[206:207] op_sel:[0,0,0] op_sel_hi:[1,0,1]
v_max_f32 v72, 0, v72
v_max_f32 v73, 0, v73
v_max_f32 v74, 0, v74
v_max_f32 v75, 0, v75
v_pk_mul_f32 v[72:73], v[72:73], v[72:73]
v_pk_mul_f32 v[74:75], v[74:75], v[74:75]
v_cvt_pk_bf16_f32 v26, v72, v73
v_cvt_pk_bf16_f32 v27, v74, v75
s_cmp_eq_u32 s72, 0
s_cbranch_scc1 XS128
buffer_store_dwordx4 v[24:27], v1, s[4:7], s24 offen
s_branch XE129
XS128:
buffer_store_dwordx4 v[24:27], v1, s[4:7], s24 offen sc1
XE129:
s_add_u32 s24, s24, 55296
v_pk_fma_f32 v[60:61], v[192:193], v[136:137], v[60:61] op_sel:[0,1,0] op_sel_hi:[1,1,1]
v_pk_fma_f32 v[62:63], v[194:195], v[136:137], v[62:63] op_sel:[0,1,0] op_sel_hi:[1,1,1]
v_pk_fma_f32 v[60:61], v[60:61], v[140:141], v[200:201] op_sel:[0,1,0] op_sel_hi:[1,1,1]
v_pk_fma_f32 v[62:63], v[62:63], v[140:141], v[202:203] op_sel:[0,1,0] op_sel_hi:[1,1,1]
v_max_f32 v60, 0, v60
v_max_f32 v61, 0, v61
v_max_f32 v62, 0, v62
v_max_f32 v63, 0, v63
v_pk_mul_f32 v[60:61], v[60:61], v[60:61]
v_pk_mul_f32 v[62:63], v[62:63], v[62:63]
v_cvt_pk_bf16_f32 v28, v60, v61
v_cvt_pk_bf16_f32 v29, v62, v63
v_pk_fma_f32 v[76:77], v[196:197], v[136:137], v[76:77] op_sel:[0,1,0] op_sel_hi:[1,1,1]
v_pk_fma_f32 v[78:79], v[198:199], v[136:137], v[78:79] op_sel:[0,1,0] op_sel_hi:[1,1,1]
v_pk_fma_f32 v[76:77], v[76:77], v[140:141], v[204:205] op_sel:[0,1,0] op_sel_hi:[1,1,1]
v_pk_fma_f32 v[78:79], v[78:79], v[140:141], v[206:207] op_sel:[0,1,0] op_sel_hi:[1,1,1]
v_max_f32 v76, 0, v76
v_max_f32 v77, 0, v77
v_max_f32 v78, 0, v78
v_max_f32 v79, 0, v79
v_pk_mul_f32 v[76:77], v[76:77], v[76:77]
v_pk_mul_f32 v[78:79], v[78:79], v[78:79]
v_cvt_pk_bf16_f32 v30, v76, v77
v_cvt_pk_bf16_f32 v31, v78, v79
s_cmp_eq_u32 s72, 0
s_cbranch_scc1 XS130
buffer_store_dwordx4 v[28:31], v1, s[4:7], s24 offen
s_branch XE131
XS130:
buffer_store_dwordx4 v[28:31], v1, s[4:7], s24 offen sc1
XE131:
s_add_u32 s24, s24, 55296
v_pk_fma_f32 v[64:65], v[192:193], v[138:139], v[64:65] op_sel:[0,0,0] op_sel_hi:[1,0,1]
v_pk_fma_f32 v[66:67], v[194:195], v[138:139], v[66:67] op_sel:[0,0,0] op_sel_hi:[1,0,1]
v_pk_fma_f32 v[64:65], v[64:65], v[142:143], v[200:201] op_sel:[0,0,0] op_sel_hi:[1,0,1]
v_pk_fma_f32 v[66:67], v[66:67], v[142:143], v[202:203] op_sel:[0,0,0] op_sel_hi:[1,0,1]
v_max_f32 v64, 0, v64
v_max_f32 v65, 0, v65
v_max_f32 v66, 0, v66
v_max_f32 v67, 0, v67
v_pk_mul_f32 v[64:65], v[64:65], v[64:65]
v_pk_mul_f32 v[66:67], v[66:67], v[66:67]
v_cvt_pk_bf16_f32 v32, v64, v65
v_cvt_pk_bf16_f32 v33, v66, v67
v_pk_fma_f32 v[80:81], v[196:197], v[138:139], v[80:81] op_sel:[0,0,0] op_sel_hi:[1,0,1]
v_pk_fma_f32 v[82:83], v[198:199], v[138:139], v[82:83] op_sel:[0,0,0] op_sel_hi:[1,0,1]
v_pk_fma_f32 v[80:81], v[80:81], v[142:143], v[204:205] op_sel:[0,0,0] op_sel_hi:[1,0,1]
v_pk_fma_f32 v[82:83], v[82:83], v[142:143], v[206:207] op_sel:[0,0,0] op_sel_hi:[1,0,1]
v_max_f32 v80, 0, v80
v_max_f32 v81, 0, v81
v_max_f32 v82, 0, v82
v_max_f32 v83, 0, v83
v_pk_mul_f32 v[80:81], v[80:81], v[80:81]
v_pk_mul_f32 v[82:83], v[82:83], v[82:83]
v_cvt_pk_bf16_f32 v34, v80, v81
v_cvt_pk_bf16_f32 v35, v82, v83
s_cmp_eq_u32 s72, 0
s_cbranch_scc1 XS132
buffer_store_dwordx4 v[32:35], v1, s[4:7], s24 offen
s_branch XE133
XS132:
buffer_store_dwordx4 v[32:35], v1, s[4:7], s24 offen sc1
XE133:
s_add_u32 s24, s24, 55296
v_pk_fma_f32 v[68:69], v[192:193], v[138:139], v[68:69] op_sel:[0,1,0] op_sel_hi:[1,1,1]
v_pk_fma_f32 v[70:71], v[194:195], v[138:139], v[70:71] op_sel:[0,1,0] op_sel_hi:[1,1,1]
v_pk_fma_f32 v[68:69], v[68:69], v[142:143], v[200:201] op_sel:[0,1,0] op_sel_hi:[1,1,1]
v_pk_fma_f32 v[70:71], v[70:71], v[142:143], v[202:203] op_sel:[0,1,0] op_sel_hi:[1,1,1]
v_max_f32 v68, 0, v68
v_max_f32 v69, 0, v69
v_max_f32 v70, 0, v70
v_max_f32 v71, 0, v71
v_pk_mul_f32 v[68:69], v[68:69], v[68:69]
v_pk_mul_f32 v[70:71], v[70:71], v[70:71]
v_cvt_pk_bf16_f32 v36, v68, v69
v_cvt_pk_bf16_f32 v37, v70, v71
v_pk_fma_f32 v[84:85], v[196:197], v[138:139], v[84:85] op_sel:[0,1,0] op_sel_hi:[1,1,1]
v_pk_fma_f32 v[86:87], v[198:199], v[138:139], v[86:87] op_sel:[0,1,0] op_sel_hi:[1,1,1]
v_pk_fma_f32 v[84:85], v[84:85], v[142:143], v[204:205] op_sel:[0,1,0] op_sel_hi:[1,1,1]
v_pk_fma_f32 v[86:87], v[86:87], v[142:143], v[206:207] op_sel:[0,1,0] op_sel_hi:[1,1,1]
v_max_f32 v84, 0, v84
v_max_f32 v85, 0, v85
v_max_f32 v86, 0, v86
v_max_f32 v87, 0, v87
v_pk_mul_f32 v[84:85], v[84:85], v[84:85]
v_pk_mul_f32 v[86:87], v[86:87], v[86:87]
v_cvt_pk_bf16_f32 v38, v84, v85
v_cvt_pk_bf16_f32 v39, v86, v87
s_cmp_eq_u32 s72, 0
s_cbranch_scc1 XS134
buffer_store_dwordx4 v[36:39], v1, s[4:7], s24 offen
s_branch XE135
XS134:
buffer_store_dwordx4 v[36:39], v1, s[4:7], s24 offen sc1
XE135:
s_waitcnt vmcnt(0)
v_mov_b32 v3, 9
s_mov_b64 exec, 1
s_cmp_eq_u32 s72, 0
s_cbranch_scc1 XS136
buffer_store_dword v3, off, s[4:7], s23
s_branch XE137
XS136:
buffer_store_dword v3, off, s[4:7], s23 sc1
XE137:
s_mov_b64 exec, -1
s_nop 7
s_branch FE116
FK118:
v_and_b32 v187, 0xffff0000, v185
v_lshlrev_b32 v186, 16, v185
v_and_b32 v185, 0xffff0000, v184
v_lshlrev_b32 v184, 16, v184
v_and_b32 v191, 0xffff0000, v189
v_lshlrev_b32 v190, 16, v189
v_and_b32 v189, 0xffff0000, v188
v_lshlrev_b32 v188, 16, v188
s_waitcnt vmcnt(5)
s_waitcnt lgkmcnt(0)
s_barrier
ds_read_b128 v[24:27], v1 offset:0
ds_read_b128 v[28:31], v1 offset:20480
ds_read_b128 v[32:35], v1 offset:40960
ds_read_b128 v[36:39], v238 offset:0
s_waitcnt lgkmcnt(3)
v_mfma_f32_16x16x32_bf16 v[56:59], a[120:123], v[24:27], 0
ds_read_b128 v[40:43], v1 offset:1024
s_waitcnt lgkmcnt(3)
v_mfma_f32_16x16x32_bf16 v[60:63], a[120:123], v[28:31], 0
ds_read_b128 v[44:47], v1 offset:21504
s_waitcnt lgkmcnt(3)
v_mfma_f32_16x16x32_bf16 v[64:67], a[120:123], v[32:35], 0
ds_read_b128 v[48:51], v1 offset:41984
s_waitcnt lgkmcnt(3)
v_mfma_f32_16x16x32_bf16 v[68:71], a[120:123], v[36:39], 0
ds_read_b128 v[52:55], v238 offset:1024
v_mfma_f32_16x16x32_bf16 v[72:75], a[124:127], v[24:27], 0
s_mov_b32 m0, s70
s_nop 0
buffer_load_dwordx4 v1, s[4:7], s69 offen offset:2048 sc1 lds
v_mfma_f32_16x16x32_bf16 v[76:79], a[124:127], v[28:31], 0
v_mfma_f32_16x16x32_bf16 v[80:83], a[124:127], v[32:35], 0
v_mfma_f32_16x16x32_bf16 v[84:87], a[124:127], v[36:39], 0
s_waitcnt lgkmcnt(3)
v_mfma_f32_16x16x32_bf16 v[56:59], a[128:131], v[40:43], v[56:59]
ds_read_b128 v[24:27], v1 offset:2048
s_waitcnt lgkmcnt(3)
v_mfma_f32_16x16x32_bf16 v[60:63], a[128:131], v[44:47], v[60:63]
ds_read_b128 v[28:31], v1 offset:22528
s_waitcnt lgkmcnt(3)
v_mfma_f32_16x16x32_bf16 v[64:67], a[128:131], v[48:51], v[64:67]
ds_read_b128 v[32:35], v1 offset:43008
s_waitcnt lgkmcnt(3)
v_mfma_f32_16x16x32_bf16 v[68:71], a[128:131], v[52:55], v[68:71]
ds_read_b128 v[36:39], v238 offset:2048
v_mfma_f32_16x16x32_bf16 v[72:75], a[132:135], v[40:43], v[72:75]
s_mov_b32 m0, s70
s_nop 0
buffer_load_dwordx4 v1, s[4:7], s69 offen offset:3072 sc1 lds
v_mfma_f32_16x16x32_bf16 v[76:79], a[132:135], v[44:47], v[76:79]
v_mfma_f32_16x16x32_bf16 v[80:83], a[132:135], v[48:51], v[80:83]
v_mfma_f32_16x16x32_bf16 v[84:87], a[132:135], v[52:55], v[84:87]
s_waitcnt lgkmcnt(3)
v_mfma_f32_16x16x32_bf16 v[56:59], a[136:139], v[24:27], v[56:59]
ds_read_b128 v[40:43], v1 offset:3072
s_waitcnt lgkmcnt(3)
v_mfma_f32_16x16x32_bf16 v[60:63], a[136:139], v[28:31], v[60:63]
ds_read_b128 v[44:47], v1 offset:23552
s_waitcnt lgkmcnt(3)
v_mfma_f32_16x16x32_bf16 v[64:67], a[136:139], v[32:35], v[64:67]
ds_read_b128 v[48:51], v1 offset:44032
s_waitcnt lgkmcnt(3)
v_mfma_f32_16x16x32_bf16 v[68:71], a[136:139], v[36:39], v[68:71]
ds_read_b128 v[52:55], v238 offset:3072
v_mfma_f32_16x16x32_bf16 v[72:75], a[140:143], v[24:27], v[72:75]
s_add_u32 s69, s69, 4096
s_add_u32 s70, s70, 4096
s_mov_b32 m0, s70
s_nop 0
buffer_load_dwordx4 v1, s[4:7], s69 offen offset:0 sc1 lds
v_mfma_f32_16x16x32_bf16 v[76:79], a[140:143], v[28:31], v[76:79]
v_mfma_f32_16x16x32_bf16 v[80:83], a[140:143], v[32:35], v[80:83]
v_mfma_f32_16x16x32_bf16 v[84:87], a[140:143], v[36:39], v[84:87]
s_waitcnt lgkmcnt(3)
v_mfma_f32_16x16x32_bf16 v[56:59], a[144:147], v[40:43], v[56:59]
ds_read_b128 v[24:27], v1 offset:4096
s_waitcnt lgkmcnt(3)
v_mfma_f32_16x16x32_bf16 v[60:63], a[144:147], v[44:47], v[60:63]
ds_read_b128 v[28:31], v1 offset:24576
s_waitcnt lgkmcnt(3)
v_mfma_f32_16x16x32_bf16 v[64:67], a[144:147], v[48:51], v[64:67]
ds_read_b128 v[32:35], v1 offset:45056
s_waitcnt lgkmcnt(3)
v_mfma_f32_16x16x32_bf16 v[68:71], a[144:147], v[52:55], v[68:71]
ds_read_b128 v[36:39], v238 offset:4096
v_mfma_f32_16x16x32_bf16 v[72:75], a[148:151], v[40:43], v[72:75]
s_mov_b32 m0, s70
s_nop 0
buffer_load_dwordx4 v1, s[4:7], s69 offen offset:1024 sc1 lds
v_mfma_f32_16x16x32_bf16 v[76:79], a[148:151], v[44:47], v[76:79]
v_mfma_f32_16x16x32_bf16 v[80:83], a[148:151], v[48:51], v[80:83]
v_mfma_f32_16x16x32_bf16 v[84:87], a[148:151], v[52:55], v[84:87]
s_waitcnt vmcnt(4)
s_barrier
s_waitcnt lgkmcnt(3)
v_mfma_f32_16x16x32_bf16 v[56:59], a[152:155], v[24:27], v[56:59]
ds_read_b128 v[40:43], v1 offset:5120
s_waitcnt lgkmcnt(3)
v_mfma_f32_16x16x32_bf16 v[60:63], a[152:155], v[28:31], v[60:63]
ds_read_b128 v[44:47], v1 offset:25600
s_waitcnt lgkmcnt(3)
v_mfma_f32_16x16x32_bf16 v[64:67], a[152:155], v[32:35], v[64:67]
ds_read_b128 v[48:51], v1 offset:46080
s_waitcnt lgkmcnt(3)
v_mfma_f32_16x16x32_bf16 v[68:71], a[152:155], v[36:39], v[68:71]
ds_read_b128 v[52:55], v238 offset:5120
v_mfma_f32_16x16x32_bf16 v[72:75], a[156:159], v[24:27], v[72:75]
s_mov_b32 m0, s70
s_nop 0
buffer_load_dwordx4 v1, s[4:7], s69 offen offset:2048 sc1 lds
v_mfma_f32_16x16x32_bf16 v[76:79], a[156:159], v[28:31], v[76:79]
v_mfma_f32_16x16x32_bf16 v[80:83], a[156:159], v[32:35], v[80:83]
v_mfma_f32_16x16x32_bf16 v[84:87], a[156:159], v[36:39], v[84:87]
s_waitcnt lgkmcnt(3)
v_mfma_f32_16x16x32_bf16 v[56:59], a[160:163], v[40:43], v[56:59]
ds_read_b128 v[24:27], v1 offset:6144
s_waitcnt lgkmcnt(3)
v_mfma_f32_16x16x32_bf16 v[60:63], a[160:163], v[44:47], v[60:63]
ds_read_b128 v[28:31], v1 offset:26624
s_waitcnt lgkmcnt(3)
v_mfma_f32_16x16x32_bf16 v[64:67], a[160:163], v[48:51], v[64:67]
ds_read_b128 v[32:35], v1 offset:47104
s_waitcnt lgkmcnt(3)
v_mfma_f32_16x16x32_bf16 v[68:71], a[160:163], v[52:55], v[68:71]
ds_read_b128 v[36:39], v238 offset:6144
v_mfma_f32_16x16x32_bf16 v[72:75], a[164:167], v[40:43], v[72:75]
s_mov_b32 m0, s70
s_nop 0
buffer_load_dwordx4 v1, s[4:7], s69 offen offset:3072 sc1 lds
v_mfma_f32_16x16x32_bf16 v[76:79], a[164:167], v[44:47], v[76:79]
v_mfma_f32_16x16x32_bf16 v[80:83], a[164:167], v[48:51], v[80:83]
v_mfma_f32_16x16x32_bf16 v[84:87], a[164:167], v[52:55], v[84:87]
s_waitcnt lgkmcnt(3)
v_mfma_f32_16x16x32_bf16 v[56:59], a[168:171], v[24:27], v[56:59]
ds_read_b128 v[40:43], v1 offset:7168
s_waitcnt lgkmcnt(3)
v_mfma_f32_16x16x32_bf16 v[60:63], a[168:171], v[28:31], v[60:63]
ds_read_b128 v[44:47], v1 offset:27648
s_waitcnt lgkmcnt(3)
v_mfma_f32_16x16x32_bf16 v[64:67], a[168:171], v[32:35], v[64:67]
ds_read_b128 v[48:51], v1 offset:48128
s_waitcnt lgkmcnt(3)
v_mfma_f32_16x16x32_bf16 v[68:71], a[168:171], v[36:39], v[68:71]
ds_read_b128 v[52:55], v238 offset:7168
v_mfma_f32_16x16x32_bf16 v[72:75], a[172:175], v[24:27], v[72:75]
s_add_u32 s69, s69, 4096
s_add_u32 s70, s70, 4096
s_mov_b32 m0, s70
s_nop 0
buffer_load_dwordx4 v1, s[4:7], s69 offen offset:0 sc1 lds
v_mfma_f32_16x16x32_bf16 v[76:79], a[172:175], v[28:31], v[76:79]
v_mfma_f32_16x16x32_bf16 v[80:83], a[172:175], v[32:35], v[80:83]
v_mfma_f32_16x16x32_bf16 v[84:87], a[172:175], v[36:39], v[84:87]
s_waitcnt lgkmcnt(3)
v_mfma_f32_16x16x32_bf16 v[56:59], a[176:179], v[40:43], v[56:59]
ds_read_b128 v[24:27], v1 offset:8192
s_waitcnt lgkmcnt(3)
v_mfma_f32_16x16x32_bf16 v[60:63], a[176:179], v[44:47], v[60:63]
ds_read_b128 v[28:31], v1 offset:28672
s_waitcnt lgkmcnt(3)
v_mfma_f32_16x16x32_bf16 v[64:67], a[176:179], v[48:51], v[64:67]
ds_read_b128 v[32:35], v1 offset:49152
s_waitcnt lgkmcnt(3)
v_mfma_f32_16x16x32_bf16 v[68:71], a[176:179], v[52:55], v[68:71]
ds_read_b128 v[36:39], v238 offset:8192
v_mfma_f32_16x16x32_bf16 v[72:75], a[180:183], v[40:43], v[72:75]
s_mov_b32 m0, s70
s_nop 0
buffer_load_dwordx4 v1, s[4:7], s69 offen offset:1024 sc1 lds
v_mfma_f32_16x16x32_bf16 v[76:79], a[180:183], v[44:47], v[76:79]
v_mfma_f32_16x16x32_bf16 v[80:83], a[180:183], v[48:51], v[80:83]
v_mfma_f32_16x16x32_bf16 v[84:87], a[180:183], v[52:55], v[84:87]
s_waitcnt lgkmcnt(3)
v_mfma_f32_16x16x32_bf16 v[56:59], a[184:187], v[24:27], v[56:59]
ds_read_b128 v[40:43], v1 offset:9216
s_waitcnt lgkmcnt(3)
v_mfma_f32_16x16x32_bf16 v[60:63], a[184:187], v[28:31], v[60:63]
ds_read_b128 v[44:47], v1 offset:29696
s_waitcnt lgkmcnt(3)
v_mfma_f32_16x16x32_bf16 v[64:67], a[184:187], v[32:35], v[64:67]
ds_read_b128 v[48:51], v1 offset:50176
s_waitcnt lgkmcnt(3)
v_mfma_f32_16x16x32_bf16 v[68:71], a[184:187], v[36:39], v[68:71]
ds_read_b128 v[52:55], v238 offset:9216
v_mfma_f32_16x16x32_bf16 v[72:75], a[188:191], v[24:27], v[72:75]
s_mov_b32 m0, s70
s_nop 0
buffer_load_dwordx4 v1, s[4:7], s69 offen offset:2048 sc1 lds
v_mfma_f32_16x16x32_bf16 v[76:79], a[188:191], v[28:31], v[76:79]
buffer_load_dwordx4 a[184:187], v1, s[4:7], s66 offen
v_mfma_f32_16x16x32_bf16 v[80:83], a[188:191], v[32:35], v[80:83]
v_mfma_f32_16x16x32_bf16 v[84:87], a[188:191], v[36:39], v[84:87]
buffer_load_dwordx4 a[188:191], v1, s[4:7], s66 offen offset:1024
s_waitcnt vmcnt(6)
s_barrier
s_waitcnt lgkmcnt(3)
v_mfma_f32_16x16x32_bf16 v[56:59], a[192:195], v[40:43], v[56:59]
ds_read_b128 v[24:27], v1 offset:10240
s_waitcnt lgkmcnt(3)
v_mfma_f32_16x16x32_bf16 v[60:63], a[192:195], v[44:47], v[60:63]
ds_read_b128 v[28:31], v1 offset:30720
s_waitcnt lgkmcnt(3)
v_mfma_f32_16x16x32_bf16 v[64:67], a[192:195], v[48:51], v[64:67]
ds_read_b128 v[32:35], v1 offset:51200
s_waitcnt lgkmcnt(3)
v_mfma_f32_16x16x32_bf16 v[68:71], a[192:195], v[52:55], v[68:71]
ds_read_b128 v[36:39], v238 offset:10240
v_mfma_f32_16x16x32_bf16 v[72:75], a[196:199], v[40:43], v[72:75]
s_mov_b32 m0, s70
s_nop 0
buffer_load_dwordx4 v1, s[4:7], s69 offen offset:3072 sc1 lds
v_mfma_f32_16x16x32_bf16 v[76:79], a[196:199], v[44:47], v[76:79]
buffer_load_dwordx4 a[192:195], v1, s[4:7], s66 offen offset:2048
v_mfma_f32_16x16x32_bf16 v[80:83], a[196:199], v[48:51], v[80:83]
v_mfma_f32_16x16x32_bf16 v[84:87], a[196:199], v[52:55], v[84:87]
buffer_load_dwordx4 a[196:199], v1, s[4:7], s66 offen offset:3072
s_waitcnt lgkmcnt(3)
v_mfma_f32_16x16x32_bf16 v[56:59], a[200:203], v[24:27], v[56:59]
ds_read_b128 v[40:43], v1 offset:11264
s_waitcnt lgkmcnt(3)
v_mfma_f32_16x16x32_bf16 v[60:63], a[200:203], v[28:31], v[60:63]
ds_read_b128 v[44:47], v1 offset:31744
s_waitcnt lgkmcnt(3)
v_mfma_f32_16x16x32_bf16 v[64:67], a[200:203], v[32:35], v[64:67]
ds_read_b128 v[48:51], v1 offset:52224
s_waitcnt lgkmcnt(3)
v_mfma_f32_16x16x32_bf16 v[68:71], a[200:203], v[36:39], v[68:71]
ds_read_b128 v[52:55], v238 offset:11264
v_mfma_f32_16x16x32_bf16 v[72:75], a[204:207], v[24:27], v[72:75]
v_mfma_f32_16x16x32_bf16 v[76:79], a[204:207], v[28:31], v[76:79]
s_add_u32 s66, s66, 4096
buffer_load_dwordx4 a[200:203], v1, s[4:7], s66 offen
v_mfma_f32_16x16x32_bf16 v[80:83], a[204:207], v[32:35], v[80:83]
v_mfma_f32_16x16x32_bf16 v[84:87], a[204:207], v[36:39], v[84:87]
buffer_load_dwordx4 a[204:207], v1, s[4:7], s66 offen offset:1024
s_waitcnt lgkmcnt(3)
v_mfma_f32_16x16x32_bf16 v[56:59], a[208:211], v[40:43], v[56:59]
ds_read_b128 v[24:27], v1 offset:12288
s_waitcnt lgkmcnt(3)
v_mfma_f32_16x16x32_bf16 v[60:63], a[208:211], v[44:47], v[60:63]
ds_read_b128 v[28:31], v1 offset:32768
s_waitcnt lgkmcnt(3)
v_mfma_f32_16x16x32_bf16 v[64:67], a[208:211], v[48:51], v[64:67]
ds_read_b128 v[32:35], v1 offset:53248
s_waitcnt lgkmcnt(3)
v_mfma_f32_16x16x32_bf16 v[68:71], a[208:211], v[52:55], v[68:71]
ds_read_b128 v[36:39], v238 offset:12288
v_mfma_f32_16x16x32_bf16 v[72:75], a[212:215], v[40:43], v[72:75]
v_mfma_f32_16x16x32_bf16 v[76:79], a[212:215], v[44:47], v[76:79]
buffer_load_dwordx4 a[208:211], v1, s[4:7], s66 offen offset:2048
v_mfma_f32_16x16x32_bf16 v[80:83], a[212:215], v[48:51], v[80:83]
v_mfma_f32_16x16x32_bf16 v[84:87], a[212:215], v[52:55], v[84:87]
buffer_load_dwordx4 a[212:215], v1, s[4:7], s66 offen offset:3072
s_waitcnt lgkmcnt(3)
v_mfma_f32_16x16x32_bf16 v[56:59], a[216:219], v[24:27], v[56:59]
ds_read_b128 v[40:43], v1 offset:13312
s_waitcnt lgkmcnt(3)
v_mfma_f32_16x16x32_bf16 v[60:63], a[216:219], v[28:31], v[60:63]
ds_read_b128 v[44:47], v1 offset:33792
s_waitcnt lgkmcnt(3)
v_mfma_f32_16x16x32_bf16 v[64:67], a[216:219], v[32:35], v[64:67]
ds_read_b128 v[48:51], v1 offset:54272
s_waitcnt lgkmcnt(3)
v_mfma_f32_16x16x32_bf16 v[68:71], a[216:219], v[36:39], v[68:71]
ds_read_b128 v[52:55], v238 offset:13312
v_mfma_f32_16x16x32_bf16 v[72:75], a[220:223], v[24:27], v[72:75]
v_mfma_f32_16x16x32_bf16 v[76:79], a[220:223], v[28:31], v[76:79]
s_add_u32 s66, s66, 4096
buffer_load_dwordx4 a[216:219], v1, s[4:7], s66 offen
v_mfma_f32_16x16x32_bf16 v[80:83], a[220:223], v[32:35], v[80:83]
v_mfma_f32_16x16x32_bf16 v[84:87], a[220:223], v[36:39], v[84:87]
buffer_load_dwordx4 a[220:223], v1, s[4:7], s66 offen offset:1024
s_waitcnt lgkmcnt(3)
v_mfma_f32_16x16x32_bf16 v[56:59], a[224:227], v[40:43], v[56:59]
ds_read_b128 v[24:27], v1 offset:14336
s_waitcnt lgkmcnt(3)
v_mfma_f32_16x16x32_bf16 v[60:63], a[224:227], v[44:47], v[60:63]
ds_read_b128 v[28:31], v1 offset:34816
s_waitcnt lgkmcnt(3)
v_mfma_f32_16x16x32_bf16 v[64:67], a[224:227], v[48:51], v[64:67]
ds_read_b128 v[32:35], v1 offset:55296
s_waitcnt lgkmcnt(3)
v_mfma_f32_16x16x32_bf16 v[68:71], a[224:227], v[52:55], v[68:71]
ds_read_b128 v[36:39], v238 offset:14336
v_mfma_f32_16x16x32_bf16 v[72:75], a[228:231], v[40:43], v[72:75]
v_mfma_f32_16x16x32_bf16 v[76:79], a[228:231], v[44:47], v[76:79]
buffer_load_dwordx4 a[224:227], v1, s[4:7], s66 offen offset:2048
v_mfma_f32_16x16x32_bf16 v[80:83], a[228:231], v[48:51], v[80:83]
v_mfma_f32_16x16x32_bf16 v[84:87], a[228:231], v[52:55], v[84:87]
buffer_load_dwordx4 a[228:231], v1, s[4:7], s66 offen offset:3072
s_waitcnt vmcnt(10)
s_barrier
s_waitcnt lgkmcnt(3)
v_mfma_f32_16x16x32_bf16 v[56:59], a[232:235], v[24:27], v[56:59]
ds_read_b128 v[40:43], v1 offset:15360
s_waitcnt lgkmcnt(3)
v_mfma_f32_16x16x32_bf16 v[60:63], a[232:235], v[28:31], v[60:63]
ds_read_b128 v[44:47], v1 offset:35840
s_waitcnt lgkmcnt(3)
v_mfma_f32_16x16x32_bf16 v[64:67], a[232:235], v[32:35], v[64:67]
ds_read_b128 v[48:51], v1 offset:56320
s_waitcnt lgkmcnt(3)
v_mfma_f32_16x16x32_bf16 v[68:71], a[232:235], v[36:39], v[68:71]
ds_read_b128 v[52:55], v238 offset:15360
v_mfma_f32_16x16x32_bf16 v[72:75], a[236:239], v[24:27], v[72:75]
v_mfma_f32_16x16x32_bf16 v[76:79], a[236:239], v[28:31], v[76:79]
s_add_u32 s66, s66, 4096
buffer_load_dwordx4 a[232:235], v1, s[4:7], s66 offen
v_mfma_f32_16x16x32_bf16 v[80:83], a[236:239], v[32:35], v[80:83]
v_mfma_f32_16x16x32_bf16 v[84:87], a[236:239], v[36:39], v[84:87]
buffer_load_dwordx4 a[236:239], v1, s[4:7], s66 offen offset:1024
s_waitcnt lgkmcnt(3)
v_mfma_f32_16x16x32_bf16 v[56:59], a[240:243], v[40:43], v[56:59]
ds_read_b64 v[24:25], v2 offset:16384
ds_read_b64 v[26:27], v2 offset:16896
s_waitcnt lgkmcnt(4)
v_mfma_f32_16x16x32_bf16 v[60:63], a[240:243], v[44:47], v[60:63]
ds_read_b64 v[28:29], v2 offset:36864
ds_read_b64 v[30:31], v2 offset:37376
s_waitcnt lgkmcnt(5)
v_mfma_f32_16x16x32_bf16 v[64:67], a[240:243], v[48:51], v[64:67]
ds_read_b64 v[32:33], v2 offset:57344
ds_read_b64 v[34:35], v2 offset:57856
s_waitcnt lgkmcnt(6)
v_mfma_f32_16x16x32_bf16 v[68:71], a[240:243], v[52:55], v[68:71]
ds_read_b64 v[36:37], v239 offset:16384
ds_read_b64 v[38:39], v239 offset:16896
v_mfma_f32_16x16x32_bf16 v[72:75], a[244:247], v[40:43], v[72:75]
v_mfma_f32_16x16x32_bf16 v[76:79], a[244:247], v[44:47], v[76:79]
buffer_load_dwordx4 a[240:243], v1, s[4:7], s66 offen offset:2048
v_mfma_f32_16x16x32_bf16 v[80:83], a[244:247], v[48:51], v[80:83]
v_mfma_f32_16x16x32_bf16 v[84:87], a[244:247], v[52:55], v[84:87]
buffer_load_dwordx4 a[244:247], v1, s[4:7], s66 offen offset:3072
s_waitcnt lgkmcnt(6)
v_mfma_f32_16x16x32_bf16 v[56:59], a[248:251], v[24:27], v[56:59]
ds_read_b64 v[40:41], v2 offset:17408
ds_read_b64 v[42:43], v2 offset:17920
s_waitcnt lgkmcnt(6)
v_mfma_f32_16x16x32_bf16 v[60:63], a[248:251], v[28:31], v[60:63]
ds_read_b64 v[44:45], v2 offset:37888
ds_read_b64 v[46:47], v2 offset:38400
s_waitcnt lgkmcnt(6)
v_mfma_f32_16x16x32_bf16 v[64:67], a[248:251], v[32:35], v[64:67]
ds_read_b64 v[48:49], v2 offset:58368
ds_read_b64 v[50:51], v2 offset:58880
s_waitcnt lgkmcnt(6)
v_mfma_f32_16x16x32_bf16 v[68:71], a[248:251], v[36:39], v[68:71]
ds_read_b64 v[52:53], v239 offset:17408
ds_read_b64 v[54:55], v239 offset:17920
v_mfma_f32_16x16x32_bf16 v[72:75], a[252:255], v[24:27], v[72:75]
v_mfma_f32_16x16x32_bf16 v[76:79], a[252:255], v[28:31], v[76:79]
s_add_u32 s66, s66, 4096
buffer_load_dwordx4 a[248:251], v1, s[4:7], s66 offen
v_mfma_f32_16x16x32_bf16 v[80:83], a[252:255], v[32:35], v[80:83]
v_mfma_f32_16x16x32_bf16 v[84:87], a[252:255], v[36:39], v[84:87]
buffer_load_dwordx4 a[252:255], v1, s[4:7], s66 offen offset:1024
s_waitcnt lgkmcnt(6)
v_mfma_f32_16x16x32_bf16 v[56:59], a[0:3], v[40:43], v[56:59]
ds_read_b64 v[24:25], v2 offset:18432
ds_read_b64 v[26:27], v2 offset:18944
s_waitcnt lgkmcnt(6)
v_mfma_f32_16x16x32_bf16 v[60:63], a[0:3], v[44:47], v[60:63]
ds_read_b64 v[28:29], v2 offset:38912
ds_read_b64 v[30:31], v2 offset:39424
s_waitcnt lgkmcnt(6)
v_mfma_f32_16x16x32_bf16 v[64:67], a[0:3], v[48:51], v[64:67]
ds_read_b64 v[32:33], v2 offset:59392
ds_read_b64 v[34:35], v2 offset:59904
s_waitcnt lgkmcnt(6)
v_mfma_f32_16x16x32_bf16 v[68:71], a[0:3], v[52:55], v[68:71]
ds_read_b64 v[36:37], v239 offset:18432
ds_read_b64 v[38:39], v239 offset:18944
v_mfma_f32_16x16x32_bf16 v[72:75], a[4:7], v[40:43], v[72:75]
v_mfma_f32_16x16x32_bf16 v[76:79], a[4:7], v[44:47], v[76:79]
buffer_load_dwordx4 a[0:3], v1, s[4:7], s66 offen offset:2048
v_mfma_f32_16x16x32_bf16 v[80:83], a[4:7], v[48:51], v[80:83]
v_mfma_f32_16x16x32_bf16 v[84:87], a[4:7], v[52:55], v[84:87]
buffer_load_dwordx4 a[4:7], v1, s[4:7], s66 offen offset:3072
s_waitcnt lgkmcnt(6)
v_mfma_f32_16x16x32_bf16 v[56:59], a[8:11], v[24:27], v[56:59]
ds_read_b64 v[40:41], v2 offset:19456
ds_read_b64 v[42:43], v2 offset:19968
s_waitcnt lgkmcnt(6)
v_mfma_f32_16x16x32_bf16 v[60:63], a[8:11], v[28:31], v[60:63]
ds_read_b64 v[44:45], v2 offset:39936
ds_read_b64 v[46:47], v2 offset:40448
s_waitcnt lgkmcnt(6)
v_mfma_f32_16x16x32_bf16 v[64:67], a[8:11], v[32:35], v[64:67]
ds_read_b64 v[48:49], v2 offset:60416
ds_read_b64 v[50:51], v2 offset:60928
s_waitcnt lgkmcnt(6)
v_mfma_f32_16x16x32_bf16 v[68:71], a[8:11], v[36:39], v[68:71]
ds_read_b64 v[52:53], v239 offset:19456
ds_read_b64 v[54:55], v239 offset:19968
v_mfma_f32_16x16x32_bf16 v[72:75], a[12:15], v[24:27], v[72:75]
v_mfma_f32_16x16x32_bf16 v[76:79], a[12:15], v[28:31], v[76:79]
s_add_u32 s66, s66, 4096
buffer_load_dwordx4 a[8:11], v1, s[4:7], s66 offen
v_mfma_f32_16x16x32_bf16 v[80:83], a[12:15], v[32:35], v[80:83]
v_mfma_f32_16x16x32_bf16 v[84:87], a[12:15], v[36:39], v[84:87]
buffer_load_dwordx4 a[12:15], v1, s[4:7], s66 offen offset:1024
s_waitcnt lgkmcnt(6)
v_mfma_f32_16x16x32_bf16 v[56:59], a[16:19], v[40:43], v[56:59]
s_waitcnt lgkmcnt(4)
v_mfma_f32_16x16x32_bf16 v[60:63], a[16:19], v[44:47], v[60:63]
s_waitcnt lgkmcnt(2)
v_mfma_f32_16x16x32_bf16 v[64:67], a[16:19], v[48:51], v[64:67]
s_waitcnt lgkmcnt(0)
v_mfma_f32_16x16x32_bf16 v[68:71], a[16:19], v[52:55], v[68:71]
buffer_load_dwordx4 a[16:19], v1, s[4:7], s66 offen offset:2048
v_mfma_f32_16x16x32_bf16 v[72:75], a[20:23], v[40:43], v[72:75]
v_mfma_f32_16x16x32_bf16 v[76:79], a[20:23], v[44:47], v[76:79]
v_mfma_f32_16x16x32_bf16 v[80:83], a[20:23], v[48:51], v[80:83]
v_mfma_f32_16x16x32_bf16 v[84:87], a[20:23], v[52:55], v[84:87]
v_lshlrev_b32 v3, 2, v241
v_add_u32 v3, 102400, v3
ds_read_b32 v136, v3 offset:0
ds_read_b32 v140, v3 offset:256
ds_read_b32 v137, v3 offset:64
ds_read_b32 v141, v3 offset:320
ds_read_b32 v138, v3 offset:128
ds_read_b32 v142, v3 offset:384
ds_read_b32 v139, v3 offset:192
ds_read_b32 v143, v3 offset:448
s_waitcnt lgkmcnt(0)
s_add_u32 s24, s63, 0
s_lshl_b32 s24, s24, 10
s_mul_i32 s25, s61, 55296
s_add_u32 s24, s24, s25
s_add_u32 s24, s24, 27123712
v_pk_fma_f32 v[56:57], v[176:177], v[136:137], v[56:57] op_sel:[0,0,0] op_sel_hi:[1,0,1]
v_pk_fma_f32 v[58:59], v[178:179], v[136:137], v[58:59] op_sel:[0,0,0] op_sel_hi:[1,0,1]
v_pk_fma_f32 v[56:57], v[56:57], v[140:141], v[184:185] op_sel:[0,0,0] op_sel_hi:[1,0,1]
v_pk_fma_f32 v[58:59], v[58:59], v[140:141], v[186:187] op_sel:[0,0,0] op_sel_hi:[1,0,1]
v_max_f32 v56, 0, v56
v_max_f32 v57, 0, v57
v_max_f32 v58, 0, v58
v_max_f32 v59, 0, v59
v_pk_mul_f32 v[56:57], v[56:57], v[56:57]
v_pk_mul_f32 v[58:59], v[58:59], v[58:59]
v_cvt_pk_bf16_f32 v24, v56, v57
v_cvt_pk_bf16_f32 v25, v58, v59
v_pk_fma_f32 v[72:73], v[180:181], v[136:137], v[72:73] op_sel:[0,0,0] op_sel_hi:[1,0,1]
v_pk_fma_f32 v[74:75], v[182:183], v[136:137], v[74:75] op_sel:[0,0,0] op_sel_hi:[1,0,1]
v_pk_fma_f32 v[72:73], v[72:73], v[140:141], v[188:189] op_sel:[0,0,0] op_sel_hi:[1,0,1]
v_pk_fma_f32 v[74:75], v[74:75], v[140:141], v[190:191] op_sel:[0,0,0] op_sel_hi:[1,0,1]
v_max_f32 v72, 0, v72
v_max_f32 v73, 0, v73
v_max_f32 v74, 0, v74
v_max_f32 v75, 0, v75
v_pk_mul_f32 v[72:73], v[72:73], v[72:73]
v_pk_mul_f32 v[74:75], v[74:75], v[74:75]
v_cvt_pk_bf16_f32 v26, v72, v73
v_cvt_pk_bf16_f32 v27, v74, v75
s_cmp_eq_u32 s72, 0
s_cbranch_scc1 XS138
buffer_store_dwordx4 v[24:27], v1, s[4:7], s24 offen
s_branch XE139
XS138:
buffer_store_dwordx4 v[24:27], v1, s[4:7], s24 offen sc1
XE139:
s_add_u32 s24, s24, 55296
v_pk_fma_f32 v[60:61], v[176:177], v[136:137], v[60:61] op_sel:[0,1,0] op_sel_hi:[1,1,1]
v_pk_fma_f32 v[62:63], v[178:179], v[136:137], v[62:63] op_sel:[0,1,0] op_sel_hi:[1,1,1]
v_pk_fma_f32 v[60:61], v[60:61], v[140:141], v[184:185] op_sel:[0,1,0] op_sel_hi:[1,1,1]
v_pk_fma_f32 v[62:63], v[62:63], v[140:141], v[186:187] op_sel:[0,1,0] op_sel_hi:[1,1,1]
v_max_f32 v60, 0, v60
v_max_f32 v61, 0, v61
v_max_f32 v62, 0, v62
v_max_f32 v63, 0, v63
v_pk_mul_f32 v[60:61], v[60:61], v[60:61]
v_pk_mul_f32 v[62:63], v[62:63], v[62:63]
v_cvt_pk_bf16_f32 v28, v60, v61
v_cvt_pk_bf16_f32 v29, v62, v63
v_pk_fma_f32 v[76:77], v[180:181], v[136:137], v[76:77] op_sel:[0,1,0] op_sel_hi:[1,1,1]
v_pk_fma_f32 v[78:79], v[182:183], v[136:137], v[78:79] op_sel:[0,1,0] op_sel_hi:[1,1,1]
v_pk_fma_f32 v[76:77], v[76:77], v[140:141], v[188:189] op_sel:[0,1,0] op_sel_hi:[1,1,1]
v_pk_fma_f32 v[78:79], v[78:79], v[140:141], v[190:191] op_sel:[0,1,0] op_sel_hi:[1,1,1]
v_max_f32 v76, 0, v76
v_max_f32 v77, 0, v77
v_max_f32 v78, 0, v78
v_max_f32 v79, 0, v79
v_pk_mul_f32 v[76:77], v[76:77], v[76:77]
v_pk_mul_f32 v[78:79], v[78:79], v[78:79]
v_cvt_pk_bf16_f32 v30, v76, v77
v_cvt_pk_bf16_f32 v31, v78, v79
s_cmp_eq_u32 s72, 0
s_cbranch_scc1 XS140
buffer_store_dwordx4 v[28:31], v1, s[4:7], s24 offen
s_branch XE141
XS140:
buffer_store_dwordx4 v[28:31], v1, s[4:7], s24 offen sc1
XE141:
s_add_u32 s24, s24, 55296
v_pk_fma_f32 v[64:65], v[176:177], v[138:139], v[64:65] op_sel:[0,0,0] op_sel_hi:[1,0,1]
v_pk_fma_f32 v[66:67], v[178:179], v[138:139], v[66:67] op_sel:[0,0,0] op_sel_hi:[1,0,1]
v_pk_fma_f32 v[64:65], v[64:65], v[142:143], v[184:185] op_sel:[0,0,0] op_sel_hi:[1,0,1]
v_pk_fma_f32 v[66:67], v[66:67], v[142:143], v[186:187] op_sel:[0,0,0] op_sel_hi:[1,0,1]
v_max_f32 v64, 0, v64
v_max_f32 v65, 0, v65
v_max_f32 v66, 0, v66
v_max_f32 v67, 0, v67
v_pk_mul_f32 v[64:65], v[64:65], v[64:65]
v_pk_mul_f32 v[66:67], v[66:67], v[66:67]
v_cvt_pk_bf16_f32 v32, v64, v65
v_cvt_pk_bf16_f32 v33, v66, v67
v_pk_fma_f32 v[80:81], v[180:181], v[138:139], v[80:81] op_sel:[0,0,0] op_sel_hi:[1,0,1]
v_pk_fma_f32 v[82:83], v[182:183], v[138:139], v[82:83] op_sel:[0,0,0] op_sel_hi:[1,0,1]
v_pk_fma_f32 v[80:81], v[80:81], v[142:143], v[188:189] op_sel:[0,0,0] op_sel_hi:[1,0,1]
v_pk_fma_f32 v[82:83], v[82:83], v[142:143], v[190:191] op_sel:[0,0,0] op_sel_hi:[1,0,1]
v_max_f32 v80, 0, v80
v_max_f32 v81, 0, v81
v_max_f32 v82, 0, v82
v_max_f32 v83, 0, v83
v_pk_mul_f32 v[80:81], v[80:81], v[80:81]
v_pk_mul_f32 v[82:83], v[82:83], v[82:83]
v_cvt_pk_bf16_f32 v34, v80, v81
v_cvt_pk_bf16_f32 v35, v82, v83
s_cmp_eq_u32 s72, 0
s_cbranch_scc1 XS142
buffer_store_dwordx4 v[32:35], v1, s[4:7], s24 offen
s_branch XE143
XS142:
buffer_store_dwordx4 v[32:35], v1, s[4:7], s24 offen sc1
XE143:
s_add_u32 s24, s24, 55296
v_pk_fma_f32 v[68:69], v[176:177], v[138:139], v[68:69] op_sel:[0,1,0] op_sel_hi:[1,1,1]
v_pk_fma_f32 v[70:71], v[178:179], v[138:139], v[70:71] op_sel:[0,1,0] op_sel_hi:[1,1,1]
v_pk_fma_f32 v[68:69], v[68:69], v[142:143], v[184:185] op_sel:[0,1,0] op_sel_hi:[1,1,1]
v_pk_fma_f32 v[70:71], v[70:71], v[142:143], v[186:187] op_sel:[0,1,0] op_sel_hi:[1,1,1]
v_max_f32 v68, 0, v68
v_max_f32 v69, 0, v69
v_max_f32 v70, 0, v70
v_max_f32 v71, 0, v71
v_pk_mul_f32 v[68:69], v[68:69], v[68:69]
v_pk_mul_f32 v[70:71], v[70:71], v[70:71]
v_cvt_pk_bf16_f32 v36, v68, v69
v_cvt_pk_bf16_f32 v37, v70, v71
v_pk_fma_f32 v[84:85], v[180:181], v[138:139], v[84:85] op_sel:[0,1,0] op_sel_hi:[1,1,1]
v_pk_fma_f32 v[86:87], v[182:183], v[138:139], v[86:87] op_sel:[0,1,0] op_sel_hi:[1,1,1]
v_pk_fma_f32 v[84:85], v[84:85], v[142:143], v[188:189] op_sel:[0,1,0] op_sel_hi:[1,1,1]
v_pk_fma_f32 v[86:87], v[86:87], v[142:143], v[190:191] op_sel:[0,1,0] op_sel_hi:[1,1,1]
v_max_f32 v84, 0, v84
v_max_f32 v85, 0, v85
v_max_f32 v86, 0, v86
v_max_f32 v87, 0, v87
v_pk_mul_f32 v[84:85], v[84:85], v[84:85]
v_pk_mul_f32 v[86:87], v[86:87], v[86:87]
v_cvt_pk_bf16_f32 v38, v84, v85
v_cvt_pk_bf16_f32 v39, v86, v87
s_cmp_eq_u32 s72, 0
s_cbranch_scc1 XS144
buffer_store_dwordx4 v[36:39], v1, s[4:7], s24 offen
s_branch XE145
XS144:
buffer_store_dwordx4 v[36:39], v1, s[4:7], s24 offen sc1
XE145:
buffer_load_dwordx4 a[20:23], v1, s[4:7], s66 offen offset:3072
s_add_u32 s66, s66, 4096
buffer_load_dwordx4 a[24:27], v1, s[4:7], s66 offen
buffer_load_dwordx4 a[28:31], v1, s[4:7], s66 offen offset:1024
buffer_load_dwordx4 a[32:35], v1, s[4:7], s66 offen offset:2048
buffer_load_dwordx4 a[36:39], v1, s[4:7], s66 offen offset:3072
s_add_u32 s66, s66, 4096
buffer_load_dwordx4 a[40:43], v1, s[4:7], s66 offen
buffer_load_dwordx4 a[44:47], v1, s[4:7], s66 offen offset:1024
buffer_load_dwordx4 a[48:51], v1, s[4:7], s66 offen offset:2048
buffer_load_dwordx4 a[52:55], v1, s[4:7], s66 offen offset:3072
s_add_u32 s66, s66, 4096
buffer_load_dwordx4 a[56:59], v1, s[4:7], s66 offen
buffer_load_dwordx4 a[60:63], v1, s[4:7], s66 offen offset:1024
buffer_load_dwordx4 a[64:67], v1, s[4:7], s66 offen offset:2048
buffer_load_dwordx4 a[104:107], v1, s[4:7], s66 offen offset:3072
s_add_u32 s66, s66, 4096
buffer_load_dwordx4 a[108:111], v1, s[4:7], s66 offen
buffer_load_dwordx4 a[112:115], v1, s[4:7], s66 offen offset:1024
buffer_load_dwordx4 a[68:71], v1, s[4:7], s66 offen offset:2048
buffer_load_dwordx4 a[72:75], v1, s[4:7], s66 offen offset:3072
s_add_u32 s66, s66, 4096
buffer_load_dwordx4 a[76:79], v1, s[4:7], s66 offen
buffer_load_dwordx4 a[80:83], v1, s[4:7], s66 offen offset:1024
buffer_load_dwordx4 a[84:87], v1, s[4:7], s66 offen offset:2048
buffer_load_dwordx4 a[88:91], v1, s[4:7], s66 offen offset:3072
s_add_u32 s66, s66, 4096
buffer_load_dwordx4 a[92:95], v1, s[4:7], s66 offen
buffer_load_dwordx4 a[96:99], v1, s[4:7], s66 offen offset:1024
buffer_load_dwordx4 a[100:103], v1, s[4:7], s66 offen offset:2048
buffer_load_dwordx4 a[116:119], v1, s[4:7], s66 offen offset:3072
s_waitcnt vmcnt(25)
v_mov_b32 v3, 9
s_mov_b64 exec, 1
s_cmp_eq_u32 s72, 0
s_cbranch_scc1 XS146
buffer_store_dword v3, off, s[4:7], s23
s_branch XE147
XS146:
buffer_store_dword v3, off, s[4:7], s23 sc1
XE147:
s_mov_b64 exec, -1
s_nop 7
s_branch FE116
FK119:
s_waitcnt vmcnt(5)
s_waitcnt lgkmcnt(0)
s_barrier
s_waitcnt vmcnt(0)
s_barrier
s_mov_b32 m0, s70
s_nop 0
buffer_load_dwordx4 v1, s[4:7], s69 offen offset:2048 sc1 lds
s_mov_b32 m0, s70
s_nop 0
buffer_load_dwordx4 v1, s[4:7], s69 offen offset:3072 sc1 lds
s_add_u32 s69, s69, 4096
s_add_u32 s70, s70, 4096
s_mov_b32 m0, s70
s_nop 0
buffer_load_dwordx4 v1, s[4:7], s69 offen offset:0 sc1 lds
s_mov_b32 m0, s70
s_nop 0
buffer_load_dwordx4 v1, s[4:7], s69 offen offset:1024 sc1 lds
s_mov_b32 m0, s70
s_nop 0
buffer_load_dwordx4 v1, s[4:7], s69 offen offset:2048 sc1 lds
s_waitcnt vmcnt(0)
s_barrier
s_mov_b32 m0, s70
s_nop 0
buffer_load_dwordx4 v1, s[4:7], s69 offen offset:3072 sc1 lds
s_add_u32 s69, s69, 4096
s_add_u32 s70, s70, 4096
s_mov_b32 m0, s70
s_nop 0
buffer_load_dwordx4 v1, s[4:7], s69 offen offset:0 sc1 lds
s_mov_b32 m0, s70
s_nop 0
buffer_load_dwordx4 v1, s[4:7], s69 offen offset:1024 sc1 lds
s_mov_b32 m0, s70
s_nop 0
buffer_load_dwordx4 v1, s[4:7], s69 offen offset:2048 sc1 lds
s_mov_b32 m0, s70
s_nop 0
buffer_load_dwordx4 v1, s[4:7], s69 offen offset:3072 sc1 lds
s_waitcnt vmcnt(0)
s_barrier
buffer_load_dwordx4 a[184:187], v1, s[4:7], s66 offen
buffer_load_dwordx4 a[188:191], v1, s[4:7], s66 offen offset:1024
buffer_load_dwordx4 a[192:195], v1, s[4:7], s66 offen offset:2048
buffer_load_dwordx4 a[196:199], v1, s[4:7], s66 offen offset:3072
s_add_u32 s66, s66, 4096
buffer_load_dwordx4 a[200:203], v1, s[4:7], s66 offen
buffer_load_dwordx4 a[204:207], v1, s[4:7], s66 offen offset:1024
buffer_load_dwordx4 a[208:211], v1, s[4:7], s66 offen offset:2048
buffer_load_dwordx4 a[212:215], v1, s[4:7], s66 offen offset:3072
s_add_u32 s66, s66, 4096
buffer_load_dwordx4 a[216:219], v1, s[4:7], s66 offen
buffer_load_dwordx4 a[220:223], v1, s[4:7], s66 offen offset:1024
buffer_load_dwordx4 a[224:227], v1, s[4:7], s66 offen offset:2048
buffer_load_dwordx4 a[228:231], v1, s[4:7], s66 offen offset:3072
s_add_u32 s66, s66, 4096
buffer_load_dwordx4 a[232:235], v1, s[4:7], s66 offen
buffer_load_dwordx4 a[236:239], v1, s[4:7], s66 offen offset:1024
buffer_load_dwordx4 a[240:243], v1, s[4:7], s66 offen offset:2048
buffer_load_dwordx4 a[244:247], v1, s[4:7], s66 offen offset:3072
s_add_u32 s66, s66, 4096
buffer_load_dwordx4 a[248:251], v1, s[4:7], s66 offen
buffer_load_dwordx4 a[252:255], v1, s[4:7], s66 offen offset:1024
buffer_load_dwordx4 a[0:3], v1, s[4:7], s66 offen offset:2048
buffer_load_dwordx4 a[4:7], v1, s[4:7], s66 offen offset:3072
s_add_u32 s66, s66, 4096
buffer_load_dwordx4 a[8:11], v1, s[4:7], s66 offen
buffer_load_dwordx4 a[12:15], v1, s[4:7], s66 offen offset:1024
buffer_load_dwordx4 a[16:19], v1, s[4:7], s66 offen offset:2048
buffer_load_dwordx4 a[20:23], v1, s[4:7], s66 offen offset:3072
s_add_u32 s66, s66, 4096
buffer_load_dwordx4 a[24:27], v1, s[4:7], s66 offen
buffer_load_dwordx4 a[28:31], v1, s[4:7], s66 offen offset:1024
buffer_load_dwordx4 a[32:35], v1, s[4:7], s66 offen offset:2048
buffer_load_dwordx4 a[36:39], v1, s[4:7], s66 offen offset:3072
s_add_u32 s66, s66, 4096
buffer_load_dwordx4 a[40:43], v1, s[4:7], s66 offen
buffer_load_dwordx4 a[44:47], v1, s[4:7], s66 offen offset:1024
buffer_load_dwordx4 a[48:51], v1, s[4:7], s66 offen offset:2048
buffer_load_dwordx4 a[52:55], v1, s[4:7], s66 offen offset:3072
s_add_u32 s66, s66, 4096
buffer_load_dwordx4 a[56:59], v1, s[4:7], s66 offen
buffer_load_dwordx4 a[60:63], v1, s[4:7], s66 offen offset:1024
buffer_load_dwordx4 a[64:67], v1, s[4:7], s66 offen offset:2048
buffer_load_dwordx4 a[104:107], v1, s[4:7], s66 offen offset:3072
s_add_u32 s66, s66, 4096
buffer_load_dwordx4 a[108:111], v1, s[4:7], s66 offen
buffer_load_dwordx4 a[112:115], v1, s[4:7], s66 offen offset:1024
buffer_load_dwordx4 a[68:71], v1, s[4:7], s66 offen offset:2048
buffer_load_dwordx4 a[72:75], v1, s[4:7], s66 offen offset:3072
s_add_u32 s66, s66, 4096
buffer_load_dwordx4 a[76:79], v1, s[4:7], s66 offen
buffer_load_dwordx4 a[80:83], v1, s[4:7], s66 offen offset:1024
buffer_load_dwordx4 a[84:87], v1, s[4:7], s66 offen offset:2048
buffer_load_dwordx4 a[88:91], v1, s[4:7], s66 offen offset:3072
s_add_u32 s66, s66, 4096
buffer_load_dwordx4 a[92:95], v1, s[4:7], s66 offen
buffer_load_dwordx4 a[96:99], v1, s[4:7], s66 offen offset:1024
buffer_load_dwordx4 a[100:103], v1, s[4:7], s66 offen offset:2048
buffer_load_dwordx4 a[116:119], v1, s[4:7], s66 offen offset:3072
s_waitcnt vmcnt(48)
v_mov_b32 v3, 9
s_mov_b64 exec, 1
s_cmp_eq_u32 s72, 0
s_cbranch_scc1 XS148
buffer_store_dword v3, off, s[4:7], s23
s_branch XE149
XS148:
buffer_store_dword v3, off, s[4:7], s23 sc1
XE149:
s_mov_b64 exec, -1
s_nop 7
s_branch FE116
FE116:
s_add_u32 s24, s22, 1
s_and_b32 s24, s24, 3
s_add_u32 s24, s24, s61
s_mul_i32 s24, s24, 54
s_add_u32 s24, s24, s67
s_lshl_b32 s24, s24, 10
s_add_u32 s45, s24, 27123712
s_add_u32 s24, s22, 2
s_and_b32 s24, s24, 3
s_add_u32 s24, s24, s61
s_mul_i32 s24, s24, 54
s_add_u32 s24, s24, s67
s_lshl_b32 s24, s24, 10
s_add_u32 s46, s24, 27123712
s_add_u32 s24, s22, 3
s_and_b32 s24, s24, 3
s_add_u32 s24, s24, s61
s_mul_i32 s24, s24, 54
s_add_u32 s24, s24, s67
s_lshl_b32 s24, s24, 10
s_add_u32 s47, s24, 27123712
s_add_u32 s24, s22, 4
s_and_b32 s24, s24, 3
s_add_u32 s24, s24, s61
s_mul_i32 s24, s24, 54
s_add_u32 s24, s24, s67
s_lshl_b32 s24, s24, 10
s_add_u32 s48, s24, 27123712
s_mul_i32 s24, s21, 160
v_lshlrev_b32 v3, 3, v240
buffer_load_dwordx2 v[84:85], v3, s[16:19], s24 offen offset:0
buffer_load_dwordx2 v[86:87], v3, s[16:19], s24 offen offset:32
buffer_load_dwordx2 v[88:89], v3, s[16:19], s24 offen offset:64
buffer_load_dwordx2 v[90:91], v3, s[16:19], s24 offen offset:96
buffer_load_dwordx2 v[92:93], v3, s[16:19], s24 offen offset:128
s_waitcnt vmcnt(0)
v_lshlrev_b32 v94, 16, v84
v_and_b32 v95, 0xffff0000, v84
v_pk_add_f32 v[4:5], v[4:5], v[94:95]
v_lshlrev_b32 v94, 16, v85
v_and_b32 v95, 0xffff0000, v85
v_pk_add_f32 v[6:7], v[6:7], v[94:95]
v_lshlrev_b32 v94, 16, v86
v_and_b32 v95, 0xffff0000, v86
v_pk_add_f32 v[8:9], v[8:9], v[94:95]
v_lshlrev_b32 v94, 16, v87
v_and_b32 v95, 0xffff0000, v87
v_pk_add_f32 v[10:11], v[10:11], v[94:95]
v_lshlrev_b32 v94, 16, v88
v_and_b32 v95, 0xffff0000, v88
v_pk_add_f32 v[12:13], v[12:13], v[94:95]
v_lshlrev_b32 v94, 16, v89
v_and_b32 v95, 0xffff0000, v89
v_pk_add_f32 v[14:15], v[14:15], v[94:95]
v_lshlrev_b32 v94, 16, v90
v_and_b32 v95, 0xffff0000, v90
v_pk_add_f32 v[16:17], v[16:17], v[94:95]
v_lshlrev_b32 v94, 16, v91
v_and_b32 v95, 0xffff0000, v91
v_pk_add_f32 v[18:19], v[18:19], v[94:95]
v_lshlrev_b32 v94, 16, v92
v_and_b32 v95, 0xffff0000, v92
v_pk_add_f32 v[20:21], v[20:21], v[94:95]
v_lshlrev_b32 v94, 16, v93
v_and_b32 v95, 0xffff0000, v93
v_pk_add_f32 v[22:23], v[22:23], v[94:95]
s_mov_b32 s24, 30000
PL150:
buffer_load_dword v3, v236, s[4:7], 0 offen sc1
s_waitcnt vmcnt(0)
v_cmp_gt_u32 vcc, 9, v3
s_sub_u32 s24, s24, 1
s_cbranch_scc1 PD151
s_cbranch_vccnz PL150
PD151:
buffer_load_dwordx4 a[120:123], v1, s[4:7], s45 offen sc1
buffer_load_dwordx4 a[124:127], v1, s[4:7], s46 offen sc1
buffer_load_dwordx4 a[128:131], v1, s[4:7], s47 offen sc1
buffer_load_dwordx4 a[132:135], v1, s[4:7], s48 offen sc1
buffer_load_dwordx4 a[136:139], v1, s[4:7], s45 offen offset:1024 sc1
buffer_load_dwordx4 a[140:143], v1, s[4:7], s46 offen offset:1024 sc1
buffer_load_dwordx4 a[144:147], v1, s[4:7], s47 offen offset:1024 sc1
buffer_load_dwordx4 a[148:151], v1, s[4:7], s48 offen offset:1024 sc1
buffer_load_dwordx4 a[152:155], v1, s[4:7], s45 offen offset:2048 sc1
buffer_load_dwordx4 a[156:159], v1, s[4:7], s46 offen offset:2048 sc1
buffer_load_dwordx4 a[160:163], v1, s[4:7], s47 offen offset:2048 sc1
buffer_load_dwordx4 a[164:167], v1, s[4:7], s48 offen offset:2048 sc1
buffer_load_dwordx4 a[168:171], v1, s[4:7], s45 offen offset:3072 sc1
buffer_load_dwordx4 a[172:175], v1, s[4:7], s46 offen offset:3072 sc1
buffer_load_dwordx4 a[176:179], v1, s[4:7], s47 offen offset:3072 sc1
buffer_load_dwordx4 a[180:183], v1, s[4:7], s48 offen offset:3072 sc1
s_waitcnt vmcnt(15)
v_mfma_f32_16x16x32_bf16 v[24:27], a[184:187], a[120:123], 0
s_waitcnt vmcnt(14)
v_mfma_f32_16x16x32_bf16 v[44:47], a[184:187], a[124:127], 0
s_waitcnt vmcnt(13)
v_mfma_f32_16x16x32_bf16 v[64:67], a[184:187], a[128:131], 0
s_waitcnt vmcnt(12)
v_mfma_f32_16x16x32_bf16 v[4:7], a[184:187], a[132:135], v[4:7]
s_add_u32 s45, s45, 4096
buffer_load_dwordx4 a[184:187], v1, s[4:7], s45 offen sc1
v_mfma_f32_16x16x32_bf16 v[28:31], a[188:191], a[120:123], 0
v_mfma_f32_16x16x32_bf16 v[48:51], a[188:191], a[124:127], 0
v_mfma_f32_16x16x32_bf16 v[68:71], a[188:191], a[128:131], 0
v_mfma_f32_16x16x32_bf16 v[8:11], a[188:191], a[132:135], v[8:11]
s_add_u32 s46, s46, 4096
buffer_load_dwordx4 a[188:191], v1, s[4:7], s46 offen sc1
v_mfma_f32_16x16x32_bf16 v[32:35], a[192:195], a[120:123], 0
v_mfma_f32_16x16x32_bf16 v[52:55], a[192:195], a[124:127], 0
v_mfma_f32_16x16x32_bf16 v[72:75], a[192:195], a[128:131], 0
v_mfma_f32_16x16x32_bf16 v[12:15], a[192:195], a[132:135], v[12:15]
s_add_u32 s47, s47, 4096
buffer_load_dwordx4 a[192:195], v1, s[4:7], s47 offen sc1
v_mfma_f32_16x16x32_bf16 v[36:39], a[196:199], a[120:123], 0
v_mfma_f32_16x16x32_bf16 v[56:59], a[196:199], a[124:127], 0
v_mfma_f32_16x16x32_bf16 v[76:79], a[196:199], a[128:131], 0
v_mfma_f32_16x16x32_bf16 v[16:19], a[196:199], a[132:135], v[16:19]
s_add_u32 s48, s48, 4096
buffer_load_dwordx4 a[196:199], v1, s[4:7], s48 offen sc1
v_mfma_f32_16x16x32_bf16 v[40:43], a[200:203], a[120:123], 0
v_mfma_f32_16x16x32_bf16 v[60:63], a[200:203], a[124:127], 0
v_mfma_f32_16x16x32_bf16 v[80:83], a[200:203], a[128:131], 0
v_mfma_f32_16x16x32_bf16 v[20:23], a[200:203], a[132:135], v[20:23]
buffer_load_dwordx4 a[200:203], v1, s[4:7], s45 offen offset:1024 sc1
s_waitcnt vmcnt(16)
v_mfma_f32_16x16x32_bf16 v[24:27], a[204:207], a[136:139], v[24:27]
s_waitcnt vmcnt(15)
v_mfma_f32_16x16x32_bf16 v[44:47], a[204:207], a[140:143], v[44:47]
buffer_load_dwordx4 a[120:123], v1, s[4:7], s46 offen offset:1024 sc1
s_waitcnt vmcnt(15)
v_mfma_f32_16x16x32_bf16 v[64:67], a[204:207], a[144:147], v[64:67]
s_waitcnt vmcnt(14)
v_mfma_f32_16x16x32_bf16 v[4:7], a[204:207], a[148:151], v[4:7]
buffer_load_dwordx4 a[124:127], v1, s[4:7], s47 offen offset:1024 sc1
v_mfma_f32_16x16x32_bf16 v[28:31], a[208:211], a[136:139], v[28:31]
v_mfma_f32_16x16x32_bf16 v[48:51], a[208:211], a[140:143], v[48:51]
buffer_load_dwordx4 a[128:131], v1, s[4:7], s48 offen offset:1024 sc1
v_mfma_f32_16x16x32_bf16 v[68:71], a[208:211], a[144:147], v[68:71]
v_mfma_f32_16x16x32_bf16 v[8:11], a[208:211], a[148:151], v[8:11]
buffer_load_dwordx4 a[132:135], v1, s[4:7], s45 offen offset:2048 sc1
v_mfma_f32_16x16x32_bf16 v[32:35], a[212:215], a[136:139], v[32:35]
v_mfma_f32_16x16x32_bf16 v[52:55], a[212:215], a[140:143], v[52:55]
buffer_load_dwordx4 a[204:207], v1, s[4:7], s46 offen offset:2048 sc1
v_mfma_f32_16x16x32_bf16 v[72:75], a[212:215], a[144:147], v[72:75]
v_mfma_f32_16x16x32_bf16 v[12:15], a[212:215], a[148:151], v[12:15]
buffer_load_dwordx4 a[208:211], v1, s[4:7], s47 offen offset:2048 sc1
v_mfma_f32_16x16x32_bf16 v[36:39], a[216:219], a[136:139], v[36:39]
v_mfma_f32_16x16x32_bf16 v[56:59], a[216:219], a[140:143], v[56:59]
buffer_load_dwordx4 a[212:215], v1, s[4:7], s48 offen offset:2048 sc1
v_mfma_f32_16x16x32_bf16 v[76:79], a[216:219], a[144:147], v[76:79]
v_mfma_f32_16x16x32_bf16 v[16:19], a[216:219], a[148:151], v[16:19]
buffer_load_dwordx4 a[216:219], v1, s[4:7], s45 offen offset:3072 sc1
v_mfma_f32_16x16x32_bf16 v[40:43], a[220:223], a[136:139], v[40:43]
v_mfma_f32_16x16x32_bf16 v[60:63], a[220:223], a[140:143], v[60:63]
v_mfma_f32_16x16x32_bf16 v[80:83], a[220:223], a[144:147], v[80:83]
v_mfma_f32_16x16x32_bf16 v[20:23], a[220:223], a[148:151], v[20:23]
buffer_load_dwordx4 a[220:223], v1, s[4:7], s46 offen offset:3072 sc1
s_waitcnt vmcnt(21)
v_mfma_f32_16x16x32_bf16 v[24:27], a[224:227], a[152:155], v[24:27]
s_waitcnt vmcnt(20)
v_mfma_f32_16x16x32_bf16 v[44:47], a[224:227], a[156:159], v[44:47]
buffer_load_dwordx4 a[136:139], v1, s[4:7], s47 offen offset:3072 sc1
s_waitcnt vmcnt(20)
v_mfma_f32_16x16x32_bf16 v[64:67], a[224:227], a[160:163], v[64:67]
s_waitcnt vmcnt(19)
v_mfma_f32_16x16x32_bf16 v[4:7], a[224:227], a[164:167], v[4:7]
buffer_load_dwordx4 a[140:143], v1, s[4:7], s48 offen offset:3072 sc1
v_mfma_f32_16x16x32_bf16 v[28:31], a[228:231], a[152:155], v[28:31]
v_mfma_f32_16x16x32_bf16 v[48:51], a[228:231], a[156:159], v[48:51]
s_add_u32 s45, s45, 4096
buffer_load_dwordx4 a[144:147], v1, s[4:7], s45 offen sc1
v_mfma_f32_16x16x32_bf16 v[68:71], a[228:231], a[160:163], v[68:71]
v_mfma_f32_16x16x32_bf16 v[8:11], a[228:231], a[164:167], v[8:11]
s_add_u32 s46, s46, 4096
buffer_load_dwordx4 a[148:151], v1, s[4:7], s46 offen sc1
v_mfma_f32_16x16x32_bf16 v[32:35], a[232:235], a[152:155], v[32:35]
v_mfma_f32_16x16x32_bf16 v[52:55], a[232:235], a[156:159], v[52:55]
s_add_u32 s47, s47, 4096
buffer_load_dwordx4 a[224:227], v1, s[4:7], s47 offen sc1
v_mfma_f32_16x16x32_bf16 v[72:75], a[232:235], a[160:163], v[72:75]
v_mfma_f32_16x16x32_bf16 v[12:15], a[232:235], a[164:167], v[12:15]
s_add_u32 s48, s48, 4096
buffer_load_dwordx4 a[228:231], v1, s[4:7], s48 offen sc1
v_mfma_f32_16x16x32_bf16 v[36:39], a[236:239], a[152:155], v[36:39]
v_mfma_f32_16x16x32_bf16 v[56:59], a[236:239], a[156:159], v[56:59]
buffer_load_dwordx4 a[232:235], v1, s[4:7], s45 offen offset:1024 sc1
v_mfma_f32_16x16x32_bf16 v[76:79], a[236:239], a[160:163], v[76:79]
v_mfma_f32_16x16x32_bf16 v[16:19], a[236:239], a[164:167], v[16:19]
buffer_load_dwordx4 a[236:239], v1, s[4:7], s46 offen offset:1024 sc1
v_mfma_f32_16x16x32_bf16 v[40:43], a[240:243], a[152:155], v[40:43]
v_mfma_f32_16x16x32_bf16 v[60:63], a[240:243], a[156:159], v[60:63]
v_mfma_f32_16x16x32_bf16 v[80:83], a[240:243], a[160:163], v[80:83]
v_mfma_f32_16x16x32_bf16 v[20:23], a[240:243], a[164:167], v[20:23]
buffer_load_dwordx4 a[240:243], v1, s[4:7], s47 offen offset:1024 sc1
s_waitcnt vmcnt(26)
v_mfma_f32_16x16x32_bf16 v[24:27], a[244:247], a[168:171], v[24:27]
s_waitcnt vmcnt(25)
v_mfma_f32_16x16x32_bf16 v[44:47], a[244:247], a[172:175], v[44:47]
buffer_load_dwordx4 a[152:155], v1, s[4:7], s48 offen offset:1024 sc1
s_waitcnt vmcnt(25)
v_mfma_f32_16x16x32_bf16 v[64:67], a[244:247], a[176:179], v[64:67]
s_waitcnt vmcnt(24)
v_mfma_f32_16x16x32_bf16 v[4:7], a[244:247], a[180:183], v[4:7]
s_add_u32 s66, s66, 4096
buffer_load_dwordx4 a[156:159], v1, s[4:7], s66 offen
v_mfma_f32_16x16x32_bf16 v[28:31], a[248:251], a[168:171], v[28:31]
v_mfma_f32_16x16x32_bf16 v[48:51], a[248:251], a[172:175], v[48:51]
buffer_load_dwordx4 a[160:163], v1, s[4:7], s66 offen offset:1024
v_mfma_f32_16x16x32_bf16 v[68:71], a[248:251], a[176:179], v[68:71]
v_mfma_f32_16x16x32_bf16 v[8:11], a[248:251], a[180:183], v[8:11]
buffer_load_dwordx4 a[164:167], v1, s[4:7], s45 offen offset:2048 sc1
v_mfma_f32_16x16x32_bf16 v[32:35], a[252:255], a[168:171], v[32:35]
v_mfma_f32_16x16x32_bf16 v[52:55], a[252:255], a[172:175], v[52:55]
buffer_load_dwordx4 a[244:247], v1, s[4:7], s46 offen offset:2048 sc1
v_mfma_f32_16x16x32_bf16 v[72:75], a[252:255], a[176:179], v[72:75]
v_mfma_f32_16x16x32_bf16 v[12:15], a[252:255], a[180:183], v[12:15]
buffer_load_dwordx4 a[248:251], v1, s[4:7], s47 offen offset:2048 sc1
v_mfma_f32_16x16x32_bf16 v[36:39], a[0:3], a[168:171], v[36:39]
v_mfma_f32_16x16x32_bf16 v[56:59], a[0:3], a[172:175], v[56:59]
buffer_load_dwordx4 a[252:255], v1, s[4:7], s48 offen offset:2048 sc1
v_mfma_f32_16x16x32_bf16 v[76:79], a[0:3], a[176:179], v[76:79]
v_mfma_f32_16x16x32_bf16 v[16:19], a[0:3], a[180:183], v[16:19]
buffer_load_dwordx4 a[0:3], v1, s[4:7], s66 offen offset:2048
v_mfma_f32_16x16x32_bf16 v[40:43], a[4:7], a[168:171], v[40:43]
v_mfma_f32_16x16x32_bf16 v[60:63], a[4:7], a[172:175], v[60:63]
v_mfma_f32_16x16x32_bf16 v[80:83], a[4:7], a[176:179], v[80:83]
v_mfma_f32_16x16x32_bf16 v[20:23], a[4:7], a[180:183], v[20:23]
buffer_load_dwordx4 a[4:7], v1, s[4:7], s66 offen offset:3072
s_waitcnt vmcnt(31)
v_mfma_f32_16x16x32_bf16 v[24:27], a[8:11], a[184:187], v[24:27]
s_waitcnt vmcnt(30)
v_mfma_f32_16x16x32_bf16 v[44:47], a[8:11], a[188:191], v[44:47]
s_add_u32 s66, s66, 4096
buffer_load_dwordx4 a[168:171], v1, s[4:7], s66 offen
s_waitcnt vmcnt(30)
v_mfma_f32_16x16x32_bf16 v[64:67], a[8:11], a[192:195], v[64:67]
s_waitcnt vmcnt(29)
v_mfma_f32_16x16x32_bf16 v[4:7], a[8:11], a[196:199], v[4:7]
buffer_load_dwordx4 a[172:175], v1, s[4:7], s66 offen offset:1024
v_mfma_f32_16x16x32_bf16 v[28:31], a[12:15], a[184:187], v[28:31]
v_mfma_f32_16x16x32_bf16 v[48:51], a[12:15], a[188:191], v[48:51]
buffer_load_dwordx4 a[176:179], v1, s[4:7], s66 offen offset:2048
v_mfma_f32_16x16x32_bf16 v[68:71], a[12:15], a[192:195], v[68:71]
v_mfma_f32_16x16x32_bf16 v[8:11], a[12:15], a[196:199], v[8:11]
buffer_load_dwordx4 a[180:183], v1, s[4:7], s45 offen offset:3072 sc1
v_mfma_f32_16x16x32_bf16 v[32:35], a[16:19], a[184:187], v[32:35]
v_mfma_f32_16x16x32_bf16 v[52:55], a[16:19], a[188:191], v[52:55]
buffer_load_dwordx4 a[8:11], v1, s[4:7], s46 offen offset:3072 sc1
v_mfma_f32_16x16x32_bf16 v[72:75], a[16:19], a[192:195], v[72:75]
v_mfma_f32_16x16x32_bf16 v[12:15], a[16:19], a[196:199], v[12:15]
buffer_load_dwordx4 a[12:15], v1, s[4:7], s47 offen offset:3072 sc1
v_mfma_f32_16x16x32_bf16 v[36:39], a[20:23], a[184:187], v[36:39]
v_mfma_f32_16x16x32_bf16 v[56:59], a[20:23], a[188:191], v[56:59]
buffer_load_dwordx4 a[16:19], v1, s[4:7], s48 offen offset:3072 sc1
v_mfma_f32_16x16x32_bf16 v[76:79], a[20:23], a[192:195], v[76:79]
v_mfma_f32_16x16x32_bf16 v[16:19], a[20:23], a[196:199], v[16:19]
buffer_load_dwordx4 a[20:23], v1, s[4:7], s66 offen offset:3072
v_mfma_f32_16x16x32_bf16 v[40:43], a[24:27], a[184:187], v[40:43]
v_mfma_f32_16x16x32_bf16 v[60:63], a[24:27], a[188:191], v[60:63]
v_mfma_f32_16x16x32_bf16 v[80:83], a[24:27], a[192:195], v[80:83]
v_mfma_f32_16x16x32_bf16 v[20:23], a[24:27], a[196:199], v[20:23]
s_add_u32 s66, s66, 4096
buffer_load_dwordx4 a[24:27], v1, s[4:7], s66 offen
s_waitcnt vmcnt(36)
v_mfma_f32_16x16x32_bf16 v[24:27], a[28:31], a[200:203], v[24:27]
s_waitcnt vmcnt(35)
v_mfma_f32_16x16x32_bf16 v[44:47], a[28:31], a[120:123], v[44:47]
buffer_load_dwordx4 a[184:187], v1, s[4:7], s66 offen offset:1024
s_waitcnt vmcnt(35)
v_mfma_f32_16x16x32_bf16 v[64:67], a[28:31], a[124:127], v[64:67]
s_waitcnt vmcnt(34)
v_mfma_f32_16x16x32_bf16 v[4:7], a[28:31], a[128:131], v[4:7]
buffer_load_dwordx4 a[188:191], v1, s[4:7], s66 offen offset:2048
v_mfma_f32_16x16x32_bf16 v[28:31], a[32:35], a[200:203], v[28:31]
v_mfma_f32_16x16x32_bf16 v[48:51], a[32:35], a[120:123], v[48:51]
buffer_load_dwordx4 a[192:195], v1, s[4:7], s66 offen offset:3072
v_mfma_f32_16x16x32_bf16 v[68:71], a[32:35], a[124:127], v[68:71]
v_mfma_f32_16x16x32_bf16 v[8:11], a[32:35], a[128:131], v[8:11]
s_add_u32 s45, s45, 4096
buffer_load_dwordx4 a[196:199], v1, s[4:7], s45 offen sc1
v_mfma_f32_16x16x32_bf16 v[32:35], a[36:39], a[200:203], v[32:35]
v_mfma_f32_16x16x32_bf16 v[52:55], a[36:39], a[120:123], v[52:55]
s_add_u32 s46, s46, 4096
buffer_load_dwordx4 a[28:31], v1, s[4:7], s46 offen sc1
v_mfma_f32_16x16x32_bf16 v[72:75], a[36:39], a[124:127], v[72:75]
v_mfma_f32_16x16x32_bf16 v[12:15], a[36:39], a[128:131], v[12:15]
s_add_u32 s47, s47, 4096
buffer_load_dwordx4 a[32:35], v1, s[4:7], s47 offen sc1
v_mfma_f32_16x16x32_bf16 v[36:39], a[40:43], a[200:203], v[36:39]
v_mfma_f32_16x16x32_bf16 v[56:59], a[40:43], a[120:123], v[56:59]
s_add_u32 s48, s48, 4096
buffer_load_dwordx4 a[36:39], v1, s[4:7], s48 offen sc1
v_mfma_f32_16x16x32_bf16 v[76:79], a[40:43], a[124:127], v[76:79]
v_mfma_f32_16x16x32_bf16 v[16:19], a[40:43], a[128:131], v[16:19]
s_add_u32 s66, s66, 4096
buffer_load_dwordx4 a[40:43], v1, s[4:7], s66 offen
v_mfma_f32_16x16x32_bf16 v[40:43], a[44:47], a[200:203], v[40:43]
v_mfma_f32_16x16x32_bf16 v[60:63], a[44:47], a[120:123], v[60:63]
v_mfma_f32_16x16x32_bf16 v[80:83], a[44:47], a[124:127], v[80:83]
v_mfma_f32_16x16x32_bf16 v[20:23], a[44:47], a[128:131], v[20:23]
buffer_load_dwordx4 a[44:47], v1, s[4:7], s66 offen offset:1024
s_waitcnt vmcnt(41)
v_mfma_f32_16x16x32_bf16 v[24:27], a[48:51], a[132:135], v[24:27]
s_waitcnt vmcnt(40)
v_mfma_f32_16x16x32_bf16 v[44:47], a[48:51], a[204:207], v[44:47]
buffer_load_dwordx4 a[200:203], v1, s[4:7], s66 offen offset:2048
s_waitcnt vmcnt(40)
v_mfma_f32_16x16x32_bf16 v[64:67], a[48:51], a[208:211], v[64:67]
s_waitcnt vmcnt(39)
v_mfma_f32_16x16x32_bf16 v[4:7], a[48:51], a[212:215], v[4:7]
buffer_load_dwordx4 a[120:123], v1, s[4:7], s66 offen offset:3072
v_mfma_f32_16x16x32_bf16 v[28:31], a[52:55], a[132:135], v[28:31]
v_mfma_f32_16x16x32_bf16 v[48:51], a[52:55], a[204:207], v[48:51]
s_add_u32 s66, s66, 4096
buffer_load_dwordx4 a[124:127], v1, s[4:7], s66 offen
v_mfma_f32_16x16x32_bf16 v[68:71], a[52:55], a[208:211], v[68:71]
v_mfma_f32_16x16x32_bf16 v[8:11], a[52:55], a[212:215], v[8:11]
buffer_load_dwordx4 a[128:131], v1, s[4:7], s45 offen offset:1024 sc1
v_mfma_f32_16x16x32_bf16 v[32:35], a[56:59], a[132:135], v[32:35]
v_mfma_f32_16x16x32_bf16 v[52:55], a[56:59], a[204:207], v[52:55]
buffer_load_dwordx4 a[48:51], v1, s[4:7], s46 offen offset:1024 sc1
v_mfma_f32_16x16x32_bf16 v[72:75], a[56:59], a[208:211], v[72:75]
v_mfma_f32_16x16x32_bf16 v[12:15], a[56:59], a[212:215], v[12:15]
buffer_load_dwordx4 a[52:55], v1, s[4:7], s47 offen offset:1024 sc1
v_mfma_f32_16x16x32_bf16 v[36:39], a[60:63], a[132:135], v[36:39]
v_mfma_f32_16x16x32_bf16 v[56:59], a[60:63], a[204:207], v[56:59]
buffer_load_dwordx4 a[56:59], v1, s[4:7], s48 offen offset:1024 sc1
v_mfma_f32_16x16x32_bf16 v[76:79], a[60:63], a[208:211], v[76:79]
v_mfma_f32_16x16x32_bf16 v[16:19], a[60:63], a[212:215], v[16:19]
buffer_load_dwordx4 a[60:63], v1, s[4:7], s66 offen offset:1024
v_mfma_f32_16x16x32_bf16 v[40:43], a[64:67], a[132:135], v[40:43]
v_mfma_f32_16x16x32_bf16 v[60:63], a[64:67], a[204:207], v[60:63]
v_mfma_f32_16x16x32_bf16 v[80:83], a[64:67], a[208:211], v[80:83]
v_mfma_f32_16x16x32_bf16 v[20:23], a[64:67], a[212:215], v[20:23]
buffer_load_dwordx4 a[64:67], v1, s[4:7], s66 offen offset:2048
s_waitcnt vmcnt(46)
v_mfma_f32_16x16x32_bf16 v[24:27], a[104:107], a[216:219], v[24:27]
s_waitcnt vmcnt(45)
v_mfma_f32_16x16x32_bf16 v[44:47], a[104:107], a[220:223], v[44:47]
buffer_load_dwordx4 a[132:135], v1, s[4:7], s66 offen offset:3072
s_waitcnt vmcnt(45)
v_mfma_f32_16x16x32_bf16 v[64:67], a[104:107], a[136:139], v[64:67]
s_waitcnt vmcnt(44)
v_mfma_f32_16x16x32_bf16 v[4:7], a[104:107], a[140:143], v[4:7]
s_add_u32 s66, s66, 4096
buffer_load_dwordx4 a[204:207], v1, s[4:7], s66 offen
v_mfma_f32_16x16x32_bf16 v[28:31], a[108:111], a[216:219], v[28:31]
v_mfma_f32_16x16x32_bf16 v[48:51], a[108:111], a[220:223], v[48:51]
buffer_load_dwordx4 a[208:211], v1, s[4:7], s66 offen offset:1024
v_mfma_f32_16x16x32_bf16 v[68:71], a[108:111], a[136:139], v[68:71]
v_mfma_f32_16x16x32_bf16 v[8:11], a[108:111], a[140:143], v[8:11]
v_mfma_f32_16x16x32_bf16 v[32:35], a[112:115], a[216:219], v[32:35]
v_mfma_f32_16x16x32_bf16 v[52:55], a[112:115], a[220:223], v[52:55]
v_mfma_f32_16x16x32_bf16 v[72:75], a[112:115], a[136:139], v[72:75]
v_mfma_f32_16x16x32_bf16 v[12:15], a[112:115], a[140:143], v[12:15]
v_mfma_f32_16x16x32_bf16 v[36:39], a[68:71], a[216:219], v[36:39]
v_mfma_f32_16x16x32_bf16 v[56:59], a[68:71], a[220:223], v[56:59]
v_mfma_f32_16x16x32_bf16 v[76:79], a[68:71], a[136:139], v[76:79]
v_mfma_f32_16x16x32_bf16 v[16:19], a[68:71], a[140:143], v[16:19]
v_mfma_f32_16x16x32_bf16 v[40:43], a[72:75], a[216:219], v[40:43]
v_mfma_f32_16x16x32_bf16 v[60:63], a[72:75], a[220:223], v[60:63]
v_mfma_f32_16x16x32_bf16 v[80:83], a[72:75], a[136:139], v[80:83]
v_mfma_f32_16x16x32_bf16 v[20:23], a[72:75], a[140:143], v[20:23]
s_waitcnt vmcnt(45)
v_mfma_f32_16x16x32_bf16 v[24:27], a[76:79], a[144:147], v[24:27]
s_waitcnt vmcnt(44)
v_mfma_f32_16x16x32_bf16 v[44:47], a[76:79], a[148:151], v[44:47]
s_waitcnt vmcnt(43)
v_mfma_f32_16x16x32_bf16 v[64:67], a[76:79], a[224:227], v[64:67]
s_waitcnt vmcnt(42)
v_mfma_f32_16x16x32_bf16 v[4:7], a[76:79], a[228:231], v[4:7]
v_mfma_f32_16x16x32_bf16 v[28:31], a[80:83], a[144:147], v[28:31]
v_mfma_f32_16x16x32_bf16 v[48:51], a[80:83], a[148:151], v[48:51]
v_mfma_f32_16x16x32_bf16 v[68:71], a[80:83], a[224:227], v[68:71]
v_mfma_f32_16x16x32_bf16 v[8:11], a[80:83], a[228:231], v[8:11]
v_mfma_f32_16x16x32_bf16 v[32:35], a[84:87], a[144:147], v[32:35]
v_mfma_f32_16x16x32_bf16 v[52:55], a[84:87], a[148:151], v[52:55]
v_mfma_f32_16x16x32_bf16 v[72:75], a[84:87], a[224:227], v[72:75]
v_mfma_f32_16x16x32_bf16 v[12:15], a[84:87], a[228:231], v[12:15]
v_mfma_f32_16x16x32_bf16 v[36:39], a[88:91], a[144:147], v[36:39]
v_mfma_f32_16x16x32_bf16 v[56:59], a[88:91], a[148:151], v[56:59]
v_mfma_f32_16x16x32_bf16 v[76:79], a[88:91], a[224:227], v[76:79]
v_mfma_f32_16x16x32_bf16 v[16:19], a[88:91], a[228:231], v[16:19]
v_mfma_f32_16x16x32_bf16 v[40:43], a[92:95], a[144:147], v[40:43]
v_mfma_f32_16x16x32_bf16 v[60:63], a[92:95], a[148:151], v[60:63]
v_mfma_f32_16x16x32_bf16 v[80:83], a[92:95], a[224:227], v[80:83]
v_mfma_f32_16x16x32_bf16 v[20:23], a[92:95], a[228:231], v[20:23]
s_waitcnt vmcnt(41)
v_mfma_f32_16x16x32_bf16 v[24:27], a[96:99], a[232:235], v[24:27]
s_waitcnt vmcnt(40)
v_mfma_f32_16x16x32_bf16 v[44:47], a[96:99], a[236:239], v[44:47]
s_waitcnt vmcnt(39)
v_mfma_f32_16x16x32_bf16 v[64:67], a[96:99], a[240:243], v[64:67]
s_waitcnt vmcnt(38)
v_mfma_f32_16x16x32_bf16 v[4:7], a[96:99], a[152:155], v[4:7]
v_mfma_f32_16x16x32_bf16 v[28:31], a[100:103], a[232:235], v[28:31]
v_mfma_f32_16x16x32_bf16 v[48:51], a[100:103], a[236:239], v[48:51]
v_mfma_f32_16x16x32_bf16 v[68:71], a[100:103], a[240:243], v[68:71]
v_mfma_f32_16x16x32_bf16 v[8:11], a[100:103], a[152:155], v[8:11]
v_mfma_f32_16x16x32_bf16 v[32:35], a[116:119], a[232:235], v[32:35]
v_mfma_f32_16x16x32_bf16 v[52:55], a[116:119], a[236:239], v[52:55]
v_mfma_f32_16x16x32_bf16 v[72:75], a[116:119], a[240:243], v[72:75]
v_mfma_f32_16x16x32_bf16 v[12:15], a[116:119], a[152:155], v[12:15]
s_waitcnt vmcnt(37)
v_mfma_f32_16x16x32_bf16 v[36:39], a[156:159], a[232:235], v[36:39]
v_mfma_f32_16x16x32_bf16 v[56:59], a[156:159], a[236:239], v[56:59]
v_mfma_f32_16x16x32_bf16 v[76:79], a[156:159], a[240:243], v[76:79]
v_mfma_f32_16x16x32_bf16 v[16:19], a[156:159], a[152:155], v[16:19]
s_waitcnt vmcnt(36)
v_mfma_f32_16x16x32_bf16 v[40:43], a[160:163], a[232:235], v[40:43]
v_mfma_f32_16x16x32_bf16 v[60:63], a[160:163], a[236:239], v[60:63]
v_mfma_f32_16x16x32_bf16 v[80:83], a[160:163], a[240:243], v[80:83]
v_mfma_f32_16x16x32_bf16 v[20:23], a[160:163], a[152:155], v[20:23]
s_waitcnt vmcnt(31)
v_mfma_f32_16x16x32_bf16 v[24:27], a[0:3], a[164:167], v[24:27]
v_mfma_f32_16x16x32_bf16 v[44:47], a[0:3], a[244:247], v[44:47]
v_mfma_f32_16x16x32_bf16 v[64:67], a[0:3], a[248:251], v[64:67]
v_mfma_f32_16x16x32_bf16 v[4:7], a[0:3], a[252:255], v[4:7]
s_waitcnt vmcnt(30)
v_mfma_f32_16x16x32_bf16 v[28:31], a[4:7], a[164:167], v[28:31]
v_mfma_f32_16x16x32_bf16 v[48:51], a[4:7], a[244:247], v[48:51]
v_mfma_f32_16x16x32_bf16 v[68:71], a[4:7], a[248:251], v[68:71]
v_mfma_f32_16x16x32_bf16 v[8:11], a[4:7], a[252:255], v[8:11]
s_waitcnt vmcnt(29)
v_mfma_f32_16x16x32_bf16 v[32:35], a[168:171], a[164:167], v[32:35]
v_mfma_f32_16x16x32_bf16 v[52:55], a[168:171], a[244:247], v[52:55]
v_mfma_f32_16x16x32_bf16 v[72:75], a[168:171], a[248:251], v[72:75]
v_mfma_f32_16x16x32_bf16 v[12:15], a[168:171], a[252:255], v[12:15]
s_waitcnt vmcnt(28)
v_mfma_f32_16x16x32_bf16 v[36:39], a[172:175], a[164:167], v[36:39]
v_mfma_f32_16x16x32_bf16 v[56:59], a[172:175], a[244:247], v[56:59]
v_mfma_f32_16x16x32_bf16 v[76:79], a[172:175], a[248:251], v[76:79]
v_mfma_f32_16x16x32_bf16 v[16:19], a[172:175], a[252:255], v[16:19]
s_waitcnt vmcnt(27)
v_mfma_f32_16x16x32_bf16 v[40:43], a[176:179], a[164:167], v[40:43]
v_mfma_f32_16x16x32_bf16 v[60:63], a[176:179], a[244:247], v[60:63]
v_mfma_f32_16x16x32_bf16 v[80:83], a[176:179], a[248:251], v[80:83]
v_mfma_f32_16x16x32_bf16 v[20:23], a[176:179], a[252:255], v[20:23]
s_waitcnt vmcnt(22)
v_mfma_f32_16x16x32_bf16 v[24:27], a[20:23], a[180:183], v[24:27]
v_mfma_f32_16x16x32_bf16 v[44:47], a[20:23], a[8:11], v[44:47]
v_mfma_f32_16x16x32_bf16 v[64:67], a[20:23], a[12:15], v[64:67]
v_mfma_f32_16x16x32_bf16 v[4:7], a[20:23], a[16:19], v[4:7]
s_waitcnt vmcnt(21)
v_mfma_f32_16x16x32_bf16 v[28:31], a[24:27], a[180:183], v[28:31]
v_mfma_f32_16x16x32_bf16 v[48:51], a[24:27], a[8:11], v[48:51]
v_mfma_f32_16x16x32_bf16 v[68:71], a[24:27], a[12:15], v[68:71]
v_mfma_f32_16x16x32_bf16 v[8:11], a[24:27], a[16:19], v[8:11]
s_waitcnt vmcnt(20)
v_mfma_f32_16x16x32_bf16 v[32:35], a[184:187], a[180:183], v[32:35]
v_mfma_f32_16x16x32_bf16 v[52:55], a[184:187], a[8:11], v[52:55]
v_mfma_f32_16x16x32_bf16 v[72:75], a[184:187], a[12:15], v[72:75]
v_mfma_f32_16x16x32_bf16 v[12:15], a[184:187], a[16:19], v[12:15]
s_waitcnt vmcnt(19)
v_mfma_f32_16x16x32_bf16 v[36:39], a[188:191], a[180:183], v[36:39]
v_mfma_f32_16x16x32_bf16 v[56:59], a[188:191], a[8:11], v[56:59]
v_mfma_f32_16x16x32_bf16 v[76:79], a[188:191], a[12:15], v[76:79]
v_mfma_f32_16x16x32_bf16 v[16:19], a[188:191], a[16:19], v[16:19]
s_waitcnt vmcnt(18)
v_mfma_f32_16x16x32_bf16 v[40:43], a[192:195], a[180:183], v[40:43]
v_mfma_f32_16x16x32_bf16 v[60:63], a[192:195], a[8:11], v[60:63]
v_mfma_f32_16x16x32_bf16 v[80:83], a[192:195], a[12:15], v[80:83]
v_mfma_f32_16x16x32_bf16 v[20:23], a[192:195], a[16:19], v[20:23]
s_waitcnt vmcnt(13)
v_mfma_f32_16x16x32_bf16 v[24:27], a[40:43], a[196:199], v[24:27]
v_mfma_f32_16x16x32_bf16 v[44:47], a[40:43], a[28:31], v[44:47]
v_mfma_f32_16x16x32_bf16 v[64:67], a[40:43], a[32:35], v[64:67]
v_mfma_f32_16x16x32_bf16 v[4:7], a[40:43], a[36:39], v[4:7]
s_waitcnt vmcnt(12)
v_mfma_f32_16x16x32_bf16 v[28:31], a[44:47], a[196:199], v[28:31]
v_mfma_f32_16x16x32_bf16 v[48:51], a[44:47], a[28:31], v[48:51]
v_mfma_f32_16x16x32_bf16 v[68:71], a[44:47], a[32:35], v[68:71]
v_mfma_f32_16x16x32_bf16 v[8:11], a[44:47], a[36:39], v[8:11]
s_waitcnt vmcnt(11)
v_mfma_f32_16x16x32_bf16 v[32:35], a[200:203], a[196:199], v[32:35]
v_mfma_f32_16x16x32_bf16 v[52:55], a[200:203], a[28:31], v[52:55]
v_mfma_f32_16x16x32_bf16 v[72:75], a[200:203], a[32:35], v[72:75]
v_mfma_f32_16x16x32_bf16 v[12:15], a[200:203], a[36:39], v[12:15]
s_waitcnt vmcnt(10)
v_mfma_f32_16x16x32_bf16 v[36:39], a[120:123], a[196:199], v[36:39]
v_mfma_f32_16x16x32_bf16 v[56:59], a[120:123], a[28:31], v[56:59]
v_mfma_f32_16x16x32_bf16 v[76:79], a[120:123], a[32:35], v[76:79]
v_mfma_f32_16x16x32_bf16 v[16:19], a[120:123], a[36:39], v[16:19]
s_waitcnt vmcnt(9)
v_mfma_f32_16x16x32_bf16 v[40:43], a[124:127], a[196:199], v[40:43]
v_mfma_f32_16x16x32_bf16 v[60:63], a[124:127], a[28:31], v[60:63]
v_mfma_f32_16x16x32_bf16 v[80:83], a[124:127], a[32:35], v[80:83]
v_mfma_f32_16x16x32_bf16 v[20:23], a[124:127], a[36:39], v[20:23]
s_waitcnt vmcnt(8)
s_waitcnt vmcnt(7)
s_waitcnt vmcnt(6)
s_waitcnt vmcnt(5)
s_waitcnt vmcnt(4)
s_waitcnt vmcnt(3)
s_waitcnt vmcnt(2)
s_waitcnt vmcnt(1)
s_waitcnt vmcnt(0)
s_cmp_ge_u32 s22, 2
s_cbranch_scc1 SK152
v_mfma_f32_16x16x32_bf16 v[24:27], a[60:63], a[128:131], v[24:27]
v_mfma_f32_16x16x32_bf16 v[44:47], a[60:63], a[48:51], v[44:47]
v_mfma_f32_16x16x32_bf16 v[64:67], a[60:63], a[52:55], v[64:67]
v_mfma_f32_16x16x32_bf16 v[4:7], a[60:63], a[56:59], v[4:7]
v_mfma_f32_16x16x32_bf16 v[28:31], a[64:67], a[128:131], v[28:31]
v_mfma_f32_16x16x32_bf16 v[48:51], a[64:67], a[48:51], v[48:51]
v_mfma_f32_16x16x32_bf16 v[68:71], a[64:67], a[52:55], v[68:71]
v_mfma_f32_16x16x32_bf16 v[8:11], a[64:67], a[56:59], v[8:11]
v_mfma_f32_16x16x32_bf16 v[32:35], a[132:135], a[128:131], v[32:35]
v_mfma_f32_16x16x32_bf16 v[52:55], a[132:135], a[48:51], v[52:55]
v_mfma_f32_16x16x32_bf16 v[72:75], a[132:135], a[52:55], v[72:75]
v_mfma_f32_16x16x32_bf16 v[12:15], a[132:135], a[56:59], v[12:15]
v_mfma_f32_16x16x32_bf16 v[36:39], a[204:207], a[128:131], v[36:39]
v_mfma_f32_16x16x32_bf16 v[56:59], a[204:207], a[48:51], v[56:59]
v_mfma_f32_16x16x32_bf16 v[76:79], a[204:207], a[52:55], v[76:79]
v_mfma_f32_16x16x32_bf16 v[16:19], a[204:207], a[56:59], v[16:19]
v_mfma_f32_16x16x32_bf16 v[40:43], a[208:211], a[128:131], v[40:43]
v_mfma_f32_16x16x32_bf16 v[60:63], a[208:211], a[48:51], v[60:63]
v_mfma_f32_16x16x32_bf16 v[80:83], a[208:211], a[52:55], v[80:83]
v_mfma_f32_16x16x32_bf16 v[20:23], a[208:211], a[56:59], v[20:23]
s_nop 7
SK152:
s_add_u32 s24, s22, 1
s_and_b32 s24, s24, 3
s_mul_i32 s24, s24, 15360
v_add_u32 v3, s24, v1
ds_write_b128 v3, v[24:27] offset:0
ds_write_b128 v3, v[28:31] offset:1024
ds_write_b128 v3, v[32:35] offset:2048
ds_write_b128 v3, v[36:39] offset:3072
ds_write_b128 v3, v[40:43] offset:4096
s_add_u32 s24, s22, 2
s_and_b32 s24, s24, 3
s_mul_i32 s24, s24, 15360
v_add_u32 v3, s24, v1
ds_write_b128 v3, v[44:47] offset:5120
ds_write_b128 v3, v[48:51] offset:6144
ds_write_b128 v3, v[52:55] offset:7168
ds_write_b128 v3, v[56:59] offset:8192
ds_write_b128 v3, v[60:63] offset:9216
s_add_u32 s24, s22, 3
s_and_b32 s24, s24, 3
s_mul_i32 s24, s24, 15360
v_add_u32 v3, s24, v1
ds_write_b128 v3, v[64:67] offset:10240
ds_write_b128 v3, v[68:71] offset:11264
ds_write_b128 v3, v[72:75] offset:12288
ds_write_b128 v3, v[76:79] offset:13312
ds_write_b128 v3, v[80:83] offset:14336
s_mul_i32 s24, s22, 15360
v_add_u32 v3, s24, v1
s_waitcnt lgkmcnt(0)
s_barrier
ds_read_b128 v[24:27], v3 offset:0
ds_read_b128 v[28:31], v3 offset:1024
ds_read_b128 v[32:35], v3 offset:2048
ds_read_b128 v[36:39], v3 offset:3072
ds_read_b128 v[40:43], v3 offset:4096
ds_read_b128 v[44:47], v3 offset:5120
ds_read_b128 v[48:51], v3 offset:6144
ds_read_b128 v[52:55], v3 offset:7168
ds_read_b128 v[56:59], v3 offset:8192
ds_read_b128 v[60:63], v3 offset:9216
ds_read_b128 v[64:67], v3 offset:10240
ds_read_b128 v[68:71], v3 offset:11264
ds_read_b128 v[72:75], v3 offset:12288
ds_read_b128 v[76:79], v3 offset:13312
ds_read_b128 v[80:83], v3 offset:14336
s_waitcnt lgkmcnt(14)
v_pk_add_f32 v[4:5], v[4:5], v[24:25]
v_pk_add_f32 v[6:7], v[6:7], v[26:27]
s_waitcnt lgkmcnt(13)
v_pk_add_f32 v[8:9], v[8:9], v[28:29]
v_pk_add_f32 v[10:11], v[10:11], v[30:31]
s_waitcnt lgkmcnt(12)
v_pk_add_f32 v[12:13], v[12:13], v[32:33]
v_pk_add_f32 v[14:15], v[14:15], v[34:35]
s_waitcnt lgkmcnt(11)
v_pk_add_f32 v[16:17], v[16:17], v[36:37]
v_pk_add_f32 v[18:19], v[18:19], v[38:39]
s_waitcnt lgkmcnt(10)
v_pk_add_f32 v[20:21], v[20:21], v[40:41]
v_pk_add_f32 v[22:23], v[22:23], v[42:43]
s_waitcnt lgkmcnt(9)
v_pk_add_f32 v[4:5], v[4:5], v[44:45]
v_pk_add_f32 v[6:7], v[6:7], v[46:47]
s_waitcnt lgkmcnt(8)
v_pk_add_f32 v[8:9], v[8:9], v[48:49]
v_pk_add_f32 v[10:11], v[10:11], v[50:51]
s_waitcnt lgkmcnt(7)
v_pk_add_f32 v[12:13], v[12:13], v[52:53]
v_pk_add_f32 v[14:15], v[14:15], v[54:55]
s_waitcnt lgkmcnt(6)
v_pk_add_f32 v[16:17], v[16:17], v[56:57]
v_pk_add_f32 v[18:19], v[18:19], v[58:59]
s_waitcnt lgkmcnt(5)
v_pk_add_f32 v[20:21], v[20:21], v[60:61]
v_pk_add_f32 v[22:23], v[22:23], v[62:63]
s_waitcnt lgkmcnt(4)
v_pk_add_f32 v[4:5], v[4:5], v[64:65]
v_pk_add_f32 v[6:7], v[6:7], v[66:67]
s_waitcnt lgkmcnt(3)
v_pk_add_f32 v[8:9], v[8:9], v[68:69]
v_pk_add_f32 v[10:11], v[10:11], v[70:71]
s_waitcnt lgkmcnt(2)
v_pk_add_f32 v[12:13], v[12:13], v[72:73]
v_pk_add_f32 v[14:15], v[14:15], v[74:75]
s_waitcnt lgkmcnt(1)
v_pk_add_f32 v[16:17], v[16:17], v[76:77]
v_pk_add_f32 v[18:19], v[18:19], v[78:79]
s_waitcnt lgkmcnt(0)
v_pk_add_f32 v[20:21], v[20:21], v[80:81]
v_pk_add_f32 v[22:23], v[22:23], v[82:83]
v_cvt_pk_bf16_f32 v24, v4, v5
v_cvt_pk_bf16_f32 v25, v6, v7
v_cvt_pk_bf16_f32 v26, v8, v9
v_cvt_pk_bf16_f32 v27, v10, v11
v_cvt_pk_bf16_f32 v28, v12, v13
v_cvt_pk_bf16_f32 v29, v14, v15
v_cvt_pk_bf16_f32 v30, v16, v17
v_cvt_pk_bf16_f32 v31, v18, v19
v_cvt_pk_bf16_f32 v32, v20, v21
v_cvt_pk_bf16_f32 v33, v22, v23
s_lshl_b32 s24, s62, 4
v_add_u32 v3, s24, v241
v_mul_u32_u24 v3, 1280, v3
v_lshlrev_b32 v34, 3, v240
v_add_u32 v3, v3, v34
s_mul_i32 s24, s21, 160
buffer_store_dwordx2 v[24:25], v3, s[8:11], s24 offen offset:0
buffer_store_dwordx2 v[26:27], v3, s[8:11], s24 offen offset:32
buffer_store_dwordx2 v[28:29], v3, s[8:11], s24 offen offset:64
buffer_store_dwordx2 v[30:31], v3, s[8:11], s24 offen offset:96
buffer_store_dwordx2 v[32:33], v3, s[8:11], s24 offen offset:128
s_waitcnt vmcnt(0)
M_END:
s_endpgm
.section .rodata,"a"
.p2align 6
.amdhsa_kernel prep_kernel
  .amdhsa_next_free_vgpr 76
  .amdhsa_next_free_sgpr 102
  .amdhsa_accum_offset 76
  .amdhsa_group_segment_fixed_size 0
  .amdhsa_kernarg_size 88
  .amdhsa_user_sgpr_count 2
  .amdhsa_user_sgpr_kernarg_segment_ptr 1
  .amdhsa_system_sgpr_workgroup_id_x 1
.end_amdhsa_kernel
.p2align 6
.amdhsa_kernel interleave_layers__sliding_block__dense_activation_squared_relu__prompt_kernel
  .amdhsa_next_free_vgpr 512
  .amdhsa_next_free_sgpr 102
  .amdhsa_accum_offset 256
  .amdhsa_group_segment_fixed_size 0
  .amdhsa_kernarg_size 88
  .amdhsa_user_sgpr_count 2
  .amdhsa_user_sgpr_kernarg_segment_ptr 1
  .amdhsa_system_sgpr_workgroup_id_x 1
.end_amdhsa_kernel
```
